```python
import torch

def _softmax(x, axis=-1):
    return torch.softmax(x, dim=axis)
def _gelu(x):
    return torch.nn.functional.gelu(x, approximate="tanh")
def _silu(x):
    return torch.nn.functional.silu(x)
def _sigmoid(x):
    return torch.sigmoid(x)
def _layernorm(x, axis=-1, eps=1e-5):
    m = x.mean(dim=axis, keepdim=True)
    v = x.var(dim=axis, keepdim=True, unbiased=False)
    return (x - m) / torch.sqrt(v + eps)
def _scatter_add(tgt, idx, src, axis=0):
    return tgt.clone().index_add_(axis, idx, src)
def _segment_sum(src, seg, n):
    out = torch.zeros((n,) + src.shape[1:], dtype=src.dtype)
    return out.index_add_(0, seg, src)
def _pad(x, pw):
    flat = tuple(v for pair in reversed(pw) for v in pair)
    return torch.nn.functional.pad(x, flat)

kernel_name = 'parallel_sum__compressed_kv_cla__geglu_ffn__prompt'

def setup_inputs():

    _w = (lambda a: (lambda t: t.to(torch.bfloat16) if t.is_floating_point() else t)(torch.as_tensor(a)))
    def _A_setup():
        B, H, Sq, Sk, D, M = 1, 32, 2048, 2048, 128, 576
        Dc = 4 * D
        return {
            "x": _w((lambda *s: torch.randn(*s, dtype=torch.bfloat16) * 0.05)(B, Sq, M)),
            "c_kv": _w((lambda *s: torch.randn(*s, dtype=torch.bfloat16) * 1.6)(B, Sk, Dc)),
            "w_q": _w((lambda *s: torch.randn(*s, dtype=torch.bfloat16) * 0.8)(M, H, D) * (M ** -0.5)),
            "w_uk": _w((lambda *s: torch.randn(*s, dtype=torch.bfloat16) * 0.8)(Dc, H, D) * (Dc ** -0.5)),
            "w_uv": _w((lambda *s: torch.randn(*s, dtype=torch.bfloat16) * 1.6)(Dc, H, D) * (Dc ** -0.5)),
            "w_o": _w((lambda *s: torch.randn(*s, dtype=torch.bfloat16) * 1.6)(H, D, M) * ((H * D) ** -0.5)),
        }
    _A_in = _A_setup()

    def _B_setup():
        B, S, D, F = 1, 2048, 576, 4608
        return {
            "x": _w((lambda *s: torch.randn(*s, dtype=torch.bfloat16) * 0.05)(B, S, D)),
            "w_gate": _w((lambda *s: torch.randn(*s, dtype=torch.bfloat16) * 0.05)(D, F)),
            "w_up": _w((lambda *s: torch.randn(*s, dtype=torch.bfloat16) * 0.05)(D, F)),
            "w_down": _w((lambda *s: torch.randn(*s, dtype=torch.bfloat16) * 0.05)(F, D)),
        }
    _B_in = _B_setup()

    return {
        "A_x": _A_in["x"],
        "A_c_kv": _A_in["c_kv"],
        "A_w_q": _A_in["w_q"],
        "A_w_uk": _A_in["w_uk"],
        "A_w_uv": _A_in["w_uv"],
        "A_w_o": _A_in["w_o"],
        "B_x": _B_in["x"],
        "B_w_gate": _B_in["w_gate"],
        "B_w_up": _B_in["w_up"],
        "B_w_down": _B_in["w_down"],
    }

def reference(A_x, A_c_kv, A_w_q, A_w_uk, A_w_uv, A_w_o, B_x, B_w_gate, B_w_up, B_w_down):
    def _A_ref(x, c_kv, w_q, w_uk, w_uv, w_o):
        B, Sq, M = x.shape[0], x.shape[1], x.shape[2]
        Sk = c_kv.shape[1]
        H, D = w_q.shape[1], w_q.shape[2]
        q = torch.einsum("bqm,mhd->bhqd", x, w_q)
        k = torch.einsum("bkc,chd->bhkd", c_kv, w_uk)
        v = torch.einsum("bkc,chd->bhkd", c_kv, w_uv)
        scores = torch.einsum("bhqd,bhkd->bhqk", q, k) * (D ** -0.5)
        off = Sk - Sq
        qi = torch.arange(Sq)[:, None]
        kj = torch.arange(Sk)[None, :]
        cmask = kj <= (qi + off)
        scores = torch.where(cmask[None, None], scores, -1e9)
        p = _softmax(scores, axis=-1)
        ctx = torch.einsum("bhqk,bhkd->bhqd", p, v)
        return torch.einsum("bhqd,hdm->bqm", ctx, w_o)

    def _B_ref(x, w_gate, w_up, w_down):
        return (_gelu(x @ w_gate) * (x @ w_up)) @ w_down

    x = A_x
    xn = _layernorm(x, axis=-1)
    return x + _A_ref(xn, A_c_kv, A_w_q, A_w_uk, A_w_uv, A_w_o) + _B_ref(xn, B_w_gate, B_w_up, B_w_down)
```

```asm
; @launch grid=(256,1,1) block=(256,1,1) lds=163840
.amdgcn_target "amdgcn-amd-amdhsa--gfx950"
.text
.globl parallel_sum__compressed_kv_cla__geglu_ffn__prompt_kernel
.p2align 8
.type parallel_sum__compressed_kv_cla__geglu_ffn__prompt_kernel,@function
parallel_sum__compressed_kv_cla__geglu_ffn__prompt_kernel:
s_cmp_ge_u32 s2, 256
s_cbranch_scc1 parallel_sum__compressed_kv_cla__geglu_ffn__prompt_kernel_end
s_getpc_b64 s[4:5]
parallel_sum__compressed_kv_cla__geglu_ffn__prompt_kernel_pc0:
s_add_u32 s4, s4, parallel_sum__compressed_kv_cla__geglu_ffn__prompt_kernel-parallel_sum__compressed_kv_cla__geglu_ffn__prompt_kernel_pc0
s_addc_u32 s5, s5, -1
v_lshrrev_b32 v248, 2, v0
v_lshlrev_b32 v248, 7, v248
v_mov_b32 v249, s5
v_add_co_u32 v248, vcc, s4, v248
s_nop 1
v_addc_co_u32 v249, vcc, 0, v249, vcc
global_load_dword v252, v[248:249], off
s_load_dwordx4 s[72:75], s[0:1], 0
s_load_dwordx4 s[76:79], s[0:1], 16
s_load_dwordx4 s[80:83], s[0:1], 32
s_load_dwordx4 s[84:87], s[0:1], 56
s_load_dwordx4 s[88:91], s[0:1], 72
s_load_dwordx2 s[64:65], s[0:1], 88
s_load_dwordx2 s[20:21], s[0:1], 96
v_lshrrev_b32 v1, 6, v0
v_and_b32 v0, 63, v0
v_readfirstlane_b32 s28, v1
s_and_b32 s3, s2, 7
s_lshr_b32 s4, s2, 3
s_lshl_b32 s3, s3, 2
s_and_b32 s5, s4, 3
s_add_u32 s29, s3, s5
s_lshr_b32 s30, s4, 2
s_getreg_b32 s101, hwreg(HW_REG_XCC_ID)
s_waitcnt lgkmcnt(0)
s_and_b32 s101, s101, 7
s_mov_b32 s22, 268435456
s_mov_b32 s23, 0x20000
s_mov_b32 s66, 256
s_mov_b32 s67, 0x20000
s_and_b32 s3, s2, 7
s_lshr_b32 s4, s2, 3
s_and_b32 s59, s3, 3
s_lshr_b32 s3, s3, 2
s_lshl_b32 s3, s3, 3
s_lshr_b32 s5, s4, 2
s_add_u32 s60, s3, s5
s_and_b32 s61, s4, 3
s_lshl_b32 s100, s60, 2
s_add_u32 s100, s100, s61
s_mov_b32 s8, s74
s_mov_b32 s9, s75
s_mov_b32 s10, 2097152
s_mov_b32 s11, 0x20000
s_mov_b32 s12, s78
s_mov_b32 s13, s79
s_mov_b32 s14, 4194304
s_mov_b32 s15, 0x20000
s_mov_b32 s16, s80
s_mov_b32 s17, s81
s_mov_b32 s18, 4194304
s_mov_b32 s19, 0x20000
s_mov_b32 s24, s72
s_mov_b32 s25, s73
s_mov_b32 s26, 2359296
s_mov_b32 s27, 0x20000
v_lshrrev_b32 v100, 4, v0
s_and_b32 s3, s28, 1
s_lshl_b32 s3, s3, 2
v_add_u32 v101, s3, v100
v_lshlrev_b32 v101, 1, v101
v_and_b32 v102, 15, v0
v_xor_b32 v101, v101, v102
v_lshlrev_b32 v101, 4, v101
s_lshl_b32 s3, s28, 3
v_add_u32 v100, s3, v100
v_lshl_add_u32 v1, v100, 13, v101
v_lshrrev_b32 v100, 3, v0
v_lshrrev_b32 v101, 4, v0
v_and_b32 v102, 7, v0
v_add_u32 v103, 0, v101
v_xor_b32 v103, v103, v102
v_lshlrev_b32 v103, 4, v103
v_lshl_add_u32 v2, v100, 10, v103
v_add_u32 v103, 4, v101
v_xor_b32 v103, v103, v102
v_lshlrev_b32 v103, 4, v103
v_lshl_add_u32 v3, v100, 10, v103
s_lshl_b32 s32, s29, 8
s_lshl_b32 s3, s28, 11
s_add_u32 s33, s3, 98304
s_lshl_b32 s3, s30, 8
s_lshl_b32 s4, s28, 6
s_add_u32 s3, s3, s4
s_lshl_b32 s34, s3, 10
s_lshl_b32 s35, s28, 13
s_add_u32 m0, s33, 0
s_add_u32 s36, s32, 0
buffer_load_dwordx4 v1, s[12:15], s36 offen offset:0 lds
s_add_u32 s36, s32, 31744
buffer_load_dwordx4 v1, s[12:15], s36 offen offset:1024 lds
s_add_u32 m0, s33, 8192
s_add_u32 s36, s32, 0
buffer_load_dwordx4 v1, s[16:19], s36 offen offset:0 lds
s_add_u32 s36, s32, 31744
buffer_load_dwordx4 v1, s[16:19], s36 offen offset:1024 lds
s_add_u32 m0, s35, 0
s_add_u32 s37, s34, 0
buffer_load_dwordx4 v2, s[8:11], s37 offen offset:0 lds
s_add_u32 s37, s34, 7168
buffer_load_dwordx4 v3, s[8:11], s37 offen offset:1024 lds
s_add_u32 s37, s34, 14336
buffer_load_dwordx4 v2, s[8:11], s37 offen offset:2048 lds
s_add_u32 s37, s34, 21504
buffer_load_dwordx4 v3, s[8:11], s37 offen offset:3072 lds
s_add_u32 m0, s35, 4096
s_add_u32 s37, s34, 32768
buffer_load_dwordx4 v2, s[8:11], s37 offen offset:0 lds
s_add_u32 s37, s34, 39936
buffer_load_dwordx4 v3, s[8:11], s37 offen offset:1024 lds
s_add_u32 s37, s34, 47104
buffer_load_dwordx4 v2, s[8:11], s37 offen offset:2048 lds
s_add_u32 s37, s34, 54272
buffer_load_dwordx4 v3, s[8:11], s37 offen offset:3072 lds
s_lshl_b32 s3, s2, 3
s_lshl_b32 s4, s28, 1
s_add_u32 s3, s3, s4
v_lshrrev_b32 v17, 5, v0
v_add_u32 v17, s3, v17
v_and_b32 v18, 31, v0
v_mul_u32_u24 v19, 1152, v17
v_lshl_add_u32 v19, v18, 6, v19
v_mov_b32 v20, 0x10000000
v_cmp_gt_u32 vcc, 18, v18
s_nop 1
v_cndmask_b32 v19, v20, v19, vcc
buffer_load_dwordx4 v[32:35], v19, s[24:27], 0 offen offset:0
buffer_load_dwordx4 v[36:39], v19, s[24:27], 0 offen offset:16
buffer_load_dwordx4 v[40:43], v19, s[24:27], 0 offen offset:32
buffer_load_dwordx4 v[44:47], v19, s[24:27], 0 offen offset:48
v_lshrrev_b32 v21, 4, v17
v_mul_u32_u24 v21, 18432, v21
v_lshl_add_u32 v21, v18, 10, v21
v_and_b32 v22, 15, v17
v_lshl_add_u32 v21, v22, 4, v21
v_cndmask_b32 v21, v20, v21, vcc
v_cndmask_b32 v22, 0, 1.0, vcc
v_lshrrev_b32 v100, 4, v0
v_and_b32 v101, 15, v0
v_lshrrev_b32 v102, 2, v101
v_and_b32 v103, 1, v100
v_lshl_add_u32 v103, v103, 2, v102
v_lshl_add_u32 v102, v100, 3, v102
v_lshlrev_b32 v102, 8, v102
v_and_b32 v101, 3, v101
v_lshl_add_u32 v102, v101, 3, v102
s_lshr_b32 s3, s28, 1
s_lshl_b32 s3, s3, 13
s_add_u32 s3, s3, 98304
v_add_u32 v102, s3, v102
v_xor_b32 v101, 0, v103
v_lshl_add_u32 v4, v101, 5, v102
v_xor_b32 v101, 1, v103
v_lshl_add_u32 v5, v101, 5, v102
v_xor_b32 v101, 2, v103
v_lshl_add_u32 v6, v101, 5, v102
v_xor_b32 v101, 3, v103
v_lshl_add_u32 v7, v101, 5, v102
v_xor_b32 v101, 4, v103
v_lshl_add_u32 v8, v101, 5, v102
v_xor_b32 v101, 5, v103
v_lshl_add_u32 v9, v101, 5, v102
v_xor_b32 v101, 6, v103
v_lshl_add_u32 v10, v101, 5, v102
v_xor_b32 v101, 7, v103
v_lshl_add_u32 v11, v101, 5, v102
v_and_b32 v101, 15, v0
v_lshrrev_b32 v102, 1, v101
s_and_b32 s3, s28, 1
s_lshl_b32 s3, s3, 14
v_lshlrev_b32 v101, 7, v101
v_add_u32 v101, s3, v101
v_add_u32 v103, 0, v100
v_xor_b32 v103, v103, v102
v_lshl_add_u32 v12, v103, 4, v101
v_add_u32 v14, 0x10000, v12
v_add_u32 v103, 4, v100
v_xor_b32 v103, v103, v102
v_lshl_add_u32 v13, v103, 4, v101
v_add_u32 v15, 0x10000, v13
v_lshrrev_b32 v101, 1, v100
v_lshlrev_b32 v101, 10, v101
v_and_b32 v102, 1, v100
v_lshl_add_u32 v101, v102, 9, v101
v_and_b32 v102, 15, v0
v_lshl_add_u32 v31, v102, 4, v101
s_lshl_b32 s3, s29, 20
s_lshl_b32 s4, s30, 17
s_add_u32 s3, s3, s4
s_and_b32 s4, s28, 1
s_lshl_b32 s4, s4, 16
s_add_u32 s3, s3, s4
s_lshr_b32 s4, s28, 1
s_lshl_b32 s4, s4, 13
s_add_u32 s3, s3, s4
s_add_u32 s92, s3, 4194304
s_add_u32 m0, s33, 16384
s_add_u32 s36, s32, 262144
buffer_load_dwordx4 v1, s[12:15], s36 offen offset:0 lds
s_add_u32 s36, s32, 293888
buffer_load_dwordx4 v1, s[12:15], s36 offen offset:1024 lds
s_add_u32 m0, s33, 24576
s_add_u32 s36, s32, 262144
buffer_load_dwordx4 v1, s[16:19], s36 offen offset:0 lds
s_add_u32 s36, s32, 293888
buffer_load_dwordx4 v1, s[16:19], s36 offen offset:1024 lds
s_getpc_b64 s[4:5]
parallel_sum__compressed_kv_cla__geglu_ffn__prompt_kernel_pc1:
s_add_u32 s4, s4, parallel_sum__compressed_kv_cla__geglu_ffn__prompt_kernel-parallel_sum__compressed_kv_cla__geglu_ffn__prompt_kernel_pc1
s_addc_u32 s5, s5, -1
s_lshr_b32 s3, s2, 3
s_lshl_b32 s3, s3, 2
s_add_u32 s3, s3, s28
s_mul_i32 s3, s3, 8
v_add_u32 v104, s3, v0
v_lshlrev_b32 v104, 7, v104
v_mov_b32 v105, parallel_sum__compressed_kv_cla__geglu_ffn__prompt_kernel_end-parallel_sum__compressed_kv_cla__geglu_ffn__prompt_kernel
v_cmp_lt_u32 vcc, v104, v105
s_nop 1
v_cndmask_b32 v104, 0, v104, vcc
v_mov_b32 v105, s5
v_add_co_u32 v104, vcc, s4, v104
s_nop 1
v_addc_co_u32 v105, vcc, 0, v105, vcc
s_mov_b64 exec, 255
global_load_dword v30, v[104:105], off
s_mov_b64 exec, -1
s_add_u32 m0, s33, 32768
s_add_u32 s36, s32, 524288
buffer_load_dwordx4 v1, s[12:15], s36 offen offset:0 lds
s_add_u32 s36, s32, 556032
buffer_load_dwordx4 v1, s[12:15], s36 offen offset:1024 lds
s_add_u32 m0, s33, 40960
s_add_u32 s36, s32, 524288
buffer_load_dwordx4 v1, s[16:19], s36 offen offset:0 lds
s_add_u32 s36, s32, 556032
buffer_load_dwordx4 v1, s[16:19], s36 offen offset:1024 lds
s_add_u32 m0, s35, 32768
s_add_u32 s37, s34, 128
buffer_load_dwordx4 v2, s[8:11], s37 offen offset:0 lds
s_add_u32 s37, s34, 7296
buffer_load_dwordx4 v3, s[8:11], s37 offen offset:1024 lds
s_add_u32 s37, s34, 14464
buffer_load_dwordx4 v2, s[8:11], s37 offen offset:2048 lds
s_add_u32 s37, s34, 21632
buffer_load_dwordx4 v3, s[8:11], s37 offen offset:3072 lds
s_add_u32 m0, s35, 36864
s_add_u32 s37, s34, 32896
buffer_load_dwordx4 v2, s[8:11], s37 offen offset:0 lds
s_add_u32 s37, s34, 40064
buffer_load_dwordx4 v3, s[8:11], s37 offen offset:1024 lds
s_add_u32 s37, s34, 47232
buffer_load_dwordx4 v2, s[8:11], s37 offen offset:2048 lds
s_add_u32 s37, s34, 54400
buffer_load_dwordx4 v3, s[8:11], s37 offen offset:3072 lds
s_add_u32 m0, s33, 49152
s_add_u32 s36, s32, 786432
buffer_load_dwordx4 v1, s[12:15], s36 offen offset:0 lds
s_add_u32 s36, s32, 818176
buffer_load_dwordx4 v1, s[12:15], s36 offen offset:1024 lds
s_add_u32 m0, s33, 57344
s_add_u32 s36, s32, 786432
buffer_load_dwordx4 v1, s[16:19], s36 offen offset:0 lds
s_add_u32 s36, s32, 818176
buffer_load_dwordx4 v1, s[16:19], s36 offen offset:1024 lds
s_add_u32 m0, s35, 65536
s_add_u32 s37, s34, 256
buffer_load_dwordx4 v2, s[8:11], s37 offen offset:0 lds
s_add_u32 s37, s34, 7424
buffer_load_dwordx4 v3, s[8:11], s37 offen offset:1024 lds
s_add_u32 s37, s34, 14592
buffer_load_dwordx4 v2, s[8:11], s37 offen offset:2048 lds
s_add_u32 s37, s34, 21760
buffer_load_dwordx4 v3, s[8:11], s37 offen offset:3072 lds
s_add_u32 m0, s35, 69632
s_add_u32 s37, s34, 33024
buffer_load_dwordx4 v2, s[8:11], s37 offen offset:0 lds
s_add_u32 s37, s34, 40192
buffer_load_dwordx4 v3, s[8:11], s37 offen offset:1024 lds
s_add_u32 s37, s34, 47360
buffer_load_dwordx4 v2, s[8:11], s37 offen offset:2048 lds
s_add_u32 s37, s34, 54528
buffer_load_dwordx4 v3, s[8:11], s37 offen offset:3072 lds
s_waitcnt vmcnt(29)
v_lshlrev_b32 v48, 16, v32
v_and_b32 v49, 0xffff0000, v32
v_lshlrev_b32 v50, 16, v33
v_and_b32 v51, 0xffff0000, v33
v_lshlrev_b32 v52, 16, v34
v_and_b32 v53, 0xffff0000, v34
v_lshlrev_b32 v54, 16, v35
v_and_b32 v55, 0xffff0000, v35
v_lshlrev_b32 v56, 16, v36
v_and_b32 v57, 0xffff0000, v36
v_lshlrev_b32 v58, 16, v37
v_and_b32 v59, 0xffff0000, v37
v_lshlrev_b32 v60, 16, v38
v_and_b32 v61, 0xffff0000, v38
v_lshlrev_b32 v62, 16, v39
v_and_b32 v63, 0xffff0000, v39
v_lshlrev_b32 v64, 16, v40
v_and_b32 v65, 0xffff0000, v40
v_lshlrev_b32 v66, 16, v41
v_and_b32 v67, 0xffff0000, v41
v_lshlrev_b32 v68, 16, v42
v_and_b32 v69, 0xffff0000, v42
v_lshlrev_b32 v70, 16, v43
v_and_b32 v71, 0xffff0000, v43
v_lshlrev_b32 v72, 16, v44
v_and_b32 v73, 0xffff0000, v44
v_lshlrev_b32 v74, 16, v45
v_and_b32 v75, 0xffff0000, v45
v_lshlrev_b32 v76, 16, v46
v_and_b32 v77, 0xffff0000, v46
v_lshlrev_b32 v78, 16, v47
v_and_b32 v79, 0xffff0000, v47
v_add_f32 v80, v48, v49
v_add_f32 v81, v50, v51
v_add_f32 v80, v80, v52
v_add_f32 v81, v81, v53
v_add_f32 v80, v80, v54
v_add_f32 v81, v81, v55
v_add_f32 v80, v80, v56
v_add_f32 v81, v81, v57
v_add_f32 v80, v80, v58
v_add_f32 v81, v81, v59
v_add_f32 v80, v80, v60
v_add_f32 v81, v81, v61
v_add_f32 v80, v80, v62
v_add_f32 v81, v81, v63
v_add_f32 v80, v80, v64
v_add_f32 v81, v81, v65
v_add_f32 v80, v80, v66
v_add_f32 v81, v81, v67
v_add_f32 v80, v80, v68
v_add_f32 v81, v81, v69
v_add_f32 v80, v80, v70
v_add_f32 v81, v81, v71
v_add_f32 v80, v80, v72
v_add_f32 v81, v81, v73
v_add_f32 v80, v80, v74
v_add_f32 v81, v81, v75
v_add_f32 v80, v80, v76
v_add_f32 v81, v81, v77
v_add_f32 v80, v80, v78
v_add_f32 v81, v81, v79
v_add_f32 v80, v80, v81
s_nop 1
v_add_f32_dpp v80, v80, v80 quad_perm:[1,0,3,2] row_mask:0xf bank_mask:0xf
s_nop 1
v_add_f32_dpp v80, v80, v80 quad_perm:[2,3,0,1] row_mask:0xf bank_mask:0xf
s_nop 1
v_add_f32_dpp v80, v80, v80 row_half_mirror row_mask:0xf bank_mask:0xf
s_nop 1
v_add_f32_dpp v80, v80, v80 row_mirror row_mask:0xf bank_mask:0xf
v_mov_b32 v82, v80
v_mov_b32 v83, v80
s_nop 1
v_permlane16_swap_b32 v82, v83
s_nop 1
v_add_f32 v80, v82, v83
v_mul_f32 v80, 0.001736111111111111, v80
v_sub_f32 v48, v48, v80
v_sub_f32 v49, v49, v80
v_sub_f32 v50, v50, v80
v_sub_f32 v51, v51, v80
v_sub_f32 v52, v52, v80
v_sub_f32 v53, v53, v80
v_sub_f32 v54, v54, v80
v_sub_f32 v55, v55, v80
v_sub_f32 v56, v56, v80
v_sub_f32 v57, v57, v80
v_sub_f32 v58, v58, v80
v_sub_f32 v59, v59, v80
v_sub_f32 v60, v60, v80
v_sub_f32 v61, v61, v80
v_sub_f32 v62, v62, v80
v_sub_f32 v63, v63, v80
v_sub_f32 v64, v64, v80
v_sub_f32 v65, v65, v80
v_sub_f32 v66, v66, v80
v_sub_f32 v67, v67, v80
v_sub_f32 v68, v68, v80
v_sub_f32 v69, v69, v80
v_sub_f32 v70, v70, v80
v_sub_f32 v71, v71, v80
v_sub_f32 v72, v72, v80
v_sub_f32 v73, v73, v80
v_sub_f32 v74, v74, v80
v_sub_f32 v75, v75, v80
v_sub_f32 v76, v76, v80
v_sub_f32 v77, v77, v80
v_sub_f32 v78, v78, v80
v_sub_f32 v79, v79, v80
v_mul_f32 v80, v48, v48
v_mul_f32 v81, v49, v49
v_fmac_f32 v80, v50, v50
v_fmac_f32 v81, v51, v51
v_fmac_f32 v80, v52, v52
v_fmac_f32 v81, v53, v53
v_fmac_f32 v80, v54, v54
v_fmac_f32 v81, v55, v55
v_fmac_f32 v80, v56, v56
v_fmac_f32 v81, v57, v57
v_fmac_f32 v80, v58, v58
v_fmac_f32 v81, v59, v59
v_fmac_f32 v80, v60, v60
v_fmac_f32 v81, v61, v61
v_fmac_f32 v80, v62, v62
v_fmac_f32 v81, v63, v63
v_fmac_f32 v80, v64, v64
v_fmac_f32 v81, v65, v65
v_fmac_f32 v80, v66, v66
v_fmac_f32 v81, v67, v67
v_fmac_f32 v80, v68, v68
v_fmac_f32 v81, v69, v69
v_fmac_f32 v80, v70, v70
v_fmac_f32 v81, v71, v71
v_fmac_f32 v80, v72, v72
v_fmac_f32 v81, v73, v73
v_fmac_f32 v80, v74, v74
v_fmac_f32 v81, v75, v75
v_fmac_f32 v80, v76, v76
v_fmac_f32 v81, v77, v77
v_fmac_f32 v80, v78, v78
v_fmac_f32 v81, v79, v79
v_add_f32 v80, v80, v81
v_mul_f32 v80, v80, v22
s_nop 1
v_add_f32_dpp v80, v80, v80 quad_perm:[1,0,3,2] row_mask:0xf bank_mask:0xf
s_nop 1
v_add_f32_dpp v80, v80, v80 quad_perm:[2,3,0,1] row_mask:0xf bank_mask:0xf
s_nop 1
v_add_f32_dpp v80, v80, v80 row_half_mirror row_mask:0xf bank_mask:0xf
s_nop 1
v_add_f32_dpp v80, v80, v80 row_mirror row_mask:0xf bank_mask:0xf
v_mov_b32 v82, v80
v_mov_b32 v83, v80
s_nop 1
v_permlane16_swap_b32 v82, v83
s_nop 1
v_add_f32 v80, v82, v83
v_mov_b32 v81, 1e-05
v_fmac_f32 v81, 0.001736111111111111, v80
v_rsq_f32 v80, v81
s_nop 0
v_mul_f32 v48, v48, v80
v_mul_f32 v49, v49, v80
v_mul_f32 v50, v50, v80
v_mul_f32 v51, v51, v80
v_mul_f32 v52, v52, v80
v_mul_f32 v53, v53, v80
v_mul_f32 v54, v54, v80
v_mul_f32 v55, v55, v80
v_mul_f32 v56, v56, v80
v_mul_f32 v57, v57, v80
v_mul_f32 v58, v58, v80
v_mul_f32 v59, v59, v80
v_mul_f32 v60, v60, v80
v_mul_f32 v61, v61, v80
v_mul_f32 v62, v62, v80
v_mul_f32 v63, v63, v80
v_mul_f32 v64, v64, v80
v_mul_f32 v65, v65, v80
v_mul_f32 v66, v66, v80
v_mul_f32 v67, v67, v80
v_mul_f32 v68, v68, v80
v_mul_f32 v69, v69, v80
v_mul_f32 v70, v70, v80
v_mul_f32 v71, v71, v80
v_mul_f32 v72, v72, v80
v_mul_f32 v73, v73, v80
v_mul_f32 v74, v74, v80
v_mul_f32 v75, v75, v80
v_mul_f32 v76, v76, v80
v_mul_f32 v77, v77, v80
v_mul_f32 v78, v78, v80
v_mul_f32 v79, v79, v80
v_cvt_pk_bf16_f32 v32, v48, v49
v_cvt_pk_bf16_f32 v33, v50, v51
v_cvt_pk_bf16_f32 v34, v64, v65
v_cvt_pk_bf16_f32 v35, v66, v67
v_cvt_pk_bf16_f32 v36, v52, v53
v_cvt_pk_bf16_f32 v37, v54, v55
v_cvt_pk_bf16_f32 v38, v68, v69
v_cvt_pk_bf16_f32 v39, v70, v71
v_cvt_pk_bf16_f32 v40, v56, v57
v_cvt_pk_bf16_f32 v41, v58, v59
v_cvt_pk_bf16_f32 v42, v72, v73
v_cvt_pk_bf16_f32 v43, v74, v75
v_cvt_pk_bf16_f32 v44, v60, v61
v_cvt_pk_bf16_f32 v45, v62, v63
v_cvt_pk_bf16_f32 v46, v76, v77
v_cvt_pk_bf16_f32 v47, v78, v79
buffer_store_dwordx4 v[32:35], v21, s[20:23], 0 offen offset:0 sc1
buffer_store_dwordx4 v[36:39], v21, s[20:23], 0 offen offset:256 sc1
buffer_store_dwordx4 v[40:43], v21, s[20:23], 0 offen offset:512 sc1
buffer_store_dwordx4 v[44:47], v21, s[20:23], 0 offen offset:768 sc1
s_lshr_b32 s68, s2, 5
s_lshl_b32 s68, s68, 7
s_and_b32 s69, s2, 31
s_lshl_b32 s69, s69, 2
s_add_u32 s68, s68, s69
s_add_u32 s68, s68, 113246208
s_cmp_eq_u32 s28, 0
s_cselect_b32 s68, s68, 0x10000000
v_mov_b32 v23, 0
s_mov_b64 exec, 1
buffer_store_dword v23, off, s[20:23], s68 sc1
s_mov_b64 exec, -1
s_nop 1
s_lshl_b32 s68, s29, 7
s_mov_b32 s69, s30
s_lshl_b32 s69, s69, 2
s_add_u32 s68, s68, s69
s_add_u32 s68, s68, 113249280
s_cmp_eq_u32 s28, 0
s_cselect_b32 s68, s68, 0x10000000
v_mov_b32 v23, 0
s_mov_b64 exec, 1
buffer_store_dword v23, off, s[20:23], s68 sc1
s_mov_b64 exec, -1
s_nop 1
s_lshl_b32 s68, s30, 7
s_mov_b32 s69, s29
s_lshl_b32 s69, s69, 2
s_add_u32 s68, s68, s69
s_add_u32 s68, s68, 113248256
s_cmp_eq_u32 s28, 0
s_cselect_b32 s68, s68, 0x10000000
v_mov_b32 v23, 0
s_mov_b64 exec, 1
buffer_store_dword v23, off, s[20:23], s68 sc1
s_mov_b64 exec, -1
s_nop 1
s_lshl_b32 s68, s100, 7
s_mov_b32 s69, s59
s_lshl_b32 s69, s69, 2
s_add_u32 s68, s68, s69
s_add_u32 s68, s68, 113254400
s_cmp_eq_u32 s28, 0
s_cselect_b32 s68, s68, 0x10000000
v_mov_b32 v23, 0
s_mov_b64 exec, 1
buffer_store_dword v23, off, s[20:23], s68 sc1
s_mov_b64 exec, -1
s_nop 1
s_cmp_lt_u32 s2, 8
s_cselect_b32 s70, 1, 0
s_cmp_eq_u32 s28, 0
s_cselect_b32 s70, s70, 0
s_lshl_b32 s68, s2, 7
s_add_u32 s68, s68, 113263616
s_cmp_eq_u32 s70, 1
s_cselect_b32 s68, s68, 0x10000000
v_mov_b32 v23, 0
s_mov_b64 exec, 1
buffer_store_dword v23, off, s[20:23], s68 sc1
s_mov_b64 exec, -1
s_nop 1
s_lshl_b32 s68, s2, 2
s_add_u32 s68, s68, 113264768
s_cmp_eq_u32 s70, 1
s_cselect_b32 s68, s68, 0x10000000
v_mov_b32 v23, 0
s_mov_b64 exec, 1
buffer_store_dword v23, off, s[20:23], s68 sc1
s_mov_b64 exec, -1
s_nop 1
s_barrier
ds_read_b64_tr_b16 a[64:65], v4 offset:0
ds_read_b64_tr_b16 a[66:67], v4 offset:1024
ds_read_b128 a[0:3], v12 offset:0
ds_read_b64_tr_b16 a[68:69], v5 offset:0
ds_read_b64_tr_b16 a[70:71], v5 offset:1024
ds_read_b128 a[4:7], v12 offset:2048
ds_read_b64_tr_b16 a[72:73], v6 offset:0
ds_read_b64_tr_b16 a[74:75], v6 offset:1024
ds_read_b128 a[8:11], v12 offset:4096
ds_read_b64_tr_b16 a[76:77], v7 offset:0
ds_read_b64_tr_b16 a[78:79], v7 offset:1024
ds_read_b128 a[12:15], v12 offset:6144
ds_read_b64_tr_b16 a[80:81], v8 offset:0
ds_read_b64_tr_b16 a[82:83], v8 offset:1024
ds_read_b128 a[16:19], v12 offset:8192
ds_read_b64_tr_b16 a[84:85], v9 offset:0
ds_read_b64_tr_b16 a[86:87], v9 offset:1024
ds_read_b128 a[20:23], v12 offset:10240
ds_read_b64_tr_b16 a[88:89], v10 offset:0
ds_read_b64_tr_b16 a[90:91], v10 offset:1024
ds_read_b128 a[24:27], v12 offset:12288
ds_read_b64_tr_b16 a[92:93], v11 offset:0
ds_read_b64_tr_b16 a[94:95], v11 offset:1024
ds_read_b128 a[28:31], v12 offset:14336
s_cmp_ge_u32 s28, 2
s_cbranch_scc1 parallel_sum__compressed_kv_cla__geglu_ffn__prompt_kernel_v
s_waitcnt lgkmcnt(0)
s_waitcnt vmcnt(35)
v_mfma_f32_16x16x32_bf16 v[32:35], a[64:67], a[0:3], 0
s_barrier
v_mfma_f32_16x16x32_bf16 v[36:39], a[64:67], a[4:7], 0
ds_read_b64_tr_b16 a[96:97], v4 offset:16384
v_mfma_f32_16x16x32_bf16 v[64:67], a[64:67], a[8:11], 0
s_add_u32 m0, s33, 0
v_mfma_f32_16x16x32_bf16 v[68:71], a[64:67], a[12:15], 0
ds_read_b64_tr_b16 a[98:99], v4 offset:17408
v_mfma_f32_16x16x32_bf16 v[96:99], a[64:67], a[16:19], 0
v_mfma_f32_16x16x32_bf16 v[100:103], a[64:67], a[20:23], 0
ds_read_b128 a[32:35], v13 offset:0
v_mfma_f32_16x16x32_bf16 v[128:131], a[64:67], a[24:27], 0
v_mfma_f32_16x16x32_bf16 v[132:135], a[64:67], a[28:31], 0
ds_read_b64_tr_b16 a[100:101], v5 offset:16384
v_mfma_f32_16x16x32_bf16 v[160:163], a[68:71], a[0:3], 0
s_add_u32 s36, s32, 1048576
v_mfma_f32_16x16x32_bf16 v[164:167], a[68:71], a[4:7], 0
ds_read_b64_tr_b16 a[102:103], v5 offset:17408
v_mfma_f32_16x16x32_bf16 v[168:171], a[68:71], a[8:11], 0
v_mfma_f32_16x16x32_bf16 v[172:175], a[68:71], a[12:15], 0
ds_read_b128 a[36:39], v13 offset:2048
v_mfma_f32_16x16x32_bf16 v[176:179], a[68:71], a[16:19], 0
v_mfma_f32_16x16x32_bf16 v[180:183], a[68:71], a[20:23], 0
ds_read_b64_tr_b16 a[104:105], v6 offset:16384
v_mfma_f32_16x16x32_bf16 v[184:187], a[68:71], a[24:27], 0
v_mfma_f32_16x16x32_bf16 v[188:191], a[68:71], a[28:31], 0
ds_read_b64_tr_b16 a[106:107], v6 offset:17408
v_mfma_f32_16x16x32_bf16 v[40:43], a[72:75], a[0:3], 0
buffer_load_dwordx4 v1, s[12:15], s36 offen offset:0 lds
v_mfma_f32_16x16x32_bf16 v[44:47], a[72:75], a[4:7], 0
ds_read_b128 a[40:43], v13 offset:4096
v_mfma_f32_16x16x32_bf16 v[72:75], a[72:75], a[8:11], 0
v_mfma_f32_16x16x32_bf16 v[76:79], a[72:75], a[12:15], 0
ds_read_b64_tr_b16 a[108:109], v7 offset:16384
v_mfma_f32_16x16x32_bf16 v[104:107], a[72:75], a[16:19], 0
v_mfma_f32_16x16x32_bf16 v[108:111], a[72:75], a[20:23], 0
ds_read_b64_tr_b16 a[110:111], v7 offset:17408
v_mfma_f32_16x16x32_bf16 v[136:139], a[72:75], a[24:27], 0
v_mfma_f32_16x16x32_bf16 v[140:143], a[72:75], a[28:31], 0
ds_read_b128 a[44:47], v13 offset:6144
v_mfma_f32_16x16x32_bf16 v[192:195], a[76:79], a[0:3], 0
s_add_u32 s36, s32, 1080320
v_mfma_f32_16x16x32_bf16 v[196:199], a[76:79], a[4:7], 0
ds_read_b64_tr_b16 a[112:113], v8 offset:16384
v_mfma_f32_16x16x32_bf16 v[200:203], a[76:79], a[8:11], 0
v_mfma_f32_16x16x32_bf16 v[204:207], a[76:79], a[12:15], 0
ds_read_b64_tr_b16 a[114:115], v8 offset:17408
v_mfma_f32_16x16x32_bf16 v[208:211], a[76:79], a[16:19], 0
v_mfma_f32_16x16x32_bf16 v[212:215], a[76:79], a[20:23], 0
ds_read_b128 a[48:51], v13 offset:8192
v_mfma_f32_16x16x32_bf16 v[216:219], a[76:79], a[24:27], 0
v_mfma_f32_16x16x32_bf16 v[220:223], a[76:79], a[28:31], 0
ds_read_b64_tr_b16 a[116:117], v9 offset:16384
v_mfma_f32_16x16x32_bf16 v[48:51], a[80:83], a[0:3], 0
buffer_load_dwordx4 v1, s[12:15], s36 offen offset:1024 lds
v_mfma_f32_16x16x32_bf16 v[52:55], a[80:83], a[4:7], 0
ds_read_b64_tr_b16 a[118:119], v9 offset:17408
v_mfma_f32_16x16x32_bf16 v[80:83], a[80:83], a[8:11], 0
v_mfma_f32_16x16x32_bf16 v[84:87], a[80:83], a[12:15], 0
ds_read_b128 a[52:55], v13 offset:10240
v_mfma_f32_16x16x32_bf16 v[112:115], a[80:83], a[16:19], 0
v_mfma_f32_16x16x32_bf16 v[116:119], a[80:83], a[20:23], 0
ds_read_b64_tr_b16 a[120:121], v10 offset:16384
v_mfma_f32_16x16x32_bf16 v[144:147], a[80:83], a[24:27], 0
v_mfma_f32_16x16x32_bf16 v[148:151], a[80:83], a[28:31], 0
ds_read_b64_tr_b16 a[122:123], v10 offset:17408
v_mfma_f32_16x16x32_bf16 v[224:227], a[84:87], a[0:3], 0
s_add_u32 m0, s33, 8192
v_mfma_f32_16x16x32_bf16 v[228:231], a[84:87], a[4:7], 0
ds_read_b128 a[56:59], v13 offset:12288
v_mfma_f32_16x16x32_bf16 v[232:235], a[84:87], a[8:11], 0
v_mfma_f32_16x16x32_bf16 v[236:239], a[84:87], a[12:15], 0
ds_read_b64_tr_b16 a[124:125], v11 offset:16384
v_mfma_f32_16x16x32_bf16 v[240:243], a[84:87], a[16:19], 0
v_mfma_f32_16x16x32_bf16 v[244:247], a[84:87], a[20:23], 0
ds_read_b64_tr_b16 a[126:127], v11 offset:17408
v_mfma_f32_16x16x32_bf16 v[248:251], a[84:87], a[24:27], 0
v_mfma_f32_16x16x32_bf16 v[252:255], a[84:87], a[28:31], 0
ds_read_b128 a[60:63], v13 offset:14336
v_mfma_f32_16x16x32_bf16 v[56:59], a[88:91], a[0:3], 0
s_add_u32 s36, s32, 1048576
v_mfma_f32_16x16x32_bf16 v[60:63], a[88:91], a[4:7], 0
v_mfma_f32_16x16x32_bf16 v[88:91], a[88:91], a[8:11], 0
v_mfma_f32_16x16x32_bf16 v[92:95], a[88:91], a[12:15], 0
v_mfma_f32_16x16x32_bf16 v[120:123], a[88:91], a[16:19], 0
buffer_load_dwordx4 v1, s[16:19], s36 offen offset:0 lds
v_mfma_f32_16x16x32_bf16 v[124:127], a[88:91], a[20:23], 0
v_mfma_f32_16x16x32_bf16 v[152:155], a[88:91], a[24:27], 0
v_mfma_f32_16x16x32_bf16 v[156:159], a[88:91], a[28:31], 0
v_mfma_f32_16x16x32_bf16 a[128:131], a[92:95], a[0:3], 0
s_add_u32 s36, s32, 1080320
v_mfma_f32_16x16x32_bf16 a[132:135], a[92:95], a[4:7], 0
v_mfma_f32_16x16x32_bf16 a[136:139], a[92:95], a[8:11], 0
v_mfma_f32_16x16x32_bf16 a[140:143], a[92:95], a[12:15], 0
v_mfma_f32_16x16x32_bf16 a[144:147], a[92:95], a[16:19], 0
buffer_load_dwordx4 v1, s[16:19], s36 offen offset:1024 lds
v_mfma_f32_16x16x32_bf16 a[148:151], a[92:95], a[20:23], 0
v_mfma_f32_16x16x32_bf16 a[152:155], a[92:95], a[24:27], 0
v_mfma_f32_16x16x32_bf16 a[156:159], a[92:95], a[28:31], 0
s_waitcnt lgkmcnt(0)
s_waitcnt vmcnt(26)
v_mfma_f32_16x16x32_bf16 v[32:35], a[96:99], a[32:35], v[32:35]
s_barrier
v_mfma_f32_16x16x32_bf16 v[36:39], a[96:99], a[36:39], v[36:39]
ds_read_b64_tr_b16 a[64:65], v4 offset:32768
v_mfma_f32_16x16x32_bf16 v[64:67], a[96:99], a[40:43], v[64:67]
s_add_u32 m0, s33, 16384
v_mfma_f32_16x16x32_bf16 v[68:71], a[96:99], a[44:47], v[68:71]
ds_read_b64_tr_b16 a[66:67], v4 offset:33792
v_mfma_f32_16x16x32_bf16 v[96:99], a[96:99], a[48:51], v[96:99]
v_mfma_f32_16x16x32_bf16 v[100:103], a[96:99], a[52:55], v[100:103]
ds_read_b128 a[0:3], v12 offset:32768
v_mfma_f32_16x16x32_bf16 v[128:131], a[96:99], a[56:59], v[128:131]
s_add_u32 s36, s32, 1310720
v_mfma_f32_16x16x32_bf16 v[132:135], a[96:99], a[60:63], v[132:135]
ds_read_b64_tr_b16 a[68:69], v5 offset:32768
v_mfma_f32_16x16x32_bf16 v[160:163], a[100:103], a[32:35], v[160:163]
v_mfma_f32_16x16x32_bf16 v[164:167], a[100:103], a[36:39], v[164:167]
ds_read_b64_tr_b16 a[70:71], v5 offset:33792
v_mfma_f32_16x16x32_bf16 v[168:171], a[100:103], a[40:43], v[168:171]
buffer_load_dwordx4 v1, s[12:15], s36 offen offset:0 lds
v_mfma_f32_16x16x32_bf16 v[172:175], a[100:103], a[44:47], v[172:175]
ds_read_b128 a[4:7], v12 offset:34816
v_mfma_f32_16x16x32_bf16 v[176:179], a[100:103], a[48:51], v[176:179]
v_mfma_f32_16x16x32_bf16 v[180:183], a[100:103], a[52:55], v[180:183]
ds_read_b64_tr_b16 a[72:73], v6 offset:32768
v_mfma_f32_16x16x32_bf16 v[184:187], a[100:103], a[56:59], v[184:187]
s_add_u32 s36, s32, 1342464
v_mfma_f32_16x16x32_bf16 v[188:191], a[100:103], a[60:63], v[188:191]
ds_read_b64_tr_b16 a[74:75], v6 offset:33792
v_mfma_f32_16x16x32_bf16 v[40:43], a[104:107], a[32:35], v[40:43]
v_mfma_f32_16x16x32_bf16 v[44:47], a[104:107], a[36:39], v[44:47]
ds_read_b128 a[8:11], v12 offset:36864
v_mfma_f32_16x16x32_bf16 v[72:75], a[104:107], a[40:43], v[72:75]
buffer_load_dwordx4 v1, s[12:15], s36 offen offset:1024 lds
v_mfma_f32_16x16x32_bf16 v[76:79], a[104:107], a[44:47], v[76:79]
ds_read_b64_tr_b16 a[76:77], v7 offset:32768
v_mfma_f32_16x16x32_bf16 v[104:107], a[104:107], a[48:51], v[104:107]
v_mfma_f32_16x16x32_bf16 v[108:111], a[104:107], a[52:55], v[108:111]
ds_read_b64_tr_b16 a[78:79], v7 offset:33792
v_mfma_f32_16x16x32_bf16 v[136:139], a[104:107], a[56:59], v[136:139]
s_add_u32 m0, s33, 24576
v_mfma_f32_16x16x32_bf16 v[140:143], a[104:107], a[60:63], v[140:143]
ds_read_b128 a[12:15], v12 offset:38912
v_mfma_f32_16x16x32_bf16 v[192:195], a[108:111], a[32:35], v[192:195]
v_mfma_f32_16x16x32_bf16 v[196:199], a[108:111], a[36:39], v[196:199]
ds_read_b64_tr_b16 a[80:81], v8 offset:32768
v_mfma_f32_16x16x32_bf16 v[200:203], a[108:111], a[40:43], v[200:203]
s_add_u32 s36, s32, 1310720
v_mfma_f32_16x16x32_bf16 v[204:207], a[108:111], a[44:47], v[204:207]
ds_read_b64_tr_b16 a[82:83], v8 offset:33792
v_mfma_f32_16x16x32_bf16 v[208:211], a[108:111], a[48:51], v[208:211]
v_mfma_f32_16x16x32_bf16 v[212:215], a[108:111], a[52:55], v[212:215]
ds_read_b128 a[16:19], v12 offset:40960
v_mfma_f32_16x16x32_bf16 v[216:219], a[108:111], a[56:59], v[216:219]
buffer_load_dwordx4 v1, s[16:19], s36 offen offset:0 lds
v_mfma_f32_16x16x32_bf16 v[220:223], a[108:111], a[60:63], v[220:223]
ds_read_b64_tr_b16 a[84:85], v9 offset:32768
v_mfma_f32_16x16x32_bf16 v[48:51], a[112:115], a[32:35], v[48:51]
v_mfma_f32_16x16x32_bf16 v[52:55], a[112:115], a[36:39], v[52:55]
ds_read_b64_tr_b16 a[86:87], v9 offset:33792
v_mfma_f32_16x16x32_bf16 v[80:83], a[112:115], a[40:43], v[80:83]
s_add_u32 s36, s32, 1342464
v_mfma_f32_16x16x32_bf16 v[84:87], a[112:115], a[44:47], v[84:87]
ds_read_b128 a[20:23], v12 offset:43008
v_mfma_f32_16x16x32_bf16 v[112:115], a[112:115], a[48:51], v[112:115]
v_mfma_f32_16x16x32_bf16 v[116:119], a[112:115], a[52:55], v[116:119]
ds_read_b64_tr_b16 a[88:89], v10 offset:32768
v_mfma_f32_16x16x32_bf16 v[144:147], a[112:115], a[56:59], v[144:147]
buffer_load_dwordx4 v1, s[16:19], s36 offen offset:1024 lds
v_mfma_f32_16x16x32_bf16 v[148:151], a[112:115], a[60:63], v[148:151]
ds_read_b64_tr_b16 a[90:91], v10 offset:33792
v_mfma_f32_16x16x32_bf16 v[224:227], a[116:119], a[32:35], v[224:227]
v_mfma_f32_16x16x32_bf16 v[228:231], a[116:119], a[36:39], v[228:231]
ds_read_b128 a[24:27], v12 offset:45056
v_mfma_f32_16x16x32_bf16 v[232:235], a[116:119], a[40:43], v[232:235]
s_add_u32 m0, s35, 0
v_mfma_f32_16x16x32_bf16 v[236:239], a[116:119], a[44:47], v[236:239]
ds_read_b64_tr_b16 a[92:93], v11 offset:32768
v_mfma_f32_16x16x32_bf16 v[240:243], a[116:119], a[48:51], v[240:243]
v_mfma_f32_16x16x32_bf16 v[244:247], a[116:119], a[52:55], v[244:247]
ds_read_b64_tr_b16 a[94:95], v11 offset:33792
v_mfma_f32_16x16x32_bf16 v[248:251], a[116:119], a[56:59], v[248:251]
s_add_u32 s37, s34, 384
v_mfma_f32_16x16x32_bf16 v[252:255], a[116:119], a[60:63], v[252:255]
ds_read_b128 a[28:31], v12 offset:47104
v_mfma_f32_16x16x32_bf16 v[56:59], a[120:123], a[32:35], v[56:59]
v_mfma_f32_16x16x32_bf16 v[60:63], a[120:123], a[36:39], v[60:63]
buffer_load_dwordx4 v2, s[8:11], s37 offen offset:0 lds
v_mfma_f32_16x16x32_bf16 v[88:91], a[120:123], a[40:43], v[88:91]
v_mfma_f32_16x16x32_bf16 v[92:95], a[120:123], a[44:47], v[92:95]
s_add_u32 s37, s34, 7552
v_mfma_f32_16x16x32_bf16 v[120:123], a[120:123], a[48:51], v[120:123]
v_mfma_f32_16x16x32_bf16 v[124:127], a[120:123], a[52:55], v[124:127]
buffer_load_dwordx4 v3, s[8:11], s37 offen offset:1024 lds
v_mfma_f32_16x16x32_bf16 v[152:155], a[120:123], a[56:59], v[152:155]
v_mfma_f32_16x16x32_bf16 v[156:159], a[120:123], a[60:63], v[156:159]
s_add_u32 s37, s34, 14720
v_mfma_f32_16x16x32_bf16 a[128:131], a[124:127], a[32:35], a[128:131]
v_mfma_f32_16x16x32_bf16 a[132:135], a[124:127], a[36:39], a[132:135]
buffer_load_dwordx4 v2, s[8:11], s37 offen offset:2048 lds
v_mfma_f32_16x16x32_bf16 a[136:139], a[124:127], a[40:43], a[136:139]
v_mfma_f32_16x16x32_bf16 a[140:143], a[124:127], a[44:47], a[140:143]
s_add_u32 s37, s34, 21888
v_mfma_f32_16x16x32_bf16 a[144:147], a[124:127], a[48:51], a[144:147]
v_mfma_f32_16x16x32_bf16 a[148:151], a[124:127], a[52:55], a[148:151]
buffer_load_dwordx4 v3, s[8:11], s37 offen offset:3072 lds
v_mfma_f32_16x16x32_bf16 a[152:155], a[124:127], a[56:59], a[152:155]
v_mfma_f32_16x16x32_bf16 a[156:159], a[124:127], a[60:63], a[156:159]
s_waitcnt lgkmcnt(0)
s_waitcnt vmcnt(30)
v_mfma_f32_16x16x32_bf16 v[32:35], a[64:67], a[0:3], v[32:35]
s_barrier
v_mfma_f32_16x16x32_bf16 v[36:39], a[64:67], a[4:7], v[36:39]
ds_read_b64_tr_b16 a[96:97], v4 offset:49152
v_mfma_f32_16x16x32_bf16 v[64:67], a[64:67], a[8:11], v[64:67]
s_add_u32 m0, s33, 32768
v_mfma_f32_16x16x32_bf16 v[68:71], a[64:67], a[12:15], v[68:71]
ds_read_b64_tr_b16 a[98:99], v4 offset:50176
v_mfma_f32_16x16x32_bf16 v[96:99], a[64:67], a[16:19], v[96:99]
v_mfma_f32_16x16x32_bf16 v[100:103], a[64:67], a[20:23], v[100:103]
ds_read_b128 a[32:35], v13 offset:32768
v_mfma_f32_16x16x32_bf16 v[128:131], a[64:67], a[24:27], v[128:131]
s_add_u32 s36, s32, 1572864
v_mfma_f32_16x16x32_bf16 v[132:135], a[64:67], a[28:31], v[132:135]
ds_read_b64_tr_b16 a[100:101], v5 offset:49152
v_mfma_f32_16x16x32_bf16 v[160:163], a[68:71], a[0:3], v[160:163]
v_mfma_f32_16x16x32_bf16 v[164:167], a[68:71], a[4:7], v[164:167]
ds_read_b64_tr_b16 a[102:103], v5 offset:50176
v_mfma_f32_16x16x32_bf16 v[168:171], a[68:71], a[8:11], v[168:171]
buffer_load_dwordx4 v1, s[12:15], s36 offen offset:0 lds
v_mfma_f32_16x16x32_bf16 v[172:175], a[68:71], a[12:15], v[172:175]
ds_read_b128 a[36:39], v13 offset:34816
v_mfma_f32_16x16x32_bf16 v[176:179], a[68:71], a[16:19], v[176:179]
v_mfma_f32_16x16x32_bf16 v[180:183], a[68:71], a[20:23], v[180:183]
ds_read_b64_tr_b16 a[104:105], v6 offset:49152
v_mfma_f32_16x16x32_bf16 v[184:187], a[68:71], a[24:27], v[184:187]
s_add_u32 s36, s32, 1604608
v_mfma_f32_16x16x32_bf16 v[188:191], a[68:71], a[28:31], v[188:191]
ds_read_b64_tr_b16 a[106:107], v6 offset:50176
v_mfma_f32_16x16x32_bf16 v[40:43], a[72:75], a[0:3], v[40:43]
v_mfma_f32_16x16x32_bf16 v[44:47], a[72:75], a[4:7], v[44:47]
ds_read_b128 a[40:43], v13 offset:36864
v_mfma_f32_16x16x32_bf16 v[72:75], a[72:75], a[8:11], v[72:75]
buffer_load_dwordx4 v1, s[12:15], s36 offen offset:1024 lds
v_mfma_f32_16x16x32_bf16 v[76:79], a[72:75], a[12:15], v[76:79]
ds_read_b64_tr_b16 a[108:109], v7 offset:49152
v_mfma_f32_16x16x32_bf16 v[104:107], a[72:75], a[16:19], v[104:107]
v_mfma_f32_16x16x32_bf16 v[108:111], a[72:75], a[20:23], v[108:111]
ds_read_b64_tr_b16 a[110:111], v7 offset:50176
v_mfma_f32_16x16x32_bf16 v[136:139], a[72:75], a[24:27], v[136:139]
s_add_u32 m0, s33, 40960
v_mfma_f32_16x16x32_bf16 v[140:143], a[72:75], a[28:31], v[140:143]
ds_read_b128 a[44:47], v13 offset:38912
v_mfma_f32_16x16x32_bf16 v[192:195], a[76:79], a[0:3], v[192:195]
v_mfma_f32_16x16x32_bf16 v[196:199], a[76:79], a[4:7], v[196:199]
ds_read_b64_tr_b16 a[112:113], v8 offset:49152
v_mfma_f32_16x16x32_bf16 v[200:203], a[76:79], a[8:11], v[200:203]
s_add_u32 s36, s32, 1572864
v_mfma_f32_16x16x32_bf16 v[204:207], a[76:79], a[12:15], v[204:207]
ds_read_b64_tr_b16 a[114:115], v8 offset:50176
v_mfma_f32_16x16x32_bf16 v[208:211], a[76:79], a[16:19], v[208:211]
v_mfma_f32_16x16x32_bf16 v[212:215], a[76:79], a[20:23], v[212:215]
ds_read_b128 a[48:51], v13 offset:40960
v_mfma_f32_16x16x32_bf16 v[216:219], a[76:79], a[24:27], v[216:219]
buffer_load_dwordx4 v1, s[16:19], s36 offen offset:0 lds
v_mfma_f32_16x16x32_bf16 v[220:223], a[76:79], a[28:31], v[220:223]
ds_read_b64_tr_b16 a[116:117], v9 offset:49152
v_mfma_f32_16x16x32_bf16 v[48:51], a[80:83], a[0:3], v[48:51]
v_mfma_f32_16x16x32_bf16 v[52:55], a[80:83], a[4:7], v[52:55]
ds_read_b64_tr_b16 a[118:119], v9 offset:50176
v_mfma_f32_16x16x32_bf16 v[80:83], a[80:83], a[8:11], v[80:83]
s_add_u32 s36, s32, 1604608
v_mfma_f32_16x16x32_bf16 v[84:87], a[80:83], a[12:15], v[84:87]
ds_read_b128 a[52:55], v13 offset:43008
v_mfma_f32_16x16x32_bf16 v[112:115], a[80:83], a[16:19], v[112:115]
v_mfma_f32_16x16x32_bf16 v[116:119], a[80:83], a[20:23], v[116:119]
ds_read_b64_tr_b16 a[120:121], v10 offset:49152
v_mfma_f32_16x16x32_bf16 v[144:147], a[80:83], a[24:27], v[144:147]
buffer_load_dwordx4 v1, s[16:19], s36 offen offset:1024 lds
v_mfma_f32_16x16x32_bf16 v[148:151], a[80:83], a[28:31], v[148:151]
ds_read_b64_tr_b16 a[122:123], v10 offset:50176
v_mfma_f32_16x16x32_bf16 v[224:227], a[84:87], a[0:3], v[224:227]
v_mfma_f32_16x16x32_bf16 v[228:231], a[84:87], a[4:7], v[228:231]
ds_read_b128 a[56:59], v13 offset:45056
v_mfma_f32_16x16x32_bf16 v[232:235], a[84:87], a[8:11], v[232:235]
s_add_u32 m0, s35, 4096
v_mfma_f32_16x16x32_bf16 v[236:239], a[84:87], a[12:15], v[236:239]
ds_read_b64_tr_b16 a[124:125], v11 offset:49152
v_mfma_f32_16x16x32_bf16 v[240:243], a[84:87], a[16:19], v[240:243]
v_mfma_f32_16x16x32_bf16 v[244:247], a[84:87], a[20:23], v[244:247]
ds_read_b64_tr_b16 a[126:127], v11 offset:50176
v_mfma_f32_16x16x32_bf16 v[248:251], a[84:87], a[24:27], v[248:251]
s_add_u32 s37, s34, 33152
v_mfma_f32_16x16x32_bf16 v[252:255], a[84:87], a[28:31], v[252:255]
ds_read_b128 a[60:63], v13 offset:47104
v_mfma_f32_16x16x32_bf16 v[56:59], a[88:91], a[0:3], v[56:59]
v_mfma_f32_16x16x32_bf16 v[60:63], a[88:91], a[4:7], v[60:63]
buffer_load_dwordx4 v2, s[8:11], s37 offen offset:0 lds
v_mfma_f32_16x16x32_bf16 v[88:91], a[88:91], a[8:11], v[88:91]
v_mfma_f32_16x16x32_bf16 v[92:95], a[88:91], a[12:15], v[92:95]
s_add_u32 s37, s34, 40320
v_mfma_f32_16x16x32_bf16 v[120:123], a[88:91], a[16:19], v[120:123]
v_mfma_f32_16x16x32_bf16 v[124:127], a[88:91], a[20:23], v[124:127]
buffer_load_dwordx4 v3, s[8:11], s37 offen offset:1024 lds
v_mfma_f32_16x16x32_bf16 v[152:155], a[88:91], a[24:27], v[152:155]
v_mfma_f32_16x16x32_bf16 v[156:159], a[88:91], a[28:31], v[156:159]
s_add_u32 s37, s34, 47488
v_mfma_f32_16x16x32_bf16 a[128:131], a[92:95], a[0:3], a[128:131]
v_mfma_f32_16x16x32_bf16 a[132:135], a[92:95], a[4:7], a[132:135]
buffer_load_dwordx4 v2, s[8:11], s37 offen offset:2048 lds
v_mfma_f32_16x16x32_bf16 a[136:139], a[92:95], a[8:11], a[136:139]
v_mfma_f32_16x16x32_bf16 a[140:143], a[92:95], a[12:15], a[140:143]
s_add_u32 s37, s34, 54656
v_mfma_f32_16x16x32_bf16 a[144:147], a[92:95], a[16:19], a[144:147]
v_mfma_f32_16x16x32_bf16 a[148:151], a[92:95], a[20:23], a[148:151]
buffer_load_dwordx4 v3, s[8:11], s37 offen offset:3072 lds
v_mfma_f32_16x16x32_bf16 a[152:155], a[92:95], a[24:27], a[152:155]
v_mfma_f32_16x16x32_bf16 a[156:159], a[92:95], a[28:31], a[156:159]
s_waitcnt lgkmcnt(0)
s_waitcnt vmcnt(16)
v_mfma_f32_16x16x32_bf16 v[32:35], a[96:99], a[32:35], v[32:35]
s_barrier
v_mfma_f32_16x16x32_bf16 v[36:39], a[96:99], a[36:39], v[36:39]
ds_read_b64_tr_b16 a[64:65], v4 offset:0
v_mfma_f32_16x16x32_bf16 v[64:67], a[96:99], a[40:43], v[64:67]
s_add_u32 m0, s33, 49152
v_mfma_f32_16x16x32_bf16 v[68:71], a[96:99], a[44:47], v[68:71]
ds_read_b64_tr_b16 a[66:67], v4 offset:1024
v_mfma_f32_16x16x32_bf16 v[96:99], a[96:99], a[48:51], v[96:99]
s_add_u32 s36, s32, 1835008
v_mfma_f32_16x16x32_bf16 v[100:103], a[96:99], a[52:55], v[100:103]
ds_read_b128 a[0:3], v14 offset:0
v_mfma_f32_16x16x32_bf16 v[128:131], a[96:99], a[56:59], v[128:131]
buffer_load_dwordx4 v1, s[12:15], s36 offen offset:0 lds
v_mfma_f32_16x16x32_bf16 v[132:135], a[96:99], a[60:63], v[132:135]
ds_read_b64_tr_b16 a[68:69], v5 offset:0
v_mfma_f32_16x16x32_bf16 v[160:163], a[100:103], a[32:35], v[160:163]
s_add_u32 s36, s32, 1866752
v_mfma_f32_16x16x32_bf16 v[164:167], a[100:103], a[36:39], v[164:167]
ds_read_b64_tr_b16 a[70:71], v5 offset:1024
v_mfma_f32_16x16x32_bf16 v[168:171], a[100:103], a[40:43], v[168:171]
buffer_load_dwordx4 v1, s[12:15], s36 offen offset:1024 lds
v_mfma_f32_16x16x32_bf16 v[172:175], a[100:103], a[44:47], v[172:175]
ds_read_b128 a[4:7], v14 offset:2048
v_mfma_f32_16x16x32_bf16 v[176:179], a[100:103], a[48:51], v[176:179]
s_add_u32 m0, s33, 57344
v_mfma_f32_16x16x32_bf16 v[180:183], a[100:103], a[52:55], v[180:183]
ds_read_b64_tr_b16 a[72:73], v6 offset:0
v_mfma_f32_16x16x32_bf16 v[184:187], a[100:103], a[56:59], v[184:187]
s_add_u32 s36, s32, 1835008
v_mfma_f32_16x16x32_bf16 v[188:191], a[100:103], a[60:63], v[188:191]
ds_read_b64_tr_b16 a[74:75], v6 offset:1024
v_mfma_f32_16x16x32_bf16 v[40:43], a[104:107], a[32:35], v[40:43]
buffer_load_dwordx4 v1, s[16:19], s36 offen offset:0 lds
v_mfma_f32_16x16x32_bf16 v[44:47], a[104:107], a[36:39], v[44:47]
ds_read_b128 a[8:11], v14 offset:4096
v_mfma_f32_16x16x32_bf16 v[72:75], a[104:107], a[40:43], v[72:75]
s_add_u32 s36, s32, 1866752
v_mfma_f32_16x16x32_bf16 v[76:79], a[104:107], a[44:47], v[76:79]
ds_read_b64_tr_b16 a[76:77], v7 offset:0
v_mfma_f32_16x16x32_bf16 v[104:107], a[104:107], a[48:51], v[104:107]
buffer_load_dwordx4 v1, s[16:19], s36 offen offset:1024 lds
v_mfma_f32_16x16x32_bf16 v[108:111], a[104:107], a[52:55], v[108:111]
ds_read_b64_tr_b16 a[78:79], v7 offset:1024
v_mfma_f32_16x16x32_bf16 v[136:139], a[104:107], a[56:59], v[136:139]
s_add_u32 m0, s35, 32768
v_mfma_f32_16x16x32_bf16 v[140:143], a[104:107], a[60:63], v[140:143]
ds_read_b128 a[12:15], v14 offset:6144
v_mfma_f32_16x16x32_bf16 v[192:195], a[108:111], a[32:35], v[192:195]
s_add_u32 s37, s34, 512
v_mfma_f32_16x16x32_bf16 v[196:199], a[108:111], a[36:39], v[196:199]
ds_read_b64_tr_b16 a[80:81], v8 offset:0
v_mfma_f32_16x16x32_bf16 v[200:203], a[108:111], a[40:43], v[200:203]
buffer_load_dwordx4 v2, s[8:11], s37 offen offset:0 lds
v_mfma_f32_16x16x32_bf16 v[204:207], a[108:111], a[44:47], v[204:207]
ds_read_b64_tr_b16 a[82:83], v8 offset:1024
v_mfma_f32_16x16x32_bf16 v[208:211], a[108:111], a[48:51], v[208:211]
s_add_u32 s37, s34, 7680
v_mfma_f32_16x16x32_bf16 v[212:215], a[108:111], a[52:55], v[212:215]
ds_read_b128 a[16:19], v14 offset:8192
v_mfma_f32_16x16x32_bf16 v[216:219], a[108:111], a[56:59], v[216:219]
buffer_load_dwordx4 v3, s[8:11], s37 offen offset:1024 lds
v_mfma_f32_16x16x32_bf16 v[220:223], a[108:111], a[60:63], v[220:223]
ds_read_b64_tr_b16 a[84:85], v9 offset:0
v_mfma_f32_16x16x32_bf16 v[48:51], a[112:115], a[32:35], v[48:51]
s_add_u32 s37, s34, 14848
v_mfma_f32_16x16x32_bf16 v[52:55], a[112:115], a[36:39], v[52:55]
ds_read_b64_tr_b16 a[86:87], v9 offset:1024
v_mfma_f32_16x16x32_bf16 v[80:83], a[112:115], a[40:43], v[80:83]
buffer_load_dwordx4 v2, s[8:11], s37 offen offset:2048 lds
v_mfma_f32_16x16x32_bf16 v[84:87], a[112:115], a[44:47], v[84:87]
ds_read_b128 a[20:23], v14 offset:10240
v_mfma_f32_16x16x32_bf16 v[112:115], a[112:115], a[48:51], v[112:115]
s_add_u32 s37, s34, 22016
v_mfma_f32_16x16x32_bf16 v[116:119], a[112:115], a[52:55], v[116:119]
ds_read_b64_tr_b16 a[88:89], v10 offset:0
v_mfma_f32_16x16x32_bf16 v[144:147], a[112:115], a[56:59], v[144:147]
buffer_load_dwordx4 v3, s[8:11], s37 offen offset:3072 lds
v_mfma_f32_16x16x32_bf16 v[148:151], a[112:115], a[60:63], v[148:151]
ds_read_b64_tr_b16 a[90:91], v10 offset:1024
v_mfma_f32_16x16x32_bf16 v[224:227], a[116:119], a[32:35], v[224:227]
v_mfma_f32_16x16x32_bf16 v[228:231], a[116:119], a[36:39], v[228:231]
ds_read_b128 a[24:27], v14 offset:12288
v_mfma_f32_16x16x32_bf16 v[232:235], a[116:119], a[40:43], v[232:235]
v_mfma_f32_16x16x32_bf16 v[236:239], a[116:119], a[44:47], v[236:239]
ds_read_b64_tr_b16 a[92:93], v11 offset:0
v_mfma_f32_16x16x32_bf16 v[240:243], a[116:119], a[48:51], v[240:243]
s_mov_b32 s40, s76
s_mov_b32 s41, s77
s_mov_b32 s42, 4718592
s_mov_b32 s43, 0x20000
v_mfma_f32_16x16x32_bf16 v[244:247], a[116:119], a[52:55], v[244:247]
ds_read_b64_tr_b16 a[94:95], v11 offset:1024
v_mfma_f32_16x16x32_bf16 v[248:251], a[116:119], a[56:59], v[248:251]
s_lshr_b32 s3, s2, 3
s_lshl_b32 s3, s3, 2
s_add_u32 s3, s3, s28
s_mul_i32 s3, s3, 36
v_mfma_f32_16x16x32_bf16 v[252:255], a[116:119], a[60:63], v[252:255]
ds_read_b128 a[28:31], v14 offset:14336
v_mfma_f32_16x16x32_bf16 v[56:59], a[120:123], a[32:35], v[56:59]
v_add_u32 v26, s3, v0
v_mfma_f32_16x16x32_bf16 v[60:63], a[120:123], a[36:39], v[60:63]
v_lshrrev_b32 v27, 3, v26
v_mfma_f32_16x16x32_bf16 v[88:91], a[120:123], a[40:43], v[88:91]
v_mul_u32_u24 v28, 8, v27
v_mfma_f32_16x16x32_bf16 v[92:95], a[120:123], a[44:47], v[92:95]
v_sub_u32 v28, v26, v28
v_mfma_f32_16x16x32_bf16 v[120:123], a[120:123], a[48:51], v[120:123]
s_mov_b32 s5, 0
s_and_b32 s6, s2, 7
s_lshl_b32 s6, s6, 10
v_mfma_f32_16x16x32_bf16 v[124:127], a[120:123], a[52:55], v[124:127]
v_add_u32 v27, s5, v27
v_mfma_f32_16x16x32_bf16 v[152:155], a[120:123], a[56:59], v[152:155]
v_mul_u32_u24 v27, 8192, v27
v_mfma_f32_16x16x32_bf16 v[156:159], a[120:123], a[60:63], v[156:159]
v_lshl_add_u32 v27, v28, 7, v27
v_mfma_f32_16x16x32_bf16 a[128:131], a[124:127], a[32:35], a[128:131]
v_add_u32 v27, s6, v27
v_mfma_f32_16x16x32_bf16 a[132:135], a[124:127], a[36:39], a[132:135]
v_mov_b32 v28, 0x10000000
v_mfma_f32_16x16x32_bf16 a[136:139], a[124:127], a[40:43], a[136:139]
v_cmp_gt_u32 vcc, 36, v0
v_mfma_f32_16x16x32_bf16 a[140:143], a[124:127], a[44:47], a[140:143]
s_mov_b32 s4, 4608
v_cmp_gt_u32 s[6:7], s4, v26
v_mfma_f32_16x16x32_bf16 a[144:147], a[124:127], a[48:51], a[144:147]
s_nop 1
s_and_b64 vcc, vcc, s[6:7]
v_mfma_f32_16x16x32_bf16 a[148:151], a[124:127], a[52:55], a[148:151]
s_nop 1
v_cndmask_b32 v27, v28, v27, vcc
v_mfma_f32_16x16x32_bf16 a[152:155], a[124:127], a[56:59], a[152:155]
buffer_load_dword v28, v27, s[40:43], 0 offen
v_mfma_f32_16x16x32_bf16 a[156:159], a[124:127], a[60:63], a[156:159]
s_waitcnt lgkmcnt(0)
s_waitcnt vmcnt(21)
v_mfma_f32_16x16x32_bf16 v[32:35], a[64:67], a[0:3], v[32:35]
s_barrier
v_mfma_f32_16x16x32_bf16 v[36:39], a[64:67], a[4:7], v[36:39]
ds_read_b64_tr_b16 a[96:97], v4 offset:16384
v_mfma_f32_16x16x32_bf16 v[64:67], a[64:67], a[8:11], v[64:67]
s_add_u32 m0, s33, 0
v_mfma_f32_16x16x32_bf16 v[68:71], a[64:67], a[12:15], v[68:71]
ds_read_b64_tr_b16 a[98:99], v4 offset:17408
v_mfma_f32_16x16x32_bf16 v[96:99], a[64:67], a[16:19], v[96:99]
s_add_u32 s36, s32, 2097152
v_mfma_f32_16x16x32_bf16 v[100:103], a[64:67], a[20:23], v[100:103]
ds_read_b128 a[32:35], v15 offset:0
v_mfma_f32_16x16x32_bf16 v[128:131], a[64:67], a[24:27], v[128:131]
v_mfma_f32_16x16x32_bf16 v[132:135], a[64:67], a[28:31], v[132:135]
ds_read_b64_tr_b16 a[100:101], v5 offset:16384
v_mfma_f32_16x16x32_bf16 v[160:163], a[68:71], a[0:3], v[160:163]
buffer_load_dwordx4 v1, s[12:15], s36 offen offset:0 lds
v_mfma_f32_16x16x32_bf16 v[164:167], a[68:71], a[4:7], v[164:167]
ds_read_b64_tr_b16 a[102:103], v5 offset:17408
v_mfma_f32_16x16x32_bf16 v[168:171], a[68:71], a[8:11], v[168:171]
v_mfma_f32_16x16x32_bf16 v[172:175], a[68:71], a[12:15], v[172:175]
ds_read_b128 a[36:39], v15 offset:2048
v_mfma_f32_16x16x32_bf16 v[176:179], a[68:71], a[16:19], v[176:179]
s_add_u32 s36, s32, 2128896
v_mfma_f32_16x16x32_bf16 v[180:183], a[68:71], a[20:23], v[180:183]
ds_read_b64_tr_b16 a[104:105], v6 offset:16384
v_mfma_f32_16x16x32_bf16 v[184:187], a[68:71], a[24:27], v[184:187]
v_mfma_f32_16x16x32_bf16 v[188:191], a[68:71], a[28:31], v[188:191]
ds_read_b64_tr_b16 a[106:107], v6 offset:17408
v_mfma_f32_16x16x32_bf16 v[40:43], a[72:75], a[0:3], v[40:43]
buffer_load_dwordx4 v1, s[12:15], s36 offen offset:1024 lds
v_mfma_f32_16x16x32_bf16 v[44:47], a[72:75], a[4:7], v[44:47]
ds_read_b128 a[40:43], v15 offset:4096
v_mfma_f32_16x16x32_bf16 v[72:75], a[72:75], a[8:11], v[72:75]
v_mfma_f32_16x16x32_bf16 v[76:79], a[72:75], a[12:15], v[76:79]
ds_read_b64_tr_b16 a[108:109], v7 offset:16384
v_mfma_f32_16x16x32_bf16 v[104:107], a[72:75], a[16:19], v[104:107]
s_add_u32 m0, s33, 8192
v_mfma_f32_16x16x32_bf16 v[108:111], a[72:75], a[20:23], v[108:111]
ds_read_b64_tr_b16 a[110:111], v7 offset:17408
v_mfma_f32_16x16x32_bf16 v[136:139], a[72:75], a[24:27], v[136:139]
v_mfma_f32_16x16x32_bf16 v[140:143], a[72:75], a[28:31], v[140:143]
ds_read_b128 a[44:47], v15 offset:6144
v_mfma_f32_16x16x32_bf16 v[192:195], a[76:79], a[0:3], v[192:195]
s_add_u32 s36, s32, 2097152
v_mfma_f32_16x16x32_bf16 v[196:199], a[76:79], a[4:7], v[196:199]
ds_read_b64_tr_b16 a[112:113], v8 offset:16384
v_mfma_f32_16x16x32_bf16 v[200:203], a[76:79], a[8:11], v[200:203]
v_mfma_f32_16x16x32_bf16 v[204:207], a[76:79], a[12:15], v[204:207]
ds_read_b64_tr_b16 a[114:115], v8 offset:17408
v_mfma_f32_16x16x32_bf16 v[208:211], a[76:79], a[16:19], v[208:211]
buffer_load_dwordx4 v1, s[16:19], s36 offen offset:0 lds
v_mfma_f32_16x16x32_bf16 v[212:215], a[76:79], a[20:23], v[212:215]
ds_read_b128 a[48:51], v15 offset:8192
v_mfma_f32_16x16x32_bf16 v[216:219], a[76:79], a[24:27], v[216:219]
v_mfma_f32_16x16x32_bf16 v[220:223], a[76:79], a[28:31], v[220:223]
ds_read_b64_tr_b16 a[116:117], v9 offset:16384
v_mfma_f32_16x16x32_bf16 v[48:51], a[80:83], a[0:3], v[48:51]
s_add_u32 s36, s32, 2128896
v_mfma_f32_16x16x32_bf16 v[52:55], a[80:83], a[4:7], v[52:55]
ds_read_b64_tr_b16 a[118:119], v9 offset:17408
v_mfma_f32_16x16x32_bf16 v[80:83], a[80:83], a[8:11], v[80:83]
v_mfma_f32_16x16x32_bf16 v[84:87], a[80:83], a[12:15], v[84:87]
ds_read_b128 a[52:55], v15 offset:10240
v_mfma_f32_16x16x32_bf16 v[112:115], a[80:83], a[16:19], v[112:115]
buffer_load_dwordx4 v1, s[16:19], s36 offen offset:1024 lds
v_mfma_f32_16x16x32_bf16 v[116:119], a[80:83], a[20:23], v[116:119]
ds_read_b64_tr_b16 a[120:121], v10 offset:16384
v_mfma_f32_16x16x32_bf16 v[144:147], a[80:83], a[24:27], v[144:147]
v_mfma_f32_16x16x32_bf16 v[148:151], a[80:83], a[28:31], v[148:151]
ds_read_b64_tr_b16 a[122:123], v10 offset:17408
v_mfma_f32_16x16x32_bf16 v[224:227], a[84:87], a[0:3], v[224:227]
s_add_u32 m0, s35, 36864
v_mfma_f32_16x16x32_bf16 v[228:231], a[84:87], a[4:7], v[228:231]
ds_read_b128 a[56:59], v15 offset:12288
v_mfma_f32_16x16x32_bf16 v[232:235], a[84:87], a[8:11], v[232:235]
v_mfma_f32_16x16x32_bf16 v[236:239], a[84:87], a[12:15], v[236:239]
ds_read_b64_tr_b16 a[124:125], v11 offset:16384
v_mfma_f32_16x16x32_bf16 v[240:243], a[84:87], a[16:19], v[240:243]
s_add_u32 s37, s34, 33280
v_mfma_f32_16x16x32_bf16 v[244:247], a[84:87], a[20:23], v[244:247]
ds_read_b64_tr_b16 a[126:127], v11 offset:17408
v_mfma_f32_16x16x32_bf16 v[248:251], a[84:87], a[24:27], v[248:251]
v_mfma_f32_16x16x32_bf16 v[252:255], a[84:87], a[28:31], v[252:255]
ds_read_b128 a[60:63], v15 offset:14336
v_mfma_f32_16x16x32_bf16 v[56:59], a[88:91], a[0:3], v[56:59]
buffer_load_dwordx4 v2, s[8:11], s37 offen offset:0 lds
v_mfma_f32_16x16x32_bf16 v[60:63], a[88:91], a[4:7], v[60:63]
v_mfma_f32_16x16x32_bf16 v[88:91], a[88:91], a[8:11], v[88:91]
s_add_u32 s37, s34, 40448
v_mfma_f32_16x16x32_bf16 v[92:95], a[88:91], a[12:15], v[92:95]
v_mfma_f32_16x16x32_bf16 v[120:123], a[88:91], a[16:19], v[120:123]
buffer_load_dwordx4 v3, s[8:11], s37 offen offset:1024 lds
v_mfma_f32_16x16x32_bf16 v[124:127], a[88:91], a[20:23], v[124:127]
v_mfma_f32_16x16x32_bf16 v[152:155], a[88:91], a[24:27], v[152:155]
s_add_u32 s37, s34, 47616
v_mfma_f32_16x16x32_bf16 v[156:159], a[88:91], a[28:31], v[156:159]
v_mfma_f32_16x16x32_bf16 a[128:131], a[92:95], a[0:3], a[128:131]
buffer_load_dwordx4 v2, s[8:11], s37 offen offset:2048 lds
v_mfma_f32_16x16x32_bf16 a[132:135], a[92:95], a[4:7], a[132:135]
v_mfma_f32_16x16x32_bf16 a[136:139], a[92:95], a[8:11], a[136:139]
s_add_u32 s37, s34, 54784
v_mfma_f32_16x16x32_bf16 a[140:143], a[92:95], a[12:15], a[140:143]
v_mfma_f32_16x16x32_bf16 a[144:147], a[92:95], a[16:19], a[144:147]
buffer_load_dwordx4 v3, s[8:11], s37 offen offset:3072 lds
v_mfma_f32_16x16x32_bf16 a[148:151], a[92:95], a[20:23], a[148:151]
v_mfma_f32_16x16x32_bf16 a[152:155], a[92:95], a[24:27], a[152:155]
s_cmp_eq_u32 s28, 0
s_cselect_b32 s68, s2, 0x1000
s_add_u32 s69, s101, 1
v_mov_b32 v26, s69
s_mov_b64 exec, 1
buffer_store_byte v26, off, s[64:67], s68 sc1
s_mov_b64 exec, -1
s_nop 1
v_mfma_f32_16x16x32_bf16 a[156:159], a[92:95], a[28:31], a[156:159]
s_waitcnt lgkmcnt(0)
s_waitcnt vmcnt(18)
v_mfma_f32_16x16x32_bf16 v[32:35], a[96:99], a[32:35], v[32:35]
s_barrier
v_mfma_f32_16x16x32_bf16 v[36:39], a[96:99], a[36:39], v[36:39]
ds_read_b64_tr_b16 a[64:65], v4 offset:32768
v_mfma_f32_16x16x32_bf16 v[64:67], a[96:99], a[40:43], v[64:67]
s_add_u32 m0, s33, 16384
v_mfma_f32_16x16x32_bf16 v[68:71], a[96:99], a[44:47], v[68:71]
ds_read_b64_tr_b16 a[66:67], v4 offset:33792
v_mfma_f32_16x16x32_bf16 v[96:99], a[96:99], a[48:51], v[96:99]
s_add_u32 s36, s32, 2359296
v_mfma_f32_16x16x32_bf16 v[100:103], a[96:99], a[52:55], v[100:103]
ds_read_b128 a[0:3], v12 offset:0
v_mfma_f32_16x16x32_bf16 v[128:131], a[96:99], a[56:59], v[128:131]
v_mfma_f32_16x16x32_bf16 v[132:135], a[96:99], a[60:63], v[132:135]
ds_read_b64_tr_b16 a[68:69], v5 offset:32768
v_mfma_f32_16x16x32_bf16 v[160:163], a[100:103], a[32:35], v[160:163]
buffer_load_dwordx4 v1, s[12:15], s36 offen offset:0 lds
v_mfma_f32_16x16x32_bf16 v[164:167], a[100:103], a[36:39], v[164:167]
ds_read_b64_tr_b16 a[70:71], v5 offset:33792
v_mfma_f32_16x16x32_bf16 v[168:171], a[100:103], a[40:43], v[168:171]
v_mfma_f32_16x16x32_bf16 v[172:175], a[100:103], a[44:47], v[172:175]
ds_read_b128 a[4:7], v12 offset:2048
v_mfma_f32_16x16x32_bf16 v[176:179], a[100:103], a[48:51], v[176:179]
s_add_u32 s36, s32, 2391040
v_mfma_f32_16x16x32_bf16 v[180:183], a[100:103], a[52:55], v[180:183]
ds_read_b64_tr_b16 a[72:73], v6 offset:32768
v_mfma_f32_16x16x32_bf16 v[184:187], a[100:103], a[56:59], v[184:187]
v_mfma_f32_16x16x32_bf16 v[188:191], a[100:103], a[60:63], v[188:191]
ds_read_b64_tr_b16 a[74:75], v6 offset:33792
v_mfma_f32_16x16x32_bf16 v[40:43], a[104:107], a[32:35], v[40:43]
buffer_load_dwordx4 v1, s[12:15], s36 offen offset:1024 lds
v_mfma_f32_16x16x32_bf16 v[44:47], a[104:107], a[36:39], v[44:47]
ds_read_b128 a[8:11], v12 offset:4096
v_mfma_f32_16x16x32_bf16 v[72:75], a[104:107], a[40:43], v[72:75]
v_mfma_f32_16x16x32_bf16 v[76:79], a[104:107], a[44:47], v[76:79]
ds_read_b64_tr_b16 a[76:77], v7 offset:32768
v_mfma_f32_16x16x32_bf16 v[104:107], a[104:107], a[48:51], v[104:107]
s_add_u32 m0, s33, 24576
v_mfma_f32_16x16x32_bf16 v[108:111], a[104:107], a[52:55], v[108:111]
ds_read_b64_tr_b16 a[78:79], v7 offset:33792
v_mfma_f32_16x16x32_bf16 v[136:139], a[104:107], a[56:59], v[136:139]
v_mfma_f32_16x16x32_bf16 v[140:143], a[104:107], a[60:63], v[140:143]
ds_read_b128 a[12:15], v12 offset:6144
v_mfma_f32_16x16x32_bf16 v[192:195], a[108:111], a[32:35], v[192:195]
s_add_u32 s36, s32, 2359296
v_mfma_f32_16x16x32_bf16 v[196:199], a[108:111], a[36:39], v[196:199]
ds_read_b64_tr_b16 a[80:81], v8 offset:32768
v_mfma_f32_16x16x32_bf16 v[200:203], a[108:111], a[40:43], v[200:203]
v_mfma_f32_16x16x32_bf16 v[204:207], a[108:111], a[44:47], v[204:207]
ds_read_b64_tr_b16 a[82:83], v8 offset:33792
v_mfma_f32_16x16x32_bf16 v[208:211], a[108:111], a[48:51], v[208:211]
buffer_load_dwordx4 v1, s[16:19], s36 offen offset:0 lds
v_mfma_f32_16x16x32_bf16 v[212:215], a[108:111], a[52:55], v[212:215]
ds_read_b128 a[16:19], v12 offset:8192
v_mfma_f32_16x16x32_bf16 v[216:219], a[108:111], a[56:59], v[216:219]
v_mfma_f32_16x16x32_bf16 v[220:223], a[108:111], a[60:63], v[220:223]
ds_read_b64_tr_b16 a[84:85], v9 offset:32768
v_mfma_f32_16x16x32_bf16 v[48:51], a[112:115], a[32:35], v[48:51]
s_add_u32 s36, s32, 2391040
v_mfma_f32_16x16x32_bf16 v[52:55], a[112:115], a[36:39], v[52:55]
ds_read_b64_tr_b16 a[86:87], v9 offset:33792
v_mfma_f32_16x16x32_bf16 v[80:83], a[112:115], a[40:43], v[80:83]
v_mfma_f32_16x16x32_bf16 v[84:87], a[112:115], a[44:47], v[84:87]
ds_read_b128 a[20:23], v12 offset:10240
v_mfma_f32_16x16x32_bf16 v[112:115], a[112:115], a[48:51], v[112:115]
buffer_load_dwordx4 v1, s[16:19], s36 offen offset:1024 lds
v_mfma_f32_16x16x32_bf16 v[116:119], a[112:115], a[52:55], v[116:119]
ds_read_b64_tr_b16 a[88:89], v10 offset:32768
v_mfma_f32_16x16x32_bf16 v[144:147], a[112:115], a[56:59], v[144:147]
v_mfma_f32_16x16x32_bf16 v[148:151], a[112:115], a[60:63], v[148:151]
ds_read_b64_tr_b16 a[90:91], v10 offset:33792
v_mfma_f32_16x16x32_bf16 v[224:227], a[116:119], a[32:35], v[224:227]
s_add_u32 m0, s35, 65536
v_mfma_f32_16x16x32_bf16 v[228:231], a[116:119], a[36:39], v[228:231]
ds_read_b128 a[24:27], v12 offset:12288
v_mfma_f32_16x16x32_bf16 v[232:235], a[116:119], a[40:43], v[232:235]
v_mfma_f32_16x16x32_bf16 v[236:239], a[116:119], a[44:47], v[236:239]
ds_read_b64_tr_b16 a[92:93], v11 offset:32768
v_mfma_f32_16x16x32_bf16 v[240:243], a[116:119], a[48:51], v[240:243]
s_add_u32 s37, s34, 640
v_mfma_f32_16x16x32_bf16 v[244:247], a[116:119], a[52:55], v[244:247]
ds_read_b64_tr_b16 a[94:95], v11 offset:33792
v_mfma_f32_16x16x32_bf16 v[248:251], a[116:119], a[56:59], v[248:251]
v_mfma_f32_16x16x32_bf16 v[252:255], a[116:119], a[60:63], v[252:255]
ds_read_b128 a[28:31], v12 offset:14336
v_mfma_f32_16x16x32_bf16 v[56:59], a[120:123], a[32:35], v[56:59]
buffer_load_dwordx4 v2, s[8:11], s37 offen offset:0 lds
v_mfma_f32_16x16x32_bf16 v[60:63], a[120:123], a[36:39], v[60:63]
v_mfma_f32_16x16x32_bf16 v[88:91], a[120:123], a[40:43], v[88:91]
s_add_u32 s37, s34, 7808
v_mfma_f32_16x16x32_bf16 v[92:95], a[120:123], a[44:47], v[92:95]
v_mfma_f32_16x16x32_bf16 v[120:123], a[120:123], a[48:51], v[120:123]
buffer_load_dwordx4 v3, s[8:11], s37 offen offset:1024 lds
v_mfma_f32_16x16x32_bf16 v[124:127], a[120:123], a[52:55], v[124:127]
v_mfma_f32_16x16x32_bf16 v[152:155], a[120:123], a[56:59], v[152:155]
s_add_u32 s37, s34, 14976
v_mfma_f32_16x16x32_bf16 v[156:159], a[120:123], a[60:63], v[156:159]
v_mfma_f32_16x16x32_bf16 a[128:131], a[124:127], a[32:35], a[128:131]
buffer_load_dwordx4 v2, s[8:11], s37 offen offset:2048 lds
v_mfma_f32_16x16x32_bf16 a[132:135], a[124:127], a[36:39], a[132:135]
v_mfma_f32_16x16x32_bf16 a[136:139], a[124:127], a[40:43], a[136:139]
s_add_u32 s37, s34, 22144
v_mfma_f32_16x16x32_bf16 a[140:143], a[124:127], a[44:47], a[140:143]
v_mfma_f32_16x16x32_bf16 a[144:147], a[124:127], a[48:51], a[144:147]
buffer_load_dwordx4 v3, s[8:11], s37 offen offset:3072 lds
v_mfma_f32_16x16x32_bf16 a[148:151], a[124:127], a[52:55], a[148:151]
v_mfma_f32_16x16x32_bf16 a[152:155], a[124:127], a[56:59], a[152:155]
s_lshr_b32 s68, s2, 5
s_lshl_b32 s68, s68, 7
s_and_b32 s69, s2, 31
s_lshl_b32 s69, s69, 2
s_add_u32 s68, s68, s69
s_add_u32 s68, s68, 113246208
s_cmp_eq_u32 s28, 0
s_cselect_b32 s68, s68, 0x10000000
v_mov_b32 v26, 1
s_mov_b64 exec, 1
buffer_store_dword v26, off, s[20:23], s68 sc1
s_mov_b64 exec, -1
s_nop 1
v_mfma_f32_16x16x32_bf16 a[156:159], a[124:127], a[60:63], a[156:159]
s_waitcnt lgkmcnt(0)
s_waitcnt vmcnt(23)
v_mfma_f32_16x16x32_bf16 v[32:35], a[64:67], a[0:3], v[32:35]
s_barrier
v_mfma_f32_16x16x32_bf16 v[36:39], a[64:67], a[4:7], v[36:39]
ds_read_b64_tr_b16 a[96:97], v4 offset:49152
v_mfma_f32_16x16x32_bf16 v[64:67], a[64:67], a[8:11], v[64:67]
s_add_u32 m0, s33, 32768
v_mfma_f32_16x16x32_bf16 v[68:71], a[64:67], a[12:15], v[68:71]
ds_read_b64_tr_b16 a[98:99], v4 offset:50176
v_mfma_f32_16x16x32_bf16 v[96:99], a[64:67], a[16:19], v[96:99]
v_mfma_f32_16x16x32_bf16 v[100:103], a[64:67], a[20:23], v[100:103]
ds_read_b128 a[32:35], v13 offset:0
v_mfma_f32_16x16x32_bf16 v[128:131], a[64:67], a[24:27], v[128:131]
s_add_u32 s36, s32, 2621440
v_mfma_f32_16x16x32_bf16 v[132:135], a[64:67], a[28:31], v[132:135]
ds_read_b64_tr_b16 a[100:101], v5 offset:49152
v_mfma_f32_16x16x32_bf16 v[160:163], a[68:71], a[0:3], v[160:163]
v_mfma_f32_16x16x32_bf16 v[164:167], a[68:71], a[4:7], v[164:167]
ds_read_b64_tr_b16 a[102:103], v5 offset:50176
v_mfma_f32_16x16x32_bf16 v[168:171], a[68:71], a[8:11], v[168:171]
buffer_load_dwordx4 v1, s[12:15], s36 offen offset:0 lds
v_mfma_f32_16x16x32_bf16 v[172:175], a[68:71], a[12:15], v[172:175]
ds_read_b128 a[36:39], v13 offset:2048
v_mfma_f32_16x16x32_bf16 v[176:179], a[68:71], a[16:19], v[176:179]
v_mfma_f32_16x16x32_bf16 v[180:183], a[68:71], a[20:23], v[180:183]
ds_read_b64_tr_b16 a[104:105], v6 offset:49152
v_mfma_f32_16x16x32_bf16 v[184:187], a[68:71], a[24:27], v[184:187]
s_add_u32 s36, s32, 2653184
v_mfma_f32_16x16x32_bf16 v[188:191], a[68:71], a[28:31], v[188:191]
ds_read_b64_tr_b16 a[106:107], v6 offset:50176
v_mfma_f32_16x16x32_bf16 v[40:43], a[72:75], a[0:3], v[40:43]
v_mfma_f32_16x16x32_bf16 v[44:47], a[72:75], a[4:7], v[44:47]
ds_read_b128 a[40:43], v13 offset:4096
v_mfma_f32_16x16x32_bf16 v[72:75], a[72:75], a[8:11], v[72:75]
buffer_load_dwordx4 v1, s[12:15], s36 offen offset:1024 lds
v_mfma_f32_16x16x32_bf16 v[76:79], a[72:75], a[12:15], v[76:79]
ds_read_b64_tr_b16 a[108:109], v7 offset:49152
v_mfma_f32_16x16x32_bf16 v[104:107], a[72:75], a[16:19], v[104:107]
v_mfma_f32_16x16x32_bf16 v[108:111], a[72:75], a[20:23], v[108:111]
ds_read_b64_tr_b16 a[110:111], v7 offset:50176
v_mfma_f32_16x16x32_bf16 v[136:139], a[72:75], a[24:27], v[136:139]
s_add_u32 m0, s33, 40960
v_mfma_f32_16x16x32_bf16 v[140:143], a[72:75], a[28:31], v[140:143]
ds_read_b128 a[44:47], v13 offset:6144
v_mfma_f32_16x16x32_bf16 v[192:195], a[76:79], a[0:3], v[192:195]
v_mfma_f32_16x16x32_bf16 v[196:199], a[76:79], a[4:7], v[196:199]
ds_read_b64_tr_b16 a[112:113], v8 offset:49152
v_mfma_f32_16x16x32_bf16 v[200:203], a[76:79], a[8:11], v[200:203]
s_add_u32 s36, s32, 2621440
v_mfma_f32_16x16x32_bf16 v[204:207], a[76:79], a[12:15], v[204:207]
ds_read_b64_tr_b16 a[114:115], v8 offset:50176
v_mfma_f32_16x16x32_bf16 v[208:211], a[76:79], a[16:19], v[208:211]
v_mfma_f32_16x16x32_bf16 v[212:215], a[76:79], a[20:23], v[212:215]
ds_read_b128 a[48:51], v13 offset:8192
v_mfma_f32_16x16x32_bf16 v[216:219], a[76:79], a[24:27], v[216:219]
buffer_load_dwordx4 v1, s[16:19], s36 offen offset:0 lds
v_mfma_f32_16x16x32_bf16 v[220:223], a[76:79], a[28:31], v[220:223]
ds_read_b64_tr_b16 a[116:117], v9 offset:49152
v_mfma_f32_16x16x32_bf16 v[48:51], a[80:83], a[0:3], v[48:51]
v_mfma_f32_16x16x32_bf16 v[52:55], a[80:83], a[4:7], v[52:55]
ds_read_b64_tr_b16 a[118:119], v9 offset:50176
v_mfma_f32_16x16x32_bf16 v[80:83], a[80:83], a[8:11], v[80:83]
s_add_u32 s36, s32, 2653184
v_mfma_f32_16x16x32_bf16 v[84:87], a[80:83], a[12:15], v[84:87]
ds_read_b128 a[52:55], v13 offset:10240
v_mfma_f32_16x16x32_bf16 v[112:115], a[80:83], a[16:19], v[112:115]
v_mfma_f32_16x16x32_bf16 v[116:119], a[80:83], a[20:23], v[116:119]
ds_read_b64_tr_b16 a[120:121], v10 offset:49152
v_mfma_f32_16x16x32_bf16 v[144:147], a[80:83], a[24:27], v[144:147]
buffer_load_dwordx4 v1, s[16:19], s36 offen offset:1024 lds
v_mfma_f32_16x16x32_bf16 v[148:151], a[80:83], a[28:31], v[148:151]
ds_read_b64_tr_b16 a[122:123], v10 offset:50176
v_mfma_f32_16x16x32_bf16 v[224:227], a[84:87], a[0:3], v[224:227]
v_mfma_f32_16x16x32_bf16 v[228:231], a[84:87], a[4:7], v[228:231]
ds_read_b128 a[56:59], v13 offset:12288
v_mfma_f32_16x16x32_bf16 v[232:235], a[84:87], a[8:11], v[232:235]
s_add_u32 m0, s35, 69632
v_mfma_f32_16x16x32_bf16 v[236:239], a[84:87], a[12:15], v[236:239]
ds_read_b64_tr_b16 a[124:125], v11 offset:49152
v_mfma_f32_16x16x32_bf16 v[240:243], a[84:87], a[16:19], v[240:243]
v_mfma_f32_16x16x32_bf16 v[244:247], a[84:87], a[20:23], v[244:247]
ds_read_b64_tr_b16 a[126:127], v11 offset:50176
v_mfma_f32_16x16x32_bf16 v[248:251], a[84:87], a[24:27], v[248:251]
s_add_u32 s37, s34, 33408
v_mfma_f32_16x16x32_bf16 v[252:255], a[84:87], a[28:31], v[252:255]
ds_read_b128 a[60:63], v13 offset:14336
v_mfma_f32_16x16x32_bf16 v[56:59], a[88:91], a[0:3], v[56:59]
v_mfma_f32_16x16x32_bf16 v[60:63], a[88:91], a[4:7], v[60:63]
buffer_load_dwordx4 v2, s[8:11], s37 offen offset:0 lds
v_mfma_f32_16x16x32_bf16 v[88:91], a[88:91], a[8:11], v[88:91]
v_mfma_f32_16x16x32_bf16 v[92:95], a[88:91], a[12:15], v[92:95]
s_add_u32 s37, s34, 40576
v_mfma_f32_16x16x32_bf16 v[120:123], a[88:91], a[16:19], v[120:123]
v_mfma_f32_16x16x32_bf16 v[124:127], a[88:91], a[20:23], v[124:127]
buffer_load_dwordx4 v3, s[8:11], s37 offen offset:1024 lds
v_mfma_f32_16x16x32_bf16 v[152:155], a[88:91], a[24:27], v[152:155]
v_mfma_f32_16x16x32_bf16 v[156:159], a[88:91], a[28:31], v[156:159]
s_add_u32 s37, s34, 47744
v_mfma_f32_16x16x32_bf16 a[128:131], a[92:95], a[0:3], a[128:131]
v_mfma_f32_16x16x32_bf16 a[132:135], a[92:95], a[4:7], a[132:135]
buffer_load_dwordx4 v2, s[8:11], s37 offen offset:2048 lds
v_mfma_f32_16x16x32_bf16 a[136:139], a[92:95], a[8:11], a[136:139]
v_mfma_f32_16x16x32_bf16 a[140:143], a[92:95], a[12:15], a[140:143]
s_add_u32 s37, s34, 54912
v_mfma_f32_16x16x32_bf16 a[144:147], a[92:95], a[16:19], a[144:147]
v_mfma_f32_16x16x32_bf16 a[148:151], a[92:95], a[20:23], a[148:151]
buffer_load_dwordx4 v3, s[8:11], s37 offen offset:3072 lds
v_mfma_f32_16x16x32_bf16 a[152:155], a[92:95], a[24:27], a[152:155]
v_mfma_f32_16x16x32_bf16 a[156:159], a[92:95], a[28:31], a[156:159]
s_waitcnt lgkmcnt(0)
s_waitcnt vmcnt(18)
v_mfma_f32_16x16x32_bf16 v[32:35], a[96:99], a[32:35], v[32:35]
s_barrier
v_mfma_f32_16x16x32_bf16 v[36:39], a[96:99], a[36:39], v[36:39]
ds_read_b64_tr_b16 a[64:65], v4 offset:0
v_mfma_f32_16x16x32_bf16 v[64:67], a[96:99], a[40:43], v[64:67]
s_add_u32 m0, s33, 49152
v_mfma_f32_16x16x32_bf16 v[68:71], a[96:99], a[44:47], v[68:71]
ds_read_b64_tr_b16 a[66:67], v4 offset:1024
v_mfma_f32_16x16x32_bf16 v[96:99], a[96:99], a[48:51], v[96:99]
v_mfma_f32_16x16x32_bf16 v[100:103], a[96:99], a[52:55], v[100:103]
ds_read_b128 a[0:3], v12 offset:32768
v_mfma_f32_16x16x32_bf16 v[128:131], a[96:99], a[56:59], v[128:131]
s_add_u32 s36, s32, 2883584
v_mfma_f32_16x16x32_bf16 v[132:135], a[96:99], a[60:63], v[132:135]
ds_read_b64_tr_b16 a[68:69], v5 offset:0
v_mfma_f32_16x16x32_bf16 v[160:163], a[100:103], a[32:35], v[160:163]
v_mfma_f32_16x16x32_bf16 v[164:167], a[100:103], a[36:39], v[164:167]
ds_read_b64_tr_b16 a[70:71], v5 offset:1024
v_mfma_f32_16x16x32_bf16 v[168:171], a[100:103], a[40:43], v[168:171]
buffer_load_dwordx4 v1, s[12:15], s36 offen offset:0 lds
v_mfma_f32_16x16x32_bf16 v[172:175], a[100:103], a[44:47], v[172:175]
ds_read_b128 a[4:7], v12 offset:34816
v_mfma_f32_16x16x32_bf16 v[176:179], a[100:103], a[48:51], v[176:179]
v_mfma_f32_16x16x32_bf16 v[180:183], a[100:103], a[52:55], v[180:183]
ds_read_b64_tr_b16 a[72:73], v6 offset:0
v_mfma_f32_16x16x32_bf16 v[184:187], a[100:103], a[56:59], v[184:187]
s_add_u32 s36, s32, 2915328
v_mfma_f32_16x16x32_bf16 v[188:191], a[100:103], a[60:63], v[188:191]
ds_read_b64_tr_b16 a[74:75], v6 offset:1024
v_mfma_f32_16x16x32_bf16 v[40:43], a[104:107], a[32:35], v[40:43]
v_mfma_f32_16x16x32_bf16 v[44:47], a[104:107], a[36:39], v[44:47]
ds_read_b128 a[8:11], v12 offset:36864
v_mfma_f32_16x16x32_bf16 v[72:75], a[104:107], a[40:43], v[72:75]
buffer_load_dwordx4 v1, s[12:15], s36 offen offset:1024 lds
v_mfma_f32_16x16x32_bf16 v[76:79], a[104:107], a[44:47], v[76:79]
ds_read_b64_tr_b16 a[76:77], v7 offset:0
v_mfma_f32_16x16x32_bf16 v[104:107], a[104:107], a[48:51], v[104:107]
v_mfma_f32_16x16x32_bf16 v[108:111], a[104:107], a[52:55], v[108:111]
ds_read_b64_tr_b16 a[78:79], v7 offset:1024
v_mfma_f32_16x16x32_bf16 v[136:139], a[104:107], a[56:59], v[136:139]
s_add_u32 m0, s33, 57344
v_mfma_f32_16x16x32_bf16 v[140:143], a[104:107], a[60:63], v[140:143]
ds_read_b128 a[12:15], v12 offset:38912
v_mfma_f32_16x16x32_bf16 v[192:195], a[108:111], a[32:35], v[192:195]
v_mfma_f32_16x16x32_bf16 v[196:199], a[108:111], a[36:39], v[196:199]
ds_read_b64_tr_b16 a[80:81], v8 offset:0
v_mfma_f32_16x16x32_bf16 v[200:203], a[108:111], a[40:43], v[200:203]
s_add_u32 s36, s32, 2883584
v_mfma_f32_16x16x32_bf16 v[204:207], a[108:111], a[44:47], v[204:207]
ds_read_b64_tr_b16 a[82:83], v8 offset:1024
v_mfma_f32_16x16x32_bf16 v[208:211], a[108:111], a[48:51], v[208:211]
v_mfma_f32_16x16x32_bf16 v[212:215], a[108:111], a[52:55], v[212:215]
ds_read_b128 a[16:19], v12 offset:40960
v_mfma_f32_16x16x32_bf16 v[216:219], a[108:111], a[56:59], v[216:219]
buffer_load_dwordx4 v1, s[16:19], s36 offen offset:0 lds
v_mfma_f32_16x16x32_bf16 v[220:223], a[108:111], a[60:63], v[220:223]
ds_read_b64_tr_b16 a[84:85], v9 offset:0
v_mfma_f32_16x16x32_bf16 v[48:51], a[112:115], a[32:35], v[48:51]
v_mfma_f32_16x16x32_bf16 v[52:55], a[112:115], a[36:39], v[52:55]
ds_read_b64_tr_b16 a[86:87], v9 offset:1024
v_mfma_f32_16x16x32_bf16 v[80:83], a[112:115], a[40:43], v[80:83]
s_add_u32 s36, s32, 2915328
v_mfma_f32_16x16x32_bf16 v[84:87], a[112:115], a[44:47], v[84:87]
ds_read_b128 a[20:23], v12 offset:43008
v_mfma_f32_16x16x32_bf16 v[112:115], a[112:115], a[48:51], v[112:115]
v_mfma_f32_16x16x32_bf16 v[116:119], a[112:115], a[52:55], v[116:119]
ds_read_b64_tr_b16 a[88:89], v10 offset:0
v_mfma_f32_16x16x32_bf16 v[144:147], a[112:115], a[56:59], v[144:147]
buffer_load_dwordx4 v1, s[16:19], s36 offen offset:1024 lds
v_mfma_f32_16x16x32_bf16 v[148:151], a[112:115], a[60:63], v[148:151]
ds_read_b64_tr_b16 a[90:91], v10 offset:1024
v_mfma_f32_16x16x32_bf16 v[224:227], a[116:119], a[32:35], v[224:227]
v_mfma_f32_16x16x32_bf16 v[228:231], a[116:119], a[36:39], v[228:231]
ds_read_b128 a[24:27], v12 offset:45056
v_mfma_f32_16x16x32_bf16 v[232:235], a[116:119], a[40:43], v[232:235]
s_add_u32 m0, s35, 0
v_mfma_f32_16x16x32_bf16 v[236:239], a[116:119], a[44:47], v[236:239]
ds_read_b64_tr_b16 a[92:93], v11 offset:0
v_mfma_f32_16x16x32_bf16 v[240:243], a[116:119], a[48:51], v[240:243]
v_mfma_f32_16x16x32_bf16 v[244:247], a[116:119], a[52:55], v[244:247]
ds_read_b64_tr_b16 a[94:95], v11 offset:1024
v_mfma_f32_16x16x32_bf16 v[248:251], a[116:119], a[56:59], v[248:251]
s_add_u32 s37, s34, 768
v_mfma_f32_16x16x32_bf16 v[252:255], a[116:119], a[60:63], v[252:255]
ds_read_b128 a[28:31], v12 offset:47104
v_mfma_f32_16x16x32_bf16 v[56:59], a[120:123], a[32:35], v[56:59]
v_mfma_f32_16x16x32_bf16 v[60:63], a[120:123], a[36:39], v[60:63]
buffer_load_dwordx4 v2, s[8:11], s37 offen offset:0 lds
v_mfma_f32_16x16x32_bf16 v[88:91], a[120:123], a[40:43], v[88:91]
v_mfma_f32_16x16x32_bf16 v[92:95], a[120:123], a[44:47], v[92:95]
s_add_u32 s37, s34, 7936
v_mfma_f32_16x16x32_bf16 v[120:123], a[120:123], a[48:51], v[120:123]
v_mfma_f32_16x16x32_bf16 v[124:127], a[120:123], a[52:55], v[124:127]
buffer_load_dwordx4 v3, s[8:11], s37 offen offset:1024 lds
v_mfma_f32_16x16x32_bf16 v[152:155], a[120:123], a[56:59], v[152:155]
v_mfma_f32_16x16x32_bf16 v[156:159], a[120:123], a[60:63], v[156:159]
s_add_u32 s37, s34, 15104
v_mfma_f32_16x16x32_bf16 a[128:131], a[124:127], a[32:35], a[128:131]
v_mfma_f32_16x16x32_bf16 a[132:135], a[124:127], a[36:39], a[132:135]
buffer_load_dwordx4 v2, s[8:11], s37 offen offset:2048 lds
v_mfma_f32_16x16x32_bf16 a[136:139], a[124:127], a[40:43], a[136:139]
v_mfma_f32_16x16x32_bf16 a[140:143], a[124:127], a[44:47], a[140:143]
s_add_u32 s37, s34, 22272
v_mfma_f32_16x16x32_bf16 a[144:147], a[124:127], a[48:51], a[144:147]
v_mfma_f32_16x16x32_bf16 a[148:151], a[124:127], a[52:55], a[148:151]
buffer_load_dwordx4 v3, s[8:11], s37 offen offset:3072 lds
v_mfma_f32_16x16x32_bf16 a[152:155], a[124:127], a[56:59], a[152:155]
v_mfma_f32_16x16x32_bf16 a[156:159], a[124:127], a[60:63], a[156:159]
s_waitcnt lgkmcnt(0)
s_waitcnt vmcnt(21)
v_mfma_f32_16x16x32_bf16 v[32:35], a[64:67], a[0:3], v[32:35]
s_barrier
v_mfma_f32_16x16x32_bf16 v[36:39], a[64:67], a[4:7], v[36:39]
ds_read_b64_tr_b16 a[96:97], v4 offset:16384
v_mfma_f32_16x16x32_bf16 v[64:67], a[64:67], a[8:11], v[64:67]
s_add_u32 m0, s33, 0
v_mfma_f32_16x16x32_bf16 v[68:71], a[64:67], a[12:15], v[68:71]
ds_read_b64_tr_b16 a[98:99], v4 offset:17408
v_mfma_f32_16x16x32_bf16 v[96:99], a[64:67], a[16:19], v[96:99]
s_add_u32 s36, s32, 3145728
v_mfma_f32_16x16x32_bf16 v[100:103], a[64:67], a[20:23], v[100:103]
ds_read_b128 a[32:35], v13 offset:32768
v_mfma_f32_16x16x32_bf16 v[128:131], a[64:67], a[24:27], v[128:131]
buffer_load_dwordx4 v1, s[12:15], s36 offen offset:0 lds
v_mfma_f32_16x16x32_bf16 v[132:135], a[64:67], a[28:31], v[132:135]
ds_read_b64_tr_b16 a[100:101], v5 offset:16384
v_mfma_f32_16x16x32_bf16 v[160:163], a[68:71], a[0:3], v[160:163]
s_add_u32 s36, s32, 3177472
v_mfma_f32_16x16x32_bf16 v[164:167], a[68:71], a[4:7], v[164:167]
ds_read_b64_tr_b16 a[102:103], v5 offset:17408
v_mfma_f32_16x16x32_bf16 v[168:171], a[68:71], a[8:11], v[168:171]
buffer_load_dwordx4 v1, s[12:15], s36 offen offset:1024 lds
v_mfma_f32_16x16x32_bf16 v[172:175], a[68:71], a[12:15], v[172:175]
ds_read_b128 a[36:39], v13 offset:34816
v_mfma_f32_16x16x32_bf16 v[176:179], a[68:71], a[16:19], v[176:179]
s_add_u32 m0, s33, 8192
v_mfma_f32_16x16x32_bf16 v[180:183], a[68:71], a[20:23], v[180:183]
ds_read_b64_tr_b16 a[104:105], v6 offset:16384
v_mfma_f32_16x16x32_bf16 v[184:187], a[68:71], a[24:27], v[184:187]
s_add_u32 s36, s32, 3145728
v_mfma_f32_16x16x32_bf16 v[188:191], a[68:71], a[28:31], v[188:191]
ds_read_b64_tr_b16 a[106:107], v6 offset:17408
v_mfma_f32_16x16x32_bf16 v[40:43], a[72:75], a[0:3], v[40:43]
buffer_load_dwordx4 v1, s[16:19], s36 offen offset:0 lds
v_mfma_f32_16x16x32_bf16 v[44:47], a[72:75], a[4:7], v[44:47]
ds_read_b128 a[40:43], v13 offset:36864
v_mfma_f32_16x16x32_bf16 v[72:75], a[72:75], a[8:11], v[72:75]
s_add_u32 s36, s32, 3177472
v_mfma_f32_16x16x32_bf16 v[76:79], a[72:75], a[12:15], v[76:79]
ds_read_b64_tr_b16 a[108:109], v7 offset:16384
v_mfma_f32_16x16x32_bf16 v[104:107], a[72:75], a[16:19], v[104:107]
buffer_load_dwordx4 v1, s[16:19], s36 offen offset:1024 lds
v_mfma_f32_16x16x32_bf16 v[108:111], a[72:75], a[20:23], v[108:111]
ds_read_b64_tr_b16 a[110:111], v7 offset:17408
v_mfma_f32_16x16x32_bf16 v[136:139], a[72:75], a[24:27], v[136:139]
s_add_u32 m0, s35, 4096
v_mfma_f32_16x16x32_bf16 v[140:143], a[72:75], a[28:31], v[140:143]
ds_read_b128 a[44:47], v13 offset:38912
v_mfma_f32_16x16x32_bf16 v[192:195], a[76:79], a[0:3], v[192:195]
s_add_u32 s37, s34, 33536
v_mfma_f32_16x16x32_bf16 v[196:199], a[76:79], a[4:7], v[196:199]
ds_read_b64_tr_b16 a[112:113], v8 offset:16384
v_mfma_f32_16x16x32_bf16 v[200:203], a[76:79], a[8:11], v[200:203]
buffer_load_dwordx4 v2, s[8:11], s37 offen offset:0 lds
v_mfma_f32_16x16x32_bf16 v[204:207], a[76:79], a[12:15], v[204:207]
ds_read_b64_tr_b16 a[114:115], v8 offset:17408
v_mfma_f32_16x16x32_bf16 v[208:211], a[76:79], a[16:19], v[208:211]
s_add_u32 s37, s34, 40704
v_mfma_f32_16x16x32_bf16 v[212:215], a[76:79], a[20:23], v[212:215]
ds_read_b128 a[48:51], v13 offset:40960
v_mfma_f32_16x16x32_bf16 v[216:219], a[76:79], a[24:27], v[216:219]
buffer_load_dwordx4 v3, s[8:11], s37 offen offset:1024 lds
v_mfma_f32_16x16x32_bf16 v[220:223], a[76:79], a[28:31], v[220:223]
ds_read_b64_tr_b16 a[116:117], v9 offset:16384
v_mfma_f32_16x16x32_bf16 v[48:51], a[80:83], a[0:3], v[48:51]
s_add_u32 s37, s34, 47872
v_mfma_f32_16x16x32_bf16 v[52:55], a[80:83], a[4:7], v[52:55]
ds_read_b64_tr_b16 a[118:119], v9 offset:17408
v_mfma_f32_16x16x32_bf16 v[80:83], a[80:83], a[8:11], v[80:83]
buffer_load_dwordx4 v2, s[8:11], s37 offen offset:2048 lds
v_mfma_f32_16x16x32_bf16 v[84:87], a[80:83], a[12:15], v[84:87]
ds_read_b128 a[52:55], v13 offset:43008
v_mfma_f32_16x16x32_bf16 v[112:115], a[80:83], a[16:19], v[112:115]
s_add_u32 s37, s34, 55040
v_mfma_f32_16x16x32_bf16 v[116:119], a[80:83], a[20:23], v[116:119]
ds_read_b64_tr_b16 a[120:121], v10 offset:16384
v_mfma_f32_16x16x32_bf16 v[144:147], a[80:83], a[24:27], v[144:147]
buffer_load_dwordx4 v3, s[8:11], s37 offen offset:3072 lds
v_mfma_f32_16x16x32_bf16 v[148:151], a[80:83], a[28:31], v[148:151]
ds_read_b64_tr_b16 a[122:123], v10 offset:17408
v_mfma_f32_16x16x32_bf16 v[224:227], a[84:87], a[0:3], v[224:227]
v_mfma_f32_16x16x32_bf16 v[228:231], a[84:87], a[4:7], v[228:231]
ds_read_b128 a[56:59], v13 offset:45056
v_mfma_f32_16x16x32_bf16 v[232:235], a[84:87], a[8:11], v[232:235]
s_mov_b32 s40, s84
s_mov_b32 s41, s85
s_mov_b32 s42, 5308416
s_mov_b32 s43, 0x20000
v_mfma_f32_16x16x32_bf16 v[236:239], a[84:87], a[12:15], v[236:239]
ds_read_b64_tr_b16 a[124:125], v11 offset:16384
v_mfma_f32_16x16x32_bf16 v[240:243], a[84:87], a[16:19], v[240:243]
s_lshr_b32 s3, s2, 3
s_lshl_b32 s3, s3, 2
s_add_u32 s3, s3, s28
s_mul_i32 s3, s3, 41
v_mfma_f32_16x16x32_bf16 v[244:247], a[84:87], a[20:23], v[244:247]
ds_read_b64_tr_b16 a[126:127], v11 offset:17408
v_mfma_f32_16x16x32_bf16 v[248:251], a[84:87], a[24:27], v[248:251]
v_add_u32 v26, s3, v0
v_mfma_f32_16x16x32_bf16 v[252:255], a[84:87], a[28:31], v[252:255]
ds_read_b128 a[60:63], v13 offset:47104
v_mfma_f32_16x16x32_bf16 v[56:59], a[88:91], a[0:3], v[56:59]
s_mov_b32 s4, 7282
v_mfma_f32_16x16x32_bf16 v[60:63], a[88:91], a[4:7], v[60:63]
v_mul_u32_u24 v27, s4, v26
v_mfma_f32_16x16x32_bf16 v[88:91], a[88:91], a[8:11], v[88:91]
v_lshrrev_b32 v27, 16, v27
v_mfma_f32_16x16x32_bf16 v[92:95], a[88:91], a[12:15], v[92:95]
v_mul_u32_u24 v30, 9, v27
v_mfma_f32_16x16x32_bf16 v[120:123], a[88:91], a[16:19], v[120:123]
v_sub_u32 v30, v26, v30
v_mfma_f32_16x16x32_bf16 v[124:127], a[88:91], a[20:23], v[124:127]
s_mov_b32 s5, 0
s_and_b32 s6, s2, 7
s_mul_i32 s6, s6, 1152
v_mfma_f32_16x16x32_bf16 v[152:155], a[88:91], a[24:27], v[152:155]
v_add_u32 v27, s5, v27
v_mfma_f32_16x16x32_bf16 v[156:159], a[88:91], a[28:31], v[156:159]
v_mul_u32_u24 v27, 9216, v27
v_mfma_f32_16x16x32_bf16 a[128:131], a[92:95], a[0:3], a[128:131]
v_lshl_add_u32 v27, v30, 7, v27
v_mfma_f32_16x16x32_bf16 a[132:135], a[92:95], a[4:7], a[132:135]
v_add_u32 v27, s6, v27
v_mfma_f32_16x16x32_bf16 a[136:139], a[92:95], a[8:11], a[136:139]
v_mov_b32 v30, 0x10000000
v_mfma_f32_16x16x32_bf16 a[140:143], a[92:95], a[12:15], a[140:143]
v_cmp_gt_u32 vcc, 41, v0
v_mfma_f32_16x16x32_bf16 a[144:147], a[92:95], a[16:19], a[144:147]
s_mov_b32 s4, 5184
v_cmp_gt_u32 s[6:7], s4, v26
v_mfma_f32_16x16x32_bf16 a[148:151], a[92:95], a[20:23], a[148:151]
s_nop 1
s_and_b64 vcc, vcc, s[6:7]
v_mfma_f32_16x16x32_bf16 a[152:155], a[92:95], a[24:27], a[152:155]
s_nop 1
v_cndmask_b32 v27, v30, v27, vcc
v_mfma_f32_16x16x32_bf16 a[156:159], a[92:95], a[28:31], a[156:159]
buffer_load_dword v30, v27, s[40:43], 0 offen
s_waitcnt lgkmcnt(0)
s_waitcnt vmcnt(17)
v_mfma_f32_16x16x32_bf16 v[32:35], a[96:99], a[32:35], v[32:35]
s_barrier
v_mfma_f32_16x16x32_bf16 v[36:39], a[96:99], a[36:39], v[36:39]
ds_read_b64_tr_b16 a[64:65], v4 offset:32768
v_mfma_f32_16x16x32_bf16 v[64:67], a[96:99], a[40:43], v[64:67]
s_add_u32 m0, s33, 16384
v_mfma_f32_16x16x32_bf16 v[68:71], a[96:99], a[44:47], v[68:71]
ds_read_b64_tr_b16 a[66:67], v4 offset:33792
v_mfma_f32_16x16x32_bf16 v[96:99], a[96:99], a[48:51], v[96:99]
s_add_u32 s36, s32, 3407872
v_mfma_f32_16x16x32_bf16 v[100:103], a[96:99], a[52:55], v[100:103]
ds_read_b128 a[0:3], v14 offset:0
v_mfma_f32_16x16x32_bf16 v[128:131], a[96:99], a[56:59], v[128:131]
v_mfma_f32_16x16x32_bf16 v[132:135], a[96:99], a[60:63], v[132:135]
ds_read_b64_tr_b16 a[68:69], v5 offset:32768
v_mfma_f32_16x16x32_bf16 v[160:163], a[100:103], a[32:35], v[160:163]
buffer_load_dwordx4 v1, s[12:15], s36 offen offset:0 lds
v_mfma_f32_16x16x32_bf16 v[164:167], a[100:103], a[36:39], v[164:167]
ds_read_b64_tr_b16 a[70:71], v5 offset:33792
v_mfma_f32_16x16x32_bf16 v[168:171], a[100:103], a[40:43], v[168:171]
v_mfma_f32_16x16x32_bf16 v[172:175], a[100:103], a[44:47], v[172:175]
ds_read_b128 a[4:7], v14 offset:2048
v_mfma_f32_16x16x32_bf16 v[176:179], a[100:103], a[48:51], v[176:179]
s_add_u32 s36, s32, 3439616
v_mfma_f32_16x16x32_bf16 v[180:183], a[100:103], a[52:55], v[180:183]
ds_read_b64_tr_b16 a[72:73], v6 offset:32768
v_mfma_f32_16x16x32_bf16 v[184:187], a[100:103], a[56:59], v[184:187]
v_mfma_f32_16x16x32_bf16 v[188:191], a[100:103], a[60:63], v[188:191]
ds_read_b64_tr_b16 a[74:75], v6 offset:33792
v_mfma_f32_16x16x32_bf16 v[40:43], a[104:107], a[32:35], v[40:43]
buffer_load_dwordx4 v1, s[12:15], s36 offen offset:1024 lds
v_mfma_f32_16x16x32_bf16 v[44:47], a[104:107], a[36:39], v[44:47]
ds_read_b128 a[8:11], v14 offset:4096
v_mfma_f32_16x16x32_bf16 v[72:75], a[104:107], a[40:43], v[72:75]
v_mfma_f32_16x16x32_bf16 v[76:79], a[104:107], a[44:47], v[76:79]
ds_read_b64_tr_b16 a[76:77], v7 offset:32768
v_mfma_f32_16x16x32_bf16 v[104:107], a[104:107], a[48:51], v[104:107]
s_add_u32 m0, s33, 24576
v_mfma_f32_16x16x32_bf16 v[108:111], a[104:107], a[52:55], v[108:111]
ds_read_b64_tr_b16 a[78:79], v7 offset:33792
v_mfma_f32_16x16x32_bf16 v[136:139], a[104:107], a[56:59], v[136:139]
v_mfma_f32_16x16x32_bf16 v[140:143], a[104:107], a[60:63], v[140:143]
ds_read_b128 a[12:15], v14 offset:6144
v_mfma_f32_16x16x32_bf16 v[192:195], a[108:111], a[32:35], v[192:195]
s_add_u32 s36, s32, 3407872
v_mfma_f32_16x16x32_bf16 v[196:199], a[108:111], a[36:39], v[196:199]
ds_read_b64_tr_b16 a[80:81], v8 offset:32768
v_mfma_f32_16x16x32_bf16 v[200:203], a[108:111], a[40:43], v[200:203]
v_mfma_f32_16x16x32_bf16 v[204:207], a[108:111], a[44:47], v[204:207]
ds_read_b64_tr_b16 a[82:83], v8 offset:33792
v_mfma_f32_16x16x32_bf16 v[208:211], a[108:111], a[48:51], v[208:211]
buffer_load_dwordx4 v1, s[16:19], s36 offen offset:0 lds
v_mfma_f32_16x16x32_bf16 v[212:215], a[108:111], a[52:55], v[212:215]
ds_read_b128 a[16:19], v14 offset:8192
v_mfma_f32_16x16x32_bf16 v[216:219], a[108:111], a[56:59], v[216:219]
v_mfma_f32_16x16x32_bf16 v[220:223], a[108:111], a[60:63], v[220:223]
ds_read_b64_tr_b16 a[84:85], v9 offset:32768
v_mfma_f32_16x16x32_bf16 v[48:51], a[112:115], a[32:35], v[48:51]
s_add_u32 s36, s32, 3439616
v_mfma_f32_16x16x32_bf16 v[52:55], a[112:115], a[36:39], v[52:55]
ds_read_b64_tr_b16 a[86:87], v9 offset:33792
v_mfma_f32_16x16x32_bf16 v[80:83], a[112:115], a[40:43], v[80:83]
v_mfma_f32_16x16x32_bf16 v[84:87], a[112:115], a[44:47], v[84:87]
ds_read_b128 a[20:23], v14 offset:10240
v_mfma_f32_16x16x32_bf16 v[112:115], a[112:115], a[48:51], v[112:115]
buffer_load_dwordx4 v1, s[16:19], s36 offen offset:1024 lds
v_mfma_f32_16x16x32_bf16 v[116:119], a[112:115], a[52:55], v[116:119]
ds_read_b64_tr_b16 a[88:89], v10 offset:32768
v_mfma_f32_16x16x32_bf16 v[144:147], a[112:115], a[56:59], v[144:147]
v_mfma_f32_16x16x32_bf16 v[148:151], a[112:115], a[60:63], v[148:151]
ds_read_b64_tr_b16 a[90:91], v10 offset:33792
v_mfma_f32_16x16x32_bf16 v[224:227], a[116:119], a[32:35], v[224:227]
s_add_u32 m0, s35, 32768
v_mfma_f32_16x16x32_bf16 v[228:231], a[116:119], a[36:39], v[228:231]
ds_read_b128 a[24:27], v14 offset:12288
v_mfma_f32_16x16x32_bf16 v[232:235], a[116:119], a[40:43], v[232:235]
v_mfma_f32_16x16x32_bf16 v[236:239], a[116:119], a[44:47], v[236:239]
ds_read_b64_tr_b16 a[92:93], v11 offset:32768
v_mfma_f32_16x16x32_bf16 v[240:243], a[116:119], a[48:51], v[240:243]
s_add_u32 s37, s34, 896
v_mfma_f32_16x16x32_bf16 v[244:247], a[116:119], a[52:55], v[244:247]
ds_read_b64_tr_b16 a[94:95], v11 offset:33792
v_mfma_f32_16x16x32_bf16 v[248:251], a[116:119], a[56:59], v[248:251]
v_mfma_f32_16x16x32_bf16 v[252:255], a[116:119], a[60:63], v[252:255]
ds_read_b128 a[28:31], v14 offset:14336
v_mfma_f32_16x16x32_bf16 v[56:59], a[120:123], a[32:35], v[56:59]
buffer_load_dwordx4 v2, s[8:11], s37 offen offset:0 lds
v_mfma_f32_16x16x32_bf16 v[60:63], a[120:123], a[36:39], v[60:63]
v_mfma_f32_16x16x32_bf16 v[88:91], a[120:123], a[40:43], v[88:91]
s_add_u32 s37, s34, 8064
v_mfma_f32_16x16x32_bf16 v[92:95], a[120:123], a[44:47], v[92:95]
v_mfma_f32_16x16x32_bf16 v[120:123], a[120:123], a[48:51], v[120:123]
buffer_load_dwordx4 v3, s[8:11], s37 offen offset:1024 lds
v_mfma_f32_16x16x32_bf16 v[124:127], a[120:123], a[52:55], v[124:127]
v_mfma_f32_16x16x32_bf16 v[152:155], a[120:123], a[56:59], v[152:155]
s_add_u32 s37, s34, 15232
v_mfma_f32_16x16x32_bf16 v[156:159], a[120:123], a[60:63], v[156:159]
v_mfma_f32_16x16x32_bf16 a[128:131], a[124:127], a[32:35], a[128:131]
buffer_load_dwordx4 v2, s[8:11], s37 offen offset:2048 lds
v_mfma_f32_16x16x32_bf16 a[132:135], a[124:127], a[36:39], a[132:135]
v_mfma_f32_16x16x32_bf16 a[136:139], a[124:127], a[40:43], a[136:139]
s_add_u32 s37, s34, 22400
v_mfma_f32_16x16x32_bf16 a[140:143], a[124:127], a[44:47], a[140:143]
v_mfma_f32_16x16x32_bf16 a[144:147], a[124:127], a[48:51], a[144:147]
buffer_load_dwordx4 v3, s[8:11], s37 offen offset:3072 lds
v_mfma_f32_16x16x32_bf16 a[148:151], a[124:127], a[52:55], a[148:151]
v_mfma_f32_16x16x32_bf16 a[152:155], a[124:127], a[56:59], a[152:155]
v_lshlrev_b32 v23, 2, v0
buffer_load_dword v23, v23, s[64:67], 0 offen sc1
v_mfma_f32_16x16x32_bf16 a[156:159], a[124:127], a[60:63], a[156:159]
s_waitcnt lgkmcnt(0)
s_waitcnt vmcnt(22)
v_mfma_f32_16x16x32_bf16 v[32:35], a[64:67], a[0:3], v[32:35]
s_barrier
v_mfma_f32_16x16x32_bf16 v[36:39], a[64:67], a[4:7], v[36:39]
ds_read_b64_tr_b16 a[96:97], v4 offset:49152
v_mfma_f32_16x16x32_bf16 v[64:67], a[64:67], a[8:11], v[64:67]
s_add_u32 m0, s33, 32768
v_mfma_f32_16x16x32_bf16 v[68:71], a[64:67], a[12:15], v[68:71]
ds_read_b64_tr_b16 a[98:99], v4 offset:50176
v_mfma_f32_16x16x32_bf16 v[96:99], a[64:67], a[16:19], v[96:99]
s_add_u32 s36, s32, 3670016
v_mfma_f32_16x16x32_bf16 v[100:103], a[64:67], a[20:23], v[100:103]
ds_read_b128 a[32:35], v15 offset:0
v_mfma_f32_16x16x32_bf16 v[128:131], a[64:67], a[24:27], v[128:131]
v_mfma_f32_16x16x32_bf16 v[132:135], a[64:67], a[28:31], v[132:135]
ds_read_b64_tr_b16 a[100:101], v5 offset:49152
v_mfma_f32_16x16x32_bf16 v[160:163], a[68:71], a[0:3], v[160:163]
buffer_load_dwordx4 v1, s[12:15], s36 offen offset:0 lds
v_mfma_f32_16x16x32_bf16 v[164:167], a[68:71], a[4:7], v[164:167]
ds_read_b64_tr_b16 a[102:103], v5 offset:50176
v_mfma_f32_16x16x32_bf16 v[168:171], a[68:71], a[8:11], v[168:171]
v_mfma_f32_16x16x32_bf16 v[172:175], a[68:71], a[12:15], v[172:175]
ds_read_b128 a[36:39], v15 offset:2048
v_mfma_f32_16x16x32_bf16 v[176:179], a[68:71], a[16:19], v[176:179]
s_add_u32 s36, s32, 3701760
v_mfma_f32_16x16x32_bf16 v[180:183], a[68:71], a[20:23], v[180:183]
ds_read_b64_tr_b16 a[104:105], v6 offset:49152
v_mfma_f32_16x16x32_bf16 v[184:187], a[68:71], a[24:27], v[184:187]
v_mfma_f32_16x16x32_bf16 v[188:191], a[68:71], a[28:31], v[188:191]
ds_read_b64_tr_b16 a[106:107], v6 offset:50176
v_mfma_f32_16x16x32_bf16 v[40:43], a[72:75], a[0:3], v[40:43]
buffer_load_dwordx4 v1, s[12:15], s36 offen offset:1024 lds
v_mfma_f32_16x16x32_bf16 v[44:47], a[72:75], a[4:7], v[44:47]
ds_read_b128 a[40:43], v15 offset:4096
v_mfma_f32_16x16x32_bf16 v[72:75], a[72:75], a[8:11], v[72:75]
v_mfma_f32_16x16x32_bf16 v[76:79], a[72:75], a[12:15], v[76:79]
ds_read_b64_tr_b16 a[108:109], v7 offset:49152
v_mfma_f32_16x16x32_bf16 v[104:107], a[72:75], a[16:19], v[104:107]
s_add_u32 m0, s33, 40960
v_mfma_f32_16x16x32_bf16 v[108:111], a[72:75], a[20:23], v[108:111]
ds_read_b64_tr_b16 a[110:111], v7 offset:50176
v_mfma_f32_16x16x32_bf16 v[136:139], a[72:75], a[24:27], v[136:139]
v_mfma_f32_16x16x32_bf16 v[140:143], a[72:75], a[28:31], v[140:143]
ds_read_b128 a[44:47], v15 offset:6144
v_mfma_f32_16x16x32_bf16 v[192:195], a[76:79], a[0:3], v[192:195]
s_add_u32 s36, s32, 3670016
v_mfma_f32_16x16x32_bf16 v[196:199], a[76:79], a[4:7], v[196:199]
ds_read_b64_tr_b16 a[112:113], v8 offset:49152
v_mfma_f32_16x16x32_bf16 v[200:203], a[76:79], a[8:11], v[200:203]
v_mfma_f32_16x16x32_bf16 v[204:207], a[76:79], a[12:15], v[204:207]
ds_read_b64_tr_b16 a[114:115], v8 offset:50176
v_mfma_f32_16x16x32_bf16 v[208:211], a[76:79], a[16:19], v[208:211]
buffer_load_dwordx4 v1, s[16:19], s36 offen offset:0 lds
v_mfma_f32_16x16x32_bf16 v[212:215], a[76:79], a[20:23], v[212:215]
ds_read_b128 a[48:51], v15 offset:8192
v_mfma_f32_16x16x32_bf16 v[216:219], a[76:79], a[24:27], v[216:219]
v_mfma_f32_16x16x32_bf16 v[220:223], a[76:79], a[28:31], v[220:223]
ds_read_b64_tr_b16 a[116:117], v9 offset:49152
v_mfma_f32_16x16x32_bf16 v[48:51], a[80:83], a[0:3], v[48:51]
s_add_u32 s36, s32, 3701760
v_mfma_f32_16x16x32_bf16 v[52:55], a[80:83], a[4:7], v[52:55]
ds_read_b64_tr_b16 a[118:119], v9 offset:50176
v_mfma_f32_16x16x32_bf16 v[80:83], a[80:83], a[8:11], v[80:83]
v_mfma_f32_16x16x32_bf16 v[84:87], a[80:83], a[12:15], v[84:87]
ds_read_b128 a[52:55], v15 offset:10240
v_mfma_f32_16x16x32_bf16 v[112:115], a[80:83], a[16:19], v[112:115]
buffer_load_dwordx4 v1, s[16:19], s36 offen offset:1024 lds
v_mfma_f32_16x16x32_bf16 v[116:119], a[80:83], a[20:23], v[116:119]
ds_read_b64_tr_b16 a[120:121], v10 offset:49152
v_mfma_f32_16x16x32_bf16 v[144:147], a[80:83], a[24:27], v[144:147]
v_mfma_f32_16x16x32_bf16 v[148:151], a[80:83], a[28:31], v[148:151]
ds_read_b64_tr_b16 a[122:123], v10 offset:50176
v_mfma_f32_16x16x32_bf16 v[224:227], a[84:87], a[0:3], v[224:227]
s_add_u32 m0, s35, 36864
v_mfma_f32_16x16x32_bf16 v[228:231], a[84:87], a[4:7], v[228:231]
ds_read_b128 a[56:59], v15 offset:12288
v_mfma_f32_16x16x32_bf16 v[232:235], a[84:87], a[8:11], v[232:235]
v_mfma_f32_16x16x32_bf16 v[236:239], a[84:87], a[12:15], v[236:239]
ds_read_b64_tr_b16 a[124:125], v11 offset:49152
v_mfma_f32_16x16x32_bf16 v[240:243], a[84:87], a[16:19], v[240:243]
s_add_u32 s37, s34, 33664
v_mfma_f32_16x16x32_bf16 v[244:247], a[84:87], a[20:23], v[244:247]
ds_read_b64_tr_b16 a[126:127], v11 offset:50176
v_mfma_f32_16x16x32_bf16 v[248:251], a[84:87], a[24:27], v[248:251]
v_mfma_f32_16x16x32_bf16 v[252:255], a[84:87], a[28:31], v[252:255]
ds_read_b128 a[60:63], v15 offset:14336
v_mfma_f32_16x16x32_bf16 v[56:59], a[88:91], a[0:3], v[56:59]
buffer_load_dwordx4 v2, s[8:11], s37 offen offset:0 lds
v_mfma_f32_16x16x32_bf16 v[60:63], a[88:91], a[4:7], v[60:63]
v_mfma_f32_16x16x32_bf16 v[88:91], a[88:91], a[8:11], v[88:91]
s_add_u32 s37, s34, 40832
v_mfma_f32_16x16x32_bf16 v[92:95], a[88:91], a[12:15], v[92:95]
v_mfma_f32_16x16x32_bf16 v[120:123], a[88:91], a[16:19], v[120:123]
buffer_load_dwordx4 v3, s[8:11], s37 offen offset:1024 lds
v_mfma_f32_16x16x32_bf16 v[124:127], a[88:91], a[20:23], v[124:127]
v_mfma_f32_16x16x32_bf16 v[152:155], a[88:91], a[24:27], v[152:155]
s_add_u32 s37, s34, 48000
v_mfma_f32_16x16x32_bf16 v[156:159], a[88:91], a[28:31], v[156:159]
v_mfma_f32_16x16x32_bf16 a[128:131], a[92:95], a[0:3], a[128:131]
buffer_load_dwordx4 v2, s[8:11], s37 offen offset:2048 lds
v_mfma_f32_16x16x32_bf16 a[132:135], a[92:95], a[4:7], a[132:135]
v_mfma_f32_16x16x32_bf16 a[136:139], a[92:95], a[8:11], a[136:139]
s_add_u32 s37, s34, 55168
v_mfma_f32_16x16x32_bf16 a[140:143], a[92:95], a[12:15], a[140:143]
v_mfma_f32_16x16x32_bf16 a[144:147], a[92:95], a[16:19], a[144:147]
buffer_load_dwordx4 v3, s[8:11], s37 offen offset:3072 lds
v_mfma_f32_16x16x32_bf16 a[148:151], a[92:95], a[20:23], a[148:151]
v_mfma_f32_16x16x32_bf16 a[152:155], a[92:95], a[24:27], a[152:155]
s_getpc_b64 s[4:5]
parallel_sum__compressed_kv_cla__geglu_ffn__prompt_kernel_pc2:
s_add_u32 s4, s4, parallel_sum__compressed_kv_cla__geglu_ffn__prompt_kernel_q-parallel_sum__compressed_kv_cla__geglu_ffn__prompt_kernel_pc2
s_addc_u32 s5, s5, 0
s_lshr_b32 s3, s2, 3
s_lshl_b32 s3, s3, 2
s_add_u32 s3, s3, s28
s_mul_i32 s3, s3, 3
v_add_u32 v26, s3, v0
v_lshlrev_b32 v26, 7, v26
v_mov_b32 v27, parallel_sum__compressed_kv_cla__geglu_ffn__prompt_kernel_L_ge-parallel_sum__compressed_kv_cla__geglu_ffn__prompt_kernel_q
v_cmp_lt_u32 vcc, v26, v27
s_nop 1
v_cndmask_b32 v26, 0, v26, vcc
v_mov_b32 v27, s5
v_add_co_u32 v26, vcc, s4, v26
s_nop 1
v_addc_co_u32 v27, vcc, 0, v27, vcc
s_mov_b64 exec, 7
global_load_dword v29, v[26:27], off
s_mov_b64 exec, -1
v_mfma_f32_16x16x32_bf16 a[156:159], a[92:95], a[28:31], a[156:159]
s_waitcnt vmcnt(9)
v_subrev_u32 v24, 0x01010101, v23
v_not_b32 v25, v23
v_and_b32 v24, v24, v25
v_and_b32 v24, 0x80808080, v24
v_cmp_ne_u32 vcc, 0, v24
s_nop 4
s_cbranch_vccnz parallel_sum__compressed_kv_cla__geglu_ffn__prompt_kernel_spin1
parallel_sum__compressed_kv_cla__geglu_ffn__prompt_kernel_spin1_ret:
s_add_u32 s70, s101, 1
s_mov_b32 s97, 0
v_bfe_u32 v24, v23, 0, 8
v_cmp_eq_u32 vcc, s70, v24
s_nop 4
s_bcnt1_i32_b64 s71, vcc
s_add_u32 s97, s97, s71
v_bfe_u32 v24, v23, 8, 8
v_cmp_eq_u32 vcc, s70, v24
s_nop 4
s_bcnt1_i32_b64 s71, vcc
s_add_u32 s97, s97, s71
v_bfe_u32 v24, v23, 16, 8
v_cmp_eq_u32 vcc, s70, v24
s_nop 4
s_bcnt1_i32_b64 s71, vcc
s_add_u32 s97, s97, s71
v_bfe_u32 v24, v23, 24, 8
v_cmp_eq_u32 vcc, s70, v24
s_nop 4
s_bcnt1_i32_b64 s71, vcc
s_add_u32 s97, s97, s71
s_waitcnt lgkmcnt(0)
v_mfma_f32_16x16x32_bf16 v[32:35], a[96:99], a[32:35], v[32:35]
s_barrier
v_mfma_f32_16x16x32_bf16 v[36:39], a[96:99], a[36:39], v[36:39]
ds_read_b64_tr_b16 a[64:65], v4 offset:0
v_mfma_f32_16x16x32_bf16 v[64:67], a[96:99], a[40:43], v[64:67]
s_add_u32 m0, s33, 49152
v_mfma_f32_16x16x32_bf16 v[68:71], a[96:99], a[44:47], v[68:71]
ds_read_b64_tr_b16 a[66:67], v4 offset:1024
v_mfma_f32_16x16x32_bf16 v[96:99], a[96:99], a[48:51], v[96:99]
v_mfma_f32_16x16x32_bf16 v[100:103], a[96:99], a[52:55], v[100:103]
ds_read_b128 a[0:3], v12 offset:0
v_mfma_f32_16x16x32_bf16 v[128:131], a[96:99], a[56:59], v[128:131]
v_mfma_f32_16x16x32_bf16 v[132:135], a[96:99], a[60:63], v[132:135]
ds_read_b64_tr_b16 a[68:69], v5 offset:0
v_mfma_f32_16x16x32_bf16 v[160:163], a[100:103], a[32:35], v[160:163]
s_add_u32 s36, s32, 3932160
v_mfma_f32_16x16x32_bf16 v[164:167], a[100:103], a[36:39], v[164:167]
ds_read_b64_tr_b16 a[70:71], v5 offset:1024
v_mfma_f32_16x16x32_bf16 v[168:171], a[100:103], a[40:43], v[168:171]
v_mfma_f32_16x16x32_bf16 v[172:175], a[100:103], a[44:47], v[172:175]
ds_read_b128 a[4:7], v12 offset:2048
v_mfma_f32_16x16x32_bf16 v[176:179], a[100:103], a[48:51], v[176:179]
v_mfma_f32_16x16x32_bf16 v[180:183], a[100:103], a[52:55], v[180:183]
ds_read_b64_tr_b16 a[72:73], v6 offset:0
v_mfma_f32_16x16x32_bf16 v[184:187], a[100:103], a[56:59], v[184:187]
v_mfma_f32_16x16x32_bf16 v[188:191], a[100:103], a[60:63], v[188:191]
ds_read_b64_tr_b16 a[74:75], v6 offset:1024
v_mfma_f32_16x16x32_bf16 v[40:43], a[104:107], a[32:35], v[40:43]
buffer_load_dwordx4 v1, s[12:15], s36 offen offset:0 lds
v_mfma_f32_16x16x32_bf16 v[44:47], a[104:107], a[36:39], v[44:47]
ds_read_b128 a[8:11], v12 offset:4096
v_mfma_f32_16x16x32_bf16 v[72:75], a[104:107], a[40:43], v[72:75]
v_mfma_f32_16x16x32_bf16 v[76:79], a[104:107], a[44:47], v[76:79]
ds_read_b64_tr_b16 a[76:77], v7 offset:0
v_mfma_f32_16x16x32_bf16 v[104:107], a[104:107], a[48:51], v[104:107]
v_mfma_f32_16x16x32_bf16 v[108:111], a[104:107], a[52:55], v[108:111]
ds_read_b64_tr_b16 a[78:79], v7 offset:1024
v_mfma_f32_16x16x32_bf16 v[136:139], a[104:107], a[56:59], v[136:139]
s_add_u32 s36, s32, 3963904
v_mfma_f32_16x16x32_bf16 v[140:143], a[104:107], a[60:63], v[140:143]
ds_read_b128 a[12:15], v12 offset:6144
v_mfma_f32_16x16x32_bf16 v[192:195], a[108:111], a[32:35], v[192:195]
v_mfma_f32_16x16x32_bf16 v[196:199], a[108:111], a[36:39], v[196:199]
ds_read_b64_tr_b16 a[80:81], v8 offset:0
v_mfma_f32_16x16x32_bf16 v[200:203], a[108:111], a[40:43], v[200:203]
v_mfma_f32_16x16x32_bf16 v[204:207], a[108:111], a[44:47], v[204:207]
ds_read_b64_tr_b16 a[82:83], v8 offset:1024
v_mfma_f32_16x16x32_bf16 v[208:211], a[108:111], a[48:51], v[208:211]
v_mfma_f32_16x16x32_bf16 v[212:215], a[108:111], a[52:55], v[212:215]
ds_read_b128 a[16:19], v12 offset:8192
v_mfma_f32_16x16x32_bf16 v[216:219], a[108:111], a[56:59], v[216:219]
buffer_load_dwordx4 v1, s[12:15], s36 offen offset:1024 lds
v_mfma_f32_16x16x32_bf16 v[220:223], a[108:111], a[60:63], v[220:223]
ds_read_b64_tr_b16 a[84:85], v9 offset:0
v_mfma_f32_16x16x32_bf16 v[48:51], a[112:115], a[32:35], v[48:51]
v_mfma_f32_16x16x32_bf16 v[52:55], a[112:115], a[36:39], v[52:55]
ds_read_b64_tr_b16 a[86:87], v9 offset:1024
v_mfma_f32_16x16x32_bf16 v[80:83], a[112:115], a[40:43], v[80:83]
v_mfma_f32_16x16x32_bf16 v[84:87], a[112:115], a[44:47], v[84:87]
ds_read_b128 a[20:23], v12 offset:10240
v_mfma_f32_16x16x32_bf16 v[112:115], a[112:115], a[48:51], v[112:115]
s_add_u32 m0, s33, 57344
v_mfma_f32_16x16x32_bf16 v[116:119], a[112:115], a[52:55], v[116:119]
ds_read_b64_tr_b16 a[88:89], v10 offset:0
v_mfma_f32_16x16x32_bf16 v[144:147], a[112:115], a[56:59], v[144:147]
v_mfma_f32_16x16x32_bf16 v[148:151], a[112:115], a[60:63], v[148:151]
ds_read_b64_tr_b16 a[90:91], v10 offset:1024
v_mfma_f32_16x16x32_bf16 v[224:227], a[116:119], a[32:35], v[224:227]
v_mfma_f32_16x16x32_bf16 v[228:231], a[116:119], a[36:39], v[228:231]
ds_read_b128 a[24:27], v12 offset:12288
v_mfma_f32_16x16x32_bf16 v[232:235], a[116:119], a[40:43], v[232:235]
v_mfma_f32_16x16x32_bf16 v[236:239], a[116:119], a[44:47], v[236:239]
ds_read_b64_tr_b16 a[92:93], v11 offset:0
v_mfma_f32_16x16x32_bf16 v[240:243], a[116:119], a[48:51], v[240:243]
s_add_u32 s36, s32, 3932160
v_mfma_f32_16x16x32_bf16 v[244:247], a[116:119], a[52:55], v[244:247]
ds_read_b64_tr_b16 a[94:95], v11 offset:1024
v_mfma_f32_16x16x32_bf16 v[248:251], a[116:119], a[56:59], v[248:251]
v_mfma_f32_16x16x32_bf16 v[252:255], a[116:119], a[60:63], v[252:255]
ds_read_b128 a[28:31], v12 offset:14336
v_mfma_f32_16x16x32_bf16 v[56:59], a[120:123], a[32:35], v[56:59]
v_mfma_f32_16x16x32_bf16 v[60:63], a[120:123], a[36:39], v[60:63]
buffer_load_dwordx4 v1, s[16:19], s36 offen offset:0 lds
v_mfma_f32_16x16x32_bf16 v[88:91], a[120:123], a[40:43], v[88:91]
v_mfma_f32_16x16x32_bf16 v[92:95], a[120:123], a[44:47], v[92:95]
v_mfma_f32_16x16x32_bf16 v[120:123], a[120:123], a[48:51], v[120:123]
v_mfma_f32_16x16x32_bf16 v[124:127], a[120:123], a[52:55], v[124:127]
s_add_u32 s36, s32, 3963904
v_mfma_f32_16x16x32_bf16 v[152:155], a[120:123], a[56:59], v[152:155]
v_mfma_f32_16x16x32_bf16 v[156:159], a[120:123], a[60:63], v[156:159]
v_mfma_f32_16x16x32_bf16 a[128:131], a[124:127], a[32:35], a[128:131]
buffer_load_dwordx4 v1, s[16:19], s36 offen offset:1024 lds
v_mfma_f32_16x16x32_bf16 a[132:135], a[124:127], a[36:39], a[132:135]
v_mfma_f32_16x16x32_bf16 a[136:139], a[124:127], a[40:43], a[136:139]
v_mfma_f32_16x16x32_bf16 a[140:143], a[124:127], a[44:47], a[140:143]
v_mfma_f32_16x16x32_bf16 a[144:147], a[124:127], a[48:51], a[144:147]
s_mov_b32 s68, 113246208
v_lshlrev_b32 v20, 4, v0
buffer_load_dwordx4 v[20:23], v20, s[20:23], s68 offen sc1
v_mfma_f32_16x16x32_bf16 a[148:151], a[124:127], a[52:55], a[148:151]
v_mfma_f32_16x16x32_bf16 a[152:155], a[124:127], a[56:59], a[152:155]
v_mfma_f32_16x16x32_bf16 a[156:159], a[124:127], a[60:63], a[156:159]
s_waitcnt lgkmcnt(0)
v_mfma_f32_16x16x32_bf16 v[32:35], a[64:67], a[0:3], v[32:35]
s_barrier
v_mfma_f32_16x16x32_bf16 v[36:39], a[64:67], a[4:7], v[36:39]
ds_read_b64_tr_b16 a[96:97], v4 offset:16384
v_mfma_f32_16x16x32_bf16 v[64:67], a[64:67], a[8:11], v[64:67]
v_mfma_f32_16x16x32_bf16 v[68:71], a[64:67], a[12:15], v[68:71]
ds_read_b64_tr_b16 a[98:99], v4 offset:17408
v_mfma_f32_16x16x32_bf16 v[96:99], a[64:67], a[16:19], v[96:99]
s_mov_b32 s40, s86
s_mov_b32 s41, s87
s_mov_b32 s42, 5308416
s_mov_b32 s43, 0x20000
v_mfma_f32_16x16x32_bf16 v[100:103], a[64:67], a[20:23], v[100:103]
ds_read_b128 a[32:35], v13 offset:0
v_mfma_f32_16x16x32_bf16 v[128:131], a[64:67], a[24:27], v[128:131]
v_mfma_f32_16x16x32_bf16 v[132:135], a[64:67], a[28:31], v[132:135]
ds_read_b64_tr_b16 a[100:101], v5 offset:16384
v_mfma_f32_16x16x32_bf16 v[160:163], a[68:71], a[0:3], v[160:163]
s_lshr_b32 s3, s2, 3
s_lshl_b32 s3, s3, 2
s_add_u32 s3, s3, s28
s_mul_i32 s3, s3, 41
v_mfma_f32_16x16x32_bf16 v[164:167], a[68:71], a[4:7], v[164:167]
ds_read_b64_tr_b16 a[102:103], v5 offset:17408
v_mfma_f32_16x16x32_bf16 v[168:171], a[68:71], a[8:11], v[168:171]
v_mfma_f32_16x16x32_bf16 v[172:175], a[68:71], a[12:15], v[172:175]
ds_read_b128 a[36:39], v13 offset:2048
v_mfma_f32_16x16x32_bf16 v[176:179], a[68:71], a[16:19], v[176:179]
v_add_u32 v26, s3, v0
v_mfma_f32_16x16x32_bf16 v[180:183], a[68:71], a[20:23], v[180:183]
ds_read_b64_tr_b16 a[104:105], v6 offset:16384
v_mfma_f32_16x16x32_bf16 v[184:187], a[68:71], a[24:27], v[184:187]
v_mfma_f32_16x16x32_bf16 v[188:191], a[68:71], a[28:31], v[188:191]
ds_read_b64_tr_b16 a[106:107], v6 offset:17408
v_mfma_f32_16x16x32_bf16 v[40:43], a[72:75], a[0:3], v[40:43]
s_mov_b32 s4, 7282
v_mfma_f32_16x16x32_bf16 v[44:47], a[72:75], a[4:7], v[44:47]
ds_read_b128 a[40:43], v13 offset:4096
v_mfma_f32_16x16x32_bf16 v[72:75], a[72:75], a[8:11], v[72:75]
v_mfma_f32_16x16x32_bf16 v[76:79], a[72:75], a[12:15], v[76:79]
ds_read_b64_tr_b16 a[108:109], v7 offset:16384
v_mfma_f32_16x16x32_bf16 v[104:107], a[72:75], a[16:19], v[104:107]
v_mul_u32_u24 v27, s4, v26
v_mfma_f32_16x16x32_bf16 v[108:111], a[72:75], a[20:23], v[108:111]
ds_read_b64_tr_b16 a[110:111], v7 offset:17408
v_mfma_f32_16x16x32_bf16 v[136:139], a[72:75], a[24:27], v[136:139]
v_mfma_f32_16x16x32_bf16 v[140:143], a[72:75], a[28:31], v[140:143]
ds_read_b128 a[44:47], v13 offset:6144
v_mfma_f32_16x16x32_bf16 v[192:195], a[76:79], a[0:3], v[192:195]
v_lshrrev_b32 v27, 16, v27
v_mfma_f32_16x16x32_bf16 v[196:199], a[76:79], a[4:7], v[196:199]
ds_read_b64_tr_b16 a[112:113], v8 offset:16384
v_mfma_f32_16x16x32_bf16 v[200:203], a[76:79], a[8:11], v[200:203]
v_mfma_f32_16x16x32_bf16 v[204:207], a[76:79], a[12:15], v[204:207]
ds_read_b64_tr_b16 a[114:115], v8 offset:17408
v_mfma_f32_16x16x32_bf16 v[208:211], a[76:79], a[16:19], v[208:211]
v_mul_u32_u24 v28, 9, v27
v_mfma_f32_16x16x32_bf16 v[212:215], a[76:79], a[20:23], v[212:215]
ds_read_b128 a[48:51], v13 offset:8192
v_mfma_f32_16x16x32_bf16 v[216:219], a[76:79], a[24:27], v[216:219]
v_mfma_f32_16x16x32_bf16 v[220:223], a[76:79], a[28:31], v[220:223]
ds_read_b64_tr_b16 a[116:117], v9 offset:16384
v_mfma_f32_16x16x32_bf16 v[48:51], a[80:83], a[0:3], v[48:51]
v_sub_u32 v28, v26, v28
v_mfma_f32_16x16x32_bf16 v[52:55], a[80:83], a[4:7], v[52:55]
ds_read_b64_tr_b16 a[118:119], v9 offset:17408
v_mfma_f32_16x16x32_bf16 v[80:83], a[80:83], a[8:11], v[80:83]
v_mfma_f32_16x16x32_bf16 v[84:87], a[80:83], a[12:15], v[84:87]
ds_read_b128 a[52:55], v13 offset:10240
v_mfma_f32_16x16x32_bf16 v[112:115], a[80:83], a[16:19], v[112:115]
s_mov_b32 s5, 0
s_and_b32 s6, s2, 7
s_mul_i32 s6, s6, 1152
v_mfma_f32_16x16x32_bf16 v[116:119], a[80:83], a[20:23], v[116:119]
ds_read_b64_tr_b16 a[120:121], v10 offset:16384
v_mfma_f32_16x16x32_bf16 v[144:147], a[80:83], a[24:27], v[144:147]
v_mfma_f32_16x16x32_bf16 v[148:151], a[80:83], a[28:31], v[148:151]
ds_read_b64_tr_b16 a[122:123], v10 offset:17408
v_mfma_f32_16x16x32_bf16 v[224:227], a[84:87], a[0:3], v[224:227]
v_add_u32 v27, s5, v27
v_mfma_f32_16x16x32_bf16 v[228:231], a[84:87], a[4:7], v[228:231]
ds_read_b128 a[56:59], v13 offset:12288
v_mfma_f32_16x16x32_bf16 v[232:235], a[84:87], a[8:11], v[232:235]
v_mfma_f32_16x16x32_bf16 v[236:239], a[84:87], a[12:15], v[236:239]
ds_read_b64_tr_b16 a[124:125], v11 offset:16384
v_mfma_f32_16x16x32_bf16 v[240:243], a[84:87], a[16:19], v[240:243]
v_mul_u32_u24 v27, 9216, v27
v_mfma_f32_16x16x32_bf16 v[244:247], a[84:87], a[20:23], v[244:247]
ds_read_b64_tr_b16 a[126:127], v11 offset:17408
v_mfma_f32_16x16x32_bf16 v[248:251], a[84:87], a[24:27], v[248:251]
v_mfma_f32_16x16x32_bf16 v[252:255], a[84:87], a[28:31], v[252:255]
ds_read_b128 a[60:63], v13 offset:14336
v_mfma_f32_16x16x32_bf16 v[56:59], a[88:91], a[0:3], v[56:59]
v_lshl_add_u32 v27, v28, 7, v27
v_mfma_f32_16x16x32_bf16 v[60:63], a[88:91], a[4:7], v[60:63]
v_mfma_f32_16x16x32_bf16 v[88:91], a[88:91], a[8:11], v[88:91]
v_add_u32 v27, s6, v27
v_mfma_f32_16x16x32_bf16 v[92:95], a[88:91], a[12:15], v[92:95]
v_mfma_f32_16x16x32_bf16 v[120:123], a[88:91], a[16:19], v[120:123]
v_mov_b32 v28, 0x10000000
v_mfma_f32_16x16x32_bf16 v[124:127], a[88:91], a[20:23], v[124:127]
v_mfma_f32_16x16x32_bf16 v[152:155], a[88:91], a[24:27], v[152:155]
v_cmp_gt_u32 vcc, 41, v0
v_mfma_f32_16x16x32_bf16 v[156:159], a[88:91], a[28:31], v[156:159]
v_mfma_f32_16x16x32_bf16 a[128:131], a[92:95], a[0:3], a[128:131]
s_mov_b32 s4, 5184
v_cmp_gt_u32 s[6:7], s4, v26
v_mfma_f32_16x16x32_bf16 a[132:135], a[92:95], a[4:7], a[132:135]
v_mfma_f32_16x16x32_bf16 a[136:139], a[92:95], a[8:11], a[136:139]
s_nop 1
s_and_b64 vcc, vcc, s[6:7]
v_mfma_f32_16x16x32_bf16 a[140:143], a[92:95], a[12:15], a[140:143]
v_mfma_f32_16x16x32_bf16 a[144:147], a[92:95], a[16:19], a[144:147]
s_nop 1
v_cndmask_b32 v27, v28, v27, vcc
v_mfma_f32_16x16x32_bf16 a[148:151], a[92:95], a[20:23], a[148:151]
v_mfma_f32_16x16x32_bf16 a[152:155], a[92:95], a[24:27], a[152:155]
buffer_load_dword v28, v27, s[40:43], 0 offen
v_mfma_f32_16x16x32_bf16 a[156:159], a[92:95], a[28:31], a[156:159]
s_waitcnt vmcnt(1)
v_min_u32 v20, v20, v21
v_min3_u32 v20, v20, v22, v23
v_cmp_eq_u32 vcc, 0, v20
s_nop 4
s_cbranch_vccnz parallel_sum__compressed_kv_cla__geglu_ffn__prompt_kernel_spin2
parallel_sum__compressed_kv_cla__geglu_ffn__prompt_kernel_spin2_ret:
s_waitcnt lgkmcnt(0)
v_mfma_f32_16x16x32_bf16 v[32:35], a[96:99], a[32:35], v[32:35]
s_barrier
v_mfma_f32_16x16x32_bf16 v[36:39], a[96:99], a[36:39], v[36:39]
ds_read_b64_tr_b16 a[64:65], v4 offset:32768
v_mfma_f32_16x16x32_bf16 v[64:67], a[96:99], a[40:43], v[64:67]
v_mfma_f32_16x16x32_bf16 v[68:71], a[96:99], a[44:47], v[68:71]
ds_read_b64_tr_b16 a[66:67], v4 offset:33792
v_mfma_f32_16x16x32_bf16 v[96:99], a[96:99], a[48:51], v[96:99]
v_mfma_f32_16x16x32_bf16 v[100:103], a[96:99], a[52:55], v[100:103]
ds_read_b128 a[0:3], v12 offset:32768
v_mfma_f32_16x16x32_bf16 v[128:131], a[96:99], a[56:59], v[128:131]
v_mfma_f32_16x16x32_bf16 v[132:135], a[96:99], a[60:63], v[132:135]
ds_read_b64_tr_b16 a[68:69], v5 offset:32768
v_mfma_f32_16x16x32_bf16 v[160:163], a[100:103], a[32:35], v[160:163]
v_mfma_f32_16x16x32_bf16 v[164:167], a[100:103], a[36:39], v[164:167]
ds_read_b64_tr_b16 a[70:71], v5 offset:33792
v_mfma_f32_16x16x32_bf16 v[168:171], a[100:103], a[40:43], v[168:171]
v_mfma_f32_16x16x32_bf16 v[172:175], a[100:103], a[44:47], v[172:175]
ds_read_b128 a[4:7], v12 offset:34816
v_mfma_f32_16x16x32_bf16 v[176:179], a[100:103], a[48:51], v[176:179]
v_mfma_f32_16x16x32_bf16 v[180:183], a[100:103], a[52:55], v[180:183]
ds_read_b64_tr_b16 a[72:73], v6 offset:32768
v_mfma_f32_16x16x32_bf16 v[184:187], a[100:103], a[56:59], v[184:187]
v_mfma_f32_16x16x32_bf16 v[188:191], a[100:103], a[60:63], v[188:191]
ds_read_b64_tr_b16 a[74:75], v6 offset:33792
v_mfma_f32_16x16x32_bf16 v[40:43], a[104:107], a[32:35], v[40:43]
v_mfma_f32_16x16x32_bf16 v[44:47], a[104:107], a[36:39], v[44:47]
ds_read_b128 a[8:11], v12 offset:36864
v_mfma_f32_16x16x32_bf16 v[72:75], a[104:107], a[40:43], v[72:75]
v_mfma_f32_16x16x32_bf16 v[76:79], a[104:107], a[44:47], v[76:79]
ds_read_b64_tr_b16 a[76:77], v7 offset:32768
v_mfma_f32_16x16x32_bf16 v[104:107], a[104:107], a[48:51], v[104:107]
v_mfma_f32_16x16x32_bf16 v[108:111], a[104:107], a[52:55], v[108:111]
ds_read_b64_tr_b16 a[78:79], v7 offset:33792
v_mfma_f32_16x16x32_bf16 v[136:139], a[104:107], a[56:59], v[136:139]
v_mfma_f32_16x16x32_bf16 v[140:143], a[104:107], a[60:63], v[140:143]
ds_read_b128 a[12:15], v12 offset:38912
v_mfma_f32_16x16x32_bf16 v[192:195], a[108:111], a[32:35], v[192:195]
v_mfma_f32_16x16x32_bf16 v[196:199], a[108:111], a[36:39], v[196:199]
ds_read_b64_tr_b16 a[80:81], v8 offset:32768
v_mfma_f32_16x16x32_bf16 v[200:203], a[108:111], a[40:43], v[200:203]
v_mfma_f32_16x16x32_bf16 v[204:207], a[108:111], a[44:47], v[204:207]
ds_read_b64_tr_b16 a[82:83], v8 offset:33792
v_mfma_f32_16x16x32_bf16 v[208:211], a[108:111], a[48:51], v[208:211]
v_mfma_f32_16x16x32_bf16 v[212:215], a[108:111], a[52:55], v[212:215]
ds_read_b128 a[16:19], v12 offset:40960
v_mfma_f32_16x16x32_bf16 v[216:219], a[108:111], a[56:59], v[216:219]
v_mfma_f32_16x16x32_bf16 v[220:223], a[108:111], a[60:63], v[220:223]
ds_read_b64_tr_b16 a[84:85], v9 offset:32768
v_mfma_f32_16x16x32_bf16 v[48:51], a[112:115], a[32:35], v[48:51]
v_mfma_f32_16x16x32_bf16 v[52:55], a[112:115], a[36:39], v[52:55]
ds_read_b64_tr_b16 a[86:87], v9 offset:33792
v_mfma_f32_16x16x32_bf16 v[80:83], a[112:115], a[40:43], v[80:83]
v_mfma_f32_16x16x32_bf16 v[84:87], a[112:115], a[44:47], v[84:87]
ds_read_b128 a[20:23], v12 offset:43008
v_mfma_f32_16x16x32_bf16 v[112:115], a[112:115], a[48:51], v[112:115]
v_mfma_f32_16x16x32_bf16 v[116:119], a[112:115], a[52:55], v[116:119]
ds_read_b64_tr_b16 a[88:89], v10 offset:32768
v_mfma_f32_16x16x32_bf16 v[144:147], a[112:115], a[56:59], v[144:147]
v_mfma_f32_16x16x32_bf16 v[148:151], a[112:115], a[60:63], v[148:151]
ds_read_b64_tr_b16 a[90:91], v10 offset:33792
v_mfma_f32_16x16x32_bf16 v[224:227], a[116:119], a[32:35], v[224:227]
v_mfma_f32_16x16x32_bf16 v[228:231], a[116:119], a[36:39], v[228:231]
ds_read_b128 a[24:27], v12 offset:45056
v_mfma_f32_16x16x32_bf16 v[232:235], a[116:119], a[40:43], v[232:235]
v_mfma_f32_16x16x32_bf16 v[236:239], a[116:119], a[44:47], v[236:239]
ds_read_b64_tr_b16 a[92:93], v11 offset:32768
v_mfma_f32_16x16x32_bf16 v[240:243], a[116:119], a[48:51], v[240:243]
v_mfma_f32_16x16x32_bf16 v[244:247], a[116:119], a[52:55], v[244:247]
ds_read_b64_tr_b16 a[94:95], v11 offset:33792
v_mfma_f32_16x16x32_bf16 v[248:251], a[116:119], a[56:59], v[248:251]
v_mfma_f32_16x16x32_bf16 v[252:255], a[116:119], a[60:63], v[252:255]
ds_read_b128 a[28:31], v12 offset:47104
v_mfma_f32_16x16x32_bf16 v[56:59], a[120:123], a[32:35], v[56:59]
v_mfma_f32_16x16x32_bf16 v[60:63], a[120:123], a[36:39], v[60:63]
v_mfma_f32_16x16x32_bf16 v[88:91], a[120:123], a[40:43], v[88:91]
v_mfma_f32_16x16x32_bf16 v[92:95], a[120:123], a[44:47], v[92:95]
v_mfma_f32_16x16x32_bf16 v[120:123], a[120:123], a[48:51], v[120:123]
v_mfma_f32_16x16x32_bf16 v[124:127], a[120:123], a[52:55], v[124:127]
v_mfma_f32_16x16x32_bf16 v[152:155], a[120:123], a[56:59], v[152:155]
v_mfma_f32_16x16x32_bf16 v[156:159], a[120:123], a[60:63], v[156:159]
v_mfma_f32_16x16x32_bf16 a[128:131], a[124:127], a[32:35], a[128:131]
v_mfma_f32_16x16x32_bf16 a[132:135], a[124:127], a[36:39], a[132:135]
v_mfma_f32_16x16x32_bf16 a[136:139], a[124:127], a[40:43], a[136:139]
v_mfma_f32_16x16x32_bf16 a[140:143], a[124:127], a[44:47], a[140:143]
v_mfma_f32_16x16x32_bf16 a[144:147], a[124:127], a[48:51], a[144:147]
v_mfma_f32_16x16x32_bf16 a[148:151], a[124:127], a[52:55], a[148:151]
v_mfma_f32_16x16x32_bf16 a[152:155], a[124:127], a[56:59], a[152:155]
v_mfma_f32_16x16x32_bf16 a[156:159], a[124:127], a[60:63], a[156:159]
s_waitcnt lgkmcnt(0)
v_mfma_f32_16x16x32_bf16 v[32:35], a[64:67], a[0:3], v[32:35]
s_barrier
v_mfma_f32_16x16x32_bf16 v[36:39], a[64:67], a[4:7], v[36:39]
ds_read_b64_tr_b16 a[96:97], v4 offset:49152
v_mfma_f32_16x16x32_bf16 v[64:67], a[64:67], a[8:11], v[64:67]
v_mfma_f32_16x16x32_bf16 v[68:71], a[64:67], a[12:15], v[68:71]
ds_read_b64_tr_b16 a[98:99], v4 offset:50176
v_mfma_f32_16x16x32_bf16 v[96:99], a[64:67], a[16:19], v[96:99]
v_mfma_f32_16x16x32_bf16 v[100:103], a[64:67], a[20:23], v[100:103]
ds_read_b128 a[32:35], v13 offset:32768
v_mfma_f32_16x16x32_bf16 v[128:131], a[64:67], a[24:27], v[128:131]
v_mfma_f32_16x16x32_bf16 v[132:135], a[64:67], a[28:31], v[132:135]
ds_read_b64_tr_b16 a[100:101], v5 offset:49152
v_mfma_f32_16x16x32_bf16 v[160:163], a[68:71], a[0:3], v[160:163]
v_mfma_f32_16x16x32_bf16 v[164:167], a[68:71], a[4:7], v[164:167]
ds_read_b64_tr_b16 a[102:103], v5 offset:50176
v_mfma_f32_16x16x32_bf16 v[168:171], a[68:71], a[8:11], v[168:171]
v_mfma_f32_16x16x32_bf16 v[172:175], a[68:71], a[12:15], v[172:175]
ds_read_b128 a[36:39], v13 offset:34816
v_mfma_f32_16x16x32_bf16 v[176:179], a[68:71], a[16:19], v[176:179]
v_mfma_f32_16x16x32_bf16 v[180:183], a[68:71], a[20:23], v[180:183]
ds_read_b64_tr_b16 a[104:105], v6 offset:49152
v_mfma_f32_16x16x32_bf16 v[184:187], a[68:71], a[24:27], v[184:187]
v_mfma_f32_16x16x32_bf16 v[188:191], a[68:71], a[28:31], v[188:191]
ds_read_b64_tr_b16 a[106:107], v6 offset:50176
v_mfma_f32_16x16x32_bf16 v[40:43], a[72:75], a[0:3], v[40:43]
v_mfma_f32_16x16x32_bf16 v[44:47], a[72:75], a[4:7], v[44:47]
ds_read_b128 a[40:43], v13 offset:36864
v_mfma_f32_16x16x32_bf16 v[72:75], a[72:75], a[8:11], v[72:75]
v_mfma_f32_16x16x32_bf16 v[76:79], a[72:75], a[12:15], v[76:79]
ds_read_b64_tr_b16 a[108:109], v7 offset:49152
v_mfma_f32_16x16x32_bf16 v[104:107], a[72:75], a[16:19], v[104:107]
v_mfma_f32_16x16x32_bf16 v[108:111], a[72:75], a[20:23], v[108:111]
ds_read_b64_tr_b16 a[110:111], v7 offset:50176
v_mfma_f32_16x16x32_bf16 v[136:139], a[72:75], a[24:27], v[136:139]
v_mfma_f32_16x16x32_bf16 v[140:143], a[72:75], a[28:31], v[140:143]
ds_read_b128 a[44:47], v13 offset:38912
v_mfma_f32_16x16x32_bf16 v[192:195], a[76:79], a[0:3], v[192:195]
v_mfma_f32_16x16x32_bf16 v[196:199], a[76:79], a[4:7], v[196:199]
ds_read_b64_tr_b16 a[112:113], v8 offset:49152
v_mfma_f32_16x16x32_bf16 v[200:203], a[76:79], a[8:11], v[200:203]
v_mfma_f32_16x16x32_bf16 v[204:207], a[76:79], a[12:15], v[204:207]
ds_read_b64_tr_b16 a[114:115], v8 offset:50176
v_mfma_f32_16x16x32_bf16 v[208:211], a[76:79], a[16:19], v[208:211]
v_mfma_f32_16x16x32_bf16 v[212:215], a[76:79], a[20:23], v[212:215]
ds_read_b128 a[48:51], v13 offset:40960
v_mfma_f32_16x16x32_bf16 v[216:219], a[76:79], a[24:27], v[216:219]
v_mfma_f32_16x16x32_bf16 v[220:223], a[76:79], a[28:31], v[220:223]
ds_read_b64_tr_b16 a[116:117], v9 offset:49152
v_mfma_f32_16x16x32_bf16 v[48:51], a[80:83], a[0:3], v[48:51]
v_mfma_f32_16x16x32_bf16 v[52:55], a[80:83], a[4:7], v[52:55]
ds_read_b64_tr_b16 a[118:119], v9 offset:50176
v_mfma_f32_16x16x32_bf16 v[80:83], a[80:83], a[8:11], v[80:83]
v_mfma_f32_16x16x32_bf16 v[84:87], a[80:83], a[12:15], v[84:87]
ds_read_b128 a[52:55], v13 offset:43008
v_mfma_f32_16x16x32_bf16 v[112:115], a[80:83], a[16:19], v[112:115]
v_mfma_f32_16x16x32_bf16 v[116:119], a[80:83], a[20:23], v[116:119]
ds_read_b64_tr_b16 a[120:121], v10 offset:49152
v_mfma_f32_16x16x32_bf16 v[144:147], a[80:83], a[24:27], v[144:147]
v_mfma_f32_16x16x32_bf16 v[148:151], a[80:83], a[28:31], v[148:151]
ds_read_b64_tr_b16 a[122:123], v10 offset:50176
v_mfma_f32_16x16x32_bf16 v[224:227], a[84:87], a[0:3], v[224:227]
v_mfma_f32_16x16x32_bf16 v[228:231], a[84:87], a[4:7], v[228:231]
ds_read_b128 a[56:59], v13 offset:45056
v_mfma_f32_16x16x32_bf16 v[232:235], a[84:87], a[8:11], v[232:235]
v_mfma_f32_16x16x32_bf16 v[236:239], a[84:87], a[12:15], v[236:239]
ds_read_b64_tr_b16 a[124:125], v11 offset:49152
v_mfma_f32_16x16x32_bf16 v[240:243], a[84:87], a[16:19], v[240:243]
v_mfma_f32_16x16x32_bf16 v[244:247], a[84:87], a[20:23], v[244:247]
ds_read_b64_tr_b16 a[126:127], v11 offset:50176
v_mfma_f32_16x16x32_bf16 v[248:251], a[84:87], a[24:27], v[248:251]
v_mfma_f32_16x16x32_bf16 v[252:255], a[84:87], a[28:31], v[252:255]
ds_read_b128 a[60:63], v13 offset:47104
v_mfma_f32_16x16x32_bf16 v[56:59], a[88:91], a[0:3], v[56:59]
v_mfma_f32_16x16x32_bf16 v[60:63], a[88:91], a[4:7], v[60:63]
v_mfma_f32_16x16x32_bf16 v[88:91], a[88:91], a[8:11], v[88:91]
v_mfma_f32_16x16x32_bf16 v[92:95], a[88:91], a[12:15], v[92:95]
v_mfma_f32_16x16x32_bf16 v[120:123], a[88:91], a[16:19], v[120:123]
v_mfma_f32_16x16x32_bf16 v[124:127], a[88:91], a[20:23], v[124:127]
v_mfma_f32_16x16x32_bf16 v[152:155], a[88:91], a[24:27], v[152:155]
v_mfma_f32_16x16x32_bf16 v[156:159], a[88:91], a[28:31], v[156:159]
v_mfma_f32_16x16x32_bf16 a[128:131], a[92:95], a[0:3], a[128:131]
v_mfma_f32_16x16x32_bf16 a[132:135], a[92:95], a[4:7], a[132:135]
v_mfma_f32_16x16x32_bf16 a[136:139], a[92:95], a[8:11], a[136:139]
v_mfma_f32_16x16x32_bf16 a[140:143], a[92:95], a[12:15], a[140:143]
v_mfma_f32_16x16x32_bf16 a[144:147], a[92:95], a[16:19], a[144:147]
v_mfma_f32_16x16x32_bf16 a[148:151], a[92:95], a[20:23], a[148:151]
v_mfma_f32_16x16x32_bf16 a[152:155], a[92:95], a[24:27], a[152:155]
v_mfma_f32_16x16x32_bf16 a[156:159], a[92:95], a[28:31], a[156:159]
s_waitcnt lgkmcnt(0)
v_mfma_f32_16x16x32_bf16 v[32:35], a[96:99], a[32:35], v[32:35]
s_barrier
v_mfma_f32_16x16x32_bf16 v[36:39], a[96:99], a[36:39], v[36:39]
s_mov_b32 s8, s76
s_mov_b32 s9, s77
v_mfma_f32_16x16x32_bf16 v[64:67], a[96:99], a[40:43], v[64:67]
s_mov_b32 s10, 4718592
s_mov_b32 s11, 0x20000
v_mfma_f32_16x16x32_bf16 v[68:71], a[96:99], a[44:47], v[68:71]
v_lshrrev_b32 v1, 4, v0
v_mfma_f32_16x16x32_bf16 v[96:99], a[96:99], a[48:51], v[96:99]
v_and_b32 v3, 15, v0
s_lshl_b32 s3, s28, 3
v_mfma_f32_16x16x32_bf16 v[100:103], a[96:99], a[52:55], v[100:103]
v_add_u32 v2, 0, v1
v_mfma_f32_16x16x32_bf16 v[128:131], a[96:99], a[56:59], v[128:131]
v_lshlrev_b32 v5, 1, v2
v_xor_b32 v5, v5, v3
v_mfma_f32_16x16x32_bf16 v[132:135], a[96:99], a[60:63], v[132:135]
v_lshlrev_b32 v5, 4, v5
v_mfma_f32_16x16x32_bf16 v[160:163], a[100:103], a[32:35], v[160:163]
v_add_u32 v2, s3, v2
v_lshl_add_u32 v16, v2, 13, v5
v_mfma_f32_16x16x32_bf16 v[164:167], a[100:103], a[36:39], v[164:167]
v_add_u32 v2, 4, v1
v_lshlrev_b32 v5, 1, v2
v_mfma_f32_16x16x32_bf16 v[168:171], a[100:103], a[40:43], v[168:171]
v_xor_b32 v5, v5, v3
v_mfma_f32_16x16x32_bf16 v[172:175], a[100:103], a[44:47], v[172:175]
v_lshlrev_b32 v5, 4, v5
v_add_u32 v2, s3, v2
v_mfma_f32_16x16x32_bf16 v[176:179], a[100:103], a[48:51], v[176:179]
v_lshl_add_u32 v17, v2, 13, v5
v_mfma_f32_16x16x32_bf16 v[180:183], a[100:103], a[52:55], v[180:183]
v_subrev_u32 v17, 1024, v17
s_lshl_b32 s40, s29, 8
v_mfma_f32_16x16x32_bf16 v[184:187], a[100:103], a[56:59], v[184:187]
s_lshl_b32 s3, s28, 11
v_mfma_f32_16x16x32_bf16 v[188:191], a[100:103], a[60:63], v[188:191]
s_add_u32 s41, s3, 98304
v_and_b32 v2, 15, v0
v_mfma_f32_16x16x32_bf16 v[40:43], a[104:107], a[32:35], v[40:43]
v_lshrrev_b32 v3, 2, v2
v_and_b32 v5, 1, v1
v_mfma_f32_16x16x32_bf16 v[44:47], a[104:107], a[36:39], v[44:47]
v_lshl_add_u32 v5, v5, 2, v3
v_mfma_f32_16x16x32_bf16 v[72:75], a[104:107], a[40:43], v[72:75]
v_lshl_add_u32 v3, v1, 2, v3
v_lshlrev_b32 v3, 8, v3
v_mfma_f32_16x16x32_bf16 v[76:79], a[104:107], a[44:47], v[76:79]
v_and_b32 v2, 3, v2
v_mfma_f32_16x16x32_bf16 v[104:107], a[104:107], a[48:51], v[104:107]
v_lshl_add_u32 v3, v2, 3, v3
v_add_u32 v3, 98304, v3
v_mfma_f32_16x16x32_bf16 v[108:111], a[104:107], a[52:55], v[108:111]
v_xor_b32 v2, 0, v5
v_mfma_f32_16x16x32_bf16 v[136:139], a[104:107], a[56:59], v[136:139]
v_lshl_add_u32 v18, v2, 5, v3
v_xor_b32 v2, 1, v5
v_mfma_f32_16x16x32_bf16 v[140:143], a[104:107], a[60:63], v[140:143]
v_lshl_add_u32 v19, v2, 5, v3
v_xor_b32 v2, 2, v5
v_mfma_f32_16x16x32_bf16 v[192:195], a[108:111], a[32:35], v[192:195]
v_lshl_add_u32 v20, v2, 5, v3
v_mfma_f32_16x16x32_bf16 v[196:199], a[108:111], a[36:39], v[196:199]
v_xor_b32 v2, 3, v5
v_lshl_add_u32 v21, v2, 5, v3
v_mfma_f32_16x16x32_bf16 v[200:203], a[108:111], a[40:43], v[200:203]
v_xor_b32 v2, 4, v5
v_mfma_f32_16x16x32_bf16 v[204:207], a[108:111], a[44:47], v[204:207]
v_lshl_add_u32 v22, v2, 5, v3
v_xor_b32 v2, 5, v5
v_mfma_f32_16x16x32_bf16 v[208:211], a[108:111], a[48:51], v[208:211]
v_lshl_add_u32 v23, v2, 5, v3
v_mfma_f32_16x16x32_bf16 v[212:215], a[108:111], a[52:55], v[212:215]
v_xor_b32 v2, 6, v5
v_lshl_add_u32 v24, v2, 5, v3
v_mfma_f32_16x16x32_bf16 v[216:219], a[108:111], a[56:59], v[216:219]
v_xor_b32 v2, 7, v5
v_lshl_add_u32 v25, v2, 5, v3
v_mfma_f32_16x16x32_bf16 v[220:223], a[108:111], a[60:63], v[220:223]
v_lshlrev_b32 v26, 4, v0
v_mfma_f32_16x16x32_bf16 v[48:51], a[112:115], a[32:35], v[48:51]
v_add_u32 v27, 18432, v26
s_lshl_b32 s3, s30, 3
v_mfma_f32_16x16x32_bf16 v[52:55], a[112:115], a[36:39], v[52:55]
s_lshl_b32 s4, s28, 1
v_mfma_f32_16x16x32_bf16 v[80:83], a[112:115], a[40:43], v[80:83]
s_add_u32 s5, s3, s4
s_mul_i32 s42, s5, 18432
v_mfma_f32_16x16x32_bf16 v[84:87], a[112:115], a[44:47], v[84:87]
s_sub_u32 s6, 120, s3
v_mfma_f32_16x16x32_bf16 v[112:115], a[112:115], a[48:51], v[112:115]
s_add_u32 s6, s6, s4
s_mul_i32 s43, s6, 18432
v_mfma_f32_16x16x32_bf16 v[116:119], a[112:115], a[52:55], v[116:119]
s_add_u32 m0, s41, 0
s_add_u32 s44, s40, 0
v_mfma_f32_16x16x32_bf16 v[144:147], a[112:115], a[56:59], v[144:147]
buffer_load_dwordx4 v16, s[8:11], s44 offen offset:0 lds
v_mfma_f32_16x16x32_bf16 v[148:151], a[112:115], a[60:63], v[148:151]
buffer_load_dwordx4 v17, s[8:11], s44 offen offset:1024 lds
s_add_u32 s45, s42, 0
v_mfma_f32_16x16x32_bf16 v[224:227], a[116:119], a[32:35], v[224:227]
buffer_load_dwordx4 a[160:163], v26, s[20:23], s45 offen sc1
v_mfma_f32_16x16x32_bf16 v[228:231], a[116:119], a[36:39], v[228:231]
buffer_load_dwordx4 a[164:167], v27, s[20:23], s45 offen sc1
s_add_u32 s45, s43, 0
v_mfma_f32_16x16x32_bf16 v[232:235], a[116:119], a[40:43], v[232:235]
buffer_load_dwordx4 a[168:171], v26, s[20:23], s45 offen sc1
v_mfma_f32_16x16x32_bf16 v[236:239], a[116:119], a[44:47], v[236:239]
buffer_load_dwordx4 a[172:175], v27, s[20:23], s45 offen sc1
s_add_u32 m0, s41, 8192
v_mfma_f32_16x16x32_bf16 v[240:243], a[116:119], a[48:51], v[240:243]
s_add_u32 s44, s40, 262144
buffer_load_dwordx4 v16, s[8:11], s44 offen offset:0 lds
v_mfma_f32_16x16x32_bf16 v[244:247], a[116:119], a[52:55], v[244:247]
buffer_load_dwordx4 v17, s[8:11], s44 offen offset:1024 lds
v_mfma_f32_16x16x32_bf16 v[248:251], a[116:119], a[56:59], v[248:251]
s_add_u32 m0, s41, 16384
s_add_u32 s44, s40, 524288
v_mfma_f32_16x16x32_bf16 v[252:255], a[116:119], a[60:63], v[252:255]
buffer_load_dwordx4 v16, s[8:11], s44 offen offset:0 lds
v_mfma_f32_16x16x32_bf16 v[56:59], a[120:123], a[32:35], v[56:59]
buffer_load_dwordx4 v17, s[8:11], s44 offen offset:1024 lds
s_add_u32 s45, s42, 1024
v_mfma_f32_16x16x32_bf16 v[60:63], a[120:123], a[36:39], v[60:63]
buffer_load_dwordx4 a[176:179], v26, s[20:23], s45 offen sc1
v_mfma_f32_16x16x32_bf16 v[88:91], a[120:123], a[40:43], v[88:91]
buffer_load_dwordx4 a[180:183], v27, s[20:23], s45 offen sc1
s_add_u32 s45, s43, 1024
v_mfma_f32_16x16x32_bf16 v[92:95], a[120:123], a[44:47], v[92:95]
buffer_load_dwordx4 a[184:187], v26, s[20:23], s45 offen sc1
buffer_load_dwordx4 a[188:191], v27, s[20:23], s45 offen sc1
v_mfma_f32_16x16x32_bf16 v[120:123], a[120:123], a[48:51], v[120:123]
s_add_u32 s45, s42, 2048
v_mfma_f32_16x16x32_bf16 v[124:127], a[120:123], a[52:55], v[124:127]
buffer_load_dwordx4 a[192:195], v26, s[20:23], s45 offen sc1
buffer_load_dwordx4 a[196:199], v27, s[20:23], s45 offen sc1
v_mfma_f32_16x16x32_bf16 v[152:155], a[120:123], a[56:59], v[152:155]
s_add_u32 s45, s43, 2048
v_mfma_f32_16x16x32_bf16 v[156:159], a[120:123], a[60:63], v[156:159]
buffer_load_dwordx4 a[200:203], v26, s[20:23], s45 offen sc1
buffer_load_dwordx4 a[204:207], v27, s[20:23], s45 offen sc1
v_mfma_f32_16x16x32_bf16 a[128:131], a[124:127], a[32:35], a[128:131]
s_add_u32 s45, s42, 3072
v_mfma_f32_16x16x32_bf16 a[132:135], a[124:127], a[36:39], a[132:135]
buffer_load_dwordx4 a[208:211], v26, s[20:23], s45 offen sc1
buffer_load_dwordx4 a[212:215], v27, s[20:23], s45 offen sc1
v_mfma_f32_16x16x32_bf16 a[136:139], a[124:127], a[40:43], a[136:139]
s_add_u32 s45, s43, 3072
buffer_load_dwordx4 a[216:219], v26, s[20:23], s45 offen sc1
v_mfma_f32_16x16x32_bf16 a[140:143], a[124:127], a[44:47], a[140:143]
buffer_load_dwordx4 a[220:223], v27, s[20:23], s45 offen sc1
v_mfma_f32_16x16x32_bf16 a[144:147], a[124:127], a[48:51], a[144:147]
s_add_u32 s45, s42, 4096
buffer_load_dwordx4 a[224:227], v26, s[20:23], s45 offen sc1
v_mfma_f32_16x16x32_bf16 a[148:151], a[124:127], a[52:55], a[148:151]
buffer_load_dwordx4 a[228:231], v27, s[20:23], s45 offen sc1
v_mfma_f32_16x16x32_bf16 a[152:155], a[124:127], a[56:59], a[152:155]
s_add_u32 s45, s43, 4096
buffer_load_dwordx4 a[232:235], v26, s[20:23], s45 offen sc1
v_mfma_f32_16x16x32_bf16 a[156:159], a[124:127], a[60:63], a[156:159]
buffer_load_dwordx4 a[236:239], v27, s[20:23], s45 offen sc1
v_cvt_pk_bf16_f32 v32, v32, v33
v_cvt_pk_bf16_f32 v33, v34, v35
v_cvt_pk_bf16_f32 v34, v160, v161
v_cvt_pk_bf16_f32 v35, v162, v163
v_cvt_pk_bf16_f32 v36, v36, v37
v_cvt_pk_bf16_f32 v37, v38, v39
v_cvt_pk_bf16_f32 v38, v164, v165
v_cvt_pk_bf16_f32 v39, v166, v167
v_cvt_pk_bf16_f32 v64, v64, v65
v_cvt_pk_bf16_f32 v65, v66, v67
v_cvt_pk_bf16_f32 v66, v168, v169
v_cvt_pk_bf16_f32 v67, v170, v171
v_cvt_pk_bf16_f32 v68, v68, v69
v_cvt_pk_bf16_f32 v69, v70, v71
v_cvt_pk_bf16_f32 v70, v172, v173
v_cvt_pk_bf16_f32 v71, v174, v175
v_cvt_pk_bf16_f32 v96, v96, v97
v_cvt_pk_bf16_f32 v97, v98, v99
v_cvt_pk_bf16_f32 v98, v176, v177
v_cvt_pk_bf16_f32 v99, v178, v179
v_cvt_pk_bf16_f32 v100, v100, v101
v_cvt_pk_bf16_f32 v101, v102, v103
v_cvt_pk_bf16_f32 v102, v180, v181
v_cvt_pk_bf16_f32 v103, v182, v183
v_cvt_pk_bf16_f32 v128, v128, v129
v_cvt_pk_bf16_f32 v129, v130, v131
v_cvt_pk_bf16_f32 v130, v184, v185
v_cvt_pk_bf16_f32 v131, v186, v187
v_cvt_pk_bf16_f32 v132, v132, v133
v_cvt_pk_bf16_f32 v133, v134, v135
v_cvt_pk_bf16_f32 v134, v188, v189
v_cvt_pk_bf16_f32 v135, v190, v191
v_cvt_pk_bf16_f32 v40, v40, v41
v_cvt_pk_bf16_f32 v41, v42, v43
v_cvt_pk_bf16_f32 v42, v192, v193
v_cvt_pk_bf16_f32 v43, v194, v195
v_cvt_pk_bf16_f32 v44, v44, v45
v_cvt_pk_bf16_f32 v45, v46, v47
v_cvt_pk_bf16_f32 v46, v196, v197
v_cvt_pk_bf16_f32 v47, v198, v199
v_cvt_pk_bf16_f32 v72, v72, v73
v_cvt_pk_bf16_f32 v73, v74, v75
v_cvt_pk_bf16_f32 v74, v200, v201
v_cvt_pk_bf16_f32 v75, v202, v203
v_cvt_pk_bf16_f32 v76, v76, v77
v_cvt_pk_bf16_f32 v77, v78, v79
v_cvt_pk_bf16_f32 v78, v204, v205
v_cvt_pk_bf16_f32 v79, v206, v207
v_cvt_pk_bf16_f32 v104, v104, v105
v_cvt_pk_bf16_f32 v105, v106, v107
v_cvt_pk_bf16_f32 v106, v208, v209
v_cvt_pk_bf16_f32 v107, v210, v211
v_cvt_pk_bf16_f32 v108, v108, v109
v_cvt_pk_bf16_f32 v109, v110, v111
v_cvt_pk_bf16_f32 v110, v212, v213
v_cvt_pk_bf16_f32 v111, v214, v215
v_cvt_pk_bf16_f32 v136, v136, v137
v_cvt_pk_bf16_f32 v137, v138, v139
v_cvt_pk_bf16_f32 v138, v216, v217
v_cvt_pk_bf16_f32 v139, v218, v219
v_cvt_pk_bf16_f32 v140, v140, v141
v_cvt_pk_bf16_f32 v141, v142, v143
v_cvt_pk_bf16_f32 v142, v220, v221
v_cvt_pk_bf16_f32 v143, v222, v223
v_cvt_pk_bf16_f32 v48, v48, v49
v_cvt_pk_bf16_f32 v49, v50, v51
v_cvt_pk_bf16_f32 v50, v224, v225
v_cvt_pk_bf16_f32 v51, v226, v227
v_cvt_pk_bf16_f32 v52, v52, v53
v_cvt_pk_bf16_f32 v53, v54, v55
v_cvt_pk_bf16_f32 v54, v228, v229
v_cvt_pk_bf16_f32 v55, v230, v231
v_cvt_pk_bf16_f32 v80, v80, v81
v_cvt_pk_bf16_f32 v81, v82, v83
v_cvt_pk_bf16_f32 v82, v232, v233
v_cvt_pk_bf16_f32 v83, v234, v235
v_cvt_pk_bf16_f32 v84, v84, v85
v_cvt_pk_bf16_f32 v85, v86, v87
v_cvt_pk_bf16_f32 v86, v236, v237
v_cvt_pk_bf16_f32 v87, v238, v239
v_cvt_pk_bf16_f32 v112, v112, v113
v_cvt_pk_bf16_f32 v113, v114, v115
v_cvt_pk_bf16_f32 v114, v240, v241
v_cvt_pk_bf16_f32 v115, v242, v243
v_cvt_pk_bf16_f32 v116, v116, v117
v_cvt_pk_bf16_f32 v117, v118, v119
v_cvt_pk_bf16_f32 v118, v244, v245
v_cvt_pk_bf16_f32 v119, v246, v247
v_cvt_pk_bf16_f32 v144, v144, v145
v_cvt_pk_bf16_f32 v145, v146, v147
v_cvt_pk_bf16_f32 v146, v248, v249
v_cvt_pk_bf16_f32 v147, v250, v251
v_cvt_pk_bf16_f32 v148, v148, v149
v_cvt_pk_bf16_f32 v149, v150, v151
v_cvt_pk_bf16_f32 v150, v252, v253
v_cvt_pk_bf16_f32 v151, v254, v255
v_accvgpr_read_b32 v4, a128
v_accvgpr_read_b32 v5, a129
v_accvgpr_read_b32 v6, a130
v_accvgpr_read_b32 v7, a131
v_cvt_pk_bf16_f32 v56, v56, v57
v_cvt_pk_bf16_f32 v57, v58, v59
v_cvt_pk_bf16_f32 v58, v4, v5
v_cvt_pk_bf16_f32 v59, v6, v7
v_accvgpr_read_b32 v4, a132
v_accvgpr_read_b32 v5, a133
v_accvgpr_read_b32 v6, a134
v_accvgpr_read_b32 v7, a135
v_cvt_pk_bf16_f32 v60, v60, v61
v_cvt_pk_bf16_f32 v61, v62, v63
v_cvt_pk_bf16_f32 v62, v4, v5
v_cvt_pk_bf16_f32 v63, v6, v7
v_accvgpr_read_b32 v4, a136
v_accvgpr_read_b32 v5, a137
v_accvgpr_read_b32 v6, a138
v_accvgpr_read_b32 v7, a139
v_cvt_pk_bf16_f32 v88, v88, v89
v_cvt_pk_bf16_f32 v89, v90, v91
v_cvt_pk_bf16_f32 v90, v4, v5
v_cvt_pk_bf16_f32 v91, v6, v7
v_accvgpr_read_b32 v4, a140
v_accvgpr_read_b32 v5, a141
v_accvgpr_read_b32 v6, a142
v_accvgpr_read_b32 v7, a143
v_cvt_pk_bf16_f32 v92, v92, v93
v_cvt_pk_bf16_f32 v93, v94, v95
v_cvt_pk_bf16_f32 v94, v4, v5
v_cvt_pk_bf16_f32 v95, v6, v7
v_accvgpr_read_b32 v4, a144
v_accvgpr_read_b32 v5, a145
v_accvgpr_read_b32 v6, a146
v_accvgpr_read_b32 v7, a147
v_cvt_pk_bf16_f32 v120, v120, v121
v_cvt_pk_bf16_f32 v121, v122, v123
v_cvt_pk_bf16_f32 v122, v4, v5
v_cvt_pk_bf16_f32 v123, v6, v7
v_accvgpr_read_b32 v4, a148
v_accvgpr_read_b32 v5, a149
v_accvgpr_read_b32 v6, a150
v_accvgpr_read_b32 v7, a151
v_cvt_pk_bf16_f32 v124, v124, v125
v_cvt_pk_bf16_f32 v125, v126, v127
v_cvt_pk_bf16_f32 v126, v4, v5
v_cvt_pk_bf16_f32 v127, v6, v7
v_accvgpr_read_b32 v4, a152
v_accvgpr_read_b32 v5, a153
v_accvgpr_read_b32 v6, a154
v_accvgpr_read_b32 v7, a155
v_cvt_pk_bf16_f32 v152, v152, v153
v_cvt_pk_bf16_f32 v153, v154, v155
v_cvt_pk_bf16_f32 v154, v4, v5
v_cvt_pk_bf16_f32 v155, v6, v7
v_accvgpr_read_b32 v4, a156
v_accvgpr_read_b32 v5, a157
v_accvgpr_read_b32 v6, a158
v_accvgpr_read_b32 v7, a159
v_cvt_pk_bf16_f32 v156, v156, v157
v_cvt_pk_bf16_f32 v157, v158, v159
v_cvt_pk_bf16_f32 v158, v4, v5
v_cvt_pk_bf16_f32 v159, v6, v7
s_branch parallel_sum__compressed_kv_cla__geglu_ffn__prompt_kernel_q
parallel_sum__compressed_kv_cla__geglu_ffn__prompt_kernel_v:
s_waitcnt lgkmcnt(0)
s_waitcnt vmcnt(35)
v_mfma_f32_16x16x32_bf16 v[32:35], a[0:3], a[64:67], 0
s_barrier
v_mfma_f32_16x16x32_bf16 v[160:163], a[4:7], a[64:67], 0
ds_read_b64_tr_b16 a[96:97], v4 offset:16384
v_mfma_f32_16x16x32_bf16 v[64:67], a[8:11], a[64:67], 0
s_add_u32 m0, s33, 0
v_mfma_f32_16x16x32_bf16 v[164:167], a[12:15], a[64:67], 0
ds_read_b64_tr_b16 a[98:99], v4 offset:17408
v_mfma_f32_16x16x32_bf16 v[96:99], a[16:19], a[64:67], 0
v_mfma_f32_16x16x32_bf16 v[168:171], a[20:23], a[64:67], 0
ds_read_b128 a[32:35], v13 offset:0
v_mfma_f32_16x16x32_bf16 v[128:131], a[24:27], a[64:67], 0
v_mfma_f32_16x16x32_bf16 v[172:175], a[28:31], a[64:67], 0
ds_read_b64_tr_b16 a[100:101], v5 offset:16384
v_mfma_f32_16x16x32_bf16 v[36:39], a[0:3], a[68:71], 0
s_add_u32 s36, s32, 1048576
v_mfma_f32_16x16x32_bf16 v[176:179], a[4:7], a[68:71], 0
ds_read_b64_tr_b16 a[102:103], v5 offset:17408
v_mfma_f32_16x16x32_bf16 v[68:71], a[8:11], a[68:71], 0
v_mfma_f32_16x16x32_bf16 v[180:183], a[12:15], a[68:71], 0
ds_read_b128 a[36:39], v13 offset:2048
v_mfma_f32_16x16x32_bf16 v[100:103], a[16:19], a[68:71], 0
v_mfma_f32_16x16x32_bf16 v[184:187], a[20:23], a[68:71], 0
ds_read_b64_tr_b16 a[104:105], v6 offset:16384
v_mfma_f32_16x16x32_bf16 v[132:135], a[24:27], a[68:71], 0
v_mfma_f32_16x16x32_bf16 v[188:191], a[28:31], a[68:71], 0
ds_read_b64_tr_b16 a[106:107], v6 offset:17408
v_mfma_f32_16x16x32_bf16 v[40:43], a[0:3], a[72:75], 0
buffer_load_dwordx4 v1, s[12:15], s36 offen offset:0 lds
v_mfma_f32_16x16x32_bf16 v[192:195], a[4:7], a[72:75], 0
ds_read_b128 a[40:43], v13 offset:4096
v_mfma_f32_16x16x32_bf16 v[72:75], a[8:11], a[72:75], 0
v_mfma_f32_16x16x32_bf16 v[196:199], a[12:15], a[72:75], 0
ds_read_b64_tr_b16 a[108:109], v7 offset:16384
v_mfma_f32_16x16x32_bf16 v[104:107], a[16:19], a[72:75], 0
v_mfma_f32_16x16x32_bf16 v[200:203], a[20:23], a[72:75], 0
ds_read_b64_tr_b16 a[110:111], v7 offset:17408
v_mfma_f32_16x16x32_bf16 v[136:139], a[24:27], a[72:75], 0
v_mfma_f32_16x16x32_bf16 v[204:207], a[28:31], a[72:75], 0
ds_read_b128 a[44:47], v13 offset:6144
v_mfma_f32_16x16x32_bf16 v[44:47], a[0:3], a[76:79], 0
s_add_u32 s36, s32, 1080320
v_mfma_f32_16x16x32_bf16 v[208:211], a[4:7], a[76:79], 0
ds_read_b64_tr_b16 a[112:113], v8 offset:16384
v_mfma_f32_16x16x32_bf16 v[76:79], a[8:11], a[76:79], 0
v_mfma_f32_16x16x32_bf16 v[212:215], a[12:15], a[76:79], 0
ds_read_b64_tr_b16 a[114:115], v8 offset:17408
v_mfma_f32_16x16x32_bf16 v[108:111], a[16:19], a[76:79], 0
v_mfma_f32_16x16x32_bf16 v[216:219], a[20:23], a[76:79], 0
ds_read_b128 a[48:51], v13 offset:8192
v_mfma_f32_16x16x32_bf16 v[140:143], a[24:27], a[76:79], 0
v_mfma_f32_16x16x32_bf16 v[220:223], a[28:31], a[76:79], 0
ds_read_b64_tr_b16 a[116:117], v9 offset:16384
v_mfma_f32_16x16x32_bf16 v[48:51], a[0:3], a[80:83], 0
buffer_load_dwordx4 v1, s[12:15], s36 offen offset:1024 lds
v_mfma_f32_16x16x32_bf16 v[224:227], a[4:7], a[80:83], 0
ds_read_b64_tr_b16 a[118:119], v9 offset:17408
v_mfma_f32_16x16x32_bf16 v[80:83], a[8:11], a[80:83], 0
v_mfma_f32_16x16x32_bf16 v[228:231], a[12:15], a[80:83], 0
ds_read_b128 a[52:55], v13 offset:10240
v_mfma_f32_16x16x32_bf16 v[112:115], a[16:19], a[80:83], 0
v_mfma_f32_16x16x32_bf16 v[232:235], a[20:23], a[80:83], 0
ds_read_b64_tr_b16 a[120:121], v10 offset:16384
v_mfma_f32_16x16x32_bf16 v[144:147], a[24:27], a[80:83], 0
v_mfma_f32_16x16x32_bf16 v[236:239], a[28:31], a[80:83], 0
ds_read_b64_tr_b16 a[122:123], v10 offset:17408
v_mfma_f32_16x16x32_bf16 v[52:55], a[0:3], a[84:87], 0
s_add_u32 m0, s33, 8192
v_mfma_f32_16x16x32_bf16 v[240:243], a[4:7], a[84:87], 0
ds_read_b128 a[56:59], v13 offset:12288
v_mfma_f32_16x16x32_bf16 v[84:87], a[8:11], a[84:87], 0
v_mfma_f32_16x16x32_bf16 v[244:247], a[12:15], a[84:87], 0
ds_read_b64_tr_b16 a[124:125], v11 offset:16384
v_mfma_f32_16x16x32_bf16 v[116:119], a[16:19], a[84:87], 0
v_mfma_f32_16x16x32_bf16 v[248:251], a[20:23], a[84:87], 0
ds_read_b64_tr_b16 a[126:127], v11 offset:17408
v_mfma_f32_16x16x32_bf16 v[148:151], a[24:27], a[84:87], 0
v_mfma_f32_16x16x32_bf16 v[252:255], a[28:31], a[84:87], 0
ds_read_b128 a[60:63], v13 offset:14336
v_mfma_f32_16x16x32_bf16 v[56:59], a[0:3], a[88:91], 0
s_add_u32 s36, s32, 1048576
v_mfma_f32_16x16x32_bf16 a[128:131], a[4:7], a[88:91], 0
v_mfma_f32_16x16x32_bf16 v[88:91], a[8:11], a[88:91], 0
v_mfma_f32_16x16x32_bf16 a[132:135], a[12:15], a[88:91], 0
v_mfma_f32_16x16x32_bf16 v[120:123], a[16:19], a[88:91], 0
buffer_load_dwordx4 v1, s[16:19], s36 offen offset:0 lds
v_mfma_f32_16x16x32_bf16 a[136:139], a[20:23], a[88:91], 0
v_mfma_f32_16x16x32_bf16 v[152:155], a[24:27], a[88:91], 0
v_mfma_f32_16x16x32_bf16 a[140:143], a[28:31], a[88:91], 0
v_mfma_f32_16x16x32_bf16 v[60:63], a[0:3], a[92:95], 0
s_add_u32 s36, s32, 1080320
v_mfma_f32_16x16x32_bf16 a[144:147], a[4:7], a[92:95], 0
v_mfma_f32_16x16x32_bf16 v[92:95], a[8:11], a[92:95], 0
v_mfma_f32_16x16x32_bf16 a[148:151], a[12:15], a[92:95], 0
v_mfma_f32_16x16x32_bf16 v[124:127], a[16:19], a[92:95], 0
buffer_load_dwordx4 v1, s[16:19], s36 offen offset:1024 lds
v_mfma_f32_16x16x32_bf16 a[152:155], a[20:23], a[92:95], 0
v_mfma_f32_16x16x32_bf16 v[156:159], a[24:27], a[92:95], 0
v_mfma_f32_16x16x32_bf16 a[156:159], a[28:31], a[92:95], 0
s_waitcnt lgkmcnt(0)
s_waitcnt vmcnt(26)
v_mfma_f32_16x16x32_bf16 v[32:35], a[32:35], a[96:99], v[32:35]
s_barrier
v_mfma_f32_16x16x32_bf16 v[160:163], a[36:39], a[96:99], v[160:163]
ds_read_b64_tr_b16 a[64:65], v4 offset:32768
v_mfma_f32_16x16x32_bf16 v[64:67], a[40:43], a[96:99], v[64:67]
s_add_u32 m0, s33, 16384
v_mfma_f32_16x16x32_bf16 v[164:167], a[44:47], a[96:99], v[164:167]
ds_read_b64_tr_b16 a[66:67], v4 offset:33792
v_mfma_f32_16x16x32_bf16 v[96:99], a[48:51], a[96:99], v[96:99]
v_mfma_f32_16x16x32_bf16 v[168:171], a[52:55], a[96:99], v[168:171]
ds_read_b128 a[0:3], v12 offset:32768
v_mfma_f32_16x16x32_bf16 v[128:131], a[56:59], a[96:99], v[128:131]
s_add_u32 s36, s32, 1310720
v_mfma_f32_16x16x32_bf16 v[172:175], a[60:63], a[96:99], v[172:175]
ds_read_b64_tr_b16 a[68:69], v5 offset:32768
v_mfma_f32_16x16x32_bf16 v[36:39], a[32:35], a[100:103], v[36:39]
v_mfma_f32_16x16x32_bf16 v[176:179], a[36:39], a[100:103], v[176:179]
ds_read_b64_tr_b16 a[70:71], v5 offset:33792
v_mfma_f32_16x16x32_bf16 v[68:71], a[40:43], a[100:103], v[68:71]
buffer_load_dwordx4 v1, s[12:15], s36 offen offset:0 lds
v_mfma_f32_16x16x32_bf16 v[180:183], a[44:47], a[100:103], v[180:183]
ds_read_b128 a[4:7], v12 offset:34816
v_mfma_f32_16x16x32_bf16 v[100:103], a[48:51], a[100:103], v[100:103]
v_mfma_f32_16x16x32_bf16 v[184:187], a[52:55], a[100:103], v[184:187]
ds_read_b64_tr_b16 a[72:73], v6 offset:32768
v_mfma_f32_16x16x32_bf16 v[132:135], a[56:59], a[100:103], v[132:135]
s_add_u32 s36, s32, 1342464
v_mfma_f32_16x16x32_bf16 v[188:191], a[60:63], a[100:103], v[188:191]
ds_read_b64_tr_b16 a[74:75], v6 offset:33792
v_mfma_f32_16x16x32_bf16 v[40:43], a[32:35], a[104:107], v[40:43]
v_mfma_f32_16x16x32_bf16 v[192:195], a[36:39], a[104:107], v[192:195]
ds_read_b128 a[8:11], v12 offset:36864
v_mfma_f32_16x16x32_bf16 v[72:75], a[40:43], a[104:107], v[72:75]
buffer_load_dwordx4 v1, s[12:15], s36 offen offset:1024 lds
v_mfma_f32_16x16x32_bf16 v[196:199], a[44:47], a[104:107], v[196:199]
ds_read_b64_tr_b16 a[76:77], v7 offset:32768
v_mfma_f32_16x16x32_bf16 v[104:107], a[48:51], a[104:107], v[104:107]
v_mfma_f32_16x16x32_bf16 v[200:203], a[52:55], a[104:107], v[200:203]
ds_read_b64_tr_b16 a[78:79], v7 offset:33792
v_mfma_f32_16x16x32_bf16 v[136:139], a[56:59], a[104:107], v[136:139]
s_add_u32 m0, s33, 24576
v_mfma_f32_16x16x32_bf16 v[204:207], a[60:63], a[104:107], v[204:207]
ds_read_b128 a[12:15], v12 offset:38912
v_mfma_f32_16x16x32_bf16 v[44:47], a[32:35], a[108:111], v[44:47]
v_mfma_f32_16x16x32_bf16 v[208:211], a[36:39], a[108:111], v[208:211]
ds_read_b64_tr_b16 a[80:81], v8 offset:32768
v_mfma_f32_16x16x32_bf16 v[76:79], a[40:43], a[108:111], v[76:79]
s_add_u32 s36, s32, 1310720
v_mfma_f32_16x16x32_bf16 v[212:215], a[44:47], a[108:111], v[212:215]
ds_read_b64_tr_b16 a[82:83], v8 offset:33792
v_mfma_f32_16x16x32_bf16 v[108:111], a[48:51], a[108:111], v[108:111]
v_mfma_f32_16x16x32_bf16 v[216:219], a[52:55], a[108:111], v[216:219]
ds_read_b128 a[16:19], v12 offset:40960
v_mfma_f32_16x16x32_bf16 v[140:143], a[56:59], a[108:111], v[140:143]
buffer_load_dwordx4 v1, s[16:19], s36 offen offset:0 lds
v_mfma_f32_16x16x32_bf16 v[220:223], a[60:63], a[108:111], v[220:223]
ds_read_b64_tr_b16 a[84:85], v9 offset:32768
v_mfma_f32_16x16x32_bf16 v[48:51], a[32:35], a[112:115], v[48:51]
v_mfma_f32_16x16x32_bf16 v[224:227], a[36:39], a[112:115], v[224:227]
ds_read_b64_tr_b16 a[86:87], v9 offset:33792
v_mfma_f32_16x16x32_bf16 v[80:83], a[40:43], a[112:115], v[80:83]
s_add_u32 s36, s32, 1342464
v_mfma_f32_16x16x32_bf16 v[228:231], a[44:47], a[112:115], v[228:231]
ds_read_b128 a[20:23], v12 offset:43008
v_mfma_f32_16x16x32_bf16 v[112:115], a[48:51], a[112:115], v[112:115]
v_mfma_f32_16x16x32_bf16 v[232:235], a[52:55], a[112:115], v[232:235]
ds_read_b64_tr_b16 a[88:89], v10 offset:32768
v_mfma_f32_16x16x32_bf16 v[144:147], a[56:59], a[112:115], v[144:147]
buffer_load_dwordx4 v1, s[16:19], s36 offen offset:1024 lds
v_mfma_f32_16x16x32_bf16 v[236:239], a[60:63], a[112:115], v[236:239]
ds_read_b64_tr_b16 a[90:91], v10 offset:33792
v_mfma_f32_16x16x32_bf16 v[52:55], a[32:35], a[116:119], v[52:55]
v_mfma_f32_16x16x32_bf16 v[240:243], a[36:39], a[116:119], v[240:243]
ds_read_b128 a[24:27], v12 offset:45056
v_mfma_f32_16x16x32_bf16 v[84:87], a[40:43], a[116:119], v[84:87]
s_add_u32 m0, s35, 0
v_mfma_f32_16x16x32_bf16 v[244:247], a[44:47], a[116:119], v[244:247]
ds_read_b64_tr_b16 a[92:93], v11 offset:32768
v_mfma_f32_16x16x32_bf16 v[116:119], a[48:51], a[116:119], v[116:119]
v_mfma_f32_16x16x32_bf16 v[248:251], a[52:55], a[116:119], v[248:251]
ds_read_b64_tr_b16 a[94:95], v11 offset:33792
v_mfma_f32_16x16x32_bf16 v[148:151], a[56:59], a[116:119], v[148:151]
s_add_u32 s37, s34, 384
v_mfma_f32_16x16x32_bf16 v[252:255], a[60:63], a[116:119], v[252:255]
ds_read_b128 a[28:31], v12 offset:47104
v_mfma_f32_16x16x32_bf16 v[56:59], a[32:35], a[120:123], v[56:59]
v_mfma_f32_16x16x32_bf16 a[128:131], a[36:39], a[120:123], a[128:131]
buffer_load_dwordx4 v2, s[8:11], s37 offen offset:0 lds
v_mfma_f32_16x16x32_bf16 v[88:91], a[40:43], a[120:123], v[88:91]
v_mfma_f32_16x16x32_bf16 a[132:135], a[44:47], a[120:123], a[132:135]
s_add_u32 s37, s34, 7552
v_mfma_f32_16x16x32_bf16 v[120:123], a[48:51], a[120:123], v[120:123]
v_mfma_f32_16x16x32_bf16 a[136:139], a[52:55], a[120:123], a[136:139]
buffer_load_dwordx4 v3, s[8:11], s37 offen offset:1024 lds
v_mfma_f32_16x16x32_bf16 v[152:155], a[56:59], a[120:123], v[152:155]
v_mfma_f32_16x16x32_bf16 a[140:143], a[60:63], a[120:123], a[140:143]
s_add_u32 s37, s34, 14720
v_mfma_f32_16x16x32_bf16 v[60:63], a[32:35], a[124:127], v[60:63]
v_mfma_f32_16x16x32_bf16 a[144:147], a[36:39], a[124:127], a[144:147]
buffer_load_dwordx4 v2, s[8:11], s37 offen offset:2048 lds
v_mfma_f32_16x16x32_bf16 v[92:95], a[40:43], a[124:127], v[92:95]
v_mfma_f32_16x16x32_bf16 a[148:151], a[44:47], a[124:127], a[148:151]
s_add_u32 s37, s34, 21888
v_mfma_f32_16x16x32_bf16 v[124:127], a[48:51], a[124:127], v[124:127]
v_mfma_f32_16x16x32_bf16 a[152:155], a[52:55], a[124:127], a[152:155]
buffer_load_dwordx4 v3, s[8:11], s37 offen offset:3072 lds
v_mfma_f32_16x16x32_bf16 v[156:159], a[56:59], a[124:127], v[156:159]
v_mfma_f32_16x16x32_bf16 a[156:159], a[60:63], a[124:127], a[156:159]
s_waitcnt lgkmcnt(0)
s_waitcnt vmcnt(30)
v_mfma_f32_16x16x32_bf16 v[32:35], a[0:3], a[64:67], v[32:35]
s_barrier
v_mfma_f32_16x16x32_bf16 v[160:163], a[4:7], a[64:67], v[160:163]
ds_read_b64_tr_b16 a[96:97], v4 offset:49152
v_mfma_f32_16x16x32_bf16 v[64:67], a[8:11], a[64:67], v[64:67]
s_add_u32 m0, s33, 32768
v_mfma_f32_16x16x32_bf16 v[164:167], a[12:15], a[64:67], v[164:167]
ds_read_b64_tr_b16 a[98:99], v4 offset:50176
v_mfma_f32_16x16x32_bf16 v[96:99], a[16:19], a[64:67], v[96:99]
v_mfma_f32_16x16x32_bf16 v[168:171], a[20:23], a[64:67], v[168:171]
ds_read_b128 a[32:35], v13 offset:32768
v_mfma_f32_16x16x32_bf16 v[128:131], a[24:27], a[64:67], v[128:131]
s_add_u32 s36, s32, 1572864
v_mfma_f32_16x16x32_bf16 v[172:175], a[28:31], a[64:67], v[172:175]
ds_read_b64_tr_b16 a[100:101], v5 offset:49152
v_mfma_f32_16x16x32_bf16 v[36:39], a[0:3], a[68:71], v[36:39]
v_mfma_f32_16x16x32_bf16 v[176:179], a[4:7], a[68:71], v[176:179]
ds_read_b64_tr_b16 a[102:103], v5 offset:50176
v_mfma_f32_16x16x32_bf16 v[68:71], a[8:11], a[68:71], v[68:71]
buffer_load_dwordx4 v1, s[12:15], s36 offen offset:0 lds
v_mfma_f32_16x16x32_bf16 v[180:183], a[12:15], a[68:71], v[180:183]
ds_read_b128 a[36:39], v13 offset:34816
v_mfma_f32_16x16x32_bf16 v[100:103], a[16:19], a[68:71], v[100:103]
v_mfma_f32_16x16x32_bf16 v[184:187], a[20:23], a[68:71], v[184:187]
ds_read_b64_tr_b16 a[104:105], v6 offset:49152
v_mfma_f32_16x16x32_bf16 v[132:135], a[24:27], a[68:71], v[132:135]
s_add_u32 s36, s32, 1604608
v_mfma_f32_16x16x32_bf16 v[188:191], a[28:31], a[68:71], v[188:191]
ds_read_b64_tr_b16 a[106:107], v6 offset:50176
v_mfma_f32_16x16x32_bf16 v[40:43], a[0:3], a[72:75], v[40:43]
v_mfma_f32_16x16x32_bf16 v[192:195], a[4:7], a[72:75], v[192:195]
ds_read_b128 a[40:43], v13 offset:36864
v_mfma_f32_16x16x32_bf16 v[72:75], a[8:11], a[72:75], v[72:75]
buffer_load_dwordx4 v1, s[12:15], s36 offen offset:1024 lds
v_mfma_f32_16x16x32_bf16 v[196:199], a[12:15], a[72:75], v[196:199]
ds_read_b64_tr_b16 a[108:109], v7 offset:49152
v_mfma_f32_16x16x32_bf16 v[104:107], a[16:19], a[72:75], v[104:107]
v_mfma_f32_16x16x32_bf16 v[200:203], a[20:23], a[72:75], v[200:203]
ds_read_b64_tr_b16 a[110:111], v7 offset:50176
v_mfma_f32_16x16x32_bf16 v[136:139], a[24:27], a[72:75], v[136:139]
s_add_u32 m0, s33, 40960
v_mfma_f32_16x16x32_bf16 v[204:207], a[28:31], a[72:75], v[204:207]
ds_read_b128 a[44:47], v13 offset:38912
v_mfma_f32_16x16x32_bf16 v[44:47], a[0:3], a[76:79], v[44:47]
v_mfma_f32_16x16x32_bf16 v[208:211], a[4:7], a[76:79], v[208:211]
ds_read_b64_tr_b16 a[112:113], v8 offset:49152
v_mfma_f32_16x16x32_bf16 v[76:79], a[8:11], a[76:79], v[76:79]
s_add_u32 s36, s32, 1572864
v_mfma_f32_16x16x32_bf16 v[212:215], a[12:15], a[76:79], v[212:215]
ds_read_b64_tr_b16 a[114:115], v8 offset:50176
v_mfma_f32_16x16x32_bf16 v[108:111], a[16:19], a[76:79], v[108:111]
v_mfma_f32_16x16x32_bf16 v[216:219], a[20:23], a[76:79], v[216:219]
ds_read_b128 a[48:51], v13 offset:40960
v_mfma_f32_16x16x32_bf16 v[140:143], a[24:27], a[76:79], v[140:143]
buffer_load_dwordx4 v1, s[16:19], s36 offen offset:0 lds
v_mfma_f32_16x16x32_bf16 v[220:223], a[28:31], a[76:79], v[220:223]
ds_read_b64_tr_b16 a[116:117], v9 offset:49152
v_mfma_f32_16x16x32_bf16 v[48:51], a[0:3], a[80:83], v[48:51]
v_mfma_f32_16x16x32_bf16 v[224:227], a[4:7], a[80:83], v[224:227]
ds_read_b64_tr_b16 a[118:119], v9 offset:50176
v_mfma_f32_16x16x32_bf16 v[80:83], a[8:11], a[80:83], v[80:83]
s_add_u32 s36, s32, 1604608
v_mfma_f32_16x16x32_bf16 v[228:231], a[12:15], a[80:83], v[228:231]
ds_read_b128 a[52:55], v13 offset:43008
v_mfma_f32_16x16x32_bf16 v[112:115], a[16:19], a[80:83], v[112:115]
v_mfma_f32_16x16x32_bf16 v[232:235], a[20:23], a[80:83], v[232:235]
ds_read_b64_tr_b16 a[120:121], v10 offset:49152
v_mfma_f32_16x16x32_bf16 v[144:147], a[24:27], a[80:83], v[144:147]
buffer_load_dwordx4 v1, s[16:19], s36 offen offset:1024 lds
v_mfma_f32_16x16x32_bf16 v[236:239], a[28:31], a[80:83], v[236:239]
ds_read_b64_tr_b16 a[122:123], v10 offset:50176
v_mfma_f32_16x16x32_bf16 v[52:55], a[0:3], a[84:87], v[52:55]
v_mfma_f32_16x16x32_bf16 v[240:243], a[4:7], a[84:87], v[240:243]
ds_read_b128 a[56:59], v13 offset:45056
v_mfma_f32_16x16x32_bf16 v[84:87], a[8:11], a[84:87], v[84:87]
s_add_u32 m0, s35, 4096
v_mfma_f32_16x16x32_bf16 v[244:247], a[12:15], a[84:87], v[244:247]
ds_read_b64_tr_b16 a[124:125], v11 offset:49152
v_mfma_f32_16x16x32_bf16 v[116:119], a[16:19], a[84:87], v[116:119]
v_mfma_f32_16x16x32_bf16 v[248:251], a[20:23], a[84:87], v[248:251]
ds_read_b64_tr_b16 a[126:127], v11 offset:50176
v_mfma_f32_16x16x32_bf16 v[148:151], a[24:27], a[84:87], v[148:151]
s_add_u32 s37, s34, 33152
v_mfma_f32_16x16x32_bf16 v[252:255], a[28:31], a[84:87], v[252:255]
ds_read_b128 a[60:63], v13 offset:47104
v_mfma_f32_16x16x32_bf16 v[56:59], a[0:3], a[88:91], v[56:59]
v_mfma_f32_16x16x32_bf16 a[128:131], a[4:7], a[88:91], a[128:131]
buffer_load_dwordx4 v2, s[8:11], s37 offen offset:0 lds
v_mfma_f32_16x16x32_bf16 v[88:91], a[8:11], a[88:91], v[88:91]
v_mfma_f32_16x16x32_bf16 a[132:135], a[12:15], a[88:91], a[132:135]
s_add_u32 s37, s34, 40320
v_mfma_f32_16x16x32_bf16 v[120:123], a[16:19], a[88:91], v[120:123]
v_mfma_f32_16x16x32_bf16 a[136:139], a[20:23], a[88:91], a[136:139]
buffer_load_dwordx4 v3, s[8:11], s37 offen offset:1024 lds
v_mfma_f32_16x16x32_bf16 v[152:155], a[24:27], a[88:91], v[152:155]
v_mfma_f32_16x16x32_bf16 a[140:143], a[28:31], a[88:91], a[140:143]
s_add_u32 s37, s34, 47488
v_mfma_f32_16x16x32_bf16 v[60:63], a[0:3], a[92:95], v[60:63]
v_mfma_f32_16x16x32_bf16 a[144:147], a[4:7], a[92:95], a[144:147]
buffer_load_dwordx4 v2, s[8:11], s37 offen offset:2048 lds
v_mfma_f32_16x16x32_bf16 v[92:95], a[8:11], a[92:95], v[92:95]
v_mfma_f32_16x16x32_bf16 a[148:151], a[12:15], a[92:95], a[148:151]
s_add_u32 s37, s34, 54656
v_mfma_f32_16x16x32_bf16 v[124:127], a[16:19], a[92:95], v[124:127]
v_mfma_f32_16x16x32_bf16 a[152:155], a[20:23], a[92:95], a[152:155]
buffer_load_dwordx4 v3, s[8:11], s37 offen offset:3072 lds
v_mfma_f32_16x16x32_bf16 v[156:159], a[24:27], a[92:95], v[156:159]
v_mfma_f32_16x16x32_bf16 a[156:159], a[28:31], a[92:95], a[156:159]
s_waitcnt lgkmcnt(0)
s_waitcnt vmcnt(16)
v_mfma_f32_16x16x32_bf16 v[32:35], a[32:35], a[96:99], v[32:35]
s_barrier
v_mfma_f32_16x16x32_bf16 v[160:163], a[36:39], a[96:99], v[160:163]
ds_read_b64_tr_b16 a[64:65], v4 offset:0
v_mfma_f32_16x16x32_bf16 v[64:67], a[40:43], a[96:99], v[64:67]
s_add_u32 m0, s33, 49152
v_mfma_f32_16x16x32_bf16 v[164:167], a[44:47], a[96:99], v[164:167]
ds_read_b64_tr_b16 a[66:67], v4 offset:1024
v_mfma_f32_16x16x32_bf16 v[96:99], a[48:51], a[96:99], v[96:99]
s_add_u32 s36, s32, 1835008
v_mfma_f32_16x16x32_bf16 v[168:171], a[52:55], a[96:99], v[168:171]
ds_read_b128 a[0:3], v14 offset:0
v_mfma_f32_16x16x32_bf16 v[128:131], a[56:59], a[96:99], v[128:131]
buffer_load_dwordx4 v1, s[12:15], s36 offen offset:0 lds
v_mfma_f32_16x16x32_bf16 v[172:175], a[60:63], a[96:99], v[172:175]
ds_read_b64_tr_b16 a[68:69], v5 offset:0
v_mfma_f32_16x16x32_bf16 v[36:39], a[32:35], a[100:103], v[36:39]
s_add_u32 s36, s32, 1866752
v_mfma_f32_16x16x32_bf16 v[176:179], a[36:39], a[100:103], v[176:179]
ds_read_b64_tr_b16 a[70:71], v5 offset:1024
v_mfma_f32_16x16x32_bf16 v[68:71], a[40:43], a[100:103], v[68:71]
buffer_load_dwordx4 v1, s[12:15], s36 offen offset:1024 lds
v_mfma_f32_16x16x32_bf16 v[180:183], a[44:47], a[100:103], v[180:183]
ds_read_b128 a[4:7], v14 offset:2048
v_mfma_f32_16x16x32_bf16 v[100:103], a[48:51], a[100:103], v[100:103]
s_add_u32 m0, s33, 57344
v_mfma_f32_16x16x32_bf16 v[184:187], a[52:55], a[100:103], v[184:187]
ds_read_b64_tr_b16 a[72:73], v6 offset:0
v_mfma_f32_16x16x32_bf16 v[132:135], a[56:59], a[100:103], v[132:135]
s_add_u32 s36, s32, 1835008
v_mfma_f32_16x16x32_bf16 v[188:191], a[60:63], a[100:103], v[188:191]
ds_read_b64_tr_b16 a[74:75], v6 offset:1024
v_mfma_f32_16x16x32_bf16 v[40:43], a[32:35], a[104:107], v[40:43]
buffer_load_dwordx4 v1, s[16:19], s36 offen offset:0 lds
v_mfma_f32_16x16x32_bf16 v[192:195], a[36:39], a[104:107], v[192:195]
ds_read_b128 a[8:11], v14 offset:4096
v_mfma_f32_16x16x32_bf16 v[72:75], a[40:43], a[104:107], v[72:75]
s_add_u32 s36, s32, 1866752
v_mfma_f32_16x16x32_bf16 v[196:199], a[44:47], a[104:107], v[196:199]
ds_read_b64_tr_b16 a[76:77], v7 offset:0
v_mfma_f32_16x16x32_bf16 v[104:107], a[48:51], a[104:107], v[104:107]
buffer_load_dwordx4 v1, s[16:19], s36 offen offset:1024 lds
v_mfma_f32_16x16x32_bf16 v[200:203], a[52:55], a[104:107], v[200:203]
ds_read_b64_tr_b16 a[78:79], v7 offset:1024
v_mfma_f32_16x16x32_bf16 v[136:139], a[56:59], a[104:107], v[136:139]
s_add_u32 m0, s35, 32768
v_mfma_f32_16x16x32_bf16 v[204:207], a[60:63], a[104:107], v[204:207]
ds_read_b128 a[12:15], v14 offset:6144
v_mfma_f32_16x16x32_bf16 v[44:47], a[32:35], a[108:111], v[44:47]
s_add_u32 s37, s34, 512
v_mfma_f32_16x16x32_bf16 v[208:211], a[36:39], a[108:111], v[208:211]
ds_read_b64_tr_b16 a[80:81], v8 offset:0
v_mfma_f32_16x16x32_bf16 v[76:79], a[40:43], a[108:111], v[76:79]
buffer_load_dwordx4 v2, s[8:11], s37 offen offset:0 lds
v_mfma_f32_16x16x32_bf16 v[212:215], a[44:47], a[108:111], v[212:215]
ds_read_b64_tr_b16 a[82:83], v8 offset:1024
v_mfma_f32_16x16x32_bf16 v[108:111], a[48:51], a[108:111], v[108:111]
s_add_u32 s37, s34, 7680
v_mfma_f32_16x16x32_bf16 v[216:219], a[52:55], a[108:111], v[216:219]
ds_read_b128 a[16:19], v14 offset:8192
v_mfma_f32_16x16x32_bf16 v[140:143], a[56:59], a[108:111], v[140:143]
buffer_load_dwordx4 v3, s[8:11], s37 offen offset:1024 lds
v_mfma_f32_16x16x32_bf16 v[220:223], a[60:63], a[108:111], v[220:223]
ds_read_b64_tr_b16 a[84:85], v9 offset:0
v_mfma_f32_16x16x32_bf16 v[48:51], a[32:35], a[112:115], v[48:51]
s_add_u32 s37, s34, 14848
v_mfma_f32_16x16x32_bf16 v[224:227], a[36:39], a[112:115], v[224:227]
ds_read_b64_tr_b16 a[86:87], v9 offset:1024
v_mfma_f32_16x16x32_bf16 v[80:83], a[40:43], a[112:115], v[80:83]
buffer_load_dwordx4 v2, s[8:11], s37 offen offset:2048 lds
v_mfma_f32_16x16x32_bf16 v[228:231], a[44:47], a[112:115], v[228:231]
ds_read_b128 a[20:23], v14 offset:10240
v_mfma_f32_16x16x32_bf16 v[112:115], a[48:51], a[112:115], v[112:115]
s_add_u32 s37, s34, 22016
v_mfma_f32_16x16x32_bf16 v[232:235], a[52:55], a[112:115], v[232:235]
ds_read_b64_tr_b16 a[88:89], v10 offset:0
v_mfma_f32_16x16x32_bf16 v[144:147], a[56:59], a[112:115], v[144:147]
buffer_load_dwordx4 v3, s[8:11], s37 offen offset:3072 lds
v_mfma_f32_16x16x32_bf16 v[236:239], a[60:63], a[112:115], v[236:239]
ds_read_b64_tr_b16 a[90:91], v10 offset:1024
v_mfma_f32_16x16x32_bf16 v[52:55], a[32:35], a[116:119], v[52:55]
v_mfma_f32_16x16x32_bf16 v[240:243], a[36:39], a[116:119], v[240:243]
ds_read_b128 a[24:27], v14 offset:12288
v_mfma_f32_16x16x32_bf16 v[84:87], a[40:43], a[116:119], v[84:87]
v_mfma_f32_16x16x32_bf16 v[244:247], a[44:47], a[116:119], v[244:247]
ds_read_b64_tr_b16 a[92:93], v11 offset:0
v_mfma_f32_16x16x32_bf16 v[116:119], a[48:51], a[116:119], v[116:119]
s_mov_b32 s40, s76
s_mov_b32 s41, s77
s_mov_b32 s42, 4718592
s_mov_b32 s43, 0x20000
v_mfma_f32_16x16x32_bf16 v[248:251], a[52:55], a[116:119], v[248:251]
ds_read_b64_tr_b16 a[94:95], v11 offset:1024
v_mfma_f32_16x16x32_bf16 v[148:151], a[56:59], a[116:119], v[148:151]
s_lshr_b32 s3, s2, 3
s_lshl_b32 s3, s3, 2
s_add_u32 s3, s3, s28
s_mul_i32 s3, s3, 36
v_mfma_f32_16x16x32_bf16 v[252:255], a[60:63], a[116:119], v[252:255]
ds_read_b128 a[28:31], v14 offset:14336
v_mfma_f32_16x16x32_bf16 v[56:59], a[32:35], a[120:123], v[56:59]
v_add_u32 v26, s3, v0
v_mfma_f32_16x16x32_bf16 a[128:131], a[36:39], a[120:123], a[128:131]
v_lshrrev_b32 v27, 3, v26
v_mfma_f32_16x16x32_bf16 v[88:91], a[40:43], a[120:123], v[88:91]
v_mul_u32_u24 v28, 8, v27
v_mfma_f32_16x16x32_bf16 a[132:135], a[44:47], a[120:123], a[132:135]
v_sub_u32 v28, v26, v28
v_mfma_f32_16x16x32_bf16 v[120:123], a[48:51], a[120:123], v[120:123]
s_mov_b32 s5, 0
s_and_b32 s6, s2, 7
s_lshl_b32 s6, s6, 10
v_mfma_f32_16x16x32_bf16 a[136:139], a[52:55], a[120:123], a[136:139]
v_add_u32 v27, s5, v27
v_mfma_f32_16x16x32_bf16 v[152:155], a[56:59], a[120:123], v[152:155]
v_mul_u32_u24 v27, 8192, v27
v_mfma_f32_16x16x32_bf16 a[140:143], a[60:63], a[120:123], a[140:143]
v_lshl_add_u32 v27, v28, 7, v27
v_mfma_f32_16x16x32_bf16 v[60:63], a[32:35], a[124:127], v[60:63]
v_add_u32 v27, s6, v27
v_mfma_f32_16x16x32_bf16 a[144:147], a[36:39], a[124:127], a[144:147]
v_mov_b32 v28, 0x10000000
v_mfma_f32_16x16x32_bf16 v[92:95], a[40:43], a[124:127], v[92:95]
v_cmp_gt_u32 vcc, 36, v0
v_mfma_f32_16x16x32_bf16 a[148:151], a[44:47], a[124:127], a[148:151]
s_mov_b32 s4, 4608
v_cmp_gt_u32 s[6:7], s4, v26
v_mfma_f32_16x16x32_bf16 v[124:127], a[48:51], a[124:127], v[124:127]
s_nop 1
s_and_b64 vcc, vcc, s[6:7]
v_mfma_f32_16x16x32_bf16 a[152:155], a[52:55], a[124:127], a[152:155]
s_nop 1
v_cndmask_b32 v27, v28, v27, vcc
v_mfma_f32_16x16x32_bf16 v[156:159], a[56:59], a[124:127], v[156:159]
buffer_load_dword v28, v27, s[40:43], 0 offen
v_mfma_f32_16x16x32_bf16 a[156:159], a[60:63], a[124:127], a[156:159]
s_waitcnt lgkmcnt(0)
s_waitcnt vmcnt(21)
v_mfma_f32_16x16x32_bf16 v[32:35], a[0:3], a[64:67], v[32:35]
s_barrier
v_mfma_f32_16x16x32_bf16 v[160:163], a[4:7], a[64:67], v[160:163]
ds_read_b64_tr_b16 a[96:97], v4 offset:16384
v_mfma_f32_16x16x32_bf16 v[64:67], a[8:11], a[64:67], v[64:67]
s_add_u32 m0, s33, 0
v_mfma_f32_16x16x32_bf16 v[164:167], a[12:15], a[64:67], v[164:167]
ds_read_b64_tr_b16 a[98:99], v4 offset:17408
v_mfma_f32_16x16x32_bf16 v[96:99], a[16:19], a[64:67], v[96:99]
s_add_u32 s36, s32, 2097152
v_mfma_f32_16x16x32_bf16 v[168:171], a[20:23], a[64:67], v[168:171]
ds_read_b128 a[32:35], v15 offset:0
v_mfma_f32_16x16x32_bf16 v[128:131], a[24:27], a[64:67], v[128:131]
v_mfma_f32_16x16x32_bf16 v[172:175], a[28:31], a[64:67], v[172:175]
ds_read_b64_tr_b16 a[100:101], v5 offset:16384
v_mfma_f32_16x16x32_bf16 v[36:39], a[0:3], a[68:71], v[36:39]
buffer_load_dwordx4 v1, s[12:15], s36 offen offset:0 lds
v_mfma_f32_16x16x32_bf16 v[176:179], a[4:7], a[68:71], v[176:179]
ds_read_b64_tr_b16 a[102:103], v5 offset:17408
v_mfma_f32_16x16x32_bf16 v[68:71], a[8:11], a[68:71], v[68:71]
v_mfma_f32_16x16x32_bf16 v[180:183], a[12:15], a[68:71], v[180:183]
ds_read_b128 a[36:39], v15 offset:2048
v_mfma_f32_16x16x32_bf16 v[100:103], a[16:19], a[68:71], v[100:103]
s_add_u32 s36, s32, 2128896
v_mfma_f32_16x16x32_bf16 v[184:187], a[20:23], a[68:71], v[184:187]
ds_read_b64_tr_b16 a[104:105], v6 offset:16384
v_mfma_f32_16x16x32_bf16 v[132:135], a[24:27], a[68:71], v[132:135]
v_mfma_f32_16x16x32_bf16 v[188:191], a[28:31], a[68:71], v[188:191]
ds_read_b64_tr_b16 a[106:107], v6 offset:17408
v_mfma_f32_16x16x32_bf16 v[40:43], a[0:3], a[72:75], v[40:43]
buffer_load_dwordx4 v1, s[12:15], s36 offen offset:1024 lds
v_mfma_f32_16x16x32_bf16 v[192:195], a[4:7], a[72:75], v[192:195]
ds_read_b128 a[40:43], v15 offset:4096
v_mfma_f32_16x16x32_bf16 v[72:75], a[8:11], a[72:75], v[72:75]
v_mfma_f32_16x16x32_bf16 v[196:199], a[12:15], a[72:75], v[196:199]
ds_read_b64_tr_b16 a[108:109], v7 offset:16384
v_mfma_f32_16x16x32_bf16 v[104:107], a[16:19], a[72:75], v[104:107]
s_add_u32 m0, s33, 8192
v_mfma_f32_16x16x32_bf16 v[200:203], a[20:23], a[72:75], v[200:203]
ds_read_b64_tr_b16 a[110:111], v7 offset:17408
v_mfma_f32_16x16x32_bf16 v[136:139], a[24:27], a[72:75], v[136:139]
v_mfma_f32_16x16x32_bf16 v[204:207], a[28:31], a[72:75], v[204:207]
ds_read_b128 a[44:47], v15 offset:6144
v_mfma_f32_16x16x32_bf16 v[44:47], a[0:3], a[76:79], v[44:47]
s_add_u32 s36, s32, 2097152
v_mfma_f32_16x16x32_bf16 v[208:211], a[4:7], a[76:79], v[208:211]
ds_read_b64_tr_b16 a[112:113], v8 offset:16384
v_mfma_f32_16x16x32_bf16 v[76:79], a[8:11], a[76:79], v[76:79]
v_mfma_f32_16x16x32_bf16 v[212:215], a[12:15], a[76:79], v[212:215]
ds_read_b64_tr_b16 a[114:115], v8 offset:17408
v_mfma_f32_16x16x32_bf16 v[108:111], a[16:19], a[76:79], v[108:111]
buffer_load_dwordx4 v1, s[16:19], s36 offen offset:0 lds
v_mfma_f32_16x16x32_bf16 v[216:219], a[20:23], a[76:79], v[216:219]
ds_read_b128 a[48:51], v15 offset:8192
v_mfma_f32_16x16x32_bf16 v[140:143], a[24:27], a[76:79], v[140:143]
v_mfma_f32_16x16x32_bf16 v[220:223], a[28:31], a[76:79], v[220:223]
ds_read_b64_tr_b16 a[116:117], v9 offset:16384
v_mfma_f32_16x16x32_bf16 v[48:51], a[0:3], a[80:83], v[48:51]
s_add_u32 s36, s32, 2128896
v_mfma_f32_16x16x32_bf16 v[224:227], a[4:7], a[80:83], v[224:227]
ds_read_b64_tr_b16 a[118:119], v9 offset:17408
v_mfma_f32_16x16x32_bf16 v[80:83], a[8:11], a[80:83], v[80:83]
v_mfma_f32_16x16x32_bf16 v[228:231], a[12:15], a[80:83], v[228:231]
ds_read_b128 a[52:55], v15 offset:10240
v_mfma_f32_16x16x32_bf16 v[112:115], a[16:19], a[80:83], v[112:115]
buffer_load_dwordx4 v1, s[16:19], s36 offen offset:1024 lds
v_mfma_f32_16x16x32_bf16 v[232:235], a[20:23], a[80:83], v[232:235]
ds_read_b64_tr_b16 a[120:121], v10 offset:16384
v_mfma_f32_16x16x32_bf16 v[144:147], a[24:27], a[80:83], v[144:147]
v_mfma_f32_16x16x32_bf16 v[236:239], a[28:31], a[80:83], v[236:239]
ds_read_b64_tr_b16 a[122:123], v10 offset:17408
v_mfma_f32_16x16x32_bf16 v[52:55], a[0:3], a[84:87], v[52:55]
s_add_u32 m0, s35, 36864
v_mfma_f32_16x16x32_bf16 v[240:243], a[4:7], a[84:87], v[240:243]
ds_read_b128 a[56:59], v15 offset:12288
v_mfma_f32_16x16x32_bf16 v[84:87], a[8:11], a[84:87], v[84:87]
v_mfma_f32_16x16x32_bf16 v[244:247], a[12:15], a[84:87], v[244:247]
ds_read_b64_tr_b16 a[124:125], v11 offset:16384
v_mfma_f32_16x16x32_bf16 v[116:119], a[16:19], a[84:87], v[116:119]
s_add_u32 s37, s34, 33280
v_mfma_f32_16x16x32_bf16 v[248:251], a[20:23], a[84:87], v[248:251]
ds_read_b64_tr_b16 a[126:127], v11 offset:17408
v_mfma_f32_16x16x32_bf16 v[148:151], a[24:27], a[84:87], v[148:151]
v_mfma_f32_16x16x32_bf16 v[252:255], a[28:31], a[84:87], v[252:255]
ds_read_b128 a[60:63], v15 offset:14336
v_mfma_f32_16x16x32_bf16 v[56:59], a[0:3], a[88:91], v[56:59]
buffer_load_dwordx4 v2, s[8:11], s37 offen offset:0 lds
v_mfma_f32_16x16x32_bf16 a[128:131], a[4:7], a[88:91], a[128:131]
v_mfma_f32_16x16x32_bf16 v[88:91], a[8:11], a[88:91], v[88:91]
s_add_u32 s37, s34, 40448
v_mfma_f32_16x16x32_bf16 a[132:135], a[12:15], a[88:91], a[132:135]
v_mfma_f32_16x16x32_bf16 v[120:123], a[16:19], a[88:91], v[120:123]
buffer_load_dwordx4 v3, s[8:11], s37 offen offset:1024 lds
v_mfma_f32_16x16x32_bf16 a[136:139], a[20:23], a[88:91], a[136:139]
v_mfma_f32_16x16x32_bf16 v[152:155], a[24:27], a[88:91], v[152:155]
s_add_u32 s37, s34, 47616
v_mfma_f32_16x16x32_bf16 a[140:143], a[28:31], a[88:91], a[140:143]
v_mfma_f32_16x16x32_bf16 v[60:63], a[0:3], a[92:95], v[60:63]
buffer_load_dwordx4 v2, s[8:11], s37 offen offset:2048 lds
v_mfma_f32_16x16x32_bf16 a[144:147], a[4:7], a[92:95], a[144:147]
v_mfma_f32_16x16x32_bf16 v[92:95], a[8:11], a[92:95], v[92:95]
s_add_u32 s37, s34, 54784
v_mfma_f32_16x16x32_bf16 a[148:151], a[12:15], a[92:95], a[148:151]
v_mfma_f32_16x16x32_bf16 v[124:127], a[16:19], a[92:95], v[124:127]
buffer_load_dwordx4 v3, s[8:11], s37 offen offset:3072 lds
v_mfma_f32_16x16x32_bf16 a[152:155], a[20:23], a[92:95], a[152:155]
v_mfma_f32_16x16x32_bf16 v[156:159], a[24:27], a[92:95], v[156:159]
s_cmp_eq_u32 s28, 0
s_cselect_b32 s68, s2, 0x1000
s_add_u32 s69, s101, 1
v_mov_b32 v26, s69
s_mov_b64 exec, 1
buffer_store_byte v26, off, s[64:67], s68 sc1
s_mov_b64 exec, -1
s_nop 1
v_mfma_f32_16x16x32_bf16 a[156:159], a[28:31], a[92:95], a[156:159]
s_waitcnt lgkmcnt(0)
s_waitcnt vmcnt(18)
v_mfma_f32_16x16x32_bf16 v[32:35], a[32:35], a[96:99], v[32:35]
s_barrier
v_mfma_f32_16x16x32_bf16 v[160:163], a[36:39], a[96:99], v[160:163]
ds_read_b64_tr_b16 a[64:65], v4 offset:32768
v_mfma_f32_16x16x32_bf16 v[64:67], a[40:43], a[96:99], v[64:67]
s_add_u32 m0, s33, 16384
v_mfma_f32_16x16x32_bf16 v[164:167], a[44:47], a[96:99], v[164:167]
ds_read_b64_tr_b16 a[66:67], v4 offset:33792
v_mfma_f32_16x16x32_bf16 v[96:99], a[48:51], a[96:99], v[96:99]
s_add_u32 s36, s32, 2359296
v_mfma_f32_16x16x32_bf16 v[168:171], a[52:55], a[96:99], v[168:171]
ds_read_b128 a[0:3], v12 offset:0
v_mfma_f32_16x16x32_bf16 v[128:131], a[56:59], a[96:99], v[128:131]
v_mfma_f32_16x16x32_bf16 v[172:175], a[60:63], a[96:99], v[172:175]
ds_read_b64_tr_b16 a[68:69], v5 offset:32768
v_mfma_f32_16x16x32_bf16 v[36:39], a[32:35], a[100:103], v[36:39]
buffer_load_dwordx4 v1, s[12:15], s36 offen offset:0 lds
v_mfma_f32_16x16x32_bf16 v[176:179], a[36:39], a[100:103], v[176:179]
ds_read_b64_tr_b16 a[70:71], v5 offset:33792
v_mfma_f32_16x16x32_bf16 v[68:71], a[40:43], a[100:103], v[68:71]
v_mfma_f32_16x16x32_bf16 v[180:183], a[44:47], a[100:103], v[180:183]
ds_read_b128 a[4:7], v12 offset:2048
v_mfma_f32_16x16x32_bf16 v[100:103], a[48:51], a[100:103], v[100:103]
s_add_u32 s36, s32, 2391040
v_mfma_f32_16x16x32_bf16 v[184:187], a[52:55], a[100:103], v[184:187]
ds_read_b64_tr_b16 a[72:73], v6 offset:32768
v_mfma_f32_16x16x32_bf16 v[132:135], a[56:59], a[100:103], v[132:135]
v_mfma_f32_16x16x32_bf16 v[188:191], a[60:63], a[100:103], v[188:191]
ds_read_b64_tr_b16 a[74:75], v6 offset:33792
v_mfma_f32_16x16x32_bf16 v[40:43], a[32:35], a[104:107], v[40:43]
buffer_load_dwordx4 v1, s[12:15], s36 offen offset:1024 lds
v_mfma_f32_16x16x32_bf16 v[192:195], a[36:39], a[104:107], v[192:195]
ds_read_b128 a[8:11], v12 offset:4096
v_mfma_f32_16x16x32_bf16 v[72:75], a[40:43], a[104:107], v[72:75]
v_mfma_f32_16x16x32_bf16 v[196:199], a[44:47], a[104:107], v[196:199]
ds_read_b64_tr_b16 a[76:77], v7 offset:32768
v_mfma_f32_16x16x32_bf16 v[104:107], a[48:51], a[104:107], v[104:107]
s_add_u32 m0, s33, 24576
v_mfma_f32_16x16x32_bf16 v[200:203], a[52:55], a[104:107], v[200:203]
ds_read_b64_tr_b16 a[78:79], v7 offset:33792
v_mfma_f32_16x16x32_bf16 v[136:139], a[56:59], a[104:107], v[136:139]
v_mfma_f32_16x16x32_bf16 v[204:207], a[60:63], a[104:107], v[204:207]
ds_read_b128 a[12:15], v12 offset:6144
v_mfma_f32_16x16x32_bf16 v[44:47], a[32:35], a[108:111], v[44:47]
s_add_u32 s36, s32, 2359296
v_mfma_f32_16x16x32_bf16 v[208:211], a[36:39], a[108:111], v[208:211]
ds_read_b64_tr_b16 a[80:81], v8 offset:32768
v_mfma_f32_16x16x32_bf16 v[76:79], a[40:43], a[108:111], v[76:79]
v_mfma_f32_16x16x32_bf16 v[212:215], a[44:47], a[108:111], v[212:215]
ds_read_b64_tr_b16 a[82:83], v8 offset:33792
v_mfma_f32_16x16x32_bf16 v[108:111], a[48:51], a[108:111], v[108:111]
buffer_load_dwordx4 v1, s[16:19], s36 offen offset:0 lds
v_mfma_f32_16x16x32_bf16 v[216:219], a[52:55], a[108:111], v[216:219]
ds_read_b128 a[16:19], v12 offset:8192
v_mfma_f32_16x16x32_bf16 v[140:143], a[56:59], a[108:111], v[140:143]
v_mfma_f32_16x16x32_bf16 v[220:223], a[60:63], a[108:111], v[220:223]
ds_read_b64_tr_b16 a[84:85], v9 offset:32768
v_mfma_f32_16x16x32_bf16 v[48:51], a[32:35], a[112:115], v[48:51]
s_add_u32 s36, s32, 2391040
v_mfma_f32_16x16x32_bf16 v[224:227], a[36:39], a[112:115], v[224:227]
ds_read_b64_tr_b16 a[86:87], v9 offset:33792
v_mfma_f32_16x16x32_bf16 v[80:83], a[40:43], a[112:115], v[80:83]
v_mfma_f32_16x16x32_bf16 v[228:231], a[44:47], a[112:115], v[228:231]
ds_read_b128 a[20:23], v12 offset:10240
v_mfma_f32_16x16x32_bf16 v[112:115], a[48:51], a[112:115], v[112:115]
buffer_load_dwordx4 v1, s[16:19], s36 offen offset:1024 lds
v_mfma_f32_16x16x32_bf16 v[232:235], a[52:55], a[112:115], v[232:235]
ds_read_b64_tr_b16 a[88:89], v10 offset:32768
v_mfma_f32_16x16x32_bf16 v[144:147], a[56:59], a[112:115], v[144:147]
v_mfma_f32_16x16x32_bf16 v[236:239], a[60:63], a[112:115], v[236:239]
ds_read_b64_tr_b16 a[90:91], v10 offset:33792
v_mfma_f32_16x16x32_bf16 v[52:55], a[32:35], a[116:119], v[52:55]
s_add_u32 m0, s35, 65536
v_mfma_f32_16x16x32_bf16 v[240:243], a[36:39], a[116:119], v[240:243]
ds_read_b128 a[24:27], v12 offset:12288
v_mfma_f32_16x16x32_bf16 v[84:87], a[40:43], a[116:119], v[84:87]
v_mfma_f32_16x16x32_bf16 v[244:247], a[44:47], a[116:119], v[244:247]
ds_read_b64_tr_b16 a[92:93], v11 offset:32768
v_mfma_f32_16x16x32_bf16 v[116:119], a[48:51], a[116:119], v[116:119]
s_add_u32 s37, s34, 640
v_mfma_f32_16x16x32_bf16 v[248:251], a[52:55], a[116:119], v[248:251]
ds_read_b64_tr_b16 a[94:95], v11 offset:33792
v_mfma_f32_16x16x32_bf16 v[148:151], a[56:59], a[116:119], v[148:151]
v_mfma_f32_16x16x32_bf16 v[252:255], a[60:63], a[116:119], v[252:255]
ds_read_b128 a[28:31], v12 offset:14336
v_mfma_f32_16x16x32_bf16 v[56:59], a[32:35], a[120:123], v[56:59]
buffer_load_dwordx4 v2, s[8:11], s37 offen offset:0 lds
v_mfma_f32_16x16x32_bf16 a[128:131], a[36:39], a[120:123], a[128:131]
v_mfma_f32_16x16x32_bf16 v[88:91], a[40:43], a[120:123], v[88:91]
s_add_u32 s37, s34, 7808
v_mfma_f32_16x16x32_bf16 a[132:135], a[44:47], a[120:123], a[132:135]
v_mfma_f32_16x16x32_bf16 v[120:123], a[48:51], a[120:123], v[120:123]
buffer_load_dwordx4 v3, s[8:11], s37 offen offset:1024 lds
v_mfma_f32_16x16x32_bf16 a[136:139], a[52:55], a[120:123], a[136:139]
v_mfma_f32_16x16x32_bf16 v[152:155], a[56:59], a[120:123], v[152:155]
s_add_u32 s37, s34, 14976
v_mfma_f32_16x16x32_bf16 a[140:143], a[60:63], a[120:123], a[140:143]
v_mfma_f32_16x16x32_bf16 v[60:63], a[32:35], a[124:127], v[60:63]
buffer_load_dwordx4 v2, s[8:11], s37 offen offset:2048 lds
v_mfma_f32_16x16x32_bf16 a[144:147], a[36:39], a[124:127], a[144:147]
v_mfma_f32_16x16x32_bf16 v[92:95], a[40:43], a[124:127], v[92:95]
s_add_u32 s37, s34, 22144
v_mfma_f32_16x16x32_bf16 a[148:151], a[44:47], a[124:127], a[148:151]
v_mfma_f32_16x16x32_bf16 v[124:127], a[48:51], a[124:127], v[124:127]
buffer_load_dwordx4 v3, s[8:11], s37 offen offset:3072 lds
v_mfma_f32_16x16x32_bf16 a[152:155], a[52:55], a[124:127], a[152:155]
v_mfma_f32_16x16x32_bf16 v[156:159], a[56:59], a[124:127], v[156:159]
s_lshr_b32 s68, s2, 5
s_lshl_b32 s68, s68, 7
s_and_b32 s69, s2, 31
s_lshl_b32 s69, s69, 2
s_add_u32 s68, s68, s69
s_add_u32 s68, s68, 113246208
s_cmp_eq_u32 s28, 0
s_cselect_b32 s68, s68, 0x10000000
v_mov_b32 v26, 1
s_mov_b64 exec, 1
buffer_store_dword v26, off, s[20:23], s68 sc1
s_mov_b64 exec, -1
s_nop 1
v_mfma_f32_16x16x32_bf16 a[156:159], a[60:63], a[124:127], a[156:159]
s_waitcnt lgkmcnt(0)
s_waitcnt vmcnt(23)
v_mfma_f32_16x16x32_bf16 v[32:35], a[0:3], a[64:67], v[32:35]
s_barrier
v_mfma_f32_16x16x32_bf16 v[160:163], a[4:7], a[64:67], v[160:163]
ds_read_b64_tr_b16 a[96:97], v4 offset:49152
v_mfma_f32_16x16x32_bf16 v[64:67], a[8:11], a[64:67], v[64:67]
s_add_u32 m0, s33, 32768
v_mfma_f32_16x16x32_bf16 v[164:167], a[12:15], a[64:67], v[164:167]
ds_read_b64_tr_b16 a[98:99], v4 offset:50176
v_mfma_f32_16x16x32_bf16 v[96:99], a[16:19], a[64:67], v[96:99]
v_mfma_f32_16x16x32_bf16 v[168:171], a[20:23], a[64:67], v[168:171]
ds_read_b128 a[32:35], v13 offset:0
v_mfma_f32_16x16x32_bf16 v[128:131], a[24:27], a[64:67], v[128:131]
s_add_u32 s36, s32, 2621440
v_mfma_f32_16x16x32_bf16 v[172:175], a[28:31], a[64:67], v[172:175]
ds_read_b64_tr_b16 a[100:101], v5 offset:49152
v_mfma_f32_16x16x32_bf16 v[36:39], a[0:3], a[68:71], v[36:39]
v_mfma_f32_16x16x32_bf16 v[176:179], a[4:7], a[68:71], v[176:179]
ds_read_b64_tr_b16 a[102:103], v5 offset:50176
v_mfma_f32_16x16x32_bf16 v[68:71], a[8:11], a[68:71], v[68:71]
buffer_load_dwordx4 v1, s[12:15], s36 offen offset:0 lds
v_mfma_f32_16x16x32_bf16 v[180:183], a[12:15], a[68:71], v[180:183]
ds_read_b128 a[36:39], v13 offset:2048
v_mfma_f32_16x16x32_bf16 v[100:103], a[16:19], a[68:71], v[100:103]
v_mfma_f32_16x16x32_bf16 v[184:187], a[20:23], a[68:71], v[184:187]
ds_read_b64_tr_b16 a[104:105], v6 offset:49152
v_mfma_f32_16x16x32_bf16 v[132:135], a[24:27], a[68:71], v[132:135]
s_add_u32 s36, s32, 2653184
v_mfma_f32_16x16x32_bf16 v[188:191], a[28:31], a[68:71], v[188:191]
ds_read_b64_tr_b16 a[106:107], v6 offset:50176
v_mfma_f32_16x16x32_bf16 v[40:43], a[0:3], a[72:75], v[40:43]
v_mfma_f32_16x16x32_bf16 v[192:195], a[4:7], a[72:75], v[192:195]
ds_read_b128 a[40:43], v13 offset:4096
v_mfma_f32_16x16x32_bf16 v[72:75], a[8:11], a[72:75], v[72:75]
buffer_load_dwordx4 v1, s[12:15], s36 offen offset:1024 lds
v_mfma_f32_16x16x32_bf16 v[196:199], a[12:15], a[72:75], v[196:199]
ds_read_b64_tr_b16 a[108:109], v7 offset:49152
v_mfma_f32_16x16x32_bf16 v[104:107], a[16:19], a[72:75], v[104:107]
v_mfma_f32_16x16x32_bf16 v[200:203], a[20:23], a[72:75], v[200:203]
ds_read_b64_tr_b16 a[110:111], v7 offset:50176
v_mfma_f32_16x16x32_bf16 v[136:139], a[24:27], a[72:75], v[136:139]
s_add_u32 m0, s33, 40960
v_mfma_f32_16x16x32_bf16 v[204:207], a[28:31], a[72:75], v[204:207]
ds_read_b128 a[44:47], v13 offset:6144
v_mfma_f32_16x16x32_bf16 v[44:47], a[0:3], a[76:79], v[44:47]
v_mfma_f32_16x16x32_bf16 v[208:211], a[4:7], a[76:79], v[208:211]
ds_read_b64_tr_b16 a[112:113], v8 offset:49152
v_mfma_f32_16x16x32_bf16 v[76:79], a[8:11], a[76:79], v[76:79]
s_add_u32 s36, s32, 2621440
v_mfma_f32_16x16x32_bf16 v[212:215], a[12:15], a[76:79], v[212:215]
ds_read_b64_tr_b16 a[114:115], v8 offset:50176
v_mfma_f32_16x16x32_bf16 v[108:111], a[16:19], a[76:79], v[108:111]
v_mfma_f32_16x16x32_bf16 v[216:219], a[20:23], a[76:79], v[216:219]
ds_read_b128 a[48:51], v13 offset:8192
v_mfma_f32_16x16x32_bf16 v[140:143], a[24:27], a[76:79], v[140:143]
buffer_load_dwordx4 v1, s[16:19], s36 offen offset:0 lds
v_mfma_f32_16x16x32_bf16 v[220:223], a[28:31], a[76:79], v[220:223]
ds_read_b64_tr_b16 a[116:117], v9 offset:49152
v_mfma_f32_16x16x32_bf16 v[48:51], a[0:3], a[80:83], v[48:51]
v_mfma_f32_16x16x32_bf16 v[224:227], a[4:7], a[80:83], v[224:227]
ds_read_b64_tr_b16 a[118:119], v9 offset:50176
v_mfma_f32_16x16x32_bf16 v[80:83], a[8:11], a[80:83], v[80:83]
s_add_u32 s36, s32, 2653184
v_mfma_f32_16x16x32_bf16 v[228:231], a[12:15], a[80:83], v[228:231]
ds_read_b128 a[52:55], v13 offset:10240
v_mfma_f32_16x16x32_bf16 v[112:115], a[16:19], a[80:83], v[112:115]
v_mfma_f32_16x16x32_bf16 v[232:235], a[20:23], a[80:83], v[232:235]
ds_read_b64_tr_b16 a[120:121], v10 offset:49152
v_mfma_f32_16x16x32_bf16 v[144:147], a[24:27], a[80:83], v[144:147]
buffer_load_dwordx4 v1, s[16:19], s36 offen offset:1024 lds
v_mfma_f32_16x16x32_bf16 v[236:239], a[28:31], a[80:83], v[236:239]
ds_read_b64_tr_b16 a[122:123], v10 offset:50176
v_mfma_f32_16x16x32_bf16 v[52:55], a[0:3], a[84:87], v[52:55]
v_mfma_f32_16x16x32_bf16 v[240:243], a[4:7], a[84:87], v[240:243]
ds_read_b128 a[56:59], v13 offset:12288
v_mfma_f32_16x16x32_bf16 v[84:87], a[8:11], a[84:87], v[84:87]
s_add_u32 m0, s35, 69632
v_mfma_f32_16x16x32_bf16 v[244:247], a[12:15], a[84:87], v[244:247]
ds_read_b64_tr_b16 a[124:125], v11 offset:49152
v_mfma_f32_16x16x32_bf16 v[116:119], a[16:19], a[84:87], v[116:119]
v_mfma_f32_16x16x32_bf16 v[248:251], a[20:23], a[84:87], v[248:251]
ds_read_b64_tr_b16 a[126:127], v11 offset:50176
v_mfma_f32_16x16x32_bf16 v[148:151], a[24:27], a[84:87], v[148:151]
s_add_u32 s37, s34, 33408
v_mfma_f32_16x16x32_bf16 v[252:255], a[28:31], a[84:87], v[252:255]
ds_read_b128 a[60:63], v13 offset:14336
v_mfma_f32_16x16x32_bf16 v[56:59], a[0:3], a[88:91], v[56:59]
v_mfma_f32_16x16x32_bf16 a[128:131], a[4:7], a[88:91], a[128:131]
buffer_load_dwordx4 v2, s[8:11], s37 offen offset:0 lds
v_mfma_f32_16x16x32_bf16 v[88:91], a[8:11], a[88:91], v[88:91]
v_mfma_f32_16x16x32_bf16 a[132:135], a[12:15], a[88:91], a[132:135]
s_add_u32 s37, s34, 40576
v_mfma_f32_16x16x32_bf16 v[120:123], a[16:19], a[88:91], v[120:123]
v_mfma_f32_16x16x32_bf16 a[136:139], a[20:23], a[88:91], a[136:139]
buffer_load_dwordx4 v3, s[8:11], s37 offen offset:1024 lds
v_mfma_f32_16x16x32_bf16 v[152:155], a[24:27], a[88:91], v[152:155]
v_mfma_f32_16x16x32_bf16 a[140:143], a[28:31], a[88:91], a[140:143]
s_add_u32 s37, s34, 47744
v_mfma_f32_16x16x32_bf16 v[60:63], a[0:3], a[92:95], v[60:63]
v_mfma_f32_16x16x32_bf16 a[144:147], a[4:7], a[92:95], a[144:147]
buffer_load_dwordx4 v2, s[8:11], s37 offen offset:2048 lds
v_mfma_f32_16x16x32_bf16 v[92:95], a[8:11], a[92:95], v[92:95]
v_mfma_f32_16x16x32_bf16 a[148:151], a[12:15], a[92:95], a[148:151]
s_add_u32 s37, s34, 54912
v_mfma_f32_16x16x32_bf16 v[124:127], a[16:19], a[92:95], v[124:127]
v_mfma_f32_16x16x32_bf16 a[152:155], a[20:23], a[92:95], a[152:155]
buffer_load_dwordx4 v3, s[8:11], s37 offen offset:3072 lds
v_mfma_f32_16x16x32_bf16 v[156:159], a[24:27], a[92:95], v[156:159]
v_mfma_f32_16x16x32_bf16 a[156:159], a[28:31], a[92:95], a[156:159]
s_waitcnt lgkmcnt(0)
s_waitcnt vmcnt(18)
v_mfma_f32_16x16x32_bf16 v[32:35], a[32:35], a[96:99], v[32:35]
s_barrier
v_mfma_f32_16x16x32_bf16 v[160:163], a[36:39], a[96:99], v[160:163]
ds_read_b64_tr_b16 a[64:65], v4 offset:0
v_mfma_f32_16x16x32_bf16 v[64:67], a[40:43], a[96:99], v[64:67]
s_add_u32 m0, s33, 49152
v_mfma_f32_16x16x32_bf16 v[164:167], a[44:47], a[96:99], v[164:167]
ds_read_b64_tr_b16 a[66:67], v4 offset:1024
v_mfma_f32_16x16x32_bf16 v[96:99], a[48:51], a[96:99], v[96:99]
v_mfma_f32_16x16x32_bf16 v[168:171], a[52:55], a[96:99], v[168:171]
ds_read_b128 a[0:3], v12 offset:32768
v_mfma_f32_16x16x32_bf16 v[128:131], a[56:59], a[96:99], v[128:131]
s_add_u32 s36, s32, 2883584
v_mfma_f32_16x16x32_bf16 v[172:175], a[60:63], a[96:99], v[172:175]
ds_read_b64_tr_b16 a[68:69], v5 offset:0
v_mfma_f32_16x16x32_bf16 v[36:39], a[32:35], a[100:103], v[36:39]
v_mfma_f32_16x16x32_bf16 v[176:179], a[36:39], a[100:103], v[176:179]
ds_read_b64_tr_b16 a[70:71], v5 offset:1024
v_mfma_f32_16x16x32_bf16 v[68:71], a[40:43], a[100:103], v[68:71]
buffer_load_dwordx4 v1, s[12:15], s36 offen offset:0 lds
v_mfma_f32_16x16x32_bf16 v[180:183], a[44:47], a[100:103], v[180:183]
ds_read_b128 a[4:7], v12 offset:34816
v_mfma_f32_16x16x32_bf16 v[100:103], a[48:51], a[100:103], v[100:103]
v_mfma_f32_16x16x32_bf16 v[184:187], a[52:55], a[100:103], v[184:187]
ds_read_b64_tr_b16 a[72:73], v6 offset:0
v_mfma_f32_16x16x32_bf16 v[132:135], a[56:59], a[100:103], v[132:135]
s_add_u32 s36, s32, 2915328
v_mfma_f32_16x16x32_bf16 v[188:191], a[60:63], a[100:103], v[188:191]
ds_read_b64_tr_b16 a[74:75], v6 offset:1024
v_mfma_f32_16x16x32_bf16 v[40:43], a[32:35], a[104:107], v[40:43]
v_mfma_f32_16x16x32_bf16 v[192:195], a[36:39], a[104:107], v[192:195]
ds_read_b128 a[8:11], v12 offset:36864
v_mfma_f32_16x16x32_bf16 v[72:75], a[40:43], a[104:107], v[72:75]
buffer_load_dwordx4 v1, s[12:15], s36 offen offset:1024 lds
v_mfma_f32_16x16x32_bf16 v[196:199], a[44:47], a[104:107], v[196:199]
ds_read_b64_tr_b16 a[76:77], v7 offset:0
v_mfma_f32_16x16x32_bf16 v[104:107], a[48:51], a[104:107], v[104:107]
v_mfma_f32_16x16x32_bf16 v[200:203], a[52:55], a[104:107], v[200:203]
ds_read_b64_tr_b16 a[78:79], v7 offset:1024
v_mfma_f32_16x16x32_bf16 v[136:139], a[56:59], a[104:107], v[136:139]
s_add_u32 m0, s33, 57344
v_mfma_f32_16x16x32_bf16 v[204:207], a[60:63], a[104:107], v[204:207]
ds_read_b128 a[12:15], v12 offset:38912
v_mfma_f32_16x16x32_bf16 v[44:47], a[32:35], a[108:111], v[44:47]
v_mfma_f32_16x16x32_bf16 v[208:211], a[36:39], a[108:111], v[208:211]
ds_read_b64_tr_b16 a[80:81], v8 offset:0
v_mfma_f32_16x16x32_bf16 v[76:79], a[40:43], a[108:111], v[76:79]
s_add_u32 s36, s32, 2883584
v_mfma_f32_16x16x32_bf16 v[212:215], a[44:47], a[108:111], v[212:215]
ds_read_b64_tr_b16 a[82:83], v8 offset:1024
v_mfma_f32_16x16x32_bf16 v[108:111], a[48:51], a[108:111], v[108:111]
v_mfma_f32_16x16x32_bf16 v[216:219], a[52:55], a[108:111], v[216:219]
ds_read_b128 a[16:19], v12 offset:40960
v_mfma_f32_16x16x32_bf16 v[140:143], a[56:59], a[108:111], v[140:143]
buffer_load_dwordx4 v1, s[16:19], s36 offen offset:0 lds
v_mfma_f32_16x16x32_bf16 v[220:223], a[60:63], a[108:111], v[220:223]
ds_read_b64_tr_b16 a[84:85], v9 offset:0
v_mfma_f32_16x16x32_bf16 v[48:51], a[32:35], a[112:115], v[48:51]
v_mfma_f32_16x16x32_bf16 v[224:227], a[36:39], a[112:115], v[224:227]
ds_read_b64_tr_b16 a[86:87], v9 offset:1024
v_mfma_f32_16x16x32_bf16 v[80:83], a[40:43], a[112:115], v[80:83]
s_add_u32 s36, s32, 2915328
v_mfma_f32_16x16x32_bf16 v[228:231], a[44:47], a[112:115], v[228:231]
ds_read_b128 a[20:23], v12 offset:43008
v_mfma_f32_16x16x32_bf16 v[112:115], a[48:51], a[112:115], v[112:115]
v_mfma_f32_16x16x32_bf16 v[232:235], a[52:55], a[112:115], v[232:235]
ds_read_b64_tr_b16 a[88:89], v10 offset:0
v_mfma_f32_16x16x32_bf16 v[144:147], a[56:59], a[112:115], v[144:147]
buffer_load_dwordx4 v1, s[16:19], s36 offen offset:1024 lds
v_mfma_f32_16x16x32_bf16 v[236:239], a[60:63], a[112:115], v[236:239]
ds_read_b64_tr_b16 a[90:91], v10 offset:1024
v_mfma_f32_16x16x32_bf16 v[52:55], a[32:35], a[116:119], v[52:55]
v_mfma_f32_16x16x32_bf16 v[240:243], a[36:39], a[116:119], v[240:243]
ds_read_b128 a[24:27], v12 offset:45056
v_mfma_f32_16x16x32_bf16 v[84:87], a[40:43], a[116:119], v[84:87]
s_add_u32 m0, s35, 0
v_mfma_f32_16x16x32_bf16 v[244:247], a[44:47], a[116:119], v[244:247]
ds_read_b64_tr_b16 a[92:93], v11 offset:0
v_mfma_f32_16x16x32_bf16 v[116:119], a[48:51], a[116:119], v[116:119]
v_mfma_f32_16x16x32_bf16 v[248:251], a[52:55], a[116:119], v[248:251]
ds_read_b64_tr_b16 a[94:95], v11 offset:1024
v_mfma_f32_16x16x32_bf16 v[148:151], a[56:59], a[116:119], v[148:151]
s_add_u32 s37, s34, 768
v_mfma_f32_16x16x32_bf16 v[252:255], a[60:63], a[116:119], v[252:255]
ds_read_b128 a[28:31], v12 offset:47104
v_mfma_f32_16x16x32_bf16 v[56:59], a[32:35], a[120:123], v[56:59]
v_mfma_f32_16x16x32_bf16 a[128:131], a[36:39], a[120:123], a[128:131]
buffer_load_dwordx4 v2, s[8:11], s37 offen offset:0 lds
v_mfma_f32_16x16x32_bf16 v[88:91], a[40:43], a[120:123], v[88:91]
v_mfma_f32_16x16x32_bf16 a[132:135], a[44:47], a[120:123], a[132:135]
s_add_u32 s37, s34, 7936
v_mfma_f32_16x16x32_bf16 v[120:123], a[48:51], a[120:123], v[120:123]
v_mfma_f32_16x16x32_bf16 a[136:139], a[52:55], a[120:123], a[136:139]
buffer_load_dwordx4 v3, s[8:11], s37 offen offset:1024 lds
v_mfma_f32_16x16x32_bf16 v[152:155], a[56:59], a[120:123], v[152:155]
v_mfma_f32_16x16x32_bf16 a[140:143], a[60:63], a[120:123], a[140:143]
s_add_u32 s37, s34, 15104
v_mfma_f32_16x16x32_bf16 v[60:63], a[32:35], a[124:127], v[60:63]
v_mfma_f32_16x16x32_bf16 a[144:147], a[36:39], a[124:127], a[144:147]
buffer_load_dwordx4 v2, s[8:11], s37 offen offset:2048 lds
v_mfma_f32_16x16x32_bf16 v[92:95], a[40:43], a[124:127], v[92:95]
v_mfma_f32_16x16x32_bf16 a[148:151], a[44:47], a[124:127], a[148:151]
s_add_u32 s37, s34, 22272
v_mfma_f32_16x16x32_bf16 v[124:127], a[48:51], a[124:127], v[124:127]
v_mfma_f32_16x16x32_bf16 a[152:155], a[52:55], a[124:127], a[152:155]
buffer_load_dwordx4 v3, s[8:11], s37 offen offset:3072 lds
v_mfma_f32_16x16x32_bf16 v[156:159], a[56:59], a[124:127], v[156:159]
v_mfma_f32_16x16x32_bf16 a[156:159], a[60:63], a[124:127], a[156:159]
s_waitcnt lgkmcnt(0)
s_waitcnt vmcnt(21)
v_mfma_f32_16x16x32_bf16 v[32:35], a[0:3], a[64:67], v[32:35]
s_barrier
v_mfma_f32_16x16x32_bf16 v[160:163], a[4:7], a[64:67], v[160:163]
ds_read_b64_tr_b16 a[96:97], v4 offset:16384
v_mfma_f32_16x16x32_bf16 v[64:67], a[8:11], a[64:67], v[64:67]
s_add_u32 m0, s33, 0
v_mfma_f32_16x16x32_bf16 v[164:167], a[12:15], a[64:67], v[164:167]
ds_read_b64_tr_b16 a[98:99], v4 offset:17408
v_mfma_f32_16x16x32_bf16 v[96:99], a[16:19], a[64:67], v[96:99]
s_add_u32 s36, s32, 3145728
v_mfma_f32_16x16x32_bf16 v[168:171], a[20:23], a[64:67], v[168:171]
ds_read_b128 a[32:35], v13 offset:32768
v_mfma_f32_16x16x32_bf16 v[128:131], a[24:27], a[64:67], v[128:131]
buffer_load_dwordx4 v1, s[12:15], s36 offen offset:0 lds
v_mfma_f32_16x16x32_bf16 v[172:175], a[28:31], a[64:67], v[172:175]
ds_read_b64_tr_b16 a[100:101], v5 offset:16384
v_mfma_f32_16x16x32_bf16 v[36:39], a[0:3], a[68:71], v[36:39]
s_add_u32 s36, s32, 3177472
v_mfma_f32_16x16x32_bf16 v[176:179], a[4:7], a[68:71], v[176:179]
ds_read_b64_tr_b16 a[102:103], v5 offset:17408
v_mfma_f32_16x16x32_bf16 v[68:71], a[8:11], a[68:71], v[68:71]
buffer_load_dwordx4 v1, s[12:15], s36 offen offset:1024 lds
v_mfma_f32_16x16x32_bf16 v[180:183], a[12:15], a[68:71], v[180:183]
ds_read_b128 a[36:39], v13 offset:34816
v_mfma_f32_16x16x32_bf16 v[100:103], a[16:19], a[68:71], v[100:103]
s_add_u32 m0, s33, 8192
v_mfma_f32_16x16x32_bf16 v[184:187], a[20:23], a[68:71], v[184:187]
ds_read_b64_tr_b16 a[104:105], v6 offset:16384
v_mfma_f32_16x16x32_bf16 v[132:135], a[24:27], a[68:71], v[132:135]
s_add_u32 s36, s32, 3145728
v_mfma_f32_16x16x32_bf16 v[188:191], a[28:31], a[68:71], v[188:191]
ds_read_b64_tr_b16 a[106:107], v6 offset:17408
v_mfma_f32_16x16x32_bf16 v[40:43], a[0:3], a[72:75], v[40:43]
buffer_load_dwordx4 v1, s[16:19], s36 offen offset:0 lds
v_mfma_f32_16x16x32_bf16 v[192:195], a[4:7], a[72:75], v[192:195]
ds_read_b128 a[40:43], v13 offset:36864
v_mfma_f32_16x16x32_bf16 v[72:75], a[8:11], a[72:75], v[72:75]
s_add_u32 s36, s32, 3177472
v_mfma_f32_16x16x32_bf16 v[196:199], a[12:15], a[72:75], v[196:199]
ds_read_b64_tr_b16 a[108:109], v7 offset:16384
v_mfma_f32_16x16x32_bf16 v[104:107], a[16:19], a[72:75], v[104:107]
buffer_load_dwordx4 v1, s[16:19], s36 offen offset:1024 lds
v_mfma_f32_16x16x32_bf16 v[200:203], a[20:23], a[72:75], v[200:203]
ds_read_b64_tr_b16 a[110:111], v7 offset:17408
v_mfma_f32_16x16x32_bf16 v[136:139], a[24:27], a[72:75], v[136:139]
s_add_u32 m0, s35, 4096
v_mfma_f32_16x16x32_bf16 v[204:207], a[28:31], a[72:75], v[204:207]
ds_read_b128 a[44:47], v13 offset:38912
v_mfma_f32_16x16x32_bf16 v[44:47], a[0:3], a[76:79], v[44:47]
s_add_u32 s37, s34, 33536
v_mfma_f32_16x16x32_bf16 v[208:211], a[4:7], a[76:79], v[208:211]
ds_read_b64_tr_b16 a[112:113], v8 offset:16384
v_mfma_f32_16x16x32_bf16 v[76:79], a[8:11], a[76:79], v[76:79]
buffer_load_dwordx4 v2, s[8:11], s37 offen offset:0 lds
v_mfma_f32_16x16x32_bf16 v[212:215], a[12:15], a[76:79], v[212:215]
ds_read_b64_tr_b16 a[114:115], v8 offset:17408
v_mfma_f32_16x16x32_bf16 v[108:111], a[16:19], a[76:79], v[108:111]
s_add_u32 s37, s34, 40704
v_mfma_f32_16x16x32_bf16 v[216:219], a[20:23], a[76:79], v[216:219]
ds_read_b128 a[48:51], v13 offset:40960
v_mfma_f32_16x16x32_bf16 v[140:143], a[24:27], a[76:79], v[140:143]
buffer_load_dwordx4 v3, s[8:11], s37 offen offset:1024 lds
v_mfma_f32_16x16x32_bf16 v[220:223], a[28:31], a[76:79], v[220:223]
ds_read_b64_tr_b16 a[116:117], v9 offset:16384
v_mfma_f32_16x16x32_bf16 v[48:51], a[0:3], a[80:83], v[48:51]
s_add_u32 s37, s34, 47872
v_mfma_f32_16x16x32_bf16 v[224:227], a[4:7], a[80:83], v[224:227]
ds_read_b64_tr_b16 a[118:119], v9 offset:17408
v_mfma_f32_16x16x32_bf16 v[80:83], a[8:11], a[80:83], v[80:83]
buffer_load_dwordx4 v2, s[8:11], s37 offen offset:2048 lds
v_mfma_f32_16x16x32_bf16 v[228:231], a[12:15], a[80:83], v[228:231]
ds_read_b128 a[52:55], v13 offset:43008
v_mfma_f32_16x16x32_bf16 v[112:115], a[16:19], a[80:83], v[112:115]
s_add_u32 s37, s34, 55040
v_mfma_f32_16x16x32_bf16 v[232:235], a[20:23], a[80:83], v[232:235]
ds_read_b64_tr_b16 a[120:121], v10 offset:16384
v_mfma_f32_16x16x32_bf16 v[144:147], a[24:27], a[80:83], v[144:147]
buffer_load_dwordx4 v3, s[8:11], s37 offen offset:3072 lds
v_mfma_f32_16x16x32_bf16 v[236:239], a[28:31], a[80:83], v[236:239]
ds_read_b64_tr_b16 a[122:123], v10 offset:17408
v_mfma_f32_16x16x32_bf16 v[52:55], a[0:3], a[84:87], v[52:55]
v_mfma_f32_16x16x32_bf16 v[240:243], a[4:7], a[84:87], v[240:243]
ds_read_b128 a[56:59], v13 offset:45056
v_mfma_f32_16x16x32_bf16 v[84:87], a[8:11], a[84:87], v[84:87]
s_mov_b32 s40, s84
s_mov_b32 s41, s85
s_mov_b32 s42, 5308416
s_mov_b32 s43, 0x20000
v_mfma_f32_16x16x32_bf16 v[244:247], a[12:15], a[84:87], v[244:247]
ds_read_b64_tr_b16 a[124:125], v11 offset:16384
v_mfma_f32_16x16x32_bf16 v[116:119], a[16:19], a[84:87], v[116:119]
s_lshr_b32 s3, s2, 3
s_lshl_b32 s3, s3, 2
s_add_u32 s3, s3, s28
s_mul_i32 s3, s3, 41
v_mfma_f32_16x16x32_bf16 v[248:251], a[20:23], a[84:87], v[248:251]
ds_read_b64_tr_b16 a[126:127], v11 offset:17408
v_mfma_f32_16x16x32_bf16 v[148:151], a[24:27], a[84:87], v[148:151]
v_add_u32 v26, s3, v0
v_mfma_f32_16x16x32_bf16 v[252:255], a[28:31], a[84:87], v[252:255]
ds_read_b128 a[60:63], v13 offset:47104
v_mfma_f32_16x16x32_bf16 v[56:59], a[0:3], a[88:91], v[56:59]
s_mov_b32 s4, 7282
v_mfma_f32_16x16x32_bf16 a[128:131], a[4:7], a[88:91], a[128:131]
v_mul_u32_u24 v27, s4, v26
v_mfma_f32_16x16x32_bf16 v[88:91], a[8:11], a[88:91], v[88:91]
v_lshrrev_b32 v27, 16, v27
v_mfma_f32_16x16x32_bf16 a[132:135], a[12:15], a[88:91], a[132:135]
v_mul_u32_u24 v30, 9, v27
v_mfma_f32_16x16x32_bf16 v[120:123], a[16:19], a[88:91], v[120:123]
v_sub_u32 v30, v26, v30
v_mfma_f32_16x16x32_bf16 a[136:139], a[20:23], a[88:91], a[136:139]
s_mov_b32 s5, 0
s_and_b32 s6, s2, 7
s_mul_i32 s6, s6, 1152
v_mfma_f32_16x16x32_bf16 v[152:155], a[24:27], a[88:91], v[152:155]
v_add_u32 v27, s5, v27
v_mfma_f32_16x16x32_bf16 a[140:143], a[28:31], a[88:91], a[140:143]
v_mul_u32_u24 v27, 9216, v27
v_mfma_f32_16x16x32_bf16 v[60:63], a[0:3], a[92:95], v[60:63]
v_lshl_add_u32 v27, v30, 7, v27
v_mfma_f32_16x16x32_bf16 a[144:147], a[4:7], a[92:95], a[144:147]
v_add_u32 v27, s6, v27
v_mfma_f32_16x16x32_bf16 v[92:95], a[8:11], a[92:95], v[92:95]
v_mov_b32 v30, 0x10000000
v_mfma_f32_16x16x32_bf16 a[148:151], a[12:15], a[92:95], a[148:151]
v_cmp_gt_u32 vcc, 41, v0
v_mfma_f32_16x16x32_bf16 v[124:127], a[16:19], a[92:95], v[124:127]
s_mov_b32 s4, 5184
v_cmp_gt_u32 s[6:7], s4, v26
v_mfma_f32_16x16x32_bf16 a[152:155], a[20:23], a[92:95], a[152:155]
s_nop 1
s_and_b64 vcc, vcc, s[6:7]
v_mfma_f32_16x16x32_bf16 v[156:159], a[24:27], a[92:95], v[156:159]
s_nop 1
v_cndmask_b32 v27, v30, v27, vcc
v_mfma_f32_16x16x32_bf16 a[156:159], a[28:31], a[92:95], a[156:159]
buffer_load_dword v30, v27, s[40:43], 0 offen
s_waitcnt lgkmcnt(0)
s_waitcnt vmcnt(17)
v_mfma_f32_16x16x32_bf16 v[32:35], a[32:35], a[96:99], v[32:35]
s_barrier
v_mfma_f32_16x16x32_bf16 v[160:163], a[36:39], a[96:99], v[160:163]
ds_read_b64_tr_b16 a[64:65], v4 offset:32768
v_mfma_f32_16x16x32_bf16 v[64:67], a[40:43], a[96:99], v[64:67]
s_add_u32 m0, s33, 16384
v_mfma_f32_16x16x32_bf16 v[164:167], a[44:47], a[96:99], v[164:167]
ds_read_b64_tr_b16 a[66:67], v4 offset:33792
v_mfma_f32_16x16x32_bf16 v[96:99], a[48:51], a[96:99], v[96:99]
s_add_u32 s36, s32, 3407872
v_mfma_f32_16x16x32_bf16 v[168:171], a[52:55], a[96:99], v[168:171]
ds_read_b128 a[0:3], v14 offset:0
v_mfma_f32_16x16x32_bf16 v[128:131], a[56:59], a[96:99], v[128:131]
v_mfma_f32_16x16x32_bf16 v[172:175], a[60:63], a[96:99], v[172:175]
ds_read_b64_tr_b16 a[68:69], v5 offset:32768
v_mfma_f32_16x16x32_bf16 v[36:39], a[32:35], a[100:103], v[36:39]
buffer_load_dwordx4 v1, s[12:15], s36 offen offset:0 lds
v_mfma_f32_16x16x32_bf16 v[176:179], a[36:39], a[100:103], v[176:179]
ds_read_b64_tr_b16 a[70:71], v5 offset:33792
v_mfma_f32_16x16x32_bf16 v[68:71], a[40:43], a[100:103], v[68:71]
v_mfma_f32_16x16x32_bf16 v[180:183], a[44:47], a[100:103], v[180:183]
ds_read_b128 a[4:7], v14 offset:2048
v_mfma_f32_16x16x32_bf16 v[100:103], a[48:51], a[100:103], v[100:103]
s_add_u32 s36, s32, 3439616
v_mfma_f32_16x16x32_bf16 v[184:187], a[52:55], a[100:103], v[184:187]
ds_read_b64_tr_b16 a[72:73], v6 offset:32768
v_mfma_f32_16x16x32_bf16 v[132:135], a[56:59], a[100:103], v[132:135]
v_mfma_f32_16x16x32_bf16 v[188:191], a[60:63], a[100:103], v[188:191]
ds_read_b64_tr_b16 a[74:75], v6 offset:33792
v_mfma_f32_16x16x32_bf16 v[40:43], a[32:35], a[104:107], v[40:43]
buffer_load_dwordx4 v1, s[12:15], s36 offen offset:1024 lds
v_mfma_f32_16x16x32_bf16 v[192:195], a[36:39], a[104:107], v[192:195]
ds_read_b128 a[8:11], v14 offset:4096
v_mfma_f32_16x16x32_bf16 v[72:75], a[40:43], a[104:107], v[72:75]
v_mfma_f32_16x16x32_bf16 v[196:199], a[44:47], a[104:107], v[196:199]
ds_read_b64_tr_b16 a[76:77], v7 offset:32768
v_mfma_f32_16x16x32_bf16 v[104:107], a[48:51], a[104:107], v[104:107]
s_add_u32 m0, s33, 24576
v_mfma_f32_16x16x32_bf16 v[200:203], a[52:55], a[104:107], v[200:203]
ds_read_b64_tr_b16 a[78:79], v7 offset:33792
v_mfma_f32_16x16x32_bf16 v[136:139], a[56:59], a[104:107], v[136:139]
v_mfma_f32_16x16x32_bf16 v[204:207], a[60:63], a[104:107], v[204:207]
ds_read_b128 a[12:15], v14 offset:6144
v_mfma_f32_16x16x32_bf16 v[44:47], a[32:35], a[108:111], v[44:47]
s_add_u32 s36, s32, 3407872
v_mfma_f32_16x16x32_bf16 v[208:211], a[36:39], a[108:111], v[208:211]
ds_read_b64_tr_b16 a[80:81], v8 offset:32768
v_mfma_f32_16x16x32_bf16 v[76:79], a[40:43], a[108:111], v[76:79]
v_mfma_f32_16x16x32_bf16 v[212:215], a[44:47], a[108:111], v[212:215]
ds_read_b64_tr_b16 a[82:83], v8 offset:33792
v_mfma_f32_16x16x32_bf16 v[108:111], a[48:51], a[108:111], v[108:111]
buffer_load_dwordx4 v1, s[16:19], s36 offen offset:0 lds
v_mfma_f32_16x16x32_bf16 v[216:219], a[52:55], a[108:111], v[216:219]
ds_read_b128 a[16:19], v14 offset:8192
v_mfma_f32_16x16x32_bf16 v[140:143], a[56:59], a[108:111], v[140:143]
v_mfma_f32_16x16x32_bf16 v[220:223], a[60:63], a[108:111], v[220:223]
ds_read_b64_tr_b16 a[84:85], v9 offset:32768
v_mfma_f32_16x16x32_bf16 v[48:51], a[32:35], a[112:115], v[48:51]
s_add_u32 s36, s32, 3439616
v_mfma_f32_16x16x32_bf16 v[224:227], a[36:39], a[112:115], v[224:227]
ds_read_b64_tr_b16 a[86:87], v9 offset:33792
v_mfma_f32_16x16x32_bf16 v[80:83], a[40:43], a[112:115], v[80:83]
v_mfma_f32_16x16x32_bf16 v[228:231], a[44:47], a[112:115], v[228:231]
ds_read_b128 a[20:23], v14 offset:10240
v_mfma_f32_16x16x32_bf16 v[112:115], a[48:51], a[112:115], v[112:115]
buffer_load_dwordx4 v1, s[16:19], s36 offen offset:1024 lds
v_mfma_f32_16x16x32_bf16 v[232:235], a[52:55], a[112:115], v[232:235]
ds_read_b64_tr_b16 a[88:89], v10 offset:32768
v_mfma_f32_16x16x32_bf16 v[144:147], a[56:59], a[112:115], v[144:147]
v_mfma_f32_16x16x32_bf16 v[236:239], a[60:63], a[112:115], v[236:239]
ds_read_b64_tr_b16 a[90:91], v10 offset:33792
v_mfma_f32_16x16x32_bf16 v[52:55], a[32:35], a[116:119], v[52:55]
s_add_u32 m0, s35, 32768
v_mfma_f32_16x16x32_bf16 v[240:243], a[36:39], a[116:119], v[240:243]
ds_read_b128 a[24:27], v14 offset:12288
v_mfma_f32_16x16x32_bf16 v[84:87], a[40:43], a[116:119], v[84:87]
v_mfma_f32_16x16x32_bf16 v[244:247], a[44:47], a[116:119], v[244:247]
ds_read_b64_tr_b16 a[92:93], v11 offset:32768
v_mfma_f32_16x16x32_bf16 v[116:119], a[48:51], a[116:119], v[116:119]
s_add_u32 s37, s34, 896
v_mfma_f32_16x16x32_bf16 v[248:251], a[52:55], a[116:119], v[248:251]
ds_read_b64_tr_b16 a[94:95], v11 offset:33792
v_mfma_f32_16x16x32_bf16 v[148:151], a[56:59], a[116:119], v[148:151]
v_mfma_f32_16x16x32_bf16 v[252:255], a[60:63], a[116:119], v[252:255]
ds_read_b128 a[28:31], v14 offset:14336
v_mfma_f32_16x16x32_bf16 v[56:59], a[32:35], a[120:123], v[56:59]
buffer_load_dwordx4 v2, s[8:11], s37 offen offset:0 lds
v_mfma_f32_16x16x32_bf16 a[128:131], a[36:39], a[120:123], a[128:131]
v_mfma_f32_16x16x32_bf16 v[88:91], a[40:43], a[120:123], v[88:91]
s_add_u32 s37, s34, 8064
v_mfma_f32_16x16x32_bf16 a[132:135], a[44:47], a[120:123], a[132:135]
v_mfma_f32_16x16x32_bf16 v[120:123], a[48:51], a[120:123], v[120:123]
buffer_load_dwordx4 v3, s[8:11], s37 offen offset:1024 lds
v_mfma_f32_16x16x32_bf16 a[136:139], a[52:55], a[120:123], a[136:139]
v_mfma_f32_16x16x32_bf16 v[152:155], a[56:59], a[120:123], v[152:155]
s_add_u32 s37, s34, 15232
v_mfma_f32_16x16x32_bf16 a[140:143], a[60:63], a[120:123], a[140:143]
v_mfma_f32_16x16x32_bf16 v[60:63], a[32:35], a[124:127], v[60:63]
buffer_load_dwordx4 v2, s[8:11], s37 offen offset:2048 lds
v_mfma_f32_16x16x32_bf16 a[144:147], a[36:39], a[124:127], a[144:147]
v_mfma_f32_16x16x32_bf16 v[92:95], a[40:43], a[124:127], v[92:95]
s_add_u32 s37, s34, 22400
v_mfma_f32_16x16x32_bf16 a[148:151], a[44:47], a[124:127], a[148:151]
v_mfma_f32_16x16x32_bf16 v[124:127], a[48:51], a[124:127], v[124:127]
buffer_load_dwordx4 v3, s[8:11], s37 offen offset:3072 lds
v_mfma_f32_16x16x32_bf16 a[152:155], a[52:55], a[124:127], a[152:155]
v_mfma_f32_16x16x32_bf16 v[156:159], a[56:59], a[124:127], v[156:159]
v_lshlrev_b32 v23, 2, v0
buffer_load_dword v23, v23, s[64:67], 0 offen sc1
v_mfma_f32_16x16x32_bf16 a[156:159], a[60:63], a[124:127], a[156:159]
s_waitcnt lgkmcnt(0)
s_waitcnt vmcnt(22)
v_mfma_f32_16x16x32_bf16 v[32:35], a[0:3], a[64:67], v[32:35]
s_barrier
v_mfma_f32_16x16x32_bf16 v[160:163], a[4:7], a[64:67], v[160:163]
ds_read_b64_tr_b16 a[96:97], v4 offset:49152
v_mfma_f32_16x16x32_bf16 v[64:67], a[8:11], a[64:67], v[64:67]
s_add_u32 m0, s33, 32768
v_mfma_f32_16x16x32_bf16 v[164:167], a[12:15], a[64:67], v[164:167]
ds_read_b64_tr_b16 a[98:99], v4 offset:50176
v_mfma_f32_16x16x32_bf16 v[96:99], a[16:19], a[64:67], v[96:99]
s_add_u32 s36, s32, 3670016
v_mfma_f32_16x16x32_bf16 v[168:171], a[20:23], a[64:67], v[168:171]
ds_read_b128 a[32:35], v15 offset:0
v_mfma_f32_16x16x32_bf16 v[128:131], a[24:27], a[64:67], v[128:131]
v_mfma_f32_16x16x32_bf16 v[172:175], a[28:31], a[64:67], v[172:175]
ds_read_b64_tr_b16 a[100:101], v5 offset:49152
v_mfma_f32_16x16x32_bf16 v[36:39], a[0:3], a[68:71], v[36:39]
buffer_load_dwordx4 v1, s[12:15], s36 offen offset:0 lds
v_mfma_f32_16x16x32_bf16 v[176:179], a[4:7], a[68:71], v[176:179]
ds_read_b64_tr_b16 a[102:103], v5 offset:50176
v_mfma_f32_16x16x32_bf16 v[68:71], a[8:11], a[68:71], v[68:71]
v_mfma_f32_16x16x32_bf16 v[180:183], a[12:15], a[68:71], v[180:183]
ds_read_b128 a[36:39], v15 offset:2048
v_mfma_f32_16x16x32_bf16 v[100:103], a[16:19], a[68:71], v[100:103]
s_add_u32 s36, s32, 3701760
v_mfma_f32_16x16x32_bf16 v[184:187], a[20:23], a[68:71], v[184:187]
ds_read_b64_tr_b16 a[104:105], v6 offset:49152
v_mfma_f32_16x16x32_bf16 v[132:135], a[24:27], a[68:71], v[132:135]
v_mfma_f32_16x16x32_bf16 v[188:191], a[28:31], a[68:71], v[188:191]
ds_read_b64_tr_b16 a[106:107], v6 offset:50176
v_mfma_f32_16x16x32_bf16 v[40:43], a[0:3], a[72:75], v[40:43]
buffer_load_dwordx4 v1, s[12:15], s36 offen offset:1024 lds
v_mfma_f32_16x16x32_bf16 v[192:195], a[4:7], a[72:75], v[192:195]
ds_read_b128 a[40:43], v15 offset:4096
v_mfma_f32_16x16x32_bf16 v[72:75], a[8:11], a[72:75], v[72:75]
v_mfma_f32_16x16x32_bf16 v[196:199], a[12:15], a[72:75], v[196:199]
ds_read_b64_tr_b16 a[108:109], v7 offset:49152
v_mfma_f32_16x16x32_bf16 v[104:107], a[16:19], a[72:75], v[104:107]
s_add_u32 m0, s33, 40960
v_mfma_f32_16x16x32_bf16 v[200:203], a[20:23], a[72:75], v[200:203]
ds_read_b64_tr_b16 a[110:111], v7 offset:50176
v_mfma_f32_16x16x32_bf16 v[136:139], a[24:27], a[72:75], v[136:139]
v_mfma_f32_16x16x32_bf16 v[204:207], a[28:31], a[72:75], v[204:207]
ds_read_b128 a[44:47], v15 offset:6144
v_mfma_f32_16x16x32_bf16 v[44:47], a[0:3], a[76:79], v[44:47]
s_add_u32 s36, s32, 3670016
v_mfma_f32_16x16x32_bf16 v[208:211], a[4:7], a[76:79], v[208:211]
ds_read_b64_tr_b16 a[112:113], v8 offset:49152
v_mfma_f32_16x16x32_bf16 v[76:79], a[8:11], a[76:79], v[76:79]
v_mfma_f32_16x16x32_bf16 v[212:215], a[12:15], a[76:79], v[212:215]
ds_read_b64_tr_b16 a[114:115], v8 offset:50176
v_mfma_f32_16x16x32_bf16 v[108:111], a[16:19], a[76:79], v[108:111]
buffer_load_dwordx4 v1, s[16:19], s36 offen offset:0 lds
v_mfma_f32_16x16x32_bf16 v[216:219], a[20:23], a[76:79], v[216:219]
ds_read_b128 a[48:51], v15 offset:8192
v_mfma_f32_16x16x32_bf16 v[140:143], a[24:27], a[76:79], v[140:143]
v_mfma_f32_16x16x32_bf16 v[220:223], a[28:31], a[76:79], v[220:223]
ds_read_b64_tr_b16 a[116:117], v9 offset:49152
v_mfma_f32_16x16x32_bf16 v[48:51], a[0:3], a[80:83], v[48:51]
s_add_u32 s36, s32, 3701760
v_mfma_f32_16x16x32_bf16 v[224:227], a[4:7], a[80:83], v[224:227]
ds_read_b64_tr_b16 a[118:119], v9 offset:50176
v_mfma_f32_16x16x32_bf16 v[80:83], a[8:11], a[80:83], v[80:83]
v_mfma_f32_16x16x32_bf16 v[228:231], a[12:15], a[80:83], v[228:231]
ds_read_b128 a[52:55], v15 offset:10240
v_mfma_f32_16x16x32_bf16 v[112:115], a[16:19], a[80:83], v[112:115]
buffer_load_dwordx4 v1, s[16:19], s36 offen offset:1024 lds
v_mfma_f32_16x16x32_bf16 v[232:235], a[20:23], a[80:83], v[232:235]
ds_read_b64_tr_b16 a[120:121], v10 offset:49152
v_mfma_f32_16x16x32_bf16 v[144:147], a[24:27], a[80:83], v[144:147]
v_mfma_f32_16x16x32_bf16 v[236:239], a[28:31], a[80:83], v[236:239]
ds_read_b64_tr_b16 a[122:123], v10 offset:50176
v_mfma_f32_16x16x32_bf16 v[52:55], a[0:3], a[84:87], v[52:55]
s_add_u32 m0, s35, 36864
v_mfma_f32_16x16x32_bf16 v[240:243], a[4:7], a[84:87], v[240:243]
ds_read_b128 a[56:59], v15 offset:12288
v_mfma_f32_16x16x32_bf16 v[84:87], a[8:11], a[84:87], v[84:87]
v_mfma_f32_16x16x32_bf16 v[244:247], a[12:15], a[84:87], v[244:247]
ds_read_b64_tr_b16 a[124:125], v11 offset:49152
v_mfma_f32_16x16x32_bf16 v[116:119], a[16:19], a[84:87], v[116:119]
s_add_u32 s37, s34, 33664
v_mfma_f32_16x16x32_bf16 v[248:251], a[20:23], a[84:87], v[248:251]
ds_read_b64_tr_b16 a[126:127], v11 offset:50176
v_mfma_f32_16x16x32_bf16 v[148:151], a[24:27], a[84:87], v[148:151]
v_mfma_f32_16x16x32_bf16 v[252:255], a[28:31], a[84:87], v[252:255]
ds_read_b128 a[60:63], v15 offset:14336
v_mfma_f32_16x16x32_bf16 v[56:59], a[0:3], a[88:91], v[56:59]
buffer_load_dwordx4 v2, s[8:11], s37 offen offset:0 lds
v_mfma_f32_16x16x32_bf16 a[128:131], a[4:7], a[88:91], a[128:131]
v_mfma_f32_16x16x32_bf16 v[88:91], a[8:11], a[88:91], v[88:91]
s_add_u32 s37, s34, 40832
v_mfma_f32_16x16x32_bf16 a[132:135], a[12:15], a[88:91], a[132:135]
v_mfma_f32_16x16x32_bf16 v[120:123], a[16:19], a[88:91], v[120:123]
buffer_load_dwordx4 v3, s[8:11], s37 offen offset:1024 lds
v_mfma_f32_16x16x32_bf16 a[136:139], a[20:23], a[88:91], a[136:139]
v_mfma_f32_16x16x32_bf16 v[152:155], a[24:27], a[88:91], v[152:155]
s_add_u32 s37, s34, 48000
v_mfma_f32_16x16x32_bf16 a[140:143], a[28:31], a[88:91], a[140:143]
v_mfma_f32_16x16x32_bf16 v[60:63], a[0:3], a[92:95], v[60:63]
buffer_load_dwordx4 v2, s[8:11], s37 offen offset:2048 lds
v_mfma_f32_16x16x32_bf16 a[144:147], a[4:7], a[92:95], a[144:147]
v_mfma_f32_16x16x32_bf16 v[92:95], a[8:11], a[92:95], v[92:95]
s_add_u32 s37, s34, 55168
v_mfma_f32_16x16x32_bf16 a[148:151], a[12:15], a[92:95], a[148:151]
v_mfma_f32_16x16x32_bf16 v[124:127], a[16:19], a[92:95], v[124:127]
buffer_load_dwordx4 v3, s[8:11], s37 offen offset:3072 lds
v_mfma_f32_16x16x32_bf16 a[152:155], a[20:23], a[92:95], a[152:155]
v_mfma_f32_16x16x32_bf16 v[156:159], a[24:27], a[92:95], v[156:159]
s_getpc_b64 s[4:5]
parallel_sum__compressed_kv_cla__geglu_ffn__prompt_kernel_pc3:
s_add_u32 s4, s4, parallel_sum__compressed_kv_cla__geglu_ffn__prompt_kernel_q-parallel_sum__compressed_kv_cla__geglu_ffn__prompt_kernel_pc3
s_addc_u32 s5, s5, 0
s_lshr_b32 s3, s2, 3
s_lshl_b32 s3, s3, 2
s_add_u32 s3, s3, s28
s_mul_i32 s3, s3, 3
v_add_u32 v26, s3, v0
v_lshlrev_b32 v26, 7, v26
v_mov_b32 v27, parallel_sum__compressed_kv_cla__geglu_ffn__prompt_kernel_L_ge-parallel_sum__compressed_kv_cla__geglu_ffn__prompt_kernel_q
v_cmp_lt_u32 vcc, v26, v27
s_nop 1
v_cndmask_b32 v26, 0, v26, vcc
v_mov_b32 v27, s5
v_add_co_u32 v26, vcc, s4, v26
s_nop 1
v_addc_co_u32 v27, vcc, 0, v27, vcc
s_mov_b64 exec, 7
global_load_dword v29, v[26:27], off
s_mov_b64 exec, -1
v_mfma_f32_16x16x32_bf16 a[156:159], a[28:31], a[92:95], a[156:159]
s_waitcnt vmcnt(9)
v_subrev_u32 v24, 0x01010101, v23
v_not_b32 v25, v23
v_and_b32 v24, v24, v25
v_and_b32 v24, 0x80808080, v24
v_cmp_ne_u32 vcc, 0, v24
s_nop 4
s_cbranch_vccnz parallel_sum__compressed_kv_cla__geglu_ffn__prompt_kernel_spin3
parallel_sum__compressed_kv_cla__geglu_ffn__prompt_kernel_spin3_ret:
s_add_u32 s70, s101, 1
s_mov_b32 s97, 0
v_bfe_u32 v24, v23, 0, 8
v_cmp_eq_u32 vcc, s70, v24
s_nop 4
s_bcnt1_i32_b64 s71, vcc
s_add_u32 s97, s97, s71
v_bfe_u32 v24, v23, 8, 8
v_cmp_eq_u32 vcc, s70, v24
s_nop 4
s_bcnt1_i32_b64 s71, vcc
s_add_u32 s97, s97, s71
v_bfe_u32 v24, v23, 16, 8
v_cmp_eq_u32 vcc, s70, v24
s_nop 4
s_bcnt1_i32_b64 s71, vcc
s_add_u32 s97, s97, s71
v_bfe_u32 v24, v23, 24, 8
v_cmp_eq_u32 vcc, s70, v24
s_nop 4
s_bcnt1_i32_b64 s71, vcc
s_add_u32 s97, s97, s71
s_waitcnt lgkmcnt(0)
v_mfma_f32_16x16x32_bf16 v[32:35], a[32:35], a[96:99], v[32:35]
s_barrier
v_mfma_f32_16x16x32_bf16 v[160:163], a[36:39], a[96:99], v[160:163]
ds_read_b64_tr_b16 a[64:65], v4 offset:0
v_mfma_f32_16x16x32_bf16 v[64:67], a[40:43], a[96:99], v[64:67]
s_add_u32 m0, s33, 49152
v_mfma_f32_16x16x32_bf16 v[164:167], a[44:47], a[96:99], v[164:167]
ds_read_b64_tr_b16 a[66:67], v4 offset:1024
v_mfma_f32_16x16x32_bf16 v[96:99], a[48:51], a[96:99], v[96:99]
v_mfma_f32_16x16x32_bf16 v[168:171], a[52:55], a[96:99], v[168:171]
ds_read_b128 a[0:3], v12 offset:0
v_mfma_f32_16x16x32_bf16 v[128:131], a[56:59], a[96:99], v[128:131]
v_mfma_f32_16x16x32_bf16 v[172:175], a[60:63], a[96:99], v[172:175]
ds_read_b64_tr_b16 a[68:69], v5 offset:0
v_mfma_f32_16x16x32_bf16 v[36:39], a[32:35], a[100:103], v[36:39]
s_add_u32 s36, s32, 3932160
v_mfma_f32_16x16x32_bf16 v[176:179], a[36:39], a[100:103], v[176:179]
ds_read_b64_tr_b16 a[70:71], v5 offset:1024
v_mfma_f32_16x16x32_bf16 v[68:71], a[40:43], a[100:103], v[68:71]
v_mfma_f32_16x16x32_bf16 v[180:183], a[44:47], a[100:103], v[180:183]
ds_read_b128 a[4:7], v12 offset:2048
v_mfma_f32_16x16x32_bf16 v[100:103], a[48:51], a[100:103], v[100:103]
v_mfma_f32_16x16x32_bf16 v[184:187], a[52:55], a[100:103], v[184:187]
ds_read_b64_tr_b16 a[72:73], v6 offset:0
v_mfma_f32_16x16x32_bf16 v[132:135], a[56:59], a[100:103], v[132:135]
v_mfma_f32_16x16x32_bf16 v[188:191], a[60:63], a[100:103], v[188:191]
ds_read_b64_tr_b16 a[74:75], v6 offset:1024
v_mfma_f32_16x16x32_bf16 v[40:43], a[32:35], a[104:107], v[40:43]
buffer_load_dwordx4 v1, s[12:15], s36 offen offset:0 lds
v_mfma_f32_16x16x32_bf16 v[192:195], a[36:39], a[104:107], v[192:195]
ds_read_b128 a[8:11], v12 offset:4096
v_mfma_f32_16x16x32_bf16 v[72:75], a[40:43], a[104:107], v[72:75]
v_mfma_f32_16x16x32_bf16 v[196:199], a[44:47], a[104:107], v[196:199]
ds_read_b64_tr_b16 a[76:77], v7 offset:0
v_mfma_f32_16x16x32_bf16 v[104:107], a[48:51], a[104:107], v[104:107]
v_mfma_f32_16x16x32_bf16 v[200:203], a[52:55], a[104:107], v[200:203]
ds_read_b64_tr_b16 a[78:79], v7 offset:1024
v_mfma_f32_16x16x32_bf16 v[136:139], a[56:59], a[104:107], v[136:139]
s_add_u32 s36, s32, 3963904
v_mfma_f32_16x16x32_bf16 v[204:207], a[60:63], a[104:107], v[204:207]
ds_read_b128 a[12:15], v12 offset:6144
v_mfma_f32_16x16x32_bf16 v[44:47], a[32:35], a[108:111], v[44:47]
v_mfma_f32_16x16x32_bf16 v[208:211], a[36:39], a[108:111], v[208:211]
ds_read_b64_tr_b16 a[80:81], v8 offset:0
v_mfma_f32_16x16x32_bf16 v[76:79], a[40:43], a[108:111], v[76:79]
v_mfma_f32_16x16x32_bf16 v[212:215], a[44:47], a[108:111], v[212:215]
ds_read_b64_tr_b16 a[82:83], v8 offset:1024
v_mfma_f32_16x16x32_bf16 v[108:111], a[48:51], a[108:111], v[108:111]
v_mfma_f32_16x16x32_bf16 v[216:219], a[52:55], a[108:111], v[216:219]
ds_read_b128 a[16:19], v12 offset:8192
v_mfma_f32_16x16x32_bf16 v[140:143], a[56:59], a[108:111], v[140:143]
buffer_load_dwordx4 v1, s[12:15], s36 offen offset:1024 lds
v_mfma_f32_16x16x32_bf16 v[220:223], a[60:63], a[108:111], v[220:223]
ds_read_b64_tr_b16 a[84:85], v9 offset:0
v_mfma_f32_16x16x32_bf16 v[48:51], a[32:35], a[112:115], v[48:51]
v_mfma_f32_16x16x32_bf16 v[224:227], a[36:39], a[112:115], v[224:227]
ds_read_b64_tr_b16 a[86:87], v9 offset:1024
v_mfma_f32_16x16x32_bf16 v[80:83], a[40:43], a[112:115], v[80:83]
v_mfma_f32_16x16x32_bf16 v[228:231], a[44:47], a[112:115], v[228:231]
ds_read_b128 a[20:23], v12 offset:10240
v_mfma_f32_16x16x32_bf16 v[112:115], a[48:51], a[112:115], v[112:115]
s_add_u32 m0, s33, 57344
v_mfma_f32_16x16x32_bf16 v[232:235], a[52:55], a[112:115], v[232:235]
ds_read_b64_tr_b16 a[88:89], v10 offset:0
v_mfma_f32_16x16x32_bf16 v[144:147], a[56:59], a[112:115], v[144:147]
v_mfma_f32_16x16x32_bf16 v[236:239], a[60:63], a[112:115], v[236:239]
ds_read_b64_tr_b16 a[90:91], v10 offset:1024
v_mfma_f32_16x16x32_bf16 v[52:55], a[32:35], a[116:119], v[52:55]
v_mfma_f32_16x16x32_bf16 v[240:243], a[36:39], a[116:119], v[240:243]
ds_read_b128 a[24:27], v12 offset:12288
v_mfma_f32_16x16x32_bf16 v[84:87], a[40:43], a[116:119], v[84:87]
v_mfma_f32_16x16x32_bf16 v[244:247], a[44:47], a[116:119], v[244:247]
ds_read_b64_tr_b16 a[92:93], v11 offset:0
v_mfma_f32_16x16x32_bf16 v[116:119], a[48:51], a[116:119], v[116:119]
s_add_u32 s36, s32, 3932160
v_mfma_f32_16x16x32_bf16 v[248:251], a[52:55], a[116:119], v[248:251]
ds_read_b64_tr_b16 a[94:95], v11 offset:1024
v_mfma_f32_16x16x32_bf16 v[148:151], a[56:59], a[116:119], v[148:151]
v_mfma_f32_16x16x32_bf16 v[252:255], a[60:63], a[116:119], v[252:255]
ds_read_b128 a[28:31], v12 offset:14336
v_mfma_f32_16x16x32_bf16 v[56:59], a[32:35], a[120:123], v[56:59]
v_mfma_f32_16x16x32_bf16 a[128:131], a[36:39], a[120:123], a[128:131]
buffer_load_dwordx4 v1, s[16:19], s36 offen offset:0 lds
v_mfma_f32_16x16x32_bf16 v[88:91], a[40:43], a[120:123], v[88:91]
v_mfma_f32_16x16x32_bf16 a[132:135], a[44:47], a[120:123], a[132:135]
v_mfma_f32_16x16x32_bf16 v[120:123], a[48:51], a[120:123], v[120:123]
v_mfma_f32_16x16x32_bf16 a[136:139], a[52:55], a[120:123], a[136:139]
s_add_u32 s36, s32, 3963904
v_mfma_f32_16x16x32_bf16 v[152:155], a[56:59], a[120:123], v[152:155]
v_mfma_f32_16x16x32_bf16 a[140:143], a[60:63], a[120:123], a[140:143]
v_mfma_f32_16x16x32_bf16 v[60:63], a[32:35], a[124:127], v[60:63]
buffer_load_dwordx4 v1, s[16:19], s36 offen offset:1024 lds
v_mfma_f32_16x16x32_bf16 a[144:147], a[36:39], a[124:127], a[144:147]
v_mfma_f32_16x16x32_bf16 v[92:95], a[40:43], a[124:127], v[92:95]
v_mfma_f32_16x16x32_bf16 a[148:151], a[44:47], a[124:127], a[148:151]
v_mfma_f32_16x16x32_bf16 v[124:127], a[48:51], a[124:127], v[124:127]
s_mov_b32 s68, 113246208
v_lshlrev_b32 v20, 4, v0
buffer_load_dwordx4 v[20:23], v20, s[20:23], s68 offen sc1
v_mfma_f32_16x16x32_bf16 a[152:155], a[52:55], a[124:127], a[152:155]
v_mfma_f32_16x16x32_bf16 v[156:159], a[56:59], a[124:127], v[156:159]
v_mfma_f32_16x16x32_bf16 a[156:159], a[60:63], a[124:127], a[156:159]
s_waitcnt lgkmcnt(0)
v_mfma_f32_16x16x32_bf16 v[32:35], a[0:3], a[64:67], v[32:35]
s_barrier
v_mfma_f32_16x16x32_bf16 v[160:163], a[4:7], a[64:67], v[160:163]
ds_read_b64_tr_b16 a[96:97], v4 offset:16384
v_mfma_f32_16x16x32_bf16 v[64:67], a[8:11], a[64:67], v[64:67]
v_mfma_f32_16x16x32_bf16 v[164:167], a[12:15], a[64:67], v[164:167]
ds_read_b64_tr_b16 a[98:99], v4 offset:17408
v_mfma_f32_16x16x32_bf16 v[96:99], a[16:19], a[64:67], v[96:99]
s_mov_b32 s40, s86
s_mov_b32 s41, s87
s_mov_b32 s42, 5308416
s_mov_b32 s43, 0x20000
v_mfma_f32_16x16x32_bf16 v[168:171], a[20:23], a[64:67], v[168:171]
ds_read_b128 a[32:35], v13 offset:0
v_mfma_f32_16x16x32_bf16 v[128:131], a[24:27], a[64:67], v[128:131]
v_mfma_f32_16x16x32_bf16 v[172:175], a[28:31], a[64:67], v[172:175]
ds_read_b64_tr_b16 a[100:101], v5 offset:16384
v_mfma_f32_16x16x32_bf16 v[36:39], a[0:3], a[68:71], v[36:39]
s_lshr_b32 s3, s2, 3
s_lshl_b32 s3, s3, 2
s_add_u32 s3, s3, s28
s_mul_i32 s3, s3, 41
v_mfma_f32_16x16x32_bf16 v[176:179], a[4:7], a[68:71], v[176:179]
ds_read_b64_tr_b16 a[102:103], v5 offset:17408
v_mfma_f32_16x16x32_bf16 v[68:71], a[8:11], a[68:71], v[68:71]
v_mfma_f32_16x16x32_bf16 v[180:183], a[12:15], a[68:71], v[180:183]
ds_read_b128 a[36:39], v13 offset:2048
v_mfma_f32_16x16x32_bf16 v[100:103], a[16:19], a[68:71], v[100:103]
v_add_u32 v26, s3, v0
v_mfma_f32_16x16x32_bf16 v[184:187], a[20:23], a[68:71], v[184:187]
ds_read_b64_tr_b16 a[104:105], v6 offset:16384
v_mfma_f32_16x16x32_bf16 v[132:135], a[24:27], a[68:71], v[132:135]
v_mfma_f32_16x16x32_bf16 v[188:191], a[28:31], a[68:71], v[188:191]
ds_read_b64_tr_b16 a[106:107], v6 offset:17408
v_mfma_f32_16x16x32_bf16 v[40:43], a[0:3], a[72:75], v[40:43]
s_mov_b32 s4, 7282
v_mfma_f32_16x16x32_bf16 v[192:195], a[4:7], a[72:75], v[192:195]
ds_read_b128 a[40:43], v13 offset:4096
v_mfma_f32_16x16x32_bf16 v[72:75], a[8:11], a[72:75], v[72:75]
v_mfma_f32_16x16x32_bf16 v[196:199], a[12:15], a[72:75], v[196:199]
ds_read_b64_tr_b16 a[108:109], v7 offset:16384
v_mfma_f32_16x16x32_bf16 v[104:107], a[16:19], a[72:75], v[104:107]
v_mul_u32_u24 v27, s4, v26
v_mfma_f32_16x16x32_bf16 v[200:203], a[20:23], a[72:75], v[200:203]
ds_read_b64_tr_b16 a[110:111], v7 offset:17408
v_mfma_f32_16x16x32_bf16 v[136:139], a[24:27], a[72:75], v[136:139]
v_mfma_f32_16x16x32_bf16 v[204:207], a[28:31], a[72:75], v[204:207]
ds_read_b128 a[44:47], v13 offset:6144
v_mfma_f32_16x16x32_bf16 v[44:47], a[0:3], a[76:79], v[44:47]
v_lshrrev_b32 v27, 16, v27
v_mfma_f32_16x16x32_bf16 v[208:211], a[4:7], a[76:79], v[208:211]
ds_read_b64_tr_b16 a[112:113], v8 offset:16384
v_mfma_f32_16x16x32_bf16 v[76:79], a[8:11], a[76:79], v[76:79]
v_mfma_f32_16x16x32_bf16 v[212:215], a[12:15], a[76:79], v[212:215]
ds_read_b64_tr_b16 a[114:115], v8 offset:17408
v_mfma_f32_16x16x32_bf16 v[108:111], a[16:19], a[76:79], v[108:111]
v_mul_u32_u24 v28, 9, v27
v_mfma_f32_16x16x32_bf16 v[216:219], a[20:23], a[76:79], v[216:219]
ds_read_b128 a[48:51], v13 offset:8192
v_mfma_f32_16x16x32_bf16 v[140:143], a[24:27], a[76:79], v[140:143]
v_mfma_f32_16x16x32_bf16 v[220:223], a[28:31], a[76:79], v[220:223]
ds_read_b64_tr_b16 a[116:117], v9 offset:16384
v_mfma_f32_16x16x32_bf16 v[48:51], a[0:3], a[80:83], v[48:51]
v_sub_u32 v28, v26, v28
v_mfma_f32_16x16x32_bf16 v[224:227], a[4:7], a[80:83], v[224:227]
ds_read_b64_tr_b16 a[118:119], v9 offset:17408
v_mfma_f32_16x16x32_bf16 v[80:83], a[8:11], a[80:83], v[80:83]
v_mfma_f32_16x16x32_bf16 v[228:231], a[12:15], a[80:83], v[228:231]
ds_read_b128 a[52:55], v13 offset:10240
v_mfma_f32_16x16x32_bf16 v[112:115], a[16:19], a[80:83], v[112:115]
s_mov_b32 s5, 0
s_and_b32 s6, s2, 7
s_mul_i32 s6, s6, 1152
v_mfma_f32_16x16x32_bf16 v[232:235], a[20:23], a[80:83], v[232:235]
ds_read_b64_tr_b16 a[120:121], v10 offset:16384
v_mfma_f32_16x16x32_bf16 v[144:147], a[24:27], a[80:83], v[144:147]
v_mfma_f32_16x16x32_bf16 v[236:239], a[28:31], a[80:83], v[236:239]
ds_read_b64_tr_b16 a[122:123], v10 offset:17408
v_mfma_f32_16x16x32_bf16 v[52:55], a[0:3], a[84:87], v[52:55]
v_add_u32 v27, s5, v27
v_mfma_f32_16x16x32_bf16 v[240:243], a[4:7], a[84:87], v[240:243]
ds_read_b128 a[56:59], v13 offset:12288
v_mfma_f32_16x16x32_bf16 v[84:87], a[8:11], a[84:87], v[84:87]
v_mfma_f32_16x16x32_bf16 v[244:247], a[12:15], a[84:87], v[244:247]
ds_read_b64_tr_b16 a[124:125], v11 offset:16384
v_mfma_f32_16x16x32_bf16 v[116:119], a[16:19], a[84:87], v[116:119]
v_mul_u32_u24 v27, 9216, v27
v_mfma_f32_16x16x32_bf16 v[248:251], a[20:23], a[84:87], v[248:251]
ds_read_b64_tr_b16 a[126:127], v11 offset:17408
v_mfma_f32_16x16x32_bf16 v[148:151], a[24:27], a[84:87], v[148:151]
v_mfma_f32_16x16x32_bf16 v[252:255], a[28:31], a[84:87], v[252:255]
ds_read_b128 a[60:63], v13 offset:14336
v_mfma_f32_16x16x32_bf16 v[56:59], a[0:3], a[88:91], v[56:59]
v_lshl_add_u32 v27, v28, 7, v27
v_mfma_f32_16x16x32_bf16 a[128:131], a[4:7], a[88:91], a[128:131]
v_mfma_f32_16x16x32_bf16 v[88:91], a[8:11], a[88:91], v[88:91]
v_add_u32 v27, s6, v27
v_mfma_f32_16x16x32_bf16 a[132:135], a[12:15], a[88:91], a[132:135]
v_mfma_f32_16x16x32_bf16 v[120:123], a[16:19], a[88:91], v[120:123]
v_mov_b32 v28, 0x10000000
v_mfma_f32_16x16x32_bf16 a[136:139], a[20:23], a[88:91], a[136:139]
v_mfma_f32_16x16x32_bf16 v[152:155], a[24:27], a[88:91], v[152:155]
v_cmp_gt_u32 vcc, 41, v0
v_mfma_f32_16x16x32_bf16 a[140:143], a[28:31], a[88:91], a[140:143]
v_mfma_f32_16x16x32_bf16 v[60:63], a[0:3], a[92:95], v[60:63]
s_mov_b32 s4, 5184
v_cmp_gt_u32 s[6:7], s4, v26
v_mfma_f32_16x16x32_bf16 a[144:147], a[4:7], a[92:95], a[144:147]
v_mfma_f32_16x16x32_bf16 v[92:95], a[8:11], a[92:95], v[92:95]
s_nop 1
s_and_b64 vcc, vcc, s[6:7]
v_mfma_f32_16x16x32_bf16 a[148:151], a[12:15], a[92:95], a[148:151]
v_mfma_f32_16x16x32_bf16 v[124:127], a[16:19], a[92:95], v[124:127]
s_nop 1
v_cndmask_b32 v27, v28, v27, vcc
v_mfma_f32_16x16x32_bf16 a[152:155], a[20:23], a[92:95], a[152:155]
v_mfma_f32_16x16x32_bf16 v[156:159], a[24:27], a[92:95], v[156:159]
buffer_load_dword v28, v27, s[40:43], 0 offen
v_mfma_f32_16x16x32_bf16 a[156:159], a[28:31], a[92:95], a[156:159]
s_waitcnt vmcnt(1)
v_min_u32 v20, v20, v21
v_min3_u32 v20, v20, v22, v23
v_cmp_eq_u32 vcc, 0, v20
s_nop 4
s_cbranch_vccnz parallel_sum__compressed_kv_cla__geglu_ffn__prompt_kernel_spin4
parallel_sum__compressed_kv_cla__geglu_ffn__prompt_kernel_spin4_ret:
s_waitcnt lgkmcnt(0)
v_mfma_f32_16x16x32_bf16 v[32:35], a[32:35], a[96:99], v[32:35]
s_barrier
v_mfma_f32_16x16x32_bf16 v[160:163], a[36:39], a[96:99], v[160:163]
ds_read_b64_tr_b16 a[64:65], v4 offset:32768
v_mfma_f32_16x16x32_bf16 v[64:67], a[40:43], a[96:99], v[64:67]
v_mfma_f32_16x16x32_bf16 v[164:167], a[44:47], a[96:99], v[164:167]
ds_read_b64_tr_b16 a[66:67], v4 offset:33792
v_mfma_f32_16x16x32_bf16 v[96:99], a[48:51], a[96:99], v[96:99]
v_mfma_f32_16x16x32_bf16 v[168:171], a[52:55], a[96:99], v[168:171]
ds_read_b128 a[0:3], v12 offset:32768
v_mfma_f32_16x16x32_bf16 v[128:131], a[56:59], a[96:99], v[128:131]
v_mfma_f32_16x16x32_bf16 v[172:175], a[60:63], a[96:99], v[172:175]
ds_read_b64_tr_b16 a[68:69], v5 offset:32768
v_mfma_f32_16x16x32_bf16 v[36:39], a[32:35], a[100:103], v[36:39]
v_mfma_f32_16x16x32_bf16 v[176:179], a[36:39], a[100:103], v[176:179]
ds_read_b64_tr_b16 a[70:71], v5 offset:33792
v_mfma_f32_16x16x32_bf16 v[68:71], a[40:43], a[100:103], v[68:71]
v_mfma_f32_16x16x32_bf16 v[180:183], a[44:47], a[100:103], v[180:183]
ds_read_b128 a[4:7], v12 offset:34816
v_mfma_f32_16x16x32_bf16 v[100:103], a[48:51], a[100:103], v[100:103]
v_mfma_f32_16x16x32_bf16 v[184:187], a[52:55], a[100:103], v[184:187]
ds_read_b64_tr_b16 a[72:73], v6 offset:32768
v_mfma_f32_16x16x32_bf16 v[132:135], a[56:59], a[100:103], v[132:135]
v_mfma_f32_16x16x32_bf16 v[188:191], a[60:63], a[100:103], v[188:191]
ds_read_b64_tr_b16 a[74:75], v6 offset:33792
v_mfma_f32_16x16x32_bf16 v[40:43], a[32:35], a[104:107], v[40:43]
v_mfma_f32_16x16x32_bf16 v[192:195], a[36:39], a[104:107], v[192:195]
ds_read_b128 a[8:11], v12 offset:36864
v_mfma_f32_16x16x32_bf16 v[72:75], a[40:43], a[104:107], v[72:75]
v_mfma_f32_16x16x32_bf16 v[196:199], a[44:47], a[104:107], v[196:199]
ds_read_b64_tr_b16 a[76:77], v7 offset:32768
v_mfma_f32_16x16x32_bf16 v[104:107], a[48:51], a[104:107], v[104:107]
v_mfma_f32_16x16x32_bf16 v[200:203], a[52:55], a[104:107], v[200:203]
ds_read_b64_tr_b16 a[78:79], v7 offset:33792
v_mfma_f32_16x16x32_bf16 v[136:139], a[56:59], a[104:107], v[136:139]
v_mfma_f32_16x16x32_bf16 v[204:207], a[60:63], a[104:107], v[204:207]
ds_read_b128 a[12:15], v12 offset:38912
v_mfma_f32_16x16x32_bf16 v[44:47], a[32:35], a[108:111], v[44:47]
v_mfma_f32_16x16x32_bf16 v[208:211], a[36:39], a[108:111], v[208:211]
ds_read_b64_tr_b16 a[80:81], v8 offset:32768
v_mfma_f32_16x16x32_bf16 v[76:79], a[40:43], a[108:111], v[76:79]
v_mfma_f32_16x16x32_bf16 v[212:215], a[44:47], a[108:111], v[212:215]
ds_read_b64_tr_b16 a[82:83], v8 offset:33792
v_mfma_f32_16x16x32_bf16 v[108:111], a[48:51], a[108:111], v[108:111]
v_mfma_f32_16x16x32_bf16 v[216:219], a[52:55], a[108:111], v[216:219]
ds_read_b128 a[16:19], v12 offset:40960
v_mfma_f32_16x16x32_bf16 v[140:143], a[56:59], a[108:111], v[140:143]
v_mfma_f32_16x16x32_bf16 v[220:223], a[60:63], a[108:111], v[220:223]
ds_read_b64_tr_b16 a[84:85], v9 offset:32768
v_mfma_f32_16x16x32_bf16 v[48:51], a[32:35], a[112:115], v[48:51]
v_mfma_f32_16x16x32_bf16 v[224:227], a[36:39], a[112:115], v[224:227]
ds_read_b64_tr_b16 a[86:87], v9 offset:33792
v_mfma_f32_16x16x32_bf16 v[80:83], a[40:43], a[112:115], v[80:83]
v_mfma_f32_16x16x32_bf16 v[228:231], a[44:47], a[112:115], v[228:231]
ds_read_b128 a[20:23], v12 offset:43008
v_mfma_f32_16x16x32_bf16 v[112:115], a[48:51], a[112:115], v[112:115]
v_mfma_f32_16x16x32_bf16 v[232:235], a[52:55], a[112:115], v[232:235]
ds_read_b64_tr_b16 a[88:89], v10 offset:32768
v_mfma_f32_16x16x32_bf16 v[144:147], a[56:59], a[112:115], v[144:147]
v_mfma_f32_16x16x32_bf16 v[236:239], a[60:63], a[112:115], v[236:239]
ds_read_b64_tr_b16 a[90:91], v10 offset:33792
v_mfma_f32_16x16x32_bf16 v[52:55], a[32:35], a[116:119], v[52:55]
v_mfma_f32_16x16x32_bf16 v[240:243], a[36:39], a[116:119], v[240:243]
ds_read_b128 a[24:27], v12 offset:45056
v_mfma_f32_16x16x32_bf16 v[84:87], a[40:43], a[116:119], v[84:87]
v_mfma_f32_16x16x32_bf16 v[244:247], a[44:47], a[116:119], v[244:247]
ds_read_b64_tr_b16 a[92:93], v11 offset:32768
v_mfma_f32_16x16x32_bf16 v[116:119], a[48:51], a[116:119], v[116:119]
v_mfma_f32_16x16x32_bf16 v[248:251], a[52:55], a[116:119], v[248:251]
ds_read_b64_tr_b16 a[94:95], v11 offset:33792
v_mfma_f32_16x16x32_bf16 v[148:151], a[56:59], a[116:119], v[148:151]
v_mfma_f32_16x16x32_bf16 v[252:255], a[60:63], a[116:119], v[252:255]
ds_read_b128 a[28:31], v12 offset:47104
v_mfma_f32_16x16x32_bf16 v[56:59], a[32:35], a[120:123], v[56:59]
v_mfma_f32_16x16x32_bf16 a[128:131], a[36:39], a[120:123], a[128:131]
v_mfma_f32_16x16x32_bf16 v[88:91], a[40:43], a[120:123], v[88:91]
v_mfma_f32_16x16x32_bf16 a[132:135], a[44:47], a[120:123], a[132:135]
v_mfma_f32_16x16x32_bf16 v[120:123], a[48:51], a[120:123], v[120:123]
v_mfma_f32_16x16x32_bf16 a[136:139], a[52:55], a[120:123], a[136:139]
v_mfma_f32_16x16x32_bf16 v[152:155], a[56:59], a[120:123], v[152:155]
v_mfma_f32_16x16x32_bf16 a[140:143], a[60:63], a[120:123], a[140:143]
v_mfma_f32_16x16x32_bf16 v[60:63], a[32:35], a[124:127], v[60:63]
v_mfma_f32_16x16x32_bf16 a[144:147], a[36:39], a[124:127], a[144:147]
v_mfma_f32_16x16x32_bf16 v[92:95], a[40:43], a[124:127], v[92:95]
v_mfma_f32_16x16x32_bf16 a[148:151], a[44:47], a[124:127], a[148:151]
v_mfma_f32_16x16x32_bf16 v[124:127], a[48:51], a[124:127], v[124:127]
v_mfma_f32_16x16x32_bf16 a[152:155], a[52:55], a[124:127], a[152:155]
v_mfma_f32_16x16x32_bf16 v[156:159], a[56:59], a[124:127], v[156:159]
v_mfma_f32_16x16x32_bf16 a[156:159], a[60:63], a[124:127], a[156:159]
s_waitcnt lgkmcnt(0)
v_mfma_f32_16x16x32_bf16 v[32:35], a[0:3], a[64:67], v[32:35]
s_barrier
v_mfma_f32_16x16x32_bf16 v[160:163], a[4:7], a[64:67], v[160:163]
ds_read_b64_tr_b16 a[96:97], v4 offset:49152
v_mfma_f32_16x16x32_bf16 v[64:67], a[8:11], a[64:67], v[64:67]
v_mfma_f32_16x16x32_bf16 v[164:167], a[12:15], a[64:67], v[164:167]
ds_read_b64_tr_b16 a[98:99], v4 offset:50176
v_mfma_f32_16x16x32_bf16 v[96:99], a[16:19], a[64:67], v[96:99]
v_mfma_f32_16x16x32_bf16 v[168:171], a[20:23], a[64:67], v[168:171]
ds_read_b128 a[32:35], v13 offset:32768
v_mfma_f32_16x16x32_bf16 v[128:131], a[24:27], a[64:67], v[128:131]
v_mfma_f32_16x16x32_bf16 v[172:175], a[28:31], a[64:67], v[172:175]
ds_read_b64_tr_b16 a[100:101], v5 offset:49152
v_mfma_f32_16x16x32_bf16 v[36:39], a[0:3], a[68:71], v[36:39]
v_mfma_f32_16x16x32_bf16 v[176:179], a[4:7], a[68:71], v[176:179]
ds_read_b64_tr_b16 a[102:103], v5 offset:50176
v_mfma_f32_16x16x32_bf16 v[68:71], a[8:11], a[68:71], v[68:71]
v_mfma_f32_16x16x32_bf16 v[180:183], a[12:15], a[68:71], v[180:183]
ds_read_b128 a[36:39], v13 offset:34816
v_mfma_f32_16x16x32_bf16 v[100:103], a[16:19], a[68:71], v[100:103]
v_mfma_f32_16x16x32_bf16 v[184:187], a[20:23], a[68:71], v[184:187]
ds_read_b64_tr_b16 a[104:105], v6 offset:49152
v_mfma_f32_16x16x32_bf16 v[132:135], a[24:27], a[68:71], v[132:135]
v_mfma_f32_16x16x32_bf16 v[188:191], a[28:31], a[68:71], v[188:191]
ds_read_b64_tr_b16 a[106:107], v6 offset:50176
v_mfma_f32_16x16x32_bf16 v[40:43], a[0:3], a[72:75], v[40:43]
v_mfma_f32_16x16x32_bf16 v[192:195], a[4:7], a[72:75], v[192:195]
ds_read_b128 a[40:43], v13 offset:36864
v_mfma_f32_16x16x32_bf16 v[72:75], a[8:11], a[72:75], v[72:75]
v_mfma_f32_16x16x32_bf16 v[196:199], a[12:15], a[72:75], v[196:199]
ds_read_b64_tr_b16 a[108:109], v7 offset:49152
v_mfma_f32_16x16x32_bf16 v[104:107], a[16:19], a[72:75], v[104:107]
v_mfma_f32_16x16x32_bf16 v[200:203], a[20:23], a[72:75], v[200:203]
ds_read_b64_tr_b16 a[110:111], v7 offset:50176
v_mfma_f32_16x16x32_bf16 v[136:139], a[24:27], a[72:75], v[136:139]
v_mfma_f32_16x16x32_bf16 v[204:207], a[28:31], a[72:75], v[204:207]
ds_read_b128 a[44:47], v13 offset:38912
v_mfma_f32_16x16x32_bf16 v[44:47], a[0:3], a[76:79], v[44:47]
v_mfma_f32_16x16x32_bf16 v[208:211], a[4:7], a[76:79], v[208:211]
ds_read_b64_tr_b16 a[112:113], v8 offset:49152
v_mfma_f32_16x16x32_bf16 v[76:79], a[8:11], a[76:79], v[76:79]
v_mfma_f32_16x16x32_bf16 v[212:215], a[12:15], a[76:79], v[212:215]
ds_read_b64_tr_b16 a[114:115], v8 offset:50176
v_mfma_f32_16x16x32_bf16 v[108:111], a[16:19], a[76:79], v[108:111]
v_mfma_f32_16x16x32_bf16 v[216:219], a[20:23], a[76:79], v[216:219]
ds_read_b128 a[48:51], v13 offset:40960
v_mfma_f32_16x16x32_bf16 v[140:143], a[24:27], a[76:79], v[140:143]
v_mfma_f32_16x16x32_bf16 v[220:223], a[28:31], a[76:79], v[220:223]
ds_read_b64_tr_b16 a[116:117], v9 offset:49152
v_mfma_f32_16x16x32_bf16 v[48:51], a[0:3], a[80:83], v[48:51]
v_mfma_f32_16x16x32_bf16 v[224:227], a[4:7], a[80:83], v[224:227]
ds_read_b64_tr_b16 a[118:119], v9 offset:50176
v_mfma_f32_16x16x32_bf16 v[80:83], a[8:11], a[80:83], v[80:83]
v_mfma_f32_16x16x32_bf16 v[228:231], a[12:15], a[80:83], v[228:231]
ds_read_b128 a[52:55], v13 offset:43008
v_mfma_f32_16x16x32_bf16 v[112:115], a[16:19], a[80:83], v[112:115]
v_mfma_f32_16x16x32_bf16 v[232:235], a[20:23], a[80:83], v[232:235]
ds_read_b64_tr_b16 a[120:121], v10 offset:49152
v_mfma_f32_16x16x32_bf16 v[144:147], a[24:27], a[80:83], v[144:147]
v_mfma_f32_16x16x32_bf16 v[236:239], a[28:31], a[80:83], v[236:239]
ds_read_b64_tr_b16 a[122:123], v10 offset:50176
v_mfma_f32_16x16x32_bf16 v[52:55], a[0:3], a[84:87], v[52:55]
v_mfma_f32_16x16x32_bf16 v[240:243], a[4:7], a[84:87], v[240:243]
ds_read_b128 a[56:59], v13 offset:45056
v_mfma_f32_16x16x32_bf16 v[84:87], a[8:11], a[84:87], v[84:87]
v_mfma_f32_16x16x32_bf16 v[244:247], a[12:15], a[84:87], v[244:247]
ds_read_b64_tr_b16 a[124:125], v11 offset:49152
v_mfma_f32_16x16x32_bf16 v[116:119], a[16:19], a[84:87], v[116:119]
v_mfma_f32_16x16x32_bf16 v[248:251], a[20:23], a[84:87], v[248:251]
ds_read_b64_tr_b16 a[126:127], v11 offset:50176
v_mfma_f32_16x16x32_bf16 v[148:151], a[24:27], a[84:87], v[148:151]
v_mfma_f32_16x16x32_bf16 v[252:255], a[28:31], a[84:87], v[252:255]
ds_read_b128 a[60:63], v13 offset:47104
v_mfma_f32_16x16x32_bf16 v[56:59], a[0:3], a[88:91], v[56:59]
v_mfma_f32_16x16x32_bf16 a[128:131], a[4:7], a[88:91], a[128:131]
v_mfma_f32_16x16x32_bf16 v[88:91], a[8:11], a[88:91], v[88:91]
v_mfma_f32_16x16x32_bf16 a[132:135], a[12:15], a[88:91], a[132:135]
v_mfma_f32_16x16x32_bf16 v[120:123], a[16:19], a[88:91], v[120:123]
v_mfma_f32_16x16x32_bf16 a[136:139], a[20:23], a[88:91], a[136:139]
v_mfma_f32_16x16x32_bf16 v[152:155], a[24:27], a[88:91], v[152:155]
v_mfma_f32_16x16x32_bf16 a[140:143], a[28:31], a[88:91], a[140:143]
v_mfma_f32_16x16x32_bf16 v[60:63], a[0:3], a[92:95], v[60:63]
v_mfma_f32_16x16x32_bf16 a[144:147], a[4:7], a[92:95], a[144:147]
v_mfma_f32_16x16x32_bf16 v[92:95], a[8:11], a[92:95], v[92:95]
v_mfma_f32_16x16x32_bf16 a[148:151], a[12:15], a[92:95], a[148:151]
v_mfma_f32_16x16x32_bf16 v[124:127], a[16:19], a[92:95], v[124:127]
v_mfma_f32_16x16x32_bf16 a[152:155], a[20:23], a[92:95], a[152:155]
v_mfma_f32_16x16x32_bf16 v[156:159], a[24:27], a[92:95], v[156:159]
v_mfma_f32_16x16x32_bf16 a[156:159], a[28:31], a[92:95], a[156:159]
s_waitcnt lgkmcnt(0)
v_mfma_f32_16x16x32_bf16 v[32:35], a[32:35], a[96:99], v[32:35]
s_barrier
v_mfma_f32_16x16x32_bf16 v[160:163], a[36:39], a[96:99], v[160:163]
s_mov_b32 s8, s76
s_mov_b32 s9, s77
v_mfma_f32_16x16x32_bf16 v[64:67], a[40:43], a[96:99], v[64:67]
s_mov_b32 s10, 4718592
s_mov_b32 s11, 0x20000
v_mfma_f32_16x16x32_bf16 v[164:167], a[44:47], a[96:99], v[164:167]
v_lshrrev_b32 v1, 4, v0
v_mfma_f32_16x16x32_bf16 v[96:99], a[48:51], a[96:99], v[96:99]
v_and_b32 v3, 15, v0
s_lshl_b32 s3, s28, 3
v_mfma_f32_16x16x32_bf16 v[168:171], a[52:55], a[96:99], v[168:171]
v_add_u32 v2, 0, v1
v_mfma_f32_16x16x32_bf16 v[128:131], a[56:59], a[96:99], v[128:131]
v_lshlrev_b32 v5, 1, v2
v_xor_b32 v5, v5, v3
v_mfma_f32_16x16x32_bf16 v[172:175], a[60:63], a[96:99], v[172:175]
v_lshlrev_b32 v5, 4, v5
v_mfma_f32_16x16x32_bf16 v[36:39], a[32:35], a[100:103], v[36:39]
v_add_u32 v2, s3, v2
v_lshl_add_u32 v16, v2, 13, v5
v_mfma_f32_16x16x32_bf16 v[176:179], a[36:39], a[100:103], v[176:179]
v_add_u32 v2, 4, v1
v_lshlrev_b32 v5, 1, v2
v_mfma_f32_16x16x32_bf16 v[68:71], a[40:43], a[100:103], v[68:71]
v_xor_b32 v5, v5, v3
v_mfma_f32_16x16x32_bf16 v[180:183], a[44:47], a[100:103], v[180:183]
v_lshlrev_b32 v5, 4, v5
v_add_u32 v2, s3, v2
v_mfma_f32_16x16x32_bf16 v[100:103], a[48:51], a[100:103], v[100:103]
v_lshl_add_u32 v17, v2, 13, v5
v_mfma_f32_16x16x32_bf16 v[184:187], a[52:55], a[100:103], v[184:187]
v_subrev_u32 v17, 1024, v17
s_lshl_b32 s40, s29, 8
v_mfma_f32_16x16x32_bf16 v[132:135], a[56:59], a[100:103], v[132:135]
s_lshl_b32 s3, s28, 11
v_mfma_f32_16x16x32_bf16 v[188:191], a[60:63], a[100:103], v[188:191]
s_add_u32 s41, s3, 98304
v_and_b32 v2, 15, v0
v_mfma_f32_16x16x32_bf16 v[40:43], a[32:35], a[104:107], v[40:43]
v_lshrrev_b32 v3, 2, v2
v_and_b32 v5, 1, v1
v_mfma_f32_16x16x32_bf16 v[192:195], a[36:39], a[104:107], v[192:195]
v_lshl_add_u32 v5, v5, 2, v3
v_mfma_f32_16x16x32_bf16 v[72:75], a[40:43], a[104:107], v[72:75]
v_lshl_add_u32 v3, v1, 2, v3
v_lshlrev_b32 v3, 8, v3
v_mfma_f32_16x16x32_bf16 v[196:199], a[44:47], a[104:107], v[196:199]
v_and_b32 v2, 3, v2
v_mfma_f32_16x16x32_bf16 v[104:107], a[48:51], a[104:107], v[104:107]
v_lshl_add_u32 v3, v2, 3, v3
v_add_u32 v3, 98304, v3
v_mfma_f32_16x16x32_bf16 v[200:203], a[52:55], a[104:107], v[200:203]
v_xor_b32 v2, 0, v5
v_mfma_f32_16x16x32_bf16 v[136:139], a[56:59], a[104:107], v[136:139]
v_lshl_add_u32 v18, v2, 5, v3
v_xor_b32 v2, 1, v5
v_mfma_f32_16x16x32_bf16 v[204:207], a[60:63], a[104:107], v[204:207]
v_lshl_add_u32 v19, v2, 5, v3
v_xor_b32 v2, 2, v5
v_mfma_f32_16x16x32_bf16 v[44:47], a[32:35], a[108:111], v[44:47]
v_lshl_add_u32 v20, v2, 5, v3
v_mfma_f32_16x16x32_bf16 v[208:211], a[36:39], a[108:111], v[208:211]
v_xor_b32 v2, 3, v5
v_lshl_add_u32 v21, v2, 5, v3
v_mfma_f32_16x16x32_bf16 v[76:79], a[40:43], a[108:111], v[76:79]
v_xor_b32 v2, 4, v5
v_mfma_f32_16x16x32_bf16 v[212:215], a[44:47], a[108:111], v[212:215]
v_lshl_add_u32 v22, v2, 5, v3
v_xor_b32 v2, 5, v5
v_mfma_f32_16x16x32_bf16 v[108:111], a[48:51], a[108:111], v[108:111]
v_lshl_add_u32 v23, v2, 5, v3
v_mfma_f32_16x16x32_bf16 v[216:219], a[52:55], a[108:111], v[216:219]
v_xor_b32 v2, 6, v5
v_lshl_add_u32 v24, v2, 5, v3
v_mfma_f32_16x16x32_bf16 v[140:143], a[56:59], a[108:111], v[140:143]
v_xor_b32 v2, 7, v5
v_lshl_add_u32 v25, v2, 5, v3
v_mfma_f32_16x16x32_bf16 v[220:223], a[60:63], a[108:111], v[220:223]
v_lshlrev_b32 v26, 4, v0
v_mfma_f32_16x16x32_bf16 v[48:51], a[32:35], a[112:115], v[48:51]
v_add_u32 v27, 18432, v26
s_lshl_b32 s3, s30, 3
v_mfma_f32_16x16x32_bf16 v[224:227], a[36:39], a[112:115], v[224:227]
s_lshl_b32 s4, s28, 1
v_mfma_f32_16x16x32_bf16 v[80:83], a[40:43], a[112:115], v[80:83]
s_add_u32 s5, s3, s4
s_mul_i32 s42, s5, 18432
v_mfma_f32_16x16x32_bf16 v[228:231], a[44:47], a[112:115], v[228:231]
s_sub_u32 s6, 120, s3
v_mfma_f32_16x16x32_bf16 v[112:115], a[48:51], a[112:115], v[112:115]
s_add_u32 s6, s6, s4
s_mul_i32 s43, s6, 18432
v_mfma_f32_16x16x32_bf16 v[232:235], a[52:55], a[112:115], v[232:235]
s_add_u32 m0, s41, 0
s_add_u32 s44, s40, 0
v_mfma_f32_16x16x32_bf16 v[144:147], a[56:59], a[112:115], v[144:147]
buffer_load_dwordx4 v16, s[8:11], s44 offen offset:0 lds
v_mfma_f32_16x16x32_bf16 v[236:239], a[60:63], a[112:115], v[236:239]
buffer_load_dwordx4 v17, s[8:11], s44 offen offset:1024 lds
s_add_u32 s45, s42, 0
v_mfma_f32_16x16x32_bf16 v[52:55], a[32:35], a[116:119], v[52:55]
buffer_load_dwordx4 a[160:163], v26, s[20:23], s45 offen sc1
v_mfma_f32_16x16x32_bf16 v[240:243], a[36:39], a[116:119], v[240:243]
buffer_load_dwordx4 a[164:167], v27, s[20:23], s45 offen sc1
s_add_u32 s45, s43, 0
v_mfma_f32_16x16x32_bf16 v[84:87], a[40:43], a[116:119], v[84:87]
buffer_load_dwordx4 a[168:171], v26, s[20:23], s45 offen sc1
v_mfma_f32_16x16x32_bf16 v[244:247], a[44:47], a[116:119], v[244:247]
buffer_load_dwordx4 a[172:175], v27, s[20:23], s45 offen sc1
s_add_u32 m0, s41, 8192
v_mfma_f32_16x16x32_bf16 v[116:119], a[48:51], a[116:119], v[116:119]
s_add_u32 s44, s40, 262144
buffer_load_dwordx4 v16, s[8:11], s44 offen offset:0 lds
v_mfma_f32_16x16x32_bf16 v[248:251], a[52:55], a[116:119], v[248:251]
buffer_load_dwordx4 v17, s[8:11], s44 offen offset:1024 lds
v_mfma_f32_16x16x32_bf16 v[148:151], a[56:59], a[116:119], v[148:151]
s_add_u32 m0, s41, 16384
s_add_u32 s44, s40, 524288
v_mfma_f32_16x16x32_bf16 v[252:255], a[60:63], a[116:119], v[252:255]
buffer_load_dwordx4 v16, s[8:11], s44 offen offset:0 lds
v_mfma_f32_16x16x32_bf16 v[56:59], a[32:35], a[120:123], v[56:59]
buffer_load_dwordx4 v17, s[8:11], s44 offen offset:1024 lds
s_add_u32 s45, s42, 1024
v_mfma_f32_16x16x32_bf16 a[128:131], a[36:39], a[120:123], a[128:131]
buffer_load_dwordx4 a[176:179], v26, s[20:23], s45 offen sc1
v_mfma_f32_16x16x32_bf16 v[88:91], a[40:43], a[120:123], v[88:91]
buffer_load_dwordx4 a[180:183], v27, s[20:23], s45 offen sc1
s_add_u32 s45, s43, 1024
v_mfma_f32_16x16x32_bf16 a[132:135], a[44:47], a[120:123], a[132:135]
buffer_load_dwordx4 a[184:187], v26, s[20:23], s45 offen sc1
buffer_load_dwordx4 a[188:191], v27, s[20:23], s45 offen sc1
v_mfma_f32_16x16x32_bf16 v[120:123], a[48:51], a[120:123], v[120:123]
s_add_u32 s45, s42, 2048
v_mfma_f32_16x16x32_bf16 a[136:139], a[52:55], a[120:123], a[136:139]
buffer_load_dwordx4 a[192:195], v26, s[20:23], s45 offen sc1
buffer_load_dwordx4 a[196:199], v27, s[20:23], s45 offen sc1
v_mfma_f32_16x16x32_bf16 v[152:155], a[56:59], a[120:123], v[152:155]
s_add_u32 s45, s43, 2048
v_mfma_f32_16x16x32_bf16 a[140:143], a[60:63], a[120:123], a[140:143]
buffer_load_dwordx4 a[200:203], v26, s[20:23], s45 offen sc1
buffer_load_dwordx4 a[204:207], v27, s[20:23], s45 offen sc1
v_mfma_f32_16x16x32_bf16 v[60:63], a[32:35], a[124:127], v[60:63]
s_add_u32 s45, s42, 3072
v_mfma_f32_16x16x32_bf16 a[144:147], a[36:39], a[124:127], a[144:147]
buffer_load_dwordx4 a[208:211], v26, s[20:23], s45 offen sc1
buffer_load_dwordx4 a[212:215], v27, s[20:23], s45 offen sc1
v_mfma_f32_16x16x32_bf16 v[92:95], a[40:43], a[124:127], v[92:95]
s_add_u32 s45, s43, 3072
buffer_load_dwordx4 a[216:219], v26, s[20:23], s45 offen sc1
v_mfma_f32_16x16x32_bf16 a[148:151], a[44:47], a[124:127], a[148:151]
buffer_load_dwordx4 a[220:223], v27, s[20:23], s45 offen sc1
v_mfma_f32_16x16x32_bf16 v[124:127], a[48:51], a[124:127], v[124:127]
s_add_u32 s45, s42, 4096
buffer_load_dwordx4 a[224:227], v26, s[20:23], s45 offen sc1
v_mfma_f32_16x16x32_bf16 a[152:155], a[52:55], a[124:127], a[152:155]
buffer_load_dwordx4 a[228:231], v27, s[20:23], s45 offen sc1
v_mfma_f32_16x16x32_bf16 v[156:159], a[56:59], a[124:127], v[156:159]
s_add_u32 s45, s43, 4096
buffer_load_dwordx4 a[232:235], v26, s[20:23], s45 offen sc1
v_mfma_f32_16x16x32_bf16 a[156:159], a[60:63], a[124:127], a[156:159]
buffer_load_dwordx4 a[236:239], v27, s[20:23], s45 offen sc1
v_cvt_pk_bf16_f32 v32, v32, v33
v_cvt_pk_bf16_f32 v33, v34, v35
v_cvt_pk_bf16_f32 v34, v160, v161
v_cvt_pk_bf16_f32 v35, v162, v163
v_cvt_pk_bf16_f32 v64, v64, v65
v_cvt_pk_bf16_f32 v65, v66, v67
v_cvt_pk_bf16_f32 v66, v164, v165
v_cvt_pk_bf16_f32 v67, v166, v167
v_cvt_pk_bf16_f32 v96, v96, v97
v_cvt_pk_bf16_f32 v97, v98, v99
v_cvt_pk_bf16_f32 v98, v168, v169
v_cvt_pk_bf16_f32 v99, v170, v171
v_cvt_pk_bf16_f32 v128, v128, v129
v_cvt_pk_bf16_f32 v129, v130, v131
v_cvt_pk_bf16_f32 v130, v172, v173
v_cvt_pk_bf16_f32 v131, v174, v175
v_cvt_pk_bf16_f32 v36, v36, v37
v_cvt_pk_bf16_f32 v37, v38, v39
v_cvt_pk_bf16_f32 v38, v176, v177
v_cvt_pk_bf16_f32 v39, v178, v179
v_cvt_pk_bf16_f32 v68, v68, v69
v_cvt_pk_bf16_f32 v69, v70, v71
v_cvt_pk_bf16_f32 v70, v180, v181
v_cvt_pk_bf16_f32 v71, v182, v183
v_cvt_pk_bf16_f32 v100, v100, v101
v_cvt_pk_bf16_f32 v101, v102, v103
v_cvt_pk_bf16_f32 v102, v184, v185
v_cvt_pk_bf16_f32 v103, v186, v187
v_cvt_pk_bf16_f32 v132, v132, v133
v_cvt_pk_bf16_f32 v133, v134, v135
v_cvt_pk_bf16_f32 v134, v188, v189
v_cvt_pk_bf16_f32 v135, v190, v191
v_cvt_pk_bf16_f32 v40, v40, v41
v_cvt_pk_bf16_f32 v41, v42, v43
v_cvt_pk_bf16_f32 v42, v192, v193
v_cvt_pk_bf16_f32 v43, v194, v195
v_cvt_pk_bf16_f32 v72, v72, v73
v_cvt_pk_bf16_f32 v73, v74, v75
v_cvt_pk_bf16_f32 v74, v196, v197
v_cvt_pk_bf16_f32 v75, v198, v199
v_cvt_pk_bf16_f32 v104, v104, v105
v_cvt_pk_bf16_f32 v105, v106, v107
v_cvt_pk_bf16_f32 v106, v200, v201
v_cvt_pk_bf16_f32 v107, v202, v203
v_cvt_pk_bf16_f32 v136, v136, v137
v_cvt_pk_bf16_f32 v137, v138, v139
v_cvt_pk_bf16_f32 v138, v204, v205
v_cvt_pk_bf16_f32 v139, v206, v207
v_cvt_pk_bf16_f32 v44, v44, v45
v_cvt_pk_bf16_f32 v45, v46, v47
v_cvt_pk_bf16_f32 v46, v208, v209
v_cvt_pk_bf16_f32 v47, v210, v211
v_cvt_pk_bf16_f32 v76, v76, v77
v_cvt_pk_bf16_f32 v77, v78, v79
v_cvt_pk_bf16_f32 v78, v212, v213
v_cvt_pk_bf16_f32 v79, v214, v215
v_cvt_pk_bf16_f32 v108, v108, v109
v_cvt_pk_bf16_f32 v109, v110, v111
v_cvt_pk_bf16_f32 v110, v216, v217
v_cvt_pk_bf16_f32 v111, v218, v219
v_cvt_pk_bf16_f32 v140, v140, v141
v_cvt_pk_bf16_f32 v141, v142, v143
v_cvt_pk_bf16_f32 v142, v220, v221
v_cvt_pk_bf16_f32 v143, v222, v223
v_cvt_pk_bf16_f32 v48, v48, v49
v_cvt_pk_bf16_f32 v49, v50, v51
v_cvt_pk_bf16_f32 v50, v224, v225
v_cvt_pk_bf16_f32 v51, v226, v227
v_cvt_pk_bf16_f32 v80, v80, v81
v_cvt_pk_bf16_f32 v81, v82, v83
v_cvt_pk_bf16_f32 v82, v228, v229
v_cvt_pk_bf16_f32 v83, v230, v231
v_cvt_pk_bf16_f32 v112, v112, v113
v_cvt_pk_bf16_f32 v113, v114, v115
v_cvt_pk_bf16_f32 v114, v232, v233
v_cvt_pk_bf16_f32 v115, v234, v235
v_cvt_pk_bf16_f32 v144, v144, v145
v_cvt_pk_bf16_f32 v145, v146, v147
v_cvt_pk_bf16_f32 v146, v236, v237
v_cvt_pk_bf16_f32 v147, v238, v239
v_cvt_pk_bf16_f32 v52, v52, v53
v_cvt_pk_bf16_f32 v53, v54, v55
v_cvt_pk_bf16_f32 v54, v240, v241
v_cvt_pk_bf16_f32 v55, v242, v243
v_cvt_pk_bf16_f32 v84, v84, v85
v_cvt_pk_bf16_f32 v85, v86, v87
v_cvt_pk_bf16_f32 v86, v244, v245
v_cvt_pk_bf16_f32 v87, v246, v247
v_cvt_pk_bf16_f32 v116, v116, v117
v_cvt_pk_bf16_f32 v117, v118, v119
v_cvt_pk_bf16_f32 v118, v248, v249
v_cvt_pk_bf16_f32 v119, v250, v251
v_cvt_pk_bf16_f32 v148, v148, v149
v_cvt_pk_bf16_f32 v149, v150, v151
v_cvt_pk_bf16_f32 v150, v252, v253
v_cvt_pk_bf16_f32 v151, v254, v255
v_accvgpr_read_b32 v4, a128
v_accvgpr_read_b32 v5, a129
v_accvgpr_read_b32 v6, a130
v_accvgpr_read_b32 v7, a131
v_cvt_pk_bf16_f32 v56, v56, v57
v_cvt_pk_bf16_f32 v57, v58, v59
v_cvt_pk_bf16_f32 v58, v4, v5
v_cvt_pk_bf16_f32 v59, v6, v7
v_accvgpr_read_b32 v4, a132
v_accvgpr_read_b32 v5, a133
v_accvgpr_read_b32 v6, a134
v_accvgpr_read_b32 v7, a135
v_cvt_pk_bf16_f32 v88, v88, v89
v_cvt_pk_bf16_f32 v89, v90, v91
v_cvt_pk_bf16_f32 v90, v4, v5
v_cvt_pk_bf16_f32 v91, v6, v7
v_accvgpr_read_b32 v4, a136
v_accvgpr_read_b32 v5, a137
v_accvgpr_read_b32 v6, a138
v_accvgpr_read_b32 v7, a139
v_cvt_pk_bf16_f32 v120, v120, v121
v_cvt_pk_bf16_f32 v121, v122, v123
v_cvt_pk_bf16_f32 v122, v4, v5
v_cvt_pk_bf16_f32 v123, v6, v7
v_accvgpr_read_b32 v4, a140
v_accvgpr_read_b32 v5, a141
v_accvgpr_read_b32 v6, a142
v_accvgpr_read_b32 v7, a143
v_cvt_pk_bf16_f32 v152, v152, v153
v_cvt_pk_bf16_f32 v153, v154, v155
v_cvt_pk_bf16_f32 v154, v4, v5
v_cvt_pk_bf16_f32 v155, v6, v7
v_accvgpr_read_b32 v4, a144
v_accvgpr_read_b32 v5, a145
v_accvgpr_read_b32 v6, a146
v_accvgpr_read_b32 v7, a147
v_cvt_pk_bf16_f32 v60, v60, v61
v_cvt_pk_bf16_f32 v61, v62, v63
v_cvt_pk_bf16_f32 v62, v4, v5
v_cvt_pk_bf16_f32 v63, v6, v7
v_accvgpr_read_b32 v4, a148
v_accvgpr_read_b32 v5, a149
v_accvgpr_read_b32 v6, a150
v_accvgpr_read_b32 v7, a151
v_cvt_pk_bf16_f32 v92, v92, v93
v_cvt_pk_bf16_f32 v93, v94, v95
v_cvt_pk_bf16_f32 v94, v4, v5
v_cvt_pk_bf16_f32 v95, v6, v7
v_accvgpr_read_b32 v4, a152
v_accvgpr_read_b32 v5, a153
v_accvgpr_read_b32 v6, a154
v_accvgpr_read_b32 v7, a155
v_cvt_pk_bf16_f32 v124, v124, v125
v_cvt_pk_bf16_f32 v125, v126, v127
v_cvt_pk_bf16_f32 v126, v4, v5
v_cvt_pk_bf16_f32 v127, v6, v7
v_accvgpr_read_b32 v4, a156
v_accvgpr_read_b32 v5, a157
v_accvgpr_read_b32 v6, a158
v_accvgpr_read_b32 v7, a159
v_cvt_pk_bf16_f32 v156, v156, v157
v_cvt_pk_bf16_f32 v157, v158, v159
v_cvt_pk_bf16_f32 v158, v4, v5
v_cvt_pk_bf16_f32 v159, v6, v7
parallel_sum__compressed_kv_cla__geglu_ffn__prompt_kernel_q:
s_waitcnt vmcnt(18)
s_barrier
ds_read_b64_tr_b16 a[64:65], v18 offset:0
ds_read_b64_tr_b16 a[66:67], v18 offset:4096
ds_read_b64_tr_b16 a[68:69], v19 offset:0
ds_read_b64_tr_b16 a[70:71], v19 offset:4096
ds_read_b64_tr_b16 a[72:73], v20 offset:0
ds_read_b64_tr_b16 a[74:75], v20 offset:4096
ds_read_b64_tr_b16 a[76:77], v21 offset:0
ds_read_b64_tr_b16 a[78:79], v21 offset:4096
ds_read_b64_tr_b16 a[80:81], v22 offset:0
ds_read_b64_tr_b16 a[82:83], v22 offset:4096
ds_read_b64_tr_b16 a[84:85], v23 offset:0
ds_read_b64_tr_b16 a[86:87], v23 offset:4096
s_waitcnt lgkmcnt(8)
v_mfma_f32_16x16x32_bf16 v[160:163], a[64:67], a[160:163], 0
ds_read_b64_tr_b16 a[88:89], v24 offset:0
s_add_u32 s45, s42, 5120
v_mfma_f32_16x16x32_bf16 v[164:167], a[64:67], a[164:167], 0
ds_read_b64_tr_b16 a[90:91], v24 offset:4096
buffer_load_dwordx4 a[240:243], v26, s[20:23], s45 offen sc1
v_mfma_f32_16x16x32_bf16 v[168:171], a[64:67], a[168:171], 0
v_mfma_f32_16x16x32_bf16 v[172:175], a[64:67], a[172:175], 0
buffer_load_dwordx4 a[244:247], v27, s[20:23], s45 offen sc1
v_mfma_f32_16x16x32_bf16 v[224:227], a[68:71], a[160:163], 0
ds_read_b64_tr_b16 a[92:93], v25 offset:0
v_mfma_f32_16x16x32_bf16 v[228:231], a[68:71], a[164:167], 0
ds_read_b64_tr_b16 a[94:95], v25 offset:4096
s_add_u32 s45, s43, 5120
v_mfma_f32_16x16x32_bf16 v[232:235], a[68:71], a[168:171], 0
v_mfma_f32_16x16x32_bf16 v[236:239], a[68:71], a[172:175], 0
buffer_load_dwordx4 a[248:251], v26, s[20:23], s45 offen sc1
s_waitcnt lgkmcnt(8)
v_mfma_f32_16x16x32_bf16 v[176:179], a[72:75], a[160:163], 0
ds_read_b64_tr_b16 a[64:65], v18 offset:8192
v_mfma_f32_16x16x32_bf16 v[180:183], a[72:75], a[164:167], 0
ds_read_b64_tr_b16 a[66:67], v18 offset:12288
buffer_load_dwordx4 a[252:255], v27, s[20:23], s45 offen sc1
v_mfma_f32_16x16x32_bf16 v[184:187], a[72:75], a[168:171], 0
v_mfma_f32_16x16x32_bf16 v[188:191], a[72:75], a[172:175], 0
s_add_u32 m0, s41, 24576
v_mfma_f32_16x16x32_bf16 v[240:243], a[76:79], a[160:163], 0
ds_read_b64_tr_b16 a[68:69], v19 offset:8192
v_mfma_f32_16x16x32_bf16 v[244:247], a[76:79], a[164:167], 0
ds_read_b64_tr_b16 a[70:71], v19 offset:12288
s_add_u32 s44, s40, 786432
v_mfma_f32_16x16x32_bf16 v[248:251], a[76:79], a[168:171], 0
v_mfma_f32_16x16x32_bf16 v[252:255], a[76:79], a[172:175], 0
buffer_load_dwordx4 v16, s[8:11], s44 offen offset:0 lds
s_waitcnt lgkmcnt(8)
v_mfma_f32_16x16x32_bf16 v[192:195], a[80:83], a[160:163], 0
ds_read_b64_tr_b16 a[72:73], v20 offset:8192
buffer_load_dwordx4 v17, s[8:11], s44 offen offset:1024 lds
v_mfma_f32_16x16x32_bf16 v[196:199], a[80:83], a[164:167], 0
ds_read_b64_tr_b16 a[74:75], v20 offset:12288
v_mfma_f32_16x16x32_bf16 v[200:203], a[80:83], a[168:171], 0
s_add_u32 m0, s41, 32768
v_mfma_f32_16x16x32_bf16 v[204:207], a[80:83], a[172:175], 0
v_mfma_f32_16x16x32_bf16 a[0:3], a[84:87], a[160:163], 0
ds_read_b64_tr_b16 a[76:77], v21 offset:8192
s_add_u32 s44, s40, 1048576
v_mfma_f32_16x16x32_bf16 a[4:7], a[84:87], a[164:167], 0
ds_read_b64_tr_b16 a[78:79], v21 offset:12288
v_mfma_f32_16x16x32_bf16 a[8:11], a[84:87], a[168:171], 0
buffer_load_dwordx4 v16, s[8:11], s44 offen offset:0 lds
v_mfma_f32_16x16x32_bf16 a[12:15], a[84:87], a[172:175], 0
s_waitcnt lgkmcnt(8)
v_mfma_f32_16x16x32_bf16 v[208:211], a[88:91], a[160:163], 0
ds_read_b64_tr_b16 a[80:81], v22 offset:8192
buffer_load_dwordx4 v17, s[8:11], s44 offen offset:1024 lds
v_mfma_f32_16x16x32_bf16 v[212:215], a[88:91], a[164:167], 0
ds_read_b64_tr_b16 a[82:83], v22 offset:12288
v_mfma_f32_16x16x32_bf16 v[216:219], a[88:91], a[168:171], 0
s_add_u32 s46, s92, 0
v_mfma_f32_16x16x32_bf16 v[220:223], a[88:91], a[172:175], 0
v_mfma_f32_16x16x32_bf16 a[16:19], a[92:95], a[160:163], 0
ds_read_b64_tr_b16 a[84:85], v23 offset:8192
buffer_store_dwordx4 v[32:35], v31, s[20:23], s46 offen offset:0 sc1
v_mfma_f32_16x16x32_bf16 a[20:23], a[92:95], a[164:167], 0
ds_read_b64_tr_b16 a[86:87], v23 offset:12288
v_mfma_f32_16x16x32_bf16 a[24:27], a[92:95], a[168:171], 0
buffer_store_dwordx4 v[36:39], v31, s[20:23], s46 offen offset:256 sc1
v_mfma_f32_16x16x32_bf16 a[28:31], a[92:95], a[172:175], 0
s_waitcnt vmcnt(22) lgkmcnt(8)
v_mfma_f32_16x16x32_bf16 v[160:163], a[64:67], a[176:179], v[160:163]
ds_read_b64_tr_b16 a[88:89], v24 offset:8192
s_add_u32 s45, s42, 6144
v_mfma_f32_16x16x32_bf16 v[164:167], a[64:67], a[180:183], v[164:167]
ds_read_b64_tr_b16 a[90:91], v24 offset:12288
v_mfma_f32_16x16x32_bf16 v[168:171], a[64:67], a[184:187], v[168:171]
buffer_load_dwordx4 a[160:163], v26, s[20:23], s45 offen sc1
v_mfma_f32_16x16x32_bf16 v[172:175], a[64:67], a[188:191], v[172:175]
v_mfma_f32_16x16x32_bf16 v[224:227], a[68:71], a[176:179], v[224:227]
ds_read_b64_tr_b16 a[92:93], v25 offset:8192
buffer_load_dwordx4 a[164:167], v27, s[20:23], s45 offen sc1
v_mfma_f32_16x16x32_bf16 v[228:231], a[68:71], a[180:183], v[228:231]
ds_read_b64_tr_b16 a[94:95], v25 offset:12288
v_mfma_f32_16x16x32_bf16 v[232:235], a[68:71], a[184:187], v[232:235]
s_waitcnt vmcnt(6)
s_add_u32 s45, s43, 6144
v_mfma_f32_16x16x32_bf16 v[236:239], a[68:71], a[188:191], v[236:239]
s_barrier
s_waitcnt lgkmcnt(8)
v_mfma_f32_16x16x32_bf16 v[176:179], a[72:75], a[176:179], v[176:179]
ds_read_b64_tr_b16 a[64:65], v18 offset:16384
buffer_load_dwordx4 a[168:171], v26, s[20:23], s45 offen sc1
v_mfma_f32_16x16x32_bf16 v[180:183], a[72:75], a[180:183], v[180:183]
ds_read_b64_tr_b16 a[66:67], v18 offset:20480
v_mfma_f32_16x16x32_bf16 v[184:187], a[72:75], a[184:187], v[184:187]
buffer_load_dwordx4 a[172:175], v27, s[20:23], s45 offen sc1
v_mfma_f32_16x16x32_bf16 v[188:191], a[72:75], a[188:191], v[188:191]
v_mfma_f32_16x16x32_bf16 v[240:243], a[76:79], a[176:179], v[240:243]
ds_read_b64_tr_b16 a[68:69], v19 offset:16384
s_add_u32 m0, s41, 40960
v_mfma_f32_16x16x32_bf16 v[244:247], a[76:79], a[180:183], v[244:247]
ds_read_b64_tr_b16 a[70:71], v19 offset:20480
v_mfma_f32_16x16x32_bf16 v[248:251], a[76:79], a[184:187], v[248:251]
s_add_u32 s44, s40, 1310720
v_mfma_f32_16x16x32_bf16 v[252:255], a[76:79], a[188:191], v[252:255]
s_waitcnt lgkmcnt(8)
v_mfma_f32_16x16x32_bf16 v[192:195], a[80:83], a[176:179], v[192:195]
ds_read_b64_tr_b16 a[72:73], v20 offset:16384
buffer_load_dwordx4 v16, s[8:11], s44 offen offset:0 lds
v_mfma_f32_16x16x32_bf16 v[196:199], a[80:83], a[180:183], v[196:199]
ds_read_b64_tr_b16 a[74:75], v20 offset:20480
v_mfma_f32_16x16x32_bf16 v[200:203], a[80:83], a[184:187], v[200:203]
buffer_load_dwordx4 v17, s[8:11], s44 offen offset:1024 lds
v_mfma_f32_16x16x32_bf16 v[204:207], a[80:83], a[188:191], v[204:207]
v_mfma_f32_16x16x32_bf16 a[0:3], a[84:87], a[176:179], a[0:3]
ds_read_b64_tr_b16 a[76:77], v21 offset:16384
s_add_u32 m0, s41, 49152
v_mfma_f32_16x16x32_bf16 a[4:7], a[84:87], a[180:183], a[4:7]
ds_read_b64_tr_b16 a[78:79], v21 offset:20480
v_mfma_f32_16x16x32_bf16 a[8:11], a[84:87], a[184:187], a[8:11]
s_add_u32 s44, s40, 1572864
v_mfma_f32_16x16x32_bf16 a[12:15], a[84:87], a[188:191], a[12:15]
s_waitcnt lgkmcnt(8)
v_mfma_f32_16x16x32_bf16 v[208:211], a[88:91], a[176:179], v[208:211]
ds_read_b64_tr_b16 a[80:81], v22 offset:16384
buffer_load_dwordx4 v16, s[8:11], s44 offen offset:0 lds
v_mfma_f32_16x16x32_bf16 v[212:215], a[88:91], a[180:183], v[212:215]
ds_read_b64_tr_b16 a[82:83], v22 offset:20480
v_mfma_f32_16x16x32_bf16 v[216:219], a[88:91], a[184:187], v[216:219]
buffer_load_dwordx4 v17, s[8:11], s44 offen offset:1024 lds
v_mfma_f32_16x16x32_bf16 v[220:223], a[88:91], a[188:191], v[220:223]
v_mfma_f32_16x16x32_bf16 a[16:19], a[92:95], a[176:179], a[16:19]
ds_read_b64_tr_b16 a[84:85], v23 offset:16384
buffer_store_dwordx4 v[40:43], v31, s[20:23], s46 offen offset:2048 sc1
v_mfma_f32_16x16x32_bf16 a[20:23], a[92:95], a[180:183], a[20:23]
ds_read_b64_tr_b16 a[86:87], v23 offset:20480
v_mfma_f32_16x16x32_bf16 a[24:27], a[92:95], a[184:187], a[24:27]
buffer_store_dwordx4 v[44:47], v31, s[20:23], s46 offen offset:2304 sc1
v_mfma_f32_16x16x32_bf16 a[28:31], a[92:95], a[188:191], a[28:31]
s_waitcnt lgkmcnt(8)
v_mfma_f32_16x16x32_bf16 v[160:163], a[64:67], a[192:195], v[160:163]
ds_read_b64_tr_b16 a[88:89], v24 offset:16384
v_mfma_f32_16x16x32_bf16 v[164:167], a[64:67], a[196:199], v[164:167]
ds_read_b64_tr_b16 a[90:91], v24 offset:20480
v_mfma_f32_16x16x32_bf16 v[168:171], a[64:67], a[200:203], v[168:171]
s_add_u32 s45, s42, 7168
v_mfma_f32_16x16x32_bf16 v[172:175], a[64:67], a[204:207], v[172:175]
buffer_load_dwordx4 a[176:179], v26, s[20:23], s45 offen sc1
v_mfma_f32_16x16x32_bf16 v[224:227], a[68:71], a[192:195], v[224:227]
ds_read_b64_tr_b16 a[92:93], v25 offset:16384
v_mfma_f32_16x16x32_bf16 v[228:231], a[68:71], a[196:199], v[228:231]
ds_read_b64_tr_b16 a[94:95], v25 offset:20480
v_mfma_f32_16x16x32_bf16 v[232:235], a[68:71], a[200:203], v[232:235]
buffer_load_dwordx4 a[180:183], v27, s[20:23], s45 offen sc1
v_mfma_f32_16x16x32_bf16 v[236:239], a[68:71], a[204:207], v[236:239]
s_add_u32 s45, s43, 7168
s_waitcnt lgkmcnt(8)
v_mfma_f32_16x16x32_bf16 v[176:179], a[72:75], a[192:195], v[176:179]
ds_read_b64_tr_b16 a[64:65], v18 offset:24576
v_mfma_f32_16x16x32_bf16 v[180:183], a[72:75], a[196:199], v[180:183]
ds_read_b64_tr_b16 a[66:67], v18 offset:28672
v_mfma_f32_16x16x32_bf16 v[184:187], a[72:75], a[200:203], v[184:187]
buffer_load_dwordx4 a[184:187], v26, s[20:23], s45 offen sc1
v_mfma_f32_16x16x32_bf16 v[188:191], a[72:75], a[204:207], v[188:191]
v_mfma_f32_16x16x32_bf16 v[240:243], a[76:79], a[192:195], v[240:243]
ds_read_b64_tr_b16 a[68:69], v19 offset:24576
v_mfma_f32_16x16x32_bf16 v[244:247], a[76:79], a[196:199], v[244:247]
ds_read_b64_tr_b16 a[70:71], v19 offset:28672
v_mfma_f32_16x16x32_bf16 v[248:251], a[76:79], a[200:203], v[248:251]
buffer_load_dwordx4 a[188:191], v27, s[20:23], s45 offen sc1
v_mfma_f32_16x16x32_bf16 v[252:255], a[76:79], a[204:207], v[252:255]
s_add_u32 m0, s41, 57344
s_waitcnt lgkmcnt(8)
v_mfma_f32_16x16x32_bf16 v[192:195], a[80:83], a[192:195], v[192:195]
ds_read_b64_tr_b16 a[72:73], v20 offset:24576
v_mfma_f32_16x16x32_bf16 v[196:199], a[80:83], a[196:199], v[196:199]
ds_read_b64_tr_b16 a[74:75], v20 offset:28672
v_mfma_f32_16x16x32_bf16 v[200:203], a[80:83], a[200:203], v[200:203]
s_add_u32 s44, s40, 1835008
v_mfma_f32_16x16x32_bf16 v[204:207], a[80:83], a[204:207], v[204:207]
buffer_load_dwordx4 v16, s[8:11], s44 offen offset:0 lds
v_mfma_f32_16x16x32_bf16 a[0:3], a[84:87], a[192:195], a[0:3]
ds_read_b64_tr_b16 a[76:77], v21 offset:24576
v_mfma_f32_16x16x32_bf16 a[4:7], a[84:87], a[196:199], a[4:7]
ds_read_b64_tr_b16 a[78:79], v21 offset:28672
v_mfma_f32_16x16x32_bf16 a[8:11], a[84:87], a[200:203], a[8:11]
v_mfma_f32_16x16x32_bf16 a[12:15], a[84:87], a[204:207], a[12:15]
buffer_load_dwordx4 v17, s[8:11], s44 offen offset:1024 lds
s_waitcnt lgkmcnt(8)
v_mfma_f32_16x16x32_bf16 v[208:211], a[88:91], a[192:195], v[208:211]
ds_read_b64_tr_b16 a[80:81], v22 offset:24576
v_mfma_f32_16x16x32_bf16 v[212:215], a[88:91], a[196:199], v[212:215]
ds_read_b64_tr_b16 a[82:83], v22 offset:28672
v_mfma_f32_16x16x32_bf16 v[216:219], a[88:91], a[200:203], v[216:219]
s_add_u32 s46, s92, 4096
v_mfma_f32_16x16x32_bf16 v[220:223], a[88:91], a[204:207], v[220:223]
buffer_store_dwordx4 v[48:51], v31, s[20:23], s46 offen offset:0 sc1
v_mfma_f32_16x16x32_bf16 a[16:19], a[92:95], a[192:195], a[16:19]
ds_read_b64_tr_b16 a[84:85], v23 offset:24576
v_mfma_f32_16x16x32_bf16 a[20:23], a[92:95], a[196:199], a[20:23]
ds_read_b64_tr_b16 a[86:87], v23 offset:28672
v_mfma_f32_16x16x32_bf16 a[24:27], a[92:95], a[200:203], a[24:27]
buffer_store_dwordx4 v[52:55], v31, s[20:23], s46 offen offset:256 sc1
v_mfma_f32_16x16x32_bf16 a[28:31], a[92:95], a[204:207], a[28:31]
s_waitcnt lgkmcnt(8)
v_mfma_f32_16x16x32_bf16 v[160:163], a[64:67], a[208:211], v[160:163]
ds_read_b64_tr_b16 a[88:89], v24 offset:24576
v_mfma_f32_16x16x32_bf16 v[164:167], a[64:67], a[212:215], v[164:167]
ds_read_b64_tr_b16 a[90:91], v24 offset:28672
v_mfma_f32_16x16x32_bf16 v[168:171], a[64:67], a[216:219], v[168:171]
s_add_u32 s45, s42, 8192
v_mfma_f32_16x16x32_bf16 v[172:175], a[64:67], a[220:223], v[172:175]
buffer_load_dwordx4 a[192:195], v26, s[20:23], s45 offen sc1
v_mfma_f32_16x16x32_bf16 v[224:227], a[68:71], a[208:211], v[224:227]
ds_read_b64_tr_b16 a[92:93], v25 offset:24576
v_mfma_f32_16x16x32_bf16 v[228:231], a[68:71], a[212:215], v[228:231]
ds_read_b64_tr_b16 a[94:95], v25 offset:28672
v_mfma_f32_16x16x32_bf16 v[232:235], a[68:71], a[216:219], v[232:235]
s_waitcnt vmcnt(13)
v_mfma_f32_16x16x32_bf16 v[236:239], a[68:71], a[220:223], v[236:239]
s_barrier
s_waitcnt lgkmcnt(8)
v_mfma_f32_16x16x32_bf16 v[176:179], a[72:75], a[208:211], v[176:179]
ds_read_b64_tr_b16 a[64:65], v18 offset:32768
v_mfma_f32_16x16x32_bf16 v[180:183], a[72:75], a[212:215], v[180:183]
ds_read_b64_tr_b16 a[66:67], v18 offset:36864
v_mfma_f32_16x16x32_bf16 v[184:187], a[72:75], a[216:219], v[184:187]
buffer_load_dwordx4 a[196:199], v27, s[20:23], s45 offen sc1
v_mfma_f32_16x16x32_bf16 v[188:191], a[72:75], a[220:223], v[188:191]
s_add_u32 s45, s43, 8192
v_mfma_f32_16x16x32_bf16 v[240:243], a[76:79], a[208:211], v[240:243]
ds_read_b64_tr_b16 a[68:69], v19 offset:32768
v_mfma_f32_16x16x32_bf16 v[244:247], a[76:79], a[212:215], v[244:247]
ds_read_b64_tr_b16 a[70:71], v19 offset:36864
v_mfma_f32_16x16x32_bf16 v[248:251], a[76:79], a[216:219], v[248:251]
buffer_load_dwordx4 a[200:203], v26, s[20:23], s45 offen sc1
v_mfma_f32_16x16x32_bf16 v[252:255], a[76:79], a[220:223], v[252:255]
buffer_load_dwordx4 a[204:207], v27, s[20:23], s45 offen sc1
s_waitcnt lgkmcnt(8)
v_mfma_f32_16x16x32_bf16 v[192:195], a[80:83], a[208:211], v[192:195]
ds_read_b64_tr_b16 a[72:73], v20 offset:32768
v_mfma_f32_16x16x32_bf16 v[196:199], a[80:83], a[212:215], v[196:199]
ds_read_b64_tr_b16 a[74:75], v20 offset:36864
v_mfma_f32_16x16x32_bf16 v[200:203], a[80:83], a[216:219], v[200:203]
v_mfma_f32_16x16x32_bf16 v[204:207], a[80:83], a[220:223], v[204:207]
s_add_u32 m0, s41, 0
v_mfma_f32_16x16x32_bf16 a[0:3], a[84:87], a[208:211], a[0:3]
ds_read_b64_tr_b16 a[76:77], v21 offset:32768
v_mfma_f32_16x16x32_bf16 a[4:7], a[84:87], a[212:215], a[4:7]
ds_read_b64_tr_b16 a[78:79], v21 offset:36864
v_mfma_f32_16x16x32_bf16 a[8:11], a[84:87], a[216:219], a[8:11]
s_add_u32 s44, s40, 2097152
v_mfma_f32_16x16x32_bf16 a[12:15], a[84:87], a[220:223], a[12:15]
buffer_load_dwordx4 v16, s[8:11], s44 offen offset:0 lds
s_waitcnt lgkmcnt(8)
v_mfma_f32_16x16x32_bf16 v[208:211], a[88:91], a[208:211], v[208:211]
ds_read_b64_tr_b16 a[80:81], v22 offset:32768
v_mfma_f32_16x16x32_bf16 v[212:215], a[88:91], a[212:215], v[212:215]
ds_read_b64_tr_b16 a[82:83], v22 offset:36864
v_mfma_f32_16x16x32_bf16 v[216:219], a[88:91], a[216:219], v[216:219]
buffer_load_dwordx4 v17, s[8:11], s44 offen offset:1024 lds
v_mfma_f32_16x16x32_bf16 v[220:223], a[88:91], a[220:223], v[220:223]
buffer_store_dwordx4 v[56:59], v31, s[20:23], s46 offen offset:2048 sc1
v_mfma_f32_16x16x32_bf16 a[16:19], a[92:95], a[208:211], a[16:19]
ds_read_b64_tr_b16 a[84:85], v23 offset:32768
v_mfma_f32_16x16x32_bf16 a[20:23], a[92:95], a[212:215], a[20:23]
ds_read_b64_tr_b16 a[86:87], v23 offset:36864
v_mfma_f32_16x16x32_bf16 a[24:27], a[92:95], a[216:219], a[24:27]
buffer_store_dwordx4 v[60:63], v31, s[20:23], s46 offen offset:2304 sc1
v_mfma_f32_16x16x32_bf16 a[28:31], a[92:95], a[220:223], a[28:31]
s_waitcnt lgkmcnt(8)
v_mfma_f32_16x16x32_bf16 v[160:163], a[64:67], a[224:227], v[160:163]
ds_read_b64_tr_b16 a[88:89], v24 offset:32768
v_mfma_f32_16x16x32_bf16 v[164:167], a[64:67], a[228:231], v[164:167]
ds_read_b64_tr_b16 a[90:91], v24 offset:36864
v_mfma_f32_16x16x32_bf16 v[168:171], a[64:67], a[232:235], v[168:171]
s_add_u32 s45, s42, 9216
v_mfma_f32_16x16x32_bf16 v[172:175], a[64:67], a[236:239], v[172:175]
buffer_load_dwordx4 a[208:211], v26, s[20:23], s45 offen sc1
v_mfma_f32_16x16x32_bf16 v[224:227], a[68:71], a[224:227], v[224:227]
ds_read_b64_tr_b16 a[92:93], v25 offset:32768
v_mfma_f32_16x16x32_bf16 v[228:231], a[68:71], a[228:231], v[228:231]
ds_read_b64_tr_b16 a[94:95], v25 offset:36864
v_mfma_f32_16x16x32_bf16 v[232:235], a[68:71], a[232:235], v[232:235]
buffer_load_dwordx4 a[212:215], v27, s[20:23], s45 offen sc1
v_mfma_f32_16x16x32_bf16 v[236:239], a[68:71], a[236:239], v[236:239]
s_add_u32 s45, s43, 9216
s_waitcnt lgkmcnt(8)
v_mfma_f32_16x16x32_bf16 v[176:179], a[72:75], a[224:227], v[176:179]
ds_read_b64_tr_b16 a[64:65], v18 offset:40960
v_mfma_f32_16x16x32_bf16 v[180:183], a[72:75], a[228:231], v[180:183]
ds_read_b64_tr_b16 a[66:67], v18 offset:45056
v_mfma_f32_16x16x32_bf16 v[184:187], a[72:75], a[232:235], v[184:187]
buffer_load_dwordx4 a[216:219], v26, s[20:23], s45 offen sc1
v_mfma_f32_16x16x32_bf16 v[188:191], a[72:75], a[236:239], v[188:191]
buffer_load_dwordx4 a[220:223], v27, s[20:23], s45 offen sc1
v_mfma_f32_16x16x32_bf16 v[240:243], a[76:79], a[224:227], v[240:243]
ds_read_b64_tr_b16 a[68:69], v19 offset:40960
v_mfma_f32_16x16x32_bf16 v[244:247], a[76:79], a[228:231], v[244:247]
ds_read_b64_tr_b16 a[70:71], v19 offset:45056
v_mfma_f32_16x16x32_bf16 v[248:251], a[76:79], a[232:235], v[248:251]
s_add_u32 m0, s41, 8192
v_mfma_f32_16x16x32_bf16 v[252:255], a[76:79], a[236:239], v[252:255]
s_waitcnt lgkmcnt(8)
v_mfma_f32_16x16x32_bf16 v[192:195], a[80:83], a[224:227], v[192:195]
ds_read_b64_tr_b16 a[72:73], v20 offset:40960
v_mfma_f32_16x16x32_bf16 v[196:199], a[80:83], a[228:231], v[196:199]
ds_read_b64_tr_b16 a[74:75], v20 offset:45056
v_mfma_f32_16x16x32_bf16 v[200:203], a[80:83], a[232:235], v[200:203]
s_add_u32 s44, s40, 2359296
v_mfma_f32_16x16x32_bf16 v[204:207], a[80:83], a[236:239], v[204:207]
buffer_load_dwordx4 v16, s[8:11], s44 offen offset:0 lds
v_mfma_f32_16x16x32_bf16 a[0:3], a[84:87], a[224:227], a[0:3]
ds_read_b64_tr_b16 a[76:77], v21 offset:40960
v_mfma_f32_16x16x32_bf16 a[4:7], a[84:87], a[228:231], a[4:7]
ds_read_b64_tr_b16 a[78:79], v21 offset:45056
v_mfma_f32_16x16x32_bf16 a[8:11], a[84:87], a[232:235], a[8:11]
buffer_load_dwordx4 v17, s[8:11], s44 offen offset:1024 lds
v_mfma_f32_16x16x32_bf16 a[12:15], a[84:87], a[236:239], a[12:15]
s_add_u32 s46, s92, 16384
s_waitcnt lgkmcnt(8)
v_mfma_f32_16x16x32_bf16 v[208:211], a[88:91], a[224:227], v[208:211]
ds_read_b64_tr_b16 a[80:81], v22 offset:40960
v_mfma_f32_16x16x32_bf16 v[212:215], a[88:91], a[228:231], v[212:215]
ds_read_b64_tr_b16 a[82:83], v22 offset:45056
v_mfma_f32_16x16x32_bf16 v[216:219], a[88:91], a[232:235], v[216:219]
buffer_store_dwordx4 v[64:67], v31, s[20:23], s46 offen offset:0 sc1
v_mfma_f32_16x16x32_bf16 v[220:223], a[88:91], a[236:239], v[220:223]
buffer_store_dwordx4 v[68:71], v31, s[20:23], s46 offen offset:256 sc1
v_mfma_f32_16x16x32_bf16 a[16:19], a[92:95], a[224:227], a[16:19]
ds_read_b64_tr_b16 a[84:85], v23 offset:40960
v_mfma_f32_16x16x32_bf16 a[20:23], a[92:95], a[228:231], a[20:23]
ds_read_b64_tr_b16 a[86:87], v23 offset:45056
v_mfma_f32_16x16x32_bf16 a[24:27], a[92:95], a[232:235], a[24:27]
s_getpc_b64 s[4:5]
parallel_sum__compressed_kv_cla__geglu_ffn__prompt_kernel_pc4:
s_add_u32 s4, s4, parallel_sum__compressed_kv_cla__geglu_ffn__prompt_kernel_L_gu-parallel_sum__compressed_kv_cla__geglu_ffn__prompt_kernel_pc4
s_addc_u32 s5, s5, 0
s_lshr_b32 s3, s2, 3
s_lshl_b32 s3, s3, 2
s_add_u32 s3, s3, s28
s_mul_i32 s3, s3, 2
v_add_u32 v12, s3, v0
v_lshlrev_b32 v12, 7, v12
v_mov_b32 v13, parallel_sum__compressed_kv_cla__geglu_ffn__prompt_kernel_L_ge-parallel_sum__compressed_kv_cla__geglu_ffn__prompt_kernel_L_gu
v_cmp_lt_u32 vcc, v12, v13
s_nop 1
v_cndmask_b32 v12, 0, v12, vcc
v_mov_b32 v13, s5
v_add_co_u32 v12, vcc, s4, v12
s_nop 1
v_addc_co_u32 v13, vcc, 0, v13, vcc
s_mov_b64 exec, 3
global_load_dword v28, v[12:13], off
s_mov_b64 exec, -1
v_mfma_f32_16x16x32_bf16 a[28:31], a[92:95], a[236:239], a[28:31]
s_waitcnt lgkmcnt(8)
v_mfma_f32_16x16x32_bf16 v[160:163], a[64:67], a[240:243], v[160:163]
ds_read_b64_tr_b16 a[88:89], v24 offset:40960
v_mfma_f32_16x16x32_bf16 v[164:167], a[64:67], a[244:247], v[164:167]
ds_read_b64_tr_b16 a[90:91], v24 offset:45056
v_mfma_f32_16x16x32_bf16 v[168:171], a[64:67], a[248:251], v[168:171]
s_add_u32 s45, s42, 10240
v_mfma_f32_16x16x32_bf16 v[172:175], a[64:67], a[252:255], v[172:175]
buffer_load_dwordx4 a[224:227], v26, s[20:23], s45 offen sc1
v_mfma_f32_16x16x32_bf16 v[224:227], a[68:71], a[240:243], v[224:227]
ds_read_b64_tr_b16 a[92:93], v25 offset:40960
v_mfma_f32_16x16x32_bf16 v[228:231], a[68:71], a[244:247], v[228:231]
ds_read_b64_tr_b16 a[94:95], v25 offset:45056
v_mfma_f32_16x16x32_bf16 v[232:235], a[68:71], a[248:251], v[232:235]
s_waitcnt vmcnt(20)
v_mfma_f32_16x16x32_bf16 v[236:239], a[68:71], a[252:255], v[236:239]
s_barrier
s_waitcnt lgkmcnt(8)
v_mfma_f32_16x16x32_bf16 v[176:179], a[72:75], a[240:243], v[176:179]
ds_read_b64_tr_b16 a[64:65], v18 offset:49152
v_mfma_f32_16x16x32_bf16 v[180:183], a[72:75], a[244:247], v[180:183]
ds_read_b64_tr_b16 a[66:67], v18 offset:53248
v_mfma_f32_16x16x32_bf16 v[184:187], a[72:75], a[248:251], v[184:187]
buffer_load_dwordx4 a[228:231], v27, s[20:23], s45 offen sc1
v_mfma_f32_16x16x32_bf16 v[188:191], a[72:75], a[252:255], v[188:191]
s_add_u32 s45, s43, 10240
v_mfma_f32_16x16x32_bf16 v[240:243], a[76:79], a[240:243], v[240:243]
ds_read_b64_tr_b16 a[68:69], v19 offset:49152
v_mfma_f32_16x16x32_bf16 v[244:247], a[76:79], a[244:247], v[244:247]
ds_read_b64_tr_b16 a[70:71], v19 offset:53248
v_mfma_f32_16x16x32_bf16 v[248:251], a[76:79], a[248:251], v[248:251]
buffer_load_dwordx4 a[232:235], v26, s[20:23], s45 offen sc1
v_mfma_f32_16x16x32_bf16 v[252:255], a[76:79], a[252:255], v[252:255]
buffer_load_dwordx4 a[236:239], v27, s[20:23], s45 offen sc1
s_waitcnt lgkmcnt(8)
v_mfma_f32_16x16x32_bf16 v[192:195], a[80:83], a[240:243], v[192:195]
ds_read_b64_tr_b16 a[72:73], v20 offset:49152
v_mfma_f32_16x16x32_bf16 v[196:199], a[80:83], a[244:247], v[196:199]
ds_read_b64_tr_b16 a[74:75], v20 offset:53248
v_mfma_f32_16x16x32_bf16 v[200:203], a[80:83], a[248:251], v[200:203]
v_mfma_f32_16x16x32_bf16 v[204:207], a[80:83], a[252:255], v[204:207]
s_add_u32 m0, s41, 16384
v_mfma_f32_16x16x32_bf16 a[0:3], a[84:87], a[240:243], a[0:3]
ds_read_b64_tr_b16 a[76:77], v21 offset:49152
v_mfma_f32_16x16x32_bf16 a[4:7], a[84:87], a[244:247], a[4:7]
ds_read_b64_tr_b16 a[78:79], v21 offset:53248
v_mfma_f32_16x16x32_bf16 a[8:11], a[84:87], a[248:251], a[8:11]
s_add_u32 s44, s40, 2621440
v_mfma_f32_16x16x32_bf16 a[12:15], a[84:87], a[252:255], a[12:15]
buffer_load_dwordx4 v16, s[8:11], s44 offen offset:0 lds
s_waitcnt lgkmcnt(8)
v_mfma_f32_16x16x32_bf16 v[208:211], a[88:91], a[240:243], v[208:211]
ds_read_b64_tr_b16 a[80:81], v22 offset:49152
v_mfma_f32_16x16x32_bf16 v[212:215], a[88:91], a[244:247], v[212:215]
ds_read_b64_tr_b16 a[82:83], v22 offset:53248
v_mfma_f32_16x16x32_bf16 v[216:219], a[88:91], a[248:251], v[216:219]
buffer_load_dwordx4 v17, s[8:11], s44 offen offset:1024 lds
v_mfma_f32_16x16x32_bf16 v[220:223], a[88:91], a[252:255], v[220:223]
buffer_store_dwordx4 v[72:75], v31, s[20:23], s46 offen offset:2048 sc1
v_mfma_f32_16x16x32_bf16 a[16:19], a[92:95], a[240:243], a[16:19]
ds_read_b64_tr_b16 a[84:85], v23 offset:49152
v_mfma_f32_16x16x32_bf16 a[20:23], a[92:95], a[244:247], a[20:23]
ds_read_b64_tr_b16 a[86:87], v23 offset:53248
v_mfma_f32_16x16x32_bf16 a[24:27], a[92:95], a[248:251], a[24:27]
buffer_store_dwordx4 v[76:79], v31, s[20:23], s46 offen offset:2304 sc1
v_mfma_f32_16x16x32_bf16 a[28:31], a[92:95], a[252:255], a[28:31]
s_waitcnt lgkmcnt(8)
v_mfma_f32_16x16x32_bf16 v[160:163], a[64:67], a[160:163], v[160:163]
ds_read_b64_tr_b16 a[88:89], v24 offset:49152
v_mfma_f32_16x16x32_bf16 v[164:167], a[64:67], a[164:167], v[164:167]
ds_read_b64_tr_b16 a[90:91], v24 offset:53248
v_mfma_f32_16x16x32_bf16 v[168:171], a[64:67], a[168:171], v[168:171]
s_add_u32 s45, s42, 11264
v_mfma_f32_16x16x32_bf16 v[172:175], a[64:67], a[172:175], v[172:175]
buffer_load_dwordx4 a[240:243], v26, s[20:23], s45 offen sc1
v_mfma_f32_16x16x32_bf16 v[224:227], a[68:71], a[160:163], v[224:227]
ds_read_b64_tr_b16 a[92:93], v25 offset:49152
v_mfma_f32_16x16x32_bf16 v[228:231], a[68:71], a[164:167], v[228:231]
ds_read_b64_tr_b16 a[94:95], v25 offset:53248
v_mfma_f32_16x16x32_bf16 v[232:235], a[68:71], a[168:171], v[232:235]
buffer_load_dwordx4 a[244:247], v27, s[20:23], s45 offen sc1
v_mfma_f32_16x16x32_bf16 v[236:239], a[68:71], a[172:175], v[236:239]
s_add_u32 s45, s43, 11264
s_waitcnt lgkmcnt(8)
v_mfma_f32_16x16x32_bf16 v[176:179], a[72:75], a[160:163], v[176:179]
ds_read_b64_tr_b16 a[64:65], v18 offset:57344
v_mfma_f32_16x16x32_bf16 v[180:183], a[72:75], a[164:167], v[180:183]
ds_read_b64_tr_b16 a[66:67], v18 offset:61440
v_mfma_f32_16x16x32_bf16 v[184:187], a[72:75], a[168:171], v[184:187]
buffer_load_dwordx4 a[248:251], v26, s[20:23], s45 offen sc1
v_mfma_f32_16x16x32_bf16 v[188:191], a[72:75], a[172:175], v[188:191]
v_mfma_f32_16x16x32_bf16 v[240:243], a[76:79], a[160:163], v[240:243]
ds_read_b64_tr_b16 a[68:69], v19 offset:57344
v_mfma_f32_16x16x32_bf16 v[244:247], a[76:79], a[164:167], v[244:247]
ds_read_b64_tr_b16 a[70:71], v19 offset:61440
v_mfma_f32_16x16x32_bf16 v[248:251], a[76:79], a[168:171], v[248:251]
buffer_load_dwordx4 a[252:255], v27, s[20:23], s45 offen sc1
v_mfma_f32_16x16x32_bf16 v[252:255], a[76:79], a[172:175], v[252:255]
s_add_u32 m0, s41, 24576
s_waitcnt lgkmcnt(8)
v_mfma_f32_16x16x32_bf16 v[192:195], a[80:83], a[160:163], v[192:195]
ds_read_b64_tr_b16 a[72:73], v20 offset:57344
v_mfma_f32_16x16x32_bf16 v[196:199], a[80:83], a[164:167], v[196:199]
ds_read_b64_tr_b16 a[74:75], v20 offset:61440
v_mfma_f32_16x16x32_bf16 v[200:203], a[80:83], a[168:171], v[200:203]
s_add_u32 s44, s40, 2883584
v_mfma_f32_16x16x32_bf16 v[204:207], a[80:83], a[172:175], v[204:207]
buffer_load_dwordx4 v16, s[8:11], s44 offen offset:0 lds
v_mfma_f32_16x16x32_bf16 a[0:3], a[84:87], a[160:163], a[0:3]
ds_read_b64_tr_b16 a[76:77], v21 offset:57344
v_mfma_f32_16x16x32_bf16 a[4:7], a[84:87], a[164:167], a[4:7]
ds_read_b64_tr_b16 a[78:79], v21 offset:61440
v_mfma_f32_16x16x32_bf16 a[8:11], a[84:87], a[168:171], a[8:11]
v_mfma_f32_16x16x32_bf16 a[12:15], a[84:87], a[172:175], a[12:15]
buffer_load_dwordx4 v17, s[8:11], s44 offen offset:1024 lds
s_waitcnt lgkmcnt(8)
v_mfma_f32_16x16x32_bf16 v[208:211], a[88:91], a[160:163], v[208:211]
ds_read_b64_tr_b16 a[80:81], v22 offset:57344
v_mfma_f32_16x16x32_bf16 v[212:215], a[88:91], a[164:167], v[212:215]
ds_read_b64_tr_b16 a[82:83], v22 offset:61440
v_mfma_f32_16x16x32_bf16 v[216:219], a[88:91], a[168:171], v[216:219]
s_add_u32 s46, s92, 20480
v_mfma_f32_16x16x32_bf16 v[220:223], a[88:91], a[172:175], v[220:223]
buffer_store_dwordx4 v[80:83], v31, s[20:23], s46 offen offset:0 sc1
v_mfma_f32_16x16x32_bf16 a[16:19], a[92:95], a[160:163], a[16:19]
ds_read_b64_tr_b16 a[84:85], v23 offset:57344
v_mfma_f32_16x16x32_bf16 a[20:23], a[92:95], a[164:167], a[20:23]
ds_read_b64_tr_b16 a[86:87], v23 offset:61440
v_mfma_f32_16x16x32_bf16 a[24:27], a[92:95], a[168:171], a[24:27]
buffer_store_dwordx4 v[84:87], v31, s[20:23], s46 offen offset:256 sc1
v_mfma_f32_16x16x32_bf16 a[28:31], a[92:95], a[172:175], a[28:31]
s_waitcnt lgkmcnt(8)
v_mfma_f32_16x16x32_bf16 v[160:163], a[64:67], a[176:179], v[160:163]
ds_read_b64_tr_b16 a[88:89], v24 offset:57344
v_mfma_f32_16x16x32_bf16 v[164:167], a[64:67], a[180:183], v[164:167]
ds_read_b64_tr_b16 a[90:91], v24 offset:61440
v_mfma_f32_16x16x32_bf16 v[168:171], a[64:67], a[184:187], v[168:171]
s_add_u32 s45, s42, 12288
v_mfma_f32_16x16x32_bf16 v[172:175], a[64:67], a[188:191], v[172:175]
buffer_load_dwordx4 a[160:163], v26, s[20:23], s45 offen sc1
v_mfma_f32_16x16x32_bf16 v[224:227], a[68:71], a[176:179], v[224:227]
ds_read_b64_tr_b16 a[92:93], v25 offset:57344
v_mfma_f32_16x16x32_bf16 v[228:231], a[68:71], a[180:183], v[228:231]
ds_read_b64_tr_b16 a[94:95], v25 offset:61440
v_mfma_f32_16x16x32_bf16 v[232:235], a[68:71], a[184:187], v[232:235]
s_waitcnt vmcnt(20)
v_mfma_f32_16x16x32_bf16 v[236:239], a[68:71], a[188:191], v[236:239]
s_barrier
s_waitcnt lgkmcnt(8)
v_mfma_f32_16x16x32_bf16 v[176:179], a[72:75], a[176:179], v[176:179]
ds_read_b64_tr_b16 a[64:65], v18 offset:0
v_mfma_f32_16x16x32_bf16 v[180:183], a[72:75], a[180:183], v[180:183]
ds_read_b64_tr_b16 a[66:67], v18 offset:4096
v_mfma_f32_16x16x32_bf16 v[184:187], a[72:75], a[184:187], v[184:187]
buffer_load_dwordx4 a[164:167], v27, s[20:23], s45 offen sc1
v_mfma_f32_16x16x32_bf16 v[188:191], a[72:75], a[188:191], v[188:191]
s_add_u32 s45, s43, 12288
v_mfma_f32_16x16x32_bf16 v[240:243], a[76:79], a[176:179], v[240:243]
ds_read_b64_tr_b16 a[68:69], v19 offset:0
v_mfma_f32_16x16x32_bf16 v[244:247], a[76:79], a[180:183], v[244:247]
ds_read_b64_tr_b16 a[70:71], v19 offset:4096
v_mfma_f32_16x16x32_bf16 v[248:251], a[76:79], a[184:187], v[248:251]
v_mfma_f32_16x16x32_bf16 v[252:255], a[76:79], a[188:191], v[252:255]
buffer_load_dwordx4 a[168:171], v26, s[20:23], s45 offen sc1
s_waitcnt lgkmcnt(8)
v_mfma_f32_16x16x32_bf16 v[192:195], a[80:83], a[176:179], v[192:195]
ds_read_b64_tr_b16 a[72:73], v20 offset:0
v_mfma_f32_16x16x32_bf16 v[196:199], a[80:83], a[180:183], v[196:199]
ds_read_b64_tr_b16 a[74:75], v20 offset:4096
v_mfma_f32_16x16x32_bf16 v[200:203], a[80:83], a[184:187], v[200:203]
buffer_load_dwordx4 a[172:175], v27, s[20:23], s45 offen sc1
v_mfma_f32_16x16x32_bf16 v[204:207], a[80:83], a[188:191], v[204:207]
s_add_u32 m0, s41, 32768
v_mfma_f32_16x16x32_bf16 a[0:3], a[84:87], a[176:179], a[0:3]
ds_read_b64_tr_b16 a[76:77], v21 offset:0
v_mfma_f32_16x16x32_bf16 a[4:7], a[84:87], a[180:183], a[4:7]
ds_read_b64_tr_b16 a[78:79], v21 offset:4096
v_mfma_f32_16x16x32_bf16 a[8:11], a[84:87], a[184:187], a[8:11]
s_add_u32 s44, s40, 3145728
v_mfma_f32_16x16x32_bf16 a[12:15], a[84:87], a[188:191], a[12:15]
s_waitcnt lgkmcnt(8)
v_mfma_f32_16x16x32_bf16 v[208:211], a[88:91], a[176:179], v[208:211]
ds_read_b64_tr_b16 a[80:81], v22 offset:0
v_mfma_f32_16x16x32_bf16 v[212:215], a[88:91], a[180:183], v[212:215]
ds_read_b64_tr_b16 a[82:83], v22 offset:4096
v_mfma_f32_16x16x32_bf16 v[216:219], a[88:91], a[184:187], v[216:219]
buffer_load_dwordx4 v16, s[8:11], s44 offen offset:0 lds
v_mfma_f32_16x16x32_bf16 v[220:223], a[88:91], a[188:191], v[220:223]
buffer_load_dwordx4 v17, s[8:11], s44 offen offset:1024 lds
v_mfma_f32_16x16x32_bf16 a[16:19], a[92:95], a[176:179], a[16:19]
ds_read_b64_tr_b16 a[84:85], v23 offset:0
v_mfma_f32_16x16x32_bf16 a[20:23], a[92:95], a[180:183], a[20:23]
ds_read_b64_tr_b16 a[86:87], v23 offset:4096
v_mfma_f32_16x16x32_bf16 a[24:27], a[92:95], a[184:187], a[24:27]
buffer_store_dwordx4 v[88:91], v31, s[20:23], s46 offen offset:2048 sc1
v_mfma_f32_16x16x32_bf16 a[28:31], a[92:95], a[188:191], a[28:31]
s_waitcnt lgkmcnt(8)
v_mfma_f32_16x16x32_bf16 v[160:163], a[64:67], a[192:195], v[160:163]
ds_read_b64_tr_b16 a[88:89], v24 offset:0
v_mfma_f32_16x16x32_bf16 v[164:167], a[64:67], a[196:199], v[164:167]
ds_read_b64_tr_b16 a[90:91], v24 offset:4096
v_mfma_f32_16x16x32_bf16 v[168:171], a[64:67], a[200:203], v[168:171]
s_add_u32 s45, s42, 13312
v_mfma_f32_16x16x32_bf16 v[172:175], a[64:67], a[204:207], v[172:175]
buffer_load_dwordx4 a[176:179], v26, s[20:23], s45 offen sc1
v_mfma_f32_16x16x32_bf16 v[224:227], a[68:71], a[192:195], v[224:227]
ds_read_b64_tr_b16 a[92:93], v25 offset:0
v_mfma_f32_16x16x32_bf16 v[228:231], a[68:71], a[196:199], v[228:231]
ds_read_b64_tr_b16 a[94:95], v25 offset:4096
v_mfma_f32_16x16x32_bf16 v[232:235], a[68:71], a[200:203], v[232:235]
buffer_load_dwordx4 a[180:183], v27, s[20:23], s45 offen sc1
v_mfma_f32_16x16x32_bf16 v[236:239], a[68:71], a[204:207], v[236:239]
s_waitcnt lgkmcnt(8)
v_mfma_f32_16x16x32_bf16 v[176:179], a[72:75], a[192:195], v[176:179]
ds_read_b64_tr_b16 a[64:65], v18 offset:8192
v_mfma_f32_16x16x32_bf16 v[180:183], a[72:75], a[196:199], v[180:183]
ds_read_b64_tr_b16 a[66:67], v18 offset:12288
v_mfma_f32_16x16x32_bf16 v[184:187], a[72:75], a[200:203], v[184:187]
s_add_u32 s45, s43, 13312
v_mfma_f32_16x16x32_bf16 v[188:191], a[72:75], a[204:207], v[188:191]
buffer_load_dwordx4 a[184:187], v26, s[20:23], s45 offen sc1
v_mfma_f32_16x16x32_bf16 v[240:243], a[76:79], a[192:195], v[240:243]
ds_read_b64_tr_b16 a[68:69], v19 offset:8192
v_mfma_f32_16x16x32_bf16 v[244:247], a[76:79], a[196:199], v[244:247]
ds_read_b64_tr_b16 a[70:71], v19 offset:12288
v_mfma_f32_16x16x32_bf16 v[248:251], a[76:79], a[200:203], v[248:251]
v_mfma_f32_16x16x32_bf16 v[252:255], a[76:79], a[204:207], v[252:255]
buffer_load_dwordx4 a[188:191], v27, s[20:23], s45 offen sc1
s_waitcnt lgkmcnt(8)
v_mfma_f32_16x16x32_bf16 v[192:195], a[80:83], a[192:195], v[192:195]
ds_read_b64_tr_b16 a[72:73], v20 offset:8192
v_mfma_f32_16x16x32_bf16 v[196:199], a[80:83], a[196:199], v[196:199]
ds_read_b64_tr_b16 a[74:75], v20 offset:12288
v_mfma_f32_16x16x32_bf16 v[200:203], a[80:83], a[200:203], v[200:203]
s_add_u32 m0, s41, 40960
v_mfma_f32_16x16x32_bf16 v[204:207], a[80:83], a[204:207], v[204:207]
v_mfma_f32_16x16x32_bf16 a[0:3], a[84:87], a[192:195], a[0:3]
ds_read_b64_tr_b16 a[76:77], v21 offset:8192
v_mfma_f32_16x16x32_bf16 a[4:7], a[84:87], a[196:199], a[4:7]
ds_read_b64_tr_b16 a[78:79], v21 offset:12288
v_mfma_f32_16x16x32_bf16 a[8:11], a[84:87], a[200:203], a[8:11]
s_add_u32 s44, s40, 3407872
v_mfma_f32_16x16x32_bf16 a[12:15], a[84:87], a[204:207], a[12:15]
buffer_load_dwordx4 v16, s[8:11], s44 offen offset:0 lds
s_waitcnt lgkmcnt(8)
v_mfma_f32_16x16x32_bf16 v[208:211], a[88:91], a[192:195], v[208:211]
ds_read_b64_tr_b16 a[80:81], v22 offset:8192
v_mfma_f32_16x16x32_bf16 v[212:215], a[88:91], a[196:199], v[212:215]
ds_read_b64_tr_b16 a[82:83], v22 offset:12288
v_mfma_f32_16x16x32_bf16 v[216:219], a[88:91], a[200:203], v[216:219]
v_mfma_f32_16x16x32_bf16 v[220:223], a[88:91], a[204:207], v[220:223]
buffer_load_dwordx4 v17, s[8:11], s44 offen offset:1024 lds
v_mfma_f32_16x16x32_bf16 a[16:19], a[92:95], a[192:195], a[16:19]
ds_read_b64_tr_b16 a[84:85], v23 offset:8192
v_mfma_f32_16x16x32_bf16 a[20:23], a[92:95], a[196:199], a[20:23]
ds_read_b64_tr_b16 a[86:87], v23 offset:12288
v_mfma_f32_16x16x32_bf16 a[24:27], a[92:95], a[200:203], a[24:27]
buffer_store_dwordx4 v[92:95], v31, s[20:23], s46 offen offset:2304 sc1
v_mfma_f32_16x16x32_bf16 a[28:31], a[92:95], a[204:207], a[28:31]
s_waitcnt lgkmcnt(8)
v_mfma_f32_16x16x32_bf16 v[160:163], a[64:67], a[208:211], v[160:163]
ds_read_b64_tr_b16 a[88:89], v24 offset:8192
v_mfma_f32_16x16x32_bf16 v[164:167], a[64:67], a[212:215], v[164:167]
ds_read_b64_tr_b16 a[90:91], v24 offset:12288
v_mfma_f32_16x16x32_bf16 v[168:171], a[64:67], a[216:219], v[168:171]
s_add_u32 s45, s42, 14336
v_mfma_f32_16x16x32_bf16 v[172:175], a[64:67], a[220:223], v[172:175]
buffer_load_dwordx4 a[192:195], v26, s[20:23], s45 offen sc1
v_mfma_f32_16x16x32_bf16 v[224:227], a[68:71], a[208:211], v[224:227]
ds_read_b64_tr_b16 a[92:93], v25 offset:8192
v_mfma_f32_16x16x32_bf16 v[228:231], a[68:71], a[212:215], v[228:231]
ds_read_b64_tr_b16 a[94:95], v25 offset:12288
v_mfma_f32_16x16x32_bf16 v[232:235], a[68:71], a[216:219], v[232:235]
s_waitcnt vmcnt(17)
v_mfma_f32_16x16x32_bf16 v[236:239], a[68:71], a[220:223], v[236:239]
s_barrier
s_waitcnt lgkmcnt(8)
v_mfma_f32_16x16x32_bf16 v[176:179], a[72:75], a[208:211], v[176:179]
ds_read_b64_tr_b16 a[64:65], v18 offset:16384
v_mfma_f32_16x16x32_bf16 v[180:183], a[72:75], a[212:215], v[180:183]
ds_read_b64_tr_b16 a[66:67], v18 offset:20480
v_mfma_f32_16x16x32_bf16 v[184:187], a[72:75], a[216:219], v[184:187]
buffer_load_dwordx4 a[196:199], v27, s[20:23], s45 offen sc1
v_mfma_f32_16x16x32_bf16 v[188:191], a[72:75], a[220:223], v[188:191]
s_add_u32 s45, s43, 14336
v_mfma_f32_16x16x32_bf16 v[240:243], a[76:79], a[208:211], v[240:243]
ds_read_b64_tr_b16 a[68:69], v19 offset:16384
v_mfma_f32_16x16x32_bf16 v[244:247], a[76:79], a[212:215], v[244:247]
ds_read_b64_tr_b16 a[70:71], v19 offset:20480
v_mfma_f32_16x16x32_bf16 v[248:251], a[76:79], a[216:219], v[248:251]
buffer_load_dwordx4 a[200:203], v26, s[20:23], s45 offen sc1
v_mfma_f32_16x16x32_bf16 v[252:255], a[76:79], a[220:223], v[252:255]
buffer_load_dwordx4 a[204:207], v27, s[20:23], s45 offen sc1
s_waitcnt lgkmcnt(8)
v_mfma_f32_16x16x32_bf16 v[192:195], a[80:83], a[208:211], v[192:195]
ds_read_b64_tr_b16 a[72:73], v20 offset:16384
v_mfma_f32_16x16x32_bf16 v[196:199], a[80:83], a[212:215], v[196:199]
ds_read_b64_tr_b16 a[74:75], v20 offset:20480
v_mfma_f32_16x16x32_bf16 v[200:203], a[80:83], a[216:219], v[200:203]
v_mfma_f32_16x16x32_bf16 v[204:207], a[80:83], a[220:223], v[204:207]
s_add_u32 m0, s41, 49152
v_mfma_f32_16x16x32_bf16 a[0:3], a[84:87], a[208:211], a[0:3]
ds_read_b64_tr_b16 a[76:77], v21 offset:16384
v_mfma_f32_16x16x32_bf16 a[4:7], a[84:87], a[212:215], a[4:7]
ds_read_b64_tr_b16 a[78:79], v21 offset:20480
v_mfma_f32_16x16x32_bf16 a[8:11], a[84:87], a[216:219], a[8:11]
s_add_u32 s44, s40, 3670016
v_mfma_f32_16x16x32_bf16 a[12:15], a[84:87], a[220:223], a[12:15]
buffer_load_dwordx4 v16, s[8:11], s44 offen offset:0 lds
s_waitcnt lgkmcnt(8)
v_mfma_f32_16x16x32_bf16 v[208:211], a[88:91], a[208:211], v[208:211]
ds_read_b64_tr_b16 a[80:81], v22 offset:16384
v_mfma_f32_16x16x32_bf16 v[212:215], a[88:91], a[212:215], v[212:215]
ds_read_b64_tr_b16 a[82:83], v22 offset:20480
v_mfma_f32_16x16x32_bf16 v[216:219], a[88:91], a[216:219], v[216:219]
buffer_load_dwordx4 v17, s[8:11], s44 offen offset:1024 lds
v_mfma_f32_16x16x32_bf16 v[220:223], a[88:91], a[220:223], v[220:223]
s_add_u32 s46, s92, 32768
v_mfma_f32_16x16x32_bf16 a[16:19], a[92:95], a[208:211], a[16:19]
ds_read_b64_tr_b16 a[84:85], v23 offset:16384
v_mfma_f32_16x16x32_bf16 a[20:23], a[92:95], a[212:215], a[20:23]
ds_read_b64_tr_b16 a[86:87], v23 offset:20480
v_mfma_f32_16x16x32_bf16 a[24:27], a[92:95], a[216:219], a[24:27]
buffer_store_dwordx4 v[96:99], v31, s[20:23], s46 offen offset:0 sc1
v_mfma_f32_16x16x32_bf16 a[28:31], a[92:95], a[220:223], a[28:31]
s_waitcnt lgkmcnt(8)
v_mfma_f32_16x16x32_bf16 v[160:163], a[64:67], a[224:227], v[160:163]
ds_read_b64_tr_b16 a[88:89], v24 offset:16384
s_add_u32 s45, s42, 15360
buffer_load_dwordx4 a[208:211], v26, s[20:23], s45 offen sc1
buffer_load_dwordx4 a[212:215], v27, s[20:23], s45 offen sc1
v_mfma_f32_16x16x32_bf16 v[164:167], a[64:67], a[228:231], v[164:167]
ds_read_b64_tr_b16 a[90:91], v24 offset:20480
s_add_u32 s45, s43, 15360
buffer_load_dwordx4 a[216:219], v26, s[20:23], s45 offen sc1
v_mfma_f32_16x16x32_bf16 v[168:171], a[64:67], a[232:235], v[168:171]
buffer_load_dwordx4 a[220:223], v27, s[20:23], s45 offen sc1
s_add_u32 m0, s41, 57344
s_add_u32 s44, s40, 3932160
v_mfma_f32_16x16x32_bf16 v[172:175], a[64:67], a[236:239], v[172:175]
buffer_load_dwordx4 v16, s[8:11], s44 offen offset:0 lds
buffer_load_dwordx4 v17, s[8:11], s44 offen offset:1024 lds
v_mfma_f32_16x16x32_bf16 v[224:227], a[68:71], a[224:227], v[224:227]
ds_read_b64_tr_b16 a[92:93], v25 offset:16384
buffer_store_dwordx4 v[100:103], v31, s[20:23], s46 offen offset:256 sc1
s_lshr_b32 s3, s28, 1
s_cmp_eq_u32 s3, 0
s_cselect_b32 s16, s84, s86
s_cselect_b32 s17, s85, s87
s_mov_b32 s18, 5308416
v_mfma_f32_16x16x32_bf16 v[228:231], a[68:71], a[228:231], v[228:231]
ds_read_b64_tr_b16 a[94:95], v25 offset:20480
s_mov_b32 s19, 0x20000
s_lshr_b32 s3, s28, 1
s_mul_i32 s33, s3, 9216
v_mfma_f32_16x16x32_bf16 v[232:235], a[68:71], a[232:235], v[232:235]
s_and_b32 s4, s28, 1
s_cmp_eq_u32 s4, 0
s_cselect_b32 s48, -1, 0
s_cselect_b32 s49, 0, -1
s_and_b32 s4, s28, 1
s_mul_i32 s5, s4, 320
s_mov_b32 s6, 3641
v_add_u32 v15, s5, v0
v_mfma_f32_16x16x32_bf16 v[236:239], a[68:71], a[236:239], v[236:239]
v_mul_u32_u24 v29, s6, v15
v_lshrrev_b32 v29, 16, v29
s_waitcnt lgkmcnt(8)
v_mfma_f32_16x16x32_bf16 v[176:179], a[72:75], a[224:227], v[176:179]
ds_read_b64_tr_b16 a[64:65], v18 offset:24576
v_mul_u32_u24 v30, 18, v29
v_sub_u32 v30, v15, v30
v_mfma_f32_16x16x32_bf16 v[180:183], a[72:75], a[228:231], v[180:183]
ds_read_b64_tr_b16 a[66:67], v18 offset:28672
v_mul_u32_u24 v29, 9216, v29
v_lshl_add_u32 v1, v30, 4, v29
v_add_u32 v15, s5, v0
v_mfma_f32_16x16x32_bf16 v[184:187], a[72:75], a[232:235], v[184:187]
v_add_u32 v15, 64, v15
v_mul_u32_u24 v29, s6, v15
v_mfma_f32_16x16x32_bf16 v[188:191], a[72:75], a[236:239], v[188:191]
v_lshrrev_b32 v29, 16, v29
v_mul_u32_u24 v30, 18, v29
v_sub_u32 v30, v15, v30
v_mfma_f32_16x16x32_bf16 v[240:243], a[76:79], a[224:227], v[240:243]
ds_read_b64_tr_b16 a[68:69], v19 offset:24576
v_mul_u32_u24 v29, 9216, v29
v_lshl_add_u32 v2, v30, 4, v29
v_mfma_f32_16x16x32_bf16 v[244:247], a[76:79], a[228:231], v[244:247]
ds_read_b64_tr_b16 a[70:71], v19 offset:28672
v_subrev_u32 v2, 1024, v2
v_add_u32 v15, s5, v0
v_add_u32 v15, 128, v15
v_mfma_f32_16x16x32_bf16 v[248:251], a[76:79], a[232:235], v[248:251]
v_mul_u32_u24 v29, s6, v15
v_lshrrev_b32 v29, 16, v29
v_mfma_f32_16x16x32_bf16 v[252:255], a[76:79], a[236:239], v[252:255]
v_mul_u32_u24 v30, 18, v29
v_sub_u32 v30, v15, v30
s_waitcnt lgkmcnt(8)
v_mfma_f32_16x16x32_bf16 v[192:195], a[80:83], a[224:227], v[192:195]
ds_read_b64_tr_b16 a[72:73], v20 offset:24576
v_mul_u32_u24 v29, 9216, v29
v_lshl_add_u32 v3, v30, 4, v29
v_subrev_u32 v3, 2048, v3
v_mfma_f32_16x16x32_bf16 v[196:199], a[80:83], a[228:231], v[196:199]
ds_read_b64_tr_b16 a[74:75], v20 offset:28672
v_add_u32 v15, s5, v0
v_add_u32 v15, 192, v15
v_mfma_f32_16x16x32_bf16 v[200:203], a[80:83], a[232:235], v[200:203]
v_mul_u32_u24 v29, s6, v15
v_lshrrev_b32 v29, 16, v29
v_mul_u32_u24 v30, 18, v29
v_mfma_f32_16x16x32_bf16 v[204:207], a[80:83], a[236:239], v[204:207]
v_sub_u32 v30, v15, v30
v_mul_u32_u24 v29, 9216, v29
v_mfma_f32_16x16x32_bf16 a[0:3], a[84:87], a[224:227], a[0:3]
ds_read_b64_tr_b16 a[76:77], v21 offset:24576
v_lshl_add_u32 v4, v30, 4, v29
v_subrev_u32 v4, 3072, v4
v_add_u32 v15, 256, v0
v_mfma_f32_16x16x32_bf16 a[4:7], a[84:87], a[228:231], a[4:7]
ds_read_b64_tr_b16 a[78:79], v21 offset:28672
v_mul_u32_u24 v29, s6, v15
v_lshrrev_b32 v29, 16, v29
v_mfma_f32_16x16x32_bf16 a[8:11], a[84:87], a[232:235], a[8:11]
v_mul_u32_u24 v30, 18, v29
v_sub_u32 v30, v15, v30
v_mul_u32_u24 v29, 9216, v29
v_mfma_f32_16x16x32_bf16 a[12:15], a[84:87], a[236:239], a[12:15]
v_lshl_add_u32 v5, v30, 4, v29
s_mul_i32 s32, s29, 288
s_waitcnt lgkmcnt(8)
v_mfma_f32_16x16x32_bf16 v[208:211], a[88:91], a[224:227], v[208:211]
ds_read_b64_tr_b16 a[80:81], v22 offset:24576
s_add_u32 s35, s33, 4096
s_and_b32 s4, s28, 1
s_mul_i32 s4, s4, 5120
s_add_u32 s33, s33, s4
v_mfma_f32_16x16x32_bf16 v[212:215], a[88:91], a[228:231], v[212:215]
ds_read_b64_tr_b16 a[82:83], v22 offset:28672
v_lshrrev_b32 v15, 4, v0
v_and_b32 v29, 15, v0
v_lshrrev_b32 v30, 2, v29
v_mfma_f32_16x16x32_bf16 v[216:219], a[88:91], a[232:235], v[216:219]
v_lshl_add_u32 v30, v15, 2, v30
v_mul_u32_u24 v30, 288, v30
v_mfma_f32_16x16x32_bf16 v[220:223], a[88:91], a[236:239], v[220:223]
v_and_b32 v29, 3, v29
v_lshl_add_u32 v6, v29, 3, v30
v_add_u32 v7, 55296, v6
v_mfma_f32_16x16x32_bf16 a[16:19], a[92:95], a[224:227], a[16:19]
ds_read_b64_tr_b16 a[84:85], v23 offset:24576
v_add_u32 v8, 110592, v6
v_lshlrev_b32 v9, 4, v0
v_mfma_f32_16x16x32_bf16 a[20:23], a[92:95], a[228:231], a[20:23]
ds_read_b64_tr_b16 a[86:87], v23 offset:28672
v_add_u32 v10, 18432, v9
v_add_u32 v11, 36864, v9
v_add_u32 v12, 55296, v9
v_mfma_f32_16x16x32_bf16 a[24:27], a[92:95], a[232:235], a[24:27]
s_lshl_b32 s3, s30, 4
s_lshl_b32 s4, s28, 2
s_add_u32 s3, s3, s4
s_mul_i32 s34, s3, 18432
v_lshlrev_b32 v13, 4, v0
v_mfma_f32_16x16x32_bf16 a[28:31], a[92:95], a[236:239], a[28:31]
v_lshlrev_b32 v14, 3, v0
s_lshl_b32 s3, s30, 4
s_lshl_b32 s4, s28, 2
s_add_u32 s3, s3, s4
s_mul_i32 s3, s3, 147456
s_lshr_b32 s4, s29, 1
s_mul_i32 s4, s4, 9216
s_add_u32 s3, s3, s4
s_add_u32 s3, s3, 41943040
s_and_b32 s4, s29, 1
s_lshl_b32 s5, s4, 12
s_add_u32 s93, s3, s5
s_lshl_b32 s5, s4, 9
s_add_u32 s5, s5, 8192
s_add_u32 s94, s3, s5
s_waitcnt lgkmcnt(8)
v_mfma_f32_16x16x32_bf16 v[160:163], a[64:67], a[240:243], v[160:163]
ds_read_b64_tr_b16 a[88:89], v24 offset:24576
v_mfma_f32_16x16x32_bf16 v[164:167], a[64:67], a[244:247], v[164:167]
ds_read_b64_tr_b16 a[90:91], v24 offset:28672
v_mfma_f32_16x16x32_bf16 v[168:171], a[64:67], a[248:251], v[168:171]
s_add_u32 s45, s42, 16384
v_mfma_f32_16x16x32_bf16 v[172:175], a[64:67], a[252:255], v[172:175]
buffer_load_dwordx4 a[224:227], v26, s[20:23], s45 offen sc1
v_mfma_f32_16x16x32_bf16 v[224:227], a[68:71], a[240:243], v[224:227]
ds_read_b64_tr_b16 a[92:93], v25 offset:24576
v_mfma_f32_16x16x32_bf16 v[228:231], a[68:71], a[244:247], v[228:231]
ds_read_b64_tr_b16 a[94:95], v25 offset:28672
v_mfma_f32_16x16x32_bf16 v[232:235], a[68:71], a[248:251], v[232:235]
s_waitcnt vmcnt(16)
v_mfma_f32_16x16x32_bf16 v[236:239], a[68:71], a[252:255], v[236:239]
s_barrier
s_waitcnt lgkmcnt(8)
v_mfma_f32_16x16x32_bf16 v[176:179], a[72:75], a[240:243], v[176:179]
ds_read_b64_tr_b16 a[64:65], v18 offset:32768
v_mfma_f32_16x16x32_bf16 v[180:183], a[72:75], a[244:247], v[180:183]
ds_read_b64_tr_b16 a[66:67], v18 offset:36864
v_mfma_f32_16x16x32_bf16 v[184:187], a[72:75], a[248:251], v[184:187]
buffer_load_dwordx4 a[228:231], v27, s[20:23], s45 offen sc1
v_mfma_f32_16x16x32_bf16 v[188:191], a[72:75], a[252:255], v[188:191]
s_add_u32 s45, s43, 16384
v_mfma_f32_16x16x32_bf16 v[240:243], a[76:79], a[240:243], v[240:243]
ds_read_b64_tr_b16 a[68:69], v19 offset:32768
v_mfma_f32_16x16x32_bf16 v[244:247], a[76:79], a[244:247], v[244:247]
ds_read_b64_tr_b16 a[70:71], v19 offset:36864
v_mfma_f32_16x16x32_bf16 v[248:251], a[76:79], a[248:251], v[248:251]
v_mfma_f32_16x16x32_bf16 v[252:255], a[76:79], a[252:255], v[252:255]
buffer_load_dwordx4 a[232:235], v26, s[20:23], s45 offen sc1
s_waitcnt lgkmcnt(8)
v_mfma_f32_16x16x32_bf16 v[192:195], a[80:83], a[240:243], v[192:195]
ds_read_b64_tr_b16 a[72:73], v20 offset:32768
v_mfma_f32_16x16x32_bf16 v[196:199], a[80:83], a[244:247], v[196:199]
ds_read_b64_tr_b16 a[74:75], v20 offset:36864
v_mfma_f32_16x16x32_bf16 v[200:203], a[80:83], a[248:251], v[200:203]
buffer_load_dwordx4 a[236:239], v27, s[20:23], s45 offen sc1
v_mfma_f32_16x16x32_bf16 v[204:207], a[80:83], a[252:255], v[204:207]
s_add_u32 m0, s41, 0
v_mfma_f32_16x16x32_bf16 a[0:3], a[84:87], a[240:243], a[0:3]
ds_read_b64_tr_b16 a[76:77], v21 offset:32768
v_mfma_f32_16x16x32_bf16 a[4:7], a[84:87], a[244:247], a[4:7]
ds_read_b64_tr_b16 a[78:79], v21 offset:36864
v_mfma_f32_16x16x32_bf16 a[8:11], a[84:87], a[248:251], a[8:11]
s_add_u32 s44, s40, 4194304
v_mfma_f32_16x16x32_bf16 a[12:15], a[84:87], a[252:255], a[12:15]
s_waitcnt lgkmcnt(8)
v_mfma_f32_16x16x32_bf16 v[208:211], a[88:91], a[240:243], v[208:211]
ds_read_b64_tr_b16 a[80:81], v22 offset:32768
v_mfma_f32_16x16x32_bf16 v[212:215], a[88:91], a[244:247], v[212:215]
ds_read_b64_tr_b16 a[82:83], v22 offset:36864
v_mfma_f32_16x16x32_bf16 v[216:219], a[88:91], a[248:251], v[216:219]
buffer_load_dwordx4 v16, s[8:11], s44 offen offset:0 lds
v_mfma_f32_16x16x32_bf16 v[220:223], a[88:91], a[252:255], v[220:223]
buffer_load_dwordx4 v17, s[8:11], s44 offen offset:1024 lds
v_mfma_f32_16x16x32_bf16 a[16:19], a[92:95], a[240:243], a[16:19]
ds_read_b64_tr_b16 a[84:85], v23 offset:32768
v_mfma_f32_16x16x32_bf16 a[20:23], a[92:95], a[244:247], a[20:23]
ds_read_b64_tr_b16 a[86:87], v23 offset:36864
v_mfma_f32_16x16x32_bf16 a[24:27], a[92:95], a[248:251], a[24:27]
buffer_store_dwordx4 v[104:107], v31, s[20:23], s46 offen offset:2048 sc1
v_mfma_f32_16x16x32_bf16 a[28:31], a[92:95], a[252:255], a[28:31]
s_waitcnt lgkmcnt(8)
v_mfma_f32_16x16x32_bf16 v[160:163], a[64:67], a[160:163], v[160:163]
ds_read_b64_tr_b16 a[88:89], v24 offset:32768
v_mfma_f32_16x16x32_bf16 v[164:167], a[64:67], a[164:167], v[164:167]
ds_read_b64_tr_b16 a[90:91], v24 offset:36864
v_mfma_f32_16x16x32_bf16 v[168:171], a[64:67], a[168:171], v[168:171]
s_add_u32 s45, s42, 17408
v_mfma_f32_16x16x32_bf16 v[172:175], a[64:67], a[172:175], v[172:175]
buffer_load_dwordx4 a[240:243], v26, s[20:23], s45 offen sc1
v_mfma_f32_16x16x32_bf16 v[224:227], a[68:71], a[160:163], v[224:227]
ds_read_b64_tr_b16 a[92:93], v25 offset:32768
v_mfma_f32_16x16x32_bf16 v[228:231], a[68:71], a[164:167], v[228:231]
ds_read_b64_tr_b16 a[94:95], v25 offset:36864
v_mfma_f32_16x16x32_bf16 v[232:235], a[68:71], a[168:171], v[232:235]
buffer_load_dwordx4 a[244:247], v27, s[20:23], s45 offen sc1
v_mfma_f32_16x16x32_bf16 v[236:239], a[68:71], a[172:175], v[236:239]
s_waitcnt lgkmcnt(8)
v_mfma_f32_16x16x32_bf16 v[176:179], a[72:75], a[160:163], v[176:179]
ds_read_b64_tr_b16 a[64:65], v18 offset:40960
v_mfma_f32_16x16x32_bf16 v[180:183], a[72:75], a[164:167], v[180:183]
ds_read_b64_tr_b16 a[66:67], v18 offset:45056
v_mfma_f32_16x16x32_bf16 v[184:187], a[72:75], a[168:171], v[184:187]
s_add_u32 s45, s43, 17408
v_mfma_f32_16x16x32_bf16 v[188:191], a[72:75], a[172:175], v[188:191]
buffer_load_dwordx4 a[248:251], v26, s[20:23], s45 offen sc1
v_mfma_f32_16x16x32_bf16 v[240:243], a[76:79], a[160:163], v[240:243]
ds_read_b64_tr_b16 a[68:69], v19 offset:40960
v_mfma_f32_16x16x32_bf16 v[244:247], a[76:79], a[164:167], v[244:247]
ds_read_b64_tr_b16 a[70:71], v19 offset:45056
v_mfma_f32_16x16x32_bf16 v[248:251], a[76:79], a[168:171], v[248:251]
v_mfma_f32_16x16x32_bf16 v[252:255], a[76:79], a[172:175], v[252:255]
buffer_load_dwordx4 a[252:255], v27, s[20:23], s45 offen sc1
s_waitcnt lgkmcnt(8)
v_mfma_f32_16x16x32_bf16 v[192:195], a[80:83], a[160:163], v[192:195]
ds_read_b64_tr_b16 a[72:73], v20 offset:40960
v_mfma_f32_16x16x32_bf16 v[196:199], a[80:83], a[164:167], v[196:199]
ds_read_b64_tr_b16 a[74:75], v20 offset:45056
v_mfma_f32_16x16x32_bf16 v[200:203], a[80:83], a[168:171], v[200:203]
s_add_u32 m0, s41, 8192
v_mfma_f32_16x16x32_bf16 v[204:207], a[80:83], a[172:175], v[204:207]
v_mfma_f32_16x16x32_bf16 a[0:3], a[84:87], a[160:163], a[0:3]
ds_read_b64_tr_b16 a[76:77], v21 offset:40960
v_mfma_f32_16x16x32_bf16 a[4:7], a[84:87], a[164:167], a[4:7]
ds_read_b64_tr_b16 a[78:79], v21 offset:45056
v_mfma_f32_16x16x32_bf16 a[8:11], a[84:87], a[168:171], a[8:11]
s_add_u32 s44, s40, 4456448
v_mfma_f32_16x16x32_bf16 a[12:15], a[84:87], a[172:175], a[12:15]
buffer_load_dwordx4 v16, s[8:11], s44 offen offset:0 lds
s_waitcnt lgkmcnt(8)
v_mfma_f32_16x16x32_bf16 v[208:211], a[88:91], a[160:163], v[208:211]
ds_read_b64_tr_b16 a[80:81], v22 offset:40960
v_mfma_f32_16x16x32_bf16 v[212:215], a[88:91], a[164:167], v[212:215]
ds_read_b64_tr_b16 a[82:83], v22 offset:45056
v_mfma_f32_16x16x32_bf16 v[216:219], a[88:91], a[168:171], v[216:219]
v_mfma_f32_16x16x32_bf16 v[220:223], a[88:91], a[172:175], v[220:223]
buffer_load_dwordx4 v17, s[8:11], s44 offen offset:1024 lds
v_mfma_f32_16x16x32_bf16 a[16:19], a[92:95], a[160:163], a[16:19]
ds_read_b64_tr_b16 a[84:85], v23 offset:40960
v_mfma_f32_16x16x32_bf16 a[20:23], a[92:95], a[164:167], a[20:23]
ds_read_b64_tr_b16 a[86:87], v23 offset:45056
v_mfma_f32_16x16x32_bf16 a[24:27], a[92:95], a[168:171], a[24:27]
buffer_store_dwordx4 v[108:111], v31, s[20:23], s46 offen offset:2304 sc1
v_mfma_f32_16x16x32_bf16 a[28:31], a[92:95], a[172:175], a[28:31]
s_waitcnt lgkmcnt(8)
v_mfma_f32_16x16x32_bf16 v[160:163], a[64:67], a[176:179], v[160:163]
ds_read_b64_tr_b16 a[88:89], v24 offset:40960
v_mfma_f32_16x16x32_bf16 v[164:167], a[64:67], a[180:183], v[164:167]
ds_read_b64_tr_b16 a[90:91], v24 offset:45056
v_mfma_f32_16x16x32_bf16 v[168:171], a[64:67], a[184:187], v[168:171]
s_add_u32 s46, s92, 36864
v_mfma_f32_16x16x32_bf16 v[172:175], a[64:67], a[188:191], v[172:175]
v_mfma_f32_16x16x32_bf16 v[224:227], a[68:71], a[176:179], v[224:227]
ds_read_b64_tr_b16 a[92:93], v25 offset:40960
v_mfma_f32_16x16x32_bf16 v[228:231], a[68:71], a[180:183], v[228:231]
ds_read_b64_tr_b16 a[94:95], v25 offset:45056
v_mfma_f32_16x16x32_bf16 v[232:235], a[68:71], a[184:187], v[232:235]
s_waitcnt vmcnt(15)
v_mfma_f32_16x16x32_bf16 v[236:239], a[68:71], a[188:191], v[236:239]
s_barrier
s_waitcnt lgkmcnt(8)
v_mfma_f32_16x16x32_bf16 v[176:179], a[72:75], a[176:179], v[176:179]
ds_read_b64_tr_b16 a[64:65], v18 offset:49152
v_mfma_f32_16x16x32_bf16 v[180:183], a[72:75], a[180:183], v[180:183]
ds_read_b64_tr_b16 a[66:67], v18 offset:53248
v_mfma_f32_16x16x32_bf16 v[184:187], a[72:75], a[184:187], v[184:187]
v_mfma_f32_16x16x32_bf16 v[188:191], a[72:75], a[188:191], v[188:191]
v_mfma_f32_16x16x32_bf16 v[240:243], a[76:79], a[176:179], v[240:243]
ds_read_b64_tr_b16 a[68:69], v19 offset:49152
v_mfma_f32_16x16x32_bf16 v[244:247], a[76:79], a[180:183], v[244:247]
ds_read_b64_tr_b16 a[70:71], v19 offset:53248
v_mfma_f32_16x16x32_bf16 v[248:251], a[76:79], a[184:187], v[248:251]
v_mfma_f32_16x16x32_bf16 v[252:255], a[76:79], a[188:191], v[252:255]
s_waitcnt lgkmcnt(8)
v_mfma_f32_16x16x32_bf16 v[192:195], a[80:83], a[176:179], v[192:195]
ds_read_b64_tr_b16 a[72:73], v20 offset:49152
v_mfma_f32_16x16x32_bf16 v[196:199], a[80:83], a[180:183], v[196:199]
ds_read_b64_tr_b16 a[74:75], v20 offset:53248
v_mfma_f32_16x16x32_bf16 v[200:203], a[80:83], a[184:187], v[200:203]
v_mfma_f32_16x16x32_bf16 v[204:207], a[80:83], a[188:191], v[204:207]
buffer_store_dwordx4 v[112:115], v31, s[20:23], s46 offen offset:0 sc1
v_mfma_f32_16x16x32_bf16 a[0:3], a[84:87], a[176:179], a[0:3]
ds_read_b64_tr_b16 a[76:77], v21 offset:49152
v_mfma_f32_16x16x32_bf16 a[4:7], a[84:87], a[180:183], a[4:7]
ds_read_b64_tr_b16 a[78:79], v21 offset:53248
v_mfma_f32_16x16x32_bf16 a[8:11], a[84:87], a[184:187], a[8:11]
v_mfma_f32_16x16x32_bf16 a[12:15], a[84:87], a[188:191], a[12:15]
s_waitcnt lgkmcnt(8)
v_mfma_f32_16x16x32_bf16 v[208:211], a[88:91], a[176:179], v[208:211]
ds_read_b64_tr_b16 a[80:81], v22 offset:49152
v_mfma_f32_16x16x32_bf16 v[212:215], a[88:91], a[180:183], v[212:215]
ds_read_b64_tr_b16 a[82:83], v22 offset:53248
v_mfma_f32_16x16x32_bf16 v[216:219], a[88:91], a[184:187], v[216:219]
v_mfma_f32_16x16x32_bf16 v[220:223], a[88:91], a[188:191], v[220:223]
v_mfma_f32_16x16x32_bf16 a[16:19], a[92:95], a[176:179], a[16:19]
ds_read_b64_tr_b16 a[84:85], v23 offset:49152
v_mfma_f32_16x16x32_bf16 a[20:23], a[92:95], a[180:183], a[20:23]
ds_read_b64_tr_b16 a[86:87], v23 offset:53248
v_mfma_f32_16x16x32_bf16 a[24:27], a[92:95], a[184:187], a[24:27]
v_mfma_f32_16x16x32_bf16 a[28:31], a[92:95], a[188:191], a[28:31]
s_waitcnt lgkmcnt(8)
v_mfma_f32_16x16x32_bf16 v[160:163], a[64:67], a[192:195], v[160:163]
ds_read_b64_tr_b16 a[88:89], v24 offset:49152
buffer_store_dwordx4 v[116:119], v31, s[20:23], s46 offen offset:256 sc1
v_mfma_f32_16x16x32_bf16 v[164:167], a[64:67], a[196:199], v[164:167]
ds_read_b64_tr_b16 a[90:91], v24 offset:53248
s_add_u32 m0, s33, 0
v_mfma_f32_16x16x32_bf16 v[168:171], a[64:67], a[200:203], v[168:171]
v_mfma_f32_16x16x32_bf16 v[172:175], a[64:67], a[204:207], v[172:175]
s_add_u32 s36, s32, 0
v_mfma_f32_16x16x32_bf16 v[224:227], a[68:71], a[192:195], v[224:227]
ds_read_b64_tr_b16 a[92:93], v25 offset:49152
v_mfma_f32_16x16x32_bf16 v[228:231], a[68:71], a[196:199], v[228:231]
ds_read_b64_tr_b16 a[94:95], v25 offset:53248
buffer_load_dwordx4 v1, s[16:19], s36 offen offset:0 lds
v_mfma_f32_16x16x32_bf16 v[232:235], a[68:71], a[200:203], v[232:235]
v_mfma_f32_16x16x32_bf16 v[236:239], a[68:71], a[204:207], v[236:239]
buffer_load_dwordx4 v2, s[16:19], s36 offen offset:1024 lds
s_waitcnt lgkmcnt(8)
v_mfma_f32_16x16x32_bf16 v[176:179], a[72:75], a[192:195], v[176:179]
ds_read_b64_tr_b16 a[64:65], v18 offset:57344
v_mfma_f32_16x16x32_bf16 v[180:183], a[72:75], a[196:199], v[180:183]
ds_read_b64_tr_b16 a[66:67], v18 offset:61440
buffer_load_dwordx4 v3, s[16:19], s36 offen offset:2048 lds
v_mfma_f32_16x16x32_bf16 v[184:187], a[72:75], a[200:203], v[184:187]
v_mfma_f32_16x16x32_bf16 v[188:191], a[72:75], a[204:207], v[188:191]
buffer_load_dwordx4 v4, s[16:19], s36 offen offset:3072 lds
v_mfma_f32_16x16x32_bf16 v[240:243], a[76:79], a[192:195], v[240:243]
ds_read_b64_tr_b16 a[68:69], v19 offset:57344
v_mfma_f32_16x16x32_bf16 v[244:247], a[76:79], a[196:199], v[244:247]
ds_read_b64_tr_b16 a[70:71], v19 offset:61440
s_add_u32 m0, s35, 0
v_mfma_f32_16x16x32_bf16 v[248:251], a[76:79], a[200:203], v[248:251]
v_mfma_f32_16x16x32_bf16 v[252:255], a[76:79], a[204:207], v[252:255]
s_mov_b64 exec, s[48:49]
buffer_load_dwordx4 v5, s[16:19], s36 offen lds
s_mov_b64 exec, -1
s_waitcnt lgkmcnt(8)
v_mfma_f32_16x16x32_bf16 v[192:195], a[80:83], a[192:195], v[192:195]
ds_read_b64_tr_b16 a[72:73], v20 offset:57344
s_add_u32 m0, s33, 18432
v_mfma_f32_16x16x32_bf16 v[196:199], a[80:83], a[196:199], v[196:199]
ds_read_b64_tr_b16 a[74:75], v20 offset:61440
v_mfma_f32_16x16x32_bf16 v[200:203], a[80:83], a[200:203], v[200:203]
s_add_u32 s36, s32, 294912
v_mfma_f32_16x16x32_bf16 v[204:207], a[80:83], a[204:207], v[204:207]
v_mfma_f32_16x16x32_bf16 a[0:3], a[84:87], a[192:195], a[0:3]
ds_read_b64_tr_b16 a[76:77], v21 offset:57344
buffer_load_dwordx4 v1, s[16:19], s36 offen offset:0 lds
v_mfma_f32_16x16x32_bf16 a[4:7], a[84:87], a[196:199], a[4:7]
ds_read_b64_tr_b16 a[78:79], v21 offset:61440
v_mfma_f32_16x16x32_bf16 a[8:11], a[84:87], a[200:203], a[8:11]
buffer_load_dwordx4 v2, s[16:19], s36 offen offset:1024 lds
v_mfma_f32_16x16x32_bf16 a[12:15], a[84:87], a[204:207], a[12:15]
s_waitcnt lgkmcnt(8)
v_mfma_f32_16x16x32_bf16 v[208:211], a[88:91], a[192:195], v[208:211]
ds_read_b64_tr_b16 a[80:81], v22 offset:57344
buffer_load_dwordx4 v3, s[16:19], s36 offen offset:2048 lds
v_mfma_f32_16x16x32_bf16 v[212:215], a[88:91], a[196:199], v[212:215]
ds_read_b64_tr_b16 a[82:83], v22 offset:61440
v_mfma_f32_16x16x32_bf16 v[216:219], a[88:91], a[200:203], v[216:219]
buffer_load_dwordx4 v4, s[16:19], s36 offen offset:3072 lds
v_mfma_f32_16x16x32_bf16 v[220:223], a[88:91], a[204:207], v[220:223]
v_mfma_f32_16x16x32_bf16 a[16:19], a[92:95], a[192:195], a[16:19]
ds_read_b64_tr_b16 a[84:85], v23 offset:57344
s_add_u32 m0, s35, 18432
v_mfma_f32_16x16x32_bf16 a[20:23], a[92:95], a[196:199], a[20:23]
ds_read_b64_tr_b16 a[86:87], v23 offset:61440
v_mfma_f32_16x16x32_bf16 a[24:27], a[92:95], a[200:203], a[24:27]
s_mov_b64 exec, s[48:49]
buffer_load_dwordx4 v5, s[16:19], s36 offen lds
s_mov_b64 exec, -1
v_mfma_f32_16x16x32_bf16 a[28:31], a[92:95], a[204:207], a[28:31]
s_waitcnt lgkmcnt(8)
v_mfma_f32_16x16x32_bf16 v[160:163], a[64:67], a[208:211], v[160:163]
ds_read_b64_tr_b16 a[88:89], v24 offset:57344
v_mfma_f32_16x16x32_bf16 v[164:167], a[64:67], a[212:215], v[164:167]
ds_read_b64_tr_b16 a[90:91], v24 offset:61440
v_mfma_f32_16x16x32_bf16 v[168:171], a[64:67], a[216:219], v[168:171]
buffer_store_dwordx4 v[120:123], v31, s[20:23], s46 offen offset:2048 sc1
v_mfma_f32_16x16x32_bf16 v[172:175], a[64:67], a[220:223], v[172:175]
s_add_u32 s37, s34, 0
v_mfma_f32_16x16x32_bf16 v[224:227], a[68:71], a[208:211], v[224:227]
ds_read_b64_tr_b16 a[92:93], v25 offset:57344
v_mfma_f32_16x16x32_bf16 v[228:231], a[68:71], a[212:215], v[228:231]
ds_read_b64_tr_b16 a[94:95], v25 offset:61440
v_mfma_f32_16x16x32_bf16 v[232:235], a[68:71], a[216:219], v[232:235]
s_waitcnt vmcnt(14)
v_mfma_f32_16x16x32_bf16 v[236:239], a[68:71], a[220:223], v[236:239]
s_barrier
s_waitcnt lgkmcnt(8)
v_mfma_f32_16x16x32_bf16 v[176:179], a[72:75], a[208:211], v[176:179]
ds_read_b64_tr_b16 a[64:65], v18 offset:0
v_mfma_f32_16x16x32_bf16 v[180:183], a[72:75], a[212:215], v[180:183]
ds_read_b64_tr_b16 a[66:67], v18 offset:4096
v_mfma_f32_16x16x32_bf16 v[184:187], a[72:75], a[216:219], v[184:187]
buffer_load_dwordx4 a[96:99], v9, s[20:23], s37 offen sc1
v_mfma_f32_16x16x32_bf16 v[188:191], a[72:75], a[220:223], v[188:191]
buffer_load_dwordx4 a[100:103], v10, s[20:23], s37 offen sc1
v_mfma_f32_16x16x32_bf16 v[240:243], a[76:79], a[208:211], v[240:243]
ds_read_b64_tr_b16 a[68:69], v19 offset:0
v_mfma_f32_16x16x32_bf16 v[244:247], a[76:79], a[212:215], v[244:247]
ds_read_b64_tr_b16 a[70:71], v19 offset:4096
v_mfma_f32_16x16x32_bf16 v[248:251], a[76:79], a[216:219], v[248:251]
v_mfma_f32_16x16x32_bf16 v[252:255], a[76:79], a[220:223], v[252:255]
buffer_load_dwordx4 a[104:107], v11, s[20:23], s37 offen sc1
s_waitcnt lgkmcnt(8)
v_mfma_f32_16x16x32_bf16 v[192:195], a[80:83], a[208:211], v[192:195]
ds_read_b64_tr_b16 a[72:73], v20 offset:0
v_mfma_f32_16x16x32_bf16 v[196:199], a[80:83], a[212:215], v[196:199]
ds_read_b64_tr_b16 a[74:75], v20 offset:4096
v_mfma_f32_16x16x32_bf16 v[200:203], a[80:83], a[216:219], v[200:203]
buffer_load_dwordx4 a[108:111], v12, s[20:23], s37 offen sc1
v_mfma_f32_16x16x32_bf16 v[204:207], a[80:83], a[220:223], v[204:207]
s_add_u32 s37, s34, 1024
v_mfma_f32_16x16x32_bf16 a[0:3], a[84:87], a[208:211], a[0:3]
ds_read_b64_tr_b16 a[76:77], v21 offset:0
v_mfma_f32_16x16x32_bf16 a[4:7], a[84:87], a[212:215], a[4:7]
ds_read_b64_tr_b16 a[78:79], v21 offset:4096
v_mfma_f32_16x16x32_bf16 a[8:11], a[84:87], a[216:219], a[8:11]
buffer_load_dwordx4 a[112:115], v9, s[20:23], s37 offen sc1
v_mfma_f32_16x16x32_bf16 a[12:15], a[84:87], a[220:223], a[12:15]
s_waitcnt lgkmcnt(8)
v_mfma_f32_16x16x32_bf16 v[208:211], a[88:91], a[208:211], v[208:211]
ds_read_b64_tr_b16 a[80:81], v22 offset:0
v_mfma_f32_16x16x32_bf16 v[212:215], a[88:91], a[212:215], v[212:215]
ds_read_b64_tr_b16 a[82:83], v22 offset:4096
v_mfma_f32_16x16x32_bf16 v[216:219], a[88:91], a[216:219], v[216:219]
buffer_load_dwordx4 a[116:119], v10, s[20:23], s37 offen sc1
v_mfma_f32_16x16x32_bf16 v[220:223], a[88:91], a[220:223], v[220:223]
buffer_load_dwordx4 a[120:123], v11, s[20:23], s37 offen sc1
v_mfma_f32_16x16x32_bf16 a[16:19], a[92:95], a[208:211], a[16:19]
ds_read_b64_tr_b16 a[84:85], v23 offset:0
v_mfma_f32_16x16x32_bf16 a[20:23], a[92:95], a[212:215], a[20:23]
ds_read_b64_tr_b16 a[86:87], v23 offset:4096
v_mfma_f32_16x16x32_bf16 a[24:27], a[92:95], a[216:219], a[24:27]
buffer_load_dwordx4 a[124:127], v12, s[20:23], s37 offen sc1
v_mfma_f32_16x16x32_bf16 a[28:31], a[92:95], a[220:223], a[28:31]
s_waitcnt lgkmcnt(8)
v_mfma_f32_16x16x32_bf16 v[160:163], a[64:67], a[224:227], v[160:163]
ds_read_b64_tr_b16 a[88:89], v24 offset:0
v_mfma_f32_16x16x32_bf16 v[164:167], a[64:67], a[228:231], v[164:167]
ds_read_b64_tr_b16 a[90:91], v24 offset:4096
v_mfma_f32_16x16x32_bf16 v[168:171], a[64:67], a[232:235], v[168:171]
buffer_store_dwordx4 v[124:127], v31, s[20:23], s46 offen offset:2304 sc1
v_mfma_f32_16x16x32_bf16 v[172:175], a[64:67], a[236:239], v[172:175]
v_mfma_f32_16x16x32_bf16 v[224:227], a[68:71], a[224:227], v[224:227]
ds_read_b64_tr_b16 a[92:93], v25 offset:0
v_mfma_f32_16x16x32_bf16 v[228:231], a[68:71], a[228:231], v[228:231]
ds_read_b64_tr_b16 a[94:95], v25 offset:4096
v_mfma_f32_16x16x32_bf16 v[232:235], a[68:71], a[232:235], v[232:235]
s_add_u32 s37, s34, 2048
v_mfma_f32_16x16x32_bf16 v[236:239], a[68:71], a[236:239], v[236:239]
s_waitcnt lgkmcnt(8)
v_mfma_f32_16x16x32_bf16 v[176:179], a[72:75], a[224:227], v[176:179]
ds_read_b64_tr_b16 a[64:65], v18 offset:8192
v_mfma_f32_16x16x32_bf16 v[180:183], a[72:75], a[228:231], v[180:183]
ds_read_b64_tr_b16 a[66:67], v18 offset:12288
v_mfma_f32_16x16x32_bf16 v[184:187], a[72:75], a[232:235], v[184:187]
v_mfma_f32_16x16x32_bf16 v[188:191], a[72:75], a[236:239], v[188:191]
buffer_load_dwordx4 a[128:131], v9, s[20:23], s37 offen sc1
v_mfma_f32_16x16x32_bf16 v[240:243], a[76:79], a[224:227], v[240:243]
ds_read_b64_tr_b16 a[68:69], v19 offset:8192
v_mfma_f32_16x16x32_bf16 v[244:247], a[76:79], a[228:231], v[244:247]
ds_read_b64_tr_b16 a[70:71], v19 offset:12288
v_mfma_f32_16x16x32_bf16 v[248:251], a[76:79], a[232:235], v[248:251]
v_mfma_f32_16x16x32_bf16 v[252:255], a[76:79], a[236:239], v[252:255]
s_waitcnt lgkmcnt(8)
v_mfma_f32_16x16x32_bf16 v[192:195], a[80:83], a[224:227], v[192:195]
ds_read_b64_tr_b16 a[72:73], v20 offset:8192
v_mfma_f32_16x16x32_bf16 v[196:199], a[80:83], a[228:231], v[196:199]
ds_read_b64_tr_b16 a[74:75], v20 offset:12288
v_mfma_f32_16x16x32_bf16 v[200:203], a[80:83], a[232:235], v[200:203]
buffer_load_dwordx4 a[132:135], v10, s[20:23], s37 offen sc1
v_mfma_f32_16x16x32_bf16 v[204:207], a[80:83], a[236:239], v[204:207]
v_mfma_f32_16x16x32_bf16 a[0:3], a[84:87], a[224:227], a[0:3]
ds_read_b64_tr_b16 a[76:77], v21 offset:8192
v_mfma_f32_16x16x32_bf16 a[4:7], a[84:87], a[228:231], a[4:7]
ds_read_b64_tr_b16 a[78:79], v21 offset:12288
v_mfma_f32_16x16x32_bf16 a[8:11], a[84:87], a[232:235], a[8:11]
buffer_load_dwordx4 a[136:139], v11, s[20:23], s37 offen sc1
v_mfma_f32_16x16x32_bf16 a[12:15], a[84:87], a[236:239], a[12:15]
s_waitcnt lgkmcnt(8)
v_mfma_f32_16x16x32_bf16 v[208:211], a[88:91], a[224:227], v[208:211]
ds_read_b64_tr_b16 a[80:81], v22 offset:8192
v_mfma_f32_16x16x32_bf16 v[212:215], a[88:91], a[228:231], v[212:215]
ds_read_b64_tr_b16 a[82:83], v22 offset:12288
v_mfma_f32_16x16x32_bf16 v[216:219], a[88:91], a[232:235], v[216:219]
v_mfma_f32_16x16x32_bf16 v[220:223], a[88:91], a[236:239], v[220:223]
buffer_load_dwordx4 a[140:143], v12, s[20:23], s37 offen sc1
v_mfma_f32_16x16x32_bf16 a[16:19], a[92:95], a[224:227], a[16:19]
ds_read_b64_tr_b16 a[84:85], v23 offset:8192
v_mfma_f32_16x16x32_bf16 a[20:23], a[92:95], a[228:231], a[20:23]
ds_read_b64_tr_b16 a[86:87], v23 offset:12288
v_mfma_f32_16x16x32_bf16 a[24:27], a[92:95], a[232:235], a[24:27]
v_mfma_f32_16x16x32_bf16 a[28:31], a[92:95], a[236:239], a[28:31]
s_waitcnt lgkmcnt(8)
v_mfma_f32_16x16x32_bf16 v[160:163], a[64:67], a[240:243], v[160:163]
ds_read_b64_tr_b16 a[88:89], v24 offset:8192
v_mfma_f32_16x16x32_bf16 v[164:167], a[64:67], a[244:247], v[164:167]
ds_read_b64_tr_b16 a[90:91], v24 offset:12288
v_mfma_f32_16x16x32_bf16 v[168:171], a[64:67], a[248:251], v[168:171]
v_mfma_f32_16x16x32_bf16 v[172:175], a[64:67], a[252:255], v[172:175]
v_mfma_f32_16x16x32_bf16 v[224:227], a[68:71], a[240:243], v[224:227]
ds_read_b64_tr_b16 a[92:93], v25 offset:8192
v_mfma_f32_16x16x32_bf16 v[228:231], a[68:71], a[244:247], v[228:231]
ds_read_b64_tr_b16 a[94:95], v25 offset:12288
v_mfma_f32_16x16x32_bf16 v[232:235], a[68:71], a[248:251], v[232:235]
v_mfma_f32_16x16x32_bf16 v[236:239], a[68:71], a[252:255], v[236:239]
s_waitcnt lgkmcnt(8)
v_mfma_f32_16x16x32_bf16 v[176:179], a[72:75], a[240:243], v[176:179]
v_mfma_f32_16x16x32_bf16 v[180:183], a[72:75], a[244:247], v[180:183]
v_mfma_f32_16x16x32_bf16 v[184:187], a[72:75], a[248:251], v[184:187]
v_mfma_f32_16x16x32_bf16 v[188:191], a[72:75], a[252:255], v[188:191]
v_mfma_f32_16x16x32_bf16 v[240:243], a[76:79], a[240:243], v[240:243]
v_mfma_f32_16x16x32_bf16 v[244:247], a[76:79], a[244:247], v[244:247]
v_mfma_f32_16x16x32_bf16 v[248:251], a[76:79], a[248:251], v[248:251]
v_mfma_f32_16x16x32_bf16 v[252:255], a[76:79], a[252:255], v[252:255]
s_waitcnt lgkmcnt(4)
v_mfma_f32_16x16x32_bf16 v[192:195], a[80:83], a[240:243], v[192:195]
v_mfma_f32_16x16x32_bf16 v[196:199], a[80:83], a[244:247], v[196:199]
v_mfma_f32_16x16x32_bf16 v[200:203], a[80:83], a[248:251], v[200:203]
v_mfma_f32_16x16x32_bf16 v[204:207], a[80:83], a[252:255], v[204:207]
v_mfma_f32_16x16x32_bf16 a[0:3], a[84:87], a[240:243], a[0:3]
v_mfma_f32_16x16x32_bf16 a[4:7], a[84:87], a[244:247], a[4:7]
v_mfma_f32_16x16x32_bf16 a[8:11], a[84:87], a[248:251], a[8:11]
v_mfma_f32_16x16x32_bf16 a[12:15], a[84:87], a[252:255], a[12:15]
s_waitcnt lgkmcnt(0)
v_mfma_f32_16x16x32_bf16 v[208:211], a[88:91], a[240:243], v[208:211]
v_mfma_f32_16x16x32_bf16 v[212:215], a[88:91], a[244:247], v[212:215]
v_mfma_f32_16x16x32_bf16 v[216:219], a[88:91], a[248:251], v[216:219]
v_mfma_f32_16x16x32_bf16 v[220:223], a[88:91], a[252:255], v[220:223]
v_mfma_f32_16x16x32_bf16 a[16:19], a[92:95], a[240:243], a[16:19]
v_mfma_f32_16x16x32_bf16 a[20:23], a[92:95], a[244:247], a[20:23]
v_mfma_f32_16x16x32_bf16 a[24:27], a[92:95], a[248:251], a[24:27]
v_mfma_f32_16x16x32_bf16 a[28:31], a[92:95], a[252:255], a[28:31]
s_waitcnt lgkmcnt(0)
s_waitcnt vmcnt(14)
s_barrier
ds_read_b64_tr_b16 a[32:33], v6 offset:0
ds_read_b64_tr_b16 a[34:35], v6 offset:4608
ds_read_b64_tr_b16 a[36:37], v6 offset:32
ds_read_b64_tr_b16 a[38:39], v6 offset:4640
ds_read_b64_tr_b16 a[40:41], v6 offset:64
ds_read_b64_tr_b16 a[42:43], v6 offset:4672
ds_read_b64_tr_b16 a[44:45], v6 offset:96
ds_read_b64_tr_b16 a[46:47], v6 offset:4704
ds_read_b64_tr_b16 a[48:49], v6 offset:128
ds_read_b64_tr_b16 a[50:51], v6 offset:4736
ds_read_b64_tr_b16 a[52:53], v6 offset:160
ds_read_b64_tr_b16 a[54:55], v6 offset:4768
v_mov_b32 v15, v31
v_accvgpr_write_b32 a160, v128
v_accvgpr_write_b32 a161, v129
v_accvgpr_write_b32 a162, v130
v_accvgpr_write_b32 a163, v131
v_accvgpr_write_b32 a164, v132
v_accvgpr_write_b32 a165, v133
v_accvgpr_write_b32 a166, v134
v_accvgpr_write_b32 a167, v135
v_accvgpr_write_b32 a168, v136
v_accvgpr_write_b32 a169, v137
v_accvgpr_write_b32 a170, v138
v_accvgpr_write_b32 a171, v139
v_accvgpr_write_b32 a172, v140
v_accvgpr_write_b32 a173, v141
v_accvgpr_write_b32 a174, v142
v_accvgpr_write_b32 a175, v143
v_accvgpr_write_b32 a176, v144
v_accvgpr_write_b32 a177, v145
v_accvgpr_write_b32 a178, v146
v_accvgpr_write_b32 a179, v147
v_accvgpr_write_b32 a180, v148
v_accvgpr_write_b32 a181, v149
v_accvgpr_write_b32 a182, v150
v_accvgpr_write_b32 a183, v151
v_accvgpr_write_b32 a184, v152
v_accvgpr_write_b32 a185, v153
v_accvgpr_write_b32 a186, v154
v_accvgpr_write_b32 a187, v155
v_accvgpr_write_b32 a188, v156
v_accvgpr_write_b32 a189, v157
v_accvgpr_write_b32 a190, v158
v_accvgpr_write_b32 a191, v159
v_mov_b32 v24, 0.12751743082459868
v_mov_b32 v25, 0.12751743082459868
v_pk_mul_f32 v[160:161], v[160:161], v[24:25]
v_pk_mul_f32 v[224:225], v[224:225], v[24:25]
v_pk_mul_f32 v[162:163], v[162:163], v[24:25]
v_pk_mul_f32 v[226:227], v[226:227], v[24:25]
v_cvt_pk_bf16_f32 v160, v160, v161
v_cvt_pk_bf16_f32 v161, v162, v163
v_cvt_pk_bf16_f32 v162, v224, v225
v_cvt_pk_bf16_f32 v163, v226, v227
v_pk_mul_f32 v[164:165], v[164:165], v[24:25]
v_pk_mul_f32 v[228:229], v[228:229], v[24:25]
v_pk_mul_f32 v[166:167], v[166:167], v[24:25]
v_pk_mul_f32 v[230:231], v[230:231], v[24:25]
v_cvt_pk_bf16_f32 v164, v164, v165
v_cvt_pk_bf16_f32 v165, v166, v167
v_cvt_pk_bf16_f32 v166, v228, v229
v_cvt_pk_bf16_f32 v167, v230, v231
v_pk_mul_f32 v[168:169], v[168:169], v[24:25]
v_pk_mul_f32 v[232:233], v[232:233], v[24:25]
v_pk_mul_f32 v[170:171], v[170:171], v[24:25]
v_pk_mul_f32 v[234:235], v[234:235], v[24:25]
v_cvt_pk_bf16_f32 v168, v168, v169
v_cvt_pk_bf16_f32 v169, v170, v171
v_cvt_pk_bf16_f32 v170, v232, v233
v_cvt_pk_bf16_f32 v171, v234, v235
v_pk_mul_f32 v[172:173], v[172:173], v[24:25]
v_pk_mul_f32 v[236:237], v[236:237], v[24:25]
v_pk_mul_f32 v[174:175], v[174:175], v[24:25]
v_pk_mul_f32 v[238:239], v[238:239], v[24:25]
v_cvt_pk_bf16_f32 v172, v172, v173
v_cvt_pk_bf16_f32 v173, v174, v175
v_cvt_pk_bf16_f32 v174, v236, v237
v_cvt_pk_bf16_f32 v175, v238, v239
v_pk_mul_f32 v[176:177], v[176:177], v[24:25]
v_pk_mul_f32 v[240:241], v[240:241], v[24:25]
v_pk_mul_f32 v[178:179], v[178:179], v[24:25]
v_pk_mul_f32 v[242:243], v[242:243], v[24:25]
v_cvt_pk_bf16_f32 v176, v176, v177
v_cvt_pk_bf16_f32 v177, v178, v179
v_cvt_pk_bf16_f32 v178, v240, v241
v_cvt_pk_bf16_f32 v179, v242, v243
v_pk_mul_f32 v[180:181], v[180:181], v[24:25]
v_pk_mul_f32 v[244:245], v[244:245], v[24:25]
v_pk_mul_f32 v[182:183], v[182:183], v[24:25]
v_pk_mul_f32 v[246:247], v[246:247], v[24:25]
v_cvt_pk_bf16_f32 v180, v180, v181
v_cvt_pk_bf16_f32 v181, v182, v183
v_cvt_pk_bf16_f32 v182, v244, v245
v_cvt_pk_bf16_f32 v183, v246, v247
v_pk_mul_f32 v[184:185], v[184:185], v[24:25]
v_pk_mul_f32 v[248:249], v[248:249], v[24:25]
v_pk_mul_f32 v[186:187], v[186:187], v[24:25]
v_pk_mul_f32 v[250:251], v[250:251], v[24:25]
v_cvt_pk_bf16_f32 v184, v184, v185
v_cvt_pk_bf16_f32 v185, v186, v187
v_cvt_pk_bf16_f32 v186, v248, v249
v_cvt_pk_bf16_f32 v187, v250, v251
v_pk_mul_f32 v[188:189], v[188:189], v[24:25]
v_pk_mul_f32 v[252:253], v[252:253], v[24:25]
v_pk_mul_f32 v[190:191], v[190:191], v[24:25]
v_pk_mul_f32 v[254:255], v[254:255], v[24:25]
v_cvt_pk_bf16_f32 v188, v188, v189
v_cvt_pk_bf16_f32 v189, v190, v191
v_cvt_pk_bf16_f32 v190, v252, v253
v_cvt_pk_bf16_f32 v191, v254, v255
v_accvgpr_read_b32 v16, a0
v_accvgpr_read_b32 v17, a1
v_accvgpr_read_b32 v18, a2
v_accvgpr_read_b32 v19, a3
v_pk_mul_f32 v[192:193], v[192:193], v[24:25]
v_pk_mul_f32 v[16:17], v[16:17], v[24:25]
v_pk_mul_f32 v[194:195], v[194:195], v[24:25]
v_pk_mul_f32 v[18:19], v[18:19], v[24:25]
v_cvt_pk_bf16_f32 v192, v192, v193
v_cvt_pk_bf16_f32 v193, v194, v195
v_cvt_pk_bf16_f32 v194, v16, v17
v_cvt_pk_bf16_f32 v195, v18, v19
v_accvgpr_read_b32 v16, a4
v_accvgpr_read_b32 v17, a5
v_accvgpr_read_b32 v18, a6
v_accvgpr_read_b32 v19, a7
v_pk_mul_f32 v[196:197], v[196:197], v[24:25]
v_pk_mul_f32 v[16:17], v[16:17], v[24:25]
v_pk_mul_f32 v[198:199], v[198:199], v[24:25]
v_pk_mul_f32 v[18:19], v[18:19], v[24:25]
v_cvt_pk_bf16_f32 v196, v196, v197
v_cvt_pk_bf16_f32 v197, v198, v199
v_cvt_pk_bf16_f32 v198, v16, v17
v_cvt_pk_bf16_f32 v199, v18, v19
v_accvgpr_read_b32 v16, a8
v_accvgpr_read_b32 v17, a9
v_accvgpr_read_b32 v18, a10
v_accvgpr_read_b32 v19, a11
v_pk_mul_f32 v[200:201], v[200:201], v[24:25]
v_pk_mul_f32 v[16:17], v[16:17], v[24:25]
v_pk_mul_f32 v[202:203], v[202:203], v[24:25]
v_pk_mul_f32 v[18:19], v[18:19], v[24:25]
v_cvt_pk_bf16_f32 v200, v200, v201
v_cvt_pk_bf16_f32 v201, v202, v203
v_cvt_pk_bf16_f32 v202, v16, v17
v_cvt_pk_bf16_f32 v203, v18, v19
v_accvgpr_read_b32 v16, a12
v_accvgpr_read_b32 v17, a13
v_accvgpr_read_b32 v18, a14
v_accvgpr_read_b32 v19, a15
v_pk_mul_f32 v[204:205], v[204:205], v[24:25]
v_pk_mul_f32 v[16:17], v[16:17], v[24:25]
v_pk_mul_f32 v[206:207], v[206:207], v[24:25]
v_pk_mul_f32 v[18:19], v[18:19], v[24:25]
v_cvt_pk_bf16_f32 v204, v204, v205
v_cvt_pk_bf16_f32 v205, v206, v207
v_cvt_pk_bf16_f32 v206, v16, v17
v_cvt_pk_bf16_f32 v207, v18, v19
v_accvgpr_read_b32 v16, a16
v_accvgpr_read_b32 v17, a17
v_accvgpr_read_b32 v18, a18
v_accvgpr_read_b32 v19, a19
v_pk_mul_f32 v[208:209], v[208:209], v[24:25]
v_pk_mul_f32 v[16:17], v[16:17], v[24:25]
v_pk_mul_f32 v[210:211], v[210:211], v[24:25]
v_pk_mul_f32 v[18:19], v[18:19], v[24:25]
v_cvt_pk_bf16_f32 v208, v208, v209
v_cvt_pk_bf16_f32 v209, v210, v211
v_cvt_pk_bf16_f32 v210, v16, v17
v_cvt_pk_bf16_f32 v211, v18, v19
v_accvgpr_read_b32 v16, a20
v_accvgpr_read_b32 v17, a21
v_accvgpr_read_b32 v18, a22
v_accvgpr_read_b32 v19, a23
v_pk_mul_f32 v[212:213], v[212:213], v[24:25]
v_pk_mul_f32 v[16:17], v[16:17], v[24:25]
v_pk_mul_f32 v[214:215], v[214:215], v[24:25]
v_pk_mul_f32 v[18:19], v[18:19], v[24:25]
v_cvt_pk_bf16_f32 v212, v212, v213
v_cvt_pk_bf16_f32 v213, v214, v215
v_cvt_pk_bf16_f32 v214, v16, v17
v_cvt_pk_bf16_f32 v215, v18, v19
v_accvgpr_read_b32 v16, a24
v_accvgpr_read_b32 v17, a25
v_accvgpr_read_b32 v18, a26
v_accvgpr_read_b32 v19, a27
v_pk_mul_f32 v[216:217], v[216:217], v[24:25]
v_pk_mul_f32 v[16:17], v[16:17], v[24:25]
v_pk_mul_f32 v[218:219], v[218:219], v[24:25]
v_pk_mul_f32 v[18:19], v[18:19], v[24:25]
v_cvt_pk_bf16_f32 v216, v216, v217
v_cvt_pk_bf16_f32 v217, v218, v219
v_cvt_pk_bf16_f32 v218, v16, v17
v_cvt_pk_bf16_f32 v219, v18, v19
v_accvgpr_read_b32 v16, a28
v_accvgpr_read_b32 v17, a29
v_accvgpr_read_b32 v18, a30
v_accvgpr_read_b32 v19, a31
v_pk_mul_f32 v[220:221], v[220:221], v[24:25]
v_pk_mul_f32 v[16:17], v[16:17], v[24:25]
v_pk_mul_f32 v[222:223], v[222:223], v[24:25]
v_pk_mul_f32 v[18:19], v[18:19], v[24:25]
v_cvt_pk_bf16_f32 v220, v220, v221
v_cvt_pk_bf16_f32 v221, v222, v223
v_cvt_pk_bf16_f32 v222, v16, v17
v_cvt_pk_bf16_f32 v223, v18, v19
v_permlane16_swap_b32 v160, v164
v_permlane16_swap_b32 v161, v165
v_permlane16_swap_b32 v162, v166
v_permlane16_swap_b32 v163, v167
v_permlane32_swap_b32 v160, v164
v_permlane32_swap_b32 v161, v165
v_permlane32_swap_b32 v162, v166
v_permlane32_swap_b32 v163, v167
v_permlane16_swap_b32 v168, v172
v_permlane16_swap_b32 v169, v173
v_permlane16_swap_b32 v170, v174
v_permlane16_swap_b32 v171, v175
v_permlane32_swap_b32 v168, v172
v_permlane32_swap_b32 v169, v173
v_permlane32_swap_b32 v170, v174
v_permlane32_swap_b32 v171, v175
v_permlane16_swap_b32 v176, v180
v_permlane16_swap_b32 v177, v181
v_permlane16_swap_b32 v178, v182
v_permlane16_swap_b32 v179, v183
v_permlane32_swap_b32 v176, v180
v_permlane32_swap_b32 v177, v181
v_permlane32_swap_b32 v178, v182
v_permlane32_swap_b32 v179, v183
v_permlane16_swap_b32 v184, v188
v_permlane16_swap_b32 v185, v189
v_permlane16_swap_b32 v186, v190
v_permlane16_swap_b32 v187, v191
v_permlane32_swap_b32 v184, v188
v_permlane32_swap_b32 v185, v189
v_permlane32_swap_b32 v186, v190
v_permlane32_swap_b32 v187, v191
v_permlane16_swap_b32 v192, v196
v_permlane16_swap_b32 v193, v197
v_permlane16_swap_b32 v194, v198
v_permlane16_swap_b32 v195, v199
v_permlane32_swap_b32 v192, v196
v_permlane32_swap_b32 v193, v197
v_permlane32_swap_b32 v194, v198
v_permlane32_swap_b32 v195, v199
v_permlane16_swap_b32 v200, v204
v_permlane16_swap_b32 v201, v205
v_permlane16_swap_b32 v202, v206
v_permlane16_swap_b32 v203, v207
v_permlane32_swap_b32 v200, v204
v_permlane32_swap_b32 v201, v205
v_permlane32_swap_b32 v202, v206
v_permlane32_swap_b32 v203, v207
v_permlane16_swap_b32 v208, v212
v_permlane16_swap_b32 v209, v213
v_permlane16_swap_b32 v210, v214
v_permlane16_swap_b32 v211, v215
v_permlane32_swap_b32 v208, v212
v_permlane32_swap_b32 v209, v213
v_permlane32_swap_b32 v210, v214
v_permlane32_swap_b32 v211, v215
v_permlane16_swap_b32 v216, v220
v_permlane16_swap_b32 v217, v221
v_permlane16_swap_b32 v218, v222
v_permlane16_swap_b32 v219, v223
v_permlane32_swap_b32 v216, v220
v_permlane32_swap_b32 v217, v221
v_permlane32_swap_b32 v218, v222
v_permlane32_swap_b32 v219, v223
v_accvgpr_write_b32 a192, v160
v_accvgpr_write_b32 a193, v161
v_accvgpr_write_b32 a194, v162
v_accvgpr_write_b32 a195, v163
v_accvgpr_write_b32 a196, v164
v_accvgpr_write_b32 a197, v165
v_accvgpr_write_b32 a198, v166
v_accvgpr_write_b32 a199, v167
v_accvgpr_write_b32 a200, v168
v_accvgpr_write_b32 a201, v169
v_accvgpr_write_b32 a202, v170
v_accvgpr_write_b32 a203, v171
v_accvgpr_write_b32 a204, v172
v_accvgpr_write_b32 a205, v173
v_accvgpr_write_b32 a206, v174
v_accvgpr_write_b32 a207, v175
v_accvgpr_write_b32 a208, v176
v_accvgpr_write_b32 a209, v177
v_accvgpr_write_b32 a210, v178
v_accvgpr_write_b32 a211, v179
v_accvgpr_write_b32 a212, v180
v_accvgpr_write_b32 a213, v181
v_accvgpr_write_b32 a214, v182
v_accvgpr_write_b32 a215, v183
v_accvgpr_write_b32 a216, v184
v_accvgpr_write_b32 a217, v185
v_accvgpr_write_b32 a218, v186
v_accvgpr_write_b32 a219, v187
v_accvgpr_write_b32 a220, v188
v_accvgpr_write_b32 a221, v189
v_accvgpr_write_b32 a222, v190
v_accvgpr_write_b32 a223, v191
v_accvgpr_write_b32 a224, v192
v_accvgpr_write_b32 a225, v193
v_accvgpr_write_b32 a226, v194
v_accvgpr_write_b32 a227, v195
v_accvgpr_write_b32 a228, v196
v_accvgpr_write_b32 a229, v197
v_accvgpr_write_b32 a230, v198
v_accvgpr_write_b32 a231, v199
v_accvgpr_write_b32 a232, v200
v_accvgpr_write_b32 a233, v201
v_accvgpr_write_b32 a234, v202
v_accvgpr_write_b32 a235, v203
v_accvgpr_write_b32 a236, v204
v_accvgpr_write_b32 a237, v205
v_accvgpr_write_b32 a238, v206
v_accvgpr_write_b32 a239, v207
v_accvgpr_write_b32 a240, v208
v_accvgpr_write_b32 a241, v209
v_accvgpr_write_b32 a242, v210
v_accvgpr_write_b32 a243, v211
v_accvgpr_write_b32 a244, v212
v_accvgpr_write_b32 a245, v213
v_accvgpr_write_b32 a246, v214
v_accvgpr_write_b32 a247, v215
v_accvgpr_write_b32 a248, v216
v_accvgpr_write_b32 a249, v217
v_accvgpr_write_b32 a250, v218
v_accvgpr_write_b32 a251, v219
v_accvgpr_write_b32 a252, v220
v_accvgpr_write_b32 a253, v221
v_accvgpr_write_b32 a254, v222
v_accvgpr_write_b32 a255, v223
parallel_sum__compressed_kv_cla__geglu_ffn__prompt_kernel_L_gu:
s_waitcnt vmcnt(9) lgkmcnt(8)
v_mfma_f32_16x16x32_bf16 v[28:31], a[32:35], a[96:99], 0
ds_read_b64_tr_b16 a[56:57], v6 offset:192
v_mfma_f32_16x16x32_bf16 v[32:35], a[32:35], a[100:103], 0
ds_read_b64_tr_b16 a[58:59], v6 offset:4800
v_mfma_f32_16x16x32_bf16 v[36:39], a[32:35], a[104:107], 0
s_add_u32 s37, s34, 3072
v_mfma_f32_16x16x32_bf16 v[40:43], a[32:35], a[108:111], 0
buffer_load_dwordx4 a[144:147], v9, s[20:23], s37 offen sc1
v_mfma_f32_16x16x32_bf16 v[44:47], a[36:39], a[96:99], 0
ds_read_b64_tr_b16 a[60:61], v6 offset:224
v_mfma_f32_16x16x32_bf16 v[48:51], a[36:39], a[100:103], 0
ds_read_b64_tr_b16 a[62:63], v6 offset:4832
v_mfma_f32_16x16x32_bf16 v[52:55], a[36:39], a[104:107], 0
v_mfma_f32_16x16x32_bf16 v[56:59], a[36:39], a[108:111], 0
buffer_load_dwordx4 a[148:151], v10, s[20:23], s37 offen sc1
s_waitcnt lgkmcnt(8)
v_mfma_f32_16x16x32_bf16 v[60:63], a[40:43], a[96:99], 0
ds_read_b64_tr_b16 a[32:33], v6 offset:256
v_mfma_f32_16x16x32_bf16 v[64:67], a[40:43], a[100:103], 0
ds_read_b64_tr_b16 a[34:35], v6 offset:4864
v_mfma_f32_16x16x32_bf16 v[68:71], a[40:43], a[104:107], 0
buffer_load_dwordx4 a[152:155], v11, s[20:23], s37 offen sc1
v_mfma_f32_16x16x32_bf16 v[72:75], a[40:43], a[108:111], 0
v_mfma_f32_16x16x32_bf16 v[76:79], a[44:47], a[96:99], 0
ds_read_b64_tr_b16 a[36:37], v6 offset:9216
v_mfma_f32_16x16x32_bf16 v[80:83], a[44:47], a[100:103], 0
ds_read_b64_tr_b16 a[38:39], v6 offset:13824
v_mfma_f32_16x16x32_bf16 v[84:87], a[44:47], a[104:107], 0
buffer_load_dwordx4 a[156:159], v12, s[20:23], s37 offen sc1
v_mfma_f32_16x16x32_bf16 v[88:91], a[44:47], a[108:111], 0
s_add_u32 m0, s33, 36864
s_waitcnt lgkmcnt(8)
v_mfma_f32_16x16x32_bf16 v[92:95], a[48:51], a[96:99], 0
ds_read_b64_tr_b16 a[40:41], v6 offset:9248
v_mfma_f32_16x16x32_bf16 v[96:99], a[48:51], a[100:103], 0
ds_read_b64_tr_b16 a[42:43], v6 offset:13856
v_mfma_f32_16x16x32_bf16 v[100:103], a[48:51], a[104:107], 0
v_mfma_f32_16x16x32_bf16 v[104:107], a[48:51], a[108:111], 0
s_add_u32 s36, s32, 589824
v_mfma_f32_16x16x32_bf16 v[108:111], a[52:55], a[96:99], 0
ds_read_b64_tr_b16 a[44:45], v6 offset:9280
v_mfma_f32_16x16x32_bf16 v[112:115], a[52:55], a[100:103], 0
ds_read_b64_tr_b16 a[46:47], v6 offset:13888
v_mfma_f32_16x16x32_bf16 v[116:119], a[52:55], a[104:107], 0
buffer_load_dwordx4 v1, s[16:19], s36 offen offset:0 lds
v_mfma_f32_16x16x32_bf16 v[120:123], a[52:55], a[108:111], 0
s_waitcnt lgkmcnt(8)
v_mfma_f32_16x16x32_bf16 v[124:127], a[56:59], a[96:99], 0
ds_read_b64_tr_b16 a[48:49], v6 offset:9312
v_mfma_f32_16x16x32_bf16 v[128:131], a[56:59], a[100:103], 0
ds_read_b64_tr_b16 a[50:51], v6 offset:13920
v_mfma_f32_16x16x32_bf16 v[132:135], a[56:59], a[104:107], 0
buffer_load_dwordx4 v2, s[16:19], s36 offen offset:1024 lds
v_mfma_f32_16x16x32_bf16 v[136:139], a[56:59], a[108:111], 0
v_mfma_f32_16x16x32_bf16 v[140:143], a[60:63], a[96:99], 0
ds_read_b64_tr_b16 a[52:53], v6 offset:9344
v_mfma_f32_16x16x32_bf16 v[144:147], a[60:63], a[100:103], 0
ds_read_b64_tr_b16 a[54:55], v6 offset:13952
v_mfma_f32_16x16x32_bf16 v[148:151], a[60:63], a[104:107], 0
buffer_load_dwordx4 v3, s[16:19], s36 offen offset:2048 lds
v_mfma_f32_16x16x32_bf16 v[152:155], a[60:63], a[108:111], 0
buffer_load_dwordx4 v4, s[16:19], s36 offen offset:3072 lds
s_waitcnt lgkmcnt(8)
v_mfma_f32_16x16x32_bf16 v[156:159], a[32:35], a[96:99], 0
ds_read_b64_tr_b16 a[56:57], v6 offset:9376
v_mfma_f32_16x16x32_bf16 v[160:163], a[32:35], a[100:103], 0
ds_read_b64_tr_b16 a[58:59], v6 offset:13984
v_mfma_f32_16x16x32_bf16 v[164:167], a[32:35], a[104:107], 0
v_mfma_f32_16x16x32_bf16 v[168:171], a[32:35], a[108:111], 0
s_add_u32 m0, s35, 36864
v_mfma_f32_16x16x32_bf16 v[172:175], a[36:39], a[96:99], 0
ds_read_b64_tr_b16 a[60:61], v6 offset:9408
v_mfma_f32_16x16x32_bf16 v[176:179], a[36:39], a[100:103], 0
ds_read_b64_tr_b16 a[62:63], v6 offset:14016
v_mfma_f32_16x16x32_bf16 v[180:183], a[36:39], a[104:107], 0
s_mov_b64 exec, s[48:49]
buffer_load_dwordx4 v5, s[16:19], s36 offen lds
s_mov_b64 exec, -1
v_mfma_f32_16x16x32_bf16 v[184:187], a[36:39], a[108:111], 0
s_waitcnt lgkmcnt(8)
v_mfma_f32_16x16x32_bf16 v[188:191], a[40:43], a[96:99], 0
ds_read_b64_tr_b16 a[32:33], v6 offset:9440
v_mfma_f32_16x16x32_bf16 v[192:195], a[40:43], a[100:103], 0
ds_read_b64_tr_b16 a[34:35], v6 offset:14048
v_mfma_f32_16x16x32_bf16 v[196:199], a[40:43], a[104:107], 0
s_add_u32 m0, s33, 55296
v_mfma_f32_16x16x32_bf16 v[200:203], a[40:43], a[108:111], 0
s_add_u32 s36, s32, 884736
v_mfma_f32_16x16x32_bf16 v[204:207], a[44:47], a[96:99], 0
ds_read_b64_tr_b16 a[36:37], v6 offset:9472
v_mfma_f32_16x16x32_bf16 v[208:211], a[44:47], a[100:103], 0
ds_read_b64_tr_b16 a[38:39], v6 offset:14080
v_mfma_f32_16x16x32_bf16 v[212:215], a[44:47], a[104:107], 0
v_mfma_f32_16x16x32_bf16 v[216:219], a[44:47], a[108:111], 0
buffer_load_dwordx4 v1, s[16:19], s36 offen offset:0 lds
s_waitcnt lgkmcnt(8)
v_mfma_f32_16x16x32_bf16 v[220:223], a[48:51], a[96:99], 0
ds_read_b64_tr_b16 a[40:41], v6 offset:18432
v_mfma_f32_16x16x32_bf16 v[224:227], a[48:51], a[100:103], 0
ds_read_b64_tr_b16 a[42:43], v6 offset:23040
v_mfma_f32_16x16x32_bf16 v[228:231], a[48:51], a[104:107], 0
v_mfma_f32_16x16x32_bf16 v[232:235], a[48:51], a[108:111], 0
buffer_load_dwordx4 v2, s[16:19], s36 offen offset:1024 lds
v_mfma_f32_16x16x32_bf16 v[236:239], a[52:55], a[96:99], 0
ds_read_b64_tr_b16 a[44:45], v6 offset:18464
v_mfma_f32_16x16x32_bf16 v[240:243], a[52:55], a[100:103], 0
ds_read_b64_tr_b16 a[46:47], v6 offset:23072
v_mfma_f32_16x16x32_bf16 v[244:247], a[52:55], a[104:107], 0
buffer_load_dwordx4 v3, s[16:19], s36 offen offset:2048 lds
v_mfma_f32_16x16x32_bf16 v[248:251], a[52:55], a[108:111], 0
s_waitcnt lgkmcnt(8)
v_mfma_f32_16x16x32_bf16 v[252:255], a[56:59], a[96:99], 0
ds_read_b64_tr_b16 a[48:49], v6 offset:18496
v_mfma_f32_16x16x32_bf16 a[0:3], a[56:59], a[100:103], 0
ds_read_b64_tr_b16 a[50:51], v6 offset:23104
v_mfma_f32_16x16x32_bf16 a[4:7], a[56:59], a[104:107], 0
buffer_load_dwordx4 v4, s[16:19], s36 offen offset:3072 lds
v_mfma_f32_16x16x32_bf16 a[8:11], a[56:59], a[108:111], 0
s_add_u32 m0, s35, 55296
v_mfma_f32_16x16x32_bf16 a[12:15], a[60:63], a[96:99], 0
ds_read_b64_tr_b16 a[52:53], v6 offset:18528
v_mfma_f32_16x16x32_bf16 a[16:19], a[60:63], a[100:103], 0
ds_read_b64_tr_b16 a[54:55], v6 offset:23136
v_mfma_f32_16x16x32_bf16 a[20:23], a[60:63], a[104:107], 0
v_mfma_f32_16x16x32_bf16 a[24:27], a[60:63], a[108:111], 0
s_mov_b64 exec, s[48:49]
buffer_load_dwordx4 v5, s[16:19], s36 offen lds
s_mov_b64 exec, -1
s_waitcnt lgkmcnt(8)
v_mfma_f32_16x16x32_bf16 a[28:31], a[32:35], a[96:99], 0
ds_read_b64_tr_b16 a[56:57], v6 offset:18560
v_mfma_f32_16x16x32_bf16 a[64:67], a[32:35], a[100:103], 0
ds_read_b64_tr_b16 a[58:59], v6 offset:23168
v_mfma_f32_16x16x32_bf16 a[68:71], a[32:35], a[104:107], 0
s_add_u32 s46, s92, 49152
v_mfma_f32_16x16x32_bf16 a[72:75], a[32:35], a[108:111], 0
v_mfma_f32_16x16x32_bf16 a[76:79], a[36:39], a[96:99], 0
ds_read_b64_tr_b16 a[60:61], v6 offset:18592
v_mfma_f32_16x16x32_bf16 a[80:83], a[36:39], a[100:103], 0
ds_read_b64_tr_b16 a[62:63], v6 offset:23200
v_mfma_f32_16x16x32_bf16 a[84:87], a[36:39], a[104:107], 0
buffer_store_dwordx4 a[160:163], v15, s[20:23], s46 offen offset:0 sc1
v_mfma_f32_16x16x32_bf16 a[88:91], a[36:39], a[108:111], 0
s_waitcnt vmcnt(20) lgkmcnt(8)
v_mfma_f32_16x16x32_bf16 v[28:31], a[40:43], a[112:115], v[28:31]
ds_read_b64_tr_b16 a[32:33], v6 offset:18624
v_mfma_f32_16x16x32_bf16 v[32:35], a[40:43], a[116:119], v[32:35]
ds_read_b64_tr_b16 a[34:35], v6 offset:23232
v_mfma_f32_16x16x32_bf16 v[36:39], a[40:43], a[120:123], v[36:39]
s_add_u32 s37, s34, 4096
v_mfma_f32_16x16x32_bf16 v[40:43], a[40:43], a[124:127], v[40:43]
buffer_load_dwordx4 a[96:99], v9, s[20:23], s37 offen sc1
v_mfma_f32_16x16x32_bf16 v[44:47], a[44:47], a[112:115], v[44:47]
ds_read_b64_tr_b16 a[36:37], v6 offset:18656
v_mfma_f32_16x16x32_bf16 v[48:51], a[44:47], a[116:119], v[48:51]
ds_read_b64_tr_b16 a[38:39], v6 offset:23264
v_mfma_f32_16x16x32_bf16 v[52:55], a[44:47], a[120:123], v[52:55]
v_mfma_f32_16x16x32_bf16 v[56:59], a[44:47], a[124:127], v[56:59]
buffer_load_dwordx4 a[100:103], v10, s[20:23], s37 offen sc1
s_waitcnt lgkmcnt(8)
v_mfma_f32_16x16x32_bf16 v[60:63], a[48:51], a[112:115], v[60:63]
ds_read_b64_tr_b16 a[40:41], v6 offset:18688
v_mfma_f32_16x16x32_bf16 v[64:67], a[48:51], a[116:119], v[64:67]
ds_read_b64_tr_b16 a[42:43], v6 offset:23296
v_mfma_f32_16x16x32_bf16 v[68:71], a[48:51], a[120:123], v[68:71]
buffer_load_dwordx4 a[104:107], v11, s[20:23], s37 offen sc1
v_mfma_f32_16x16x32_bf16 v[72:75], a[48:51], a[124:127], v[72:75]
v_mfma_f32_16x16x32_bf16 v[76:79], a[52:55], a[112:115], v[76:79]
ds_read_b64_tr_b16 a[44:45], v6 offset:27648
v_mfma_f32_16x16x32_bf16 v[80:83], a[52:55], a[116:119], v[80:83]
ds_read_b64_tr_b16 a[46:47], v6 offset:32256
v_mfma_f32_16x16x32_bf16 v[84:87], a[52:55], a[120:123], v[84:87]
buffer_load_dwordx4 a[108:111], v12, s[20:23], s37 offen sc1
v_mfma_f32_16x16x32_bf16 v[88:91], a[52:55], a[124:127], v[88:91]
s_add_u32 m0, s33, 73728
s_waitcnt lgkmcnt(8)
v_mfma_f32_16x16x32_bf16 v[92:95], a[56:59], a[112:115], v[92:95]
ds_read_b64_tr_b16 a[48:49], v6 offset:27680
v_mfma_f32_16x16x32_bf16 v[96:99], a[56:59], a[116:119], v[96:99]
ds_read_b64_tr_b16 a[50:51], v6 offset:32288
v_mfma_f32_16x16x32_bf16 v[100:103], a[56:59], a[120:123], v[100:103]
v_mfma_f32_16x16x32_bf16 v[104:107], a[56:59], a[124:127], v[104:107]
s_add_u32 s36, s32, 1179648
v_mfma_f32_16x16x32_bf16 v[108:111], a[60:63], a[112:115], v[108:111]
ds_read_b64_tr_b16 a[52:53], v6 offset:27712
v_mfma_f32_16x16x32_bf16 v[112:115], a[60:63], a[116:119], v[112:115]
ds_read_b64_tr_b16 a[54:55], v6 offset:32320
v_mfma_f32_16x16x32_bf16 v[116:119], a[60:63], a[120:123], v[116:119]
buffer_load_dwordx4 v1, s[16:19], s36 offen offset:0 lds
v_mfma_f32_16x16x32_bf16 v[120:123], a[60:63], a[124:127], v[120:123]
s_waitcnt lgkmcnt(8)
v_mfma_f32_16x16x32_bf16 v[124:127], a[32:35], a[112:115], v[124:127]
ds_read_b64_tr_b16 a[56:57], v6 offset:27744
v_mfma_f32_16x16x32_bf16 v[128:131], a[32:35], a[116:119], v[128:131]
ds_read_b64_tr_b16 a[58:59], v6 offset:32352
v_mfma_f32_16x16x32_bf16 v[132:135], a[32:35], a[120:123], v[132:135]
buffer_load_dwordx4 v2, s[16:19], s36 offen offset:1024 lds
v_mfma_f32_16x16x32_bf16 v[136:139], a[32:35], a[124:127], v[136:139]
buffer_load_dwordx4 v3, s[16:19], s36 offen offset:2048 lds
v_mfma_f32_16x16x32_bf16 v[140:143], a[36:39], a[112:115], v[140:143]
ds_read_b64_tr_b16 a[60:61], v6 offset:27776
v_mfma_f32_16x16x32_bf16 v[144:147], a[36:39], a[116:119], v[144:147]
ds_read_b64_tr_b16 a[62:63], v6 offset:32384
v_mfma_f32_16x16x32_bf16 v[148:151], a[36:39], a[120:123], v[148:151]
v_mfma_f32_16x16x32_bf16 v[152:155], a[36:39], a[124:127], v[152:155]
buffer_load_dwordx4 v4, s[16:19], s36 offen offset:3072 lds
s_waitcnt lgkmcnt(8)
v_mfma_f32_16x16x32_bf16 v[156:159], a[40:43], a[112:115], v[156:159]
ds_read_b64_tr_b16 a[32:33], v6 offset:27808
v_mfma_f32_16x16x32_bf16 v[160:163], a[40:43], a[116:119], v[160:163]
ds_read_b64_tr_b16 a[34:35], v6 offset:32416
v_mfma_f32_16x16x32_bf16 v[164:167], a[40:43], a[120:123], v[164:167]
v_mfma_f32_16x16x32_bf16 v[168:171], a[40:43], a[124:127], v[168:171]
s_add_u32 m0, s35, 73728
v_mfma_f32_16x16x32_bf16 v[172:175], a[44:47], a[112:115], v[172:175]
ds_read_b64_tr_b16 a[36:37], v6 offset:27840
v_mfma_f32_16x16x32_bf16 v[176:179], a[44:47], a[116:119], v[176:179]
ds_read_b64_tr_b16 a[38:39], v6 offset:32448
v_mfma_f32_16x16x32_bf16 v[180:183], a[44:47], a[120:123], v[180:183]
s_mov_b64 exec, s[48:49]
buffer_load_dwordx4 v5, s[16:19], s36 offen lds
s_mov_b64 exec, -1
v_mfma_f32_16x16x32_bf16 v[184:187], a[44:47], a[124:127], v[184:187]
s_waitcnt lgkmcnt(8)
v_mfma_f32_16x16x32_bf16 v[188:191], a[48:51], a[112:115], v[188:191]
ds_read_b64_tr_b16 a[40:41], v6 offset:27872
v_mfma_f32_16x16x32_bf16 v[192:195], a[48:51], a[116:119], v[192:195]
ds_read_b64_tr_b16 a[42:43], v6 offset:32480
v_mfma_f32_16x16x32_bf16 v[196:199], a[48:51], a[120:123], v[196:199]
s_add_u32 m0, s33, 92160
v_mfma_f32_16x16x32_bf16 v[200:203], a[48:51], a[124:127], v[200:203]
s_add_u32 s36, s32, 1474560
v_mfma_f32_16x16x32_bf16 v[204:207], a[52:55], a[112:115], v[204:207]
ds_read_b64_tr_b16 a[44:45], v6 offset:27904
v_mfma_f32_16x16x32_bf16 v[208:211], a[52:55], a[116:119], v[208:211]
ds_read_b64_tr_b16 a[46:47], v6 offset:32512
v_mfma_f32_16x16x32_bf16 v[212:215], a[52:55], a[120:123], v[212:215]
s_waitcnt vmcnt(10)
v_mfma_f32_16x16x32_bf16 v[216:219], a[52:55], a[124:127], v[216:219]
s_barrier
s_waitcnt lgkmcnt(8)
v_mfma_f32_16x16x32_bf16 v[220:223], a[56:59], a[112:115], v[220:223]
ds_read_b64_tr_b16 a[48:49], v6 offset:36864
v_mfma_f32_16x16x32_bf16 v[224:227], a[56:59], a[116:119], v[224:227]
ds_read_b64_tr_b16 a[50:51], v6 offset:41472
v_mfma_f32_16x16x32_bf16 v[228:231], a[56:59], a[120:123], v[228:231]
v_mfma_f32_16x16x32_bf16 v[232:235], a[56:59], a[124:127], v[232:235]
buffer_load_dwordx4 v1, s[16:19], s36 offen offset:0 lds
v_mfma_f32_16x16x32_bf16 v[236:239], a[60:63], a[112:115], v[236:239]
ds_read_b64_tr_b16 a[52:53], v6 offset:36896
v_mfma_f32_16x16x32_bf16 v[240:243], a[60:63], a[116:119], v[240:243]
ds_read_b64_tr_b16 a[54:55], v6 offset:41504
v_mfma_f32_16x16x32_bf16 v[244:247], a[60:63], a[120:123], v[244:247]
buffer_load_dwordx4 v2, s[16:19], s36 offen offset:1024 lds
v_mfma_f32_16x16x32_bf16 v[248:251], a[60:63], a[124:127], v[248:251]
s_waitcnt lgkmcnt(8)
v_mfma_f32_16x16x32_bf16 v[252:255], a[32:35], a[112:115], v[252:255]
ds_read_b64_tr_b16 a[56:57], v6 offset:36928
v_mfma_f32_16x16x32_bf16 a[0:3], a[32:35], a[116:119], a[0:3]
ds_read_b64_tr_b16 a[58:59], v6 offset:41536
v_mfma_f32_16x16x32_bf16 a[4:7], a[32:35], a[120:123], a[4:7]
buffer_load_dwordx4 v3, s[16:19], s36 offen offset:2048 lds
v_mfma_f32_16x16x32_bf16 a[8:11], a[32:35], a[124:127], a[8:11]
buffer_load_dwordx4 v4, s[16:19], s36 offen offset:3072 lds
v_mfma_f32_16x16x32_bf16 a[12:15], a[36:39], a[112:115], a[12:15]
ds_read_b64_tr_b16 a[60:61], v6 offset:36960
v_mfma_f32_16x16x32_bf16 a[16:19], a[36:39], a[116:119], a[16:19]
ds_read_b64_tr_b16 a[62:63], v6 offset:41568
v_mfma_f32_16x16x32_bf16 a[20:23], a[36:39], a[120:123], a[20:23]
v_mfma_f32_16x16x32_bf16 a[24:27], a[36:39], a[124:127], a[24:27]
s_add_u32 m0, s35, 92160
s_waitcnt lgkmcnt(8)
v_mfma_f32_16x16x32_bf16 a[28:31], a[40:43], a[112:115], a[28:31]
ds_read_b64_tr_b16 a[32:33], v6 offset:36992
v_mfma_f32_16x16x32_bf16 a[64:67], a[40:43], a[116:119], a[64:67]
ds_read_b64_tr_b16 a[34:35], v6 offset:41600
v_mfma_f32_16x16x32_bf16 a[68:71], a[40:43], a[120:123], a[68:71]
s_mov_b64 exec, s[48:49]
buffer_load_dwordx4 v5, s[16:19], s36 offen lds
s_mov_b64 exec, -1
v_mfma_f32_16x16x32_bf16 a[72:75], a[40:43], a[124:127], a[72:75]
v_mfma_f32_16x16x32_bf16 a[76:79], a[44:47], a[112:115], a[76:79]
ds_read_b64_tr_b16 a[36:37], v6 offset:37024
v_mfma_f32_16x16x32_bf16 a[80:83], a[44:47], a[116:119], a[80:83]
ds_read_b64_tr_b16 a[38:39], v6 offset:41632
v_mfma_f32_16x16x32_bf16 a[84:87], a[44:47], a[120:123], a[84:87]
buffer_store_dwordx4 a[164:167], v15, s[20:23], s46 offen offset:256 sc1
v_mfma_f32_16x16x32_bf16 a[88:91], a[44:47], a[124:127], a[88:91]
s_waitcnt lgkmcnt(8)
v_mfma_f32_16x16x32_bf16 v[28:31], a[48:51], a[128:131], v[28:31]
ds_read_b64_tr_b16 a[40:41], v6 offset:37056
v_mfma_f32_16x16x32_bf16 v[32:35], a[48:51], a[132:135], v[32:35]
ds_read_b64_tr_b16 a[42:43], v6 offset:41664
v_mfma_f32_16x16x32_bf16 v[36:39], a[48:51], a[136:139], v[36:39]
s_add_u32 s37, s34, 5120
v_mfma_f32_16x16x32_bf16 v[40:43], a[48:51], a[140:143], v[40:43]
buffer_load_dwordx4 a[112:115], v9, s[20:23], s37 offen sc1
v_mfma_f32_16x16x32_bf16 v[44:47], a[52:55], a[128:131], v[44:47]
ds_read_b64_tr_b16 a[44:45], v6 offset:37088
v_mfma_f32_16x16x32_bf16 v[48:51], a[52:55], a[132:135], v[48:51]
ds_read_b64_tr_b16 a[46:47], v6 offset:41696
v_mfma_f32_16x16x32_bf16 v[52:55], a[52:55], a[136:139], v[52:55]
v_mfma_f32_16x16x32_bf16 v[56:59], a[52:55], a[140:143], v[56:59]
buffer_load_dwordx4 a[116:119], v10, s[20:23], s37 offen sc1
s_waitcnt lgkmcnt(8)
v_mfma_f32_16x16x32_bf16 v[60:63], a[56:59], a[128:131], v[60:63]
ds_read_b64_tr_b16 a[48:49], v6 offset:37120
v_mfma_f32_16x16x32_bf16 v[64:67], a[56:59], a[132:135], v[64:67]
ds_read_b64_tr_b16 a[50:51], v6 offset:41728
v_mfma_f32_16x16x32_bf16 v[68:71], a[56:59], a[136:139], v[68:71]
buffer_load_dwordx4 a[120:123], v11, s[20:23], s37 offen sc1
v_mfma_f32_16x16x32_bf16 v[72:75], a[56:59], a[140:143], v[72:75]
v_mfma_f32_16x16x32_bf16 v[76:79], a[60:63], a[128:131], v[76:79]
ds_read_b64_tr_b16 a[52:53], v6 offset:46080
v_mfma_f32_16x16x32_bf16 v[80:83], a[60:63], a[132:135], v[80:83]
ds_read_b64_tr_b16 a[54:55], v6 offset:50688
v_mfma_f32_16x16x32_bf16 v[84:87], a[60:63], a[136:139], v[84:87]
buffer_load_dwordx4 a[124:127], v12, s[20:23], s37 offen sc1
v_mfma_f32_16x16x32_bf16 v[88:91], a[60:63], a[140:143], v[88:91]
s_waitcnt lgkmcnt(8)
v_mfma_f32_16x16x32_bf16 v[92:95], a[32:35], a[128:131], v[92:95]
ds_read_b64_tr_b16 a[56:57], v6 offset:46112
v_mfma_f32_16x16x32_bf16 v[96:99], a[32:35], a[132:135], v[96:99]
ds_read_b64_tr_b16 a[58:59], v6 offset:50720
v_mfma_f32_16x16x32_bf16 v[100:103], a[32:35], a[136:139], v[100:103]
s_add_u32 m0, s33, 110592
v_mfma_f32_16x16x32_bf16 v[104:107], a[32:35], a[140:143], v[104:107]
s_add_u32 s36, s32, 1769472
v_mfma_f32_16x16x32_bf16 v[108:111], a[36:39], a[128:131], v[108:111]
ds_read_b64_tr_b16 a[60:61], v6 offset:46144
v_mfma_f32_16x16x32_bf16 v[112:115], a[36:39], a[132:135], v[112:115]
ds_read_b64_tr_b16 a[62:63], v6 offset:50752
v_mfma_f32_16x16x32_bf16 v[116:119], a[36:39], a[136:139], v[116:119]
v_mfma_f32_16x16x32_bf16 v[120:123], a[36:39], a[140:143], v[120:123]
buffer_load_dwordx4 v1, s[16:19], s36 offen offset:0 lds
s_waitcnt lgkmcnt(8)
v_mfma_f32_16x16x32_bf16 v[124:127], a[40:43], a[128:131], v[124:127]
ds_read_b64_tr_b16 a[32:33], v6 offset:46176
v_mfma_f32_16x16x32_bf16 v[128:131], a[40:43], a[132:135], v[128:131]
ds_read_b64_tr_b16 a[34:35], v6 offset:50784
v_mfma_f32_16x16x32_bf16 v[132:135], a[40:43], a[136:139], v[132:135]
v_mfma_f32_16x16x32_bf16 v[136:139], a[40:43], a[140:143], v[136:139]
buffer_load_dwordx4 v2, s[16:19], s36 offen offset:1024 lds
v_mfma_f32_16x16x32_bf16 v[140:143], a[44:47], a[128:131], v[140:143]
ds_read_b64_tr_b16 a[36:37], v6 offset:46208
v_mfma_f32_16x16x32_bf16 v[144:147], a[44:47], a[132:135], v[144:147]
ds_read_b64_tr_b16 a[38:39], v6 offset:50816
v_mfma_f32_16x16x32_bf16 v[148:151], a[44:47], a[136:139], v[148:151]
buffer_load_dwordx4 v3, s[16:19], s36 offen offset:2048 lds
v_mfma_f32_16x16x32_bf16 v[152:155], a[44:47], a[140:143], v[152:155]
s_waitcnt lgkmcnt(8)
v_mfma_f32_16x16x32_bf16 v[156:159], a[48:51], a[128:131], v[156:159]
ds_read_b64_tr_b16 a[40:41], v6 offset:46240
v_mfma_f32_16x16x32_bf16 v[160:163], a[48:51], a[132:135], v[160:163]
ds_read_b64_tr_b16 a[42:43], v6 offset:50848
v_mfma_f32_16x16x32_bf16 v[164:167], a[48:51], a[136:139], v[164:167]
buffer_load_dwordx4 v4, s[16:19], s36 offen offset:3072 lds
v_mfma_f32_16x16x32_bf16 v[168:171], a[48:51], a[140:143], v[168:171]
v_mfma_f32_16x16x32_bf16 v[172:175], a[52:55], a[128:131], v[172:175]
ds_read_b64_tr_b16 a[44:45], v6 offset:46272
v_mfma_f32_16x16x32_bf16 v[176:179], a[52:55], a[132:135], v[176:179]
ds_read_b64_tr_b16 a[46:47], v6 offset:50880
v_mfma_f32_16x16x32_bf16 v[180:183], a[52:55], a[136:139], v[180:183]
s_add_u32 m0, s35, 110592
v_mfma_f32_16x16x32_bf16 v[184:187], a[52:55], a[140:143], v[184:187]
s_mov_b64 exec, s[48:49]
buffer_load_dwordx4 v5, s[16:19], s36 offen lds
s_mov_b64 exec, -1
s_waitcnt lgkmcnt(8)
v_mfma_f32_16x16x32_bf16 v[188:191], a[56:59], a[128:131], v[188:191]
ds_read_b64_tr_b16 a[48:49], v6 offset:46304
v_mfma_f32_16x16x32_bf16 v[192:195], a[56:59], a[132:135], v[192:195]
ds_read_b64_tr_b16 a[50:51], v6 offset:50912
v_mfma_f32_16x16x32_bf16 v[196:199], a[56:59], a[136:139], v[196:199]
v_mfma_f32_16x16x32_bf16 v[200:203], a[56:59], a[140:143], v[200:203]
s_add_u32 m0, s33, 129024
v_mfma_f32_16x16x32_bf16 v[204:207], a[60:63], a[128:131], v[204:207]
ds_read_b64_tr_b16 a[52:53], v6 offset:46336
v_mfma_f32_16x16x32_bf16 v[208:211], a[60:63], a[132:135], v[208:211]
ds_read_b64_tr_b16 a[54:55], v6 offset:50944
v_mfma_f32_16x16x32_bf16 v[212:215], a[60:63], a[136:139], v[212:215]
s_add_u32 s36, s32, 2064384
v_mfma_f32_16x16x32_bf16 v[216:219], a[60:63], a[140:143], v[216:219]
s_waitcnt lgkmcnt(8)
v_mfma_f32_16x16x32_bf16 v[220:223], a[32:35], a[128:131], v[220:223]
ds_read_b64_tr_b16 a[56:57], v7 offset:0
v_mfma_f32_16x16x32_bf16 v[224:227], a[32:35], a[132:135], v[224:227]
ds_read_b64_tr_b16 a[58:59], v7 offset:4608
v_mfma_f32_16x16x32_bf16 v[228:231], a[32:35], a[136:139], v[228:231]
buffer_load_dwordx4 v1, s[16:19], s36 offen offset:0 lds
v_mfma_f32_16x16x32_bf16 v[232:235], a[32:35], a[140:143], v[232:235]
v_mfma_f32_16x16x32_bf16 v[236:239], a[36:39], a[128:131], v[236:239]
ds_read_b64_tr_b16 a[60:61], v7 offset:32
v_mfma_f32_16x16x32_bf16 v[240:243], a[36:39], a[132:135], v[240:243]
ds_read_b64_tr_b16 a[62:63], v7 offset:4640
v_mfma_f32_16x16x32_bf16 v[244:247], a[36:39], a[136:139], v[244:247]
buffer_load_dwordx4 v2, s[16:19], s36 offen offset:1024 lds
v_mfma_f32_16x16x32_bf16 v[248:251], a[36:39], a[140:143], v[248:251]
buffer_load_dwordx4 v3, s[16:19], s36 offen offset:2048 lds
s_waitcnt lgkmcnt(8)
v_mfma_f32_16x16x32_bf16 v[252:255], a[40:43], a[128:131], v[252:255]
ds_read_b64_tr_b16 a[32:33], v7 offset:64
v_mfma_f32_16x16x32_bf16 a[0:3], a[40:43], a[132:135], a[0:3]
ds_read_b64_tr_b16 a[34:35], v7 offset:4672
v_mfma_f32_16x16x32_bf16 a[4:7], a[40:43], a[136:139], a[4:7]
v_mfma_f32_16x16x32_bf16 a[8:11], a[40:43], a[140:143], a[8:11]
buffer_load_dwordx4 v4, s[16:19], s36 offen offset:3072 lds
v_mfma_f32_16x16x32_bf16 a[12:15], a[44:47], a[128:131], a[12:15]
ds_read_b64_tr_b16 a[36:37], v7 offset:96
v_mfma_f32_16x16x32_bf16 a[16:19], a[44:47], a[132:135], a[16:19]
ds_read_b64_tr_b16 a[38:39], v7 offset:4704
v_mfma_f32_16x16x32_bf16 a[20:23], a[44:47], a[136:139], a[20:23]
v_mfma_f32_16x16x32_bf16 a[24:27], a[44:47], a[140:143], a[24:27]
s_add_u32 m0, s35, 129024
s_waitcnt lgkmcnt(8)
v_mfma_f32_16x16x32_bf16 a[28:31], a[48:51], a[128:131], a[28:31]
ds_read_b64_tr_b16 a[40:41], v7 offset:128
v_mfma_f32_16x16x32_bf16 a[64:67], a[48:51], a[132:135], a[64:67]
ds_read_b64_tr_b16 a[42:43], v7 offset:4736
v_mfma_f32_16x16x32_bf16 a[68:71], a[48:51], a[136:139], a[68:71]
s_mov_b64 exec, s[48:49]
buffer_load_dwordx4 v5, s[16:19], s36 offen lds
s_mov_b64 exec, -1
v_mfma_f32_16x16x32_bf16 a[72:75], a[48:51], a[140:143], a[72:75]
v_mfma_f32_16x16x32_bf16 a[76:79], a[52:55], a[128:131], a[76:79]
ds_read_b64_tr_b16 a[44:45], v7 offset:160
v_mfma_f32_16x16x32_bf16 a[80:83], a[52:55], a[132:135], a[80:83]
ds_read_b64_tr_b16 a[46:47], v7 offset:4768
v_mfma_f32_16x16x32_bf16 a[84:87], a[52:55], a[136:139], a[84:87]
buffer_store_dwordx4 a[168:171], v15, s[20:23], s46 offen offset:2048 sc1
v_mfma_f32_16x16x32_bf16 a[88:91], a[52:55], a[140:143], a[88:91]
s_waitcnt lgkmcnt(8)
v_mfma_f32_16x16x32_bf16 v[28:31], a[56:59], a[144:147], v[28:31]
ds_read_b64_tr_b16 a[48:49], v7 offset:192
v_mfma_f32_16x16x32_bf16 v[32:35], a[56:59], a[148:151], v[32:35]
ds_read_b64_tr_b16 a[50:51], v7 offset:4800
v_mfma_f32_16x16x32_bf16 v[36:39], a[56:59], a[152:155], v[36:39]
s_add_u32 s37, s34, 6144
v_mfma_f32_16x16x32_bf16 v[40:43], a[56:59], a[156:159], v[40:43]
v_mfma_f32_16x16x32_bf16 v[44:47], a[60:63], a[144:147], v[44:47]
ds_read_b64_tr_b16 a[52:53], v7 offset:224
v_mfma_f32_16x16x32_bf16 v[48:51], a[60:63], a[148:151], v[48:51]
ds_read_b64_tr_b16 a[54:55], v7 offset:4832
v_mfma_f32_16x16x32_bf16 v[52:55], a[60:63], a[152:155], v[52:55]
buffer_load_dwordx4 a[128:131], v9, s[20:23], s37 offen sc1
v_mfma_f32_16x16x32_bf16 v[56:59], a[60:63], a[156:159], v[56:59]
s_waitcnt lgkmcnt(8)
v_mfma_f32_16x16x32_bf16 v[60:63], a[32:35], a[144:147], v[60:63]
ds_read_b64_tr_b16 a[56:57], v7 offset:256
v_mfma_f32_16x16x32_bf16 v[64:67], a[32:35], a[148:151], v[64:67]
ds_read_b64_tr_b16 a[58:59], v7 offset:4864
v_mfma_f32_16x16x32_bf16 v[68:71], a[32:35], a[152:155], v[68:71]
buffer_load_dwordx4 a[132:135], v10, s[20:23], s37 offen sc1
v_mfma_f32_16x16x32_bf16 v[72:75], a[32:35], a[156:159], v[72:75]
v_mfma_f32_16x16x32_bf16 v[76:79], a[36:39], a[144:147], v[76:79]
ds_read_b64_tr_b16 a[60:61], v7 offset:9216
v_mfma_f32_16x16x32_bf16 v[80:83], a[36:39], a[148:151], v[80:83]
ds_read_b64_tr_b16 a[62:63], v7 offset:13824
v_mfma_f32_16x16x32_bf16 v[84:87], a[36:39], a[152:155], v[84:87]
v_mfma_f32_16x16x32_bf16 v[88:91], a[36:39], a[156:159], v[88:91]
buffer_load_dwordx4 a[136:139], v11, s[20:23], s37 offen sc1
s_waitcnt lgkmcnt(8)
v_mfma_f32_16x16x32_bf16 v[92:95], a[40:43], a[144:147], v[92:95]
ds_read_b64_tr_b16 a[32:33], v7 offset:9248
v_mfma_f32_16x16x32_bf16 v[96:99], a[40:43], a[148:151], v[96:99]
ds_read_b64_tr_b16 a[34:35], v7 offset:13856
v_mfma_f32_16x16x32_bf16 v[100:103], a[40:43], a[152:155], v[100:103]
v_mfma_f32_16x16x32_bf16 v[104:107], a[40:43], a[156:159], v[104:107]
buffer_load_dwordx4 a[140:143], v12, s[20:23], s37 offen sc1
v_mfma_f32_16x16x32_bf16 v[108:111], a[44:47], a[144:147], v[108:111]
ds_read_b64_tr_b16 a[36:37], v7 offset:9280
v_mfma_f32_16x16x32_bf16 v[112:115], a[44:47], a[148:151], v[112:115]
ds_read_b64_tr_b16 a[38:39], v7 offset:13888
v_mfma_f32_16x16x32_bf16 v[116:119], a[44:47], a[152:155], v[116:119]
v_mfma_f32_16x16x32_bf16 v[120:123], a[44:47], a[156:159], v[120:123]
s_waitcnt lgkmcnt(8)
v_mfma_f32_16x16x32_bf16 v[124:127], a[48:51], a[144:147], v[124:127]
ds_read_b64_tr_b16 a[40:41], v7 offset:9312
v_mfma_f32_16x16x32_bf16 v[128:131], a[48:51], a[148:151], v[128:131]
ds_read_b64_tr_b16 a[42:43], v7 offset:13920
v_mfma_f32_16x16x32_bf16 v[132:135], a[48:51], a[152:155], v[132:135]
s_add_u32 m0, s33, 0
v_mfma_f32_16x16x32_bf16 v[136:139], a[48:51], a[156:159], v[136:139]
v_mfma_f32_16x16x32_bf16 v[140:143], a[52:55], a[144:147], v[140:143]
ds_read_b64_tr_b16 a[44:45], v7 offset:9344
v_mfma_f32_16x16x32_bf16 v[144:147], a[52:55], a[148:151], v[144:147]
ds_read_b64_tr_b16 a[46:47], v7 offset:13952
v_mfma_f32_16x16x32_bf16 v[148:151], a[52:55], a[152:155], v[148:151]
s_add_u32 s36, s32, 2359296
v_mfma_f32_16x16x32_bf16 v[152:155], a[52:55], a[156:159], v[152:155]
s_waitcnt lgkmcnt(8)
v_mfma_f32_16x16x32_bf16 v[156:159], a[56:59], a[144:147], v[156:159]
ds_read_b64_tr_b16 a[48:49], v7 offset:9376
v_mfma_f32_16x16x32_bf16 v[160:163], a[56:59], a[148:151], v[160:163]
ds_read_b64_tr_b16 a[50:51], v7 offset:13984
v_mfma_f32_16x16x32_bf16 v[164:167], a[56:59], a[152:155], v[164:167]
v_mfma_f32_16x16x32_bf16 v[168:171], a[56:59], a[156:159], v[168:171]
buffer_load_dwordx4 v1, s[16:19], s36 offen offset:0 lds
v_mfma_f32_16x16x32_bf16 v[172:175], a[60:63], a[144:147], v[172:175]
ds_read_b64_tr_b16 a[52:53], v7 offset:9408
v_mfma_f32_16x16x32_bf16 v[176:179], a[60:63], a[148:151], v[176:179]
ds_read_b64_tr_b16 a[54:55], v7 offset:14016
v_mfma_f32_16x16x32_bf16 v[180:183], a[60:63], a[152:155], v[180:183]
v_mfma_f32_16x16x32_bf16 v[184:187], a[60:63], a[156:159], v[184:187]
buffer_load_dwordx4 v2, s[16:19], s36 offen offset:1024 lds
s_waitcnt lgkmcnt(8)
v_mfma_f32_16x16x32_bf16 v[188:191], a[32:35], a[144:147], v[188:191]
ds_read_b64_tr_b16 a[56:57], v7 offset:9440
v_mfma_f32_16x16x32_bf16 v[192:195], a[32:35], a[148:151], v[192:195]
ds_read_b64_tr_b16 a[58:59], v7 offset:14048
v_mfma_f32_16x16x32_bf16 v[196:199], a[32:35], a[152:155], v[196:199]
v_mfma_f32_16x16x32_bf16 v[200:203], a[32:35], a[156:159], v[200:203]
buffer_load_dwordx4 v3, s[16:19], s36 offen offset:2048 lds
v_mfma_f32_16x16x32_bf16 v[204:207], a[36:39], a[144:147], v[204:207]
ds_read_b64_tr_b16 a[60:61], v7 offset:9472
v_mfma_f32_16x16x32_bf16 v[208:211], a[36:39], a[148:151], v[208:211]
ds_read_b64_tr_b16 a[62:63], v7 offset:14080
v_mfma_f32_16x16x32_bf16 v[212:215], a[36:39], a[152:155], v[212:215]
s_waitcnt vmcnt(23)
v_mfma_f32_16x16x32_bf16 v[216:219], a[36:39], a[156:159], v[216:219]
s_barrier
s_waitcnt lgkmcnt(8)
v_mfma_f32_16x16x32_bf16 v[220:223], a[40:43], a[144:147], v[220:223]
ds_read_b64_tr_b16 a[32:33], v7 offset:18432
v_mfma_f32_16x16x32_bf16 v[224:227], a[40:43], a[148:151], v[224:227]
ds_read_b64_tr_b16 a[34:35], v7 offset:23040
v_mfma_f32_16x16x32_bf16 v[228:231], a[40:43], a[152:155], v[228:231]
v_mfma_f32_16x16x32_bf16 v[232:235], a[40:43], a[156:159], v[232:235]
v_mfma_f32_16x16x32_bf16 v[236:239], a[44:47], a[144:147], v[236:239]
ds_read_b64_tr_b16 a[36:37], v7 offset:18464
v_mfma_f32_16x16x32_bf16 v[240:243], a[44:47], a[148:151], v[240:243]
ds_read_b64_tr_b16 a[38:39], v7 offset:23072
v_mfma_f32_16x16x32_bf16 v[244:247], a[44:47], a[152:155], v[244:247]
buffer_load_dwordx4 v4, s[16:19], s36 offen offset:3072 lds
v_mfma_f32_16x16x32_bf16 v[248:251], a[44:47], a[156:159], v[248:251]
s_waitcnt lgkmcnt(8)
v_mfma_f32_16x16x32_bf16 v[252:255], a[48:51], a[144:147], v[252:255]
ds_read_b64_tr_b16 a[40:41], v7 offset:18496
v_mfma_f32_16x16x32_bf16 a[0:3], a[48:51], a[148:151], a[0:3]
ds_read_b64_tr_b16 a[42:43], v7 offset:23104
v_mfma_f32_16x16x32_bf16 a[4:7], a[48:51], a[152:155], a[4:7]
s_add_u32 m0, s35, 0
v_mfma_f32_16x16x32_bf16 a[8:11], a[48:51], a[156:159], a[8:11]
v_mfma_f32_16x16x32_bf16 a[12:15], a[52:55], a[144:147], a[12:15]
ds_read_b64_tr_b16 a[44:45], v7 offset:18528
v_mfma_f32_16x16x32_bf16 a[16:19], a[52:55], a[148:151], a[16:19]
ds_read_b64_tr_b16 a[46:47], v7 offset:23136
v_mfma_f32_16x16x32_bf16 a[20:23], a[52:55], a[152:155], a[20:23]
v_mfma_f32_16x16x32_bf16 a[24:27], a[52:55], a[156:159], a[24:27]
s_mov_b64 exec, s[48:49]
buffer_load_dwordx4 v5, s[16:19], s36 offen lds
s_mov_b64 exec, -1
s_waitcnt lgkmcnt(8)
v_mfma_f32_16x16x32_bf16 a[28:31], a[56:59], a[144:147], a[28:31]
ds_read_b64_tr_b16 a[48:49], v7 offset:18560
v_mfma_f32_16x16x32_bf16 a[64:67], a[56:59], a[148:151], a[64:67]
ds_read_b64_tr_b16 a[50:51], v7 offset:23168
v_mfma_f32_16x16x32_bf16 a[68:71], a[56:59], a[152:155], a[68:71]
v_mfma_f32_16x16x32_bf16 a[72:75], a[56:59], a[156:159], a[72:75]
buffer_store_dwordx4 a[172:175], v15, s[20:23], s46 offen offset:2304 sc1
v_mfma_f32_16x16x32_bf16 a[76:79], a[60:63], a[144:147], a[76:79]
ds_read_b64_tr_b16 a[52:53], v7 offset:18592
v_mfma_f32_16x16x32_bf16 a[80:83], a[60:63], a[148:151], a[80:83]
ds_read_b64_tr_b16 a[54:55], v7 offset:23200
v_mfma_f32_16x16x32_bf16 a[84:87], a[60:63], a[152:155], a[84:87]
v_mfma_f32_16x16x32_bf16 a[88:91], a[60:63], a[156:159], a[88:91]
s_waitcnt lgkmcnt(8)
v_mfma_f32_16x16x32_bf16 v[28:31], a[32:35], a[96:99], v[28:31]
ds_read_b64_tr_b16 a[56:57], v7 offset:18624
v_mfma_f32_16x16x32_bf16 v[32:35], a[32:35], a[100:103], v[32:35]
ds_read_b64_tr_b16 a[58:59], v7 offset:23232
v_mfma_f32_16x16x32_bf16 v[36:39], a[32:35], a[104:107], v[36:39]
s_add_u32 s37, s34, 7168
v_mfma_f32_16x16x32_bf16 v[40:43], a[32:35], a[108:111], v[40:43]
v_mfma_f32_16x16x32_bf16 v[44:47], a[36:39], a[96:99], v[44:47]
ds_read_b64_tr_b16 a[60:61], v7 offset:18656
v_mfma_f32_16x16x32_bf16 v[48:51], a[36:39], a[100:103], v[48:51]
ds_read_b64_tr_b16 a[62:63], v7 offset:23264
v_mfma_f32_16x16x32_bf16 v[52:55], a[36:39], a[104:107], v[52:55]
buffer_load_dwordx4 a[144:147], v9, s[20:23], s37 offen sc1
v_mfma_f32_16x16x32_bf16 v[56:59], a[36:39], a[108:111], v[56:59]
s_waitcnt lgkmcnt(8)
v_mfma_f32_16x16x32_bf16 v[60:63], a[40:43], a[96:99], v[60:63]
ds_read_b64_tr_b16 a[32:33], v7 offset:18688
v_mfma_f32_16x16x32_bf16 v[64:67], a[40:43], a[100:103], v[64:67]
ds_read_b64_tr_b16 a[34:35], v7 offset:23296
v_mfma_f32_16x16x32_bf16 v[68:71], a[40:43], a[104:107], v[68:71]
buffer_load_dwordx4 a[148:151], v10, s[20:23], s37 offen sc1
v_mfma_f32_16x16x32_bf16 v[72:75], a[40:43], a[108:111], v[72:75]
v_mfma_f32_16x16x32_bf16 v[76:79], a[44:47], a[96:99], v[76:79]
ds_read_b64_tr_b16 a[36:37], v7 offset:27648
v_mfma_f32_16x16x32_bf16 v[80:83], a[44:47], a[100:103], v[80:83]
ds_read_b64_tr_b16 a[38:39], v7 offset:32256
v_mfma_f32_16x16x32_bf16 v[84:87], a[44:47], a[104:107], v[84:87]
v_mfma_f32_16x16x32_bf16 v[88:91], a[44:47], a[108:111], v[88:91]
buffer_load_dwordx4 a[152:155], v11, s[20:23], s37 offen sc1
s_waitcnt lgkmcnt(8)
v_mfma_f32_16x16x32_bf16 v[92:95], a[48:51], a[96:99], v[92:95]
ds_read_b64_tr_b16 a[40:41], v7 offset:27680
v_mfma_f32_16x16x32_bf16 v[96:99], a[48:51], a[100:103], v[96:99]
ds_read_b64_tr_b16 a[42:43], v7 offset:32288
v_mfma_f32_16x16x32_bf16 v[100:103], a[48:51], a[104:107], v[100:103]
v_mfma_f32_16x16x32_bf16 v[104:107], a[48:51], a[108:111], v[104:107]
buffer_load_dwordx4 a[156:159], v12, s[20:23], s37 offen sc1
v_mfma_f32_16x16x32_bf16 v[108:111], a[52:55], a[96:99], v[108:111]
ds_read_b64_tr_b16 a[44:45], v7 offset:27712
v_mfma_f32_16x16x32_bf16 v[112:115], a[52:55], a[100:103], v[112:115]
ds_read_b64_tr_b16 a[46:47], v7 offset:32320
v_mfma_f32_16x16x32_bf16 v[116:119], a[52:55], a[104:107], v[116:119]
v_mfma_f32_16x16x32_bf16 v[120:123], a[52:55], a[108:111], v[120:123]
s_waitcnt lgkmcnt(8)
v_mfma_f32_16x16x32_bf16 v[124:127], a[56:59], a[96:99], v[124:127]
ds_read_b64_tr_b16 a[48:49], v7 offset:27744
v_mfma_f32_16x16x32_bf16 v[128:131], a[56:59], a[100:103], v[128:131]
ds_read_b64_tr_b16 a[50:51], v7 offset:32352
v_mfma_f32_16x16x32_bf16 v[132:135], a[56:59], a[104:107], v[132:135]
s_add_u32 m0, s33, 18432
v_mfma_f32_16x16x32_bf16 v[136:139], a[56:59], a[108:111], v[136:139]
v_mfma_f32_16x16x32_bf16 v[140:143], a[60:63], a[96:99], v[140:143]
ds_read_b64_tr_b16 a[52:53], v7 offset:27776
v_mfma_f32_16x16x32_bf16 v[144:147], a[60:63], a[100:103], v[144:147]
ds_read_b64_tr_b16 a[54:55], v7 offset:32384
v_mfma_f32_16x16x32_bf16 v[148:151], a[60:63], a[104:107], v[148:151]
s_add_u32 s36, s32, 2654208
v_mfma_f32_16x16x32_bf16 v[152:155], a[60:63], a[108:111], v[152:155]
s_waitcnt lgkmcnt(8)
v_mfma_f32_16x16x32_bf16 v[156:159], a[32:35], a[96:99], v[156:159]
ds_read_b64_tr_b16 a[56:57], v7 offset:27808
v_mfma_f32_16x16x32_bf16 v[160:163], a[32:35], a[100:103], v[160:163]
ds_read_b64_tr_b16 a[58:59], v7 offset:32416
v_mfma_f32_16x16x32_bf16 v[164:167], a[32:35], a[104:107], v[164:167]
buffer_load_dwordx4 v1, s[16:19], s36 offen offset:0 lds
v_mfma_f32_16x16x32_bf16 v[168:171], a[32:35], a[108:111], v[168:171]
v_mfma_f32_16x16x32_bf16 v[172:175], a[36:39], a[96:99], v[172:175]
ds_read_b64_tr_b16 a[60:61], v7 offset:27840
v_mfma_f32_16x16x32_bf16 v[176:179], a[36:39], a[100:103], v[176:179]
ds_read_b64_tr_b16 a[62:63], v7 offset:32448
v_mfma_f32_16x16x32_bf16 v[180:183], a[36:39], a[104:107], v[180:183]
v_mfma_f32_16x16x32_bf16 v[184:187], a[36:39], a[108:111], v[184:187]
buffer_load_dwordx4 v2, s[16:19], s36 offen offset:1024 lds
s_waitcnt lgkmcnt(8)
v_mfma_f32_16x16x32_bf16 v[188:191], a[40:43], a[96:99], v[188:191]
ds_read_b64_tr_b16 a[32:33], v7 offset:27872
v_mfma_f32_16x16x32_bf16 v[192:195], a[40:43], a[100:103], v[192:195]
ds_read_b64_tr_b16 a[34:35], v7 offset:32480
v_mfma_f32_16x16x32_bf16 v[196:199], a[40:43], a[104:107], v[196:199]
v_mfma_f32_16x16x32_bf16 v[200:203], a[40:43], a[108:111], v[200:203]
buffer_load_dwordx4 v3, s[16:19], s36 offen offset:2048 lds
v_mfma_f32_16x16x32_bf16 v[204:207], a[44:47], a[96:99], v[204:207]
ds_read_b64_tr_b16 a[36:37], v7 offset:27904
v_mfma_f32_16x16x32_bf16 v[208:211], a[44:47], a[100:103], v[208:211]
ds_read_b64_tr_b16 a[38:39], v7 offset:32512
v_mfma_f32_16x16x32_bf16 v[212:215], a[44:47], a[104:107], v[212:215]
v_mfma_f32_16x16x32_bf16 v[216:219], a[44:47], a[108:111], v[216:219]
s_waitcnt lgkmcnt(8)
v_mfma_f32_16x16x32_bf16 v[220:223], a[48:51], a[96:99], v[220:223]
ds_read_b64_tr_b16 a[40:41], v7 offset:36864
v_mfma_f32_16x16x32_bf16 v[224:227], a[48:51], a[100:103], v[224:227]
ds_read_b64_tr_b16 a[42:43], v7 offset:41472
v_mfma_f32_16x16x32_bf16 v[228:231], a[48:51], a[104:107], v[228:231]
buffer_load_dwordx4 v4, s[16:19], s36 offen offset:3072 lds
v_mfma_f32_16x16x32_bf16 v[232:235], a[48:51], a[108:111], v[232:235]
v_mfma_f32_16x16x32_bf16 v[236:239], a[52:55], a[96:99], v[236:239]
ds_read_b64_tr_b16 a[44:45], v7 offset:36896
v_mfma_f32_16x16x32_bf16 v[240:243], a[52:55], a[100:103], v[240:243]
ds_read_b64_tr_b16 a[46:47], v7 offset:41504
v_mfma_f32_16x16x32_bf16 v[244:247], a[52:55], a[104:107], v[244:247]
s_add_u32 m0, s35, 18432
v_mfma_f32_16x16x32_bf16 v[248:251], a[52:55], a[108:111], v[248:251]
s_waitcnt lgkmcnt(8)
v_mfma_f32_16x16x32_bf16 v[252:255], a[56:59], a[96:99], v[252:255]
ds_read_b64_tr_b16 a[48:49], v7 offset:36928
v_mfma_f32_16x16x32_bf16 a[0:3], a[56:59], a[100:103], a[0:3]
ds_read_b64_tr_b16 a[50:51], v7 offset:41536
v_mfma_f32_16x16x32_bf16 a[4:7], a[56:59], a[104:107], a[4:7]
s_mov_b64 exec, s[48:49]
buffer_load_dwordx4 v5, s[16:19], s36 offen lds
s_mov_b64 exec, -1
v_mfma_f32_16x16x32_bf16 a[8:11], a[56:59], a[108:111], a[8:11]
v_mfma_f32_16x16x32_bf16 a[12:15], a[60:63], a[96:99], a[12:15]
ds_read_b64_tr_b16 a[52:53], v7 offset:36960
v_mfma_f32_16x16x32_bf16 a[16:19], a[60:63], a[100:103], a[16:19]
ds_read_b64_tr_b16 a[54:55], v7 offset:41568
v_mfma_f32_16x16x32_bf16 a[20:23], a[60:63], a[104:107], a[20:23]
v_mfma_f32_16x16x32_bf16 a[24:27], a[60:63], a[108:111], a[24:27]
s_add_u32 s46, s92, 53248
s_waitcnt lgkmcnt(8)
v_mfma_f32_16x16x32_bf16 a[28:31], a[32:35], a[96:99], a[28:31]
ds_read_b64_tr_b16 a[56:57], v7 offset:36992
v_mfma_f32_16x16x32_bf16 a[64:67], a[32:35], a[100:103], a[64:67]
ds_read_b64_tr_b16 a[58:59], v7 offset:41600
v_mfma_f32_16x16x32_bf16 a[68:71], a[32:35], a[104:107], a[68:71]
v_mfma_f32_16x16x32_bf16 a[72:75], a[32:35], a[108:111], a[72:75]
buffer_store_dwordx4 a[176:179], v15, s[20:23], s46 offen offset:0 sc1
v_mfma_f32_16x16x32_bf16 a[76:79], a[36:39], a[96:99], a[76:79]
ds_read_b64_tr_b16 a[60:61], v7 offset:37024
v_mfma_f32_16x16x32_bf16 a[80:83], a[36:39], a[100:103], a[80:83]
ds_read_b64_tr_b16 a[62:63], v7 offset:41632
v_mfma_f32_16x16x32_bf16 a[84:87], a[36:39], a[104:107], a[84:87]
v_mfma_f32_16x16x32_bf16 a[88:91], a[36:39], a[108:111], a[88:91]
s_waitcnt vmcnt(31) lgkmcnt(8)
v_mfma_f32_16x16x32_bf16 v[28:31], a[40:43], a[112:115], v[28:31]
ds_read_b64_tr_b16 a[32:33], v7 offset:37056
v_mfma_f32_16x16x32_bf16 v[32:35], a[40:43], a[116:119], v[32:35]
ds_read_b64_tr_b16 a[34:35], v7 offset:41664
v_mfma_f32_16x16x32_bf16 v[36:39], a[40:43], a[120:123], v[36:39]
s_add_u32 s37, s34, 8192
v_mfma_f32_16x16x32_bf16 v[40:43], a[40:43], a[124:127], v[40:43]
v_mfma_f32_16x16x32_bf16 v[44:47], a[44:47], a[112:115], v[44:47]
ds_read_b64_tr_b16 a[36:37], v7 offset:37088
v_mfma_f32_16x16x32_bf16 v[48:51], a[44:47], a[116:119], v[48:51]
ds_read_b64_tr_b16 a[38:39], v7 offset:41696
v_mfma_f32_16x16x32_bf16 v[52:55], a[44:47], a[120:123], v[52:55]
buffer_load_dwordx4 a[96:99], v9, s[20:23], s37 offen sc1
v_mfma_f32_16x16x32_bf16 v[56:59], a[44:47], a[124:127], v[56:59]
s_waitcnt lgkmcnt(8)
v_mfma_f32_16x16x32_bf16 v[60:63], a[48:51], a[112:115], v[60:63]
ds_read_b64_tr_b16 a[40:41], v7 offset:37120
v_mfma_f32_16x16x32_bf16 v[64:67], a[48:51], a[116:119], v[64:67]
ds_read_b64_tr_b16 a[42:43], v7 offset:41728
v_mfma_f32_16x16x32_bf16 v[68:71], a[48:51], a[120:123], v[68:71]
buffer_load_dwordx4 a[100:103], v10, s[20:23], s37 offen sc1
v_mfma_f32_16x16x32_bf16 v[72:75], a[48:51], a[124:127], v[72:75]
v_mfma_f32_16x16x32_bf16 v[76:79], a[52:55], a[112:115], v[76:79]
ds_read_b64_tr_b16 a[44:45], v7 offset:46080
v_mfma_f32_16x16x32_bf16 v[80:83], a[52:55], a[116:119], v[80:83]
ds_read_b64_tr_b16 a[46:47], v7 offset:50688
v_mfma_f32_16x16x32_bf16 v[84:87], a[52:55], a[120:123], v[84:87]
v_mfma_f32_16x16x32_bf16 v[88:91], a[52:55], a[124:127], v[88:91]
buffer_load_dwordx4 a[104:107], v11, s[20:23], s37 offen sc1
s_waitcnt lgkmcnt(8)
v_mfma_f32_16x16x32_bf16 v[92:95], a[56:59], a[112:115], v[92:95]
ds_read_b64_tr_b16 a[48:49], v7 offset:46112
v_mfma_f32_16x16x32_bf16 v[96:99], a[56:59], a[116:119], v[96:99]
ds_read_b64_tr_b16 a[50:51], v7 offset:50720
v_mfma_f32_16x16x32_bf16 v[100:103], a[56:59], a[120:123], v[100:103]
v_mfma_f32_16x16x32_bf16 v[104:107], a[56:59], a[124:127], v[104:107]
buffer_load_dwordx4 a[108:111], v12, s[20:23], s37 offen sc1
v_mfma_f32_16x16x32_bf16 v[108:111], a[60:63], a[112:115], v[108:111]
ds_read_b64_tr_b16 a[52:53], v7 offset:46144
v_mfma_f32_16x16x32_bf16 v[112:115], a[60:63], a[116:119], v[112:115]
ds_read_b64_tr_b16 a[54:55], v7 offset:50752
v_mfma_f32_16x16x32_bf16 v[116:119], a[60:63], a[120:123], v[116:119]
v_mfma_f32_16x16x32_bf16 v[120:123], a[60:63], a[124:127], v[120:123]
s_waitcnt lgkmcnt(8)
v_mfma_f32_16x16x32_bf16 v[124:127], a[32:35], a[112:115], v[124:127]
ds_read_b64_tr_b16 a[56:57], v7 offset:46176
v_mfma_f32_16x16x32_bf16 v[128:131], a[32:35], a[116:119], v[128:131]
ds_read_b64_tr_b16 a[58:59], v7 offset:50784
v_mfma_f32_16x16x32_bf16 v[132:135], a[32:35], a[120:123], v[132:135]
s_add_u32 m0, s33, 36864
v_mfma_f32_16x16x32_bf16 v[136:139], a[32:35], a[124:127], v[136:139]
v_mfma_f32_16x16x32_bf16 v[140:143], a[36:39], a[112:115], v[140:143]
ds_read_b64_tr_b16 a[60:61], v7 offset:46208
v_mfma_f32_16x16x32_bf16 v[144:147], a[36:39], a[116:119], v[144:147]
ds_read_b64_tr_b16 a[62:63], v7 offset:50816
v_mfma_f32_16x16x32_bf16 v[148:151], a[36:39], a[120:123], v[148:151]
s_add_u32 s36, s32, 2949120
v_mfma_f32_16x16x32_bf16 v[152:155], a[36:39], a[124:127], v[152:155]
s_waitcnt lgkmcnt(8)
v_mfma_f32_16x16x32_bf16 v[156:159], a[40:43], a[112:115], v[156:159]
ds_read_b64_tr_b16 a[32:33], v7 offset:46240
v_mfma_f32_16x16x32_bf16 v[160:163], a[40:43], a[116:119], v[160:163]
ds_read_b64_tr_b16 a[34:35], v7 offset:50848
v_mfma_f32_16x16x32_bf16 v[164:167], a[40:43], a[120:123], v[164:167]
v_mfma_f32_16x16x32_bf16 v[168:171], a[40:43], a[124:127], v[168:171]
buffer_load_dwordx4 v1, s[16:19], s36 offen offset:0 lds
v_mfma_f32_16x16x32_bf16 v[172:175], a[44:47], a[112:115], v[172:175]
ds_read_b64_tr_b16 a[36:37], v7 offset:46272
v_mfma_f32_16x16x32_bf16 v[176:179], a[44:47], a[116:119], v[176:179]
ds_read_b64_tr_b16 a[38:39], v7 offset:50880
v_mfma_f32_16x16x32_bf16 v[180:183], a[44:47], a[120:123], v[180:183]
v_mfma_f32_16x16x32_bf16 v[184:187], a[44:47], a[124:127], v[184:187]
buffer_load_dwordx4 v2, s[16:19], s36 offen offset:1024 lds
s_waitcnt lgkmcnt(8)
v_mfma_f32_16x16x32_bf16 v[188:191], a[48:51], a[112:115], v[188:191]
ds_read_b64_tr_b16 a[40:41], v7 offset:46304
v_mfma_f32_16x16x32_bf16 v[192:195], a[48:51], a[116:119], v[192:195]
ds_read_b64_tr_b16 a[42:43], v7 offset:50912
v_mfma_f32_16x16x32_bf16 v[196:199], a[48:51], a[120:123], v[196:199]
v_mfma_f32_16x16x32_bf16 v[200:203], a[48:51], a[124:127], v[200:203]
buffer_load_dwordx4 v3, s[16:19], s36 offen offset:2048 lds
v_mfma_f32_16x16x32_bf16 v[204:207], a[52:55], a[112:115], v[204:207]
ds_read_b64_tr_b16 a[44:45], v7 offset:46336
v_mfma_f32_16x16x32_bf16 v[208:211], a[52:55], a[116:119], v[208:211]
ds_read_b64_tr_b16 a[46:47], v7 offset:50944
v_mfma_f32_16x16x32_bf16 v[212:215], a[52:55], a[120:123], v[212:215]
s_waitcnt vmcnt(28)
v_mfma_f32_16x16x32_bf16 v[216:219], a[52:55], a[124:127], v[216:219]
s_barrier
s_waitcnt lgkmcnt(8)
v_mfma_f32_16x16x32_bf16 v[220:223], a[56:59], a[112:115], v[220:223]
ds_read_b64_tr_b16 a[48:49], v8 offset:0
v_mfma_f32_16x16x32_bf16 v[224:227], a[56:59], a[116:119], v[224:227]
ds_read_b64_tr_b16 a[50:51], v8 offset:4608
v_mfma_f32_16x16x32_bf16 v[228:231], a[56:59], a[120:123], v[228:231]
v_mfma_f32_16x16x32_bf16 v[232:235], a[56:59], a[124:127], v[232:235]
v_mfma_f32_16x16x32_bf16 v[236:239], a[60:63], a[112:115], v[236:239]
ds_read_b64_tr_b16 a[52:53], v8 offset:32
v_mfma_f32_16x16x32_bf16 v[240:243], a[60:63], a[116:119], v[240:243]
ds_read_b64_tr_b16 a[54:55], v8 offset:4640
v_mfma_f32_16x16x32_bf16 v[244:247], a[60:63], a[120:123], v[244:247]
buffer_load_dwordx4 v4, s[16:19], s36 offen offset:3072 lds
v_mfma_f32_16x16x32_bf16 v[248:251], a[60:63], a[124:127], v[248:251]
s_waitcnt lgkmcnt(8)
v_mfma_f32_16x16x32_bf16 v[252:255], a[32:35], a[112:115], v[252:255]
ds_read_b64_tr_b16 a[56:57], v8 offset:64
v_mfma_f32_16x16x32_bf16 a[0:3], a[32:35], a[116:119], a[0:3]
ds_read_b64_tr_b16 a[58:59], v8 offset:4672
v_mfma_f32_16x16x32_bf16 a[4:7], a[32:35], a[120:123], a[4:7]
s_add_u32 m0, s35, 36864
v_mfma_f32_16x16x32_bf16 a[8:11], a[32:35], a[124:127], a[8:11]
v_mfma_f32_16x16x32_bf16 a[12:15], a[36:39], a[112:115], a[12:15]
ds_read_b64_tr_b16 a[60:61], v8 offset:96
v_mfma_f32_16x16x32_bf16 a[16:19], a[36:39], a[116:119], a[16:19]
ds_read_b64_tr_b16 a[62:63], v8 offset:4704
v_mfma_f32_16x16x32_bf16 a[20:23], a[36:39], a[120:123], a[20:23]
v_mfma_f32_16x16x32_bf16 a[24:27], a[36:39], a[124:127], a[24:27]
s_mov_b64 exec, s[48:49]
buffer_load_dwordx4 v5, s[16:19], s36 offen lds
s_mov_b64 exec, -1
s_waitcnt lgkmcnt(8)
v_mfma_f32_16x16x32_bf16 a[28:31], a[40:43], a[112:115], a[28:31]
ds_read_b64_tr_b16 a[32:33], v8 offset:128
v_mfma_f32_16x16x32_bf16 a[64:67], a[40:43], a[116:119], a[64:67]
ds_read_b64_tr_b16 a[34:35], v8 offset:4736
v_mfma_f32_16x16x32_bf16 a[68:71], a[40:43], a[120:123], a[68:71]
v_mfma_f32_16x16x32_bf16 a[72:75], a[40:43], a[124:127], a[72:75]
buffer_store_dwordx4 a[180:183], v15, s[20:23], s46 offen offset:256 sc1
v_mfma_f32_16x16x32_bf16 a[76:79], a[44:47], a[112:115], a[76:79]
ds_read_b64_tr_b16 a[36:37], v8 offset:160
v_mfma_f32_16x16x32_bf16 a[80:83], a[44:47], a[116:119], a[80:83]
ds_read_b64_tr_b16 a[38:39], v8 offset:4768
v_mfma_f32_16x16x32_bf16 a[84:87], a[44:47], a[120:123], a[84:87]
v_mfma_f32_16x16x32_bf16 a[88:91], a[44:47], a[124:127], a[88:91]
s_waitcnt vmcnt(26) lgkmcnt(8)
v_mfma_f32_16x16x32_bf16 v[28:31], a[48:51], a[128:131], v[28:31]
ds_read_b64_tr_b16 a[40:41], v8 offset:192
v_mfma_f32_16x16x32_bf16 v[32:35], a[48:51], a[132:135], v[32:35]
ds_read_b64_tr_b16 a[42:43], v8 offset:4800
v_mfma_f32_16x16x32_bf16 v[36:39], a[48:51], a[136:139], v[36:39]
s_add_u32 s37, s34, 9216
v_mfma_f32_16x16x32_bf16 v[40:43], a[48:51], a[140:143], v[40:43]
buffer_load_dwordx4 a[112:115], v9, s[20:23], s37 offen sc1
v_mfma_f32_16x16x32_bf16 v[44:47], a[52:55], a[128:131], v[44:47]
ds_read_b64_tr_b16 a[44:45], v8 offset:224
v_mfma_f32_16x16x32_bf16 v[48:51], a[52:55], a[132:135], v[48:51]
ds_read_b64_tr_b16 a[46:47], v8 offset:4832
v_mfma_f32_16x16x32_bf16 v[52:55], a[52:55], a[136:139], v[52:55]
buffer_load_dwordx4 a[116:119], v10, s[20:23], s37 offen sc1
v_mfma_f32_16x16x32_bf16 v[56:59], a[52:55], a[140:143], v[56:59]
buffer_load_dwordx4 a[120:123], v11, s[20:23], s37 offen sc1
s_waitcnt lgkmcnt(8)
v_mfma_f32_16x16x32_bf16 v[60:63], a[56:59], a[128:131], v[60:63]
ds_read_b64_tr_b16 a[48:49], v8 offset:256
v_mfma_f32_16x16x32_bf16 v[64:67], a[56:59], a[132:135], v[64:67]
ds_read_b64_tr_b16 a[50:51], v8 offset:4864
v_mfma_f32_16x16x32_bf16 v[68:71], a[56:59], a[136:139], v[68:71]
buffer_load_dwordx4 a[124:127], v12, s[20:23], s37 offen sc1
v_mfma_f32_16x16x32_bf16 v[72:75], a[56:59], a[140:143], v[72:75]
s_add_u32 m0, s33, 55296
v_mfma_f32_16x16x32_bf16 v[76:79], a[60:63], a[128:131], v[76:79]
ds_read_b64_tr_b16 a[52:53], v8 offset:9216
v_mfma_f32_16x16x32_bf16 v[80:83], a[60:63], a[132:135], v[80:83]
ds_read_b64_tr_b16 a[54:55], v8 offset:13824
v_mfma_f32_16x16x32_bf16 v[84:87], a[60:63], a[136:139], v[84:87]
s_add_u32 s36, s32, 3244032
v_mfma_f32_16x16x32_bf16 v[88:91], a[60:63], a[140:143], v[88:91]
buffer_load_dwordx4 v1, s[16:19], s36 offen offset:0 lds
s_waitcnt lgkmcnt(8)
v_mfma_f32_16x16x32_bf16 v[92:95], a[32:35], a[128:131], v[92:95]
ds_read_b64_tr_b16 a[56:57], v8 offset:9248
v_mfma_f32_16x16x32_bf16 v[96:99], a[32:35], a[132:135], v[96:99]
ds_read_b64_tr_b16 a[58:59], v8 offset:13856
v_mfma_f32_16x16x32_bf16 v[100:103], a[32:35], a[136:139], v[100:103]
buffer_load_dwordx4 v2, s[16:19], s36 offen offset:1024 lds
v_mfma_f32_16x16x32_bf16 v[104:107], a[32:35], a[140:143], v[104:107]
buffer_load_dwordx4 v3, s[16:19], s36 offen offset:2048 lds
v_mfma_f32_16x16x32_bf16 v[108:111], a[36:39], a[128:131], v[108:111]
ds_read_b64_tr_b16 a[60:61], v8 offset:9280
v_mfma_f32_16x16x32_bf16 v[112:115], a[36:39], a[132:135], v[112:115]
ds_read_b64_tr_b16 a[62:63], v8 offset:13888
v_mfma_f32_16x16x32_bf16 v[116:119], a[36:39], a[136:139], v[116:119]
buffer_load_dwordx4 v4, s[16:19], s36 offen offset:3072 lds
v_mfma_f32_16x16x32_bf16 v[120:123], a[36:39], a[140:143], v[120:123]
s_add_u32 m0, s35, 55296
s_waitcnt lgkmcnt(8)
v_mfma_f32_16x16x32_bf16 v[124:127], a[40:43], a[128:131], v[124:127]
ds_read_b64_tr_b16 a[32:33], v8 offset:9312
v_mfma_f32_16x16x32_bf16 v[128:131], a[40:43], a[132:135], v[128:131]
ds_read_b64_tr_b16 a[34:35], v8 offset:13920
v_mfma_f32_16x16x32_bf16 v[132:135], a[40:43], a[136:139], v[132:135]
s_mov_b64 exec, s[48:49]
buffer_load_dwordx4 v5, s[16:19], s36 offen lds
s_mov_b64 exec, -1
v_mfma_f32_16x16x32_bf16 v[136:139], a[40:43], a[140:143], v[136:139]
buffer_store_dwordx4 a[184:187], v15, s[20:23], s46 offen offset:2048 sc1
v_mfma_f32_16x16x32_bf16 v[140:143], a[44:47], a[128:131], v[140:143]
ds_read_b64_tr_b16 a[36:37], v8 offset:9344
v_mfma_f32_16x16x32_bf16 v[144:147], a[44:47], a[132:135], v[144:147]
ds_read_b64_tr_b16 a[38:39], v8 offset:13952
v_mfma_f32_16x16x32_bf16 v[148:151], a[44:47], a[136:139], v[148:151]
v_mfma_f32_16x16x32_bf16 v[152:155], a[44:47], a[140:143], v[152:155]
s_mov_b32 s40, s88
s_mov_b32 s41, s89
s_mov_b32 s42, 5308416
s_mov_b32 s43, 0x20000
s_waitcnt lgkmcnt(8)
v_mfma_f32_16x16x32_bf16 v[156:159], a[48:51], a[128:131], v[156:159]
ds_read_b64_tr_b16 a[40:41], v8 offset:9376
v_mfma_f32_16x16x32_bf16 v[160:163], a[48:51], a[132:135], v[160:163]
ds_read_b64_tr_b16 a[42:43], v8 offset:13984
v_mfma_f32_16x16x32_bf16 v[164:167], a[48:51], a[136:139], v[164:167]
s_lshr_b32 s3, s2, 3
s_lshl_b32 s3, s3, 2
s_add_u32 s3, s3, s28
s_mul_i32 s3, s3, 41
v_mfma_f32_16x16x32_bf16 v[168:171], a[48:51], a[140:143], v[168:171]
v_mfma_f32_16x16x32_bf16 v[172:175], a[52:55], a[128:131], v[172:175]
ds_read_b64_tr_b16 a[44:45], v8 offset:9408
v_mfma_f32_16x16x32_bf16 v[176:179], a[52:55], a[132:135], v[176:179]
ds_read_b64_tr_b16 a[46:47], v8 offset:14016
v_mfma_f32_16x16x32_bf16 v[180:183], a[52:55], a[136:139], v[180:183]
v_add_u32 v22, s3, v0
v_mfma_f32_16x16x32_bf16 v[184:187], a[52:55], a[140:143], v[184:187]
s_mov_b32 s4, 7282
s_waitcnt lgkmcnt(8)
v_mfma_f32_16x16x32_bf16 v[188:191], a[56:59], a[128:131], v[188:191]
ds_read_b64_tr_b16 a[48:49], v8 offset:9440
v_mfma_f32_16x16x32_bf16 v[192:195], a[56:59], a[132:135], v[192:195]
ds_read_b64_tr_b16 a[50:51], v8 offset:14048
v_mfma_f32_16x16x32_bf16 v[196:199], a[56:59], a[136:139], v[196:199]
v_mul_u32_u24 v23, s4, v22
v_mfma_f32_16x16x32_bf16 v[200:203], a[56:59], a[140:143], v[200:203]
v_lshrrev_b32 v23, 16, v23
v_mfma_f32_16x16x32_bf16 v[204:207], a[60:63], a[128:131], v[204:207]
ds_read_b64_tr_b16 a[52:53], v8 offset:9472
v_mfma_f32_16x16x32_bf16 v[208:211], a[60:63], a[132:135], v[208:211]
ds_read_b64_tr_b16 a[54:55], v8 offset:14080
v_mfma_f32_16x16x32_bf16 v[212:215], a[60:63], a[136:139], v[212:215]
v_mul_u32_u24 v20, 9, v23
v_mfma_f32_16x16x32_bf16 v[216:219], a[60:63], a[140:143], v[216:219]
v_sub_u32 v20, v22, v20
s_waitcnt lgkmcnt(8)
v_mfma_f32_16x16x32_bf16 v[220:223], a[32:35], a[128:131], v[220:223]
ds_read_b64_tr_b16 a[56:57], v8 offset:18432
v_mfma_f32_16x16x32_bf16 v[224:227], a[32:35], a[132:135], v[224:227]
ds_read_b64_tr_b16 a[58:59], v8 offset:23040
v_mfma_f32_16x16x32_bf16 v[228:231], a[32:35], a[136:139], v[228:231]
s_and_b32 s5, s2, 3
s_mul_i32 s5, s5, 1152
s_and_b32 s6, s2, 4
s_mul_i32 s6, s6, 144
s_add_u32 s5, s5, s6
s_mov_b32 s6, 0
v_mfma_f32_16x16x32_bf16 v[232:235], a[32:35], a[140:143], v[232:235]
v_add_u32 v23, s5, v23
v_mfma_f32_16x16x32_bf16 v[236:239], a[36:39], a[128:131], v[236:239]
ds_read_b64_tr_b16 a[60:61], v8 offset:18464
v_mfma_f32_16x16x32_bf16 v[240:243], a[36:39], a[132:135], v[240:243]
ds_read_b64_tr_b16 a[62:63], v8 offset:23072
v_mfma_f32_16x16x32_bf16 v[244:247], a[36:39], a[136:139], v[244:247]
v_mul_u32_u24 v23, 1152, v23
v_mfma_f32_16x16x32_bf16 v[248:251], a[36:39], a[140:143], v[248:251]
v_lshl_add_u32 v23, v20, 7, v23
s_waitcnt lgkmcnt(8)
v_mfma_f32_16x16x32_bf16 v[252:255], a[40:43], a[128:131], v[252:255]
ds_read_b64_tr_b16 a[32:33], v8 offset:18496
v_mfma_f32_16x16x32_bf16 a[0:3], a[40:43], a[132:135], a[0:3]
ds_read_b64_tr_b16 a[34:35], v8 offset:23104
v_mfma_f32_16x16x32_bf16 a[4:7], a[40:43], a[136:139], a[4:7]
v_add_u32 v23, s6, v23
v_mfma_f32_16x16x32_bf16 a[8:11], a[40:43], a[140:143], a[8:11]
v_mov_b32 v20, 0x10000000
v_mfma_f32_16x16x32_bf16 a[12:15], a[44:47], a[128:131], a[12:15]
ds_read_b64_tr_b16 a[36:37], v8 offset:18528
v_mfma_f32_16x16x32_bf16 a[16:19], a[44:47], a[132:135], a[16:19]
ds_read_b64_tr_b16 a[38:39], v8 offset:23136
v_mfma_f32_16x16x32_bf16 a[20:23], a[44:47], a[136:139], a[20:23]
v_cmp_gt_u32 vcc, 41, v0
v_mfma_f32_16x16x32_bf16 a[24:27], a[44:47], a[140:143], a[24:27]
s_mov_b32 s4, 5184
v_cmp_gt_u32 s[6:7], s4, v22
s_waitcnt lgkmcnt(8)
v_mfma_f32_16x16x32_bf16 a[28:31], a[48:51], a[128:131], a[28:31]
ds_read_b64_tr_b16 a[40:41], v8 offset:18560
v_mfma_f32_16x16x32_bf16 a[64:67], a[48:51], a[132:135], a[64:67]
ds_read_b64_tr_b16 a[42:43], v8 offset:23168
v_mfma_f32_16x16x32_bf16 a[68:71], a[48:51], a[136:139], a[68:71]
s_nop 1
s_and_b64 vcc, vcc, s[6:7]
v_mfma_f32_16x16x32_bf16 a[72:75], a[48:51], a[140:143], a[72:75]
s_nop 1
v_cndmask_b32 v23, v20, v23, vcc
v_mfma_f32_16x16x32_bf16 a[76:79], a[52:55], a[128:131], a[76:79]
ds_read_b64_tr_b16 a[44:45], v8 offset:18592
v_mfma_f32_16x16x32_bf16 a[80:83], a[52:55], a[132:135], a[80:83]
ds_read_b64_tr_b16 a[46:47], v8 offset:23200
v_mfma_f32_16x16x32_bf16 a[84:87], a[52:55], a[136:139], a[84:87]
buffer_load_dword v20, v23, s[40:43], 0 offen
v_mfma_f32_16x16x32_bf16 a[88:91], a[52:55], a[140:143], a[88:91]
s_waitcnt vmcnt(27) lgkmcnt(8)
v_mfma_f32_16x16x32_bf16 v[28:31], a[56:59], a[144:147], v[28:31]
ds_read_b64_tr_b16 a[48:49], v8 offset:18624
v_mfma_f32_16x16x32_bf16 v[32:35], a[56:59], a[148:151], v[32:35]
ds_read_b64_tr_b16 a[50:51], v8 offset:23232
v_mfma_f32_16x16x32_bf16 v[36:39], a[56:59], a[152:155], v[36:39]
s_add_u32 s37, s34, 10240
v_mfma_f32_16x16x32_bf16 v[40:43], a[56:59], a[156:159], v[40:43]
v_mfma_f32_16x16x32_bf16 v[44:47], a[60:63], a[144:147], v[44:47]
ds_read_b64_tr_b16 a[52:53], v8 offset:18656
v_mfma_f32_16x16x32_bf16 v[48:51], a[60:63], a[148:151], v[48:51]
ds_read_b64_tr_b16 a[54:55], v8 offset:23264
v_mfma_f32_16x16x32_bf16 v[52:55], a[60:63], a[152:155], v[52:55]
buffer_load_dwordx4 a[128:131], v9, s[20:23], s37 offen sc1
v_mfma_f32_16x16x32_bf16 v[56:59], a[60:63], a[156:159], v[56:59]
s_waitcnt lgkmcnt(8)
v_mfma_f32_16x16x32_bf16 v[60:63], a[32:35], a[144:147], v[60:63]
ds_read_b64_tr_b16 a[56:57], v8 offset:18688
v_mfma_f32_16x16x32_bf16 v[64:67], a[32:35], a[148:151], v[64:67]
ds_read_b64_tr_b16 a[58:59], v8 offset:23296
v_mfma_f32_16x16x32_bf16 v[68:71], a[32:35], a[152:155], v[68:71]
buffer_load_dwordx4 a[132:135], v10, s[20:23], s37 offen sc1
v_mfma_f32_16x16x32_bf16 v[72:75], a[32:35], a[156:159], v[72:75]
v_mfma_f32_16x16x32_bf16 v[76:79], a[36:39], a[144:147], v[76:79]
ds_read_b64_tr_b16 a[60:61], v8 offset:27648
v_mfma_f32_16x16x32_bf16 v[80:83], a[36:39], a[148:151], v[80:83]
ds_read_b64_tr_b16 a[62:63], v8 offset:32256
v_mfma_f32_16x16x32_bf16 v[84:87], a[36:39], a[152:155], v[84:87]
v_mfma_f32_16x16x32_bf16 v[88:91], a[36:39], a[156:159], v[88:91]
buffer_load_dwordx4 a[136:139], v11, s[20:23], s37 offen sc1
s_waitcnt lgkmcnt(8)
v_mfma_f32_16x16x32_bf16 v[92:95], a[40:43], a[144:147], v[92:95]
ds_read_b64_tr_b16 a[32:33], v8 offset:27680
v_mfma_f32_16x16x32_bf16 v[96:99], a[40:43], a[148:151], v[96:99]
ds_read_b64_tr_b16 a[34:35], v8 offset:32288
v_mfma_f32_16x16x32_bf16 v[100:103], a[40:43], a[152:155], v[100:103]
v_mfma_f32_16x16x32_bf16 v[104:107], a[40:43], a[156:159], v[104:107]
buffer_load_dwordx4 a[140:143], v12, s[20:23], s37 offen sc1
v_mfma_f32_16x16x32_bf16 v[108:111], a[44:47], a[144:147], v[108:111]
ds_read_b64_tr_b16 a[36:37], v8 offset:27712
v_mfma_f32_16x16x32_bf16 v[112:115], a[44:47], a[148:151], v[112:115]
ds_read_b64_tr_b16 a[38:39], v8 offset:32320
v_mfma_f32_16x16x32_bf16 v[116:119], a[44:47], a[152:155], v[116:119]
v_mfma_f32_16x16x32_bf16 v[120:123], a[44:47], a[156:159], v[120:123]
s_waitcnt lgkmcnt(8)
v_mfma_f32_16x16x32_bf16 v[124:127], a[48:51], a[144:147], v[124:127]
ds_read_b64_tr_b16 a[40:41], v8 offset:27744
v_mfma_f32_16x16x32_bf16 v[128:131], a[48:51], a[148:151], v[128:131]
ds_read_b64_tr_b16 a[42:43], v8 offset:32352
v_mfma_f32_16x16x32_bf16 v[132:135], a[48:51], a[152:155], v[132:135]
s_add_u32 m0, s33, 73728
v_mfma_f32_16x16x32_bf16 v[136:139], a[48:51], a[156:159], v[136:139]
v_mfma_f32_16x16x32_bf16 v[140:143], a[52:55], a[144:147], v[140:143]
ds_read_b64_tr_b16 a[44:45], v8 offset:27776
v_mfma_f32_16x16x32_bf16 v[144:147], a[52:55], a[148:151], v[144:147]
ds_read_b64_tr_b16 a[46:47], v8 offset:32384
v_mfma_f32_16x16x32_bf16 v[148:151], a[52:55], a[152:155], v[148:151]
s_add_u32 s36, s32, 3538944
v_mfma_f32_16x16x32_bf16 v[152:155], a[52:55], a[156:159], v[152:155]
s_waitcnt lgkmcnt(8)
v_mfma_f32_16x16x32_bf16 v[156:159], a[56:59], a[144:147], v[156:159]
ds_read_b64_tr_b16 a[48:49], v8 offset:27808
v_mfma_f32_16x16x32_bf16 v[160:163], a[56:59], a[148:151], v[160:163]
ds_read_b64_tr_b16 a[50:51], v8 offset:32416
v_mfma_f32_16x16x32_bf16 v[164:167], a[56:59], a[152:155], v[164:167]
v_mfma_f32_16x16x32_bf16 v[168:171], a[56:59], a[156:159], v[168:171]
buffer_load_dwordx4 v1, s[16:19], s36 offen offset:0 lds
v_mfma_f32_16x16x32_bf16 v[172:175], a[60:63], a[144:147], v[172:175]
ds_read_b64_tr_b16 a[52:53], v8 offset:27840
v_mfma_f32_16x16x32_bf16 v[176:179], a[60:63], a[148:151], v[176:179]
ds_read_b64_tr_b16 a[54:55], v8 offset:32448
v_mfma_f32_16x16x32_bf16 v[180:183], a[60:63], a[152:155], v[180:183]
v_mfma_f32_16x16x32_bf16 v[184:187], a[60:63], a[156:159], v[184:187]
buffer_load_dwordx4 v2, s[16:19], s36 offen offset:1024 lds
s_waitcnt lgkmcnt(8)
v_mfma_f32_16x16x32_bf16 v[188:191], a[32:35], a[144:147], v[188:191]
ds_read_b64_tr_b16 a[56:57], v8 offset:27872
v_mfma_f32_16x16x32_bf16 v[192:195], a[32:35], a[148:151], v[192:195]
ds_read_b64_tr_b16 a[58:59], v8 offset:32480
v_mfma_f32_16x16x32_bf16 v[196:199], a[32:35], a[152:155], v[196:199]
v_mfma_f32_16x16x32_bf16 v[200:203], a[32:35], a[156:159], v[200:203]
buffer_load_dwordx4 v3, s[16:19], s36 offen offset:2048 lds
v_mfma_f32_16x16x32_bf16 v[204:207], a[36:39], a[144:147], v[204:207]
ds_read_b64_tr_b16 a[60:61], v8 offset:27904
v_mfma_f32_16x16x32_bf16 v[208:211], a[36:39], a[148:151], v[208:211]
ds_read_b64_tr_b16 a[62:63], v8 offset:32512
v_mfma_f32_16x16x32_bf16 v[212:215], a[36:39], a[152:155], v[212:215]
s_waitcnt vmcnt(29)
v_mfma_f32_16x16x32_bf16 v[216:219], a[36:39], a[156:159], v[216:219]
s_barrier
s_waitcnt lgkmcnt(8)
v_mfma_f32_16x16x32_bf16 v[220:223], a[40:43], a[144:147], v[220:223]
ds_read_b64_tr_b16 a[32:33], v6 offset:0
v_mfma_f32_16x16x32_bf16 v[224:227], a[40:43], a[148:151], v[224:227]
ds_read_b64_tr_b16 a[34:35], v6 offset:4608
v_mfma_f32_16x16x32_bf16 v[228:231], a[40:43], a[152:155], v[228:231]
v_mfma_f32_16x16x32_bf16 v[232:235], a[40:43], a[156:159], v[232:235]
v_mfma_f32_16x16x32_bf16 v[236:239], a[44:47], a[144:147], v[236:239]
ds_read_b64_tr_b16 a[36:37], v6 offset:32
v_mfma_f32_16x16x32_bf16 v[240:243], a[44:47], a[148:151], v[240:243]
ds_read_b64_tr_b16 a[38:39], v6 offset:4640
v_mfma_f32_16x16x32_bf16 v[244:247], a[44:47], a[152:155], v[244:247]
buffer_load_dwordx4 v4, s[16:19], s36 offen offset:3072 lds
v_mfma_f32_16x16x32_bf16 v[248:251], a[44:47], a[156:159], v[248:251]
s_waitcnt lgkmcnt(8)
v_mfma_f32_16x16x32_bf16 v[252:255], a[48:51], a[144:147], v[252:255]
ds_read_b64_tr_b16 a[40:41], v6 offset:64
v_mfma_f32_16x16x32_bf16 a[0:3], a[48:51], a[148:151], a[0:3]
ds_read_b64_tr_b16 a[42:43], v6 offset:4672
v_mfma_f32_16x16x32_bf16 a[4:7], a[48:51], a[152:155], a[4:7]
s_add_u32 m0, s35, 73728
v_mfma_f32_16x16x32_bf16 a[8:11], a[48:51], a[156:159], a[8:11]
v_mfma_f32_16x16x32_bf16 a[12:15], a[52:55], a[144:147], a[12:15]
ds_read_b64_tr_b16 a[44:45], v6 offset:96
v_mfma_f32_16x16x32_bf16 a[16:19], a[52:55], a[148:151], a[16:19]
ds_read_b64_tr_b16 a[46:47], v6 offset:4704
v_mfma_f32_16x16x32_bf16 a[20:23], a[52:55], a[152:155], a[20:23]
v_mfma_f32_16x16x32_bf16 a[24:27], a[52:55], a[156:159], a[24:27]
s_mov_b64 exec, s[48:49]
buffer_load_dwordx4 v5, s[16:19], s36 offen lds
s_mov_b64 exec, -1
s_waitcnt lgkmcnt(8)
v_mfma_f32_16x16x32_bf16 a[28:31], a[56:59], a[144:147], a[28:31]
ds_read_b64_tr_b16 a[48:49], v6 offset:128
v_mfma_f32_16x16x32_bf16 a[64:67], a[56:59], a[148:151], a[64:67]
ds_read_b64_tr_b16 a[50:51], v6 offset:4736
v_mfma_f32_16x16x32_bf16 a[68:71], a[56:59], a[152:155], a[68:71]
v_mfma_f32_16x16x32_bf16 a[72:75], a[56:59], a[156:159], a[72:75]
buffer_store_dwordx4 a[188:191], v15, s[20:23], s46 offen offset:2304 sc1
v_mfma_f32_16x16x32_bf16 a[76:79], a[60:63], a[144:147], a[76:79]
ds_read_b64_tr_b16 a[52:53], v6 offset:160
v_mfma_f32_16x16x32_bf16 a[80:83], a[60:63], a[148:151], a[80:83]
ds_read_b64_tr_b16 a[54:55], v6 offset:4768
v_mfma_f32_16x16x32_bf16 a[84:87], a[60:63], a[152:155], a[84:87]
v_mfma_f32_16x16x32_bf16 a[88:91], a[60:63], a[156:159], a[88:91]
s_waitcnt vmcnt(27) lgkmcnt(8)
v_mfma_f32_16x16x32_bf16 v[28:31], a[32:35], a[96:99], v[28:31]
ds_read_b64_tr_b16 a[56:57], v6 offset:192
v_mfma_f32_16x16x32_bf16 v[32:35], a[32:35], a[100:103], v[32:35]
ds_read_b64_tr_b16 a[58:59], v6 offset:4800
v_mfma_f32_16x16x32_bf16 v[36:39], a[32:35], a[104:107], v[36:39]
s_add_u32 s37, s34, 11264
v_mfma_f32_16x16x32_bf16 v[40:43], a[32:35], a[108:111], v[40:43]
v_mfma_f32_16x16x32_bf16 v[44:47], a[36:39], a[96:99], v[44:47]
ds_read_b64_tr_b16 a[60:61], v6 offset:224
v_mfma_f32_16x16x32_bf16 v[48:51], a[36:39], a[100:103], v[48:51]
ds_read_b64_tr_b16 a[62:63], v6 offset:4832
v_mfma_f32_16x16x32_bf16 v[52:55], a[36:39], a[104:107], v[52:55]
buffer_load_dwordx4 a[144:147], v9, s[20:23], s37 offen sc1
v_mfma_f32_16x16x32_bf16 v[56:59], a[36:39], a[108:111], v[56:59]
s_waitcnt lgkmcnt(8)
v_mfma_f32_16x16x32_bf16 v[60:63], a[40:43], a[96:99], v[60:63]
ds_read_b64_tr_b16 a[32:33], v6 offset:256
v_mfma_f32_16x16x32_bf16 v[64:67], a[40:43], a[100:103], v[64:67]
ds_read_b64_tr_b16 a[34:35], v6 offset:4864
v_mfma_f32_16x16x32_bf16 v[68:71], a[40:43], a[104:107], v[68:71]
v_mfma_f32_16x16x32_bf16 v[72:75], a[40:43], a[108:111], v[72:75]
buffer_load_dwordx4 a[148:151], v10, s[20:23], s37 offen sc1
v_mfma_f32_16x16x32_bf16 v[76:79], a[44:47], a[96:99], v[76:79]
ds_read_b64_tr_b16 a[36:37], v6 offset:9216
v_mfma_f32_16x16x32_bf16 v[80:83], a[44:47], a[100:103], v[80:83]
ds_read_b64_tr_b16 a[38:39], v6 offset:13824
v_mfma_f32_16x16x32_bf16 v[84:87], a[44:47], a[104:107], v[84:87]
v_mfma_f32_16x16x32_bf16 v[88:91], a[44:47], a[108:111], v[88:91]
s_waitcnt lgkmcnt(8)
v_mfma_f32_16x16x32_bf16 v[92:95], a[48:51], a[96:99], v[92:95]
ds_read_b64_tr_b16 a[40:41], v6 offset:9248
v_mfma_f32_16x16x32_bf16 v[96:99], a[48:51], a[100:103], v[96:99]
ds_read_b64_tr_b16 a[42:43], v6 offset:13856
v_mfma_f32_16x16x32_bf16 v[100:103], a[48:51], a[104:107], v[100:103]
buffer_load_dwordx4 a[152:155], v11, s[20:23], s37 offen sc1
v_mfma_f32_16x16x32_bf16 v[104:107], a[48:51], a[108:111], v[104:107]
v_mfma_f32_16x16x32_bf16 v[108:111], a[52:55], a[96:99], v[108:111]
ds_read_b64_tr_b16 a[44:45], v6 offset:9280
v_mfma_f32_16x16x32_bf16 v[112:115], a[52:55], a[100:103], v[112:115]
ds_read_b64_tr_b16 a[46:47], v6 offset:13888
v_mfma_f32_16x16x32_bf16 v[116:119], a[52:55], a[104:107], v[116:119]
v_mfma_f32_16x16x32_bf16 v[120:123], a[52:55], a[108:111], v[120:123]
buffer_load_dwordx4 a[156:159], v12, s[20:23], s37 offen sc1
s_waitcnt lgkmcnt(8)
v_mfma_f32_16x16x32_bf16 v[124:127], a[56:59], a[96:99], v[124:127]
ds_read_b64_tr_b16 a[48:49], v6 offset:9312
v_mfma_f32_16x16x32_bf16 v[128:131], a[56:59], a[100:103], v[128:131]
ds_read_b64_tr_b16 a[50:51], v6 offset:13920
v_mfma_f32_16x16x32_bf16 v[132:135], a[56:59], a[104:107], v[132:135]
v_mfma_f32_16x16x32_bf16 v[136:139], a[56:59], a[108:111], v[136:139]
s_add_u32 m0, s33, 92160
v_mfma_f32_16x16x32_bf16 v[140:143], a[60:63], a[96:99], v[140:143]
ds_read_b64_tr_b16 a[52:53], v6 offset:9344
v_mfma_f32_16x16x32_bf16 v[144:147], a[60:63], a[100:103], v[144:147]
ds_read_b64_tr_b16 a[54:55], v6 offset:13952
v_mfma_f32_16x16x32_bf16 v[148:151], a[60:63], a[104:107], v[148:151]
v_mfma_f32_16x16x32_bf16 v[152:155], a[60:63], a[108:111], v[152:155]
s_waitcnt lgkmcnt(8)
v_mfma_f32_16x16x32_bf16 v[156:159], a[32:35], a[96:99], v[156:159]
ds_read_b64_tr_b16 a[56:57], v6 offset:9376
v_mfma_f32_16x16x32_bf16 v[160:163], a[32:35], a[100:103], v[160:163]
ds_read_b64_tr_b16 a[58:59], v6 offset:13984
v_mfma_f32_16x16x32_bf16 v[164:167], a[32:35], a[104:107], v[164:167]
s_add_u32 s36, s32, 3833856
v_mfma_f32_16x16x32_bf16 v[168:171], a[32:35], a[108:111], v[168:171]
v_mfma_f32_16x16x32_bf16 v[172:175], a[36:39], a[96:99], v[172:175]
ds_read_b64_tr_b16 a[60:61], v6 offset:9408
v_mfma_f32_16x16x32_bf16 v[176:179], a[36:39], a[100:103], v[176:179]
ds_read_b64_tr_b16 a[62:63], v6 offset:14016
v_mfma_f32_16x16x32_bf16 v[180:183], a[36:39], a[104:107], v[180:183]
v_mfma_f32_16x16x32_bf16 v[184:187], a[36:39], a[108:111], v[184:187]
buffer_load_dwordx4 v1, s[16:19], s36 offen offset:0 lds
s_waitcnt lgkmcnt(8)
v_mfma_f32_16x16x32_bf16 v[188:191], a[40:43], a[96:99], v[188:191]
ds_read_b64_tr_b16 a[32:33], v6 offset:9440
v_mfma_f32_16x16x32_bf16 v[192:195], a[40:43], a[100:103], v[192:195]
ds_read_b64_tr_b16 a[34:35], v6 offset:14048
v_mfma_f32_16x16x32_bf16 v[196:199], a[40:43], a[104:107], v[196:199]
v_mfma_f32_16x16x32_bf16 v[200:203], a[40:43], a[108:111], v[200:203]
v_mfma_f32_16x16x32_bf16 v[204:207], a[44:47], a[96:99], v[204:207]
ds_read_b64_tr_b16 a[36:37], v6 offset:9472
v_mfma_f32_16x16x32_bf16 v[208:211], a[44:47], a[100:103], v[208:211]
ds_read_b64_tr_b16 a[38:39], v6 offset:14080
v_mfma_f32_16x16x32_bf16 v[212:215], a[44:47], a[104:107], v[212:215]
buffer_load_dwordx4 v2, s[16:19], s36 offen offset:1024 lds
v_mfma_f32_16x16x32_bf16 v[216:219], a[44:47], a[108:111], v[216:219]
s_waitcnt lgkmcnt(8)
v_mfma_f32_16x16x32_bf16 v[220:223], a[48:51], a[96:99], v[220:223]
ds_read_b64_tr_b16 a[40:41], v6 offset:18432
v_mfma_f32_16x16x32_bf16 v[224:227], a[48:51], a[100:103], v[224:227]
ds_read_b64_tr_b16 a[42:43], v6 offset:23040
v_mfma_f32_16x16x32_bf16 v[228:231], a[48:51], a[104:107], v[228:231]
buffer_load_dwordx4 v3, s[16:19], s36 offen offset:2048 lds
v_mfma_f32_16x16x32_bf16 v[232:235], a[48:51], a[108:111], v[232:235]
v_mfma_f32_16x16x32_bf16 v[236:239], a[52:55], a[96:99], v[236:239]
ds_read_b64_tr_b16 a[44:45], v6 offset:18464
v_mfma_f32_16x16x32_bf16 v[240:243], a[52:55], a[100:103], v[240:243]
ds_read_b64_tr_b16 a[46:47], v6 offset:23072
v_mfma_f32_16x16x32_bf16 v[244:247], a[52:55], a[104:107], v[244:247]
v_mfma_f32_16x16x32_bf16 v[248:251], a[52:55], a[108:111], v[248:251]
buffer_load_dwordx4 v4, s[16:19], s36 offen offset:3072 lds
s_waitcnt lgkmcnt(8)
v_mfma_f32_16x16x32_bf16 v[252:255], a[56:59], a[96:99], v[252:255]
ds_read_b64_tr_b16 a[48:49], v6 offset:18496
v_mfma_f32_16x16x32_bf16 a[0:3], a[56:59], a[100:103], a[0:3]
ds_read_b64_tr_b16 a[50:51], v6 offset:23104
v_mfma_f32_16x16x32_bf16 a[4:7], a[56:59], a[104:107], a[4:7]
v_mfma_f32_16x16x32_bf16 a[8:11], a[56:59], a[108:111], a[8:11]
v_mfma_f32_16x16x32_bf16 a[12:15], a[60:63], a[96:99], a[12:15]
ds_read_b64_tr_b16 a[52:53], v6 offset:18528
v_mfma_f32_16x16x32_bf16 a[16:19], a[60:63], a[100:103], a[16:19]
ds_read_b64_tr_b16 a[54:55], v6 offset:23136
v_mfma_f32_16x16x32_bf16 a[20:23], a[60:63], a[104:107], a[20:23]
s_add_u32 m0, s35, 92160
v_mfma_f32_16x16x32_bf16 a[24:27], a[60:63], a[108:111], a[24:27]
s_waitcnt lgkmcnt(8)
v_mfma_f32_16x16x32_bf16 a[28:31], a[32:35], a[96:99], a[28:31]
ds_read_b64_tr_b16 a[56:57], v6 offset:18560
v_mfma_f32_16x16x32_bf16 a[64:67], a[32:35], a[100:103], a[64:67]
ds_read_b64_tr_b16 a[58:59], v6 offset:23168
v_mfma_f32_16x16x32_bf16 a[68:71], a[32:35], a[104:107], a[68:71]
v_mfma_f32_16x16x32_bf16 a[72:75], a[32:35], a[108:111], a[72:75]
s_mov_b64 exec, s[48:49]
buffer_load_dwordx4 v5, s[16:19], s36 offen lds
s_mov_b64 exec, -1
v_mfma_f32_16x16x32_bf16 a[76:79], a[36:39], a[96:99], a[76:79]
ds_read_b64_tr_b16 a[60:61], v6 offset:18592
v_mfma_f32_16x16x32_bf16 a[80:83], a[36:39], a[100:103], a[80:83]
ds_read_b64_tr_b16 a[62:63], v6 offset:23200
v_mfma_f32_16x16x32_bf16 a[84:87], a[36:39], a[104:107], a[84:87]
v_mfma_f32_16x16x32_bf16 a[88:91], a[36:39], a[108:111], a[88:91]
s_waitcnt vmcnt(26) lgkmcnt(8)
v_mfma_f32_16x16x32_bf16 v[28:31], a[40:43], a[112:115], v[28:31]
ds_read_b64_tr_b16 a[32:33], v6 offset:18624
v_mfma_f32_16x16x32_bf16 v[32:35], a[40:43], a[116:119], v[32:35]
ds_read_b64_tr_b16 a[34:35], v6 offset:23232
v_mfma_f32_16x16x32_bf16 v[36:39], a[40:43], a[120:123], v[36:39]
s_add_u32 s37, s34, 12288
v_mfma_f32_16x16x32_bf16 v[40:43], a[40:43], a[124:127], v[40:43]
v_mfma_f32_16x16x32_bf16 v[44:47], a[44:47], a[112:115], v[44:47]
ds_read_b64_tr_b16 a[36:37], v6 offset:18656
v_mfma_f32_16x16x32_bf16 v[48:51], a[44:47], a[116:119], v[48:51]
ds_read_b64_tr_b16 a[38:39], v6 offset:23264
v_mfma_f32_16x16x32_bf16 v[52:55], a[44:47], a[120:123], v[52:55]
buffer_load_dwordx4 a[96:99], v9, s[20:23], s37 offen sc1
v_mfma_f32_16x16x32_bf16 v[56:59], a[44:47], a[124:127], v[56:59]
s_waitcnt lgkmcnt(8)
v_mfma_f32_16x16x32_bf16 v[60:63], a[48:51], a[112:115], v[60:63]
ds_read_b64_tr_b16 a[40:41], v6 offset:18688
v_mfma_f32_16x16x32_bf16 v[64:67], a[48:51], a[116:119], v[64:67]
ds_read_b64_tr_b16 a[42:43], v6 offset:23296
v_mfma_f32_16x16x32_bf16 v[68:71], a[48:51], a[120:123], v[68:71]
v_mfma_f32_16x16x32_bf16 v[72:75], a[48:51], a[124:127], v[72:75]
buffer_load_dwordx4 a[100:103], v10, s[20:23], s37 offen sc1
v_mfma_f32_16x16x32_bf16 v[76:79], a[52:55], a[112:115], v[76:79]
ds_read_b64_tr_b16 a[44:45], v6 offset:27648
v_mfma_f32_16x16x32_bf16 v[80:83], a[52:55], a[116:119], v[80:83]
ds_read_b64_tr_b16 a[46:47], v6 offset:32256
v_mfma_f32_16x16x32_bf16 v[84:87], a[52:55], a[120:123], v[84:87]
v_mfma_f32_16x16x32_bf16 v[88:91], a[52:55], a[124:127], v[88:91]
buffer_load_dwordx4 a[104:107], v11, s[20:23], s37 offen sc1
s_waitcnt lgkmcnt(8)
v_mfma_f32_16x16x32_bf16 v[92:95], a[56:59], a[112:115], v[92:95]
ds_read_b64_tr_b16 a[48:49], v6 offset:27680
v_mfma_f32_16x16x32_bf16 v[96:99], a[56:59], a[116:119], v[96:99]
ds_read_b64_tr_b16 a[50:51], v6 offset:32288
v_mfma_f32_16x16x32_bf16 v[100:103], a[56:59], a[120:123], v[100:103]
v_mfma_f32_16x16x32_bf16 v[104:107], a[56:59], a[124:127], v[104:107]
v_mfma_f32_16x16x32_bf16 v[108:111], a[60:63], a[112:115], v[108:111]
ds_read_b64_tr_b16 a[52:53], v6 offset:27712
v_mfma_f32_16x16x32_bf16 v[112:115], a[60:63], a[116:119], v[112:115]
ds_read_b64_tr_b16 a[54:55], v6 offset:32320
v_mfma_f32_16x16x32_bf16 v[116:119], a[60:63], a[120:123], v[116:119]
buffer_load_dwordx4 a[108:111], v12, s[20:23], s37 offen sc1
v_mfma_f32_16x16x32_bf16 v[120:123], a[60:63], a[124:127], v[120:123]
s_waitcnt lgkmcnt(8)
v_mfma_f32_16x16x32_bf16 v[124:127], a[32:35], a[112:115], v[124:127]
ds_read_b64_tr_b16 a[56:57], v6 offset:27744
v_mfma_f32_16x16x32_bf16 v[128:131], a[32:35], a[116:119], v[128:131]
ds_read_b64_tr_b16 a[58:59], v6 offset:32352
v_mfma_f32_16x16x32_bf16 v[132:135], a[32:35], a[120:123], v[132:135]
v_mfma_f32_16x16x32_bf16 v[136:139], a[32:35], a[124:127], v[136:139]
s_add_u32 m0, s33, 110592
v_mfma_f32_16x16x32_bf16 v[140:143], a[36:39], a[112:115], v[140:143]
ds_read_b64_tr_b16 a[60:61], v6 offset:27776
v_mfma_f32_16x16x32_bf16 v[144:147], a[36:39], a[116:119], v[144:147]
ds_read_b64_tr_b16 a[62:63], v6 offset:32384
v_mfma_f32_16x16x32_bf16 v[148:151], a[36:39], a[120:123], v[148:151]
v_mfma_f32_16x16x32_bf16 v[152:155], a[36:39], a[124:127], v[152:155]
s_add_u32 s36, s32, 4128768
s_waitcnt lgkmcnt(8)
v_mfma_f32_16x16x32_bf16 v[156:159], a[40:43], a[112:115], v[156:159]
ds_read_b64_tr_b16 a[32:33], v6 offset:27808
v_mfma_f32_16x16x32_bf16 v[160:163], a[40:43], a[116:119], v[160:163]
ds_read_b64_tr_b16 a[34:35], v6 offset:32416
v_mfma_f32_16x16x32_bf16 v[164:167], a[40:43], a[120:123], v[164:167]
v_mfma_f32_16x16x32_bf16 v[168:171], a[40:43], a[124:127], v[168:171]
v_mfma_f32_16x16x32_bf16 v[172:175], a[44:47], a[112:115], v[172:175]
ds_read_b64_tr_b16 a[36:37], v6 offset:27840
v_mfma_f32_16x16x32_bf16 v[176:179], a[44:47], a[116:119], v[176:179]
ds_read_b64_tr_b16 a[38:39], v6 offset:32448
v_mfma_f32_16x16x32_bf16 v[180:183], a[44:47], a[120:123], v[180:183]
buffer_load_dwordx4 v1, s[16:19], s36 offen offset:0 lds
v_mfma_f32_16x16x32_bf16 v[184:187], a[44:47], a[124:127], v[184:187]
s_waitcnt lgkmcnt(8)
v_mfma_f32_16x16x32_bf16 v[188:191], a[48:51], a[112:115], v[188:191]
ds_read_b64_tr_b16 a[40:41], v6 offset:27872
v_mfma_f32_16x16x32_bf16 v[192:195], a[48:51], a[116:119], v[192:195]
ds_read_b64_tr_b16 a[42:43], v6 offset:32480
v_mfma_f32_16x16x32_bf16 v[196:199], a[48:51], a[120:123], v[196:199]
buffer_load_dwordx4 v2, s[16:19], s36 offen offset:1024 lds
v_mfma_f32_16x16x32_bf16 v[200:203], a[48:51], a[124:127], v[200:203]
v_mfma_f32_16x16x32_bf16 v[204:207], a[52:55], a[112:115], v[204:207]
ds_read_b64_tr_b16 a[44:45], v6 offset:27904
v_mfma_f32_16x16x32_bf16 v[208:211], a[52:55], a[116:119], v[208:211]
ds_read_b64_tr_b16 a[46:47], v6 offset:32512
v_mfma_f32_16x16x32_bf16 v[212:215], a[52:55], a[120:123], v[212:215]
s_waitcnt vmcnt(27)
v_mfma_f32_16x16x32_bf16 v[216:219], a[52:55], a[124:127], v[216:219]
s_barrier
s_waitcnt lgkmcnt(8)
v_mfma_f32_16x16x32_bf16 v[220:223], a[56:59], a[112:115], v[220:223]
ds_read_b64_tr_b16 a[48:49], v6 offset:36864
v_mfma_f32_16x16x32_bf16 v[224:227], a[56:59], a[116:119], v[224:227]
ds_read_b64_tr_b16 a[50:51], v6 offset:41472
v_mfma_f32_16x16x32_bf16 v[228:231], a[56:59], a[120:123], v[228:231]
v_mfma_f32_16x16x32_bf16 v[232:235], a[56:59], a[124:127], v[232:235]
buffer_load_dwordx4 v3, s[16:19], s36 offen offset:2048 lds
v_mfma_f32_16x16x32_bf16 v[236:239], a[60:63], a[112:115], v[236:239]
ds_read_b64_tr_b16 a[52:53], v6 offset:36896
v_mfma_f32_16x16x32_bf16 v[240:243], a[60:63], a[116:119], v[240:243]
ds_read_b64_tr_b16 a[54:55], v6 offset:41504
v_mfma_f32_16x16x32_bf16 v[244:247], a[60:63], a[120:123], v[244:247]
v_mfma_f32_16x16x32_bf16 v[248:251], a[60:63], a[124:127], v[248:251]
s_waitcnt lgkmcnt(8)
v_mfma_f32_16x16x32_bf16 v[252:255], a[32:35], a[112:115], v[252:255]
ds_read_b64_tr_b16 a[56:57], v6 offset:36928
v_mfma_f32_16x16x32_bf16 a[0:3], a[32:35], a[116:119], a[0:3]
ds_read_b64_tr_b16 a[58:59], v6 offset:41536
v_mfma_f32_16x16x32_bf16 a[4:7], a[32:35], a[120:123], a[4:7]
buffer_load_dwordx4 v4, s[16:19], s36 offen offset:3072 lds
v_mfma_f32_16x16x32_bf16 a[8:11], a[32:35], a[124:127], a[8:11]
v_mfma_f32_16x16x32_bf16 a[12:15], a[36:39], a[112:115], a[12:15]
ds_read_b64_tr_b16 a[60:61], v6 offset:36960
v_mfma_f32_16x16x32_bf16 a[16:19], a[36:39], a[116:119], a[16:19]
ds_read_b64_tr_b16 a[62:63], v6 offset:41568
v_mfma_f32_16x16x32_bf16 a[20:23], a[36:39], a[120:123], a[20:23]
s_add_u32 m0, s35, 110592
v_mfma_f32_16x16x32_bf16 a[24:27], a[36:39], a[124:127], a[24:27]
s_waitcnt lgkmcnt(8)
v_mfma_f32_16x16x32_bf16 a[28:31], a[40:43], a[112:115], a[28:31]
ds_read_b64_tr_b16 a[32:33], v6 offset:36992
v_mfma_f32_16x16x32_bf16 a[64:67], a[40:43], a[116:119], a[64:67]
ds_read_b64_tr_b16 a[34:35], v6 offset:41600
v_mfma_f32_16x16x32_bf16 a[68:71], a[40:43], a[120:123], a[68:71]
v_mfma_f32_16x16x32_bf16 a[72:75], a[40:43], a[124:127], a[72:75]
s_mov_b64 exec, s[48:49]
buffer_load_dwordx4 v5, s[16:19], s36 offen lds
s_mov_b64 exec, -1
v_mfma_f32_16x16x32_bf16 a[76:79], a[44:47], a[112:115], a[76:79]
ds_read_b64_tr_b16 a[36:37], v6 offset:37024
v_mfma_f32_16x16x32_bf16 a[80:83], a[44:47], a[116:119], a[80:83]
ds_read_b64_tr_b16 a[38:39], v6 offset:41632
v_mfma_f32_16x16x32_bf16 a[84:87], a[44:47], a[120:123], a[84:87]
v_mfma_f32_16x16x32_bf16 a[88:91], a[44:47], a[124:127], a[88:91]
s_waitcnt vmcnt(24) lgkmcnt(8)
v_mfma_f32_16x16x32_bf16 v[28:31], a[48:51], a[128:131], v[28:31]
ds_read_b64_tr_b16 a[40:41], v6 offset:37056
v_mfma_f32_16x16x32_bf16 v[32:35], a[48:51], a[132:135], v[32:35]
ds_read_b64_tr_b16 a[42:43], v6 offset:41664
v_mfma_f32_16x16x32_bf16 v[36:39], a[48:51], a[136:139], v[36:39]
s_add_u32 s37, s34, 13312
v_mfma_f32_16x16x32_bf16 v[40:43], a[48:51], a[140:143], v[40:43]
buffer_load_dwordx4 a[112:115], v9, s[20:23], s37 offen sc1
v_mfma_f32_16x16x32_bf16 v[44:47], a[52:55], a[128:131], v[44:47]
ds_read_b64_tr_b16 a[44:45], v6 offset:37088
v_mfma_f32_16x16x32_bf16 v[48:51], a[52:55], a[132:135], v[48:51]
ds_read_b64_tr_b16 a[46:47], v6 offset:41696
v_mfma_f32_16x16x32_bf16 v[52:55], a[52:55], a[136:139], v[52:55]
buffer_load_dwordx4 a[116:119], v10, s[20:23], s37 offen sc1
v_mfma_f32_16x16x32_bf16 v[56:59], a[52:55], a[140:143], v[56:59]
buffer_load_dwordx4 a[120:123], v11, s[20:23], s37 offen sc1
s_waitcnt lgkmcnt(8)
v_mfma_f32_16x16x32_bf16 v[60:63], a[56:59], a[128:131], v[60:63]
ds_read_b64_tr_b16 a[48:49], v6 offset:37120
v_mfma_f32_16x16x32_bf16 v[64:67], a[56:59], a[132:135], v[64:67]
ds_read_b64_tr_b16 a[50:51], v6 offset:41728
v_mfma_f32_16x16x32_bf16 v[68:71], a[56:59], a[136:139], v[68:71]
buffer_load_dwordx4 a[124:127], v12, s[20:23], s37 offen sc1
v_mfma_f32_16x16x32_bf16 v[72:75], a[56:59], a[140:143], v[72:75]
s_add_u32 m0, s33, 129024
v_mfma_f32_16x16x32_bf16 v[76:79], a[60:63], a[128:131], v[76:79]
ds_read_b64_tr_b16 a[52:53], v6 offset:46080
v_mfma_f32_16x16x32_bf16 v[80:83], a[60:63], a[132:135], v[80:83]
ds_read_b64_tr_b16 a[54:55], v6 offset:50688
v_mfma_f32_16x16x32_bf16 v[84:87], a[60:63], a[136:139], v[84:87]
s_add_u32 s36, s32, 4423680
v_mfma_f32_16x16x32_bf16 v[88:91], a[60:63], a[140:143], v[88:91]
buffer_load_dwordx4 v1, s[16:19], s36 offen offset:0 lds
s_waitcnt lgkmcnt(8)
v_mfma_f32_16x16x32_bf16 v[92:95], a[32:35], a[128:131], v[92:95]
ds_read_b64_tr_b16 a[56:57], v6 offset:46112
v_mfma_f32_16x16x32_bf16 v[96:99], a[32:35], a[132:135], v[96:99]
ds_read_b64_tr_b16 a[58:59], v6 offset:50720
v_mfma_f32_16x16x32_bf16 v[100:103], a[32:35], a[136:139], v[100:103]
buffer_load_dwordx4 v2, s[16:19], s36 offen offset:1024 lds
v_mfma_f32_16x16x32_bf16 v[104:107], a[32:35], a[140:143], v[104:107]
buffer_load_dwordx4 v3, s[16:19], s36 offen offset:2048 lds
v_mfma_f32_16x16x32_bf16 v[108:111], a[36:39], a[128:131], v[108:111]
ds_read_b64_tr_b16 a[60:61], v6 offset:46144
v_mfma_f32_16x16x32_bf16 v[112:115], a[36:39], a[132:135], v[112:115]
ds_read_b64_tr_b16 a[62:63], v6 offset:50752
v_mfma_f32_16x16x32_bf16 v[116:119], a[36:39], a[136:139], v[116:119]
buffer_load_dwordx4 v4, s[16:19], s36 offen offset:3072 lds
v_mfma_f32_16x16x32_bf16 v[120:123], a[36:39], a[140:143], v[120:123]
s_add_u32 m0, s35, 129024
s_waitcnt lgkmcnt(8)
v_mfma_f32_16x16x32_bf16 v[124:127], a[40:43], a[128:131], v[124:127]
ds_read_b64_tr_b16 a[32:33], v6 offset:46176
v_mfma_f32_16x16x32_bf16 v[128:131], a[40:43], a[132:135], v[128:131]
ds_read_b64_tr_b16 a[34:35], v6 offset:50784
v_mfma_f32_16x16x32_bf16 v[132:135], a[40:43], a[136:139], v[132:135]
s_mov_b64 exec, s[48:49]
buffer_load_dwordx4 v5, s[16:19], s36 offen lds
s_mov_b64 exec, -1
v_mfma_f32_16x16x32_bf16 v[136:139], a[40:43], a[140:143], v[136:139]
s_waitcnt vmcnt(27)
v_mfma_f32_16x16x32_bf16 v[140:143], a[44:47], a[128:131], v[140:143]
ds_read_b64_tr_b16 a[36:37], v6 offset:46208
v_mfma_f32_16x16x32_bf16 v[144:147], a[44:47], a[132:135], v[144:147]
ds_read_b64_tr_b16 a[38:39], v6 offset:50816
v_mfma_f32_16x16x32_bf16 v[148:151], a[44:47], a[136:139], v[148:151]
v_mfma_f32_16x16x32_bf16 v[152:155], a[44:47], a[140:143], v[152:155]
s_mov_b32 s40, s82
s_mov_b32 s41, s83
s_mov_b32 s42, 4718592
s_mov_b32 s43, 0x20000
s_waitcnt lgkmcnt(8)
v_mfma_f32_16x16x32_bf16 v[156:159], a[48:51], a[128:131], v[156:159]
ds_read_b64_tr_b16 a[40:41], v6 offset:46240
v_mfma_f32_16x16x32_bf16 v[160:163], a[48:51], a[132:135], v[160:163]
ds_read_b64_tr_b16 a[42:43], v6 offset:50848
v_mfma_f32_16x16x32_bf16 v[164:167], a[48:51], a[136:139], v[164:167]
s_lshr_b32 s3, s2, 3
s_lshl_b32 s3, s3, 2
s_add_u32 s3, s3, s28
s_mul_i32 s3, s3, 36
v_mfma_f32_16x16x32_bf16 v[168:171], a[48:51], a[140:143], v[168:171]
v_mfma_f32_16x16x32_bf16 v[172:175], a[52:55], a[128:131], v[172:175]
ds_read_b64_tr_b16 a[44:45], v6 offset:46272
v_mfma_f32_16x16x32_bf16 v[176:179], a[52:55], a[132:135], v[176:179]
ds_read_b64_tr_b16 a[46:47], v6 offset:50880
v_mfma_f32_16x16x32_bf16 v[180:183], a[52:55], a[136:139], v[180:183]
v_add_u32 v22, s3, v0
v_mfma_f32_16x16x32_bf16 v[184:187], a[52:55], a[140:143], v[184:187]
s_mov_b32 s4, 7282
s_waitcnt lgkmcnt(8)
v_mfma_f32_16x16x32_bf16 v[188:191], a[56:59], a[128:131], v[188:191]
ds_read_b64_tr_b16 a[48:49], v6 offset:46304
v_mfma_f32_16x16x32_bf16 v[192:195], a[56:59], a[132:135], v[192:195]
ds_read_b64_tr_b16 a[50:51], v6 offset:50912
v_mfma_f32_16x16x32_bf16 v[196:199], a[56:59], a[136:139], v[196:199]
v_mul_u32_u24 v23, s4, v22
v_mfma_f32_16x16x32_bf16 v[200:203], a[56:59], a[140:143], v[200:203]
v_lshrrev_b32 v23, 16, v23
v_mfma_f32_16x16x32_bf16 v[204:207], a[60:63], a[128:131], v[204:207]
ds_read_b64_tr_b16 a[52:53], v6 offset:46336
v_mfma_f32_16x16x32_bf16 v[208:211], a[60:63], a[132:135], v[208:211]
ds_read_b64_tr_b16 a[54:55], v6 offset:50944
v_mfma_f32_16x16x32_bf16 v[212:215], a[60:63], a[136:139], v[212:215]
v_mul_u32_u24 v19, 9, v23
v_mfma_f32_16x16x32_bf16 v[216:219], a[60:63], a[140:143], v[216:219]
v_sub_u32 v19, v22, v19
s_waitcnt lgkmcnt(8)
v_mfma_f32_16x16x32_bf16 v[220:223], a[32:35], a[128:131], v[220:223]
ds_read_b64_tr_b16 a[56:57], v7 offset:0
v_mfma_f32_16x16x32_bf16 v[224:227], a[32:35], a[132:135], v[224:227]
ds_read_b64_tr_b16 a[58:59], v7 offset:4608
v_mfma_f32_16x16x32_bf16 v[228:231], a[32:35], a[136:139], v[228:231]
s_and_b32 s5, s2, 3
s_lshl_b32 s5, s5, 10
s_and_b32 s6, s2, 4
s_lshl_b32 s6, s6, 7
s_add_u32 s5, s5, s6
s_mov_b32 s6, 0
v_mfma_f32_16x16x32_bf16 v[232:235], a[32:35], a[140:143], v[232:235]
v_add_u32 v23, s5, v23
v_mfma_f32_16x16x32_bf16 v[236:239], a[36:39], a[128:131], v[236:239]
ds_read_b64_tr_b16 a[60:61], v7 offset:32
v_mfma_f32_16x16x32_bf16 v[240:243], a[36:39], a[132:135], v[240:243]
ds_read_b64_tr_b16 a[62:63], v7 offset:4640
v_mfma_f32_16x16x32_bf16 v[244:247], a[36:39], a[136:139], v[244:247]
v_mul_u32_u24 v23, 1152, v23
v_mfma_f32_16x16x32_bf16 v[248:251], a[36:39], a[140:143], v[248:251]
v_lshl_add_u32 v23, v19, 7, v23
s_waitcnt lgkmcnt(8)
v_mfma_f32_16x16x32_bf16 v[252:255], a[40:43], a[128:131], v[252:255]
ds_read_b64_tr_b16 a[32:33], v7 offset:64
v_mfma_f32_16x16x32_bf16 a[0:3], a[40:43], a[132:135], a[0:3]
ds_read_b64_tr_b16 a[34:35], v7 offset:4672
v_mfma_f32_16x16x32_bf16 a[4:7], a[40:43], a[136:139], a[4:7]
v_add_u32 v23, s6, v23
v_mfma_f32_16x16x32_bf16 a[8:11], a[40:43], a[140:143], a[8:11]
v_mov_b32 v19, 0x10000000
v_mfma_f32_16x16x32_bf16 a[12:15], a[44:47], a[128:131], a[12:15]
ds_read_b64_tr_b16 a[36:37], v7 offset:96
v_mfma_f32_16x16x32_bf16 a[16:19], a[44:47], a[132:135], a[16:19]
ds_read_b64_tr_b16 a[38:39], v7 offset:4704
v_mfma_f32_16x16x32_bf16 a[20:23], a[44:47], a[136:139], a[20:23]
v_cmp_gt_u32 vcc, 36, v0
v_mfma_f32_16x16x32_bf16 a[24:27], a[44:47], a[140:143], a[24:27]
s_mov_b32 s4, 4608
v_cmp_gt_u32 s[6:7], s4, v22
s_waitcnt lgkmcnt(8)
v_mfma_f32_16x16x32_bf16 a[28:31], a[48:51], a[128:131], a[28:31]
ds_read_b64_tr_b16 a[40:41], v7 offset:128
v_mfma_f32_16x16x32_bf16 a[64:67], a[48:51], a[132:135], a[64:67]
ds_read_b64_tr_b16 a[42:43], v7 offset:4736
v_mfma_f32_16x16x32_bf16 a[68:71], a[48:51], a[136:139], a[68:71]
s_nop 1
s_and_b64 vcc, vcc, s[6:7]
v_mfma_f32_16x16x32_bf16 a[72:75], a[48:51], a[140:143], a[72:75]
s_nop 1
v_cndmask_b32 v23, v19, v23, vcc
v_mfma_f32_16x16x32_bf16 a[76:79], a[52:55], a[128:131], a[76:79]
ds_read_b64_tr_b16 a[44:45], v7 offset:160
v_mfma_f32_16x16x32_bf16 a[80:83], a[52:55], a[132:135], a[80:83]
ds_read_b64_tr_b16 a[46:47], v7 offset:4768
v_mfma_f32_16x16x32_bf16 a[84:87], a[52:55], a[136:139], a[84:87]
buffer_load_dword v19, v23, s[40:43], 0 offen
v_mfma_f32_16x16x32_bf16 a[88:91], a[52:55], a[140:143], a[88:91]
s_waitcnt vmcnt(24) lgkmcnt(8)
v_mfma_f32_16x16x32_bf16 v[28:31], a[56:59], a[144:147], v[28:31]
ds_read_b64_tr_b16 a[48:49], v7 offset:192
v_mfma_f32_16x16x32_bf16 v[32:35], a[56:59], a[148:151], v[32:35]
ds_read_b64_tr_b16 a[50:51], v7 offset:4800
v_mfma_f32_16x16x32_bf16 v[36:39], a[56:59], a[152:155], v[36:39]
s_add_u32 s37, s34, 14336
v_mfma_f32_16x16x32_bf16 v[40:43], a[56:59], a[156:159], v[40:43]
v_mfma_f32_16x16x32_bf16 v[44:47], a[60:63], a[144:147], v[44:47]
ds_read_b64_tr_b16 a[52:53], v7 offset:224
v_mfma_f32_16x16x32_bf16 v[48:51], a[60:63], a[148:151], v[48:51]
ds_read_b64_tr_b16 a[54:55], v7 offset:4832
v_mfma_f32_16x16x32_bf16 v[52:55], a[60:63], a[152:155], v[52:55]
buffer_load_dwordx4 a[128:131], v9, s[20:23], s37 offen sc1
v_mfma_f32_16x16x32_bf16 v[56:59], a[60:63], a[156:159], v[56:59]
s_waitcnt lgkmcnt(8)
v_mfma_f32_16x16x32_bf16 v[60:63], a[32:35], a[144:147], v[60:63]
ds_read_b64_tr_b16 a[56:57], v7 offset:256
v_mfma_f32_16x16x32_bf16 v[64:67], a[32:35], a[148:151], v[64:67]
ds_read_b64_tr_b16 a[58:59], v7 offset:4864
v_mfma_f32_16x16x32_bf16 v[68:71], a[32:35], a[152:155], v[68:71]
v_mfma_f32_16x16x32_bf16 v[72:75], a[32:35], a[156:159], v[72:75]
buffer_load_dwordx4 a[132:135], v10, s[20:23], s37 offen sc1
v_mfma_f32_16x16x32_bf16 v[76:79], a[36:39], a[144:147], v[76:79]
ds_read_b64_tr_b16 a[60:61], v7 offset:9216
v_mfma_f32_16x16x32_bf16 v[80:83], a[36:39], a[148:151], v[80:83]
ds_read_b64_tr_b16 a[62:63], v7 offset:13824
v_mfma_f32_16x16x32_bf16 v[84:87], a[36:39], a[152:155], v[84:87]
v_mfma_f32_16x16x32_bf16 v[88:91], a[36:39], a[156:159], v[88:91]
buffer_load_dwordx4 a[136:139], v11, s[20:23], s37 offen sc1
s_waitcnt lgkmcnt(8)
v_mfma_f32_16x16x32_bf16 v[92:95], a[40:43], a[144:147], v[92:95]
ds_read_b64_tr_b16 a[32:33], v7 offset:9248
v_mfma_f32_16x16x32_bf16 v[96:99], a[40:43], a[148:151], v[96:99]
ds_read_b64_tr_b16 a[34:35], v7 offset:13856
v_mfma_f32_16x16x32_bf16 v[100:103], a[40:43], a[152:155], v[100:103]
v_mfma_f32_16x16x32_bf16 v[104:107], a[40:43], a[156:159], v[104:107]
v_mfma_f32_16x16x32_bf16 v[108:111], a[44:47], a[144:147], v[108:111]
ds_read_b64_tr_b16 a[36:37], v7 offset:9280
v_mfma_f32_16x16x32_bf16 v[112:115], a[44:47], a[148:151], v[112:115]
ds_read_b64_tr_b16 a[38:39], v7 offset:13888
v_mfma_f32_16x16x32_bf16 v[116:119], a[44:47], a[152:155], v[116:119]
buffer_load_dwordx4 a[140:143], v12, s[20:23], s37 offen sc1
v_mfma_f32_16x16x32_bf16 v[120:123], a[44:47], a[156:159], v[120:123]
s_waitcnt lgkmcnt(8)
v_mfma_f32_16x16x32_bf16 v[124:127], a[48:51], a[144:147], v[124:127]
ds_read_b64_tr_b16 a[40:41], v7 offset:9312
v_mfma_f32_16x16x32_bf16 v[128:131], a[48:51], a[148:151], v[128:131]
ds_read_b64_tr_b16 a[42:43], v7 offset:13920
v_mfma_f32_16x16x32_bf16 v[132:135], a[48:51], a[152:155], v[132:135]
v_mfma_f32_16x16x32_bf16 v[136:139], a[48:51], a[156:159], v[136:139]
s_add_u32 m0, s33, 0
v_mfma_f32_16x16x32_bf16 v[140:143], a[52:55], a[144:147], v[140:143]
ds_read_b64_tr_b16 a[44:45], v7 offset:9344
v_mfma_f32_16x16x32_bf16 v[144:147], a[52:55], a[148:151], v[144:147]
ds_read_b64_tr_b16 a[46:47], v7 offset:13952
v_mfma_f32_16x16x32_bf16 v[148:151], a[52:55], a[152:155], v[148:151]
v_mfma_f32_16x16x32_bf16 v[152:155], a[52:55], a[156:159], v[152:155]
s_add_u32 s36, s32, 4718592
s_waitcnt lgkmcnt(8)
v_mfma_f32_16x16x32_bf16 v[156:159], a[56:59], a[144:147], v[156:159]
ds_read_b64_tr_b16 a[48:49], v7 offset:9376
v_mfma_f32_16x16x32_bf16 v[160:163], a[56:59], a[148:151], v[160:163]
ds_read_b64_tr_b16 a[50:51], v7 offset:13984
v_mfma_f32_16x16x32_bf16 v[164:167], a[56:59], a[152:155], v[164:167]
v_mfma_f32_16x16x32_bf16 v[168:171], a[56:59], a[156:159], v[168:171]
v_mfma_f32_16x16x32_bf16 v[172:175], a[60:63], a[144:147], v[172:175]
ds_read_b64_tr_b16 a[52:53], v7 offset:9408
v_mfma_f32_16x16x32_bf16 v[176:179], a[60:63], a[148:151], v[176:179]
ds_read_b64_tr_b16 a[54:55], v7 offset:14016
v_mfma_f32_16x16x32_bf16 v[180:183], a[60:63], a[152:155], v[180:183]
buffer_load_dwordx4 v1, s[16:19], s36 offen offset:0 lds
v_mfma_f32_16x16x32_bf16 v[184:187], a[60:63], a[156:159], v[184:187]
s_waitcnt lgkmcnt(8)
v_mfma_f32_16x16x32_bf16 v[188:191], a[32:35], a[144:147], v[188:191]
ds_read_b64_tr_b16 a[56:57], v7 offset:9440
v_mfma_f32_16x16x32_bf16 v[192:195], a[32:35], a[148:151], v[192:195]
ds_read_b64_tr_b16 a[58:59], v7 offset:14048
v_mfma_f32_16x16x32_bf16 v[196:199], a[32:35], a[152:155], v[196:199]
buffer_load_dwordx4 v2, s[16:19], s36 offen offset:1024 lds
v_mfma_f32_16x16x32_bf16 v[200:203], a[32:35], a[156:159], v[200:203]
v_mfma_f32_16x16x32_bf16 v[204:207], a[36:39], a[144:147], v[204:207]
ds_read_b64_tr_b16 a[60:61], v7 offset:9472
v_mfma_f32_16x16x32_bf16 v[208:211], a[36:39], a[148:151], v[208:211]
ds_read_b64_tr_b16 a[62:63], v7 offset:14080
v_mfma_f32_16x16x32_bf16 v[212:215], a[36:39], a[152:155], v[212:215]
s_waitcnt vmcnt(25)
v_mfma_f32_16x16x32_bf16 v[216:219], a[36:39], a[156:159], v[216:219]
s_barrier
s_waitcnt lgkmcnt(8)
v_mfma_f32_16x16x32_bf16 v[220:223], a[40:43], a[144:147], v[220:223]
ds_read_b64_tr_b16 a[32:33], v7 offset:18432
v_mfma_f32_16x16x32_bf16 v[224:227], a[40:43], a[148:151], v[224:227]
ds_read_b64_tr_b16 a[34:35], v7 offset:23040
v_mfma_f32_16x16x32_bf16 v[228:231], a[40:43], a[152:155], v[228:231]
v_mfma_f32_16x16x32_bf16 v[232:235], a[40:43], a[156:159], v[232:235]
buffer_load_dwordx4 v3, s[16:19], s36 offen offset:2048 lds
v_mfma_f32_16x16x32_bf16 v[236:239], a[44:47], a[144:147], v[236:239]
ds_read_b64_tr_b16 a[36:37], v7 offset:18464
v_mfma_f32_16x16x32_bf16 v[240:243], a[44:47], a[148:151], v[240:243]
ds_read_b64_tr_b16 a[38:39], v7 offset:23072
v_mfma_f32_16x16x32_bf16 v[244:247], a[44:47], a[152:155], v[244:247]
v_mfma_f32_16x16x32_bf16 v[248:251], a[44:47], a[156:159], v[248:251]
s_waitcnt lgkmcnt(8)
v_mfma_f32_16x16x32_bf16 v[252:255], a[48:51], a[144:147], v[252:255]
ds_read_b64_tr_b16 a[40:41], v7 offset:18496
v_mfma_f32_16x16x32_bf16 a[0:3], a[48:51], a[148:151], a[0:3]
ds_read_b64_tr_b16 a[42:43], v7 offset:23104
v_mfma_f32_16x16x32_bf16 a[4:7], a[48:51], a[152:155], a[4:7]
buffer_load_dwordx4 v4, s[16:19], s36 offen offset:3072 lds
v_mfma_f32_16x16x32_bf16 a[8:11], a[48:51], a[156:159], a[8:11]
v_mfma_f32_16x16x32_bf16 a[12:15], a[52:55], a[144:147], a[12:15]
ds_read_b64_tr_b16 a[44:45], v7 offset:18528
v_mfma_f32_16x16x32_bf16 a[16:19], a[52:55], a[148:151], a[16:19]
ds_read_b64_tr_b16 a[46:47], v7 offset:23136
v_mfma_f32_16x16x32_bf16 a[20:23], a[52:55], a[152:155], a[20:23]
s_add_u32 m0, s35, 0
v_mfma_f32_16x16x32_bf16 a[24:27], a[52:55], a[156:159], a[24:27]
s_waitcnt lgkmcnt(8)
v_mfma_f32_16x16x32_bf16 a[28:31], a[56:59], a[144:147], a[28:31]
ds_read_b64_tr_b16 a[48:49], v7 offset:18560
v_mfma_f32_16x16x32_bf16 a[64:67], a[56:59], a[148:151], a[64:67]
ds_read_b64_tr_b16 a[50:51], v7 offset:23168
v_mfma_f32_16x16x32_bf16 a[68:71], a[56:59], a[152:155], a[68:71]
v_mfma_f32_16x16x32_bf16 a[72:75], a[56:59], a[156:159], a[72:75]
s_mov_b64 exec, s[48:49]
buffer_load_dwordx4 v5, s[16:19], s36 offen lds
s_mov_b64 exec, -1
v_mfma_f32_16x16x32_bf16 a[76:79], a[60:63], a[144:147], a[76:79]
ds_read_b64_tr_b16 a[52:53], v7 offset:18592
v_mfma_f32_16x16x32_bf16 a[80:83], a[60:63], a[148:151], a[80:83]
ds_read_b64_tr_b16 a[54:55], v7 offset:23200
v_mfma_f32_16x16x32_bf16 a[84:87], a[60:63], a[152:155], a[84:87]
v_mfma_f32_16x16x32_bf16 a[88:91], a[60:63], a[156:159], a[88:91]
s_waitcnt vmcnt(24) lgkmcnt(8)
v_mfma_f32_16x16x32_bf16 v[28:31], a[32:35], a[96:99], v[28:31]
ds_read_b64_tr_b16 a[56:57], v7 offset:18624
v_mfma_f32_16x16x32_bf16 v[32:35], a[32:35], a[100:103], v[32:35]
ds_read_b64_tr_b16 a[58:59], v7 offset:23232
v_mfma_f32_16x16x32_bf16 v[36:39], a[32:35], a[104:107], v[36:39]
s_add_u32 s37, s34, 15360
v_mfma_f32_16x16x32_bf16 v[40:43], a[32:35], a[108:111], v[40:43]
v_mfma_f32_16x16x32_bf16 v[44:47], a[36:39], a[96:99], v[44:47]
ds_read_b64_tr_b16 a[60:61], v7 offset:18656
v_mfma_f32_16x16x32_bf16 v[48:51], a[36:39], a[100:103], v[48:51]
ds_read_b64_tr_b16 a[62:63], v7 offset:23264
v_mfma_f32_16x16x32_bf16 v[52:55], a[36:39], a[104:107], v[52:55]
buffer_load_dwordx4 a[144:147], v9, s[20:23], s37 offen sc1
v_mfma_f32_16x16x32_bf16 v[56:59], a[36:39], a[108:111], v[56:59]
s_waitcnt lgkmcnt(8)
v_mfma_f32_16x16x32_bf16 v[60:63], a[40:43], a[96:99], v[60:63]
ds_read_b64_tr_b16 a[32:33], v7 offset:18688
v_mfma_f32_16x16x32_bf16 v[64:67], a[40:43], a[100:103], v[64:67]
ds_read_b64_tr_b16 a[34:35], v7 offset:23296
v_mfma_f32_16x16x32_bf16 v[68:71], a[40:43], a[104:107], v[68:71]
buffer_load_dwordx4 a[148:151], v10, s[20:23], s37 offen sc1
v_mfma_f32_16x16x32_bf16 v[72:75], a[40:43], a[108:111], v[72:75]
v_mfma_f32_16x16x32_bf16 v[76:79], a[44:47], a[96:99], v[76:79]
ds_read_b64_tr_b16 a[36:37], v7 offset:27648
v_mfma_f32_16x16x32_bf16 v[80:83], a[44:47], a[100:103], v[80:83]
ds_read_b64_tr_b16 a[38:39], v7 offset:32256
v_mfma_f32_16x16x32_bf16 v[84:87], a[44:47], a[104:107], v[84:87]
v_mfma_f32_16x16x32_bf16 v[88:91], a[44:47], a[108:111], v[88:91]
buffer_load_dwordx4 a[152:155], v11, s[20:23], s37 offen sc1
s_waitcnt lgkmcnt(8)
v_mfma_f32_16x16x32_bf16 v[92:95], a[48:51], a[96:99], v[92:95]
ds_read_b64_tr_b16 a[40:41], v7 offset:27680
v_mfma_f32_16x16x32_bf16 v[96:99], a[48:51], a[100:103], v[96:99]
ds_read_b64_tr_b16 a[42:43], v7 offset:32288
v_mfma_f32_16x16x32_bf16 v[100:103], a[48:51], a[104:107], v[100:103]
v_mfma_f32_16x16x32_bf16 v[104:107], a[48:51], a[108:111], v[104:107]
buffer_load_dwordx4 a[156:159], v12, s[20:23], s37 offen sc1
v_mfma_f32_16x16x32_bf16 v[108:111], a[52:55], a[96:99], v[108:111]
ds_read_b64_tr_b16 a[44:45], v7 offset:27712
v_mfma_f32_16x16x32_bf16 v[112:115], a[52:55], a[100:103], v[112:115]
ds_read_b64_tr_b16 a[46:47], v7 offset:32320
v_mfma_f32_16x16x32_bf16 v[116:119], a[52:55], a[104:107], v[116:119]
v_mfma_f32_16x16x32_bf16 v[120:123], a[52:55], a[108:111], v[120:123]
s_waitcnt lgkmcnt(8)
v_mfma_f32_16x16x32_bf16 v[124:127], a[56:59], a[96:99], v[124:127]
ds_read_b64_tr_b16 a[48:49], v7 offset:27744
v_mfma_f32_16x16x32_bf16 v[128:131], a[56:59], a[100:103], v[128:131]
ds_read_b64_tr_b16 a[50:51], v7 offset:32352
v_mfma_f32_16x16x32_bf16 v[132:135], a[56:59], a[104:107], v[132:135]
s_add_u32 m0, s33, 18432
v_mfma_f32_16x16x32_bf16 v[136:139], a[56:59], a[108:111], v[136:139]
v_mfma_f32_16x16x32_bf16 v[140:143], a[60:63], a[96:99], v[140:143]
ds_read_b64_tr_b16 a[52:53], v7 offset:27776
v_mfma_f32_16x16x32_bf16 v[144:147], a[60:63], a[100:103], v[144:147]
ds_read_b64_tr_b16 a[54:55], v7 offset:32384
v_mfma_f32_16x16x32_bf16 v[148:151], a[60:63], a[104:107], v[148:151]
s_add_u32 s36, s32, 5013504
v_mfma_f32_16x16x32_bf16 v[152:155], a[60:63], a[108:111], v[152:155]
s_waitcnt lgkmcnt(8)
v_mfma_f32_16x16x32_bf16 v[156:159], a[32:35], a[96:99], v[156:159]
ds_read_b64_tr_b16 a[56:57], v7 offset:27808
v_mfma_f32_16x16x32_bf16 v[160:163], a[32:35], a[100:103], v[160:163]
ds_read_b64_tr_b16 a[58:59], v7 offset:32416
v_mfma_f32_16x16x32_bf16 v[164:167], a[32:35], a[104:107], v[164:167]
buffer_load_dwordx4 v1, s[16:19], s36 offen offset:0 lds
v_mfma_f32_16x16x32_bf16 v[168:171], a[32:35], a[108:111], v[168:171]
v_mfma_f32_16x16x32_bf16 v[172:175], a[36:39], a[96:99], v[172:175]
ds_read_b64_tr_b16 a[60:61], v7 offset:27840
v_mfma_f32_16x16x32_bf16 v[176:179], a[36:39], a[100:103], v[176:179]
ds_read_b64_tr_b16 a[62:63], v7 offset:32448
v_mfma_f32_16x16x32_bf16 v[180:183], a[36:39], a[104:107], v[180:183]
v_mfma_f32_16x16x32_bf16 v[184:187], a[36:39], a[108:111], v[184:187]
buffer_load_dwordx4 v2, s[16:19], s36 offen offset:1024 lds
s_waitcnt lgkmcnt(8)
v_mfma_f32_16x16x32_bf16 v[188:191], a[40:43], a[96:99], v[188:191]
ds_read_b64_tr_b16 a[32:33], v7 offset:27872
v_mfma_f32_16x16x32_bf16 v[192:195], a[40:43], a[100:103], v[192:195]
ds_read_b64_tr_b16 a[34:35], v7 offset:32480
v_mfma_f32_16x16x32_bf16 v[196:199], a[40:43], a[104:107], v[196:199]
v_mfma_f32_16x16x32_bf16 v[200:203], a[40:43], a[108:111], v[200:203]
buffer_load_dwordx4 v3, s[16:19], s36 offen offset:2048 lds
v_mfma_f32_16x16x32_bf16 v[204:207], a[44:47], a[96:99], v[204:207]
ds_read_b64_tr_b16 a[36:37], v7 offset:27904
v_mfma_f32_16x16x32_bf16 v[208:211], a[44:47], a[100:103], v[208:211]
ds_read_b64_tr_b16 a[38:39], v7 offset:32512
v_mfma_f32_16x16x32_bf16 v[212:215], a[44:47], a[104:107], v[212:215]
v_mfma_f32_16x16x32_bf16 v[216:219], a[44:47], a[108:111], v[216:219]
s_waitcnt lgkmcnt(8)
v_mfma_f32_16x16x32_bf16 v[220:223], a[48:51], a[96:99], v[220:223]
ds_read_b64_tr_b16 a[40:41], v7 offset:36864
v_mfma_f32_16x16x32_bf16 v[224:227], a[48:51], a[100:103], v[224:227]
ds_read_b64_tr_b16 a[42:43], v7 offset:41472
v_mfma_f32_16x16x32_bf16 v[228:231], a[48:51], a[104:107], v[228:231]
buffer_load_dwordx4 v4, s[16:19], s36 offen offset:3072 lds
v_mfma_f32_16x16x32_bf16 v[232:235], a[48:51], a[108:111], v[232:235]
v_mfma_f32_16x16x32_bf16 v[236:239], a[52:55], a[96:99], v[236:239]
ds_read_b64_tr_b16 a[44:45], v7 offset:36896
v_mfma_f32_16x16x32_bf16 v[240:243], a[52:55], a[100:103], v[240:243]
ds_read_b64_tr_b16 a[46:47], v7 offset:41504
v_mfma_f32_16x16x32_bf16 v[244:247], a[52:55], a[104:107], v[244:247]
s_add_u32 m0, s35, 18432
v_mfma_f32_16x16x32_bf16 v[248:251], a[52:55], a[108:111], v[248:251]
s_waitcnt lgkmcnt(8)
v_mfma_f32_16x16x32_bf16 v[252:255], a[56:59], a[96:99], v[252:255]
ds_read_b64_tr_b16 a[48:49], v7 offset:36928
v_mfma_f32_16x16x32_bf16 a[0:3], a[56:59], a[100:103], a[0:3]
ds_read_b64_tr_b16 a[50:51], v7 offset:41536
v_mfma_f32_16x16x32_bf16 a[4:7], a[56:59], a[104:107], a[4:7]
s_mov_b64 exec, s[48:49]
buffer_load_dwordx4 v5, s[16:19], s36 offen lds
s_mov_b64 exec, -1
v_mfma_f32_16x16x32_bf16 a[8:11], a[56:59], a[108:111], a[8:11]
v_mfma_f32_16x16x32_bf16 a[12:15], a[60:63], a[96:99], a[12:15]
ds_read_b64_tr_b16 a[52:53], v7 offset:36960
v_mfma_f32_16x16x32_bf16 a[16:19], a[60:63], a[100:103], a[16:19]
ds_read_b64_tr_b16 a[54:55], v7 offset:41568
v_mfma_f32_16x16x32_bf16 a[20:23], a[60:63], a[104:107], a[20:23]
v_mfma_f32_16x16x32_bf16 a[24:27], a[60:63], a[108:111], a[24:27]
s_lshl_b32 s68, s29, 7
s_mov_b32 s69, s30
s_lshl_b32 s69, s69, 2
s_add_u32 s68, s68, s69
s_add_u32 s68, s68, 113249280
s_cmp_eq_u32 s28, 0
s_cselect_b32 s68, s68, 0x10000000
v_mov_b32 v16, 1
s_mov_b64 exec, 1
buffer_store_dword v16, off, s[20:23], s68 sc1
s_mov_b64 exec, -1
s_nop 1
s_waitcnt lgkmcnt(8)
v_mfma_f32_16x16x32_bf16 a[28:31], a[32:35], a[96:99], a[28:31]
ds_read_b64_tr_b16 a[56:57], v7 offset:36992
v_mfma_f32_16x16x32_bf16 a[64:67], a[32:35], a[100:103], a[64:67]
ds_read_b64_tr_b16 a[58:59], v7 offset:41600
v_mfma_f32_16x16x32_bf16 a[68:71], a[32:35], a[104:107], a[68:71]
v_mfma_f32_16x16x32_bf16 a[72:75], a[32:35], a[108:111], a[72:75]
s_getpc_b64 s[4:5]
parallel_sum__compressed_kv_cla__geglu_ffn__prompt_kernel_pc5:
s_add_u32 s4, s4, parallel_sum__compressed_kv_cla__geglu_ffn__prompt_kernel_L_ge-parallel_sum__compressed_kv_cla__geglu_ffn__prompt_kernel_pc5
s_addc_u32 s5, s5, 0
s_lshr_b32 s3, s2, 3
s_lshl_b32 s3, s3, 2
s_add_u32 s3, s3, s28
s_mul_i32 s3, s3, 3
v_add_u32 v24, s3, v0
v_lshlrev_b32 v24, 7, v24
v_mov_b32 v25, parallel_sum__compressed_kv_cla__geglu_ffn__prompt_kernel_L_fin-parallel_sum__compressed_kv_cla__geglu_ffn__prompt_kernel_L_ge
v_cmp_lt_u32 vcc, v24, v25
s_nop 1
v_cndmask_b32 v24, 0, v24, vcc
v_mov_b32 v25, s5
v_add_co_u32 v24, vcc, s4, v24
s_nop 1
v_addc_co_u32 v25, vcc, 0, v25, vcc
s_mov_b64 exec, 7
global_load_dword v18, v[24:25], off
s_mov_b64 exec, -1
v_mfma_f32_16x16x32_bf16 a[76:79], a[36:39], a[96:99], a[76:79]
ds_read_b64_tr_b16 a[60:61], v7 offset:37024
v_mfma_f32_16x16x32_bf16 a[80:83], a[36:39], a[100:103], a[80:83]
ds_read_b64_tr_b16 a[62:63], v7 offset:41632
v_mfma_f32_16x16x32_bf16 a[84:87], a[36:39], a[104:107], a[84:87]
v_mfma_f32_16x16x32_bf16 a[88:91], a[36:39], a[108:111], a[88:91]
s_waitcnt vmcnt(26) lgkmcnt(8)
v_mfma_f32_16x16x32_bf16 v[28:31], a[40:43], a[112:115], v[28:31]
ds_read_b64_tr_b16 a[32:33], v7 offset:37056
v_mfma_f32_16x16x32_bf16 v[32:35], a[40:43], a[116:119], v[32:35]
ds_read_b64_tr_b16 a[34:35], v7 offset:41664
v_mfma_f32_16x16x32_bf16 v[36:39], a[40:43], a[120:123], v[36:39]
s_add_u32 s37, s34, 16384
v_mfma_f32_16x16x32_bf16 v[40:43], a[40:43], a[124:127], v[40:43]
v_mfma_f32_16x16x32_bf16 v[44:47], a[44:47], a[112:115], v[44:47]
ds_read_b64_tr_b16 a[36:37], v7 offset:37088
v_mfma_f32_16x16x32_bf16 v[48:51], a[44:47], a[116:119], v[48:51]
ds_read_b64_tr_b16 a[38:39], v7 offset:41696
v_mfma_f32_16x16x32_bf16 v[52:55], a[44:47], a[120:123], v[52:55]
v_mfma_f32_16x16x32_bf16 v[56:59], a[44:47], a[124:127], v[56:59]
s_waitcnt lgkmcnt(8)
v_mfma_f32_16x16x32_bf16 v[60:63], a[48:51], a[112:115], v[60:63]
ds_read_b64_tr_b16 a[40:41], v7 offset:37120
v_mfma_f32_16x16x32_bf16 v[64:67], a[48:51], a[116:119], v[64:67]
ds_read_b64_tr_b16 a[42:43], v7 offset:41728
v_mfma_f32_16x16x32_bf16 v[68:71], a[48:51], a[120:123], v[68:71]
v_mfma_f32_16x16x32_bf16 v[72:75], a[48:51], a[124:127], v[72:75]
v_mfma_f32_16x16x32_bf16 v[76:79], a[52:55], a[112:115], v[76:79]
ds_read_b64_tr_b16 a[44:45], v7 offset:46080
v_mfma_f32_16x16x32_bf16 v[80:83], a[52:55], a[116:119], v[80:83]
ds_read_b64_tr_b16 a[46:47], v7 offset:50688
v_mfma_f32_16x16x32_bf16 v[84:87], a[52:55], a[120:123], v[84:87]
buffer_load_dwordx4 a[96:99], v9, s[20:23], s37 offen sc1
v_mfma_f32_16x16x32_bf16 v[88:91], a[52:55], a[124:127], v[88:91]
s_waitcnt lgkmcnt(8)
v_mfma_f32_16x16x32_bf16 v[92:95], a[56:59], a[112:115], v[92:95]
ds_read_b64_tr_b16 a[48:49], v7 offset:46112
v_mfma_f32_16x16x32_bf16 v[96:99], a[56:59], a[116:119], v[96:99]
ds_read_b64_tr_b16 a[50:51], v7 offset:50720
v_mfma_f32_16x16x32_bf16 v[100:103], a[56:59], a[120:123], v[100:103]
v_mfma_f32_16x16x32_bf16 v[104:107], a[56:59], a[124:127], v[104:107]
v_mfma_f32_16x16x32_bf16 v[108:111], a[60:63], a[112:115], v[108:111]
ds_read_b64_tr_b16 a[52:53], v7 offset:46144
v_mfma_f32_16x16x32_bf16 v[112:115], a[60:63], a[116:119], v[112:115]
ds_read_b64_tr_b16 a[54:55], v7 offset:50752
v_mfma_f32_16x16x32_bf16 v[116:119], a[60:63], a[120:123], v[116:119]
v_mfma_f32_16x16x32_bf16 v[120:123], a[60:63], a[124:127], v[120:123]
s_waitcnt lgkmcnt(8)
v_mfma_f32_16x16x32_bf16 v[124:127], a[32:35], a[112:115], v[124:127]
ds_read_b64_tr_b16 a[56:57], v7 offset:46176
v_mfma_f32_16x16x32_bf16 v[128:131], a[32:35], a[116:119], v[128:131]
ds_read_b64_tr_b16 a[58:59], v7 offset:50784
v_mfma_f32_16x16x32_bf16 v[132:135], a[32:35], a[120:123], v[132:135]
v_mfma_f32_16x16x32_bf16 v[136:139], a[32:35], a[124:127], v[136:139]
buffer_load_dwordx4 a[100:103], v10, s[20:23], s37 offen sc1
v_mfma_f32_16x16x32_bf16 v[140:143], a[36:39], a[112:115], v[140:143]
ds_read_b64_tr_b16 a[60:61], v7 offset:46208
v_mfma_f32_16x16x32_bf16 v[144:147], a[36:39], a[116:119], v[144:147]
ds_read_b64_tr_b16 a[62:63], v7 offset:50816
v_mfma_f32_16x16x32_bf16 v[148:151], a[36:39], a[120:123], v[148:151]
v_mfma_f32_16x16x32_bf16 v[152:155], a[36:39], a[124:127], v[152:155]
s_waitcnt lgkmcnt(8)
v_mfma_f32_16x16x32_bf16 v[156:159], a[40:43], a[112:115], v[156:159]
ds_read_b64_tr_b16 a[32:33], v7 offset:46240
v_mfma_f32_16x16x32_bf16 v[160:163], a[40:43], a[116:119], v[160:163]
ds_read_b64_tr_b16 a[34:35], v7 offset:50848
v_mfma_f32_16x16x32_bf16 v[164:167], a[40:43], a[120:123], v[164:167]
v_mfma_f32_16x16x32_bf16 v[168:171], a[40:43], a[124:127], v[168:171]
v_mfma_f32_16x16x32_bf16 v[172:175], a[44:47], a[112:115], v[172:175]
ds_read_b64_tr_b16 a[36:37], v7 offset:46272
v_mfma_f32_16x16x32_bf16 v[176:179], a[44:47], a[116:119], v[176:179]
ds_read_b64_tr_b16 a[38:39], v7 offset:50880
v_mfma_f32_16x16x32_bf16 v[180:183], a[44:47], a[120:123], v[180:183]
v_mfma_f32_16x16x32_bf16 v[184:187], a[44:47], a[124:127], v[184:187]
s_waitcnt lgkmcnt(8)
v_mfma_f32_16x16x32_bf16 v[188:191], a[48:51], a[112:115], v[188:191]
ds_read_b64_tr_b16 a[40:41], v7 offset:46304
v_mfma_f32_16x16x32_bf16 v[192:195], a[48:51], a[116:119], v[192:195]
ds_read_b64_tr_b16 a[42:43], v7 offset:50912
v_mfma_f32_16x16x32_bf16 v[196:199], a[48:51], a[120:123], v[196:199]
buffer_load_dwordx4 a[104:107], v11, s[20:23], s37 offen sc1
v_mfma_f32_16x16x32_bf16 v[200:203], a[48:51], a[124:127], v[200:203]
v_mfma_f32_16x16x32_bf16 v[204:207], a[52:55], a[112:115], v[204:207]
ds_read_b64_tr_b16 a[44:45], v7 offset:46336
v_mfma_f32_16x16x32_bf16 v[208:211], a[52:55], a[116:119], v[208:211]
ds_read_b64_tr_b16 a[46:47], v7 offset:50944
v_mfma_f32_16x16x32_bf16 v[212:215], a[52:55], a[120:123], v[212:215]
s_waitcnt vmcnt(24)
v_mfma_f32_16x16x32_bf16 v[216:219], a[52:55], a[124:127], v[216:219]
s_barrier
s_waitcnt lgkmcnt(8)
v_mfma_f32_16x16x32_bf16 v[220:223], a[56:59], a[112:115], v[220:223]
ds_read_b64_tr_b16 a[48:49], v8 offset:0
v_mfma_f32_16x16x32_bf16 v[224:227], a[56:59], a[116:119], v[224:227]
ds_read_b64_tr_b16 a[50:51], v8 offset:4608
v_mfma_f32_16x16x32_bf16 v[228:231], a[56:59], a[120:123], v[228:231]
v_mfma_f32_16x16x32_bf16 v[232:235], a[56:59], a[124:127], v[232:235]
v_mfma_f32_16x16x32_bf16 v[236:239], a[60:63], a[112:115], v[236:239]
ds_read_b64_tr_b16 a[52:53], v8 offset:32
v_mfma_f32_16x16x32_bf16 v[240:243], a[60:63], a[116:119], v[240:243]
ds_read_b64_tr_b16 a[54:55], v8 offset:4640
v_mfma_f32_16x16x32_bf16 v[244:247], a[60:63], a[120:123], v[244:247]
v_mfma_f32_16x16x32_bf16 v[248:251], a[60:63], a[124:127], v[248:251]
s_waitcnt lgkmcnt(8)
v_mfma_f32_16x16x32_bf16 v[252:255], a[32:35], a[112:115], v[252:255]
ds_read_b64_tr_b16 a[56:57], v8 offset:64
v_mfma_f32_16x16x32_bf16 a[0:3], a[32:35], a[116:119], a[0:3]
ds_read_b64_tr_b16 a[58:59], v8 offset:4672
v_mfma_f32_16x16x32_bf16 a[4:7], a[32:35], a[120:123], a[4:7]
v_mfma_f32_16x16x32_bf16 a[8:11], a[32:35], a[124:127], a[8:11]
buffer_load_dwordx4 a[108:111], v12, s[20:23], s37 offen sc1
v_mfma_f32_16x16x32_bf16 a[12:15], a[36:39], a[112:115], a[12:15]
ds_read_b64_tr_b16 a[60:61], v8 offset:96
v_mfma_f32_16x16x32_bf16 a[16:19], a[36:39], a[116:119], a[16:19]
ds_read_b64_tr_b16 a[62:63], v8 offset:4704
v_mfma_f32_16x16x32_bf16 a[20:23], a[36:39], a[120:123], a[20:23]
v_mfma_f32_16x16x32_bf16 a[24:27], a[36:39], a[124:127], a[24:27]
s_waitcnt lgkmcnt(8)
v_mfma_f32_16x16x32_bf16 a[28:31], a[40:43], a[112:115], a[28:31]
ds_read_b64_tr_b16 a[32:33], v8 offset:128
v_mfma_f32_16x16x32_bf16 a[64:67], a[40:43], a[116:119], a[64:67]
ds_read_b64_tr_b16 a[34:35], v8 offset:4736
v_mfma_f32_16x16x32_bf16 a[68:71], a[40:43], a[120:123], a[68:71]
v_mfma_f32_16x16x32_bf16 a[72:75], a[40:43], a[124:127], a[72:75]
v_mfma_f32_16x16x32_bf16 a[76:79], a[44:47], a[112:115], a[76:79]
ds_read_b64_tr_b16 a[36:37], v8 offset:160
v_mfma_f32_16x16x32_bf16 a[80:83], a[44:47], a[116:119], a[80:83]
ds_read_b64_tr_b16 a[38:39], v8 offset:4768
v_mfma_f32_16x16x32_bf16 a[84:87], a[44:47], a[120:123], a[84:87]
v_mfma_f32_16x16x32_bf16 a[88:91], a[44:47], a[124:127], a[88:91]
s_waitcnt vmcnt(20) lgkmcnt(8)
v_mfma_f32_16x16x32_bf16 v[28:31], a[48:51], a[128:131], v[28:31]
ds_read_b64_tr_b16 a[40:41], v8 offset:192
v_mfma_f32_16x16x32_bf16 v[32:35], a[48:51], a[132:135], v[32:35]
ds_read_b64_tr_b16 a[42:43], v8 offset:4800
v_mfma_f32_16x16x32_bf16 v[36:39], a[48:51], a[136:139], v[36:39]
s_add_u32 s37, s34, 17408
v_mfma_f32_16x16x32_bf16 v[40:43], a[48:51], a[140:143], v[40:43]
v_mfma_f32_16x16x32_bf16 v[44:47], a[52:55], a[128:131], v[44:47]
ds_read_b64_tr_b16 a[44:45], v8 offset:224
v_mfma_f32_16x16x32_bf16 v[48:51], a[52:55], a[132:135], v[48:51]
ds_read_b64_tr_b16 a[46:47], v8 offset:4832
v_mfma_f32_16x16x32_bf16 v[52:55], a[52:55], a[136:139], v[52:55]
v_mfma_f32_16x16x32_bf16 v[56:59], a[52:55], a[140:143], v[56:59]
s_waitcnt lgkmcnt(8)
v_mfma_f32_16x16x32_bf16 v[60:63], a[56:59], a[128:131], v[60:63]
ds_read_b64_tr_b16 a[48:49], v8 offset:256
v_mfma_f32_16x16x32_bf16 v[64:67], a[56:59], a[132:135], v[64:67]
ds_read_b64_tr_b16 a[50:51], v8 offset:4864
v_mfma_f32_16x16x32_bf16 v[68:71], a[56:59], a[136:139], v[68:71]
v_mfma_f32_16x16x32_bf16 v[72:75], a[56:59], a[140:143], v[72:75]
v_mfma_f32_16x16x32_bf16 v[76:79], a[60:63], a[128:131], v[76:79]
ds_read_b64_tr_b16 a[52:53], v8 offset:9216
v_mfma_f32_16x16x32_bf16 v[80:83], a[60:63], a[132:135], v[80:83]
ds_read_b64_tr_b16 a[54:55], v8 offset:13824
v_mfma_f32_16x16x32_bf16 v[84:87], a[60:63], a[136:139], v[84:87]
v_mfma_f32_16x16x32_bf16 v[88:91], a[60:63], a[140:143], v[88:91]
buffer_load_dwordx4 a[112:115], v9, s[20:23], s37 offen sc1
s_waitcnt lgkmcnt(8)
v_mfma_f32_16x16x32_bf16 v[92:95], a[32:35], a[128:131], v[92:95]
ds_read_b64_tr_b16 a[56:57], v8 offset:9248
v_mfma_f32_16x16x32_bf16 v[96:99], a[32:35], a[132:135], v[96:99]
ds_read_b64_tr_b16 a[58:59], v8 offset:13856
v_mfma_f32_16x16x32_bf16 v[100:103], a[32:35], a[136:139], v[100:103]
v_mfma_f32_16x16x32_bf16 v[104:107], a[32:35], a[140:143], v[104:107]
v_mfma_f32_16x16x32_bf16 v[108:111], a[36:39], a[128:131], v[108:111]
ds_read_b64_tr_b16 a[60:61], v8 offset:9280
v_mfma_f32_16x16x32_bf16 v[112:115], a[36:39], a[132:135], v[112:115]
ds_read_b64_tr_b16 a[62:63], v8 offset:13888
v_mfma_f32_16x16x32_bf16 v[116:119], a[36:39], a[136:139], v[116:119]
v_mfma_f32_16x16x32_bf16 v[120:123], a[36:39], a[140:143], v[120:123]
s_waitcnt lgkmcnt(8)
v_mfma_f32_16x16x32_bf16 v[124:127], a[40:43], a[128:131], v[124:127]
ds_read_b64_tr_b16 a[32:33], v8 offset:9312
v_mfma_f32_16x16x32_bf16 v[128:131], a[40:43], a[132:135], v[128:131]
ds_read_b64_tr_b16 a[34:35], v8 offset:13920
v_mfma_f32_16x16x32_bf16 v[132:135], a[40:43], a[136:139], v[132:135]
v_mfma_f32_16x16x32_bf16 v[136:139], a[40:43], a[140:143], v[136:139]
v_mfma_f32_16x16x32_bf16 v[140:143], a[44:47], a[128:131], v[140:143]
ds_read_b64_tr_b16 a[36:37], v8 offset:9344
v_mfma_f32_16x16x32_bf16 v[144:147], a[44:47], a[132:135], v[144:147]
ds_read_b64_tr_b16 a[38:39], v8 offset:13952
v_mfma_f32_16x16x32_bf16 v[148:151], a[44:47], a[136:139], v[148:151]
buffer_load_dwordx4 a[116:119], v10, s[20:23], s37 offen sc1
v_mfma_f32_16x16x32_bf16 v[152:155], a[44:47], a[140:143], v[152:155]
s_waitcnt lgkmcnt(8)
v_mfma_f32_16x16x32_bf16 v[156:159], a[48:51], a[128:131], v[156:159]
ds_read_b64_tr_b16 a[40:41], v8 offset:9376
v_mfma_f32_16x16x32_bf16 v[160:163], a[48:51], a[132:135], v[160:163]
ds_read_b64_tr_b16 a[42:43], v8 offset:13984
v_mfma_f32_16x16x32_bf16 v[164:167], a[48:51], a[136:139], v[164:167]
v_mfma_f32_16x16x32_bf16 v[168:171], a[48:51], a[140:143], v[168:171]
v_mfma_f32_16x16x32_bf16 v[172:175], a[52:55], a[128:131], v[172:175]
ds_read_b64_tr_b16 a[44:45], v8 offset:9408
v_mfma_f32_16x16x32_bf16 v[176:179], a[52:55], a[132:135], v[176:179]
ds_read_b64_tr_b16 a[46:47], v8 offset:14016
v_mfma_f32_16x16x32_bf16 v[180:183], a[52:55], a[136:139], v[180:183]
v_mfma_f32_16x16x32_bf16 v[184:187], a[52:55], a[140:143], v[184:187]
s_waitcnt lgkmcnt(8)
v_mfma_f32_16x16x32_bf16 v[188:191], a[56:59], a[128:131], v[188:191]
ds_read_b64_tr_b16 a[48:49], v8 offset:9440
v_mfma_f32_16x16x32_bf16 v[192:195], a[56:59], a[132:135], v[192:195]
ds_read_b64_tr_b16 a[50:51], v8 offset:14048
v_mfma_f32_16x16x32_bf16 v[196:199], a[56:59], a[136:139], v[196:199]
v_mfma_f32_16x16x32_bf16 v[200:203], a[56:59], a[140:143], v[200:203]
buffer_load_dwordx4 a[120:123], v11, s[20:23], s37 offen sc1
v_mfma_f32_16x16x32_bf16 v[204:207], a[60:63], a[128:131], v[204:207]
ds_read_b64_tr_b16 a[52:53], v8 offset:9472
v_mfma_f32_16x16x32_bf16 v[208:211], a[60:63], a[132:135], v[208:211]
ds_read_b64_tr_b16 a[54:55], v8 offset:14080
v_mfma_f32_16x16x32_bf16 v[212:215], a[60:63], a[136:139], v[212:215]
v_mfma_f32_16x16x32_bf16 v[216:219], a[60:63], a[140:143], v[216:219]
s_waitcnt lgkmcnt(8)
v_mfma_f32_16x16x32_bf16 v[220:223], a[32:35], a[128:131], v[220:223]
ds_read_b64_tr_b16 a[56:57], v8 offset:18432
v_mfma_f32_16x16x32_bf16 v[224:227], a[32:35], a[132:135], v[224:227]
ds_read_b64_tr_b16 a[58:59], v8 offset:23040
v_mfma_f32_16x16x32_bf16 v[228:231], a[32:35], a[136:139], v[228:231]
v_mfma_f32_16x16x32_bf16 v[232:235], a[32:35], a[140:143], v[232:235]
v_mfma_f32_16x16x32_bf16 v[236:239], a[36:39], a[128:131], v[236:239]
ds_read_b64_tr_b16 a[60:61], v8 offset:18464
v_mfma_f32_16x16x32_bf16 v[240:243], a[36:39], a[132:135], v[240:243]
ds_read_b64_tr_b16 a[62:63], v8 offset:23072
v_mfma_f32_16x16x32_bf16 v[244:247], a[36:39], a[136:139], v[244:247]
v_mfma_f32_16x16x32_bf16 v[248:251], a[36:39], a[140:143], v[248:251]
s_waitcnt lgkmcnt(8)
v_mfma_f32_16x16x32_bf16 v[252:255], a[40:43], a[128:131], v[252:255]
ds_read_b64_tr_b16 a[32:33], v8 offset:18496
v_mfma_f32_16x16x32_bf16 a[0:3], a[40:43], a[132:135], a[0:3]
ds_read_b64_tr_b16 a[34:35], v8 offset:23104
v_mfma_f32_16x16x32_bf16 a[4:7], a[40:43], a[136:139], a[4:7]
buffer_load_dwordx4 a[124:127], v12, s[20:23], s37 offen sc1
v_mfma_f32_16x16x32_bf16 a[8:11], a[40:43], a[140:143], a[8:11]
v_mfma_f32_16x16x32_bf16 a[12:15], a[44:47], a[128:131], a[12:15]
ds_read_b64_tr_b16 a[36:37], v8 offset:18528
v_mfma_f32_16x16x32_bf16 a[16:19], a[44:47], a[132:135], a[16:19]
ds_read_b64_tr_b16 a[38:39], v8 offset:23136
v_mfma_f32_16x16x32_bf16 a[20:23], a[44:47], a[136:139], a[20:23]
v_mfma_f32_16x16x32_bf16 a[24:27], a[44:47], a[140:143], a[24:27]
s_waitcnt lgkmcnt(8)
v_mfma_f32_16x16x32_bf16 a[28:31], a[48:51], a[128:131], a[28:31]
ds_read_b64_tr_b16 a[40:41], v8 offset:18560
v_mfma_f32_16x16x32_bf16 a[64:67], a[48:51], a[132:135], a[64:67]
ds_read_b64_tr_b16 a[42:43], v8 offset:23168
v_mfma_f32_16x16x32_bf16 a[68:71], a[48:51], a[136:139], a[68:71]
v_mfma_f32_16x16x32_bf16 a[72:75], a[48:51], a[140:143], a[72:75]
v_mfma_f32_16x16x32_bf16 a[76:79], a[52:55], a[128:131], a[76:79]
ds_read_b64_tr_b16 a[44:45], v8 offset:18592
v_mfma_f32_16x16x32_bf16 a[80:83], a[52:55], a[132:135], a[80:83]
ds_read_b64_tr_b16 a[46:47], v8 offset:23200
v_mfma_f32_16x16x32_bf16 a[84:87], a[52:55], a[136:139], a[84:87]
v_mfma_f32_16x16x32_bf16 a[88:91], a[52:55], a[140:143], a[88:91]
s_waitcnt vmcnt(15) lgkmcnt(8)
v_mfma_f32_16x16x32_bf16 v[28:31], a[56:59], a[144:147], v[28:31]
ds_read_b64_tr_b16 a[48:49], v8 offset:18624
v_mfma_f32_16x16x32_bf16 v[32:35], a[56:59], a[148:151], v[32:35]
ds_read_b64_tr_b16 a[50:51], v8 offset:23232
v_mfma_f32_16x16x32_bf16 v[36:39], a[56:59], a[152:155], v[36:39]
s_lshl_b32 s68, s29, 7
s_add_u32 s68, s68, 113249280
v_and_b32 v17, 7, v0
v_lshlrev_b32 v17, 2, v17
buffer_load_dword v17, v17, s[20:23], s68 offen sc1
v_mfma_f32_16x16x32_bf16 v[40:43], a[56:59], a[156:159], v[40:43]
v_mfma_f32_16x16x32_bf16 v[44:47], a[60:63], a[144:147], v[44:47]
ds_read_b64_tr_b16 a[52:53], v8 offset:18656
v_mfma_f32_16x16x32_bf16 v[48:51], a[60:63], a[148:151], v[48:51]
ds_read_b64_tr_b16 a[54:55], v8 offset:23264
v_mfma_f32_16x16x32_bf16 v[52:55], a[60:63], a[152:155], v[52:55]
v_mfma_f32_16x16x32_bf16 v[56:59], a[60:63], a[156:159], v[56:59]
s_waitcnt lgkmcnt(8)
v_mfma_f32_16x16x32_bf16 v[60:63], a[32:35], a[144:147], v[60:63]
ds_read_b64_tr_b16 a[56:57], v8 offset:18688
v_mfma_f32_16x16x32_bf16 v[64:67], a[32:35], a[148:151], v[64:67]
ds_read_b64_tr_b16 a[58:59], v8 offset:23296
v_mfma_f32_16x16x32_bf16 v[68:71], a[32:35], a[152:155], v[68:71]
v_mfma_f32_16x16x32_bf16 v[72:75], a[32:35], a[156:159], v[72:75]
v_mfma_f32_16x16x32_bf16 v[76:79], a[36:39], a[144:147], v[76:79]
ds_read_b64_tr_b16 a[60:61], v8 offset:27648
v_mfma_f32_16x16x32_bf16 v[80:83], a[36:39], a[148:151], v[80:83]
ds_read_b64_tr_b16 a[62:63], v8 offset:32256
v_mfma_f32_16x16x32_bf16 v[84:87], a[36:39], a[152:155], v[84:87]
v_mfma_f32_16x16x32_bf16 v[88:91], a[36:39], a[156:159], v[88:91]
s_waitcnt lgkmcnt(8)
v_mfma_f32_16x16x32_bf16 v[92:95], a[40:43], a[144:147], v[92:95]
ds_read_b64_tr_b16 a[32:33], v8 offset:27680
v_mfma_f32_16x16x32_bf16 v[96:99], a[40:43], a[148:151], v[96:99]
ds_read_b64_tr_b16 a[34:35], v8 offset:32288
v_mfma_f32_16x16x32_bf16 v[100:103], a[40:43], a[152:155], v[100:103]
v_mfma_f32_16x16x32_bf16 v[104:107], a[40:43], a[156:159], v[104:107]
v_mfma_f32_16x16x32_bf16 v[108:111], a[44:47], a[144:147], v[108:111]
ds_read_b64_tr_b16 a[36:37], v8 offset:27712
v_mfma_f32_16x16x32_bf16 v[112:115], a[44:47], a[148:151], v[112:115]
ds_read_b64_tr_b16 a[38:39], v8 offset:32320
v_mfma_f32_16x16x32_bf16 v[116:119], a[44:47], a[152:155], v[116:119]
v_mfma_f32_16x16x32_bf16 v[120:123], a[44:47], a[156:159], v[120:123]
s_waitcnt lgkmcnt(8)
v_mfma_f32_16x16x32_bf16 v[124:127], a[48:51], a[144:147], v[124:127]
ds_read_b64_tr_b16 a[40:41], v8 offset:27744
v_mfma_f32_16x16x32_bf16 v[128:131], a[48:51], a[148:151], v[128:131]
ds_read_b64_tr_b16 a[42:43], v8 offset:32352
v_mfma_f32_16x16x32_bf16 v[132:135], a[48:51], a[152:155], v[132:135]
v_mfma_f32_16x16x32_bf16 v[136:139], a[48:51], a[156:159], v[136:139]
v_mfma_f32_16x16x32_bf16 v[140:143], a[52:55], a[144:147], v[140:143]
ds_read_b64_tr_b16 a[44:45], v8 offset:27776
v_mfma_f32_16x16x32_bf16 v[144:147], a[52:55], a[148:151], v[144:147]
ds_read_b64_tr_b16 a[46:47], v8 offset:32384
v_mfma_f32_16x16x32_bf16 v[148:151], a[52:55], a[152:155], v[148:151]
v_mfma_f32_16x16x32_bf16 v[152:155], a[52:55], a[156:159], v[152:155]
s_waitcnt lgkmcnt(8)
v_mfma_f32_16x16x32_bf16 v[156:159], a[56:59], a[144:147], v[156:159]
ds_read_b64_tr_b16 a[48:49], v8 offset:27808
v_mfma_f32_16x16x32_bf16 v[160:163], a[56:59], a[148:151], v[160:163]
ds_read_b64_tr_b16 a[50:51], v8 offset:32416
v_mfma_f32_16x16x32_bf16 v[164:167], a[56:59], a[152:155], v[164:167]
v_mfma_f32_16x16x32_bf16 v[168:171], a[56:59], a[156:159], v[168:171]
v_mfma_f32_16x16x32_bf16 v[172:175], a[60:63], a[144:147], v[172:175]
ds_read_b64_tr_b16 a[52:53], v8 offset:27840
v_mfma_f32_16x16x32_bf16 v[176:179], a[60:63], a[148:151], v[176:179]
ds_read_b64_tr_b16 a[54:55], v8 offset:32448
v_mfma_f32_16x16x32_bf16 v[180:183], a[60:63], a[152:155], v[180:183]
v_mfma_f32_16x16x32_bf16 v[184:187], a[60:63], a[156:159], v[184:187]
s_waitcnt lgkmcnt(8)
v_mfma_f32_16x16x32_bf16 v[188:191], a[32:35], a[144:147], v[188:191]
ds_read_b64_tr_b16 a[56:57], v8 offset:27872
v_mfma_f32_16x16x32_bf16 v[192:195], a[32:35], a[148:151], v[192:195]
ds_read_b64_tr_b16 a[58:59], v8 offset:32480
v_mfma_f32_16x16x32_bf16 v[196:199], a[32:35], a[152:155], v[196:199]
v_mfma_f32_16x16x32_bf16 v[200:203], a[32:35], a[156:159], v[200:203]
v_mfma_f32_16x16x32_bf16 v[204:207], a[36:39], a[144:147], v[204:207]
ds_read_b64_tr_b16 a[60:61], v8 offset:27904
v_mfma_f32_16x16x32_bf16 v[208:211], a[36:39], a[148:151], v[208:211]
ds_read_b64_tr_b16 a[62:63], v8 offset:32512
v_mfma_f32_16x16x32_bf16 v[212:215], a[36:39], a[152:155], v[212:215]
s_waitcnt vmcnt(11)
v_mfma_f32_16x16x32_bf16 v[216:219], a[36:39], a[156:159], v[216:219]
s_barrier
s_waitcnt lgkmcnt(8)
v_mfma_f32_16x16x32_bf16 v[220:223], a[40:43], a[144:147], v[220:223]
ds_read_b64_tr_b16 a[32:33], v6 offset:0
v_mfma_f32_16x16x32_bf16 v[224:227], a[40:43], a[148:151], v[224:227]
ds_read_b64_tr_b16 a[34:35], v6 offset:4608
v_mfma_f32_16x16x32_bf16 v[228:231], a[40:43], a[152:155], v[228:231]
v_mfma_f32_16x16x32_bf16 v[232:235], a[40:43], a[156:159], v[232:235]
v_mfma_f32_16x16x32_bf16 v[236:239], a[44:47], a[144:147], v[236:239]
ds_read_b64_tr_b16 a[36:37], v6 offset:32
v_mfma_f32_16x16x32_bf16 v[240:243], a[44:47], a[148:151], v[240:243]
ds_read_b64_tr_b16 a[38:39], v6 offset:4640
v_mfma_f32_16x16x32_bf16 v[244:247], a[44:47], a[152:155], v[244:247]
v_mfma_f32_16x16x32_bf16 v[248:251], a[44:47], a[156:159], v[248:251]
s_waitcnt lgkmcnt(8)
v_mfma_f32_16x16x32_bf16 v[252:255], a[48:51], a[144:147], v[252:255]
ds_read_b64_tr_b16 a[40:41], v6 offset:64
v_mfma_f32_16x16x32_bf16 a[0:3], a[48:51], a[148:151], a[0:3]
ds_read_b64_tr_b16 a[42:43], v6 offset:4672
v_mfma_f32_16x16x32_bf16 a[4:7], a[48:51], a[152:155], a[4:7]
v_mfma_f32_16x16x32_bf16 a[8:11], a[48:51], a[156:159], a[8:11]
v_mfma_f32_16x16x32_bf16 a[12:15], a[52:55], a[144:147], a[12:15]
ds_read_b64_tr_b16 a[44:45], v6 offset:96
v_mfma_f32_16x16x32_bf16 a[16:19], a[52:55], a[148:151], a[16:19]
ds_read_b64_tr_b16 a[46:47], v6 offset:4704
v_mfma_f32_16x16x32_bf16 a[20:23], a[52:55], a[152:155], a[20:23]
v_mfma_f32_16x16x32_bf16 a[24:27], a[52:55], a[156:159], a[24:27]
s_waitcnt lgkmcnt(8)
v_mfma_f32_16x16x32_bf16 a[28:31], a[56:59], a[144:147], a[28:31]
ds_read_b64_tr_b16 a[48:49], v6 offset:128
v_mfma_f32_16x16x32_bf16 a[64:67], a[56:59], a[148:151], a[64:67]
ds_read_b64_tr_b16 a[50:51], v6 offset:4736
v_mfma_f32_16x16x32_bf16 a[68:71], a[56:59], a[152:155], a[68:71]
v_mfma_f32_16x16x32_bf16 a[72:75], a[56:59], a[156:159], a[72:75]
v_mfma_f32_16x16x32_bf16 a[76:79], a[60:63], a[144:147], a[76:79]
ds_read_b64_tr_b16 a[52:53], v6 offset:160
v_mfma_f32_16x16x32_bf16 a[80:83], a[60:63], a[148:151], a[80:83]
ds_read_b64_tr_b16 a[54:55], v6 offset:4768
v_mfma_f32_16x16x32_bf16 a[84:87], a[60:63], a[152:155], a[84:87]
v_mfma_f32_16x16x32_bf16 a[88:91], a[60:63], a[156:159], a[88:91]
s_waitcnt vmcnt(5) lgkmcnt(8)
v_mfma_f32_16x16x32_bf16 v[28:31], a[32:35], a[96:99], v[28:31]
ds_read_b64_tr_b16 a[56:57], v6 offset:192
v_mfma_f32_16x16x32_bf16 v[32:35], a[32:35], a[100:103], v[32:35]
ds_read_b64_tr_b16 a[58:59], v6 offset:4800
v_mfma_f32_16x16x32_bf16 v[36:39], a[32:35], a[104:107], v[36:39]
v_mfma_f32_16x16x32_bf16 v[40:43], a[32:35], a[108:111], v[40:43]
v_mfma_f32_16x16x32_bf16 v[44:47], a[36:39], a[96:99], v[44:47]
ds_read_b64_tr_b16 a[60:61], v6 offset:224
v_mfma_f32_16x16x32_bf16 v[48:51], a[36:39], a[100:103], v[48:51]
ds_read_b64_tr_b16 a[62:63], v6 offset:4832
v_mfma_f32_16x16x32_bf16 v[52:55], a[36:39], a[104:107], v[52:55]
v_mfma_f32_16x16x32_bf16 v[56:59], a[36:39], a[108:111], v[56:59]
s_waitcnt lgkmcnt(8)
v_mfma_f32_16x16x32_bf16 v[60:63], a[40:43], a[96:99], v[60:63]
ds_read_b64_tr_b16 a[32:33], v6 offset:256
v_mfma_f32_16x16x32_bf16 v[64:67], a[40:43], a[100:103], v[64:67]
ds_read_b64_tr_b16 a[34:35], v6 offset:4864
v_mfma_f32_16x16x32_bf16 v[68:71], a[40:43], a[104:107], v[68:71]
v_mfma_f32_16x16x32_bf16 v[72:75], a[40:43], a[108:111], v[72:75]
v_mfma_f32_16x16x32_bf16 v[76:79], a[44:47], a[96:99], v[76:79]
ds_read_b64_tr_b16 a[36:37], v6 offset:9216
v_mfma_f32_16x16x32_bf16 v[80:83], a[44:47], a[100:103], v[80:83]
ds_read_b64_tr_b16 a[38:39], v6 offset:13824
v_mfma_f32_16x16x32_bf16 v[84:87], a[44:47], a[104:107], v[84:87]
v_mfma_f32_16x16x32_bf16 v[88:91], a[44:47], a[108:111], v[88:91]
s_waitcnt lgkmcnt(8)
v_mfma_f32_16x16x32_bf16 v[92:95], a[48:51], a[96:99], v[92:95]
ds_read_b64_tr_b16 a[40:41], v6 offset:9248
v_mfma_f32_16x16x32_bf16 v[96:99], a[48:51], a[100:103], v[96:99]
ds_read_b64_tr_b16 a[42:43], v6 offset:13856
v_mfma_f32_16x16x32_bf16 v[100:103], a[48:51], a[104:107], v[100:103]
v_mfma_f32_16x16x32_bf16 v[104:107], a[48:51], a[108:111], v[104:107]
v_mfma_f32_16x16x32_bf16 v[108:111], a[52:55], a[96:99], v[108:111]
ds_read_b64_tr_b16 a[44:45], v6 offset:9280
v_mfma_f32_16x16x32_bf16 v[112:115], a[52:55], a[100:103], v[112:115]
ds_read_b64_tr_b16 a[46:47], v6 offset:13888
v_mfma_f32_16x16x32_bf16 v[116:119], a[52:55], a[104:107], v[116:119]
v_mfma_f32_16x16x32_bf16 v[120:123], a[52:55], a[108:111], v[120:123]
s_waitcnt lgkmcnt(8)
v_mfma_f32_16x16x32_bf16 v[124:127], a[56:59], a[96:99], v[124:127]
ds_read_b64_tr_b16 a[48:49], v6 offset:9312
v_mfma_f32_16x16x32_bf16 v[128:131], a[56:59], a[100:103], v[128:131]
ds_read_b64_tr_b16 a[50:51], v6 offset:13920
v_mfma_f32_16x16x32_bf16 v[132:135], a[56:59], a[104:107], v[132:135]
v_mfma_f32_16x16x32_bf16 v[136:139], a[56:59], a[108:111], v[136:139]
v_mfma_f32_16x16x32_bf16 v[140:143], a[60:63], a[96:99], v[140:143]
ds_read_b64_tr_b16 a[52:53], v6 offset:9344
v_mfma_f32_16x16x32_bf16 v[144:147], a[60:63], a[100:103], v[144:147]
ds_read_b64_tr_b16 a[54:55], v6 offset:13952
v_mfma_f32_16x16x32_bf16 v[148:151], a[60:63], a[104:107], v[148:151]
v_mfma_f32_16x16x32_bf16 v[152:155], a[60:63], a[108:111], v[152:155]
s_waitcnt lgkmcnt(8)
v_mfma_f32_16x16x32_bf16 v[156:159], a[32:35], a[96:99], v[156:159]
ds_read_b64_tr_b16 a[56:57], v6 offset:9376
v_mfma_f32_16x16x32_bf16 v[160:163], a[32:35], a[100:103], v[160:163]
ds_read_b64_tr_b16 a[58:59], v6 offset:13984
v_mfma_f32_16x16x32_bf16 v[164:167], a[32:35], a[104:107], v[164:167]
v_mfma_f32_16x16x32_bf16 v[168:171], a[32:35], a[108:111], v[168:171]
v_mfma_f32_16x16x32_bf16 v[172:175], a[36:39], a[96:99], v[172:175]
ds_read_b64_tr_b16 a[60:61], v6 offset:9408
v_mfma_f32_16x16x32_bf16 v[176:179], a[36:39], a[100:103], v[176:179]
ds_read_b64_tr_b16 a[62:63], v6 offset:14016
v_mfma_f32_16x16x32_bf16 v[180:183], a[36:39], a[104:107], v[180:183]
v_mfma_f32_16x16x32_bf16 v[184:187], a[36:39], a[108:111], v[184:187]
s_waitcnt lgkmcnt(8)
v_mfma_f32_16x16x32_bf16 v[188:191], a[40:43], a[96:99], v[188:191]
ds_read_b64_tr_b16 a[32:33], v6 offset:9440
v_mfma_f32_16x16x32_bf16 v[192:195], a[40:43], a[100:103], v[192:195]
ds_read_b64_tr_b16 a[34:35], v6 offset:14048
v_mfma_f32_16x16x32_bf16 v[196:199], a[40:43], a[104:107], v[196:199]
v_mfma_f32_16x16x32_bf16 v[200:203], a[40:43], a[108:111], v[200:203]
v_mfma_f32_16x16x32_bf16 v[204:207], a[44:47], a[96:99], v[204:207]
ds_read_b64_tr_b16 a[36:37], v6 offset:9472
v_mfma_f32_16x16x32_bf16 v[208:211], a[44:47], a[100:103], v[208:211]
ds_read_b64_tr_b16 a[38:39], v6 offset:14080
v_mfma_f32_16x16x32_bf16 v[212:215], a[44:47], a[104:107], v[212:215]
v_mfma_f32_16x16x32_bf16 v[216:219], a[44:47], a[108:111], v[216:219]
s_waitcnt lgkmcnt(8)
v_mfma_f32_16x16x32_bf16 v[220:223], a[48:51], a[96:99], v[220:223]
ds_read_b64_tr_b16 a[40:41], v6 offset:18432
v_mfma_f32_16x16x32_bf16 v[224:227], a[48:51], a[100:103], v[224:227]
ds_read_b64_tr_b16 a[42:43], v6 offset:23040
v_mfma_f32_16x16x32_bf16 v[228:231], a[48:51], a[104:107], v[228:231]
v_mfma_f32_16x16x32_bf16 v[232:235], a[48:51], a[108:111], v[232:235]
v_mfma_f32_16x16x32_bf16 v[236:239], a[52:55], a[96:99], v[236:239]
ds_read_b64_tr_b16 a[44:45], v6 offset:18464
v_mfma_f32_16x16x32_bf16 v[240:243], a[52:55], a[100:103], v[240:243]
ds_read_b64_tr_b16 a[46:47], v6 offset:23072
v_mfma_f32_16x16x32_bf16 v[244:247], a[52:55], a[104:107], v[244:247]
v_mfma_f32_16x16x32_bf16 v[248:251], a[52:55], a[108:111], v[248:251]
s_waitcnt lgkmcnt(8)
v_mfma_f32_16x16x32_bf16 v[252:255], a[56:59], a[96:99], v[252:255]
ds_read_b64_tr_b16 a[48:49], v6 offset:18496
v_mfma_f32_16x16x32_bf16 a[0:3], a[56:59], a[100:103], a[0:3]
ds_read_b64_tr_b16 a[50:51], v6 offset:23104
v_mfma_f32_16x16x32_bf16 a[4:7], a[56:59], a[104:107], a[4:7]
v_mfma_f32_16x16x32_bf16 a[8:11], a[56:59], a[108:111], a[8:11]
v_mfma_f32_16x16x32_bf16 a[12:15], a[60:63], a[96:99], a[12:15]
ds_read_b64_tr_b16 a[52:53], v6 offset:18528
v_mfma_f32_16x16x32_bf16 a[16:19], a[60:63], a[100:103], a[16:19]
ds_read_b64_tr_b16 a[54:55], v6 offset:23136
v_mfma_f32_16x16x32_bf16 a[20:23], a[60:63], a[104:107], a[20:23]
v_mfma_f32_16x16x32_bf16 a[24:27], a[60:63], a[108:111], a[24:27]
s_waitcnt lgkmcnt(8)
v_mfma_f32_16x16x32_bf16 a[28:31], a[32:35], a[96:99], a[28:31]
ds_read_b64_tr_b16 a[56:57], v6 offset:18560
v_mfma_f32_16x16x32_bf16 a[64:67], a[32:35], a[100:103], a[64:67]
ds_read_b64_tr_b16 a[58:59], v6 offset:23168
v_mfma_f32_16x16x32_bf16 a[68:71], a[32:35], a[104:107], a[68:71]
v_mfma_f32_16x16x32_bf16 a[72:75], a[32:35], a[108:111], a[72:75]
v_mfma_f32_16x16x32_bf16 a[76:79], a[36:39], a[96:99], a[76:79]
ds_read_b64_tr_b16 a[60:61], v6 offset:18592
v_mfma_f32_16x16x32_bf16 a[80:83], a[36:39], a[100:103], a[80:83]
ds_read_b64_tr_b16 a[62:63], v6 offset:23200
v_mfma_f32_16x16x32_bf16 a[84:87], a[36:39], a[104:107], a[84:87]
v_mfma_f32_16x16x32_bf16 a[88:91], a[36:39], a[108:111], a[88:91]
s_waitcnt vmcnt(1) lgkmcnt(8)
v_mfma_f32_16x16x32_bf16 v[28:31], a[40:43], a[112:115], v[28:31]
ds_read_b64_tr_b16 a[32:33], v6 offset:18624
v_mfma_f32_16x16x32_bf16 v[32:35], a[40:43], a[116:119], v[32:35]
ds_read_b64_tr_b16 a[34:35], v6 offset:23232
v_mfma_f32_16x16x32_bf16 v[36:39], a[40:43], a[120:123], v[36:39]
v_mfma_f32_16x16x32_bf16 v[40:43], a[40:43], a[124:127], v[40:43]
v_mfma_f32_16x16x32_bf16 v[44:47], a[44:47], a[112:115], v[44:47]
ds_read_b64_tr_b16 a[36:37], v6 offset:18656
v_mfma_f32_16x16x32_bf16 v[48:51], a[44:47], a[116:119], v[48:51]
ds_read_b64_tr_b16 a[38:39], v6 offset:23264
v_mfma_f32_16x16x32_bf16 v[52:55], a[44:47], a[120:123], v[52:55]
v_mfma_f32_16x16x32_bf16 v[56:59], a[44:47], a[124:127], v[56:59]
s_waitcnt lgkmcnt(8)
v_mfma_f32_16x16x32_bf16 v[60:63], a[48:51], a[112:115], v[60:63]
ds_read_b64_tr_b16 a[40:41], v6 offset:18688
v_mfma_f32_16x16x32_bf16 v[64:67], a[48:51], a[116:119], v[64:67]
ds_read_b64_tr_b16 a[42:43], v6 offset:23296
v_mfma_f32_16x16x32_bf16 v[68:71], a[48:51], a[120:123], v[68:71]
v_mfma_f32_16x16x32_bf16 v[72:75], a[48:51], a[124:127], v[72:75]
v_mfma_f32_16x16x32_bf16 v[76:79], a[52:55], a[112:115], v[76:79]
ds_read_b64_tr_b16 a[44:45], v6 offset:27648
v_mfma_f32_16x16x32_bf16 v[80:83], a[52:55], a[116:119], v[80:83]
ds_read_b64_tr_b16 a[46:47], v6 offset:32256
v_mfma_f32_16x16x32_bf16 v[84:87], a[52:55], a[120:123], v[84:87]
v_mfma_f32_16x16x32_bf16 v[88:91], a[52:55], a[124:127], v[88:91]
s_waitcnt lgkmcnt(8)
v_mfma_f32_16x16x32_bf16 v[92:95], a[56:59], a[112:115], v[92:95]
ds_read_b64_tr_b16 a[48:49], v6 offset:27680
v_mfma_f32_16x16x32_bf16 v[96:99], a[56:59], a[116:119], v[96:99]
ds_read_b64_tr_b16 a[50:51], v6 offset:32288
v_mfma_f32_16x16x32_bf16 v[100:103], a[56:59], a[120:123], v[100:103]
v_mfma_f32_16x16x32_bf16 v[104:107], a[56:59], a[124:127], v[104:107]
v_mfma_f32_16x16x32_bf16 v[108:111], a[60:63], a[112:115], v[108:111]
ds_read_b64_tr_b16 a[52:53], v6 offset:27712
v_mfma_f32_16x16x32_bf16 v[112:115], a[60:63], a[116:119], v[112:115]
ds_read_b64_tr_b16 a[54:55], v6 offset:32320
v_mfma_f32_16x16x32_bf16 v[116:119], a[60:63], a[120:123], v[116:119]
v_mfma_f32_16x16x32_bf16 v[120:123], a[60:63], a[124:127], v[120:123]
s_waitcnt lgkmcnt(8)
v_mfma_f32_16x16x32_bf16 v[124:127], a[32:35], a[112:115], v[124:127]
ds_read_b64_tr_b16 a[56:57], v6 offset:27744
v_mfma_f32_16x16x32_bf16 v[128:131], a[32:35], a[116:119], v[128:131]
ds_read_b64_tr_b16 a[58:59], v6 offset:32352
v_mfma_f32_16x16x32_bf16 v[132:135], a[32:35], a[120:123], v[132:135]
v_mfma_f32_16x16x32_bf16 v[136:139], a[32:35], a[124:127], v[136:139]
v_mfma_f32_16x16x32_bf16 v[140:143], a[36:39], a[112:115], v[140:143]
ds_read_b64_tr_b16 a[60:61], v6 offset:27776
v_mfma_f32_16x16x32_bf16 v[144:147], a[36:39], a[116:119], v[144:147]
ds_read_b64_tr_b16 a[62:63], v6 offset:32384
v_mfma_f32_16x16x32_bf16 v[148:151], a[36:39], a[120:123], v[148:151]
v_mfma_f32_16x16x32_bf16 v[152:155], a[36:39], a[124:127], v[152:155]
s_waitcnt lgkmcnt(8)
v_mfma_f32_16x16x32_bf16 v[156:159], a[40:43], a[112:115], v[156:159]
ds_read_b64_tr_b16 a[32:33], v6 offset:27808
v_mfma_f32_16x16x32_bf16 v[160:163], a[40:43], a[116:119], v[160:163]
ds_read_b64_tr_b16 a[34:35], v6 offset:32416
v_mfma_f32_16x16x32_bf16 v[164:167], a[40:43], a[120:123], v[164:167]
v_mfma_f32_16x16x32_bf16 v[168:171], a[40:43], a[124:127], v[168:171]
v_mfma_f32_16x16x32_bf16 v[172:175], a[44:47], a[112:115], v[172:175]
ds_read_b64_tr_b16 a[36:37], v6 offset:27840
v_mfma_f32_16x16x32_bf16 v[176:179], a[44:47], a[116:119], v[176:179]
ds_read_b64_tr_b16 a[38:39], v6 offset:32448
v_mfma_f32_16x16x32_bf16 v[180:183], a[44:47], a[120:123], v[180:183]
v_mfma_f32_16x16x32_bf16 v[184:187], a[44:47], a[124:127], v[184:187]
s_waitcnt lgkmcnt(8)
v_mfma_f32_16x16x32_bf16 v[188:191], a[48:51], a[112:115], v[188:191]
ds_read_b64_tr_b16 a[40:41], v6 offset:27872
v_mfma_f32_16x16x32_bf16 v[192:195], a[48:51], a[116:119], v[192:195]
ds_read_b64_tr_b16 a[42:43], v6 offset:32480
v_mfma_f32_16x16x32_bf16 v[196:199], a[48:51], a[120:123], v[196:199]
v_mfma_f32_16x16x32_bf16 v[200:203], a[48:51], a[124:127], v[200:203]
v_mfma_f32_16x16x32_bf16 v[204:207], a[52:55], a[112:115], v[204:207]
ds_read_b64_tr_b16 a[44:45], v6 offset:27904
v_mfma_f32_16x16x32_bf16 v[208:211], a[52:55], a[116:119], v[208:211]
ds_read_b64_tr_b16 a[46:47], v6 offset:32512
v_mfma_f32_16x16x32_bf16 v[212:215], a[52:55], a[120:123], v[212:215]
v_mfma_f32_16x16x32_bf16 v[216:219], a[52:55], a[124:127], v[216:219]
s_waitcnt lgkmcnt(8)
v_mfma_f32_16x16x32_bf16 v[220:223], a[56:59], a[112:115], v[220:223]
v_mfma_f32_16x16x32_bf16 v[224:227], a[56:59], a[116:119], v[224:227]
v_mfma_f32_16x16x32_bf16 v[228:231], a[56:59], a[120:123], v[228:231]
v_mfma_f32_16x16x32_bf16 v[232:235], a[56:59], a[124:127], v[232:235]
v_mfma_f32_16x16x32_bf16 v[236:239], a[60:63], a[112:115], v[236:239]
v_mfma_f32_16x16x32_bf16 v[240:243], a[60:63], a[116:119], v[240:243]
v_mfma_f32_16x16x32_bf16 v[244:247], a[60:63], a[120:123], v[244:247]
v_mfma_f32_16x16x32_bf16 v[248:251], a[60:63], a[124:127], v[248:251]
s_waitcnt lgkmcnt(4)
v_mfma_f32_16x16x32_bf16 v[252:255], a[32:35], a[112:115], v[252:255]
v_mfma_f32_16x16x32_bf16 a[0:3], a[32:35], a[116:119], a[0:3]
v_mfma_f32_16x16x32_bf16 a[4:7], a[32:35], a[120:123], a[4:7]
v_mfma_f32_16x16x32_bf16 a[8:11], a[32:35], a[124:127], a[8:11]
v_mfma_f32_16x16x32_bf16 a[12:15], a[36:39], a[112:115], a[12:15]
v_mfma_f32_16x16x32_bf16 a[16:19], a[36:39], a[116:119], a[16:19]
v_mfma_f32_16x16x32_bf16 a[20:23], a[36:39], a[120:123], a[20:23]
v_mfma_f32_16x16x32_bf16 a[24:27], a[36:39], a[124:127], a[24:27]
s_waitcnt lgkmcnt(0)
v_mfma_f32_16x16x32_bf16 a[28:31], a[40:43], a[112:115], a[28:31]
v_mfma_f32_16x16x32_bf16 a[64:67], a[40:43], a[116:119], a[64:67]
v_mfma_f32_16x16x32_bf16 a[68:71], a[40:43], a[120:123], a[68:71]
v_mfma_f32_16x16x32_bf16 a[72:75], a[40:43], a[124:127], a[72:75]
v_mfma_f32_16x16x32_bf16 a[76:79], a[44:47], a[112:115], a[76:79]
v_mfma_f32_16x16x32_bf16 a[80:83], a[44:47], a[116:119], a[80:83]
v_mfma_f32_16x16x32_bf16 a[84:87], a[44:47], a[120:123], a[84:87]
v_mfma_f32_16x16x32_bf16 a[88:91], a[44:47], a[124:127], a[88:91]
parallel_sum__compressed_kv_cla__geglu_ffn__prompt_kernel_L_ge:
s_waitcnt vmcnt(0)
v_cmp_eq_u32 vcc, 0, v17
s_nop 4
s_cbranch_vccnz parallel_sum__compressed_kv_cla__geglu_ffn__prompt_kernel_spin5
parallel_sum__compressed_kv_cla__geglu_ffn__prompt_kernel_spin5_ret:
s_waitcnt lgkmcnt(0)
s_barrier
s_lshl_b32 s3, s29, 20
s_add_u32 s3, s3, 4194304
s_lshl_b32 s4, s30, 16
s_sub_u32 s5, 1048576, s4
s_add_u32 s5, s5, s3
s_mov_b32 s12, s20
s_mov_b32 s13, s21
s_mov_b32 s14, s5
s_mov_b32 s15, 0x20000
s_sub_u32 s24, s20, 40960
s_subb_u32 s25, s21, 0
s_add_u32 s26, s5, 49152
s_mov_b32 s27, 0x20000
s_lshl_b32 s4, s28, 11
s_add_u32 s50, s3, s4
s_mov_b32 s51, s4
s_mov_b32 s58, 0xffff
v_mov_b32 v24, -2.302208198144325
v_mov_b32 v25, -2.302208198144325
v_mov_b32 v26, -0.1029432395800235
v_mov_b32 v27, -0.1029432395800235
v_pk_mul_f32 v[16:17], v[28:29], v[28:29]
v_pk_mul_f32 v[18:19], v[30:31], v[30:31]
v_pk_mul_f32 v[20:21], v[44:45], v[44:45]
v_pk_mul_f32 v[22:23], v[46:47], v[46:47]
v_pk_fma_f32 v[16:17], v[16:17], v[26:27], v[24:25]
v_pk_fma_f32 v[18:19], v[18:19], v[26:27], v[24:25]
v_pk_fma_f32 v[20:21], v[20:21], v[26:27], v[24:25]
v_pk_fma_f32 v[22:23], v[22:23], v[26:27], v[24:25]
v_pk_mul_f32 v[16:17], v[16:17], v[28:29]
v_pk_mul_f32 v[18:19], v[18:19], v[30:31]
v_pk_mul_f32 v[20:21], v[20:21], v[44:45]
v_pk_mul_f32 v[22:23], v[22:23], v[46:47]
v_exp_f32 v16, v16
v_exp_f32 v17, v17
v_exp_f32 v18, v18
v_exp_f32 v19, v19
v_exp_f32 v20, v20
v_exp_f32 v21, v21
v_exp_f32 v22, v22
v_exp_f32 v23, v23
v_pk_mul_f32 v[172:173], v[28:29], v[172:173]
v_pk_mul_f32 v[174:175], v[30:31], v[174:175]
v_pk_mul_f32 v[188:189], v[44:45], v[188:189]
v_pk_mul_f32 v[190:191], v[46:47], v[190:191]
s_and_b32 m0, s51, s58
v_pk_add_f32 v[16:17], v[16:17], 1.0 op_sel_hi:[1,0]
v_pk_add_f32 v[18:19], v[18:19], 1.0 op_sel_hi:[1,0]
v_pk_add_f32 v[20:21], v[20:21], 1.0 op_sel_hi:[1,0]
v_pk_add_f32 v[22:23], v[22:23], 1.0 op_sel_hi:[1,0]
v_rcp_f32 v16, v16
v_rcp_f32 v17, v17
v_rcp_f32 v18, v18
v_rcp_f32 v19, v19
v_rcp_f32 v20, v20
v_rcp_f32 v21, v21
v_rcp_f32 v22, v22
v_rcp_f32 v23, v23
buffer_load_dwordx4 v13, s[12:15], s50 offen offset:0 sc1 lds
v_pk_mul_f32 v[16:17], v[16:17], v[172:173]
v_pk_mul_f32 v[18:19], v[18:19], v[174:175]
v_pk_mul_f32 v[20:21], v[20:21], v[188:189]
v_pk_mul_f32 v[22:23], v[22:23], v[190:191]
v_cvt_pk_bf16_f32 v28, v16, v17
v_cvt_pk_bf16_f32 v29, v18, v19
v_cvt_pk_bf16_f32 v30, v20, v21
v_cvt_pk_bf16_f32 v31, v22, v23
buffer_load_dwordx4 v13, s[12:15], s50 offen offset:1024 sc1 lds
s_add_u32 s36, s93, 0
buffer_store_dwordx4 v[28:31], v13, s[20:23], s36 offen
v_pk_mul_f32 v[16:17], v[60:61], v[60:61]
v_pk_mul_f32 v[18:19], v[62:63], v[62:63]
v_pk_mul_f32 v[20:21], v[76:77], v[76:77]
v_pk_mul_f32 v[22:23], v[78:79], v[78:79]
v_pk_fma_f32 v[16:17], v[16:17], v[26:27], v[24:25]
v_pk_fma_f32 v[18:19], v[18:19], v[26:27], v[24:25]
v_pk_fma_f32 v[20:21], v[20:21], v[26:27], v[24:25]
v_pk_fma_f32 v[22:23], v[22:23], v[26:27], v[24:25]
v_pk_mul_f32 v[16:17], v[16:17], v[60:61]
v_pk_mul_f32 v[18:19], v[18:19], v[62:63]
v_pk_mul_f32 v[20:21], v[20:21], v[76:77]
v_pk_mul_f32 v[22:23], v[22:23], v[78:79]
v_exp_f32 v16, v16
v_exp_f32 v17, v17
v_exp_f32 v18, v18
v_exp_f32 v19, v19
v_exp_f32 v20, v20
v_exp_f32 v21, v21
v_exp_f32 v22, v22
v_exp_f32 v23, v23
v_pk_mul_f32 v[204:205], v[60:61], v[204:205]
v_pk_mul_f32 v[206:207], v[62:63], v[206:207]
v_pk_mul_f32 v[220:221], v[76:77], v[220:221]
v_pk_mul_f32 v[222:223], v[78:79], v[222:223]
s_add_u32 s51, s51, 8192
v_pk_add_f32 v[16:17], v[16:17], 1.0 op_sel_hi:[1,0]
v_pk_add_f32 v[18:19], v[18:19], 1.0 op_sel_hi:[1,0]
v_pk_add_f32 v[20:21], v[20:21], 1.0 op_sel_hi:[1,0]
v_pk_add_f32 v[22:23], v[22:23], 1.0 op_sel_hi:[1,0]
v_rcp_f32 v16, v16
v_rcp_f32 v17, v17
v_rcp_f32 v18, v18
v_rcp_f32 v19, v19
v_rcp_f32 v20, v20
v_rcp_f32 v21, v21
v_rcp_f32 v22, v22
v_rcp_f32 v23, v23
s_add_u32 s50, s50, 16384
v_pk_mul_f32 v[16:17], v[16:17], v[204:205]
v_pk_mul_f32 v[18:19], v[18:19], v[206:207]
v_pk_mul_f32 v[20:21], v[20:21], v[220:221]
v_pk_mul_f32 v[22:23], v[22:23], v[222:223]
v_cvt_pk_bf16_f32 v60, v16, v17
v_cvt_pk_bf16_f32 v61, v18, v19
v_cvt_pk_bf16_f32 v62, v20, v21
v_cvt_pk_bf16_f32 v63, v22, v23
s_and_b32 m0, s51, s58
s_add_u32 s36, s93, 1024
buffer_store_dwordx4 v[60:63], v13, s[20:23], s36 offen
v_pk_mul_f32 v[16:17], v[92:93], v[92:93]
v_pk_mul_f32 v[18:19], v[94:95], v[94:95]
v_pk_mul_f32 v[20:21], v[108:109], v[108:109]
v_pk_mul_f32 v[22:23], v[110:111], v[110:111]
v_pk_fma_f32 v[16:17], v[16:17], v[26:27], v[24:25]
v_pk_fma_f32 v[18:19], v[18:19], v[26:27], v[24:25]
v_pk_fma_f32 v[20:21], v[20:21], v[26:27], v[24:25]
v_pk_fma_f32 v[22:23], v[22:23], v[26:27], v[24:25]
v_pk_mul_f32 v[16:17], v[16:17], v[92:93]
v_pk_mul_f32 v[18:19], v[18:19], v[94:95]
v_pk_mul_f32 v[20:21], v[20:21], v[108:109]
v_pk_mul_f32 v[22:23], v[22:23], v[110:111]
v_exp_f32 v16, v16
v_exp_f32 v17, v17
v_exp_f32 v18, v18
v_exp_f32 v19, v19
v_exp_f32 v20, v20
v_exp_f32 v21, v21
v_exp_f32 v22, v22
v_exp_f32 v23, v23
v_pk_mul_f32 v[236:237], v[92:93], v[236:237]
v_pk_mul_f32 v[238:239], v[94:95], v[238:239]
v_pk_mul_f32 v[252:253], v[108:109], v[252:253]
v_pk_mul_f32 v[254:255], v[110:111], v[254:255]
buffer_load_dwordx4 v13, s[12:15], s50 offen offset:0 sc1 lds
v_pk_add_f32 v[16:17], v[16:17], 1.0 op_sel_hi:[1,0]
v_pk_add_f32 v[18:19], v[18:19], 1.0 op_sel_hi:[1,0]
v_pk_add_f32 v[20:21], v[20:21], 1.0 op_sel_hi:[1,0]
v_pk_add_f32 v[22:23], v[22:23], 1.0 op_sel_hi:[1,0]
v_rcp_f32 v16, v16
v_rcp_f32 v17, v17
v_rcp_f32 v18, v18
v_rcp_f32 v19, v19
v_rcp_f32 v20, v20
v_rcp_f32 v21, v21
v_rcp_f32 v22, v22
v_rcp_f32 v23, v23
buffer_load_dwordx4 v13, s[12:15], s50 offen offset:1024 sc1 lds
v_pk_mul_f32 v[16:17], v[16:17], v[236:237]
v_pk_mul_f32 v[18:19], v[18:19], v[238:239]
v_pk_mul_f32 v[20:21], v[20:21], v[252:253]
v_pk_mul_f32 v[22:23], v[22:23], v[254:255]
v_cvt_pk_bf16_f32 v92, v16, v17
v_cvt_pk_bf16_f32 v93, v18, v19
v_cvt_pk_bf16_f32 v94, v20, v21
v_cvt_pk_bf16_f32 v95, v22, v23
s_add_u32 s51, s51, 8192
s_add_u32 s36, s93, 2048
buffer_store_dwordx4 v[92:95], v13, s[20:23], s36 offen
v_accvgpr_read_b32 v2, a12
v_accvgpr_read_b32 v3, a13
v_accvgpr_read_b32 v4, a14
v_accvgpr_read_b32 v5, a15
v_accvgpr_read_b32 v6, a28
v_accvgpr_read_b32 v7, a29
v_accvgpr_read_b32 v8, a30
v_accvgpr_read_b32 v9, a31
v_pk_mul_f32 v[16:17], v[124:125], v[124:125]
v_pk_mul_f32 v[18:19], v[126:127], v[126:127]
v_pk_mul_f32 v[20:21], v[140:141], v[140:141]
v_pk_mul_f32 v[22:23], v[142:143], v[142:143]
v_pk_fma_f32 v[16:17], v[16:17], v[26:27], v[24:25]
v_pk_fma_f32 v[18:19], v[18:19], v[26:27], v[24:25]
v_pk_fma_f32 v[20:21], v[20:21], v[26:27], v[24:25]
v_pk_fma_f32 v[22:23], v[22:23], v[26:27], v[24:25]
v_pk_mul_f32 v[16:17], v[16:17], v[124:125]
v_pk_mul_f32 v[18:19], v[18:19], v[126:127]
v_pk_mul_f32 v[20:21], v[20:21], v[140:141]
v_pk_mul_f32 v[22:23], v[22:23], v[142:143]
v_exp_f32 v16, v16
v_exp_f32 v17, v17
v_exp_f32 v18, v18
v_exp_f32 v19, v19
v_exp_f32 v20, v20
v_exp_f32 v21, v21
v_exp_f32 v22, v22
v_exp_f32 v23, v23
v_pk_mul_f32 v[2:3], v[124:125], v[2:3]
v_pk_mul_f32 v[4:5], v[126:127], v[4:5]
v_pk_mul_f32 v[6:7], v[140:141], v[6:7]
v_pk_mul_f32 v[8:9], v[142:143], v[8:9]
s_add_u32 s50, s50, 16384
v_pk_add_f32 v[16:17], v[16:17], 1.0 op_sel_hi:[1,0]
v_pk_add_f32 v[18:19], v[18:19], 1.0 op_sel_hi:[1,0]
v_pk_add_f32 v[20:21], v[20:21], 1.0 op_sel_hi:[1,0]
v_pk_add_f32 v[22:23], v[22:23], 1.0 op_sel_hi:[1,0]
v_rcp_f32 v16, v16
v_rcp_f32 v17, v17
v_rcp_f32 v18, v18
v_rcp_f32 v19, v19
v_rcp_f32 v20, v20
v_rcp_f32 v21, v21
v_rcp_f32 v22, v22
v_rcp_f32 v23, v23
s_and_b32 m0, s51, s58
v_pk_mul_f32 v[16:17], v[16:17], v[2:3]
v_pk_mul_f32 v[18:19], v[18:19], v[4:5]
v_pk_mul_f32 v[20:21], v[20:21], v[6:7]
v_pk_mul_f32 v[22:23], v[22:23], v[8:9]
v_cvt_pk_bf16_f32 v124, v16, v17
v_cvt_pk_bf16_f32 v125, v18, v19
v_cvt_pk_bf16_f32 v126, v20, v21
v_cvt_pk_bf16_f32 v127, v22, v23
buffer_load_dwordx4 v13, s[12:15], s50 offen offset:0 sc1 lds
s_add_u32 s36, s93, 3072
buffer_store_dwordx4 v[124:127], v13, s[20:23], s36 offen
v_pk_mul_f32 v[16:17], v[32:33], v[32:33]
v_pk_mul_f32 v[18:19], v[34:35], v[34:35]
v_pk_mul_f32 v[20:21], v[48:49], v[48:49]
v_pk_mul_f32 v[22:23], v[50:51], v[50:51]
v_pk_fma_f32 v[16:17], v[16:17], v[26:27], v[24:25]
v_pk_fma_f32 v[18:19], v[18:19], v[26:27], v[24:25]
v_pk_fma_f32 v[20:21], v[20:21], v[26:27], v[24:25]
v_pk_fma_f32 v[22:23], v[22:23], v[26:27], v[24:25]
v_pk_mul_f32 v[16:17], v[16:17], v[32:33]
v_pk_mul_f32 v[18:19], v[18:19], v[34:35]
v_pk_mul_f32 v[20:21], v[20:21], v[48:49]
v_pk_mul_f32 v[22:23], v[22:23], v[50:51]
v_exp_f32 v16, v16
v_exp_f32 v17, v17
v_exp_f32 v18, v18
v_exp_f32 v19, v19
v_exp_f32 v20, v20
v_exp_f32 v21, v21
v_exp_f32 v22, v22
v_exp_f32 v23, v23
v_pk_mul_f32 v[176:177], v[32:33], v[176:177]
v_pk_mul_f32 v[178:179], v[34:35], v[178:179]
v_pk_mul_f32 v[192:193], v[48:49], v[192:193]
v_pk_mul_f32 v[194:195], v[50:51], v[194:195]
buffer_load_dwordx4 v13, s[12:15], s50 offen offset:1024 sc1 lds
v_pk_add_f32 v[16:17], v[16:17], 1.0 op_sel_hi:[1,0]
v_pk_add_f32 v[18:19], v[18:19], 1.0 op_sel_hi:[1,0]
v_pk_add_f32 v[20:21], v[20:21], 1.0 op_sel_hi:[1,0]
v_pk_add_f32 v[22:23], v[22:23], 1.0 op_sel_hi:[1,0]
v_rcp_f32 v16, v16
v_rcp_f32 v17, v17
v_rcp_f32 v18, v18
v_rcp_f32 v19, v19
v_rcp_f32 v20, v20
v_rcp_f32 v21, v21
v_rcp_f32 v22, v22
v_rcp_f32 v23, v23
s_add_u32 s51, s51, 8192
v_pk_mul_f32 v[16:17], v[16:17], v[176:177]
v_pk_mul_f32 v[18:19], v[18:19], v[178:179]
v_pk_mul_f32 v[20:21], v[20:21], v[192:193]
v_pk_mul_f32 v[22:23], v[22:23], v[194:195]
v_cvt_pk_bf16_f32 v32, v16, v17
v_cvt_pk_bf16_f32 v33, v18, v19
v_cvt_pk_bf16_f32 v34, v20, v21
v_cvt_pk_bf16_f32 v35, v22, v23
s_add_u32 s50, s50, 16384
s_add_u32 s36, s93, 147456
buffer_store_dwordx4 v[32:35], v13, s[20:23], s36 offen
v_pk_mul_f32 v[16:17], v[64:65], v[64:65]
v_pk_mul_f32 v[18:19], v[66:67], v[66:67]
v_pk_mul_f32 v[20:21], v[80:81], v[80:81]
v_pk_mul_f32 v[22:23], v[82:83], v[82:83]
v_pk_fma_f32 v[16:17], v[16:17], v[26:27], v[24:25]
v_pk_fma_f32 v[18:19], v[18:19], v[26:27], v[24:25]
v_pk_fma_f32 v[20:21], v[20:21], v[26:27], v[24:25]
v_pk_fma_f32 v[22:23], v[22:23], v[26:27], v[24:25]
v_pk_mul_f32 v[16:17], v[16:17], v[64:65]
v_pk_mul_f32 v[18:19], v[18:19], v[66:67]
v_pk_mul_f32 v[20:21], v[20:21], v[80:81]
v_pk_mul_f32 v[22:23], v[22:23], v[82:83]
v_exp_f32 v16, v16
v_exp_f32 v17, v17
v_exp_f32 v18, v18
v_exp_f32 v19, v19
v_exp_f32 v20, v20
v_exp_f32 v21, v21
v_exp_f32 v22, v22
v_exp_f32 v23, v23
v_pk_mul_f32 v[208:209], v[64:65], v[208:209]
v_pk_mul_f32 v[210:211], v[66:67], v[210:211]
v_pk_mul_f32 v[224:225], v[80:81], v[224:225]
v_pk_mul_f32 v[226:227], v[82:83], v[226:227]
s_and_b32 m0, s51, s58
v_pk_add_f32 v[16:17], v[16:17], 1.0 op_sel_hi:[1,0]
v_pk_add_f32 v[18:19], v[18:19], 1.0 op_sel_hi:[1,0]
v_pk_add_f32 v[20:21], v[20:21], 1.0 op_sel_hi:[1,0]
v_pk_add_f32 v[22:23], v[22:23], 1.0 op_sel_hi:[1,0]
v_rcp_f32 v16, v16
v_rcp_f32 v17, v17
v_rcp_f32 v18, v18
v_rcp_f32 v19, v19
v_rcp_f32 v20, v20
v_rcp_f32 v21, v21
v_rcp_f32 v22, v22
v_rcp_f32 v23, v23
buffer_load_dwordx4 v13, s[12:15], s50 offen offset:0 sc1 lds
v_pk_mul_f32 v[16:17], v[16:17], v[208:209]
v_pk_mul_f32 v[18:19], v[18:19], v[210:211]
v_pk_mul_f32 v[20:21], v[20:21], v[224:225]
v_pk_mul_f32 v[22:23], v[22:23], v[226:227]
v_cvt_pk_bf16_f32 v64, v16, v17
v_cvt_pk_bf16_f32 v65, v18, v19
v_cvt_pk_bf16_f32 v66, v20, v21
v_cvt_pk_bf16_f32 v67, v22, v23
buffer_load_dwordx4 v13, s[12:15], s50 offen offset:1024 sc1 lds
s_add_u32 s36, s93, 148480
buffer_store_dwordx4 v[64:67], v13, s[20:23], s36 offen
v_accvgpr_read_b32 v6, a0
v_accvgpr_read_b32 v7, a1
v_accvgpr_read_b32 v8, a2
v_accvgpr_read_b32 v9, a3
v_pk_mul_f32 v[16:17], v[96:97], v[96:97]
v_pk_mul_f32 v[18:19], v[98:99], v[98:99]
v_pk_mul_f32 v[20:21], v[112:113], v[112:113]
v_pk_mul_f32 v[22:23], v[114:115], v[114:115]
v_pk_fma_f32 v[16:17], v[16:17], v[26:27], v[24:25]
v_pk_fma_f32 v[18:19], v[18:19], v[26:27], v[24:25]
v_pk_fma_f32 v[20:21], v[20:21], v[26:27], v[24:25]
v_pk_fma_f32 v[22:23], v[22:23], v[26:27], v[24:25]
v_pk_mul_f32 v[16:17], v[16:17], v[96:97]
v_pk_mul_f32 v[18:19], v[18:19], v[98:99]
v_pk_mul_f32 v[20:21], v[20:21], v[112:113]
v_pk_mul_f32 v[22:23], v[22:23], v[114:115]
v_exp_f32 v16, v16
v_exp_f32 v17, v17
v_exp_f32 v18, v18
v_exp_f32 v19, v19
v_exp_f32 v20, v20
v_exp_f32 v21, v21
v_exp_f32 v22, v22
v_exp_f32 v23, v23
v_pk_mul_f32 v[240:241], v[96:97], v[240:241]
v_pk_mul_f32 v[242:243], v[98:99], v[242:243]
v_pk_mul_f32 v[6:7], v[112:113], v[6:7]
v_pk_mul_f32 v[8:9], v[114:115], v[8:9]
s_bitset1_b32 m0, 16
v_pk_add_f32 v[16:17], v[16:17], 1.0 op_sel_hi:[1,0]
v_pk_add_f32 v[18:19], v[18:19], 1.0 op_sel_hi:[1,0]
v_pk_add_f32 v[20:21], v[20:21], 1.0 op_sel_hi:[1,0]
v_pk_add_f32 v[22:23], v[22:23], 1.0 op_sel_hi:[1,0]
v_rcp_f32 v16, v16
v_rcp_f32 v17, v17
v_rcp_f32 v18, v18
v_rcp_f32 v19, v19
v_rcp_f32 v20, v20
v_rcp_f32 v21, v21
v_rcp_f32 v22, v22
v_rcp_f32 v23, v23
s_add_u32 s51, s51, 8192
v_pk_mul_f32 v[16:17], v[16:17], v[240:241]
v_pk_mul_f32 v[18:19], v[18:19], v[242:243]
v_pk_mul_f32 v[20:21], v[20:21], v[6:7]
v_pk_mul_f32 v[22:23], v[22:23], v[8:9]
v_cvt_pk_bf16_f32 v96, v16, v17
v_cvt_pk_bf16_f32 v97, v18, v19
v_cvt_pk_bf16_f32 v98, v20, v21
v_cvt_pk_bf16_f32 v99, v22, v23
buffer_load_dwordx4 v13, s[24:27], s50 offen offset:0 sc1 lds
s_add_u32 s36, s93, 149504
buffer_store_dwordx4 v[96:99], v13, s[20:23], s36 offen
v_accvgpr_read_b32 v2, a16
v_accvgpr_read_b32 v3, a17
v_accvgpr_read_b32 v4, a18
v_accvgpr_read_b32 v5, a19
v_accvgpr_read_b32 v6, a64
v_accvgpr_read_b32 v7, a65
v_accvgpr_read_b32 v8, a66
v_accvgpr_read_b32 v9, a67
v_pk_mul_f32 v[16:17], v[128:129], v[128:129]
v_pk_mul_f32 v[18:19], v[130:131], v[130:131]
v_pk_mul_f32 v[20:21], v[144:145], v[144:145]
v_pk_mul_f32 v[22:23], v[146:147], v[146:147]
v_pk_fma_f32 v[16:17], v[16:17], v[26:27], v[24:25]
v_pk_fma_f32 v[18:19], v[18:19], v[26:27], v[24:25]
v_pk_fma_f32 v[20:21], v[20:21], v[26:27], v[24:25]
v_pk_fma_f32 v[22:23], v[22:23], v[26:27], v[24:25]
v_pk_mul_f32 v[16:17], v[16:17], v[128:129]
v_pk_mul_f32 v[18:19], v[18:19], v[130:131]
v_pk_mul_f32 v[20:21], v[20:21], v[144:145]
v_pk_mul_f32 v[22:23], v[22:23], v[146:147]
v_exp_f32 v16, v16
v_exp_f32 v17, v17
v_exp_f32 v18, v18
v_exp_f32 v19, v19
v_exp_f32 v20, v20
v_exp_f32 v21, v21
v_exp_f32 v22, v22
v_exp_f32 v23, v23
v_pk_mul_f32 v[2:3], v[128:129], v[2:3]
v_pk_mul_f32 v[4:5], v[130:131], v[4:5]
v_pk_mul_f32 v[6:7], v[144:145], v[6:7]
v_pk_mul_f32 v[8:9], v[146:147], v[8:9]
buffer_load_dwordx4 v13, s[24:27], s50 offen offset:1024 sc1 lds
v_pk_add_f32 v[16:17], v[16:17], 1.0 op_sel_hi:[1,0]
v_pk_add_f32 v[18:19], v[18:19], 1.0 op_sel_hi:[1,0]
v_pk_add_f32 v[20:21], v[20:21], 1.0 op_sel_hi:[1,0]
v_pk_add_f32 v[22:23], v[22:23], 1.0 op_sel_hi:[1,0]
v_rcp_f32 v16, v16
v_rcp_f32 v17, v17
v_rcp_f32 v18, v18
v_rcp_f32 v19, v19
v_rcp_f32 v20, v20
v_rcp_f32 v21, v21
v_rcp_f32 v22, v22
v_rcp_f32 v23, v23
s_add_u32 s50, s50, 16384
v_pk_mul_f32 v[16:17], v[16:17], v[2:3]
v_pk_mul_f32 v[18:19], v[18:19], v[4:5]
v_pk_mul_f32 v[20:21], v[20:21], v[6:7]
v_pk_mul_f32 v[22:23], v[22:23], v[8:9]
v_cvt_pk_bf16_f32 v128, v16, v17
v_cvt_pk_bf16_f32 v129, v18, v19
v_cvt_pk_bf16_f32 v130, v20, v21
v_cvt_pk_bf16_f32 v131, v22, v23
s_and_b32 m0, s51, s58
s_add_u32 s36, s93, 150528
buffer_store_dwordx4 v[128:131], v13, s[20:23], s36 offen
v_pk_mul_f32 v[16:17], v[36:37], v[36:37]
v_pk_mul_f32 v[18:19], v[38:39], v[38:39]
v_pk_mul_f32 v[20:21], v[52:53], v[52:53]
v_pk_mul_f32 v[22:23], v[54:55], v[54:55]
v_pk_fma_f32 v[16:17], v[16:17], v[26:27], v[24:25]
v_pk_fma_f32 v[18:19], v[18:19], v[26:27], v[24:25]
v_pk_fma_f32 v[20:21], v[20:21], v[26:27], v[24:25]
v_pk_fma_f32 v[22:23], v[22:23], v[26:27], v[24:25]
v_pk_mul_f32 v[16:17], v[16:17], v[36:37]
v_pk_mul_f32 v[18:19], v[18:19], v[38:39]
v_pk_mul_f32 v[20:21], v[20:21], v[52:53]
v_pk_mul_f32 v[22:23], v[22:23], v[54:55]
v_exp_f32 v16, v16
v_exp_f32 v17, v17
v_exp_f32 v18, v18
v_exp_f32 v19, v19
v_exp_f32 v20, v20
v_exp_f32 v21, v21
v_exp_f32 v22, v22
v_exp_f32 v23, v23
v_pk_mul_f32 v[180:181], v[36:37], v[180:181]
v_pk_mul_f32 v[182:183], v[38:39], v[182:183]
v_pk_mul_f32 v[196:197], v[52:53], v[196:197]
v_pk_mul_f32 v[198:199], v[54:55], v[198:199]
buffer_load_dwordx4 v13, s[12:15], s50 offen offset:0 sc1 lds
v_pk_add_f32 v[16:17], v[16:17], 1.0 op_sel_hi:[1,0]
v_pk_add_f32 v[18:19], v[18:19], 1.0 op_sel_hi:[1,0]
v_pk_add_f32 v[20:21], v[20:21], 1.0 op_sel_hi:[1,0]
v_pk_add_f32 v[22:23], v[22:23], 1.0 op_sel_hi:[1,0]
v_rcp_f32 v16, v16
v_rcp_f32 v17, v17
v_rcp_f32 v18, v18
v_rcp_f32 v19, v19
v_rcp_f32 v20, v20
v_rcp_f32 v21, v21
v_rcp_f32 v22, v22
v_rcp_f32 v23, v23
buffer_load_dwordx4 v13, s[12:15], s50 offen offset:1024 sc1 lds
v_pk_mul_f32 v[16:17], v[16:17], v[180:181]
v_pk_mul_f32 v[18:19], v[18:19], v[182:183]
v_pk_mul_f32 v[20:21], v[20:21], v[196:197]
v_pk_mul_f32 v[22:23], v[22:23], v[198:199]
v_cvt_pk_bf16_f32 v36, v16, v17
v_cvt_pk_bf16_f32 v37, v18, v19
v_cvt_pk_bf16_f32 v38, v20, v21
v_cvt_pk_bf16_f32 v39, v22, v23
s_bitset1_b32 m0, 16
s_add_u32 s36, s93, 294912
buffer_store_dwordx4 v[36:39], v13, s[20:23], s36 offen
v_pk_mul_f32 v[16:17], v[68:69], v[68:69]
v_pk_mul_f32 v[18:19], v[70:71], v[70:71]
v_pk_mul_f32 v[20:21], v[84:85], v[84:85]
v_pk_mul_f32 v[22:23], v[86:87], v[86:87]
v_pk_fma_f32 v[16:17], v[16:17], v[26:27], v[24:25]
v_pk_fma_f32 v[18:19], v[18:19], v[26:27], v[24:25]
v_pk_fma_f32 v[20:21], v[20:21], v[26:27], v[24:25]
v_pk_fma_f32 v[22:23], v[22:23], v[26:27], v[24:25]
v_pk_mul_f32 v[16:17], v[16:17], v[68:69]
v_pk_mul_f32 v[18:19], v[18:19], v[70:71]
v_pk_mul_f32 v[20:21], v[20:21], v[84:85]
v_pk_mul_f32 v[22:23], v[22:23], v[86:87]
v_exp_f32 v16, v16
v_exp_f32 v17, v17
v_exp_f32 v18, v18
v_exp_f32 v19, v19
v_exp_f32 v20, v20
v_exp_f32 v21, v21
v_exp_f32 v22, v22
v_exp_f32 v23, v23
v_pk_mul_f32 v[212:213], v[68:69], v[212:213]
v_pk_mul_f32 v[214:215], v[70:71], v[214:215]
v_pk_mul_f32 v[228:229], v[84:85], v[228:229]
v_pk_mul_f32 v[230:231], v[86:87], v[230:231]
s_add_u32 s51, s51, 8192
v_pk_add_f32 v[16:17], v[16:17], 1.0 op_sel_hi:[1,0]
v_pk_add_f32 v[18:19], v[18:19], 1.0 op_sel_hi:[1,0]
v_pk_add_f32 v[20:21], v[20:21], 1.0 op_sel_hi:[1,0]
v_pk_add_f32 v[22:23], v[22:23], 1.0 op_sel_hi:[1,0]
v_rcp_f32 v16, v16
v_rcp_f32 v17, v17
v_rcp_f32 v18, v18
v_rcp_f32 v19, v19
v_rcp_f32 v20, v20
v_rcp_f32 v21, v21
v_rcp_f32 v22, v22
v_rcp_f32 v23, v23
buffer_load_dwordx4 v13, s[24:27], s50 offen offset:0 sc1 lds
v_pk_mul_f32 v[16:17], v[16:17], v[212:213]
v_pk_mul_f32 v[18:19], v[18:19], v[214:215]
v_pk_mul_f32 v[20:21], v[20:21], v[228:229]
v_pk_mul_f32 v[22:23], v[22:23], v[230:231]
v_cvt_pk_bf16_f32 v68, v16, v17
v_cvt_pk_bf16_f32 v69, v18, v19
v_cvt_pk_bf16_f32 v70, v20, v21
v_cvt_pk_bf16_f32 v71, v22, v23
buffer_load_dwordx4 v13, s[24:27], s50 offen offset:1024 sc1 lds
s_add_u32 s36, s93, 295936
buffer_store_dwordx4 v[68:71], v13, s[20:23], s36 offen
v_accvgpr_read_b32 v6, a4
v_accvgpr_read_b32 v7, a5
v_accvgpr_read_b32 v8, a6
v_accvgpr_read_b32 v9, a7
v_pk_mul_f32 v[16:17], v[100:101], v[100:101]
v_pk_mul_f32 v[18:19], v[102:103], v[102:103]
v_pk_mul_f32 v[20:21], v[116:117], v[116:117]
v_pk_mul_f32 v[22:23], v[118:119], v[118:119]
v_pk_fma_f32 v[16:17], v[16:17], v[26:27], v[24:25]
v_pk_fma_f32 v[18:19], v[18:19], v[26:27], v[24:25]
v_pk_fma_f32 v[20:21], v[20:21], v[26:27], v[24:25]
v_pk_fma_f32 v[22:23], v[22:23], v[26:27], v[24:25]
v_pk_mul_f32 v[16:17], v[16:17], v[100:101]
v_pk_mul_f32 v[18:19], v[18:19], v[102:103]
v_pk_mul_f32 v[20:21], v[20:21], v[116:117]
v_pk_mul_f32 v[22:23], v[22:23], v[118:119]
v_exp_f32 v16, v16
v_exp_f32 v17, v17
v_exp_f32 v18, v18
v_exp_f32 v19, v19
v_exp_f32 v20, v20
v_exp_f32 v21, v21
v_exp_f32 v22, v22
v_exp_f32 v23, v23
v_pk_mul_f32 v[244:245], v[100:101], v[244:245]
v_pk_mul_f32 v[246:247], v[102:103], v[246:247]
v_pk_mul_f32 v[6:7], v[116:117], v[6:7]
v_pk_mul_f32 v[8:9], v[118:119], v[8:9]
s_add_u32 s50, s50, 16384
v_pk_add_f32 v[16:17], v[16:17], 1.0 op_sel_hi:[1,0]
v_pk_add_f32 v[18:19], v[18:19], 1.0 op_sel_hi:[1,0]
v_pk_add_f32 v[20:21], v[20:21], 1.0 op_sel_hi:[1,0]
v_pk_add_f32 v[22:23], v[22:23], 1.0 op_sel_hi:[1,0]
v_rcp_f32 v16, v16
v_rcp_f32 v17, v17
v_rcp_f32 v18, v18
v_rcp_f32 v19, v19
v_rcp_f32 v20, v20
v_rcp_f32 v21, v21
v_rcp_f32 v22, v22
v_rcp_f32 v23, v23
s_and_b32 m0, s51, s58
v_pk_mul_f32 v[16:17], v[16:17], v[244:245]
v_pk_mul_f32 v[18:19], v[18:19], v[246:247]
v_pk_mul_f32 v[20:21], v[20:21], v[6:7]
v_pk_mul_f32 v[22:23], v[22:23], v[8:9]
v_cvt_pk_bf16_f32 v100, v16, v17
v_cvt_pk_bf16_f32 v101, v18, v19
v_cvt_pk_bf16_f32 v102, v20, v21
v_cvt_pk_bf16_f32 v103, v22, v23
buffer_load_dwordx4 v13, s[12:15], s50 offen offset:0 sc1 lds
s_add_u32 s36, s93, 296960
buffer_store_dwordx4 v[100:103], v13, s[20:23], s36 offen
v_accvgpr_read_b32 v2, a20
v_accvgpr_read_b32 v3, a21
v_accvgpr_read_b32 v4, a22
v_accvgpr_read_b32 v5, a23
v_accvgpr_read_b32 v6, a68
v_accvgpr_read_b32 v7, a69
v_accvgpr_read_b32 v8, a70
v_accvgpr_read_b32 v9, a71
v_pk_mul_f32 v[16:17], v[132:133], v[132:133]
v_pk_mul_f32 v[18:19], v[134:135], v[134:135]
v_pk_mul_f32 v[20:21], v[148:149], v[148:149]
v_pk_mul_f32 v[22:23], v[150:151], v[150:151]
v_pk_fma_f32 v[16:17], v[16:17], v[26:27], v[24:25]
v_pk_fma_f32 v[18:19], v[18:19], v[26:27], v[24:25]
v_pk_fma_f32 v[20:21], v[20:21], v[26:27], v[24:25]
v_pk_fma_f32 v[22:23], v[22:23], v[26:27], v[24:25]
v_pk_mul_f32 v[16:17], v[16:17], v[132:133]
v_pk_mul_f32 v[18:19], v[18:19], v[134:135]
v_pk_mul_f32 v[20:21], v[20:21], v[148:149]
v_pk_mul_f32 v[22:23], v[22:23], v[150:151]
v_exp_f32 v16, v16
v_exp_f32 v17, v17
v_exp_f32 v18, v18
v_exp_f32 v19, v19
v_exp_f32 v20, v20
v_exp_f32 v21, v21
v_exp_f32 v22, v22
v_exp_f32 v23, v23
v_pk_mul_f32 v[2:3], v[132:133], v[2:3]
v_pk_mul_f32 v[4:5], v[134:135], v[4:5]
v_pk_mul_f32 v[6:7], v[148:149], v[6:7]
v_pk_mul_f32 v[8:9], v[150:151], v[8:9]
buffer_load_dwordx4 v13, s[12:15], s50 offen offset:1024 sc1 lds
v_pk_add_f32 v[16:17], v[16:17], 1.0 op_sel_hi:[1,0]
v_pk_add_f32 v[18:19], v[18:19], 1.0 op_sel_hi:[1,0]
v_pk_add_f32 v[20:21], v[20:21], 1.0 op_sel_hi:[1,0]
v_pk_add_f32 v[22:23], v[22:23], 1.0 op_sel_hi:[1,0]
v_rcp_f32 v16, v16
v_rcp_f32 v17, v17
v_rcp_f32 v18, v18
v_rcp_f32 v19, v19
v_rcp_f32 v20, v20
v_rcp_f32 v21, v21
v_rcp_f32 v22, v22
v_rcp_f32 v23, v23
s_bitset1_b32 m0, 16
v_pk_mul_f32 v[16:17], v[16:17], v[2:3]
v_pk_mul_f32 v[18:19], v[18:19], v[4:5]
v_pk_mul_f32 v[20:21], v[20:21], v[6:7]
v_pk_mul_f32 v[22:23], v[22:23], v[8:9]
v_cvt_pk_bf16_f32 v132, v16, v17
v_cvt_pk_bf16_f32 v133, v18, v19
v_cvt_pk_bf16_f32 v134, v20, v21
v_cvt_pk_bf16_f32 v135, v22, v23
s_add_u32 s51, s51, 8192
s_add_u32 s36, s93, 297984
buffer_store_dwordx4 v[132:135], v13, s[20:23], s36 offen
v_pk_mul_f32 v[16:17], v[40:41], v[40:41]
v_pk_mul_f32 v[18:19], v[42:43], v[42:43]
v_pk_mul_f32 v[20:21], v[56:57], v[56:57]
v_pk_mul_f32 v[22:23], v[58:59], v[58:59]
v_pk_fma_f32 v[16:17], v[16:17], v[26:27], v[24:25]
v_pk_fma_f32 v[18:19], v[18:19], v[26:27], v[24:25]
v_pk_fma_f32 v[20:21], v[20:21], v[26:27], v[24:25]
v_pk_fma_f32 v[22:23], v[22:23], v[26:27], v[24:25]
v_pk_mul_f32 v[16:17], v[16:17], v[40:41]
v_pk_mul_f32 v[18:19], v[18:19], v[42:43]
v_pk_mul_f32 v[20:21], v[20:21], v[56:57]
v_pk_mul_f32 v[22:23], v[22:23], v[58:59]
v_exp_f32 v16, v16
v_exp_f32 v17, v17
v_exp_f32 v18, v18
v_exp_f32 v19, v19
v_exp_f32 v20, v20
v_exp_f32 v21, v21
v_exp_f32 v22, v22
v_exp_f32 v23, v23
v_pk_mul_f32 v[184:185], v[40:41], v[184:185]
v_pk_mul_f32 v[186:187], v[42:43], v[186:187]
v_pk_mul_f32 v[200:201], v[56:57], v[200:201]
v_pk_mul_f32 v[202:203], v[58:59], v[202:203]
buffer_load_dwordx4 v13, s[24:27], s50 offen offset:0 sc1 lds
v_pk_add_f32 v[16:17], v[16:17], 1.0 op_sel_hi:[1,0]
v_pk_add_f32 v[18:19], v[18:19], 1.0 op_sel_hi:[1,0]
v_pk_add_f32 v[20:21], v[20:21], 1.0 op_sel_hi:[1,0]
v_pk_add_f32 v[22:23], v[22:23], 1.0 op_sel_hi:[1,0]
v_rcp_f32 v16, v16
v_rcp_f32 v17, v17
v_rcp_f32 v18, v18
v_rcp_f32 v19, v19
v_rcp_f32 v20, v20
v_rcp_f32 v21, v21
v_rcp_f32 v22, v22
v_rcp_f32 v23, v23
buffer_load_dwordx4 v13, s[24:27], s50 offen offset:1024 sc1 lds
v_pk_mul_f32 v[16:17], v[16:17], v[184:185]
v_pk_mul_f32 v[18:19], v[18:19], v[186:187]
v_pk_mul_f32 v[20:21], v[20:21], v[200:201]
v_pk_mul_f32 v[22:23], v[22:23], v[202:203]
v_cvt_pk_bf16_f32 v40, v16, v17
v_cvt_pk_bf16_f32 v41, v18, v19
v_cvt_pk_bf16_f32 v42, v20, v21
v_cvt_pk_bf16_f32 v43, v22, v23
s_add_u32 s50, s50, 16384
s_add_u32 s36, s93, 442368
buffer_store_dwordx4 v[40:43], v13, s[20:23], s36 offen
v_pk_mul_f32 v[16:17], v[72:73], v[72:73]
v_pk_mul_f32 v[18:19], v[74:75], v[74:75]
v_pk_mul_f32 v[20:21], v[88:89], v[88:89]
v_pk_mul_f32 v[22:23], v[90:91], v[90:91]
v_pk_fma_f32 v[16:17], v[16:17], v[26:27], v[24:25]
v_pk_fma_f32 v[18:19], v[18:19], v[26:27], v[24:25]
v_pk_fma_f32 v[20:21], v[20:21], v[26:27], v[24:25]
v_pk_fma_f32 v[22:23], v[22:23], v[26:27], v[24:25]
v_pk_mul_f32 v[16:17], v[16:17], v[72:73]
v_pk_mul_f32 v[18:19], v[18:19], v[74:75]
v_pk_mul_f32 v[20:21], v[20:21], v[88:89]
v_pk_mul_f32 v[22:23], v[22:23], v[90:91]
v_exp_f32 v16, v16
v_exp_f32 v17, v17
v_exp_f32 v18, v18
v_exp_f32 v19, v19
v_exp_f32 v20, v20
v_exp_f32 v21, v21
v_exp_f32 v22, v22
v_exp_f32 v23, v23
v_pk_mul_f32 v[216:217], v[72:73], v[216:217]
v_pk_mul_f32 v[218:219], v[74:75], v[218:219]
v_pk_mul_f32 v[232:233], v[88:89], v[232:233]
v_pk_mul_f32 v[234:235], v[90:91], v[234:235]
s_and_b32 m0, s51, s58
v_pk_add_f32 v[16:17], v[16:17], 1.0 op_sel_hi:[1,0]
v_pk_add_f32 v[18:19], v[18:19], 1.0 op_sel_hi:[1,0]
v_pk_add_f32 v[20:21], v[20:21], 1.0 op_sel_hi:[1,0]
v_pk_add_f32 v[22:23], v[22:23], 1.0 op_sel_hi:[1,0]
v_rcp_f32 v16, v16
v_rcp_f32 v17, v17
v_rcp_f32 v18, v18
v_rcp_f32 v19, v19
v_rcp_f32 v20, v20
v_rcp_f32 v21, v21
v_rcp_f32 v22, v22
v_rcp_f32 v23, v23
buffer_load_dwordx4 v13, s[12:15], s50 offen offset:0 sc1 lds
v_pk_mul_f32 v[16:17], v[16:17], v[216:217]
v_pk_mul_f32 v[18:19], v[18:19], v[218:219]
v_pk_mul_f32 v[20:21], v[20:21], v[232:233]
v_pk_mul_f32 v[22:23], v[22:23], v[234:235]
v_cvt_pk_bf16_f32 v72, v16, v17
v_cvt_pk_bf16_f32 v73, v18, v19
v_cvt_pk_bf16_f32 v74, v20, v21
v_cvt_pk_bf16_f32 v75, v22, v23
buffer_load_dwordx4 v13, s[12:15], s50 offen offset:1024 sc1 lds
s_add_u32 s36, s93, 443392
buffer_store_dwordx4 v[72:75], v13, s[20:23], s36 offen
v_accvgpr_read_b32 v6, a8
v_accvgpr_read_b32 v7, a9
v_accvgpr_read_b32 v8, a10
v_accvgpr_read_b32 v9, a11
v_pk_mul_f32 v[16:17], v[104:105], v[104:105]
v_pk_mul_f32 v[18:19], v[106:107], v[106:107]
v_pk_mul_f32 v[20:21], v[120:121], v[120:121]
v_pk_mul_f32 v[22:23], v[122:123], v[122:123]
v_pk_fma_f32 v[16:17], v[16:17], v[26:27], v[24:25]
v_pk_fma_f32 v[18:19], v[18:19], v[26:27], v[24:25]
v_pk_fma_f32 v[20:21], v[20:21], v[26:27], v[24:25]
v_pk_fma_f32 v[22:23], v[22:23], v[26:27], v[24:25]
v_pk_mul_f32 v[16:17], v[16:17], v[104:105]
v_pk_mul_f32 v[18:19], v[18:19], v[106:107]
v_pk_mul_f32 v[20:21], v[20:21], v[120:121]
v_pk_mul_f32 v[22:23], v[22:23], v[122:123]
v_exp_f32 v16, v16
v_exp_f32 v17, v17
v_exp_f32 v18, v18
v_exp_f32 v19, v19
v_exp_f32 v20, v20
v_exp_f32 v21, v21
v_exp_f32 v22, v22
v_exp_f32 v23, v23
v_pk_mul_f32 v[248:249], v[104:105], v[248:249]
v_pk_mul_f32 v[250:251], v[106:107], v[250:251]
v_pk_mul_f32 v[6:7], v[120:121], v[6:7]
v_pk_mul_f32 v[8:9], v[122:123], v[8:9]
s_bitset1_b32 m0, 16
v_pk_add_f32 v[16:17], v[16:17], 1.0 op_sel_hi:[1,0]
v_pk_add_f32 v[18:19], v[18:19], 1.0 op_sel_hi:[1,0]
v_pk_add_f32 v[20:21], v[20:21], 1.0 op_sel_hi:[1,0]
v_pk_add_f32 v[22:23], v[22:23], 1.0 op_sel_hi:[1,0]
v_rcp_f32 v16, v16
v_rcp_f32 v17, v17
v_rcp_f32 v18, v18
v_rcp_f32 v19, v19
v_rcp_f32 v20, v20
v_rcp_f32 v21, v21
v_rcp_f32 v22, v22
v_rcp_f32 v23, v23
s_add_u32 s51, s51, 8192
v_pk_mul_f32 v[16:17], v[16:17], v[248:249]
v_pk_mul_f32 v[18:19], v[18:19], v[250:251]
v_pk_mul_f32 v[20:21], v[20:21], v[6:7]
v_pk_mul_f32 v[22:23], v[22:23], v[8:9]
v_cvt_pk_bf16_f32 v104, v16, v17
v_cvt_pk_bf16_f32 v105, v18, v19
v_cvt_pk_bf16_f32 v106, v20, v21
v_cvt_pk_bf16_f32 v107, v22, v23
buffer_load_dwordx4 v13, s[24:27], s50 offen offset:0 sc1 lds
s_add_u32 s36, s93, 444416
buffer_store_dwordx4 v[104:107], v13, s[20:23], s36 offen
v_accvgpr_read_b32 v2, a24
v_accvgpr_read_b32 v3, a25
v_accvgpr_read_b32 v4, a26
v_accvgpr_read_b32 v5, a27
v_accvgpr_read_b32 v6, a72
v_accvgpr_read_b32 v7, a73
v_accvgpr_read_b32 v8, a74
v_accvgpr_read_b32 v9, a75
v_pk_mul_f32 v[16:17], v[136:137], v[136:137]
v_pk_mul_f32 v[18:19], v[138:139], v[138:139]
v_pk_mul_f32 v[20:21], v[152:153], v[152:153]
v_pk_mul_f32 v[22:23], v[154:155], v[154:155]
v_pk_fma_f32 v[16:17], v[16:17], v[26:27], v[24:25]
v_pk_fma_f32 v[18:19], v[18:19], v[26:27], v[24:25]
v_pk_fma_f32 v[20:21], v[20:21], v[26:27], v[24:25]
v_pk_fma_f32 v[22:23], v[22:23], v[26:27], v[24:25]
v_pk_mul_f32 v[16:17], v[16:17], v[136:137]
v_pk_mul_f32 v[18:19], v[18:19], v[138:139]
v_pk_mul_f32 v[20:21], v[20:21], v[152:153]
v_pk_mul_f32 v[22:23], v[22:23], v[154:155]
v_exp_f32 v16, v16
v_exp_f32 v17, v17
v_exp_f32 v18, v18
v_exp_f32 v19, v19
v_exp_f32 v20, v20
v_exp_f32 v21, v21
v_exp_f32 v22, v22
v_exp_f32 v23, v23
v_pk_mul_f32 v[2:3], v[136:137], v[2:3]
v_pk_mul_f32 v[4:5], v[138:139], v[4:5]
v_pk_mul_f32 v[6:7], v[152:153], v[6:7]
v_pk_mul_f32 v[8:9], v[154:155], v[8:9]
buffer_load_dwordx4 v13, s[24:27], s50 offen offset:1024 sc1 lds
v_pk_add_f32 v[16:17], v[16:17], 1.0 op_sel_hi:[1,0]
v_pk_add_f32 v[18:19], v[18:19], 1.0 op_sel_hi:[1,0]
v_pk_add_f32 v[20:21], v[20:21], 1.0 op_sel_hi:[1,0]
v_pk_add_f32 v[22:23], v[22:23], 1.0 op_sel_hi:[1,0]
v_rcp_f32 v16, v16
v_rcp_f32 v17, v17
v_rcp_f32 v18, v18
v_rcp_f32 v19, v19
v_rcp_f32 v20, v20
v_rcp_f32 v21, v21
v_rcp_f32 v22, v22
v_rcp_f32 v23, v23
s_add_u32 s50, s50, 16384
v_pk_mul_f32 v[16:17], v[16:17], v[2:3]
v_pk_mul_f32 v[18:19], v[18:19], v[4:5]
v_pk_mul_f32 v[20:21], v[20:21], v[6:7]
v_pk_mul_f32 v[22:23], v[22:23], v[8:9]
v_cvt_pk_bf16_f32 v136, v16, v17
v_cvt_pk_bf16_f32 v137, v18, v19
v_cvt_pk_bf16_f32 v138, v20, v21
v_cvt_pk_bf16_f32 v139, v22, v23
s_add_u32 s36, s93, 445440
buffer_store_dwordx4 v[136:139], v13, s[20:23], s36 offen
v_accvgpr_read_b32 v2, a76
v_accvgpr_read_b32 v3, a77
v_accvgpr_read_b32 v4, a78
v_accvgpr_read_b32 v5, a79
v_accvgpr_read_b32 v6, a80
v_accvgpr_read_b32 v7, a81
v_accvgpr_read_b32 v8, a82
v_accvgpr_read_b32 v9, a83
v_pk_mul_f32 v[16:17], v[156:157], v[156:157]
v_pk_mul_f32 v[18:19], v[158:159], v[158:159]
v_pk_mul_f32 v[20:21], v[160:161], v[160:161]
v_pk_mul_f32 v[22:23], v[162:163], v[162:163]
v_pk_fma_f32 v[16:17], v[16:17], v[26:27], v[24:25]
v_pk_fma_f32 v[18:19], v[18:19], v[26:27], v[24:25]
v_pk_fma_f32 v[20:21], v[20:21], v[26:27], v[24:25]
v_pk_fma_f32 v[22:23], v[22:23], v[26:27], v[24:25]
v_pk_mul_f32 v[16:17], v[16:17], v[156:157]
v_pk_mul_f32 v[18:19], v[18:19], v[158:159]
v_pk_mul_f32 v[20:21], v[20:21], v[160:161]
v_pk_mul_f32 v[22:23], v[22:23], v[162:163]
v_exp_f32 v16, v16
v_exp_f32 v17, v17
v_exp_f32 v18, v18
v_exp_f32 v19, v19
v_exp_f32 v20, v20
v_exp_f32 v21, v21
v_exp_f32 v22, v22
v_exp_f32 v23, v23
v_pk_mul_f32 v[2:3], v[156:157], v[2:3]
v_pk_mul_f32 v[4:5], v[158:159], v[4:5]
v_pk_mul_f32 v[6:7], v[160:161], v[6:7]
v_pk_mul_f32 v[8:9], v[162:163], v[8:9]
v_pk_add_f32 v[16:17], v[16:17], 1.0 op_sel_hi:[1,0]
v_pk_add_f32 v[18:19], v[18:19], 1.0 op_sel_hi:[1,0]
v_pk_add_f32 v[20:21], v[20:21], 1.0 op_sel_hi:[1,0]
v_pk_add_f32 v[22:23], v[22:23], 1.0 op_sel_hi:[1,0]
v_rcp_f32 v16, v16
v_rcp_f32 v17, v17
v_rcp_f32 v18, v18
v_rcp_f32 v19, v19
v_rcp_f32 v20, v20
v_rcp_f32 v21, v21
v_rcp_f32 v22, v22
v_rcp_f32 v23, v23
s_nop 0
v_pk_mul_f32 v[16:17], v[16:17], v[2:3]
v_pk_mul_f32 v[18:19], v[18:19], v[4:5]
v_pk_mul_f32 v[20:21], v[20:21], v[6:7]
v_pk_mul_f32 v[22:23], v[22:23], v[8:9]
v_cvt_pk_bf16_f32 v156, v16, v17
v_cvt_pk_bf16_f32 v157, v18, v19
v_cvt_pk_bf16_f32 v160, v20, v21
v_cvt_pk_bf16_f32 v161, v22, v23
s_add_u32 s36, s94, 0
buffer_store_dwordx2 v[156:157], v14, s[20:23], s36 offen
s_add_u32 s36, s94, 147456
buffer_store_dwordx2 v[160:161], v14, s[20:23], s36 offen
v_accvgpr_read_b32 v2, a84
v_accvgpr_read_b32 v3, a85
v_accvgpr_read_b32 v4, a86
v_accvgpr_read_b32 v5, a87
v_accvgpr_read_b32 v6, a88
v_accvgpr_read_b32 v7, a89
v_accvgpr_read_b32 v8, a90
v_accvgpr_read_b32 v9, a91
v_pk_mul_f32 v[16:17], v[164:165], v[164:165]
v_pk_mul_f32 v[18:19], v[166:167], v[166:167]
v_pk_mul_f32 v[20:21], v[168:169], v[168:169]
v_pk_mul_f32 v[22:23], v[170:171], v[170:171]
v_pk_fma_f32 v[16:17], v[16:17], v[26:27], v[24:25]
v_pk_fma_f32 v[18:19], v[18:19], v[26:27], v[24:25]
v_pk_fma_f32 v[20:21], v[20:21], v[26:27], v[24:25]
v_pk_fma_f32 v[22:23], v[22:23], v[26:27], v[24:25]
v_pk_mul_f32 v[16:17], v[16:17], v[164:165]
v_pk_mul_f32 v[18:19], v[18:19], v[166:167]
v_pk_mul_f32 v[20:21], v[20:21], v[168:169]
v_pk_mul_f32 v[22:23], v[22:23], v[170:171]
v_exp_f32 v16, v16
v_exp_f32 v17, v17
v_exp_f32 v18, v18
v_exp_f32 v19, v19
v_exp_f32 v20, v20
v_exp_f32 v21, v21
v_exp_f32 v22, v22
v_exp_f32 v23, v23
v_pk_mul_f32 v[2:3], v[164:165], v[2:3]
v_pk_mul_f32 v[4:5], v[166:167], v[4:5]
v_pk_mul_f32 v[6:7], v[168:169], v[6:7]
v_pk_mul_f32 v[8:9], v[170:171], v[8:9]
v_pk_add_f32 v[16:17], v[16:17], 1.0 op_sel_hi:[1,0]
v_pk_add_f32 v[18:19], v[18:19], 1.0 op_sel_hi:[1,0]
v_pk_add_f32 v[20:21], v[20:21], 1.0 op_sel_hi:[1,0]
v_pk_add_f32 v[22:23], v[22:23], 1.0 op_sel_hi:[1,0]
v_rcp_f32 v16, v16
v_rcp_f32 v17, v17
v_rcp_f32 v18, v18
v_rcp_f32 v19, v19
v_rcp_f32 v20, v20
v_rcp_f32 v21, v21
v_rcp_f32 v22, v22
v_rcp_f32 v23, v23
s_nop 0
v_pk_mul_f32 v[16:17], v[16:17], v[2:3]
v_pk_mul_f32 v[18:19], v[18:19], v[4:5]
v_pk_mul_f32 v[20:21], v[20:21], v[6:7]
v_pk_mul_f32 v[22:23], v[22:23], v[8:9]
v_cvt_pk_bf16_f32 v164, v16, v17
v_cvt_pk_bf16_f32 v165, v18, v19
v_cvt_pk_bf16_f32 v168, v20, v21
v_cvt_pk_bf16_f32 v169, v22, v23
s_add_u32 s36, s94, 294912
buffer_store_dwordx2 v[164:165], v14, s[20:23], s36 offen
s_add_u32 s36, s94, 442368
buffer_store_dwordx2 v[168:169], v14, s[20:23], s36 offen
s_lshl_b32 s3, s30, 7
s_lshl_b32 s4, s28, 5
s_add_u32 s52, s3, s4
s_sub_u32 s3, 1920, s3
s_add_u32 s53, s3, s4
v_lshrrev_b32 v130, 5, v0
v_lshlrev_b32 v130, 2, v130
v_and_b32 v131, 31, v0
v_sub_u32 v122, v130, v131
v_mov_b32 v126, 0xff800000
v_mov_b32 v120, v13
v_add_u32 v121, 90112, v13
v_mov_b32 v123, 0
v_mov_b32 v124, 0
v_mov_b32 v127, 65536
s_mov_b32 s56, 512.0
v_mov_b32 v80, 0
v_mov_b32 v96, 0
v_mov_b32 v81, 0
v_mov_b32 v97, 0
v_mov_b32 v82, 0
v_mov_b32 v98, 0
v_mov_b32 v83, 0
v_mov_b32 v99, 0
v_mov_b32 v84, 0
v_mov_b32 v100, 0
v_mov_b32 v85, 0
v_mov_b32 v101, 0
v_mov_b32 v86, 0
v_mov_b32 v102, 0
v_mov_b32 v87, 0
v_mov_b32 v103, 0
v_mov_b32 v88, 0
v_mov_b32 v104, 0
v_mov_b32 v89, 0
v_mov_b32 v105, 0
v_mov_b32 v90, 0
v_mov_b32 v106, 0
v_mov_b32 v91, 0
v_mov_b32 v107, 0
v_mov_b32 v92, 0
v_mov_b32 v108, 0
v_mov_b32 v93, 0
v_mov_b32 v109, 0
v_mov_b32 v94, 0
v_mov_b32 v110, 0
v_mov_b32 v95, 0
v_mov_b32 v111, 0
s_mov_b32 s8, s88
s_mov_b32 s9, s89
s_mov_b32 s10, 5308416
s_mov_b32 s11, 0x20000
s_mov_b32 s16, s82
s_mov_b32 s17, s83
s_mov_b32 s18, 4718592
s_mov_b32 s19, 0x20000
s_lshr_b32 s3, s28, 1
s_mul_i32 s33, s3, 9216
s_and_b32 s4, s28, 1
s_cmp_eq_u32 s4, 0
s_cselect_b32 s48, -1, 0
s_cselect_b32 s49, 0, -1
s_mul_i32 s39, s4, 147456
s_mul_i32 s5, s4, 320
s_mov_b32 s6, 3641
v_add_u32 v22, s5, v0
v_mul_u32_u24 v23, s6, v22
v_lshrrev_b32 v23, 16, v23
v_mul_u32_u24 v24, 18, v23
v_sub_u32 v24, v22, v24
v_mul_u32_u24 v23, 1152, v23
v_lshl_add_u32 v1, v24, 4, v23
v_add_u32 v22, s5, v0
v_add_u32 v22, 64, v22
v_mul_u32_u24 v23, s6, v22
v_lshrrev_b32 v23, 16, v23
v_mul_u32_u24 v24, 18, v23
v_sub_u32 v24, v22, v24
v_mul_u32_u24 v23, 1152, v23
v_lshl_add_u32 v2, v24, 4, v23
v_subrev_u32 v2, 1024, v2
v_add_u32 v22, s5, v0
v_add_u32 v22, 128, v22
v_mul_u32_u24 v23, s6, v22
v_lshrrev_b32 v23, 16, v23
v_mul_u32_u24 v24, 18, v23
v_sub_u32 v24, v22, v24
v_mul_u32_u24 v23, 1152, v23
v_lshl_add_u32 v3, v24, 4, v23
v_subrev_u32 v3, 2048, v3
v_add_u32 v22, s5, v0
v_add_u32 v22, 192, v22
v_mul_u32_u24 v23, s6, v22
v_lshrrev_b32 v23, 16, v23
v_mul_u32_u24 v24, 18, v23
v_sub_u32 v24, v22, v24
v_mul_u32_u24 v23, 1152, v23
v_lshl_add_u32 v4, v24, 4, v23
v_subrev_u32 v4, 3072, v4
v_add_u32 v22, 256, v0
v_mul_u32_u24 v23, s6, v22
v_lshrrev_b32 v23, 16, v23
v_mul_u32_u24 v24, 18, v23
v_sub_u32 v24, v22, v24
v_mul_u32_u24 v23, 1152, v23
v_lshl_add_u32 v5, v24, 4, v23
s_add_u32 s35, s33, 4096
s_mul_i32 s4, s4, 5120
s_add_u32 s33, s33, s4
s_lshl_b32 s4, s59, 2
s_lshl_b32 s5, s3, 1
s_add_u32 s4, s4, s5
s_mul_i32 s5, s4, 331776
s_mul_i32 s6, s61, 288
s_add_u32 s32, s5, s6
s_lshl_b32 s5, s4, 1
s_mul_i32 s7, s5, 147456
s_add_u32 s62, s7, s6
v_lshrrev_b32 v22, 4, v0
v_and_b32 v23, 15, v0
v_lshrrev_b32 v24, 2, v23
v_lshl_add_u32 v24, v22, 2, v24
v_mul_u32_u24 v24, 288, v24
v_and_b32 v23, 3, v23
v_lshl_add_u32 v24, v23, 3, v24
s_mul_i32 s6, s3, 9216
v_add_u32 v6, s6, v24
v_add_u32 v7, 55296, v6
v_add_u32 v8, 110592, v6
v_lshlrev_b32 v21, 4, v0
v_lshlrev_b32 v22, 3, v0
v_add_u32 v9, 0, v21
v_add_u32 v240, 0, v22
v_add_u32 v17, 0, v21
v_add_u32 v10, 147456, v21
v_add_u32 v241, 147456, v22
v_add_u32 v18, 131072, v21
v_add_u32 v11, 294912, v21
v_add_u32 v242, 294912, v22
v_add_u32 v19, 262144, v21
v_add_u32 v12, 442368, v21
v_add_u32 v243, 442368, v22
v_add_u32 v20, 393216, v21
s_lshl_b32 s6, s60, 3
s_and_b32 s7, s28, 1
s_lshl_b32 s7, s7, 2
s_add_u32 s6, s6, s7
s_mul_i32 s7, s6, 147456
s_mul_i32 s4, s4, 9216
s_add_u32 s7, s7, s4
s_add_u32 s34, s7, 41943040
s_lshl_b32 s7, s6, 17
s_lshl_b32 s5, s5, 12
s_add_u32 s7, s7, s5
s_add_u32 s38, s7, 67108864
s_lshl_b32 s4, s60, 2
s_add_u32 s4, s4, s61
s_lshl_b32 s4, s4, 2
s_and_b32 s5, s28, 1
s_lshl_b32 s5, s5, 1
s_add_u32 s4, s4, s5
s_add_u32 s4, s4, s3
s_mul_i32 s4, s4, 18432
s_mul_i32 s5, s59, 4718592
s_add_u32 s4, s4, s5
s_add_u32 s63, s4, 88080384
v_and_b32 v130, 31, v0
v_lshrrev_b32 v131, 4, v130
v_lshlrev_b32 v31, 17, v131
v_and_b32 v130, 15, v130
v_lshrrev_b32 v131, 5, v0
v_lshl_add_u32 v130, v131, 4, v130
v_lshl_add_u32 v31, v130, 4, v31
s_lshl_b32 s3, s30, 3
s_lshl_b32 s4, s28, 1
s_add_u32 s3, s3, s4
s_lshl_b32 s3, s3, 17
s_lshl_b32 s4, s29, 12
s_add_u32 s3, s3, s4
s_add_u32 s95, s3, 67108864
s_lshl_b32 s3, s30, 3
s_sub_u32 s3, 120, s3
s_lshl_b32 s4, s28, 1
s_add_u32 s3, s3, s4
s_lshl_b32 s3, s3, 17
s_lshl_b32 s4, s29, 12
s_add_u32 s3, s3, s4
s_add_u32 s96, s3, 67108864
s_waitcnt vmcnt(25)
s_barrier
ds_read_b128 a[128:131], v120 offset:0
ds_read_b128 a[132:135], v120 offset:1024
ds_read_b128 a[136:139], v120 offset:2048
ds_read_b128 a[140:143], v120 offset:3072
ds_read_b128 a[144:147], v120 offset:4096
ds_read_b128 a[148:151], v120 offset:5120
ds_read_b128 a[152:155], v120 offset:6144
ds_read_b128 a[156:159], v120 offset:7168
v_add_u32 v120, 8192, v120
v_and_b32 v120, 0xffff, v120
s_waitcnt lgkmcnt(4)
v_mfma_f32_32x32x16_bf16 v[32:47], a[128:131], a[192:195], v[80:95]
v_accvgpr_write_b32 a64, 0
v_accvgpr_write_b32 a65, 0
v_accvgpr_write_b32 a66, 0
v_accvgpr_write_b32 a67, 0
v_mfma_f32_32x32x16_bf16 v[32:47], a[132:135], a[196:199], v[32:47]
v_accvgpr_write_b32 a68, 0
v_accvgpr_write_b32 a69, 0
v_accvgpr_write_b32 a70, 0
v_accvgpr_write_b32 a71, 0
v_mfma_f32_32x32x16_bf16 v[32:47], a[136:139], a[208:211], v[32:47]
v_accvgpr_write_b32 a72, 0
v_accvgpr_write_b32 a73, 0
v_accvgpr_write_b32 a74, 0
v_accvgpr_write_b32 a75, 0
v_mfma_f32_32x32x16_bf16 v[32:47], a[140:143], a[212:215], v[32:47]
v_accvgpr_write_b32 a76, 0
v_accvgpr_write_b32 a77, 0
v_accvgpr_write_b32 a78, 0
v_accvgpr_write_b32 a79, 0
s_waitcnt lgkmcnt(0)
v_mfma_f32_32x32x16_bf16 v[32:47], a[144:147], a[224:227], v[32:47]
v_accvgpr_write_b32 a80, 0
v_accvgpr_write_b32 a81, 0
v_accvgpr_write_b32 a82, 0
v_accvgpr_write_b32 a83, 0
v_mfma_f32_32x32x16_bf16 v[32:47], a[148:151], a[228:231], v[32:47]
v_accvgpr_write_b32 a84, 0
v_accvgpr_write_b32 a85, 0
v_accvgpr_write_b32 a86, 0
v_accvgpr_write_b32 a87, 0
v_mfma_f32_32x32x16_bf16 v[32:47], a[152:155], a[240:243], v[32:47]
v_accvgpr_write_b32 a88, 0
v_accvgpr_write_b32 a89, 0
v_accvgpr_write_b32 a90, 0
v_accvgpr_write_b32 a91, 0
v_mfma_f32_32x32x16_bf16 v[32:47], a[156:159], a[244:247], v[32:47]
v_accvgpr_write_b32 a92, 0
v_accvgpr_write_b32 a93, 0
v_accvgpr_write_b32 a94, 0
v_accvgpr_write_b32 a95, 0
v_mfma_f32_32x32x16_bf16 v[48:63], a[128:131], a[200:203], v[96:111]
ds_read_b128 a[128:131], v120 offset:0
v_accvgpr_write_b32 a96, 0
v_accvgpr_write_b32 a97, 0
v_accvgpr_write_b32 a98, 0
v_accvgpr_write_b32 a99, 0
v_mfma_f32_32x32x16_bf16 v[48:63], a[132:135], a[204:207], v[48:63]
ds_read_b128 a[132:135], v120 offset:1024
v_accvgpr_write_b32 a100, 0
v_accvgpr_write_b32 a101, 0
v_accvgpr_write_b32 a102, 0
v_accvgpr_write_b32 a103, 0
v_mfma_f32_32x32x16_bf16 v[48:63], a[136:139], a[216:219], v[48:63]
ds_read_b128 a[136:139], v120 offset:2048
v_accvgpr_write_b32 a104, 0
v_accvgpr_write_b32 a105, 0
v_accvgpr_write_b32 a106, 0
v_accvgpr_write_b32 a107, 0
v_mfma_f32_32x32x16_bf16 v[48:63], a[140:143], a[220:223], v[48:63]
ds_read_b128 a[140:143], v120 offset:3072
v_accvgpr_write_b32 a108, 0
v_accvgpr_write_b32 a109, 0
v_accvgpr_write_b32 a110, 0
v_accvgpr_write_b32 a111, 0
s_waitcnt lgkmcnt(0)
v_mfma_f32_32x32x16_bf16 v[48:63], a[144:147], a[232:235], v[48:63]
ds_read_b128 a[144:147], v120 offset:4096
v_accvgpr_write_b32 a112, 0
v_accvgpr_write_b32 a113, 0
v_accvgpr_write_b32 a114, 0
v_accvgpr_write_b32 a115, 0
v_mfma_f32_32x32x16_bf16 v[48:63], a[148:151], a[236:239], v[48:63]
ds_read_b128 a[148:151], v120 offset:5120
v_accvgpr_write_b32 a116, 0
v_accvgpr_write_b32 a117, 0
v_accvgpr_write_b32 a118, 0
v_accvgpr_write_b32 a119, 0
v_mfma_f32_32x32x16_bf16 v[48:63], a[152:155], a[248:251], v[48:63]
ds_read_b128 a[152:155], v120 offset:6144
v_accvgpr_write_b32 a120, 0
v_accvgpr_write_b32 a121, 0
v_accvgpr_write_b32 a122, 0
v_accvgpr_write_b32 a123, 0
v_mfma_f32_32x32x16_bf16 v[48:63], a[156:159], a[252:255], v[48:63]
ds_read_b128 a[156:159], v120 offset:7168
v_accvgpr_write_b32 a124, 0
v_accvgpr_write_b32 a125, 0
v_accvgpr_write_b32 a126, 0
v_accvgpr_write_b32 a127, 0
v_add_u32 v120, 8192, v120
v_and_b32 v120, 0xffff, v120
s_nop 15
s_cmp_le_i32 s52, 0
s_cbranch_scc1 parallel_sum__compressed_kv_cla__geglu_ffn__prompt_kernel_mask_pro
parallel_sum__compressed_kv_cla__geglu_ffn__prompt_kernel_mask_pro_ret:
s_sub_i32 s52, s52, 32
v_max3_f32 v125, v32, v33, v34
v_max3_f32 v128, v48, v49, v50
v_max3_f32 v125, v125, v35, v36
v_max3_f32 v128, v128, v51, v52
v_max3_f32 v125, v125, v37, v38
v_max3_f32 v128, v128, v53, v54
v_max3_f32 v125, v125, v39, v40
v_max3_f32 v128, v128, v55, v56
v_max3_f32 v125, v125, v41, v42
v_max3_f32 v128, v128, v57, v58
v_max3_f32 v125, v125, v43, v44
v_max3_f32 v128, v128, v59, v60
v_max3_f32 v125, v125, v45, v46
v_max3_f32 v128, v128, v61, v62
v_max_f32 v125, v125, v47
v_max_f32 v128, v128, v63
v_mov_b32 v130, v125
v_mov_b32 v131, v125
v_mov_b32 v132, v128
v_mov_b32 v133, v128
s_nop 0
v_permlane32_swap_b32 v130, v131
v_permlane32_swap_b32 v132, v133
s_nop 0
v_max_f32 v130, v130, v131
v_max_f32 v132, v132, v133
v_ceil_f32 v130, v130
v_ceil_f32 v132, v132
v_sub_f32 v32, v32, v130
v_sub_f32 v48, v48, v132
v_sub_f32 v33, v33, v130
v_sub_f32 v49, v49, v132
v_sub_f32 v34, v34, v130
v_sub_f32 v50, v50, v132
v_sub_f32 v35, v35, v130
v_sub_f32 v51, v51, v132
v_sub_f32 v36, v36, v130
v_sub_f32 v52, v52, v132
v_sub_f32 v37, v37, v130
v_sub_f32 v53, v53, v132
v_sub_f32 v38, v38, v130
v_sub_f32 v54, v54, v132
v_sub_f32 v39, v39, v130
v_sub_f32 v55, v55, v132
v_sub_f32 v40, v40, v130
v_sub_f32 v56, v56, v132
v_sub_f32 v41, v41, v130
v_sub_f32 v57, v57, v132
v_sub_f32 v42, v42, v130
v_sub_f32 v58, v58, v132
v_sub_f32 v43, v43, v130
v_sub_f32 v59, v59, v132
v_sub_f32 v44, v44, v130
v_sub_f32 v60, v60, v132
v_sub_f32 v45, v45, v130
v_sub_f32 v61, v61, v132
v_sub_f32 v46, v46, v130
v_sub_f32 v62, v62, v132
v_sub_f32 v47, v47, v130
v_sub_f32 v63, v63, v132
v_sub_f32 v80, 0, v130
v_sub_f32 v96, 0, v132
v_sub_f32 v81, 0, v130
v_sub_f32 v97, 0, v132
v_sub_f32 v82, 0, v130
v_sub_f32 v98, 0, v132
v_sub_f32 v83, 0, v130
v_sub_f32 v99, 0, v132
v_sub_f32 v84, 0, v130
v_sub_f32 v100, 0, v132
v_sub_f32 v85, 0, v130
v_sub_f32 v101, 0, v132
v_sub_f32 v86, 0, v130
v_sub_f32 v102, 0, v132
v_sub_f32 v87, 0, v130
v_sub_f32 v103, 0, v132
v_sub_f32 v88, 0, v130
v_sub_f32 v104, 0, v132
v_sub_f32 v89, 0, v130
v_sub_f32 v105, 0, v132
v_sub_f32 v90, 0, v130
v_sub_f32 v106, 0, v132
v_sub_f32 v91, 0, v130
v_sub_f32 v107, 0, v132
v_sub_f32 v92, 0, v130
v_sub_f32 v108, 0, v132
v_sub_f32 v93, 0, v130
v_sub_f32 v109, 0, v132
v_sub_f32 v94, 0, v130
v_sub_f32 v110, 0, v132
v_sub_f32 v95, 0, v130
v_sub_f32 v111, 0, v132
s_nop 1
s_waitcnt vmcnt(0)
s_barrier
s_lshl_b32 s68, s101, 7
s_add_u32 s68, s68, 113263616
s_cmp_eq_u32 s28, 0
s_cselect_b32 s68, s68, 0x10000000
v_mov_b32 v141, 1
s_mov_b64 exec, 1
buffer_atomic_add v141, off, s[20:23], s68 sc0 sc1
s_mov_b64 exec, -1
v_exp_f32 v112, v32
v_exp_f32 v113, v33
s_and_b32 m0, s51, s58
v_add_f32 v128, v112, v113
v_cvt_pk_bf16_f32 v64, v112, v113
v_exp_f32 v114, v34
v_exp_f32 v115, v35
buffer_load_dwordx4 v13, s[12:15], s50 offen offset:0 sc1 lds
v_add_f32 v128, v128, v114
v_add_f32 v128, v128, v115
v_cvt_pk_bf16_f32 v65, v114, v115
v_exp_f32 v116, v36
v_exp_f32 v117, v37
buffer_load_dwordx4 v13, s[12:15], s50 offen offset:1024 sc1 lds
v_add_f32 v128, v128, v116
v_add_f32 v128, v128, v117
v_cvt_pk_bf16_f32 v68, v116, v117
v_exp_f32 v118, v38
v_exp_f32 v119, v39
s_bitset1_b32 m0, 16
v_add_f32 v128, v128, v118
v_add_f32 v128, v128, v119
v_cvt_pk_bf16_f32 v69, v118, v119
v_exp_f32 v112, v40
v_exp_f32 v113, v41
s_add_u32 s51, s51, 8192
v_add_f32 v128, v128, v112
v_add_f32 v128, v128, v113
v_cvt_pk_bf16_f32 v66, v112, v113
v_exp_f32 v114, v42
v_exp_f32 v115, v43
buffer_load_dwordx4 v13, s[24:27], s50 offen offset:0 sc1 lds
v_add_f32 v128, v128, v114
v_add_f32 v128, v128, v115
v_cvt_pk_bf16_f32 v67, v114, v115
v_exp_f32 v116, v44
v_exp_f32 v117, v45
buffer_load_dwordx4 v13, s[24:27], s50 offen offset:1024 sc1 lds
v_add_f32 v128, v128, v116
v_add_f32 v128, v128, v117
v_cvt_pk_bf16_f32 v70, v116, v117
v_exp_f32 v118, v46
v_exp_f32 v119, v47
s_add_u32 s50, s50, 16384
v_add_f32 v128, v128, v118
v_add_f32 v128, v128, v119
v_cvt_pk_bf16_f32 v71, v118, v119
v_cmp_lt_f32 vcc, s56, v128
s_nop 3
s_cbranch_vccnz parallel_sum__compressed_kv_cla__geglu_ffn__prompt_kernel_site_p0a_call
parallel_sum__compressed_kv_cla__geglu_ffn__prompt_kernel_site_p0a_ret:
v_add_f32 v123, v123, v128
v_mfma_f32_32x32x16_bf16 v[32:47], a[128:131], a[192:195], v[80:95]
ds_read_b128 a[160:163], v121 offset:0
v_exp_f32 v112, v48
v_exp_f32 v113, v49
v_mfma_f32_32x32x16_bf16 v[32:47], a[132:135], a[196:199], v[32:47]
ds_read_b128 a[168:171], v121 offset:2048
v_exp_f32 v114, v50
v_add_f32 v129, v112, v113
v_exp_f32 v115, v51
v_mfma_f32_32x32x16_bf16 v[32:47], a[136:139], a[208:211], v[32:47]
ds_read_b128 a[176:179], v121 offset:4096
v_add_f32 v129, v129, v114
v_add_f32 v129, v129, v115
v_exp_f32 v116, v52
v_cvt_pk_bf16_f32 v72, v112, v113
v_mfma_f32_32x32x16_bf16 v[32:47], a[140:143], a[212:215], v[32:47]
ds_read_b128 a[184:187], v121 offset:6144
v_exp_f32 v117, v53
v_add_f32 v129, v129, v116
v_add_f32 v129, v129, v117
s_waitcnt lgkmcnt(4)
v_mfma_f32_32x32x16_bf16 v[32:47], a[144:147], a[224:227], v[32:47]
ds_read_b128 a[164:167], v121 offset:1024
v_exp_f32 v118, v54
v_cvt_pk_bf16_f32 v73, v114, v115
v_exp_f32 v119, v55
v_mfma_f32_32x32x16_bf16 v[32:47], a[148:151], a[228:231], v[32:47]
ds_read_b128 a[172:175], v121 offset:3072
v_add_f32 v129, v129, v118
v_add_f32 v129, v129, v119
v_exp_f32 v112, v56
v_cvt_pk_bf16_f32 v76, v116, v117
v_mfma_f32_32x32x16_bf16 v[32:47], a[152:155], a[240:243], v[32:47]
ds_read_b128 a[180:183], v121 offset:5120
v_exp_f32 v113, v57
v_add_f32 v129, v129, v112
v_add_f32 v129, v129, v113
v_cvt_pk_bf16_f32 v77, v118, v119
v_mfma_f32_32x32x16_bf16 v[32:47], a[156:159], a[244:247], v[32:47]
ds_read_b128 a[188:191], v121 offset:7168
v_exp_f32 v114, v58
v_exp_f32 v115, v59
s_waitcnt lgkmcnt(4)
v_mfma_f32_32x32x16_bf16 a[0:15], a[160:163], v[64:67], 0
v_add_f32 v129, v129, v114
v_add_f32 v129, v129, v115
v_exp_f32 v116, v60
v_cvt_pk_bf16_f32 v74, v112, v113
v_mfma_f32_32x32x16_bf16 a[16:31], a[168:171], v[64:67], 0
s_cmp_le_i32 s52, 0
s_cbranch_scc1 parallel_sum__compressed_kv_cla__geglu_ffn__prompt_kernel_mask_p0b
parallel_sum__compressed_kv_cla__geglu_ffn__prompt_kernel_mask_p0b_ret:
v_exp_f32 v117, v61
v_add_f32 v129, v129, v116
v_add_f32 v129, v129, v117
v_cvt_pk_bf16_f32 v75, v114, v115
v_mfma_f32_32x32x16_bf16 a[32:47], a[176:179], v[64:67], 0
v_exp_f32 v118, v62
v_exp_f32 v119, v63
v_add_f32 v129, v129, v118
v_mfma_f32_32x32x16_bf16 a[48:63], a[184:187], v[64:67], 0
s_sub_i32 s52, s52, 32
v_add_f32 v129, v129, v119
v_cvt_pk_bf16_f32 v78, v116, v117
v_cvt_pk_bf16_f32 v79, v118, v119
s_waitcnt lgkmcnt(0)
v_mfma_f32_32x32x16_bf16 a[0:15], a[164:167], v[68:71], a[0:15]
v_mfma_f32_32x32x16_bf16 a[16:31], a[172:175], v[68:71], a[16:31]
v_mfma_f32_32x32x16_bf16 a[32:47], a[180:183], v[68:71], a[32:47]
v_cmp_lt_f32 vcc, s56, v129
v_mfma_f32_32x32x16_bf16 a[48:63], a[188:191], v[68:71], a[48:63]
s_cbranch_vccnz parallel_sum__compressed_kv_cla__geglu_ffn__prompt_kernel_site_p0b_call
parallel_sum__compressed_kv_cla__geglu_ffn__prompt_kernel_site_p0b_ret:
v_add_f32 v124, v124, v129
s_waitcnt vmcnt(4)
v_readfirstlane_b32 s70, v141
s_nop 3
s_add_u32 s70, s70, 1
s_cmp_eq_u32 s70, s97
s_cselect_b32 s99, 1, 0
s_cmp_eq_u32 s28, 0
s_cselect_b32 s99, s99, 0
s_cmp_eq_u32 s99, 0
s_cbranch_scc1 parallel_sum__compressed_kv_cla__geglu_ffn__prompt_kernel_rel6
buffer_wbl2 sc1
parallel_sum__compressed_kv_cla__geglu_ffn__prompt_kernel_rel6:
s_lshl_b32 s54, s30, 2
s_add_u32 s54, s54, 1
parallel_sum__compressed_kv_cla__geglu_ffn__prompt_kernel_p1:
s_waitcnt vmcnt(12)
v_mfma_f32_32x32x16_bf16 v[48:63], a[128:131], a[200:203], v[96:111]
s_barrier
v_mfma_f32_32x32x16_bf16 v[48:63], a[132:135], a[204:207], v[48:63]
s_and_b32 m0, s51, s58
v_exp_f32 v112, v32
v_exp_f32 v113, v33
v_mfma_f32_32x32x16_bf16 v[48:63], a[136:139], a[216:219], v[48:63]
buffer_load_dwordx4 v13, s[12:15], s50 offen offset:0 sc1 lds
v_exp_f32 v114, v34
v_add_f32 v128, v112, v113
v_mfma_f32_32x32x16_bf16 v[48:63], a[140:143], a[220:223], v[48:63]
v_exp_f32 v115, v35
v_add_f32 v128, v128, v114
v_add_f32 v128, v128, v115
v_mfma_f32_32x32x16_bf16 v[48:63], a[144:147], a[232:235], v[48:63]
buffer_load_dwordx4 v13, s[12:15], s50 offen offset:1024 sc1 lds
v_exp_f32 v116, v36
v_cvt_pk_bf16_f32 v64, v112, v113
v_mfma_f32_32x32x16_bf16 v[48:63], a[148:151], a[236:239], v[48:63]
ds_read_b128 a[128:131], v120 offset:0
v_exp_f32 v117, v37
v_add_f32 v128, v128, v116
v_add_f32 v128, v128, v117
v_cvt_pk_bf16_f32 v65, v114, v115
v_mfma_f32_32x32x16_bf16 v[48:63], a[152:155], a[248:251], v[48:63]
s_bitset1_b32 m0, 16
ds_read_b128 a[132:135], v120 offset:1024
buffer_load_dwordx4 v13, s[24:27], s50 offen offset:0 sc1 lds
v_exp_f32 v118, v38
v_cvt_pk_bf16_f32 v68, v116, v117
v_mfma_f32_32x32x16_bf16 v[48:63], a[156:159], a[252:255], v[48:63]
ds_read_b128 a[136:139], v120 offset:2048
v_exp_f32 v119, v39
v_add_f32 v128, v128, v118
v_add_f32 v128, v128, v119
v_mfma_f32_32x32x16_bf16 a[64:79], a[160:163], v[72:75], a[64:79]
s_add_u32 s51, s51, 8192
ds_read_b128 a[140:143], v120 offset:3072
buffer_load_dwordx4 v13, s[24:27], s50 offen offset:1024 sc1 lds
v_exp_f32 v112, v40
v_cvt_pk_bf16_f32 v69, v118, v119
v_mfma_f32_32x32x16_bf16 a[80:95], a[168:171], v[72:75], a[80:95]
v_exp_f32 v113, v41
v_add_f32 v128, v128, v112
v_exp_f32 v114, v42
v_mfma_f32_32x32x16_bf16 a[96:111], a[176:179], v[72:75], a[96:111]
s_add_u32 s50, s50, 16384
ds_read_b128 a[144:147], v120 offset:4096
v_add_f32 v128, v128, v113
v_exp_f32 v115, v43
v_add_f32 v128, v128, v114
v_add_f32 v128, v128, v115
v_mfma_f32_32x32x16_bf16 a[112:127], a[184:187], v[72:75], a[112:127]
ds_read_b128 a[148:151], v120 offset:5120
v_exp_f32 v116, v44
v_cvt_pk_bf16_f32 v66, v112, v113
v_add_f32 v128, v128, v116
v_mfma_f32_32x32x16_bf16 a[64:79], a[164:167], v[76:79], a[64:79]
ds_read_b128 a[152:155], v120 offset:6144
v_exp_f32 v117, v45
v_cvt_pk_bf16_f32 v67, v114, v115
v_exp_f32 v118, v46
v_mfma_f32_32x32x16_bf16 a[80:95], a[172:175], v[76:79], a[80:95]
ds_read_b128 a[156:159], v120 offset:7168
v_add_f32 v128, v128, v117
v_exp_f32 v119, v47
v_add_f32 v128, v128, v118
v_add_f32 v128, v128, v119
v_mfma_f32_32x32x16_bf16 a[96:111], a[180:183], v[76:79], a[96:111]
v_cvt_pk_bf16_f32 v70, v116, v117
v_cvt_pk_bf16_f32 v71, v118, v119
v_add_u32 v121, 8192, v121
v_and_or_b32 v121, v121, s58, v127
v_cmp_lt_f32 vcc, s56, v128
v_mfma_f32_32x32x16_bf16 a[112:127], a[188:191], v[76:79], a[112:127]
s_cbranch_vccnz parallel_sum__compressed_kv_cla__geglu_ffn__prompt_kernel_site_p1a_call
parallel_sum__compressed_kv_cla__geglu_ffn__prompt_kernel_site_p1a_ret:
v_add_f32 v123, v123, v128
s_waitcnt lgkmcnt(4)
v_mfma_f32_32x32x16_bf16 v[32:47], a[128:131], a[192:195], v[80:95]
ds_read_b128 a[160:163], v121 offset:0
v_add_u32 v120, 8192, v120
v_and_b32 v120, 0xffff, v120
v_exp_f32 v112, v48
v_mfma_f32_32x32x16_bf16 v[32:47], a[132:135], a[196:199], v[32:47]
ds_read_b128 a[168:171], v121 offset:2048
v_exp_f32 v113, v49
v_exp_f32 v114, v50
v_add_f32 v129, v112, v113
v_mfma_f32_32x32x16_bf16 v[32:47], a[136:139], a[208:211], v[32:47]
ds_read_b128 a[176:179], v121 offset:4096
v_exp_f32 v115, v51
v_add_f32 v129, v129, v114
v_add_f32 v129, v129, v115
v_cvt_pk_bf16_f32 v72, v112, v113
v_mfma_f32_32x32x16_bf16 v[32:47], a[140:143], a[212:215], v[32:47]
ds_read_b128 a[184:187], v121 offset:6144
v_exp_f32 v116, v52
v_exp_f32 v117, v53
s_waitcnt lgkmcnt(4)
v_mfma_f32_32x32x16_bf16 v[32:47], a[144:147], a[224:227], v[32:47]
ds_read_b128 a[164:167], v121 offset:1024
v_add_f32 v129, v129, v116
v_add_f32 v129, v129, v117
v_exp_f32 v118, v54
v_cvt_pk_bf16_f32 v73, v114, v115
v_mfma_f32_32x32x16_bf16 v[32:47], a[148:151], a[228:231], v[32:47]
ds_read_b128 a[172:175], v121 offset:3072
v_exp_f32 v119, v55
v_add_f32 v129, v129, v118
v_add_f32 v129, v129, v119
v_cvt_pk_bf16_f32 v76, v116, v117
v_mfma_f32_32x32x16_bf16 v[32:47], a[152:155], a[240:243], v[32:47]
ds_read_b128 a[180:183], v121 offset:5120
v_exp_f32 v112, v56
v_exp_f32 v113, v57
v_add_f32 v129, v129, v112
v_mfma_f32_32x32x16_bf16 v[32:47], a[156:159], a[244:247], v[32:47]
ds_read_b128 a[188:191], v121 offset:7168
v_add_f32 v129, v129, v113
v_exp_f32 v114, v58
v_cvt_pk_bf16_f32 v77, v118, v119
s_waitcnt lgkmcnt(4)
v_mfma_f32_32x32x16_bf16 a[0:15], a[160:163], v[64:67], a[0:15]
v_exp_f32 v115, v59
v_add_f32 v129, v129, v114
v_add_f32 v129, v129, v115
v_cvt_pk_bf16_f32 v74, v112, v113
v_mfma_f32_32x32x16_bf16 a[16:31], a[168:171], v[64:67], a[16:31]
s_cmp_le_i32 s52, 0
s_cbranch_scc1 parallel_sum__compressed_kv_cla__geglu_ffn__prompt_kernel_mask_p1b
parallel_sum__compressed_kv_cla__geglu_ffn__prompt_kernel_mask_p1b_ret:
v_exp_f32 v116, v60
v_exp_f32 v117, v61
v_add_f32 v129, v129, v116
v_mfma_f32_32x32x16_bf16 a[32:47], a[176:179], v[64:67], a[32:47]
v_add_f32 v129, v129, v117
v_exp_f32 v118, v62
v_cvt_pk_bf16_f32 v75, v114, v115
v_add_f32 v129, v129, v118
v_mfma_f32_32x32x16_bf16 a[48:63], a[184:187], v[64:67], a[48:63]
s_sub_i32 s52, s52, 32
v_exp_f32 v119, v63
v_cvt_pk_bf16_f32 v78, v116, v117
v_add_f32 v129, v129, v119
s_waitcnt lgkmcnt(0)
v_mfma_f32_32x32x16_bf16 a[0:15], a[164:167], v[68:71], a[0:15]
v_cvt_pk_bf16_f32 v79, v118, v119
v_mfma_f32_32x32x16_bf16 a[16:31], a[172:175], v[68:71], a[16:31]
v_mfma_f32_32x32x16_bf16 a[32:47], a[180:183], v[68:71], a[32:47]
v_cmp_lt_f32 vcc, s56, v129
v_mfma_f32_32x32x16_bf16 a[48:63], a[188:191], v[68:71], a[48:63]
s_cbranch_vccnz parallel_sum__compressed_kv_cla__geglu_ffn__prompt_kernel_site_p1b_call
parallel_sum__compressed_kv_cla__geglu_ffn__prompt_kernel_site_p1b_ret:
s_sub_u32 s54, s54, 1
v_add_f32 v124, v124, v129
s_cbranch_scc0 parallel_sum__compressed_kv_cla__geglu_ffn__prompt_kernel_p1
s_cmp_eq_u32 s99, 0
s_cbranch_scc1 parallel_sum__compressed_kv_cla__geglu_ffn__prompt_kernel_pub7
s_waitcnt vmcnt(8)
s_lshl_b32 s68, s101, 2
s_add_u32 s68, s68, 113264768
v_mov_b32 v130, s97
s_mov_b64 exec, 1
buffer_store_dword v130, off, s[20:23], s68 sc1
s_mov_b64 exec, -1
s_nop 1
parallel_sum__compressed_kv_cla__geglu_ffn__prompt_kernel_pub7:
s_waitcnt vmcnt(12)
v_mfma_f32_32x32x16_bf16 v[48:63], a[128:131], a[200:203], v[96:111]
s_barrier
v_mfma_f32_32x32x16_bf16 v[48:63], a[132:135], a[204:207], v[48:63]
s_and_b32 m0, s51, s58
v_exp_f32 v112, v32
v_exp_f32 v113, v33
v_mfma_f32_32x32x16_bf16 v[48:63], a[136:139], a[216:219], v[48:63]
buffer_load_dwordx4 v13, s[12:15], s50 offen offset:0 sc1 lds
v_exp_f32 v114, v34
v_add_f32 v128, v112, v113
v_mfma_f32_32x32x16_bf16 v[48:63], a[140:143], a[220:223], v[48:63]
v_exp_f32 v115, v35
v_add_f32 v128, v128, v114
v_add_f32 v128, v128, v115
v_mfma_f32_32x32x16_bf16 v[48:63], a[144:147], a[232:235], v[48:63]
buffer_load_dwordx4 v13, s[12:15], s50 offen offset:1024 sc1 lds
v_exp_f32 v116, v36
v_cvt_pk_bf16_f32 v64, v112, v113
v_mfma_f32_32x32x16_bf16 v[48:63], a[148:151], a[236:239], v[48:63]
ds_read_b128 a[128:131], v120 offset:0
v_exp_f32 v117, v37
v_add_f32 v128, v128, v116
v_add_f32 v128, v128, v117
v_cvt_pk_bf16_f32 v65, v114, v115
v_mfma_f32_32x32x16_bf16 v[48:63], a[152:155], a[248:251], v[48:63]
s_bitset1_b32 m0, 16
ds_read_b128 a[132:135], v120 offset:1024
buffer_load_dwordx4 v13, s[24:27], s50 offen offset:0 sc1 lds
v_exp_f32 v118, v38
v_cvt_pk_bf16_f32 v68, v116, v117
v_mfma_f32_32x32x16_bf16 v[48:63], a[156:159], a[252:255], v[48:63]
ds_read_b128 a[136:139], v120 offset:2048
v_exp_f32 v119, v39
v_add_f32 v128, v128, v118
v_add_f32 v128, v128, v119
v_mfma_f32_32x32x16_bf16 a[64:79], a[160:163], v[72:75], a[64:79]
s_add_u32 s51, s51, 8192
ds_read_b128 a[140:143], v120 offset:3072
buffer_load_dwordx4 v13, s[24:27], s50 offen offset:1024 sc1 lds
v_exp_f32 v112, v40
v_cvt_pk_bf16_f32 v69, v118, v119
v_mfma_f32_32x32x16_bf16 a[80:95], a[168:171], v[72:75], a[80:95]
v_exp_f32 v113, v41
v_add_f32 v128, v128, v112
v_exp_f32 v114, v42
v_mfma_f32_32x32x16_bf16 a[96:111], a[176:179], v[72:75], a[96:111]
s_add_u32 s50, s50, 16384
ds_read_b128 a[144:147], v120 offset:4096
v_add_f32 v128, v128, v113
v_exp_f32 v115, v43
v_add_f32 v128, v128, v114
v_add_f32 v128, v128, v115
v_mfma_f32_32x32x16_bf16 a[112:127], a[184:187], v[72:75], a[112:127]
ds_read_b128 a[148:151], v120 offset:5120
v_exp_f32 v116, v44
v_cvt_pk_bf16_f32 v66, v112, v113
v_add_f32 v128, v128, v116
v_mfma_f32_32x32x16_bf16 a[64:79], a[164:167], v[76:79], a[64:79]
ds_read_b128 a[152:155], v120 offset:6144
v_exp_f32 v117, v45
v_cvt_pk_bf16_f32 v67, v114, v115
v_exp_f32 v118, v46
v_mfma_f32_32x32x16_bf16 a[80:95], a[172:175], v[76:79], a[80:95]
ds_read_b128 a[156:159], v120 offset:7168
v_add_f32 v128, v128, v117
v_exp_f32 v119, v47
v_add_f32 v128, v128, v118
v_add_f32 v128, v128, v119
v_mfma_f32_32x32x16_bf16 a[96:111], a[180:183], v[76:79], a[96:111]
v_cvt_pk_bf16_f32 v70, v116, v117
v_cvt_pk_bf16_f32 v71, v118, v119
v_add_u32 v121, 8192, v121
v_and_or_b32 v121, v121, s58, v127
v_cmp_lt_f32 vcc, s56, v128
v_mfma_f32_32x32x16_bf16 a[112:127], a[188:191], v[76:79], a[112:127]
s_cbranch_vccnz parallel_sum__compressed_kv_cla__geglu_ffn__prompt_kernel_site_p1la_call
parallel_sum__compressed_kv_cla__geglu_ffn__prompt_kernel_site_p1la_ret:
v_add_f32 v123, v123, v128
v_add_u32 v120, 8192, v120
v_and_b32 v120, 0xffff, v120
s_lshl_b32 s3, s30, 7
s_sub_u32 s53, s53, s3
s_sub_u32 s53, s53, 128
s_waitcnt lgkmcnt(4)
v_mfma_f32_32x32x16_bf16 v[32:47], a[128:131], a[200:203], v[96:111]
ds_read_b128 a[160:163], v121 offset:0
v_exp_f32 v112, v48
v_exp_f32 v113, v49
v_mfma_f32_32x32x16_bf16 v[32:47], a[132:135], a[204:207], v[32:47]
ds_read_b128 a[168:171], v121 offset:2048
v_exp_f32 v114, v50
v_add_f32 v129, v112, v113
v_exp_f32 v115, v51
v_mfma_f32_32x32x16_bf16 v[32:47], a[136:139], a[216:219], v[32:47]
ds_read_b128 a[176:179], v121 offset:4096
v_add_f32 v129, v129, v114
v_add_f32 v129, v129, v115
v_exp_f32 v116, v52
v_cvt_pk_bf16_f32 v72, v112, v113
v_mfma_f32_32x32x16_bf16 v[32:47], a[140:143], a[220:223], v[32:47]
ds_read_b128 a[184:187], v121 offset:6144
v_exp_f32 v117, v53
v_add_f32 v129, v129, v116
v_add_f32 v129, v129, v117
s_waitcnt lgkmcnt(4)
v_mfma_f32_32x32x16_bf16 v[32:47], a[144:147], a[232:235], v[32:47]
ds_read_b128 a[164:167], v121 offset:1024
v_exp_f32 v118, v54
v_cvt_pk_bf16_f32 v73, v114, v115
v_exp_f32 v119, v55
v_mfma_f32_32x32x16_bf16 v[32:47], a[148:151], a[236:239], v[32:47]
ds_read_b128 a[172:175], v121 offset:3072
v_add_f32 v129, v129, v118
v_add_f32 v129, v129, v119
v_exp_f32 v112, v56
v_cvt_pk_bf16_f32 v76, v116, v117
v_mfma_f32_32x32x16_bf16 v[32:47], a[152:155], a[248:251], v[32:47]
ds_read_b128 a[180:183], v121 offset:5120
v_exp_f32 v113, v57
v_add_f32 v129, v129, v112
v_add_f32 v129, v129, v113
v_cvt_pk_bf16_f32 v77, v118, v119
v_mfma_f32_32x32x16_bf16 v[32:47], a[156:159], a[252:255], v[32:47]
ds_read_b128 a[188:191], v121 offset:7168
v_exp_f32 v114, v58
v_exp_f32 v115, v59
s_waitcnt lgkmcnt(4)
v_mfma_f32_32x32x16_bf16 a[0:15], a[160:163], v[64:67], a[0:15]
ds_read_b128 a[128:131], v120 offset:0
v_add_f32 v129, v129, v114
v_add_f32 v129, v129, v115
v_exp_f32 v116, v60
v_cvt_pk_bf16_f32 v74, v112, v113
v_mfma_f32_32x32x16_bf16 a[16:31], a[168:171], v[64:67], a[16:31]
s_cmp_le_i32 s53, 0
s_cbranch_scc1 parallel_sum__compressed_kv_cla__geglu_ffn__prompt_kernel_mask_p1lb
parallel_sum__compressed_kv_cla__geglu_ffn__prompt_kernel_mask_p1lb_ret:
v_exp_f32 v117, v61
v_add_f32 v129, v129, v116
v_add_f32 v129, v129, v117
v_cvt_pk_bf16_f32 v75, v114, v115
v_mfma_f32_32x32x16_bf16 a[32:47], a[176:179], v[64:67], a[32:47]
ds_read_b128 a[132:135], v120 offset:1024
ds_read_b128 a[136:139], v120 offset:2048
v_exp_f32 v118, v62
v_exp_f32 v119, v63
v_mfma_f32_32x32x16_bf16 a[48:63], a[184:187], v[64:67], a[48:63]
s_sub_i32 s53, s53, 32
ds_read_b128 a[140:143], v120 offset:3072
v_add_f32 v129, v129, v118
v_add_f32 v129, v129, v119
v_cvt_pk_bf16_f32 v78, v116, v117
v_cvt_pk_bf16_f32 v79, v118, v119
s_waitcnt lgkmcnt(4)
v_mfma_f32_32x32x16_bf16 a[0:15], a[164:167], v[68:71], a[0:15]
ds_read_b128 a[144:147], v120 offset:4096
v_mfma_f32_32x32x16_bf16 a[16:31], a[172:175], v[68:71], a[16:31]
ds_read_b128 a[148:151], v120 offset:5120
ds_read_b128 a[152:155], v120 offset:6144
v_mfma_f32_32x32x16_bf16 a[32:47], a[180:183], v[68:71], a[32:47]
ds_read_b128 a[156:159], v120 offset:7168
v_cmp_lt_f32 vcc, s56, v129
v_mfma_f32_32x32x16_bf16 a[48:63], a[188:191], v[68:71], a[48:63]
s_cbranch_vccnz parallel_sum__compressed_kv_cla__geglu_ffn__prompt_kernel_site_p1lb_call
parallel_sum__compressed_kv_cla__geglu_ffn__prompt_kernel_site_p1lb_ret:
v_add_f32 v124, v124, v129
v_add_u32 v120, 8192, v120
v_and_b32 v120, 0xffff, v120
s_lshl_b32 s54, s30, 2
s_sub_u32 s54, 28, s54
parallel_sum__compressed_kv_cla__geglu_ffn__prompt_kernel_p2:
s_waitcnt vmcnt(12)
s_waitcnt lgkmcnt(4)
v_mfma_f32_32x32x16_bf16 v[48:63], a[128:131], a[200:203], v[96:111]
s_barrier
v_mfma_f32_32x32x16_bf16 v[48:63], a[132:135], a[204:207], v[48:63]
s_and_b32 m0, s51, s58
ds_read_b128 a[160:163], v121 offset:0
v_exp_f32 v112, v32
v_exp_f32 v113, v33
v_mfma_f32_32x32x16_bf16 v[48:63], a[136:139], a[216:219], v[48:63]
ds_read_b128 a[168:171], v121 offset:2048
buffer_load_dwordx4 v13, s[12:15], s50 offen offset:0 sc1 lds
v_exp_f32 v114, v34
v_add_f32 v128, v112, v113
v_mfma_f32_32x32x16_bf16 v[48:63], a[140:143], a[220:223], v[48:63]
ds_read_b128 a[176:179], v121 offset:4096
v_exp_f32 v115, v35
v_add_f32 v128, v128, v114
v_add_f32 v128, v128, v115
s_waitcnt lgkmcnt(3)
v_mfma_f32_32x32x16_bf16 v[48:63], a[144:147], a[232:235], v[48:63]
ds_read_b128 a[184:187], v121 offset:6144
buffer_load_dwordx4 v13, s[12:15], s50 offen offset:1024 sc1 lds
v_exp_f32 v116, v36
v_cvt_pk_bf16_f32 v64, v112, v113
v_mfma_f32_32x32x16_bf16 v[48:63], a[148:151], a[236:239], v[48:63]
ds_read_b128 a[164:167], v121 offset:1024
v_exp_f32 v117, v37
v_add_f32 v128, v128, v116
v_add_f32 v128, v128, v117
v_cvt_pk_bf16_f32 v65, v114, v115
v_mfma_f32_32x32x16_bf16 v[48:63], a[152:155], a[248:251], v[48:63]
s_bitset1_b32 m0, 16
ds_read_b128 a[172:175], v121 offset:3072
buffer_load_dwordx4 v13, s[24:27], s50 offen offset:0 sc1 lds
v_exp_f32 v118, v38
v_cvt_pk_bf16_f32 v68, v116, v117
v_mfma_f32_32x32x16_bf16 v[48:63], a[156:159], a[252:255], v[48:63]
ds_read_b128 a[180:183], v121 offset:5120
v_exp_f32 v119, v39
v_add_f32 v128, v128, v118
v_add_f32 v128, v128, v119
s_waitcnt lgkmcnt(3)
v_mfma_f32_32x32x16_bf16 a[64:79], a[160:163], v[72:75], a[64:79]
s_add_u32 s51, s51, 8192
ds_read_b128 a[188:191], v121 offset:7168
buffer_load_dwordx4 v13, s[24:27], s50 offen offset:1024 sc1 lds
v_exp_f32 v112, v40
v_cvt_pk_bf16_f32 v69, v118, v119
v_mfma_f32_32x32x16_bf16 a[80:95], a[168:171], v[72:75], a[80:95]
s_cmp_le_i32 s53, 0
s_cbranch_scc1 parallel_sum__compressed_kv_cla__geglu_ffn__prompt_kernel_mask_p2a
parallel_sum__compressed_kv_cla__geglu_ffn__prompt_kernel_mask_p2a_ret:
v_exp_f32 v113, v41
v_add_f32 v128, v128, v112
v_exp_f32 v114, v42
v_mfma_f32_32x32x16_bf16 a[96:111], a[176:179], v[72:75], a[96:111]
s_add_u32 s50, s50, 16384
ds_read_b128 a[128:131], v120 offset:0
ds_read_b128 a[132:135], v120 offset:1024
v_add_f32 v128, v128, v113
v_exp_f32 v115, v43
v_add_f32 v128, v128, v114
v_mfma_f32_32x32x16_bf16 a[112:127], a[184:187], v[72:75], a[112:127]
s_sub_i32 s53, s53, 32
ds_read_b128 a[136:139], v120 offset:2048
v_add_f32 v128, v128, v115
v_exp_f32 v116, v44
v_cvt_pk_bf16_f32 v66, v112, v113
s_waitcnt lgkmcnt(3)
v_mfma_f32_32x32x16_bf16 a[64:79], a[164:167], v[76:79], a[64:79]
ds_read_b128 a[140:143], v120 offset:3072
v_exp_f32 v117, v45
v_add_f32 v128, v128, v116
v_add_f32 v128, v128, v117
v_cvt_pk_bf16_f32 v67, v114, v115
v_mfma_f32_32x32x16_bf16 a[80:95], a[172:175], v[76:79], a[80:95]
ds_read_b128 a[144:147], v120 offset:4096
ds_read_b128 a[148:151], v120 offset:5120
v_exp_f32 v118, v46
v_exp_f32 v119, v47
v_mfma_f32_32x32x16_bf16 a[96:111], a[180:183], v[76:79], a[96:111]
ds_read_b128 a[152:155], v120 offset:6144
v_add_f32 v128, v128, v118
v_add_f32 v128, v128, v119
v_cvt_pk_bf16_f32 v70, v116, v117
v_cvt_pk_bf16_f32 v71, v118, v119
v_cmp_lt_f32 vcc, s56, v128
v_mfma_f32_32x32x16_bf16 a[112:127], a[188:191], v[76:79], a[112:127]
s_cbranch_vccnz parallel_sum__compressed_kv_cla__geglu_ffn__prompt_kernel_site_p2a_call
parallel_sum__compressed_kv_cla__geglu_ffn__prompt_kernel_site_p2a_ret:
ds_read_b128 a[156:159], v120 offset:7168
v_add_f32 v124, v124, v128
s_waitcnt lgkmcnt(4)
v_mfma_f32_32x32x16_bf16 v[32:47], a[128:131], a[200:203], v[96:111]
ds_read_b128 a[160:163], v121 offset:8192
v_exp_f32 v112, v48
v_exp_f32 v113, v49
v_mfma_f32_32x32x16_bf16 v[32:47], a[132:135], a[204:207], v[32:47]
s_and_b32 m0, s51, s58
ds_read_b128 a[168:171], v121 offset:10240
v_exp_f32 v114, v50
v_add_f32 v129, v112, v113
v_exp_f32 v115, v51
v_mfma_f32_32x32x16_bf16 v[32:47], a[136:139], a[216:219], v[32:47]
ds_read_b128 a[176:179], v121 offset:12288
buffer_load_dwordx4 v13, s[12:15], s50 offen offset:0 sc1 lds
v_add_f32 v129, v129, v114
v_add_f32 v129, v129, v115
v_cvt_pk_bf16_f32 v72, v112, v113
v_mfma_f32_32x32x16_bf16 v[32:47], a[140:143], a[220:223], v[32:47]
ds_read_b128 a[184:187], v121 offset:14336
v_exp_f32 v116, v52
v_exp_f32 v117, v53
s_waitcnt lgkmcnt(4)
v_mfma_f32_32x32x16_bf16 v[32:47], a[144:147], a[232:235], v[32:47]
ds_read_b128 a[164:167], v121 offset:9216
buffer_load_dwordx4 v13, s[12:15], s50 offen offset:1024 sc1 lds
v_add_f32 v129, v129, v116
v_add_f32 v129, v129, v117
v_cvt_pk_bf16_f32 v73, v114, v115
v_mfma_f32_32x32x16_bf16 v[32:47], a[148:151], a[236:239], v[32:47]
ds_read_b128 a[172:175], v121 offset:11264
v_exp_f32 v118, v54
v_exp_f32 v119, v55
v_add_f32 v129, v129, v118
v_mfma_f32_32x32x16_bf16 v[32:47], a[152:155], a[248:251], v[32:47]
s_bitset1_b32 m0, 16
ds_read_b128 a[180:183], v121 offset:13312
buffer_load_dwordx4 v13, s[24:27], s50 offen offset:0 sc1 lds
v_add_f32 v129, v129, v119
v_exp_f32 v112, v56
v_mfma_f32_32x32x16_bf16 v[32:47], a[156:159], a[252:255], v[32:47]
ds_read_b128 a[188:191], v121 offset:15360
v_add_f32 v129, v129, v112
v_exp_f32 v113, v57
v_cvt_pk_bf16_f32 v76, v116, v117
s_waitcnt lgkmcnt(4)
v_mfma_f32_32x32x16_bf16 a[64:79], a[160:163], v[64:67], a[64:79]
s_add_u32 s51, s51, 8192
ds_read_b128 a[128:131], v120 offset:8192
buffer_load_dwordx4 v13, s[24:27], s50 offen offset:1024 sc1 lds
v_add_f32 v129, v129, v113
v_exp_f32 v114, v58
v_mfma_f32_32x32x16_bf16 a[80:95], a[168:171], v[64:67], a[80:95]
s_cmp_le_i32 s53, 0
s_cbranch_scc1 parallel_sum__compressed_kv_cla__geglu_ffn__prompt_kernel_mask_p2b
parallel_sum__compressed_kv_cla__geglu_ffn__prompt_kernel_mask_p2b_ret:
v_add_f32 v129, v129, v114
v_exp_f32 v115, v59
v_cvt_pk_bf16_f32 v77, v118, v119
v_add_f32 v129, v129, v115
v_mfma_f32_32x32x16_bf16 a[96:111], a[176:179], v[64:67], a[96:111]
s_add_u32 s50, s50, 16384
ds_read_b128 a[132:135], v120 offset:9216
ds_read_b128 a[136:139], v120 offset:10240
v_exp_f32 v116, v60
v_cvt_pk_bf16_f32 v74, v112, v113
v_add_f32 v129, v129, v116
v_mfma_f32_32x32x16_bf16 a[112:127], a[184:187], v[64:67], a[112:127]
s_sub_i32 s53, s53, 32
ds_read_b128 a[140:143], v120 offset:11264
v_exp_f32 v117, v61
v_cvt_pk_bf16_f32 v75, v114, v115
v_add_f32 v129, v129, v117
s_waitcnt lgkmcnt(4)
v_mfma_f32_32x32x16_bf16 a[64:79], a[164:167], v[68:71], a[64:79]
ds_read_b128 a[144:147], v120 offset:12288
v_exp_f32 v118, v62
v_exp_f32 v119, v63
v_add_f32 v129, v129, v118
v_mfma_f32_32x32x16_bf16 a[80:95], a[172:175], v[68:71], a[80:95]
ds_read_b128 a[148:151], v120 offset:13312
ds_read_b128 a[152:155], v120 offset:14336
v_add_f32 v129, v129, v119
v_cvt_pk_bf16_f32 v78, v116, v117
v_cvt_pk_bf16_f32 v79, v118, v119
v_add_u32 v121, 16384, v121
v_mfma_f32_32x32x16_bf16 a[96:111], a[180:183], v[68:71], a[96:111]
ds_read_b128 a[156:159], v120 offset:15360
v_and_or_b32 v121, v121, s58, v127
v_cmp_lt_f32 vcc, s56, v129
v_mfma_f32_32x32x16_bf16 a[112:127], a[188:191], v[68:71], a[112:127]
s_cbranch_vccnz parallel_sum__compressed_kv_cla__geglu_ffn__prompt_kernel_site_p2b_call
parallel_sum__compressed_kv_cla__geglu_ffn__prompt_kernel_site_p2b_ret:
s_sub_u32 s54, s54, 1
v_add_f32 v124, v124, v129
v_add_u32 v120, 16384, v120
v_and_b32 v120, 0xffff, v120
s_cbranch_scc0 parallel_sum__compressed_kv_cla__geglu_ffn__prompt_kernel_p2
s_lshr_b32 s98, s60, 1
s_mov_b32 s68, 113264768
v_and_b32 v140, 7, v0
v_lshlrev_b32 v140, 2, v140
buffer_load_dword v140, v140, s[20:23], s68 offen sc1
s_getpc_b64 s[4:5]
parallel_sum__compressed_kv_cla__geglu_ffn__prompt_kernel_pc13:
s_add_u32 s4, s4, parallel_sum__compressed_kv_cla__geglu_ffn__prompt_kernel_L_fin-parallel_sum__compressed_kv_cla__geglu_ffn__prompt_kernel_pc13
s_addc_u32 s5, s5, 0
s_lshr_b32 s3, s2, 3
s_lshl_b32 s3, s3, 2
s_add_u32 s3, s3, s28
s_mul_i32 s3, s3, 3
v_add_u32 v142, s3, v0
v_lshlrev_b32 v142, 7, v142
v_mov_b32 v143, parallel_sum__compressed_kv_cla__geglu_ffn__prompt_kernel_end-parallel_sum__compressed_kv_cla__geglu_ffn__prompt_kernel_L_fin
v_cmp_lt_u32 vcc, v142, v143
s_nop 1
v_cndmask_b32 v142, 0, v142, vcc
v_mov_b32 v143, s5
v_add_co_u32 v142, vcc, s4, v142
s_nop 1
v_addc_co_u32 v143, vcc, 0, v143, vcc
s_mov_b64 exec, 7
global_load_dword v144, v[142:143], off
s_mov_b64 exec, -1
s_waitcnt vmcnt(0)
s_waitcnt lgkmcnt(4)
v_mfma_f32_32x32x16_bf16 v[48:63], a[128:131], a[200:203], v[96:111]
s_barrier
v_mfma_f32_32x32x16_bf16 v[48:63], a[132:135], a[204:207], v[48:63]
ds_read_b128 a[160:163], v121 offset:0
v_exp_f32 v112, v32
v_exp_f32 v113, v33
v_mfma_f32_32x32x16_bf16 v[48:63], a[136:139], a[216:219], v[48:63]
ds_read_b128 a[168:171], v121 offset:2048
v_exp_f32 v114, v34
v_add_f32 v128, v112, v113
v_exp_f32 v115, v35
v_mfma_f32_32x32x16_bf16 v[48:63], a[140:143], a[220:223], v[48:63]
ds_read_b128 a[176:179], v121 offset:4096
v_add_f32 v128, v128, v114
v_add_f32 v128, v128, v115
v_exp_f32 v116, v36
s_waitcnt lgkmcnt(3)
v_mfma_f32_32x32x16_bf16 v[48:63], a[144:147], a[232:235], v[48:63]
ds_read_b128 a[184:187], v121 offset:6144
v_add_f32 v128, v128, v116
v_exp_f32 v117, v37
v_cvt_pk_bf16_f32 v64, v112, v113
v_add_f32 v128, v128, v117
v_mfma_f32_32x32x16_bf16 v[48:63], a[148:151], a[236:239], v[48:63]
ds_read_b128 a[164:167], v121 offset:1024
v_exp_f32 v118, v38
v_cvt_pk_bf16_f32 v65, v114, v115
v_exp_f32 v119, v39
v_mfma_f32_32x32x16_bf16 v[48:63], a[152:155], a[248:251], v[48:63]
ds_read_b128 a[172:175], v121 offset:3072
v_add_f32 v128, v128, v118
v_add_f32 v128, v128, v119
v_exp_f32 v112, v40
v_cvt_pk_bf16_f32 v68, v116, v117
v_mfma_f32_32x32x16_bf16 v[48:63], a[156:159], a[252:255], v[48:63]
ds_read_b128 a[180:183], v121 offset:5120
v_exp_f32 v113, v41
v_add_f32 v128, v128, v112
v_add_f32 v128, v128, v113
s_waitcnt lgkmcnt(3)
v_mfma_f32_32x32x16_bf16 a[64:79], a[160:163], v[72:75], a[64:79]
ds_read_b128 a[188:191], v121 offset:7168
v_exp_f32 v114, v42
v_cvt_pk_bf16_f32 v69, v118, v119
v_exp_f32 v115, v43
v_mfma_f32_32x32x16_bf16 a[80:95], a[168:171], v[72:75], a[80:95]
s_cmp_le_i32 s53, 0
s_cbranch_scc1 parallel_sum__compressed_kv_cla__geglu_ffn__prompt_kernel_mask_p2la
parallel_sum__compressed_kv_cla__geglu_ffn__prompt_kernel_mask_p2la_ret:
v_add_f32 v128, v128, v114
v_add_f32 v128, v128, v115
v_exp_f32 v116, v44
v_cvt_pk_bf16_f32 v66, v112, v113
v_mfma_f32_32x32x16_bf16 a[96:111], a[176:179], v[72:75], a[96:111]
ds_read_b128 a[128:131], v121 offset:8192
ds_read_b128 a[136:139], v121 offset:10240
v_exp_f32 v117, v45
v_add_f32 v128, v128, v116
v_add_f32 v128, v128, v117
v_mfma_f32_32x32x16_bf16 a[112:127], a[184:187], v[72:75], a[112:127]
s_sub_i32 s53, s53, 32
ds_read_b128 a[144:147], v121 offset:12288
v_exp_f32 v118, v46
v_cvt_pk_bf16_f32 v67, v114, v115
v_add_f32 v128, v128, v118
s_waitcnt lgkmcnt(3)
v_mfma_f32_32x32x16_bf16 a[64:79], a[164:167], v[76:79], a[64:79]
ds_read_b128 a[152:155], v121 offset:14336
v_exp_f32 v119, v47
v_cvt_pk_bf16_f32 v70, v116, v117
v_add_f32 v128, v128, v119
v_cvt_pk_bf16_f32 v71, v118, v119
v_mfma_f32_32x32x16_bf16 a[80:95], a[172:175], v[76:79], a[80:95]
ds_read_b128 a[132:135], v121 offset:9216
ds_read_b128 a[140:143], v121 offset:11264
v_mfma_f32_32x32x16_bf16 a[96:111], a[180:183], v[76:79], a[96:111]
ds_read_b128 a[148:151], v121 offset:13312
v_cmp_lt_f32 vcc, s56, v128
v_mfma_f32_32x32x16_bf16 a[112:127], a[188:191], v[76:79], a[112:127]
s_cbranch_vccnz parallel_sum__compressed_kv_cla__geglu_ffn__prompt_kernel_site_p2la_call
parallel_sum__compressed_kv_cla__geglu_ffn__prompt_kernel_site_p2la_ret:
ds_read_b128 a[156:159], v121 offset:15360
v_add_f32 v124, v124, v128
v_add_u32 v121, 16384, v121
v_and_or_b32 v121, v121, s58, v127
s_waitcnt lgkmcnt(4)
v_mfma_f32_32x32x16_bf16 a[64:79], a[128:131], v[64:67], a[64:79]
ds_read_b128 a[160:163], v121 offset:0
v_exp_f32 v112, v48
v_exp_f32 v113, v49
v_mfma_f32_32x32x16_bf16 a[80:95], a[136:139], v[64:67], a[80:95]
ds_read_b128 a[168:171], v121 offset:2048
v_exp_f32 v114, v50
v_exp_f32 v115, v51
v_add_f32 v129, v112, v113
v_cvt_pk_bf16_f32 v72, v112, v113
v_add_f32 v129, v129, v114
v_mfma_f32_32x32x16_bf16 a[96:111], a[144:147], v[64:67], a[96:111]
ds_read_b128 a[176:179], v121 offset:4096
v_exp_f32 v116, v52
v_exp_f32 v117, v53
v_add_f32 v129, v129, v115
v_cvt_pk_bf16_f32 v73, v114, v115
v_add_f32 v129, v129, v116
v_mfma_f32_32x32x16_bf16 a[112:127], a[152:155], v[64:67], a[112:127]
ds_read_b128 a[184:187], v121 offset:6144
v_exp_f32 v118, v54
v_exp_f32 v119, v55
v_add_f32 v129, v129, v117
v_cvt_pk_bf16_f32 v76, v116, v117
v_add_f32 v129, v129, v118
s_waitcnt lgkmcnt(4)
v_mfma_f32_32x32x16_bf16 a[64:79], a[132:135], v[68:71], a[64:79]
ds_read_b128 a[164:167], v121 offset:1024
v_exp_f32 v112, v56
v_exp_f32 v113, v57
v_add_f32 v129, v129, v119
v_cvt_pk_bf16_f32 v77, v118, v119
v_add_f32 v129, v129, v112
v_mfma_f32_32x32x16_bf16 a[80:95], a[140:143], v[68:71], a[80:95]
ds_read_b128 a[172:175], v121 offset:3072
v_exp_f32 v114, v58
v_exp_f32 v115, v59
v_add_f32 v129, v129, v113
v_cvt_pk_bf16_f32 v74, v112, v113
v_add_f32 v129, v129, v114
v_mfma_f32_32x32x16_bf16 a[96:111], a[148:151], v[68:71], a[96:111]
ds_read_b128 a[180:183], v121 offset:5120
v_exp_f32 v116, v60
v_exp_f32 v117, v61
v_add_f32 v129, v129, v115
v_cvt_pk_bf16_f32 v75, v114, v115
v_add_f32 v129, v129, v116
v_mfma_f32_32x32x16_bf16 a[112:127], a[156:159], v[68:71], a[112:127]
ds_read_b128 a[188:191], v121 offset:7168
v_exp_f32 v118, v62
v_exp_f32 v119, v63
v_add_f32 v129, v129, v117
v_cvt_pk_bf16_f32 v78, v116, v117
v_add_f32 v129, v129, v118
s_nop 0
v_add_f32 v129, v129, v119
v_cvt_pk_bf16_f32 v79, v118, v119
v_cmp_lt_f32 vcc, s56, v129
s_nop 3
s_cbranch_vccnz parallel_sum__compressed_kv_cla__geglu_ffn__prompt_kernel_site_p2lb_call
parallel_sum__compressed_kv_cla__geglu_ffn__prompt_kernel_site_p2lb_ret:
v_add_f32 v124, v124, v129
s_nop 1
s_waitcnt lgkmcnt(4)
v_mfma_f32_32x32x16_bf16 a[64:79], a[160:163], v[72:75], a[64:79]
v_mfma_f32_32x32x16_bf16 a[80:95], a[168:171], v[72:75], a[80:95]
v_mfma_f32_32x32x16_bf16 a[96:111], a[176:179], v[72:75], a[96:111]
v_mfma_f32_32x32x16_bf16 a[112:127], a[184:187], v[72:75], a[112:127]
s_waitcnt lgkmcnt(0)
v_mfma_f32_32x32x16_bf16 a[64:79], a[164:167], v[76:79], a[64:79]
v_mfma_f32_32x32x16_bf16 a[80:95], a[172:175], v[76:79], a[80:95]
v_mfma_f32_32x32x16_bf16 a[96:111], a[180:183], v[76:79], a[96:111]
v_mfma_f32_32x32x16_bf16 a[112:127], a[188:191], v[76:79], a[112:127]
parallel_sum__compressed_kv_cla__geglu_ffn__prompt_kernel_L_fin:
s_waitcnt lgkmcnt(0)
s_barrier
s_nop 1
v_add_u32_dpp v140, v140, v140 quad_perm:[1,0,3,2] row_mask:0xf bank_mask:0xf
s_nop 1
v_add_u32_dpp v140, v140, v140 quad_perm:[2,3,0,1] row_mask:0xf bank_mask:0xf
s_nop 1
v_add_u32_dpp v140, v140, v140 row_half_mirror row_mask:0xf bank_mask:0xf
v_cmp_ne_u32 vcc, 0x100, v140
s_nop 4
s_cbranch_vccnz parallel_sum__compressed_kv_cla__geglu_ffn__prompt_kernel_spin8
parallel_sum__compressed_kv_cla__geglu_ffn__prompt_kernel_spin8_ret:
s_nop 7
v_mov_b32 v130, v123
v_mov_b32 v131, v123
s_nop 1
v_permlane32_swap_b32 v130, v131
s_nop 1
v_add_f32 v130, v130, v131
v_rcp_f32 v132, v130
s_nop 0
v_mov_b32 v133, v132
v_accvgpr_read_b32 v32, a0
v_accvgpr_read_b32 v33, a1
v_accvgpr_read_b32 v34, a2
v_accvgpr_read_b32 v35, a3
v_accvgpr_read_b32 v36, a4
v_accvgpr_read_b32 v37, a5
v_accvgpr_read_b32 v38, a6
v_accvgpr_read_b32 v39, a7
s_add_u32 m0, s33, 0
s_add_u32 s36, s32, 0
v_accvgpr_read_b32 v40, a8
v_accvgpr_read_b32 v41, a9
v_accvgpr_read_b32 v42, a10
v_accvgpr_read_b32 v43, a11
v_accvgpr_read_b32 v44, a12
v_accvgpr_read_b32 v45, a13
v_accvgpr_read_b32 v46, a14
v_accvgpr_read_b32 v47, a15
buffer_load_dwordx4 v1, s[8:11], s36 offen offset:0 lds
buffer_load_dwordx4 v2, s[8:11], s36 offen offset:1024 lds
v_pk_mul_f32 v[32:33], v[32:33], v[132:133]
v_pk_mul_f32 v[34:35], v[34:35], v[132:133]
v_pk_mul_f32 v[36:37], v[36:37], v[132:133]
v_pk_mul_f32 v[38:39], v[38:39], v[132:133]
v_pk_mul_f32 v[40:41], v[40:41], v[132:133]
v_pk_mul_f32 v[42:43], v[42:43], v[132:133]
v_pk_mul_f32 v[44:45], v[44:45], v[132:133]
v_pk_mul_f32 v[46:47], v[46:47], v[132:133]
v_cvt_pk_bf16_f32 v176, v32, v33
v_cvt_pk_bf16_f32 v177, v34, v35
v_cvt_pk_bf16_f32 v178, v40, v41
v_cvt_pk_bf16_f32 v179, v42, v43
buffer_load_dwordx4 v3, s[8:11], s36 offen offset:2048 lds
buffer_load_dwordx4 v4, s[8:11], s36 offen offset:3072 lds
v_cvt_pk_bf16_f32 v180, v36, v37
v_cvt_pk_bf16_f32 v181, v38, v39
v_cvt_pk_bf16_f32 v182, v44, v45
v_cvt_pk_bf16_f32 v183, v46, v47
s_add_u32 m0, s35, 0
s_mov_b64 exec, s[48:49]
buffer_load_dwordx4 v5, s[8:11], s36 offen lds
s_mov_b64 exec, -1
v_accvgpr_read_b32 v48, a16
v_accvgpr_read_b32 v49, a17
v_accvgpr_read_b32 v50, a18
v_accvgpr_read_b32 v51, a19
v_accvgpr_read_b32 v52, a20
v_accvgpr_read_b32 v53, a21
v_accvgpr_read_b32 v54, a22
v_accvgpr_read_b32 v55, a23
s_add_u32 s37, s34, 0
buffer_load_dwordx4 a[128:131], v9, s[20:23], s37 offen sc1
v_accvgpr_read_b32 v56, a24
v_accvgpr_read_b32 v57, a25
v_accvgpr_read_b32 v58, a26
v_accvgpr_read_b32 v59, a27
v_accvgpr_read_b32 v60, a28
v_accvgpr_read_b32 v61, a29
v_accvgpr_read_b32 v62, a30
v_accvgpr_read_b32 v63, a31
buffer_load_dwordx4 a[132:135], v10, s[20:23], s37 offen sc1
buffer_load_dwordx4 a[136:139], v11, s[20:23], s37 offen sc1
v_pk_mul_f32 v[48:49], v[48:49], v[132:133]
v_pk_mul_f32 v[50:51], v[50:51], v[132:133]
v_pk_mul_f32 v[52:53], v[52:53], v[132:133]
v_pk_mul_f32 v[54:55], v[54:55], v[132:133]
v_pk_mul_f32 v[56:57], v[56:57], v[132:133]
v_pk_mul_f32 v[58:59], v[58:59], v[132:133]
v_pk_mul_f32 v[60:61], v[60:61], v[132:133]
v_pk_mul_f32 v[62:63], v[62:63], v[132:133]
v_cvt_pk_bf16_f32 v184, v48, v49
v_cvt_pk_bf16_f32 v185, v50, v51
v_cvt_pk_bf16_f32 v186, v56, v57
v_cvt_pk_bf16_f32 v187, v58, v59
buffer_load_dwordx4 a[140:143], v12, s[20:23], s37 offen sc1
s_add_u32 m0, s33, 18432
v_cvt_pk_bf16_f32 v188, v52, v53
v_cvt_pk_bf16_f32 v189, v54, v55
v_cvt_pk_bf16_f32 v190, v60, v61
v_cvt_pk_bf16_f32 v191, v62, v63
s_add_u32 s36, s32, 36864
buffer_load_dwordx4 v1, s[8:11], s36 offen offset:0 lds
v_accvgpr_read_b32 v32, a32
v_accvgpr_read_b32 v33, a33
v_accvgpr_read_b32 v34, a34
v_accvgpr_read_b32 v35, a35
v_accvgpr_read_b32 v36, a36
v_accvgpr_read_b32 v37, a37
v_accvgpr_read_b32 v38, a38
v_accvgpr_read_b32 v39, a39
buffer_load_dwordx4 v2, s[8:11], s36 offen offset:1024 lds
buffer_load_dwordx4 v3, s[8:11], s36 offen offset:2048 lds
v_accvgpr_read_b32 v40, a40
v_accvgpr_read_b32 v41, a41
v_accvgpr_read_b32 v42, a42
v_accvgpr_read_b32 v43, a43
v_accvgpr_read_b32 v44, a44
v_accvgpr_read_b32 v45, a45
v_accvgpr_read_b32 v46, a46
v_accvgpr_read_b32 v47, a47
buffer_load_dwordx4 v4, s[8:11], s36 offen offset:3072 lds
s_add_u32 m0, s35, 18432
v_pk_mul_f32 v[32:33], v[32:33], v[132:133]
v_pk_mul_f32 v[34:35], v[34:35], v[132:133]
v_pk_mul_f32 v[36:37], v[36:37], v[132:133]
v_pk_mul_f32 v[38:39], v[38:39], v[132:133]
v_pk_mul_f32 v[40:41], v[40:41], v[132:133]
v_pk_mul_f32 v[42:43], v[42:43], v[132:133]
v_pk_mul_f32 v[44:45], v[44:45], v[132:133]
v_pk_mul_f32 v[46:47], v[46:47], v[132:133]
v_cvt_pk_bf16_f32 v192, v32, v33
v_cvt_pk_bf16_f32 v193, v34, v35
v_cvt_pk_bf16_f32 v194, v40, v41
v_cvt_pk_bf16_f32 v195, v42, v43
s_mov_b64 exec, s[48:49]
buffer_load_dwordx4 v5, s[8:11], s36 offen lds
s_mov_b64 exec, -1
s_add_u32 s37, s34, 1024
v_cvt_pk_bf16_f32 v196, v36, v37
v_cvt_pk_bf16_f32 v197, v38, v39
v_cvt_pk_bf16_f32 v198, v44, v45
v_cvt_pk_bf16_f32 v199, v46, v47
buffer_load_dwordx4 a[144:147], v9, s[20:23], s37 offen sc1
buffer_load_dwordx4 a[148:151], v10, s[20:23], s37 offen sc1
v_accvgpr_read_b32 v48, a48
v_accvgpr_read_b32 v49, a49
v_accvgpr_read_b32 v50, a50
v_accvgpr_read_b32 v51, a51
v_accvgpr_read_b32 v52, a52
v_accvgpr_read_b32 v53, a53
v_accvgpr_read_b32 v54, a54
v_accvgpr_read_b32 v55, a55
buffer_load_dwordx4 a[152:155], v11, s[20:23], s37 offen sc1
buffer_load_dwordx4 a[156:159], v12, s[20:23], s37 offen sc1
v_accvgpr_read_b32 v56, a56
v_accvgpr_read_b32 v57, a57
v_accvgpr_read_b32 v58, a58
v_accvgpr_read_b32 v59, a59
v_accvgpr_read_b32 v60, a60
v_accvgpr_read_b32 v61, a61
v_accvgpr_read_b32 v62, a62
v_accvgpr_read_b32 v63, a63
s_add_u32 s37, s34, 2048
buffer_load_dwordx4 a[160:163], v9, s[20:23], s37 offen sc1
v_pk_mul_f32 v[48:49], v[48:49], v[132:133]
v_pk_mul_f32 v[50:51], v[50:51], v[132:133]
v_pk_mul_f32 v[52:53], v[52:53], v[132:133]
v_pk_mul_f32 v[54:55], v[54:55], v[132:133]
v_pk_mul_f32 v[56:57], v[56:57], v[132:133]
v_pk_mul_f32 v[58:59], v[58:59], v[132:133]
v_pk_mul_f32 v[60:61], v[60:61], v[132:133]
v_pk_mul_f32 v[62:63], v[62:63], v[132:133]
v_cvt_pk_bf16_f32 v200, v48, v49
v_cvt_pk_bf16_f32 v201, v50, v51
v_cvt_pk_bf16_f32 v202, v56, v57
v_cvt_pk_bf16_f32 v203, v58, v59
buffer_load_dwordx4 a[164:167], v10, s[20:23], s37 offen sc1
buffer_load_dwordx4 a[168:171], v11, s[20:23], s37 offen sc1
v_cvt_pk_bf16_f32 v204, v52, v53
v_cvt_pk_bf16_f32 v205, v54, v55
v_cvt_pk_bf16_f32 v206, v60, v61
v_cvt_pk_bf16_f32 v207, v62, v63
buffer_load_dwordx4 a[172:175], v12, s[20:23], s37 offen sc1
s_add_u32 s37, s34, 3072
v_mov_b32 v130, v124
v_mov_b32 v131, v124
s_nop 1
v_permlane32_swap_b32 v130, v131
s_nop 1
v_add_f32 v130, v130, v131
v_rcp_f32 v132, v130
s_nop 0
v_mov_b32 v133, v132
v_accvgpr_read_b32 v32, a64
v_accvgpr_read_b32 v33, a65
v_accvgpr_read_b32 v34, a66
v_accvgpr_read_b32 v35, a67
v_accvgpr_read_b32 v36, a68
v_accvgpr_read_b32 v37, a69
v_accvgpr_read_b32 v38, a70
v_accvgpr_read_b32 v39, a71
buffer_load_dwordx4 a[176:179], v9, s[20:23], s37 offen sc1
buffer_load_dwordx4 a[180:183], v10, s[20:23], s37 offen sc1
v_accvgpr_read_b32 v40, a72
v_accvgpr_read_b32 v41, a73
v_accvgpr_read_b32 v42, a74
v_accvgpr_read_b32 v43, a75
v_accvgpr_read_b32 v44, a76
v_accvgpr_read_b32 v45, a77
v_accvgpr_read_b32 v46, a78
v_accvgpr_read_b32 v47, a79
buffer_load_dwordx4 a[184:187], v11, s[20:23], s37 offen sc1
buffer_load_dwordx4 a[188:191], v12, s[20:23], s37 offen sc1
v_pk_mul_f32 v[32:33], v[32:33], v[132:133]
v_pk_mul_f32 v[34:35], v[34:35], v[132:133]
v_pk_mul_f32 v[36:37], v[36:37], v[132:133]
v_pk_mul_f32 v[38:39], v[38:39], v[132:133]
v_pk_mul_f32 v[40:41], v[40:41], v[132:133]
v_pk_mul_f32 v[42:43], v[42:43], v[132:133]
v_pk_mul_f32 v[44:45], v[44:45], v[132:133]
v_pk_mul_f32 v[46:47], v[46:47], v[132:133]
v_cvt_pk_bf16_f32 v208, v32, v33
v_cvt_pk_bf16_f32 v209, v34, v35
v_cvt_pk_bf16_f32 v210, v40, v41
v_cvt_pk_bf16_f32 v211, v42, v43
s_add_u32 m0, s33, 36864
s_add_u32 s36, s32, 73728
v_cvt_pk_bf16_f32 v212, v36, v37
v_cvt_pk_bf16_f32 v213, v38, v39
v_cvt_pk_bf16_f32 v214, v44, v45
v_cvt_pk_bf16_f32 v215, v46, v47
buffer_load_dwordx4 v1, s[8:11], s36 offen offset:0 lds
buffer_load_dwordx4 v2, s[8:11], s36 offen offset:1024 lds
v_accvgpr_read_b32 v48, a80
v_accvgpr_read_b32 v49, a81
v_accvgpr_read_b32 v50, a82
v_accvgpr_read_b32 v51, a83
v_accvgpr_read_b32 v52, a84
v_accvgpr_read_b32 v53, a85
v_accvgpr_read_b32 v54, a86
v_accvgpr_read_b32 v55, a87
buffer_load_dwordx4 v3, s[8:11], s36 offen offset:2048 lds
buffer_load_dwordx4 v4, s[8:11], s36 offen offset:3072 lds
v_accvgpr_read_b32 v56, a88
v_accvgpr_read_b32 v57, a89
v_accvgpr_read_b32 v58, a90
v_accvgpr_read_b32 v59, a91
v_accvgpr_read_b32 v60, a92
v_accvgpr_read_b32 v61, a93
v_accvgpr_read_b32 v62, a94
v_accvgpr_read_b32 v63, a95
s_add_u32 m0, s35, 36864
s_mov_b64 exec, s[48:49]
buffer_load_dwordx4 v5, s[8:11], s36 offen lds
s_mov_b64 exec, -1
v_pk_mul_f32 v[48:49], v[48:49], v[132:133]
v_pk_mul_f32 v[50:51], v[50:51], v[132:133]
v_pk_mul_f32 v[52:53], v[52:53], v[132:133]
v_pk_mul_f32 v[54:55], v[54:55], v[132:133]
v_pk_mul_f32 v[56:57], v[56:57], v[132:133]
v_pk_mul_f32 v[58:59], v[58:59], v[132:133]
v_pk_mul_f32 v[60:61], v[60:61], v[132:133]
v_pk_mul_f32 v[62:63], v[62:63], v[132:133]
v_cvt_pk_bf16_f32 v216, v48, v49
v_cvt_pk_bf16_f32 v217, v50, v51
v_cvt_pk_bf16_f32 v218, v56, v57
v_cvt_pk_bf16_f32 v219, v58, v59
s_add_u32 m0, s33, 55296
s_add_u32 s36, s32, 110592
v_cvt_pk_bf16_f32 v220, v52, v53
v_cvt_pk_bf16_f32 v221, v54, v55
v_cvt_pk_bf16_f32 v222, v60, v61
v_cvt_pk_bf16_f32 v223, v62, v63
buffer_load_dwordx4 v1, s[8:11], s36 offen offset:0 lds
buffer_load_dwordx4 v2, s[8:11], s36 offen offset:1024 lds
v_accvgpr_read_b32 v32, a96
v_accvgpr_read_b32 v33, a97
v_accvgpr_read_b32 v34, a98
v_accvgpr_read_b32 v35, a99
v_accvgpr_read_b32 v36, a100
v_accvgpr_read_b32 v37, a101
v_accvgpr_read_b32 v38, a102
v_accvgpr_read_b32 v39, a103
buffer_load_dwordx4 v3, s[8:11], s36 offen offset:2048 lds
buffer_load_dwordx4 v4, s[8:11], s36 offen offset:3072 lds
v_accvgpr_read_b32 v40, a104
v_accvgpr_read_b32 v41, a105
v_accvgpr_read_b32 v42, a106
v_accvgpr_read_b32 v43, a107
v_accvgpr_read_b32 v44, a108
v_accvgpr_read_b32 v45, a109
v_accvgpr_read_b32 v46, a110
v_accvgpr_read_b32 v47, a111
s_add_u32 m0, s35, 55296
s_mov_b64 exec, s[48:49]
buffer_load_dwordx4 v5, s[8:11], s36 offen lds
s_mov_b64 exec, -1
v_pk_mul_f32 v[32:33], v[32:33], v[132:133]
v_pk_mul_f32 v[34:35], v[34:35], v[132:133]
v_pk_mul_f32 v[36:37], v[36:37], v[132:133]
v_pk_mul_f32 v[38:39], v[38:39], v[132:133]
v_pk_mul_f32 v[40:41], v[40:41], v[132:133]
v_pk_mul_f32 v[42:43], v[42:43], v[132:133]
v_pk_mul_f32 v[44:45], v[44:45], v[132:133]
v_pk_mul_f32 v[46:47], v[46:47], v[132:133]
v_cvt_pk_bf16_f32 v224, v32, v33
v_cvt_pk_bf16_f32 v225, v34, v35
v_cvt_pk_bf16_f32 v226, v40, v41
v_cvt_pk_bf16_f32 v227, v42, v43
v_cvt_pk_bf16_f32 v228, v36, v37
v_cvt_pk_bf16_f32 v229, v38, v39
v_cvt_pk_bf16_f32 v230, v44, v45
v_cvt_pk_bf16_f32 v231, v46, v47
v_accvgpr_read_b32 v48, a112
v_accvgpr_read_b32 v49, a113
v_accvgpr_read_b32 v50, a114
v_accvgpr_read_b32 v51, a115
v_accvgpr_read_b32 v52, a116
v_accvgpr_read_b32 v53, a117
v_accvgpr_read_b32 v54, a118
v_accvgpr_read_b32 v55, a119
v_accvgpr_read_b32 v56, a120
v_accvgpr_read_b32 v57, a121
v_accvgpr_read_b32 v58, a122
v_accvgpr_read_b32 v59, a123
v_accvgpr_read_b32 v60, a124
v_accvgpr_read_b32 v61, a125
v_accvgpr_read_b32 v62, a126
v_accvgpr_read_b32 v63, a127
v_pk_mul_f32 v[48:49], v[48:49], v[132:133]
v_pk_mul_f32 v[50:51], v[50:51], v[132:133]
v_pk_mul_f32 v[52:53], v[52:53], v[132:133]
v_pk_mul_f32 v[54:55], v[54:55], v[132:133]
v_pk_mul_f32 v[56:57], v[56:57], v[132:133]
v_pk_mul_f32 v[58:59], v[58:59], v[132:133]
v_pk_mul_f32 v[60:61], v[60:61], v[132:133]
v_pk_mul_f32 v[62:63], v[62:63], v[132:133]
v_cvt_pk_bf16_f32 v232, v48, v49
v_cvt_pk_bf16_f32 v233, v50, v51
v_cvt_pk_bf16_f32 v234, v56, v57
v_cvt_pk_bf16_f32 v235, v58, v59
v_cvt_pk_bf16_f32 v236, v52, v53
v_cvt_pk_bf16_f32 v237, v54, v55
v_cvt_pk_bf16_f32 v238, v60, v61
v_cvt_pk_bf16_f32 v239, v62, v63
s_waitcnt vmcnt(22)
s_barrier
ds_read_b64_tr_b16 a[96:97], v6 offset:0
ds_read_b64_tr_b16 a[98:99], v6 offset:4608
ds_read_b64_tr_b16 a[100:101], v6 offset:32
ds_read_b64_tr_b16 a[102:103], v6 offset:4640
ds_read_b64_tr_b16 a[104:105], v6 offset:64
ds_read_b64_tr_b16 a[106:107], v6 offset:4672
ds_read_b64_tr_b16 a[108:109], v6 offset:96
ds_read_b64_tr_b16 a[110:111], v6 offset:4704
s_sub_u32 s98, 15, s60
s_min_u32 s98, s98, s60
s_waitcnt lgkmcnt(6)
v_mfma_f32_16x16x32_bf16 v[32:35], a[96:99], a[128:131], 0
ds_read_b64_tr_b16 a[112:113], v6 offset:128
s_add_u32 s37, s34, 4096
v_mfma_f32_16x16x32_bf16 v[36:39], a[96:99], a[132:135], 0
ds_read_b64_tr_b16 a[114:115], v6 offset:4736
buffer_load_dwordx4 a[192:195], v9, s[20:23], s37 offen sc1
v_mfma_f32_16x16x32_bf16 v[40:43], a[96:99], a[136:139], 0
buffer_load_dwordx4 a[196:199], v10, s[20:23], s37 offen sc1
v_mfma_f32_16x16x32_bf16 v[44:47], a[96:99], a[140:143], 0
s_waitcnt lgkmcnt(6)
v_mfma_f32_16x16x32_bf16 v[48:51], a[100:103], a[128:131], 0
ds_read_b64_tr_b16 a[116:117], v6 offset:160
buffer_load_dwordx4 a[200:203], v11, s[20:23], s37 offen sc1
v_mfma_f32_16x16x32_bf16 v[52:55], a[100:103], a[132:135], 0
ds_read_b64_tr_b16 a[118:119], v6 offset:4768
buffer_load_dwordx4 a[204:207], v12, s[20:23], s37 offen sc1
v_mfma_f32_16x16x32_bf16 v[56:59], a[100:103], a[136:139], 0
v_mfma_f32_16x16x32_bf16 v[60:63], a[100:103], a[140:143], 0
s_add_u32 m0, s33, 73728
s_waitcnt lgkmcnt(6)
v_mfma_f32_16x16x32_bf16 v[64:67], a[104:107], a[128:131], 0
ds_read_b64_tr_b16 a[96:97], v6 offset:192
s_add_u32 s36, s32, 165888
v_mfma_f32_16x16x32_bf16 v[68:71], a[104:107], a[132:135], 0
ds_read_b64_tr_b16 a[98:99], v6 offset:4800
v_mfma_f32_16x16x32_bf16 v[72:75], a[104:107], a[136:139], 0
buffer_load_dwordx4 v1, s[8:11], s36 offen offset:0 lds
v_mfma_f32_16x16x32_bf16 v[76:79], a[104:107], a[140:143], 0
buffer_load_dwordx4 v2, s[8:11], s36 offen offset:1024 lds
s_waitcnt lgkmcnt(6)
v_mfma_f32_16x16x32_bf16 v[80:83], a[108:111], a[128:131], 0
ds_read_b64_tr_b16 a[100:101], v6 offset:224
buffer_load_dwordx4 v3, s[8:11], s36 offen offset:2048 lds
v_mfma_f32_16x16x32_bf16 v[84:87], a[108:111], a[132:135], 0
ds_read_b64_tr_b16 a[102:103], v6 offset:4832
v_mfma_f32_16x16x32_bf16 v[88:91], a[108:111], a[136:139], 0
buffer_load_dwordx4 v4, s[8:11], s36 offen offset:3072 lds
v_mfma_f32_16x16x32_bf16 v[92:95], a[108:111], a[140:143], 0
s_add_u32 m0, s35, 73728
s_waitcnt lgkmcnt(6)
v_mfma_f32_16x16x32_bf16 v[96:99], a[112:115], a[128:131], 0
ds_read_b64_tr_b16 a[104:105], v6 offset:256
v_mfma_f32_16x16x32_bf16 v[100:103], a[112:115], a[132:135], 0
ds_read_b64_tr_b16 a[106:107], v6 offset:4864
s_mov_b64 exec, s[48:49]
buffer_load_dwordx4 v5, s[8:11], s36 offen lds
s_mov_b64 exec, -1
v_mfma_f32_16x16x32_bf16 v[104:107], a[112:115], a[136:139], 0
s_add_u32 m0, s33, 92160
v_mfma_f32_16x16x32_bf16 v[108:111], a[112:115], a[140:143], 0
s_waitcnt lgkmcnt(6)
v_mfma_f32_16x16x32_bf16 v[112:115], a[116:119], a[128:131], 0
ds_read_b64_tr_b16 a[108:109], v6 offset:18432
s_add_u32 s36, s32, 202752
v_mfma_f32_16x16x32_bf16 v[116:119], a[116:119], a[132:135], 0
ds_read_b64_tr_b16 a[110:111], v6 offset:23040
buffer_load_dwordx4 v1, s[8:11], s36 offen offset:0 lds
v_mfma_f32_16x16x32_bf16 v[120:123], a[116:119], a[136:139], 0
v_mfma_f32_16x16x32_bf16 v[124:127], a[116:119], a[140:143], 0
buffer_load_dwordx4 v2, s[8:11], s36 offen offset:1024 lds
s_waitcnt lgkmcnt(6)
v_mfma_f32_16x16x32_bf16 v[128:131], a[96:99], a[128:131], 0
ds_read_b64_tr_b16 a[112:113], v6 offset:18464
buffer_load_dwordx4 v3, s[8:11], s36 offen offset:2048 lds
v_mfma_f32_16x16x32_bf16 v[132:135], a[96:99], a[132:135], 0
ds_read_b64_tr_b16 a[114:115], v6 offset:23072
buffer_load_dwordx4 v4, s[8:11], s36 offen offset:3072 lds
v_mfma_f32_16x16x32_bf16 v[136:139], a[96:99], a[136:139], 0
v_mfma_f32_16x16x32_bf16 v[140:143], a[96:99], a[140:143], 0
s_add_u32 m0, s35, 92160
s_waitcnt lgkmcnt(6)
v_mfma_f32_16x16x32_bf16 v[144:147], a[100:103], a[128:131], 0
ds_read_b64_tr_b16 a[116:117], v6 offset:18496
s_mov_b64 exec, s[48:49]
buffer_load_dwordx4 v5, s[8:11], s36 offen lds
s_mov_b64 exec, -1
v_mfma_f32_16x16x32_bf16 v[148:151], a[100:103], a[132:135], 0
ds_read_b64_tr_b16 a[118:119], v6 offset:23104
v_mfma_f32_16x16x32_bf16 v[152:155], a[100:103], a[136:139], 0
buffer_store_dwordx4 v[176:179], v31, s[20:23], s95 offen offset:0 sc1
v_mfma_f32_16x16x32_bf16 v[156:159], a[100:103], a[140:143], 0
buffer_store_dwordx4 v[180:183], v31, s[20:23], s95 offen offset:512 sc1
s_waitcnt lgkmcnt(6)
v_mfma_f32_16x16x32_bf16 v[160:163], a[104:107], a[128:131], 0
ds_read_b64_tr_b16 a[96:97], v6 offset:18528
v_mfma_f32_16x16x32_bf16 v[164:167], a[104:107], a[132:135], 0
ds_read_b64_tr_b16 a[98:99], v6 offset:23136
buffer_store_dwordx4 v[184:187], v31, s[20:23], s95 offen offset:1024 sc1
v_mfma_f32_16x16x32_bf16 v[168:171], a[104:107], a[136:139], 0
buffer_store_dwordx4 v[188:191], v31, s[20:23], s95 offen offset:1536 sc1
v_mfma_f32_16x16x32_bf16 v[172:175], a[104:107], a[140:143], 0
s_waitcnt vmcnt(36) lgkmcnt(6)
v_mfma_f32_16x16x32_bf16 v[32:35], a[108:111], a[144:147], v[32:35]
ds_read_b64_tr_b16 a[100:101], v6 offset:18560
s_add_u32 s37, s34, 5120
v_mfma_f32_16x16x32_bf16 v[36:39], a[108:111], a[148:151], v[36:39]
ds_read_b64_tr_b16 a[102:103], v6 offset:23168
v_mfma_f32_16x16x32_bf16 v[40:43], a[108:111], a[152:155], v[40:43]
buffer_load_dwordx4 a[128:131], v9, s[20:23], s37 offen sc1
v_mfma_f32_16x16x32_bf16 v[44:47], a[108:111], a[156:159], v[44:47]
s_waitcnt lgkmcnt(6)
v_mfma_f32_16x16x32_bf16 v[48:51], a[112:115], a[144:147], v[48:51]
ds_read_b64_tr_b16 a[104:105], v6 offset:18592
buffer_load_dwordx4 a[132:135], v10, s[20:23], s37 offen sc1
v_mfma_f32_16x16x32_bf16 v[52:55], a[112:115], a[148:151], v[52:55]
ds_read_b64_tr_b16 a[106:107], v6 offset:23200
v_mfma_f32_16x16x32_bf16 v[56:59], a[112:115], a[152:155], v[56:59]
buffer_load_dwordx4 a[136:139], v11, s[20:23], s37 offen sc1
v_mfma_f32_16x16x32_bf16 v[60:63], a[112:115], a[156:159], v[60:63]
s_waitcnt lgkmcnt(6)
v_mfma_f32_16x16x32_bf16 v[64:67], a[116:119], a[144:147], v[64:67]
ds_read_b64_tr_b16 a[108:109], v6 offset:18624
buffer_load_dwordx4 a[140:143], v12, s[20:23], s37 offen sc1
v_mfma_f32_16x16x32_bf16 v[68:71], a[116:119], a[148:151], v[68:71]
ds_read_b64_tr_b16 a[110:111], v6 offset:23232
v_mfma_f32_16x16x32_bf16 v[72:75], a[116:119], a[152:155], v[72:75]
s_add_u32 m0, s33, 110592
v_mfma_f32_16x16x32_bf16 v[76:79], a[116:119], a[156:159], v[76:79]
s_waitcnt lgkmcnt(6)
v_mfma_f32_16x16x32_bf16 v[80:83], a[96:99], a[144:147], v[80:83]
ds_read_b64_tr_b16 a[112:113], v6 offset:18656
s_add_u32 s36, s32, 239616
v_mfma_f32_16x16x32_bf16 v[84:87], a[96:99], a[148:151], v[84:87]
ds_read_b64_tr_b16 a[114:115], v6 offset:23264
v_mfma_f32_16x16x32_bf16 v[88:91], a[96:99], a[152:155], v[88:91]
buffer_load_dwordx4 v1, s[8:11], s36 offen offset:0 lds
v_mfma_f32_16x16x32_bf16 v[92:95], a[96:99], a[156:159], v[92:95]
s_waitcnt lgkmcnt(6)
v_mfma_f32_16x16x32_bf16 v[96:99], a[100:103], a[144:147], v[96:99]
ds_read_b64_tr_b16 a[116:117], v6 offset:18688
buffer_load_dwordx4 v2, s[8:11], s36 offen offset:1024 lds
v_mfma_f32_16x16x32_bf16 v[100:103], a[100:103], a[148:151], v[100:103]
ds_read_b64_tr_b16 a[118:119], v6 offset:23296
v_mfma_f32_16x16x32_bf16 v[104:107], a[100:103], a[152:155], v[104:107]
s_waitcnt vmcnt(24)
v_mfma_f32_16x16x32_bf16 v[108:111], a[100:103], a[156:159], v[108:111]
s_barrier
s_waitcnt lgkmcnt(6)
v_mfma_f32_16x16x32_bf16 v[112:115], a[104:107], a[144:147], v[112:115]
ds_read_b64_tr_b16 a[96:97], v6 offset:36864
buffer_load_dwordx4 v3, s[8:11], s36 offen offset:2048 lds
v_mfma_f32_16x16x32_bf16 v[116:119], a[104:107], a[148:151], v[116:119]
ds_read_b64_tr_b16 a[98:99], v6 offset:41472
buffer_load_dwordx4 v4, s[8:11], s36 offen offset:3072 lds
v_mfma_f32_16x16x32_bf16 v[120:123], a[104:107], a[152:155], v[120:123]
v_mfma_f32_16x16x32_bf16 v[124:127], a[104:107], a[156:159], v[124:127]
s_add_u32 m0, s35, 110592
s_waitcnt lgkmcnt(6)
v_mfma_f32_16x16x32_bf16 v[128:131], a[108:111], a[144:147], v[128:131]
ds_read_b64_tr_b16 a[100:101], v6 offset:36896
v_mfma_f32_16x16x32_bf16 v[132:135], a[108:111], a[148:151], v[132:135]
ds_read_b64_tr_b16 a[102:103], v6 offset:41504
s_mov_b64 exec, s[48:49]
buffer_load_dwordx4 v5, s[8:11], s36 offen lds
s_mov_b64 exec, -1
v_mfma_f32_16x16x32_bf16 v[136:139], a[108:111], a[152:155], v[136:139]
v_mfma_f32_16x16x32_bf16 v[140:143], a[108:111], a[156:159], v[140:143]
buffer_store_dwordx4 v[192:195], v31, s[20:23], s95 offen offset:2048 sc1
s_waitcnt lgkmcnt(6)
v_mfma_f32_16x16x32_bf16 v[144:147], a[112:115], a[144:147], v[144:147]
ds_read_b64_tr_b16 a[104:105], v6 offset:36928
v_mfma_f32_16x16x32_bf16 v[148:151], a[112:115], a[148:151], v[148:151]
ds_read_b64_tr_b16 a[106:107], v6 offset:41536
buffer_store_dwordx4 v[196:199], v31, s[20:23], s95 offen offset:2560 sc1
v_mfma_f32_16x16x32_bf16 v[152:155], a[112:115], a[152:155], v[152:155]
v_mfma_f32_16x16x32_bf16 v[156:159], a[112:115], a[156:159], v[156:159]
buffer_store_dwordx4 v[200:203], v31, s[20:23], s95 offen offset:3072 sc1
s_waitcnt lgkmcnt(6)
v_mfma_f32_16x16x32_bf16 v[160:163], a[116:119], a[144:147], v[160:163]
ds_read_b64_tr_b16 a[108:109], v6 offset:36960
v_mfma_f32_16x16x32_bf16 v[164:167], a[116:119], a[148:151], v[164:167]
ds_read_b64_tr_b16 a[110:111], v6 offset:41568
buffer_store_dwordx4 v[204:207], v31, s[20:23], s95 offen offset:3584 sc1
v_mfma_f32_16x16x32_bf16 v[168:171], a[116:119], a[152:155], v[168:171]
v_mfma_f32_16x16x32_bf16 v[172:175], a[116:119], a[156:159], v[172:175]
s_waitcnt lgkmcnt(6)
v_mfma_f32_16x16x32_bf16 v[32:35], a[96:99], a[160:163], v[32:35]
ds_read_b64_tr_b16 a[112:113], v6 offset:36992
v_mfma_f32_16x16x32_bf16 v[36:39], a[96:99], a[164:167], v[36:39]
ds_read_b64_tr_b16 a[114:115], v6 offset:41600
v_mfma_f32_16x16x32_bf16 v[40:43], a[96:99], a[168:171], v[40:43]
s_add_u32 s37, s34, 6144
v_mfma_f32_16x16x32_bf16 v[44:47], a[96:99], a[172:175], v[44:47]
buffer_load_dwordx4 a[144:147], v9, s[20:23], s37 offen sc1
s_waitcnt lgkmcnt(6)
v_mfma_f32_16x16x32_bf16 v[48:51], a[100:103], a[160:163], v[48:51]
ds_read_b64_tr_b16 a[116:117], v6 offset:37024
v_mfma_f32_16x16x32_bf16 v[52:55], a[100:103], a[164:167], v[52:55]
ds_read_b64_tr_b16 a[118:119], v6 offset:41632
v_mfma_f32_16x16x32_bf16 v[56:59], a[100:103], a[168:171], v[56:59]
buffer_load_dwordx4 a[148:151], v10, s[20:23], s37 offen sc1
v_mfma_f32_16x16x32_bf16 v[60:63], a[100:103], a[172:175], v[60:63]
buffer_load_dwordx4 a[152:155], v11, s[20:23], s37 offen sc1
s_waitcnt lgkmcnt(6)
v_mfma_f32_16x16x32_bf16 v[64:67], a[104:107], a[160:163], v[64:67]
ds_read_b64_tr_b16 a[96:97], v6 offset:37056
v_mfma_f32_16x16x32_bf16 v[68:71], a[104:107], a[164:167], v[68:71]
ds_read_b64_tr_b16 a[98:99], v6 offset:41664
v_mfma_f32_16x16x32_bf16 v[72:75], a[104:107], a[168:171], v[72:75]
buffer_load_dwordx4 a[156:159], v12, s[20:23], s37 offen sc1
v_mfma_f32_16x16x32_bf16 v[76:79], a[104:107], a[172:175], v[76:79]
s_add_u32 m0, s33, 129024
s_waitcnt lgkmcnt(6)
v_mfma_f32_16x16x32_bf16 v[80:83], a[108:111], a[160:163], v[80:83]
ds_read_b64_tr_b16 a[100:101], v6 offset:37088
v_mfma_f32_16x16x32_bf16 v[84:87], a[108:111], a[164:167], v[84:87]
ds_read_b64_tr_b16 a[102:103], v6 offset:41696
v_mfma_f32_16x16x32_bf16 v[88:91], a[108:111], a[168:171], v[88:91]
s_add_u32 s36, s32, 276480
v_mfma_f32_16x16x32_bf16 v[92:95], a[108:111], a[172:175], v[92:95]
buffer_load_dwordx4 v1, s[8:11], s36 offen offset:0 lds
s_waitcnt lgkmcnt(6)
v_mfma_f32_16x16x32_bf16 v[96:99], a[112:115], a[160:163], v[96:99]
ds_read_b64_tr_b16 a[104:105], v6 offset:37120
v_mfma_f32_16x16x32_bf16 v[100:103], a[112:115], a[164:167], v[100:103]
ds_read_b64_tr_b16 a[106:107], v6 offset:41728
v_mfma_f32_16x16x32_bf16 v[104:107], a[112:115], a[168:171], v[104:107]
buffer_load_dwordx4 v2, s[8:11], s36 offen offset:1024 lds
v_mfma_f32_16x16x32_bf16 v[108:111], a[112:115], a[172:175], v[108:111]
buffer_load_dwordx4 v3, s[8:11], s36 offen offset:2048 lds
s_waitcnt lgkmcnt(6)
v_mfma_f32_16x16x32_bf16 v[112:115], a[116:119], a[160:163], v[112:115]
ds_read_b64_tr_b16 a[108:109], v7 offset:0
v_mfma_f32_16x16x32_bf16 v[116:119], a[116:119], a[164:167], v[116:119]
ds_read_b64_tr_b16 a[110:111], v7 offset:4608
v_mfma_f32_16x16x32_bf16 v[120:123], a[116:119], a[168:171], v[120:123]
buffer_load_dwordx4 v4, s[8:11], s36 offen offset:3072 lds
v_mfma_f32_16x16x32_bf16 v[124:127], a[116:119], a[172:175], v[124:127]
s_add_u32 m0, s35, 129024
s_waitcnt lgkmcnt(6)
v_mfma_f32_16x16x32_bf16 v[128:131], a[96:99], a[160:163], v[128:131]
ds_read_b64_tr_b16 a[112:113], v7 offset:32
v_mfma_f32_16x16x32_bf16 v[132:135], a[96:99], a[164:167], v[132:135]
ds_read_b64_tr_b16 a[114:115], v7 offset:4640
v_mfma_f32_16x16x32_bf16 v[136:139], a[96:99], a[168:171], v[136:139]
s_mov_b64 exec, s[48:49]
buffer_load_dwordx4 v5, s[8:11], s36 offen lds
s_mov_b64 exec, -1
v_mfma_f32_16x16x32_bf16 v[140:143], a[96:99], a[172:175], v[140:143]
buffer_store_dwordx4 v[208:211], v31, s[20:23], s96 offen offset:0 sc1
s_waitcnt lgkmcnt(6)
v_mfma_f32_16x16x32_bf16 v[144:147], a[100:103], a[160:163], v[144:147]
ds_read_b64_tr_b16 a[116:117], v7 offset:64
v_mfma_f32_16x16x32_bf16 v[148:151], a[100:103], a[164:167], v[148:151]
ds_read_b64_tr_b16 a[118:119], v7 offset:4672
v_mfma_f32_16x16x32_bf16 v[152:155], a[100:103], a[168:171], v[152:155]
buffer_store_dwordx4 v[212:215], v31, s[20:23], s96 offen offset:512 sc1
v_mfma_f32_16x16x32_bf16 v[156:159], a[100:103], a[172:175], v[156:159]
buffer_store_dwordx4 v[216:219], v31, s[20:23], s96 offen offset:1024 sc1
s_waitcnt lgkmcnt(6)
v_mfma_f32_16x16x32_bf16 v[160:163], a[104:107], a[160:163], v[160:163]
ds_read_b64_tr_b16 a[96:97], v7 offset:96
v_mfma_f32_16x16x32_bf16 v[164:167], a[104:107], a[164:167], v[164:167]
ds_read_b64_tr_b16 a[98:99], v7 offset:4704
v_mfma_f32_16x16x32_bf16 v[168:171], a[104:107], a[168:171], v[168:171]
buffer_store_dwordx4 v[220:223], v31, s[20:23], s96 offen offset:1536 sc1
v_mfma_f32_16x16x32_bf16 v[172:175], a[104:107], a[172:175], v[172:175]
s_waitcnt lgkmcnt(6)
v_mfma_f32_16x16x32_bf16 v[32:35], a[108:111], a[176:179], v[32:35]
ds_read_b64_tr_b16 a[100:101], v7 offset:128
s_add_u32 s37, s34, 7168
v_mfma_f32_16x16x32_bf16 v[36:39], a[108:111], a[180:183], v[36:39]
ds_read_b64_tr_b16 a[102:103], v7 offset:4736
v_mfma_f32_16x16x32_bf16 v[40:43], a[108:111], a[184:187], v[40:43]
buffer_load_dwordx4 a[160:163], v9, s[20:23], s37 offen sc1
v_mfma_f32_16x16x32_bf16 v[44:47], a[108:111], a[188:191], v[44:47]
s_waitcnt lgkmcnt(6)
v_mfma_f32_16x16x32_bf16 v[48:51], a[112:115], a[176:179], v[48:51]
ds_read_b64_tr_b16 a[104:105], v7 offset:160
buffer_load_dwordx4 a[164:167], v10, s[20:23], s37 offen sc1
v_mfma_f32_16x16x32_bf16 v[52:55], a[112:115], a[180:183], v[52:55]
ds_read_b64_tr_b16 a[106:107], v7 offset:4768
v_mfma_f32_16x16x32_bf16 v[56:59], a[112:115], a[184:187], v[56:59]
buffer_load_dwordx4 a[168:171], v11, s[20:23], s37 offen sc1
v_mfma_f32_16x16x32_bf16 v[60:63], a[112:115], a[188:191], v[60:63]
s_waitcnt lgkmcnt(6)
v_mfma_f32_16x16x32_bf16 v[64:67], a[116:119], a[176:179], v[64:67]
ds_read_b64_tr_b16 a[108:109], v7 offset:192
buffer_load_dwordx4 a[172:175], v12, s[20:23], s37 offen sc1
v_mfma_f32_16x16x32_bf16 v[68:71], a[116:119], a[180:183], v[68:71]
ds_read_b64_tr_b16 a[110:111], v7 offset:4800
v_mfma_f32_16x16x32_bf16 v[72:75], a[116:119], a[184:187], v[72:75]
s_add_u32 m0, s33, 0
v_mfma_f32_16x16x32_bf16 v[76:79], a[116:119], a[188:191], v[76:79]
s_waitcnt lgkmcnt(6)
v_mfma_f32_16x16x32_bf16 v[80:83], a[96:99], a[176:179], v[80:83]
ds_read_b64_tr_b16 a[112:113], v7 offset:224
s_add_u32 s36, s32, 147456
v_mfma_f32_16x16x32_bf16 v[84:87], a[96:99], a[180:183], v[84:87]
ds_read_b64_tr_b16 a[114:115], v7 offset:4832
v_mfma_f32_16x16x32_bf16 v[88:91], a[96:99], a[184:187], v[88:91]
s_add_u32 s36, s36, s39
v_mfma_f32_16x16x32_bf16 v[92:95], a[96:99], a[188:191], v[92:95]
s_waitcnt lgkmcnt(6)
v_mfma_f32_16x16x32_bf16 v[96:99], a[100:103], a[176:179], v[96:99]
ds_read_b64_tr_b16 a[116:117], v7 offset:256
buffer_load_dwordx4 v1, s[8:11], s36 offen offset:0 lds
v_mfma_f32_16x16x32_bf16 v[100:103], a[100:103], a[180:183], v[100:103]
ds_read_b64_tr_b16 a[118:119], v7 offset:4864
v_mfma_f32_16x16x32_bf16 v[104:107], a[100:103], a[184:187], v[104:107]
s_waitcnt vmcnt(35)
buffer_load_dwordx4 v2, s[8:11], s36 offen offset:1024 lds
v_mfma_f32_16x16x32_bf16 v[108:111], a[100:103], a[188:191], v[108:111]
s_barrier
s_waitcnt lgkmcnt(6)
v_mfma_f32_16x16x32_bf16 v[112:115], a[104:107], a[176:179], v[112:115]
ds_read_b64_tr_b16 a[96:97], v7 offset:18432
buffer_load_dwordx4 v3, s[8:11], s36 offen offset:2048 lds
v_mfma_f32_16x16x32_bf16 v[116:119], a[104:107], a[180:183], v[116:119]
ds_read_b64_tr_b16 a[98:99], v7 offset:23040
v_mfma_f32_16x16x32_bf16 v[120:123], a[104:107], a[184:187], v[120:123]
buffer_load_dwordx4 v4, s[8:11], s36 offen offset:3072 lds
v_mfma_f32_16x16x32_bf16 v[124:127], a[104:107], a[188:191], v[124:127]
s_waitcnt lgkmcnt(6)
v_mfma_f32_16x16x32_bf16 v[128:131], a[108:111], a[176:179], v[128:131]
ds_read_b64_tr_b16 a[100:101], v7 offset:18464
s_add_u32 m0, s35, 0
v_mfma_f32_16x16x32_bf16 v[132:135], a[108:111], a[180:183], v[132:135]
ds_read_b64_tr_b16 a[102:103], v7 offset:23072
v_mfma_f32_16x16x32_bf16 v[136:139], a[108:111], a[184:187], v[136:139]
s_mov_b64 exec, s[48:49]
buffer_load_dwordx4 v5, s[8:11], s36 offen lds
s_mov_b64 exec, -1
v_mfma_f32_16x16x32_bf16 v[140:143], a[108:111], a[188:191], v[140:143]
s_waitcnt lgkmcnt(6)
v_mfma_f32_16x16x32_bf16 v[144:147], a[112:115], a[176:179], v[144:147]
ds_read_b64_tr_b16 a[104:105], v7 offset:18496
buffer_store_dwordx4 v[224:227], v31, s[20:23], s96 offen offset:2048 sc1
v_mfma_f32_16x16x32_bf16 v[148:151], a[112:115], a[180:183], v[148:151]
ds_read_b64_tr_b16 a[106:107], v7 offset:23104
v_mfma_f32_16x16x32_bf16 v[152:155], a[112:115], a[184:187], v[152:155]
buffer_store_dwordx4 v[228:231], v31, s[20:23], s96 offen offset:2560 sc1
v_mfma_f32_16x16x32_bf16 v[156:159], a[112:115], a[188:191], v[156:159]
s_waitcnt lgkmcnt(6)
v_mfma_f32_16x16x32_bf16 v[160:163], a[116:119], a[176:179], v[160:163]
ds_read_b64_tr_b16 a[108:109], v7 offset:18528
buffer_store_dwordx4 v[232:235], v31, s[20:23], s96 offen offset:3072 sc1
v_mfma_f32_16x16x32_bf16 v[164:167], a[116:119], a[180:183], v[164:167]
ds_read_b64_tr_b16 a[110:111], v7 offset:23136
v_mfma_f32_16x16x32_bf16 v[168:171], a[116:119], a[184:187], v[168:171]
buffer_store_dwordx4 v[236:239], v31, s[20:23], s96 offen offset:3584 sc1
v_mfma_f32_16x16x32_bf16 v[172:175], a[116:119], a[188:191], v[172:175]
s_waitcnt lgkmcnt(6)
v_mfma_f32_16x16x32_bf16 v[32:35], a[96:99], a[192:195], v[32:35]
ds_read_b64_tr_b16 a[112:113], v7 offset:18560
v_mfma_f32_16x16x32_bf16 v[36:39], a[96:99], a[196:199], v[36:39]
ds_read_b64_tr_b16 a[114:115], v7 offset:23168
v_mfma_f32_16x16x32_bf16 v[40:43], a[96:99], a[200:203], v[40:43]
s_add_u32 s37, s34, 8192
v_mfma_f32_16x16x32_bf16 v[44:47], a[96:99], a[204:207], v[44:47]
buffer_load_dwordx2 a[176:177], v240, s[20:23], s37 offen sc1
s_waitcnt lgkmcnt(6)
v_mfma_f32_16x16x32_bf16 v[48:51], a[100:103], a[192:195], v[48:51]
ds_read_b64_tr_b16 a[116:117], v7 offset:18592
v_mfma_f32_16x16x32_bf16 v[52:55], a[100:103], a[196:199], v[52:55]
ds_read_b64_tr_b16 a[118:119], v7 offset:23200
v_mfma_f32_16x16x32_bf16 v[56:59], a[100:103], a[200:203], v[56:59]
buffer_load_dwordx2 a[178:179], v240, s[20:23], s37 offen offset:512 sc1
v_mfma_f32_16x16x32_bf16 v[60:63], a[100:103], a[204:207], v[60:63]
buffer_load_dwordx2 a[180:181], v241, s[20:23], s37 offen sc1
s_waitcnt lgkmcnt(6)
v_mfma_f32_16x16x32_bf16 v[64:67], a[104:107], a[192:195], v[64:67]
ds_read_b64_tr_b16 a[96:97], v7 offset:18624
v_mfma_f32_16x16x32_bf16 v[68:71], a[104:107], a[196:199], v[68:71]
ds_read_b64_tr_b16 a[98:99], v7 offset:23232
v_mfma_f32_16x16x32_bf16 v[72:75], a[104:107], a[200:203], v[72:75]
buffer_load_dwordx2 a[182:183], v241, s[20:23], s37 offen offset:512 sc1
v_mfma_f32_16x16x32_bf16 v[76:79], a[104:107], a[204:207], v[76:79]
buffer_load_dwordx2 a[184:185], v242, s[20:23], s37 offen sc1
s_waitcnt lgkmcnt(6)
v_mfma_f32_16x16x32_bf16 v[80:83], a[108:111], a[192:195], v[80:83]
ds_read_b64_tr_b16 a[100:101], v7 offset:18656
v_mfma_f32_16x16x32_bf16 v[84:87], a[108:111], a[196:199], v[84:87]
ds_read_b64_tr_b16 a[102:103], v7 offset:23264
v_mfma_f32_16x16x32_bf16 v[88:91], a[108:111], a[200:203], v[88:91]
buffer_load_dwordx2 a[186:187], v242, s[20:23], s37 offen offset:512 sc1
v_mfma_f32_16x16x32_bf16 v[92:95], a[108:111], a[204:207], v[92:95]
buffer_load_dwordx2 a[188:189], v243, s[20:23], s37 offen sc1
s_waitcnt lgkmcnt(6)
v_mfma_f32_16x16x32_bf16 v[96:99], a[112:115], a[192:195], v[96:99]
ds_read_b64_tr_b16 a[104:105], v7 offset:18688
v_mfma_f32_16x16x32_bf16 v[100:103], a[112:115], a[196:199], v[100:103]
ds_read_b64_tr_b16 a[106:107], v7 offset:23296
v_mfma_f32_16x16x32_bf16 v[104:107], a[112:115], a[200:203], v[104:107]
buffer_load_dwordx2 a[190:191], v243, s[20:23], s37 offen offset:512 sc1
v_mfma_f32_16x16x32_bf16 v[108:111], a[112:115], a[204:207], v[108:111]
s_add_u32 m0, s33, 18432
s_waitcnt lgkmcnt(6)
v_mfma_f32_16x16x32_bf16 v[112:115], a[116:119], a[192:195], v[112:115]
ds_read_b64_tr_b16 a[108:109], v7 offset:36864
v_mfma_f32_16x16x32_bf16 v[116:119], a[116:119], a[196:199], v[116:119]
ds_read_b64_tr_b16 a[110:111], v7 offset:41472
v_mfma_f32_16x16x32_bf16 v[120:123], a[116:119], a[200:203], v[120:123]
s_add_u32 s36, s32, 331776
v_mfma_f32_16x16x32_bf16 v[124:127], a[116:119], a[204:207], v[124:127]
buffer_load_dwordx4 v1, s[8:11], s36 offen offset:0 lds
s_waitcnt lgkmcnt(6)
v_mfma_f32_16x16x32_bf16 v[128:131], a[96:99], a[192:195], v[128:131]
ds_read_b64_tr_b16 a[112:113], v7 offset:36896
v_mfma_f32_16x16x32_bf16 v[132:135], a[96:99], a[196:199], v[132:135]
ds_read_b64_tr_b16 a[114:115], v7 offset:41504
v_mfma_f32_16x16x32_bf16 v[136:139], a[96:99], a[200:203], v[136:139]
buffer_load_dwordx4 v2, s[8:11], s36 offen offset:1024 lds
v_mfma_f32_16x16x32_bf16 v[140:143], a[96:99], a[204:207], v[140:143]
buffer_load_dwordx4 v3, s[8:11], s36 offen offset:2048 lds
s_waitcnt lgkmcnt(6)
v_mfma_f32_16x16x32_bf16 v[144:147], a[100:103], a[192:195], v[144:147]
ds_read_b64_tr_b16 a[116:117], v7 offset:36928
v_mfma_f32_16x16x32_bf16 v[148:151], a[100:103], a[196:199], v[148:151]
ds_read_b64_tr_b16 a[118:119], v7 offset:41536
v_mfma_f32_16x16x32_bf16 v[152:155], a[100:103], a[200:203], v[152:155]
buffer_load_dwordx4 v4, s[8:11], s36 offen offset:3072 lds
v_mfma_f32_16x16x32_bf16 v[156:159], a[100:103], a[204:207], v[156:159]
s_add_u32 m0, s35, 18432
s_waitcnt lgkmcnt(6)
v_mfma_f32_16x16x32_bf16 v[160:163], a[104:107], a[192:195], v[160:163]
ds_read_b64_tr_b16 a[96:97], v7 offset:36960
v_mfma_f32_16x16x32_bf16 v[164:167], a[104:107], a[196:199], v[164:167]
ds_read_b64_tr_b16 a[98:99], v7 offset:41568
v_mfma_f32_16x16x32_bf16 v[168:171], a[104:107], a[200:203], v[168:171]
s_mov_b64 exec, s[48:49]
buffer_load_dwordx4 v5, s[8:11], s36 offen lds
s_mov_b64 exec, -1
v_mfma_f32_16x16x32_bf16 v[172:175], a[104:107], a[204:207], v[172:175]
s_waitcnt vmcnt(48) lgkmcnt(6)
v_mfma_f32_16x16x32_bf16 v[32:35], a[108:111], a[128:131], v[32:35]
ds_read_b64_tr_b16 a[100:101], v7 offset:36992
v_mfma_f32_16x16x32_bf16 v[36:39], a[108:111], a[132:135], v[36:39]
ds_read_b64_tr_b16 a[102:103], v7 offset:41600
v_mfma_f32_16x16x32_bf16 v[40:43], a[108:111], a[136:139], v[40:43]
s_add_u32 s37, s34, 9216
v_mfma_f32_16x16x32_bf16 v[44:47], a[108:111], a[140:143], v[44:47]
buffer_load_dwordx4 a[192:195], v9, s[20:23], s37 offen sc1
s_waitcnt lgkmcnt(6)
v_mfma_f32_16x16x32_bf16 v[48:51], a[112:115], a[128:131], v[48:51]
ds_read_b64_tr_b16 a[104:105], v7 offset:37024
v_mfma_f32_16x16x32_bf16 v[52:55], a[112:115], a[132:135], v[52:55]
ds_read_b64_tr_b16 a[106:107], v7 offset:41632
v_mfma_f32_16x16x32_bf16 v[56:59], a[112:115], a[136:139], v[56:59]
buffer_load_dwordx4 a[196:199], v10, s[20:23], s37 offen sc1
v_mfma_f32_16x16x32_bf16 v[60:63], a[112:115], a[140:143], v[60:63]
buffer_load_dwordx4 a[200:203], v11, s[20:23], s37 offen sc1
s_waitcnt lgkmcnt(6)
v_mfma_f32_16x16x32_bf16 v[64:67], a[116:119], a[128:131], v[64:67]
ds_read_b64_tr_b16 a[108:109], v7 offset:37056
v_mfma_f32_16x16x32_bf16 v[68:71], a[116:119], a[132:135], v[68:71]
ds_read_b64_tr_b16 a[110:111], v7 offset:41664
v_mfma_f32_16x16x32_bf16 v[72:75], a[116:119], a[136:139], v[72:75]
buffer_load_dwordx4 a[204:207], v12, s[20:23], s37 offen sc1
v_mfma_f32_16x16x32_bf16 v[76:79], a[116:119], a[140:143], v[76:79]
s_waitcnt lgkmcnt(6)
v_mfma_f32_16x16x32_bf16 v[80:83], a[96:99], a[128:131], v[80:83]
ds_read_b64_tr_b16 a[112:113], v7 offset:37088
v_mfma_f32_16x16x32_bf16 v[84:87], a[96:99], a[132:135], v[84:87]
ds_read_b64_tr_b16 a[114:115], v7 offset:41696
v_mfma_f32_16x16x32_bf16 v[88:91], a[96:99], a[136:139], v[88:91]
s_add_u32 m0, s33, 36864
v_mfma_f32_16x16x32_bf16 v[92:95], a[96:99], a[140:143], v[92:95]
s_add_u32 s36, s32, 368640
s_waitcnt lgkmcnt(6)
v_mfma_f32_16x16x32_bf16 v[96:99], a[100:103], a[128:131], v[96:99]
ds_read_b64_tr_b16 a[116:117], v7 offset:37120
v_mfma_f32_16x16x32_bf16 v[100:103], a[100:103], a[132:135], v[100:103]
ds_read_b64_tr_b16 a[118:119], v7 offset:41728
v_mfma_f32_16x16x32_bf16 v[104:107], a[100:103], a[136:139], v[104:107]
s_waitcnt vmcnt(34)
v_mfma_f32_16x16x32_bf16 v[108:111], a[100:103], a[140:143], v[108:111]
s_barrier
s_waitcnt lgkmcnt(6)
v_mfma_f32_16x16x32_bf16 v[112:115], a[104:107], a[128:131], v[112:115]
ds_read_b64_tr_b16 a[96:97], v8 offset:0
v_mfma_f32_16x16x32_bf16 v[116:119], a[104:107], a[132:135], v[116:119]
ds_read_b64_tr_b16 a[98:99], v8 offset:4608
v_mfma_f32_16x16x32_bf16 v[120:123], a[104:107], a[136:139], v[120:123]
buffer_load_dwordx4 v1, s[8:11], s36 offen offset:0 lds
v_mfma_f32_16x16x32_bf16 v[124:127], a[104:107], a[140:143], v[124:127]
buffer_load_dwordx4 v2, s[8:11], s36 offen offset:1024 lds
s_waitcnt lgkmcnt(6)
v_mfma_f32_16x16x32_bf16 v[128:131], a[108:111], a[128:131], v[128:131]
ds_read_b64_tr_b16 a[100:101], v8 offset:32
v_mfma_f32_16x16x32_bf16 v[132:135], a[108:111], a[132:135], v[132:135]
ds_read_b64_tr_b16 a[102:103], v8 offset:4640
v_mfma_f32_16x16x32_bf16 v[136:139], a[108:111], a[136:139], v[136:139]
v_mfma_f32_16x16x32_bf16 v[140:143], a[108:111], a[140:143], v[140:143]
buffer_load_dwordx4 v3, s[8:11], s36 offen offset:2048 lds
s_waitcnt lgkmcnt(6)
v_mfma_f32_16x16x32_bf16 v[144:147], a[112:115], a[128:131], v[144:147]
ds_read_b64_tr_b16 a[104:105], v8 offset:64
v_mfma_f32_16x16x32_bf16 v[148:151], a[112:115], a[132:135], v[148:151]
ds_read_b64_tr_b16 a[106:107], v8 offset:4672
v_mfma_f32_16x16x32_bf16 v[152:155], a[112:115], a[136:139], v[152:155]
buffer_load_dwordx4 v4, s[8:11], s36 offen offset:3072 lds
v_mfma_f32_16x16x32_bf16 v[156:159], a[112:115], a[140:143], v[156:159]
s_add_u32 m0, s35, 36864
s_waitcnt lgkmcnt(6)
v_mfma_f32_16x16x32_bf16 v[160:163], a[116:119], a[128:131], v[160:163]
ds_read_b64_tr_b16 a[108:109], v8 offset:96
v_mfma_f32_16x16x32_bf16 v[164:167], a[116:119], a[132:135], v[164:167]
ds_read_b64_tr_b16 a[110:111], v8 offset:4704
v_mfma_f32_16x16x32_bf16 v[168:171], a[116:119], a[136:139], v[168:171]
s_mov_b64 exec, s[48:49]
buffer_load_dwordx4 v5, s[8:11], s36 offen lds
s_mov_b64 exec, -1
v_mfma_f32_16x16x32_bf16 v[172:175], a[116:119], a[140:143], v[172:175]
s_waitcnt lgkmcnt(6)
v_mfma_f32_16x16x32_bf16 v[32:35], a[96:99], a[144:147], v[32:35]
ds_read_b64_tr_b16 a[112:113], v8 offset:128
v_mfma_f32_16x16x32_bf16 v[36:39], a[96:99], a[148:151], v[36:39]
ds_read_b64_tr_b16 a[114:115], v8 offset:4736
v_mfma_f32_16x16x32_bf16 v[40:43], a[96:99], a[152:155], v[40:43]
s_add_u32 s37, s34, 10240
v_mfma_f32_16x16x32_bf16 v[44:47], a[96:99], a[156:159], v[44:47]
buffer_load_dwordx4 a[128:131], v9, s[20:23], s37 offen sc1
s_waitcnt lgkmcnt(6)
v_mfma_f32_16x16x32_bf16 v[48:51], a[100:103], a[144:147], v[48:51]
ds_read_b64_tr_b16 a[116:117], v8 offset:160
v_mfma_f32_16x16x32_bf16 v[52:55], a[100:103], a[148:151], v[52:55]
ds_read_b64_tr_b16 a[118:119], v8 offset:4768
v_mfma_f32_16x16x32_bf16 v[56:59], a[100:103], a[152:155], v[56:59]
buffer_load_dwordx4 a[132:135], v10, s[20:23], s37 offen sc1
v_mfma_f32_16x16x32_bf16 v[60:63], a[100:103], a[156:159], v[60:63]
buffer_load_dwordx4 a[136:139], v11, s[20:23], s37 offen sc1
s_waitcnt lgkmcnt(6)
v_mfma_f32_16x16x32_bf16 v[64:67], a[104:107], a[144:147], v[64:67]
ds_read_b64_tr_b16 a[96:97], v8 offset:192
v_mfma_f32_16x16x32_bf16 v[68:71], a[104:107], a[148:151], v[68:71]
ds_read_b64_tr_b16 a[98:99], v8 offset:4800
v_mfma_f32_16x16x32_bf16 v[72:75], a[104:107], a[152:155], v[72:75]
v_mfma_f32_16x16x32_bf16 v[76:79], a[104:107], a[156:159], v[76:79]
buffer_load_dwordx4 a[140:143], v12, s[20:23], s37 offen sc1
s_waitcnt lgkmcnt(6)
v_mfma_f32_16x16x32_bf16 v[80:83], a[108:111], a[144:147], v[80:83]
ds_read_b64_tr_b16 a[100:101], v8 offset:224
v_mfma_f32_16x16x32_bf16 v[84:87], a[108:111], a[148:151], v[84:87]
ds_read_b64_tr_b16 a[102:103], v8 offset:4832
v_mfma_f32_16x16x32_bf16 v[88:91], a[108:111], a[152:155], v[88:91]
s_add_u32 m0, s33, 55296
v_mfma_f32_16x16x32_bf16 v[92:95], a[108:111], a[156:159], v[92:95]
s_add_u32 s36, s32, 405504
s_waitcnt lgkmcnt(6)
v_mfma_f32_16x16x32_bf16 v[96:99], a[112:115], a[144:147], v[96:99]
ds_read_b64_tr_b16 a[104:105], v8 offset:256
v_mfma_f32_16x16x32_bf16 v[100:103], a[112:115], a[148:151], v[100:103]
ds_read_b64_tr_b16 a[106:107], v8 offset:4864
v_mfma_f32_16x16x32_bf16 v[104:107], a[112:115], a[152:155], v[104:107]
v_mfma_f32_16x16x32_bf16 v[108:111], a[112:115], a[156:159], v[108:111]
buffer_load_dwordx4 v1, s[8:11], s36 offen offset:0 lds
s_waitcnt lgkmcnt(6)
v_mfma_f32_16x16x32_bf16 v[112:115], a[116:119], a[144:147], v[112:115]
ds_read_b64_tr_b16 a[108:109], v8 offset:18432
v_mfma_f32_16x16x32_bf16 v[116:119], a[116:119], a[148:151], v[116:119]
ds_read_b64_tr_b16 a[110:111], v8 offset:23040
v_mfma_f32_16x16x32_bf16 v[120:123], a[116:119], a[152:155], v[120:123]
buffer_load_dwordx4 v2, s[8:11], s36 offen offset:1024 lds
v_mfma_f32_16x16x32_bf16 v[124:127], a[116:119], a[156:159], v[124:127]
buffer_load_dwordx4 v3, s[8:11], s36 offen offset:2048 lds
s_waitcnt lgkmcnt(6)
v_mfma_f32_16x16x32_bf16 v[128:131], a[96:99], a[144:147], v[128:131]
ds_read_b64_tr_b16 a[112:113], v8 offset:18464
v_mfma_f32_16x16x32_bf16 v[132:135], a[96:99], a[148:151], v[132:135]
ds_read_b64_tr_b16 a[114:115], v8 offset:23072
v_mfma_f32_16x16x32_bf16 v[136:139], a[96:99], a[152:155], v[136:139]
buffer_load_dwordx4 v4, s[8:11], s36 offen offset:3072 lds
v_mfma_f32_16x16x32_bf16 v[140:143], a[96:99], a[156:159], v[140:143]
s_waitcnt lgkmcnt(6)
v_mfma_f32_16x16x32_bf16 v[144:147], a[100:103], a[144:147], v[144:147]
ds_read_b64_tr_b16 a[116:117], v8 offset:18496
v_mfma_f32_16x16x32_bf16 v[148:151], a[100:103], a[148:151], v[148:151]
ds_read_b64_tr_b16 a[118:119], v8 offset:23104
v_mfma_f32_16x16x32_bf16 v[152:155], a[100:103], a[152:155], v[152:155]
s_add_u32 m0, s35, 55296
v_mfma_f32_16x16x32_bf16 v[156:159], a[100:103], a[156:159], v[156:159]
s_mov_b64 exec, s[48:49]
buffer_load_dwordx4 v5, s[8:11], s36 offen lds
s_mov_b64 exec, -1
s_waitcnt lgkmcnt(6)
v_mfma_f32_16x16x32_bf16 v[160:163], a[104:107], a[144:147], v[160:163]
ds_read_b64_tr_b16 a[96:97], v8 offset:18528
v_mfma_f32_16x16x32_bf16 v[164:167], a[104:107], a[148:151], v[164:167]
ds_read_b64_tr_b16 a[98:99], v8 offset:23136
v_mfma_f32_16x16x32_bf16 v[168:171], a[104:107], a[152:155], v[168:171]
s_waitcnt vmcnt(31)
v_mfma_f32_16x16x32_bf16 v[172:175], a[104:107], a[156:159], v[172:175]
s_waitcnt lgkmcnt(6)
v_mfma_f32_16x16x32_bf16 v[32:35], a[108:111], a[160:163], v[32:35]
ds_read_b64_tr_b16 a[100:101], v8 offset:18560
v_mfma_f32_16x16x32_bf16 v[36:39], a[108:111], a[164:167], v[36:39]
ds_read_b64_tr_b16 a[102:103], v8 offset:23168
v_mfma_f32_16x16x32_bf16 v[40:43], a[108:111], a[168:171], v[40:43]
s_add_u32 s37, s34, 11264
v_mfma_f32_16x16x32_bf16 v[44:47], a[108:111], a[172:175], v[44:47]
buffer_load_dwordx4 a[144:147], v9, s[20:23], s37 offen sc1
s_waitcnt lgkmcnt(6)
v_mfma_f32_16x16x32_bf16 v[48:51], a[112:115], a[160:163], v[48:51]
ds_read_b64_tr_b16 a[104:105], v8 offset:18592
v_mfma_f32_16x16x32_bf16 v[52:55], a[112:115], a[164:167], v[52:55]
ds_read_b64_tr_b16 a[106:107], v8 offset:23200
v_mfma_f32_16x16x32_bf16 v[56:59], a[112:115], a[168:171], v[56:59]
buffer_load_dwordx4 a[148:151], v10, s[20:23], s37 offen sc1
v_mfma_f32_16x16x32_bf16 v[60:63], a[112:115], a[172:175], v[60:63]
buffer_load_dwordx4 a[152:155], v11, s[20:23], s37 offen sc1
s_waitcnt lgkmcnt(6)
v_mfma_f32_16x16x32_bf16 v[64:67], a[116:119], a[160:163], v[64:67]
ds_read_b64_tr_b16 a[108:109], v8 offset:18624
v_mfma_f32_16x16x32_bf16 v[68:71], a[116:119], a[164:167], v[68:71]
ds_read_b64_tr_b16 a[110:111], v8 offset:23232
v_mfma_f32_16x16x32_bf16 v[72:75], a[116:119], a[168:171], v[72:75]
buffer_load_dwordx4 a[156:159], v12, s[20:23], s37 offen sc1
v_mfma_f32_16x16x32_bf16 v[76:79], a[116:119], a[172:175], v[76:79]
s_waitcnt lgkmcnt(6)
v_mfma_f32_16x16x32_bf16 v[80:83], a[96:99], a[160:163], v[80:83]
ds_read_b64_tr_b16 a[112:113], v8 offset:18656
v_mfma_f32_16x16x32_bf16 v[84:87], a[96:99], a[164:167], v[84:87]
ds_read_b64_tr_b16 a[114:115], v8 offset:23264
v_mfma_f32_16x16x32_bf16 v[88:91], a[96:99], a[168:171], v[88:91]
s_add_u32 m0, s33, 73728
v_mfma_f32_16x16x32_bf16 v[92:95], a[96:99], a[172:175], v[92:95]
s_add_u32 s36, s32, 442368
s_waitcnt lgkmcnt(6)
v_mfma_f32_16x16x32_bf16 v[96:99], a[100:103], a[160:163], v[96:99]
ds_read_b64_tr_b16 a[116:117], v8 offset:18688
v_mfma_f32_16x16x32_bf16 v[100:103], a[100:103], a[164:167], v[100:103]
ds_read_b64_tr_b16 a[118:119], v8 offset:23296
v_mfma_f32_16x16x32_bf16 v[104:107], a[100:103], a[168:171], v[104:107]
s_waitcnt vmcnt(22)
v_mfma_f32_16x16x32_bf16 v[108:111], a[100:103], a[172:175], v[108:111]
s_barrier
s_waitcnt lgkmcnt(6)
v_mfma_f32_16x16x32_bf16 v[112:115], a[104:107], a[160:163], v[112:115]
ds_read_b64_tr_b16 a[96:97], v6 offset:0
v_mfma_f32_16x16x32_bf16 v[116:119], a[104:107], a[164:167], v[116:119]
ds_read_b64_tr_b16 a[98:99], v6 offset:4608
v_mfma_f32_16x16x32_bf16 v[120:123], a[104:107], a[168:171], v[120:123]
buffer_load_dwordx4 v1, s[8:11], s36 offen offset:0 lds
v_mfma_f32_16x16x32_bf16 v[124:127], a[104:107], a[172:175], v[124:127]
buffer_load_dwordx4 v2, s[8:11], s36 offen offset:1024 lds
s_waitcnt lgkmcnt(6)
v_mfma_f32_16x16x32_bf16 v[128:131], a[108:111], a[160:163], v[128:131]
ds_read_b64_tr_b16 a[100:101], v6 offset:32
v_mfma_f32_16x16x32_bf16 v[132:135], a[108:111], a[164:167], v[132:135]
ds_read_b64_tr_b16 a[102:103], v6 offset:4640
v_mfma_f32_16x16x32_bf16 v[136:139], a[108:111], a[168:171], v[136:139]
v_mfma_f32_16x16x32_bf16 v[140:143], a[108:111], a[172:175], v[140:143]
buffer_load_dwordx4 v3, s[8:11], s36 offen offset:2048 lds
s_waitcnt lgkmcnt(6)
v_mfma_f32_16x16x32_bf16 v[144:147], a[112:115], a[160:163], v[144:147]
ds_read_b64_tr_b16 a[104:105], v6 offset:64
v_mfma_f32_16x16x32_bf16 v[148:151], a[112:115], a[164:167], v[148:151]
ds_read_b64_tr_b16 a[106:107], v6 offset:4672
v_mfma_f32_16x16x32_bf16 v[152:155], a[112:115], a[168:171], v[152:155]
buffer_load_dwordx4 v4, s[8:11], s36 offen offset:3072 lds
v_mfma_f32_16x16x32_bf16 v[156:159], a[112:115], a[172:175], v[156:159]
s_add_u32 m0, s35, 73728
s_waitcnt lgkmcnt(6)
v_mfma_f32_16x16x32_bf16 v[160:163], a[116:119], a[160:163], v[160:163]
ds_read_b64_tr_b16 a[108:109], v6 offset:96
v_mfma_f32_16x16x32_bf16 v[164:167], a[116:119], a[164:167], v[164:167]
ds_read_b64_tr_b16 a[110:111], v6 offset:4704
v_mfma_f32_16x16x32_bf16 v[168:171], a[116:119], a[168:171], v[168:171]
s_mov_b64 exec, s[48:49]
buffer_load_dwordx4 v5, s[8:11], s36 offen lds
s_mov_b64 exec, -1
v_mfma_f32_16x16x32_bf16 v[172:175], a[116:119], a[172:175], v[172:175]
s_waitcnt lgkmcnt(6)
v_mfma_f32_16x16x32_bf16 v[32:35], a[96:99], a[176:179], v[32:35]
ds_read_b64_tr_b16 a[112:113], v6 offset:128
v_mfma_f32_16x16x32_bf16 v[36:39], a[96:99], a[180:183], v[36:39]
ds_read_b64_tr_b16 a[114:115], v6 offset:4736
v_mfma_f32_16x16x32_bf16 v[40:43], a[96:99], a[184:187], v[40:43]
s_add_u32 s37, s34, 12288
v_mfma_f32_16x16x32_bf16 v[44:47], a[96:99], a[188:191], v[44:47]
buffer_load_dwordx4 a[160:163], v9, s[20:23], s37 offen sc1
s_waitcnt lgkmcnt(6)
v_mfma_f32_16x16x32_bf16 v[48:51], a[100:103], a[176:179], v[48:51]
ds_read_b64_tr_b16 a[116:117], v6 offset:160
v_mfma_f32_16x16x32_bf16 v[52:55], a[100:103], a[180:183], v[52:55]
ds_read_b64_tr_b16 a[118:119], v6 offset:4768
v_mfma_f32_16x16x32_bf16 v[56:59], a[100:103], a[184:187], v[56:59]
buffer_load_dwordx4 a[164:167], v10, s[20:23], s37 offen sc1
v_mfma_f32_16x16x32_bf16 v[60:63], a[100:103], a[188:191], v[60:63]
buffer_load_dwordx4 a[168:171], v11, s[20:23], s37 offen sc1
s_waitcnt lgkmcnt(6)
v_mfma_f32_16x16x32_bf16 v[64:67], a[104:107], a[176:179], v[64:67]
ds_read_b64_tr_b16 a[96:97], v6 offset:192
v_mfma_f32_16x16x32_bf16 v[68:71], a[104:107], a[180:183], v[68:71]
ds_read_b64_tr_b16 a[98:99], v6 offset:4800
v_mfma_f32_16x16x32_bf16 v[72:75], a[104:107], a[184:187], v[72:75]
v_mfma_f32_16x16x32_bf16 v[76:79], a[104:107], a[188:191], v[76:79]
buffer_load_dwordx4 a[172:175], v12, s[20:23], s37 offen sc1
s_waitcnt lgkmcnt(6)
v_mfma_f32_16x16x32_bf16 v[80:83], a[108:111], a[176:179], v[80:83]
ds_read_b64_tr_b16 a[100:101], v6 offset:224
v_mfma_f32_16x16x32_bf16 v[84:87], a[108:111], a[180:183], v[84:87]
ds_read_b64_tr_b16 a[102:103], v6 offset:4832
v_mfma_f32_16x16x32_bf16 v[88:91], a[108:111], a[184:187], v[88:91]
s_add_u32 m0, s33, 92160
v_mfma_f32_16x16x32_bf16 v[92:95], a[108:111], a[188:191], v[92:95]
s_add_u32 s36, s32, 497664
s_waitcnt lgkmcnt(6)
v_mfma_f32_16x16x32_bf16 v[96:99], a[112:115], a[176:179], v[96:99]
ds_read_b64_tr_b16 a[104:105], v6 offset:256
v_mfma_f32_16x16x32_bf16 v[100:103], a[112:115], a[180:183], v[100:103]
ds_read_b64_tr_b16 a[106:107], v6 offset:4864
v_mfma_f32_16x16x32_bf16 v[104:107], a[112:115], a[184:187], v[104:107]
v_mfma_f32_16x16x32_bf16 v[108:111], a[112:115], a[188:191], v[108:111]
buffer_load_dwordx4 v1, s[8:11], s36 offen offset:0 lds
s_waitcnt lgkmcnt(6)
v_mfma_f32_16x16x32_bf16 v[112:115], a[116:119], a[176:179], v[112:115]
ds_read_b64_tr_b16 a[108:109], v6 offset:18432
v_mfma_f32_16x16x32_bf16 v[116:119], a[116:119], a[180:183], v[116:119]
ds_read_b64_tr_b16 a[110:111], v6 offset:23040
v_mfma_f32_16x16x32_bf16 v[120:123], a[116:119], a[184:187], v[120:123]
buffer_load_dwordx4 v2, s[8:11], s36 offen offset:1024 lds
v_mfma_f32_16x16x32_bf16 v[124:127], a[116:119], a[188:191], v[124:127]
buffer_load_dwordx4 v3, s[8:11], s36 offen offset:2048 lds
s_waitcnt lgkmcnt(6)
v_mfma_f32_16x16x32_bf16 v[128:131], a[96:99], a[176:179], v[128:131]
ds_read_b64_tr_b16 a[112:113], v6 offset:18464
v_mfma_f32_16x16x32_bf16 v[132:135], a[96:99], a[180:183], v[132:135]
ds_read_b64_tr_b16 a[114:115], v6 offset:23072
v_mfma_f32_16x16x32_bf16 v[136:139], a[96:99], a[184:187], v[136:139]
buffer_load_dwordx4 v4, s[8:11], s36 offen offset:3072 lds
v_mfma_f32_16x16x32_bf16 v[140:143], a[96:99], a[188:191], v[140:143]
s_waitcnt lgkmcnt(6)
v_mfma_f32_16x16x32_bf16 v[144:147], a[100:103], a[176:179], v[144:147]
ds_read_b64_tr_b16 a[116:117], v6 offset:18496
v_mfma_f32_16x16x32_bf16 v[148:151], a[100:103], a[180:183], v[148:151]
ds_read_b64_tr_b16 a[118:119], v6 offset:23104
v_mfma_f32_16x16x32_bf16 v[152:155], a[100:103], a[184:187], v[152:155]
s_add_u32 m0, s35, 92160
v_mfma_f32_16x16x32_bf16 v[156:159], a[100:103], a[188:191], v[156:159]
s_mov_b64 exec, s[48:49]
buffer_load_dwordx4 v5, s[8:11], s36 offen lds
s_mov_b64 exec, -1
s_waitcnt lgkmcnt(6)
v_mfma_f32_16x16x32_bf16 v[160:163], a[104:107], a[176:179], v[160:163]
ds_read_b64_tr_b16 a[96:97], v6 offset:18528
v_mfma_f32_16x16x32_bf16 v[164:167], a[104:107], a[180:183], v[164:167]
ds_read_b64_tr_b16 a[98:99], v6 offset:23136
v_mfma_f32_16x16x32_bf16 v[168:171], a[104:107], a[184:187], v[168:171]
s_lshl_b32 s68, s30, 7
s_mov_b32 s69, s29
s_lshl_b32 s69, s69, 2
s_add_u32 s68, s68, s69
s_add_u32 s68, s68, 113248256
s_cmp_eq_u32 s28, 0
s_cselect_b32 s68, s68, 0x10000000
v_mov_b32 v26, 1
s_mov_b64 exec, 1
buffer_store_dword v26, off, s[20:23], s68 sc1
s_mov_b64 exec, -1
s_nop 1
v_mfma_f32_16x16x32_bf16 v[172:175], a[104:107], a[188:191], v[172:175]
s_waitcnt vmcnt(33) lgkmcnt(6)
v_mfma_f32_16x16x32_bf16 v[32:35], a[108:111], a[192:195], v[32:35]
ds_read_b64_tr_b16 a[100:101], v6 offset:18560
v_mfma_f32_16x16x32_bf16 v[36:39], a[108:111], a[196:199], v[36:39]
ds_read_b64_tr_b16 a[102:103], v6 offset:23168
v_mfma_f32_16x16x32_bf16 v[40:43], a[108:111], a[200:203], v[40:43]
s_add_u32 s37, s34, 13312
v_mfma_f32_16x16x32_bf16 v[44:47], a[108:111], a[204:207], v[44:47]
buffer_load_dwordx4 a[176:179], v9, s[20:23], s37 offen sc1
s_waitcnt lgkmcnt(6)
v_mfma_f32_16x16x32_bf16 v[48:51], a[112:115], a[192:195], v[48:51]
ds_read_b64_tr_b16 a[104:105], v6 offset:18592
v_mfma_f32_16x16x32_bf16 v[52:55], a[112:115], a[196:199], v[52:55]
ds_read_b64_tr_b16 a[106:107], v6 offset:23200
v_mfma_f32_16x16x32_bf16 v[56:59], a[112:115], a[200:203], v[56:59]
buffer_load_dwordx4 a[180:183], v10, s[20:23], s37 offen sc1
v_mfma_f32_16x16x32_bf16 v[60:63], a[112:115], a[204:207], v[60:63]
buffer_load_dwordx4 a[184:187], v11, s[20:23], s37 offen sc1
s_waitcnt lgkmcnt(6)
v_mfma_f32_16x16x32_bf16 v[64:67], a[116:119], a[192:195], v[64:67]
ds_read_b64_tr_b16 a[108:109], v6 offset:18624
v_mfma_f32_16x16x32_bf16 v[68:71], a[116:119], a[196:199], v[68:71]
ds_read_b64_tr_b16 a[110:111], v6 offset:23232
v_mfma_f32_16x16x32_bf16 v[72:75], a[116:119], a[200:203], v[72:75]
buffer_load_dwordx4 a[188:191], v12, s[20:23], s37 offen sc1
v_mfma_f32_16x16x32_bf16 v[76:79], a[116:119], a[204:207], v[76:79]
s_waitcnt lgkmcnt(6)
v_mfma_f32_16x16x32_bf16 v[80:83], a[96:99], a[192:195], v[80:83]
ds_read_b64_tr_b16 a[112:113], v6 offset:18656
v_mfma_f32_16x16x32_bf16 v[84:87], a[96:99], a[196:199], v[84:87]
ds_read_b64_tr_b16 a[114:115], v6 offset:23264
v_mfma_f32_16x16x32_bf16 v[88:91], a[96:99], a[200:203], v[88:91]
s_add_u32 m0, s33, 110592
v_mfma_f32_16x16x32_bf16 v[92:95], a[96:99], a[204:207], v[92:95]
s_add_u32 s36, s32, 534528
s_waitcnt lgkmcnt(6)
v_mfma_f32_16x16x32_bf16 v[96:99], a[100:103], a[192:195], v[96:99]
ds_read_b64_tr_b16 a[116:117], v6 offset:18688
v_mfma_f32_16x16x32_bf16 v[100:103], a[100:103], a[196:199], v[100:103]
ds_read_b64_tr_b16 a[118:119], v6 offset:23296
v_mfma_f32_16x16x32_bf16 v[104:107], a[100:103], a[200:203], v[104:107]
s_waitcnt vmcnt(23)
v_mfma_f32_16x16x32_bf16 v[108:111], a[100:103], a[204:207], v[108:111]
s_barrier
s_waitcnt lgkmcnt(6)
v_mfma_f32_16x16x32_bf16 v[112:115], a[104:107], a[192:195], v[112:115]
ds_read_b64_tr_b16 a[96:97], v6 offset:36864
v_mfma_f32_16x16x32_bf16 v[116:119], a[104:107], a[196:199], v[116:119]
ds_read_b64_tr_b16 a[98:99], v6 offset:41472
v_mfma_f32_16x16x32_bf16 v[120:123], a[104:107], a[200:203], v[120:123]
buffer_load_dwordx4 v1, s[8:11], s36 offen offset:0 lds
v_mfma_f32_16x16x32_bf16 v[124:127], a[104:107], a[204:207], v[124:127]
buffer_load_dwordx4 v2, s[8:11], s36 offen offset:1024 lds
s_waitcnt lgkmcnt(6)
v_mfma_f32_16x16x32_bf16 v[128:131], a[108:111], a[192:195], v[128:131]
ds_read_b64_tr_b16 a[100:101], v6 offset:36896
v_mfma_f32_16x16x32_bf16 v[132:135], a[108:111], a[196:199], v[132:135]
ds_read_b64_tr_b16 a[102:103], v6 offset:41504
v_mfma_f32_16x16x32_bf16 v[136:139], a[108:111], a[200:203], v[136:139]
v_mfma_f32_16x16x32_bf16 v[140:143], a[108:111], a[204:207], v[140:143]
buffer_load_dwordx4 v3, s[8:11], s36 offen offset:2048 lds
s_waitcnt lgkmcnt(6)
v_mfma_f32_16x16x32_bf16 v[144:147], a[112:115], a[192:195], v[144:147]
ds_read_b64_tr_b16 a[104:105], v6 offset:36928
v_mfma_f32_16x16x32_bf16 v[148:151], a[112:115], a[196:199], v[148:151]
ds_read_b64_tr_b16 a[106:107], v6 offset:41536
v_mfma_f32_16x16x32_bf16 v[152:155], a[112:115], a[200:203], v[152:155]
buffer_load_dwordx4 v4, s[8:11], s36 offen offset:3072 lds
v_mfma_f32_16x16x32_bf16 v[156:159], a[112:115], a[204:207], v[156:159]
s_add_u32 m0, s35, 110592
s_waitcnt lgkmcnt(6)
v_mfma_f32_16x16x32_bf16 v[160:163], a[116:119], a[192:195], v[160:163]
ds_read_b64_tr_b16 a[108:109], v6 offset:36960
v_mfma_f32_16x16x32_bf16 v[164:167], a[116:119], a[196:199], v[164:167]
ds_read_b64_tr_b16 a[110:111], v6 offset:41568
v_mfma_f32_16x16x32_bf16 v[168:171], a[116:119], a[200:203], v[168:171]
s_mov_b64 exec, s[48:49]
buffer_load_dwordx4 v5, s[8:11], s36 offen lds
s_mov_b64 exec, -1
v_mfma_f32_16x16x32_bf16 v[172:175], a[116:119], a[204:207], v[172:175]
s_waitcnt lgkmcnt(6)
v_mfma_f32_16x16x32_bf16 v[32:35], a[96:99], a[128:131], v[32:35]
ds_read_b64_tr_b16 a[112:113], v6 offset:36992
v_mfma_f32_16x16x32_bf16 v[36:39], a[96:99], a[132:135], v[36:39]
ds_read_b64_tr_b16 a[114:115], v6 offset:41600
v_mfma_f32_16x16x32_bf16 v[40:43], a[96:99], a[136:139], v[40:43]
s_add_u32 s37, s34, 14336
v_mfma_f32_16x16x32_bf16 v[44:47], a[96:99], a[140:143], v[44:47]
buffer_load_dwordx4 a[192:195], v9, s[20:23], s37 offen sc1
s_waitcnt lgkmcnt(6)
v_mfma_f32_16x16x32_bf16 v[48:51], a[100:103], a[128:131], v[48:51]
ds_read_b64_tr_b16 a[116:117], v6 offset:37024
v_mfma_f32_16x16x32_bf16 v[52:55], a[100:103], a[132:135], v[52:55]
ds_read_b64_tr_b16 a[118:119], v6 offset:41632
v_mfma_f32_16x16x32_bf16 v[56:59], a[100:103], a[136:139], v[56:59]
buffer_load_dwordx4 a[196:199], v10, s[20:23], s37 offen sc1
v_mfma_f32_16x16x32_bf16 v[60:63], a[100:103], a[140:143], v[60:63]
s_waitcnt lgkmcnt(6)
v_mfma_f32_16x16x32_bf16 v[64:67], a[104:107], a[128:131], v[64:67]
ds_read_b64_tr_b16 a[96:97], v6 offset:37056
v_mfma_f32_16x16x32_bf16 v[68:71], a[104:107], a[132:135], v[68:71]
ds_read_b64_tr_b16 a[98:99], v6 offset:41664
v_mfma_f32_16x16x32_bf16 v[72:75], a[104:107], a[136:139], v[72:75]
buffer_load_dwordx4 a[200:203], v11, s[20:23], s37 offen sc1
v_mfma_f32_16x16x32_bf16 v[76:79], a[104:107], a[140:143], v[76:79]
buffer_load_dwordx4 a[204:207], v12, s[20:23], s37 offen sc1
s_waitcnt lgkmcnt(6)
v_mfma_f32_16x16x32_bf16 v[80:83], a[108:111], a[128:131], v[80:83]
ds_read_b64_tr_b16 a[100:101], v6 offset:37088
v_mfma_f32_16x16x32_bf16 v[84:87], a[108:111], a[132:135], v[84:87]
ds_read_b64_tr_b16 a[102:103], v6 offset:41696
v_mfma_f32_16x16x32_bf16 v[88:91], a[108:111], a[136:139], v[88:91]
s_add_u32 m0, s33, 129024
v_mfma_f32_16x16x32_bf16 v[92:95], a[108:111], a[140:143], v[92:95]
s_waitcnt lgkmcnt(6)
v_mfma_f32_16x16x32_bf16 v[96:99], a[112:115], a[128:131], v[96:99]
ds_read_b64_tr_b16 a[104:105], v6 offset:37120
v_mfma_f32_16x16x32_bf16 v[100:103], a[112:115], a[132:135], v[100:103]
ds_read_b64_tr_b16 a[106:107], v6 offset:41728
v_mfma_f32_16x16x32_bf16 v[104:107], a[112:115], a[136:139], v[104:107]
s_add_u32 s36, s32, 571392
v_mfma_f32_16x16x32_bf16 v[108:111], a[112:115], a[140:143], v[108:111]
buffer_load_dwordx4 v1, s[8:11], s36 offen offset:0 lds
s_waitcnt lgkmcnt(6)
v_mfma_f32_16x16x32_bf16 v[112:115], a[116:119], a[128:131], v[112:115]
ds_read_b64_tr_b16 a[108:109], v7 offset:0
v_mfma_f32_16x16x32_bf16 v[116:119], a[116:119], a[132:135], v[116:119]
ds_read_b64_tr_b16 a[110:111], v7 offset:4608
v_mfma_f32_16x16x32_bf16 v[120:123], a[116:119], a[136:139], v[120:123]
v_mfma_f32_16x16x32_bf16 v[124:127], a[116:119], a[140:143], v[124:127]
buffer_load_dwordx4 v2, s[8:11], s36 offen offset:1024 lds
s_waitcnt lgkmcnt(6)
v_mfma_f32_16x16x32_bf16 v[128:131], a[96:99], a[128:131], v[128:131]
ds_read_b64_tr_b16 a[112:113], v7 offset:32
v_mfma_f32_16x16x32_bf16 v[132:135], a[96:99], a[132:135], v[132:135]
ds_read_b64_tr_b16 a[114:115], v7 offset:4640
v_mfma_f32_16x16x32_bf16 v[136:139], a[96:99], a[136:139], v[136:139]
buffer_load_dwordx4 v3, s[8:11], s36 offen offset:2048 lds
v_mfma_f32_16x16x32_bf16 v[140:143], a[96:99], a[140:143], v[140:143]
buffer_load_dwordx4 v4, s[8:11], s36 offen offset:3072 lds
s_waitcnt lgkmcnt(6)
v_mfma_f32_16x16x32_bf16 v[144:147], a[100:103], a[128:131], v[144:147]
ds_read_b64_tr_b16 a[116:117], v7 offset:64
v_mfma_f32_16x16x32_bf16 v[148:151], a[100:103], a[132:135], v[148:151]
ds_read_b64_tr_b16 a[118:119], v7 offset:4672
v_mfma_f32_16x16x32_bf16 v[152:155], a[100:103], a[136:139], v[152:155]
v_mfma_f32_16x16x32_bf16 v[156:159], a[100:103], a[140:143], v[156:159]
s_add_u32 m0, s35, 129024
s_waitcnt lgkmcnt(6)
v_mfma_f32_16x16x32_bf16 v[160:163], a[104:107], a[128:131], v[160:163]
ds_read_b64_tr_b16 a[96:97], v7 offset:96
v_mfma_f32_16x16x32_bf16 v[164:167], a[104:107], a[132:135], v[164:167]
ds_read_b64_tr_b16 a[98:99], v7 offset:4704
v_mfma_f32_16x16x32_bf16 v[168:171], a[104:107], a[136:139], v[168:171]
s_mov_b64 exec, s[48:49]
buffer_load_dwordx4 v5, s[8:11], s36 offen lds
s_mov_b64 exec, -1
v_mfma_f32_16x16x32_bf16 v[172:175], a[104:107], a[140:143], v[172:175]
s_waitcnt vmcnt(33) lgkmcnt(6)
v_mfma_f32_16x16x32_bf16 v[32:35], a[108:111], a[144:147], v[32:35]
ds_read_b64_tr_b16 a[100:101], v7 offset:128
v_mfma_f32_16x16x32_bf16 v[36:39], a[108:111], a[148:151], v[36:39]
ds_read_b64_tr_b16 a[102:103], v7 offset:4736
v_mfma_f32_16x16x32_bf16 v[40:43], a[108:111], a[152:155], v[40:43]
s_add_u32 s37, s34, 15360
v_mfma_f32_16x16x32_bf16 v[44:47], a[108:111], a[156:159], v[44:47]
buffer_load_dwordx4 a[128:131], v9, s[20:23], s37 offen sc1
s_waitcnt lgkmcnt(6)
v_mfma_f32_16x16x32_bf16 v[48:51], a[112:115], a[144:147], v[48:51]
ds_read_b64_tr_b16 a[104:105], v7 offset:160
v_mfma_f32_16x16x32_bf16 v[52:55], a[112:115], a[148:151], v[52:55]
ds_read_b64_tr_b16 a[106:107], v7 offset:4768
v_mfma_f32_16x16x32_bf16 v[56:59], a[112:115], a[152:155], v[56:59]
buffer_load_dwordx4 a[132:135], v10, s[20:23], s37 offen sc1
v_mfma_f32_16x16x32_bf16 v[60:63], a[112:115], a[156:159], v[60:63]
buffer_load_dwordx4 a[136:139], v11, s[20:23], s37 offen sc1
s_waitcnt lgkmcnt(6)
v_mfma_f32_16x16x32_bf16 v[64:67], a[116:119], a[144:147], v[64:67]
ds_read_b64_tr_b16 a[108:109], v7 offset:192
v_mfma_f32_16x16x32_bf16 v[68:71], a[116:119], a[148:151], v[68:71]
ds_read_b64_tr_b16 a[110:111], v7 offset:4800
v_mfma_f32_16x16x32_bf16 v[72:75], a[116:119], a[152:155], v[72:75]
buffer_load_dwordx4 a[140:143], v12, s[20:23], s37 offen sc1
v_mfma_f32_16x16x32_bf16 v[76:79], a[116:119], a[156:159], v[76:79]
s_waitcnt lgkmcnt(6)
v_mfma_f32_16x16x32_bf16 v[80:83], a[96:99], a[144:147], v[80:83]
ds_read_b64_tr_b16 a[112:113], v7 offset:224
v_mfma_f32_16x16x32_bf16 v[84:87], a[96:99], a[148:151], v[84:87]
ds_read_b64_tr_b16 a[114:115], v7 offset:4832
v_mfma_f32_16x16x32_bf16 v[88:91], a[96:99], a[152:155], v[88:91]
s_add_u32 m0, s33, 0
v_mfma_f32_16x16x32_bf16 v[92:95], a[96:99], a[156:159], v[92:95]
s_add_u32 s36, s32, 608256
s_waitcnt lgkmcnt(6)
v_mfma_f32_16x16x32_bf16 v[96:99], a[100:103], a[144:147], v[96:99]
ds_read_b64_tr_b16 a[116:117], v7 offset:256
v_mfma_f32_16x16x32_bf16 v[100:103], a[100:103], a[148:151], v[100:103]
ds_read_b64_tr_b16 a[118:119], v7 offset:4864
v_mfma_f32_16x16x32_bf16 v[104:107], a[100:103], a[152:155], v[104:107]
s_waitcnt vmcnt(23)
v_mfma_f32_16x16x32_bf16 v[108:111], a[100:103], a[156:159], v[108:111]
s_barrier
s_waitcnt lgkmcnt(6)
v_mfma_f32_16x16x32_bf16 v[112:115], a[104:107], a[144:147], v[112:115]
ds_read_b64_tr_b16 a[96:97], v7 offset:18432
v_mfma_f32_16x16x32_bf16 v[116:119], a[104:107], a[148:151], v[116:119]
ds_read_b64_tr_b16 a[98:99], v7 offset:23040
v_mfma_f32_16x16x32_bf16 v[120:123], a[104:107], a[152:155], v[120:123]
buffer_load_dwordx4 v1, s[8:11], s36 offen offset:0 lds
v_mfma_f32_16x16x32_bf16 v[124:127], a[104:107], a[156:159], v[124:127]
buffer_load_dwordx4 v2, s[8:11], s36 offen offset:1024 lds
s_waitcnt lgkmcnt(6)
v_mfma_f32_16x16x32_bf16 v[128:131], a[108:111], a[144:147], v[128:131]
ds_read_b64_tr_b16 a[100:101], v7 offset:18464
v_mfma_f32_16x16x32_bf16 v[132:135], a[108:111], a[148:151], v[132:135]
ds_read_b64_tr_b16 a[102:103], v7 offset:23072
v_mfma_f32_16x16x32_bf16 v[136:139], a[108:111], a[152:155], v[136:139]
v_mfma_f32_16x16x32_bf16 v[140:143], a[108:111], a[156:159], v[140:143]
buffer_load_dwordx4 v3, s[8:11], s36 offen offset:2048 lds
s_waitcnt lgkmcnt(6)
v_mfma_f32_16x16x32_bf16 v[144:147], a[112:115], a[144:147], v[144:147]
ds_read_b64_tr_b16 a[104:105], v7 offset:18496
v_mfma_f32_16x16x32_bf16 v[148:151], a[112:115], a[148:151], v[148:151]
ds_read_b64_tr_b16 a[106:107], v7 offset:23104
v_mfma_f32_16x16x32_bf16 v[152:155], a[112:115], a[152:155], v[152:155]
buffer_load_dwordx4 v4, s[8:11], s36 offen offset:3072 lds
v_mfma_f32_16x16x32_bf16 v[156:159], a[112:115], a[156:159], v[156:159]
s_add_u32 m0, s35, 0
s_waitcnt lgkmcnt(6)
v_mfma_f32_16x16x32_bf16 v[160:163], a[116:119], a[144:147], v[160:163]
ds_read_b64_tr_b16 a[108:109], v7 offset:18528
v_mfma_f32_16x16x32_bf16 v[164:167], a[116:119], a[148:151], v[164:167]
ds_read_b64_tr_b16 a[110:111], v7 offset:23136
v_mfma_f32_16x16x32_bf16 v[168:171], a[116:119], a[152:155], v[168:171]
s_mov_b64 exec, s[48:49]
buffer_load_dwordx4 v5, s[8:11], s36 offen lds
s_mov_b64 exec, -1
v_mfma_f32_16x16x32_bf16 v[172:175], a[116:119], a[156:159], v[172:175]
s_waitcnt lgkmcnt(6)
v_mfma_f32_16x16x32_bf16 v[32:35], a[96:99], a[160:163], v[32:35]
ds_read_b64_tr_b16 a[112:113], v7 offset:18560
v_mfma_f32_16x16x32_bf16 v[36:39], a[96:99], a[164:167], v[36:39]
ds_read_b64_tr_b16 a[114:115], v7 offset:23168
v_mfma_f32_16x16x32_bf16 v[40:43], a[96:99], a[168:171], v[40:43]
s_add_u32 s37, s34, 16384
v_mfma_f32_16x16x32_bf16 v[44:47], a[96:99], a[172:175], v[44:47]
buffer_load_dwordx4 a[144:147], v9, s[20:23], s37 offen sc1
s_waitcnt lgkmcnt(6)
v_mfma_f32_16x16x32_bf16 v[48:51], a[100:103], a[160:163], v[48:51]
ds_read_b64_tr_b16 a[116:117], v7 offset:18592
v_mfma_f32_16x16x32_bf16 v[52:55], a[100:103], a[164:167], v[52:55]
ds_read_b64_tr_b16 a[118:119], v7 offset:23200
v_mfma_f32_16x16x32_bf16 v[56:59], a[100:103], a[168:171], v[56:59]
buffer_load_dwordx4 a[148:151], v10, s[20:23], s37 offen sc1
v_mfma_f32_16x16x32_bf16 v[60:63], a[100:103], a[172:175], v[60:63]
buffer_load_dwordx4 a[152:155], v11, s[20:23], s37 offen sc1
s_waitcnt lgkmcnt(6)
v_mfma_f32_16x16x32_bf16 v[64:67], a[104:107], a[160:163], v[64:67]
ds_read_b64_tr_b16 a[96:97], v7 offset:18624
v_mfma_f32_16x16x32_bf16 v[68:71], a[104:107], a[164:167], v[68:71]
ds_read_b64_tr_b16 a[98:99], v7 offset:23232
v_mfma_f32_16x16x32_bf16 v[72:75], a[104:107], a[168:171], v[72:75]
buffer_load_dwordx4 a[156:159], v12, s[20:23], s37 offen sc1
v_mfma_f32_16x16x32_bf16 v[76:79], a[104:107], a[172:175], v[76:79]
s_waitcnt lgkmcnt(6)
v_mfma_f32_16x16x32_bf16 v[80:83], a[108:111], a[160:163], v[80:83]
ds_read_b64_tr_b16 a[100:101], v7 offset:18656
v_mfma_f32_16x16x32_bf16 v[84:87], a[108:111], a[164:167], v[84:87]
ds_read_b64_tr_b16 a[102:103], v7 offset:23264
v_mfma_f32_16x16x32_bf16 v[88:91], a[108:111], a[168:171], v[88:91]
s_add_u32 m0, s33, 18432
v_mfma_f32_16x16x32_bf16 v[92:95], a[108:111], a[172:175], v[92:95]
s_add_u32 s36, s32, 479232
s_waitcnt lgkmcnt(6)
v_mfma_f32_16x16x32_bf16 v[96:99], a[112:115], a[160:163], v[96:99]
ds_read_b64_tr_b16 a[104:105], v7 offset:18688
v_mfma_f32_16x16x32_bf16 v[100:103], a[112:115], a[164:167], v[100:103]
ds_read_b64_tr_b16 a[106:107], v7 offset:23296
v_mfma_f32_16x16x32_bf16 v[104:107], a[112:115], a[168:171], v[104:107]
s_add_u32 s36, s36, s39
v_mfma_f32_16x16x32_bf16 v[108:111], a[112:115], a[172:175], v[108:111]
buffer_load_dwordx4 v1, s[8:11], s36 offen offset:0 lds
s_waitcnt lgkmcnt(6)
v_mfma_f32_16x16x32_bf16 v[112:115], a[116:119], a[160:163], v[112:115]
ds_read_b64_tr_b16 a[108:109], v7 offset:36864
v_mfma_f32_16x16x32_bf16 v[116:119], a[116:119], a[164:167], v[116:119]
ds_read_b64_tr_b16 a[110:111], v7 offset:41472
v_mfma_f32_16x16x32_bf16 v[120:123], a[116:119], a[168:171], v[120:123]
buffer_load_dwordx4 v2, s[8:11], s36 offen offset:1024 lds
v_mfma_f32_16x16x32_bf16 v[124:127], a[116:119], a[172:175], v[124:127]
s_waitcnt lgkmcnt(6)
v_mfma_f32_16x16x32_bf16 v[128:131], a[96:99], a[160:163], v[128:131]
ds_read_b64_tr_b16 a[112:113], v7 offset:36896
v_mfma_f32_16x16x32_bf16 v[132:135], a[96:99], a[164:167], v[132:135]
ds_read_b64_tr_b16 a[114:115], v7 offset:41504
v_mfma_f32_16x16x32_bf16 v[136:139], a[96:99], a[168:171], v[136:139]
buffer_load_dwordx4 v3, s[8:11], s36 offen offset:2048 lds
v_mfma_f32_16x16x32_bf16 v[140:143], a[96:99], a[172:175], v[140:143]
buffer_load_dwordx4 v4, s[8:11], s36 offen offset:3072 lds
s_waitcnt lgkmcnt(6)
v_mfma_f32_16x16x32_bf16 v[144:147], a[100:103], a[160:163], v[144:147]
ds_read_b64_tr_b16 a[116:117], v7 offset:36928
v_mfma_f32_16x16x32_bf16 v[148:151], a[100:103], a[164:167], v[148:151]
ds_read_b64_tr_b16 a[118:119], v7 offset:41536
v_mfma_f32_16x16x32_bf16 v[152:155], a[100:103], a[168:171], v[152:155]
s_add_u32 m0, s35, 18432
v_mfma_f32_16x16x32_bf16 v[156:159], a[100:103], a[172:175], v[156:159]
s_mov_b64 exec, s[48:49]
buffer_load_dwordx4 v5, s[8:11], s36 offen lds
s_mov_b64 exec, -1
s_waitcnt lgkmcnt(6)
v_mfma_f32_16x16x32_bf16 v[160:163], a[104:107], a[160:163], v[160:163]
ds_read_b64_tr_b16 a[96:97], v7 offset:36960
v_mfma_f32_16x16x32_bf16 v[164:167], a[104:107], a[164:167], v[164:167]
ds_read_b64_tr_b16 a[98:99], v7 offset:41568
v_mfma_f32_16x16x32_bf16 v[168:171], a[104:107], a[168:171], v[168:171]
s_lshl_b32 s68, s98, 7
s_add_u32 s68, s68, 113248256
v_and_b32 v27, 31, v0
v_lshlrev_b32 v27, 2, v27
buffer_load_dword v27, v27, s[20:23], s68 offen sc1
v_mfma_f32_16x16x32_bf16 v[172:175], a[104:107], a[172:175], v[172:175]
s_waitcnt vmcnt(33) lgkmcnt(6)
v_mfma_f32_16x16x32_bf16 v[32:35], a[108:111], a[176:179], v[32:35]
ds_read_b64_tr_b16 a[100:101], v7 offset:36992
s_add_u32 s37, s34, 17408
v_mfma_f32_16x16x32_bf16 v[36:39], a[108:111], a[180:183], v[36:39]
ds_read_b64_tr_b16 a[102:103], v7 offset:41600
v_mfma_f32_16x16x32_bf16 v[40:43], a[108:111], a[184:187], v[40:43]
buffer_load_dwordx2 a[160:161], v240, s[20:23], s37 offen sc1
v_mfma_f32_16x16x32_bf16 v[44:47], a[108:111], a[188:191], v[44:47]
s_waitcnt lgkmcnt(6)
v_mfma_f32_16x16x32_bf16 v[48:51], a[112:115], a[176:179], v[48:51]
ds_read_b64_tr_b16 a[104:105], v7 offset:37024
buffer_load_dwordx2 a[162:163], v240, s[20:23], s37 offen offset:512 sc1
v_mfma_f32_16x16x32_bf16 v[52:55], a[112:115], a[180:183], v[52:55]
ds_read_b64_tr_b16 a[106:107], v7 offset:41632
v_mfma_f32_16x16x32_bf16 v[56:59], a[112:115], a[184:187], v[56:59]
buffer_load_dwordx2 a[164:165], v241, s[20:23], s37 offen sc1
v_mfma_f32_16x16x32_bf16 v[60:63], a[112:115], a[188:191], v[60:63]
s_waitcnt lgkmcnt(6)
v_mfma_f32_16x16x32_bf16 v[64:67], a[116:119], a[176:179], v[64:67]
ds_read_b64_tr_b16 a[108:109], v7 offset:37056
buffer_load_dwordx2 a[166:167], v241, s[20:23], s37 offen offset:512 sc1
v_mfma_f32_16x16x32_bf16 v[68:71], a[116:119], a[180:183], v[68:71]
ds_read_b64_tr_b16 a[110:111], v7 offset:41664
v_mfma_f32_16x16x32_bf16 v[72:75], a[116:119], a[184:187], v[72:75]
buffer_load_dwordx2 a[168:169], v242, s[20:23], s37 offen sc1
v_mfma_f32_16x16x32_bf16 v[76:79], a[116:119], a[188:191], v[76:79]
s_waitcnt lgkmcnt(6)
v_mfma_f32_16x16x32_bf16 v[80:83], a[96:99], a[176:179], v[80:83]
ds_read_b64_tr_b16 a[112:113], v7 offset:37088
buffer_load_dwordx2 a[170:171], v242, s[20:23], s37 offen offset:512 sc1
v_mfma_f32_16x16x32_bf16 v[84:87], a[96:99], a[180:183], v[84:87]
ds_read_b64_tr_b16 a[114:115], v7 offset:41696
v_mfma_f32_16x16x32_bf16 v[88:91], a[96:99], a[184:187], v[88:91]
buffer_load_dwordx2 a[172:173], v243, s[20:23], s37 offen sc1
v_mfma_f32_16x16x32_bf16 v[92:95], a[96:99], a[188:191], v[92:95]
s_waitcnt lgkmcnt(6)
v_mfma_f32_16x16x32_bf16 v[96:99], a[100:103], a[176:179], v[96:99]
ds_read_b64_tr_b16 a[116:117], v7 offset:37120
buffer_load_dwordx2 a[174:175], v243, s[20:23], s37 offen offset:512 sc1
v_mfma_f32_16x16x32_bf16 v[100:103], a[100:103], a[180:183], v[100:103]
ds_read_b64_tr_b16 a[118:119], v7 offset:41728
v_mfma_f32_16x16x32_bf16 v[104:107], a[100:103], a[184:187], v[104:107]
s_waitcnt vmcnt(27)
v_mfma_f32_16x16x32_bf16 v[108:111], a[100:103], a[188:191], v[108:111]
s_barrier
s_waitcnt lgkmcnt(6)
v_mfma_f32_16x16x32_bf16 v[112:115], a[104:107], a[176:179], v[112:115]
ds_read_b64_tr_b16 a[96:97], v8 offset:0
s_add_u32 m0, s33, 36864
v_mfma_f32_16x16x32_bf16 v[116:119], a[104:107], a[180:183], v[116:119]
ds_read_b64_tr_b16 a[98:99], v8 offset:4608
s_add_u32 s36, s62, 0
v_mfma_f32_16x16x32_bf16 v[120:123], a[104:107], a[184:187], v[120:123]
v_mfma_f32_16x16x32_bf16 v[124:127], a[104:107], a[188:191], v[124:127]
buffer_load_dwordx4 v1, s[16:19], s36 offen offset:0 lds
s_waitcnt lgkmcnt(6)
v_mfma_f32_16x16x32_bf16 v[128:131], a[108:111], a[176:179], v[128:131]
ds_read_b64_tr_b16 a[100:101], v8 offset:32
v_mfma_f32_16x16x32_bf16 v[132:135], a[108:111], a[180:183], v[132:135]
ds_read_b64_tr_b16 a[102:103], v8 offset:4640
buffer_load_dwordx4 v2, s[16:19], s36 offen offset:1024 lds
v_mfma_f32_16x16x32_bf16 v[136:139], a[108:111], a[184:187], v[136:139]
v_mfma_f32_16x16x32_bf16 v[140:143], a[108:111], a[188:191], v[140:143]
buffer_load_dwordx4 v3, s[16:19], s36 offen offset:2048 lds
s_waitcnt lgkmcnt(6)
v_mfma_f32_16x16x32_bf16 v[144:147], a[112:115], a[176:179], v[144:147]
ds_read_b64_tr_b16 a[104:105], v8 offset:64
v_mfma_f32_16x16x32_bf16 v[148:151], a[112:115], a[180:183], v[148:151]
ds_read_b64_tr_b16 a[106:107], v8 offset:4672
buffer_load_dwordx4 v4, s[16:19], s36 offen offset:3072 lds
v_mfma_f32_16x16x32_bf16 v[152:155], a[112:115], a[184:187], v[152:155]
v_mfma_f32_16x16x32_bf16 v[156:159], a[112:115], a[188:191], v[156:159]
s_add_u32 m0, s35, 36864
s_waitcnt lgkmcnt(6)
v_mfma_f32_16x16x32_bf16 v[160:163], a[116:119], a[176:179], v[160:163]
ds_read_b64_tr_b16 a[108:109], v8 offset:96
v_mfma_f32_16x16x32_bf16 v[164:167], a[116:119], a[180:183], v[164:167]
ds_read_b64_tr_b16 a[110:111], v8 offset:4704
s_mov_b64 exec, s[48:49]
buffer_load_dwordx4 v5, s[16:19], s36 offen lds
s_mov_b64 exec, -1
v_mfma_f32_16x16x32_bf16 v[168:171], a[116:119], a[184:187], v[168:171]
v_mfma_f32_16x16x32_bf16 v[172:175], a[116:119], a[188:191], v[172:175]
s_waitcnt vmcnt(13)
v_cmp_eq_u32 vcc, 0, v27
s_nop 4
s_cbranch_vccnz parallel_sum__compressed_kv_cla__geglu_ffn__prompt_kernel_spin9
parallel_sum__compressed_kv_cla__geglu_ffn__prompt_kernel_spin9_ret:
s_waitcnt lgkmcnt(6)
v_mfma_f32_16x16x32_bf16 v[32:35], a[96:99], a[192:195], v[32:35]
ds_read_b64_tr_b16 a[112:113], v8 offset:128
v_mfma_f32_16x16x32_bf16 v[36:39], a[96:99], a[196:199], v[36:39]
ds_read_b64_tr_b16 a[114:115], v8 offset:4736
v_mfma_f32_16x16x32_bf16 v[40:43], a[96:99], a[200:203], v[40:43]
s_add_u32 s37, s38, 0
v_mfma_f32_16x16x32_bf16 v[44:47], a[96:99], a[204:207], v[44:47]
buffer_load_dwordx4 a[176:179], v17, s[20:23], s37 offen sc1
s_waitcnt lgkmcnt(6)
v_mfma_f32_16x16x32_bf16 v[48:51], a[100:103], a[192:195], v[48:51]
ds_read_b64_tr_b16 a[116:117], v8 offset:160
v_mfma_f32_16x16x32_bf16 v[52:55], a[100:103], a[196:199], v[52:55]
ds_read_b64_tr_b16 a[118:119], v8 offset:4768
v_mfma_f32_16x16x32_bf16 v[56:59], a[100:103], a[200:203], v[56:59]
buffer_load_dwordx4 a[180:183], v18, s[20:23], s37 offen sc1
v_mfma_f32_16x16x32_bf16 v[60:63], a[100:103], a[204:207], v[60:63]
s_waitcnt lgkmcnt(6)
v_mfma_f32_16x16x32_bf16 v[64:67], a[104:107], a[192:195], v[64:67]
ds_read_b64_tr_b16 a[96:97], v8 offset:192
v_mfma_f32_16x16x32_bf16 v[68:71], a[104:107], a[196:199], v[68:71]
ds_read_b64_tr_b16 a[98:99], v8 offset:4800
v_mfma_f32_16x16x32_bf16 v[72:75], a[104:107], a[200:203], v[72:75]
buffer_load_dwordx4 a[184:187], v19, s[20:23], s37 offen sc1
v_mfma_f32_16x16x32_bf16 v[76:79], a[104:107], a[204:207], v[76:79]
buffer_load_dwordx4 a[188:191], v20, s[20:23], s37 offen sc1
s_waitcnt lgkmcnt(6)
v_mfma_f32_16x16x32_bf16 v[80:83], a[108:111], a[192:195], v[80:83]
ds_read_b64_tr_b16 a[100:101], v8 offset:224
v_mfma_f32_16x16x32_bf16 v[84:87], a[108:111], a[196:199], v[84:87]
ds_read_b64_tr_b16 a[102:103], v8 offset:4832
v_mfma_f32_16x16x32_bf16 v[88:91], a[108:111], a[200:203], v[88:91]
s_add_u32 m0, s33, 55296
v_mfma_f32_16x16x32_bf16 v[92:95], a[108:111], a[204:207], v[92:95]
s_waitcnt lgkmcnt(6)
v_mfma_f32_16x16x32_bf16 v[96:99], a[112:115], a[192:195], v[96:99]
ds_read_b64_tr_b16 a[104:105], v8 offset:256
v_mfma_f32_16x16x32_bf16 v[100:103], a[112:115], a[196:199], v[100:103]
ds_read_b64_tr_b16 a[106:107], v8 offset:4864
v_mfma_f32_16x16x32_bf16 v[104:107], a[112:115], a[200:203], v[104:107]
s_add_u32 s36, s62, 36864
v_mfma_f32_16x16x32_bf16 v[108:111], a[112:115], a[204:207], v[108:111]
buffer_load_dwordx4 v1, s[16:19], s36 offen offset:0 lds
s_waitcnt lgkmcnt(6)
v_mfma_f32_16x16x32_bf16 v[112:115], a[116:119], a[192:195], v[112:115]
ds_read_b64_tr_b16 a[108:109], v8 offset:18432
v_mfma_f32_16x16x32_bf16 v[116:119], a[116:119], a[196:199], v[116:119]
ds_read_b64_tr_b16 a[110:111], v8 offset:23040
v_mfma_f32_16x16x32_bf16 v[120:123], a[116:119], a[200:203], v[120:123]
v_mfma_f32_16x16x32_bf16 v[124:127], a[116:119], a[204:207], v[124:127]
buffer_load_dwordx4 v2, s[16:19], s36 offen offset:1024 lds
s_waitcnt lgkmcnt(6)
v_mfma_f32_16x16x32_bf16 v[128:131], a[96:99], a[192:195], v[128:131]
ds_read_b64_tr_b16 a[112:113], v8 offset:18464
v_mfma_f32_16x16x32_bf16 v[132:135], a[96:99], a[196:199], v[132:135]
ds_read_b64_tr_b16 a[114:115], v8 offset:23072
v_mfma_f32_16x16x32_bf16 v[136:139], a[96:99], a[200:203], v[136:139]
buffer_load_dwordx4 v3, s[16:19], s36 offen offset:2048 lds
v_mfma_f32_16x16x32_bf16 v[140:143], a[96:99], a[204:207], v[140:143]
buffer_load_dwordx4 v4, s[16:19], s36 offen offset:3072 lds
s_waitcnt lgkmcnt(6)
v_mfma_f32_16x16x32_bf16 v[144:147], a[100:103], a[192:195], v[144:147]
ds_read_b64_tr_b16 a[116:117], v8 offset:18496
v_mfma_f32_16x16x32_bf16 v[148:151], a[100:103], a[196:199], v[148:151]
ds_read_b64_tr_b16 a[118:119], v8 offset:23104
v_mfma_f32_16x16x32_bf16 v[152:155], a[100:103], a[200:203], v[152:155]
v_mfma_f32_16x16x32_bf16 v[156:159], a[100:103], a[204:207], v[156:159]
s_add_u32 m0, s35, 55296
s_waitcnt lgkmcnt(6)
v_mfma_f32_16x16x32_bf16 v[160:163], a[104:107], a[192:195], v[160:163]
ds_read_b64_tr_b16 a[96:97], v8 offset:18528
v_mfma_f32_16x16x32_bf16 v[164:167], a[104:107], a[196:199], v[164:167]
ds_read_b64_tr_b16 a[98:99], v8 offset:23136
v_mfma_f32_16x16x32_bf16 v[168:171], a[104:107], a[200:203], v[168:171]
s_mov_b64 exec, s[48:49]
buffer_load_dwordx4 v5, s[16:19], s36 offen lds
s_mov_b64 exec, -1
v_mfma_f32_16x16x32_bf16 v[172:175], a[104:107], a[204:207], v[172:175]
s_waitcnt lgkmcnt(6)
v_mfma_f32_16x16x32_bf16 v[32:35], a[108:111], a[128:131], v[32:35]
ds_read_b64_tr_b16 a[100:101], v8 offset:18560
v_mfma_f32_16x16x32_bf16 v[36:39], a[108:111], a[132:135], v[36:39]
ds_read_b64_tr_b16 a[102:103], v8 offset:23168
v_mfma_f32_16x16x32_bf16 v[40:43], a[108:111], a[136:139], v[40:43]
s_add_u32 s37, s38, 1024
v_mfma_f32_16x16x32_bf16 v[44:47], a[108:111], a[140:143], v[44:47]
buffer_load_dwordx4 a[192:195], v17, s[20:23], s37 offen sc1
s_waitcnt lgkmcnt(6)
v_mfma_f32_16x16x32_bf16 v[48:51], a[112:115], a[128:131], v[48:51]
ds_read_b64_tr_b16 a[104:105], v8 offset:18592
v_mfma_f32_16x16x32_bf16 v[52:55], a[112:115], a[132:135], v[52:55]
ds_read_b64_tr_b16 a[106:107], v8 offset:23200
v_mfma_f32_16x16x32_bf16 v[56:59], a[112:115], a[136:139], v[56:59]
buffer_load_dwordx4 a[196:199], v18, s[20:23], s37 offen sc1
v_mfma_f32_16x16x32_bf16 v[60:63], a[112:115], a[140:143], v[60:63]
buffer_load_dwordx4 a[200:203], v19, s[20:23], s37 offen sc1
s_waitcnt lgkmcnt(6)
v_mfma_f32_16x16x32_bf16 v[64:67], a[116:119], a[128:131], v[64:67]
ds_read_b64_tr_b16 a[108:109], v8 offset:18624
v_mfma_f32_16x16x32_bf16 v[68:71], a[116:119], a[132:135], v[68:71]
ds_read_b64_tr_b16 a[110:111], v8 offset:23232
v_mfma_f32_16x16x32_bf16 v[72:75], a[116:119], a[136:139], v[72:75]
buffer_load_dwordx4 a[204:207], v20, s[20:23], s37 offen sc1
v_mfma_f32_16x16x32_bf16 v[76:79], a[116:119], a[140:143], v[76:79]
s_waitcnt lgkmcnt(6)
v_mfma_f32_16x16x32_bf16 v[80:83], a[96:99], a[128:131], v[80:83]
ds_read_b64_tr_b16 a[112:113], v8 offset:18656
v_mfma_f32_16x16x32_bf16 v[84:87], a[96:99], a[132:135], v[84:87]
ds_read_b64_tr_b16 a[114:115], v8 offset:23264
v_mfma_f32_16x16x32_bf16 v[88:91], a[96:99], a[136:139], v[88:91]
s_add_u32 m0, s33, 73728
v_mfma_f32_16x16x32_bf16 v[92:95], a[96:99], a[140:143], v[92:95]
s_add_u32 s36, s62, 73728
s_waitcnt lgkmcnt(6)
v_mfma_f32_16x16x32_bf16 v[96:99], a[100:103], a[128:131], v[96:99]
ds_read_b64_tr_b16 a[116:117], v8 offset:18688
v_mfma_f32_16x16x32_bf16 v[100:103], a[100:103], a[132:135], v[100:103]
ds_read_b64_tr_b16 a[118:119], v8 offset:23296
v_mfma_f32_16x16x32_bf16 v[104:107], a[100:103], a[136:139], v[104:107]
v_mfma_f32_16x16x32_bf16 v[108:111], a[100:103], a[140:143], v[108:111]
s_barrier
s_waitcnt lgkmcnt(6)
v_mfma_f32_16x16x32_bf16 v[112:115], a[104:107], a[128:131], v[112:115]
ds_read_b64_tr_b16 a[96:97], v6 offset:0
v_mfma_f32_16x16x32_bf16 v[116:119], a[104:107], a[132:135], v[116:119]
ds_read_b64_tr_b16 a[98:99], v6 offset:4608
v_mfma_f32_16x16x32_bf16 v[120:123], a[104:107], a[136:139], v[120:123]
buffer_load_dwordx4 v1, s[16:19], s36 offen offset:0 lds
v_mfma_f32_16x16x32_bf16 v[124:127], a[104:107], a[140:143], v[124:127]
buffer_load_dwordx4 v2, s[16:19], s36 offen offset:1024 lds
s_waitcnt lgkmcnt(6)
v_mfma_f32_16x16x32_bf16 v[128:131], a[108:111], a[128:131], v[128:131]
ds_read_b64_tr_b16 a[100:101], v6 offset:32
v_mfma_f32_16x16x32_bf16 v[132:135], a[108:111], a[132:135], v[132:135]
ds_read_b64_tr_b16 a[102:103], v6 offset:4640
v_mfma_f32_16x16x32_bf16 v[136:139], a[108:111], a[136:139], v[136:139]
v_mfma_f32_16x16x32_bf16 v[140:143], a[108:111], a[140:143], v[140:143]
buffer_load_dwordx4 v3, s[16:19], s36 offen offset:2048 lds
s_waitcnt lgkmcnt(6)
v_mfma_f32_16x16x32_bf16 v[144:147], a[112:115], a[128:131], v[144:147]
ds_read_b64_tr_b16 a[104:105], v6 offset:64
v_mfma_f32_16x16x32_bf16 v[148:151], a[112:115], a[132:135], v[148:151]
ds_read_b64_tr_b16 a[106:107], v6 offset:4672
v_mfma_f32_16x16x32_bf16 v[152:155], a[112:115], a[136:139], v[152:155]
buffer_load_dwordx4 v4, s[16:19], s36 offen offset:3072 lds
v_mfma_f32_16x16x32_bf16 v[156:159], a[112:115], a[140:143], v[156:159]
s_add_u32 m0, s35, 73728
s_waitcnt lgkmcnt(6)
v_mfma_f32_16x16x32_bf16 v[160:163], a[116:119], a[128:131], v[160:163]
ds_read_b64_tr_b16 a[108:109], v6 offset:96
v_mfma_f32_16x16x32_bf16 v[164:167], a[116:119], a[132:135], v[164:167]
ds_read_b64_tr_b16 a[110:111], v6 offset:4704
v_mfma_f32_16x16x32_bf16 v[168:171], a[116:119], a[136:139], v[168:171]
s_mov_b64 exec, s[48:49]
buffer_load_dwordx4 v5, s[16:19], s36 offen lds
s_mov_b64 exec, -1
v_mfma_f32_16x16x32_bf16 v[172:175], a[116:119], a[140:143], v[172:175]
s_waitcnt lgkmcnt(6)
v_mfma_f32_16x16x32_bf16 v[32:35], a[96:99], a[144:147], v[32:35]
ds_read_b64_tr_b16 a[112:113], v6 offset:128
v_mfma_f32_16x16x32_bf16 v[36:39], a[96:99], a[148:151], v[36:39]
ds_read_b64_tr_b16 a[114:115], v6 offset:4736
v_mfma_f32_16x16x32_bf16 v[40:43], a[96:99], a[152:155], v[40:43]
s_add_u32 s37, s38, 2048
v_mfma_f32_16x16x32_bf16 v[44:47], a[96:99], a[156:159], v[44:47]
buffer_load_dwordx4 a[128:131], v17, s[20:23], s37 offen sc1
s_waitcnt lgkmcnt(6)
v_mfma_f32_16x16x32_bf16 v[48:51], a[100:103], a[144:147], v[48:51]
ds_read_b64_tr_b16 a[116:117], v6 offset:160
v_mfma_f32_16x16x32_bf16 v[52:55], a[100:103], a[148:151], v[52:55]
ds_read_b64_tr_b16 a[118:119], v6 offset:4768
v_mfma_f32_16x16x32_bf16 v[56:59], a[100:103], a[152:155], v[56:59]
buffer_load_dwordx4 a[132:135], v18, s[20:23], s37 offen sc1
v_mfma_f32_16x16x32_bf16 v[60:63], a[100:103], a[156:159], v[60:63]
s_waitcnt lgkmcnt(6)
v_mfma_f32_16x16x32_bf16 v[64:67], a[104:107], a[144:147], v[64:67]
ds_read_b64_tr_b16 a[96:97], v6 offset:192
v_mfma_f32_16x16x32_bf16 v[68:71], a[104:107], a[148:151], v[68:71]
ds_read_b64_tr_b16 a[98:99], v6 offset:4800
v_mfma_f32_16x16x32_bf16 v[72:75], a[104:107], a[152:155], v[72:75]
buffer_load_dwordx4 a[136:139], v19, s[20:23], s37 offen sc1
v_mfma_f32_16x16x32_bf16 v[76:79], a[104:107], a[156:159], v[76:79]
buffer_load_dwordx4 a[140:143], v20, s[20:23], s37 offen sc1
s_waitcnt lgkmcnt(6)
v_mfma_f32_16x16x32_bf16 v[80:83], a[108:111], a[144:147], v[80:83]
ds_read_b64_tr_b16 a[100:101], v6 offset:224
v_mfma_f32_16x16x32_bf16 v[84:87], a[108:111], a[148:151], v[84:87]
ds_read_b64_tr_b16 a[102:103], v6 offset:4832
v_mfma_f32_16x16x32_bf16 v[88:91], a[108:111], a[152:155], v[88:91]
s_add_u32 m0, s33, 92160
v_mfma_f32_16x16x32_bf16 v[92:95], a[108:111], a[156:159], v[92:95]
s_waitcnt lgkmcnt(6)
v_mfma_f32_16x16x32_bf16 v[96:99], a[112:115], a[144:147], v[96:99]
ds_read_b64_tr_b16 a[104:105], v6 offset:256
v_mfma_f32_16x16x32_bf16 v[100:103], a[112:115], a[148:151], v[100:103]
ds_read_b64_tr_b16 a[106:107], v6 offset:4864
v_mfma_f32_16x16x32_bf16 v[104:107], a[112:115], a[152:155], v[104:107]
s_add_u32 s36, s62, 110592
v_mfma_f32_16x16x32_bf16 v[108:111], a[112:115], a[156:159], v[108:111]
buffer_load_dwordx4 v1, s[16:19], s36 offen offset:0 lds
s_waitcnt lgkmcnt(6)
v_mfma_f32_16x16x32_bf16 v[112:115], a[116:119], a[144:147], v[112:115]
ds_read_b64_tr_b16 a[108:109], v6 offset:18432
v_mfma_f32_16x16x32_bf16 v[116:119], a[116:119], a[148:151], v[116:119]
ds_read_b64_tr_b16 a[110:111], v6 offset:23040
v_mfma_f32_16x16x32_bf16 v[120:123], a[116:119], a[152:155], v[120:123]
v_mfma_f32_16x16x32_bf16 v[124:127], a[116:119], a[156:159], v[124:127]
buffer_load_dwordx4 v2, s[16:19], s36 offen offset:1024 lds
s_waitcnt lgkmcnt(6)
v_mfma_f32_16x16x32_bf16 v[128:131], a[96:99], a[144:147], v[128:131]
ds_read_b64_tr_b16 a[112:113], v6 offset:18464
v_mfma_f32_16x16x32_bf16 v[132:135], a[96:99], a[148:151], v[132:135]
ds_read_b64_tr_b16 a[114:115], v6 offset:23072
v_mfma_f32_16x16x32_bf16 v[136:139], a[96:99], a[152:155], v[136:139]
buffer_load_dwordx4 v3, s[16:19], s36 offen offset:2048 lds
v_mfma_f32_16x16x32_bf16 v[140:143], a[96:99], a[156:159], v[140:143]
buffer_load_dwordx4 v4, s[16:19], s36 offen offset:3072 lds
s_waitcnt lgkmcnt(6)
v_mfma_f32_16x16x32_bf16 v[144:147], a[100:103], a[144:147], v[144:147]
ds_read_b64_tr_b16 a[116:117], v6 offset:18496
v_mfma_f32_16x16x32_bf16 v[148:151], a[100:103], a[148:151], v[148:151]
ds_read_b64_tr_b16 a[118:119], v6 offset:23104
v_mfma_f32_16x16x32_bf16 v[152:155], a[100:103], a[152:155], v[152:155]
v_mfma_f32_16x16x32_bf16 v[156:159], a[100:103], a[156:159], v[156:159]
s_add_u32 m0, s35, 92160
s_waitcnt lgkmcnt(6)
v_mfma_f32_16x16x32_bf16 v[160:163], a[104:107], a[144:147], v[160:163]
ds_read_b64_tr_b16 a[96:97], v6 offset:18528
v_mfma_f32_16x16x32_bf16 v[164:167], a[104:107], a[148:151], v[164:167]
ds_read_b64_tr_b16 a[98:99], v6 offset:23136
v_mfma_f32_16x16x32_bf16 v[168:171], a[104:107], a[152:155], v[168:171]
s_mov_b64 exec, s[48:49]
buffer_load_dwordx4 v5, s[16:19], s36 offen lds
s_mov_b64 exec, -1
v_mfma_f32_16x16x32_bf16 v[172:175], a[104:107], a[156:159], v[172:175]
s_waitcnt vmcnt(32) lgkmcnt(6)
v_mfma_f32_16x16x32_bf16 v[32:35], a[108:111], a[160:163], v[32:35]
ds_read_b64_tr_b16 a[100:101], v6 offset:18560
v_mfma_f32_16x16x32_bf16 v[36:39], a[108:111], a[164:167], v[36:39]
ds_read_b64_tr_b16 a[102:103], v6 offset:23168
v_mfma_f32_16x16x32_bf16 v[40:43], a[108:111], a[168:171], v[40:43]
s_add_u32 s37, s38, 3072
v_mfma_f32_16x16x32_bf16 v[44:47], a[108:111], a[172:175], v[44:47]
buffer_load_dwordx4 a[144:147], v17, s[20:23], s37 offen sc1
s_waitcnt lgkmcnt(6)
v_mfma_f32_16x16x32_bf16 v[48:51], a[112:115], a[160:163], v[48:51]
ds_read_b64_tr_b16 a[104:105], v6 offset:18592
v_mfma_f32_16x16x32_bf16 v[52:55], a[112:115], a[164:167], v[52:55]
ds_read_b64_tr_b16 a[106:107], v6 offset:23200
v_mfma_f32_16x16x32_bf16 v[56:59], a[112:115], a[168:171], v[56:59]
buffer_load_dwordx4 a[148:151], v18, s[20:23], s37 offen sc1
v_mfma_f32_16x16x32_bf16 v[60:63], a[112:115], a[172:175], v[60:63]
buffer_load_dwordx4 a[152:155], v19, s[20:23], s37 offen sc1
s_waitcnt lgkmcnt(6)
v_mfma_f32_16x16x32_bf16 v[64:67], a[116:119], a[160:163], v[64:67]
ds_read_b64_tr_b16 a[108:109], v6 offset:18624
v_mfma_f32_16x16x32_bf16 v[68:71], a[116:119], a[164:167], v[68:71]
ds_read_b64_tr_b16 a[110:111], v6 offset:23232
v_mfma_f32_16x16x32_bf16 v[72:75], a[116:119], a[168:171], v[72:75]
buffer_load_dwordx4 a[156:159], v20, s[20:23], s37 offen sc1
v_mfma_f32_16x16x32_bf16 v[76:79], a[116:119], a[172:175], v[76:79]
s_waitcnt lgkmcnt(6)
v_mfma_f32_16x16x32_bf16 v[80:83], a[96:99], a[160:163], v[80:83]
ds_read_b64_tr_b16 a[112:113], v6 offset:18656
v_mfma_f32_16x16x32_bf16 v[84:87], a[96:99], a[164:167], v[84:87]
ds_read_b64_tr_b16 a[114:115], v6 offset:23264
v_mfma_f32_16x16x32_bf16 v[88:91], a[96:99], a[168:171], v[88:91]
s_add_u32 m0, s33, 110592
v_mfma_f32_16x16x32_bf16 v[92:95], a[96:99], a[172:175], v[92:95]
s_add_u32 s36, s62, 147456
s_waitcnt lgkmcnt(6)
v_mfma_f32_16x16x32_bf16 v[96:99], a[100:103], a[160:163], v[96:99]
ds_read_b64_tr_b16 a[116:117], v6 offset:18688
v_mfma_f32_16x16x32_bf16 v[100:103], a[100:103], a[164:167], v[100:103]
ds_read_b64_tr_b16 a[118:119], v6 offset:23296
v_mfma_f32_16x16x32_bf16 v[104:107], a[100:103], a[168:171], v[104:107]
s_waitcnt vmcnt(22)
v_mfma_f32_16x16x32_bf16 v[108:111], a[100:103], a[172:175], v[108:111]
s_barrier
s_waitcnt lgkmcnt(6)
v_mfma_f32_16x16x32_bf16 v[112:115], a[104:107], a[160:163], v[112:115]
ds_read_b64_tr_b16 a[96:97], v6 offset:36864
v_mfma_f32_16x16x32_bf16 v[116:119], a[104:107], a[164:167], v[116:119]
ds_read_b64_tr_b16 a[98:99], v6 offset:41472
v_mfma_f32_16x16x32_bf16 v[120:123], a[104:107], a[168:171], v[120:123]
buffer_load_dwordx4 v1, s[16:19], s36 offen offset:0 lds
v_mfma_f32_16x16x32_bf16 v[124:127], a[104:107], a[172:175], v[124:127]
buffer_load_dwordx4 v2, s[16:19], s36 offen offset:1024 lds
s_waitcnt lgkmcnt(6)
v_mfma_f32_16x16x32_bf16 v[128:131], a[108:111], a[160:163], v[128:131]
ds_read_b64_tr_b16 a[100:101], v6 offset:36896
v_mfma_f32_16x16x32_bf16 v[132:135], a[108:111], a[164:167], v[132:135]
ds_read_b64_tr_b16 a[102:103], v6 offset:41504
v_mfma_f32_16x16x32_bf16 v[136:139], a[108:111], a[168:171], v[136:139]
v_mfma_f32_16x16x32_bf16 v[140:143], a[108:111], a[172:175], v[140:143]
buffer_load_dwordx4 v3, s[16:19], s36 offen offset:2048 lds
s_waitcnt lgkmcnt(6)
v_mfma_f32_16x16x32_bf16 v[144:147], a[112:115], a[160:163], v[144:147]
ds_read_b64_tr_b16 a[104:105], v6 offset:36928
v_mfma_f32_16x16x32_bf16 v[148:151], a[112:115], a[164:167], v[148:151]
ds_read_b64_tr_b16 a[106:107], v6 offset:41536
v_mfma_f32_16x16x32_bf16 v[152:155], a[112:115], a[168:171], v[152:155]
buffer_load_dwordx4 v4, s[16:19], s36 offen offset:3072 lds
v_mfma_f32_16x16x32_bf16 v[156:159], a[112:115], a[172:175], v[156:159]
s_add_u32 m0, s35, 110592
s_waitcnt lgkmcnt(6)
v_mfma_f32_16x16x32_bf16 v[160:163], a[116:119], a[160:163], v[160:163]
ds_read_b64_tr_b16 a[108:109], v6 offset:36960
v_mfma_f32_16x16x32_bf16 v[164:167], a[116:119], a[164:167], v[164:167]
ds_read_b64_tr_b16 a[110:111], v6 offset:41568
v_mfma_f32_16x16x32_bf16 v[168:171], a[116:119], a[168:171], v[168:171]
s_mov_b64 exec, s[48:49]
buffer_load_dwordx4 v5, s[16:19], s36 offen lds
s_mov_b64 exec, -1
v_mfma_f32_16x16x32_bf16 v[172:175], a[116:119], a[172:175], v[172:175]
s_waitcnt lgkmcnt(6)
v_mfma_f32_16x16x32_bf16 v[32:35], a[96:99], a[176:179], v[32:35]
ds_read_b64_tr_b16 a[112:113], v6 offset:36992
v_mfma_f32_16x16x32_bf16 v[36:39], a[96:99], a[180:183], v[36:39]
ds_read_b64_tr_b16 a[114:115], v6 offset:41600
v_mfma_f32_16x16x32_bf16 v[40:43], a[96:99], a[184:187], v[40:43]
s_add_u32 s37, s38, 4096
v_mfma_f32_16x16x32_bf16 v[44:47], a[96:99], a[188:191], v[44:47]
buffer_load_dwordx4 a[160:163], v17, s[20:23], s37 offen sc1
s_waitcnt lgkmcnt(6)
v_mfma_f32_16x16x32_bf16 v[48:51], a[100:103], a[176:179], v[48:51]
ds_read_b64_tr_b16 a[116:117], v6 offset:37024
v_mfma_f32_16x16x32_bf16 v[52:55], a[100:103], a[180:183], v[52:55]
ds_read_b64_tr_b16 a[118:119], v6 offset:41632
v_mfma_f32_16x16x32_bf16 v[56:59], a[100:103], a[184:187], v[56:59]
buffer_load_dwordx4 a[164:167], v18, s[20:23], s37 offen sc1
v_mfma_f32_16x16x32_bf16 v[60:63], a[100:103], a[188:191], v[60:63]
s_waitcnt lgkmcnt(6)
v_mfma_f32_16x16x32_bf16 v[64:67], a[104:107], a[176:179], v[64:67]
ds_read_b64_tr_b16 a[96:97], v6 offset:37056
v_mfma_f32_16x16x32_bf16 v[68:71], a[104:107], a[180:183], v[68:71]
ds_read_b64_tr_b16 a[98:99], v6 offset:41664
v_mfma_f32_16x16x32_bf16 v[72:75], a[104:107], a[184:187], v[72:75]
buffer_load_dwordx4 a[168:171], v19, s[20:23], s37 offen sc1
v_mfma_f32_16x16x32_bf16 v[76:79], a[104:107], a[188:191], v[76:79]
buffer_load_dwordx4 a[172:175], v20, s[20:23], s37 offen sc1
s_waitcnt lgkmcnt(6)
v_mfma_f32_16x16x32_bf16 v[80:83], a[108:111], a[176:179], v[80:83]
ds_read_b64_tr_b16 a[100:101], v6 offset:37088
v_mfma_f32_16x16x32_bf16 v[84:87], a[108:111], a[180:183], v[84:87]
ds_read_b64_tr_b16 a[102:103], v6 offset:41696
v_mfma_f32_16x16x32_bf16 v[88:91], a[108:111], a[184:187], v[88:91]
s_add_u32 m0, s33, 129024
v_mfma_f32_16x16x32_bf16 v[92:95], a[108:111], a[188:191], v[92:95]
s_waitcnt lgkmcnt(6)
v_mfma_f32_16x16x32_bf16 v[96:99], a[112:115], a[176:179], v[96:99]
ds_read_b64_tr_b16 a[104:105], v6 offset:37120
v_mfma_f32_16x16x32_bf16 v[100:103], a[112:115], a[180:183], v[100:103]
ds_read_b64_tr_b16 a[106:107], v6 offset:41728
v_mfma_f32_16x16x32_bf16 v[104:107], a[112:115], a[184:187], v[104:107]
s_add_u32 s36, s62, 184320
v_mfma_f32_16x16x32_bf16 v[108:111], a[112:115], a[188:191], v[108:111]
buffer_load_dwordx4 v1, s[16:19], s36 offen offset:0 lds
s_waitcnt lgkmcnt(6)
v_mfma_f32_16x16x32_bf16 v[112:115], a[116:119], a[176:179], v[112:115]
ds_read_b64_tr_b16 a[108:109], v7 offset:0
v_mfma_f32_16x16x32_bf16 v[116:119], a[116:119], a[180:183], v[116:119]
ds_read_b64_tr_b16 a[110:111], v7 offset:4608
v_mfma_f32_16x16x32_bf16 v[120:123], a[116:119], a[184:187], v[120:123]
v_mfma_f32_16x16x32_bf16 v[124:127], a[116:119], a[188:191], v[124:127]
buffer_load_dwordx4 v2, s[16:19], s36 offen offset:1024 lds
s_waitcnt lgkmcnt(6)
v_mfma_f32_16x16x32_bf16 v[128:131], a[96:99], a[176:179], v[128:131]
ds_read_b64_tr_b16 a[112:113], v7 offset:32
v_mfma_f32_16x16x32_bf16 v[132:135], a[96:99], a[180:183], v[132:135]
ds_read_b64_tr_b16 a[114:115], v7 offset:4640
v_mfma_f32_16x16x32_bf16 v[136:139], a[96:99], a[184:187], v[136:139]
buffer_load_dwordx4 v3, s[16:19], s36 offen offset:2048 lds
v_mfma_f32_16x16x32_bf16 v[140:143], a[96:99], a[188:191], v[140:143]
buffer_load_dwordx4 v4, s[16:19], s36 offen offset:3072 lds
s_waitcnt lgkmcnt(6)
v_mfma_f32_16x16x32_bf16 v[144:147], a[100:103], a[176:179], v[144:147]
ds_read_b64_tr_b16 a[116:117], v7 offset:64
v_mfma_f32_16x16x32_bf16 v[148:151], a[100:103], a[180:183], v[148:151]
ds_read_b64_tr_b16 a[118:119], v7 offset:4672
v_mfma_f32_16x16x32_bf16 v[152:155], a[100:103], a[184:187], v[152:155]
v_mfma_f32_16x16x32_bf16 v[156:159], a[100:103], a[188:191], v[156:159]
s_add_u32 m0, s35, 129024
s_waitcnt lgkmcnt(6)
v_mfma_f32_16x16x32_bf16 v[160:163], a[104:107], a[176:179], v[160:163]
ds_read_b64_tr_b16 a[96:97], v7 offset:96
v_mfma_f32_16x16x32_bf16 v[164:167], a[104:107], a[180:183], v[164:167]
ds_read_b64_tr_b16 a[98:99], v7 offset:4704
v_mfma_f32_16x16x32_bf16 v[168:171], a[104:107], a[184:187], v[168:171]
s_mov_b64 exec, s[48:49]
buffer_load_dwordx4 v5, s[16:19], s36 offen lds
s_mov_b64 exec, -1
v_mfma_f32_16x16x32_bf16 v[172:175], a[104:107], a[188:191], v[172:175]
s_waitcnt vmcnt(32) lgkmcnt(6)
v_mfma_f32_16x16x32_bf16 v[32:35], a[108:111], a[192:195], v[32:35]
ds_read_b64_tr_b16 a[100:101], v7 offset:128
v_mfma_f32_16x16x32_bf16 v[36:39], a[108:111], a[196:199], v[36:39]
ds_read_b64_tr_b16 a[102:103], v7 offset:4736
v_mfma_f32_16x16x32_bf16 v[40:43], a[108:111], a[200:203], v[40:43]
s_add_u32 s37, s38, 5120
v_mfma_f32_16x16x32_bf16 v[44:47], a[108:111], a[204:207], v[44:47]
buffer_load_dwordx4 a[176:179], v17, s[20:23], s37 offen sc1
s_waitcnt lgkmcnt(6)
v_mfma_f32_16x16x32_bf16 v[48:51], a[112:115], a[192:195], v[48:51]
ds_read_b64_tr_b16 a[104:105], v7 offset:160
v_mfma_f32_16x16x32_bf16 v[52:55], a[112:115], a[196:199], v[52:55]
ds_read_b64_tr_b16 a[106:107], v7 offset:4768
v_mfma_f32_16x16x32_bf16 v[56:59], a[112:115], a[200:203], v[56:59]
buffer_load_dwordx4 a[180:183], v18, s[20:23], s37 offen sc1
v_mfma_f32_16x16x32_bf16 v[60:63], a[112:115], a[204:207], v[60:63]
buffer_load_dwordx4 a[184:187], v19, s[20:23], s37 offen sc1
s_waitcnt lgkmcnt(6)
v_mfma_f32_16x16x32_bf16 v[64:67], a[116:119], a[192:195], v[64:67]
ds_read_b64_tr_b16 a[108:109], v7 offset:192
v_mfma_f32_16x16x32_bf16 v[68:71], a[116:119], a[196:199], v[68:71]
ds_read_b64_tr_b16 a[110:111], v7 offset:4800
v_mfma_f32_16x16x32_bf16 v[72:75], a[116:119], a[200:203], v[72:75]
buffer_load_dwordx4 a[188:191], v20, s[20:23], s37 offen sc1
v_mfma_f32_16x16x32_bf16 v[76:79], a[116:119], a[204:207], v[76:79]
s_waitcnt lgkmcnt(6)
v_mfma_f32_16x16x32_bf16 v[80:83], a[96:99], a[192:195], v[80:83]
ds_read_b64_tr_b16 a[112:113], v7 offset:224
v_mfma_f32_16x16x32_bf16 v[84:87], a[96:99], a[196:199], v[84:87]
ds_read_b64_tr_b16 a[114:115], v7 offset:4832
v_mfma_f32_16x16x32_bf16 v[88:91], a[96:99], a[200:203], v[88:91]
s_add_u32 m0, s33, 0
v_mfma_f32_16x16x32_bf16 v[92:95], a[96:99], a[204:207], v[92:95]
s_add_u32 s36, s62, 221184
s_waitcnt lgkmcnt(6)
v_mfma_f32_16x16x32_bf16 v[96:99], a[100:103], a[192:195], v[96:99]
ds_read_b64_tr_b16 a[116:117], v7 offset:256
v_mfma_f32_16x16x32_bf16 v[100:103], a[100:103], a[196:199], v[100:103]
ds_read_b64_tr_b16 a[118:119], v7 offset:4864
v_mfma_f32_16x16x32_bf16 v[104:107], a[100:103], a[200:203], v[104:107]
s_waitcnt vmcnt(22)
v_mfma_f32_16x16x32_bf16 v[108:111], a[100:103], a[204:207], v[108:111]
s_barrier
s_waitcnt lgkmcnt(6)
v_mfma_f32_16x16x32_bf16 v[112:115], a[104:107], a[192:195], v[112:115]
ds_read_b64_tr_b16 a[96:97], v7 offset:18432
v_mfma_f32_16x16x32_bf16 v[116:119], a[104:107], a[196:199], v[116:119]
ds_read_b64_tr_b16 a[98:99], v7 offset:23040
v_mfma_f32_16x16x32_bf16 v[120:123], a[104:107], a[200:203], v[120:123]
buffer_load_dwordx4 v1, s[16:19], s36 offen offset:0 lds
v_mfma_f32_16x16x32_bf16 v[124:127], a[104:107], a[204:207], v[124:127]
buffer_load_dwordx4 v2, s[16:19], s36 offen offset:1024 lds
s_waitcnt lgkmcnt(6)
v_mfma_f32_16x16x32_bf16 v[128:131], a[108:111], a[192:195], v[128:131]
ds_read_b64_tr_b16 a[100:101], v7 offset:18464
v_mfma_f32_16x16x32_bf16 v[132:135], a[108:111], a[196:199], v[132:135]
ds_read_b64_tr_b16 a[102:103], v7 offset:23072
v_mfma_f32_16x16x32_bf16 v[136:139], a[108:111], a[200:203], v[136:139]
v_mfma_f32_16x16x32_bf16 v[140:143], a[108:111], a[204:207], v[140:143]
buffer_load_dwordx4 v3, s[16:19], s36 offen offset:2048 lds
s_waitcnt lgkmcnt(6)
v_mfma_f32_16x16x32_bf16 v[144:147], a[112:115], a[192:195], v[144:147]
ds_read_b64_tr_b16 a[104:105], v7 offset:18496
v_mfma_f32_16x16x32_bf16 v[148:151], a[112:115], a[196:199], v[148:151]
ds_read_b64_tr_b16 a[106:107], v7 offset:23104
v_mfma_f32_16x16x32_bf16 v[152:155], a[112:115], a[200:203], v[152:155]
buffer_load_dwordx4 v4, s[16:19], s36 offen offset:3072 lds
v_mfma_f32_16x16x32_bf16 v[156:159], a[112:115], a[204:207], v[156:159]
s_add_u32 m0, s35, 0
s_waitcnt lgkmcnt(6)
v_mfma_f32_16x16x32_bf16 v[160:163], a[116:119], a[192:195], v[160:163]
ds_read_b64_tr_b16 a[108:109], v7 offset:18528
v_mfma_f32_16x16x32_bf16 v[164:167], a[116:119], a[196:199], v[164:167]
ds_read_b64_tr_b16 a[110:111], v7 offset:23136
v_mfma_f32_16x16x32_bf16 v[168:171], a[116:119], a[200:203], v[168:171]
s_mov_b64 exec, s[48:49]
buffer_load_dwordx4 v5, s[16:19], s36 offen lds
s_mov_b64 exec, -1
v_mfma_f32_16x16x32_bf16 v[172:175], a[116:119], a[204:207], v[172:175]
s_waitcnt lgkmcnt(6)
v_mfma_f32_16x16x32_bf16 v[32:35], a[96:99], a[128:131], v[32:35]
ds_read_b64_tr_b16 a[112:113], v7 offset:18560
v_mfma_f32_16x16x32_bf16 v[36:39], a[96:99], a[132:135], v[36:39]
ds_read_b64_tr_b16 a[114:115], v7 offset:23168
v_mfma_f32_16x16x32_bf16 v[40:43], a[96:99], a[136:139], v[40:43]
s_add_u32 s37, s38, 6144
v_mfma_f32_16x16x32_bf16 v[44:47], a[96:99], a[140:143], v[44:47]
buffer_load_dwordx4 a[192:195], v17, s[20:23], s37 offen sc1
s_waitcnt lgkmcnt(6)
v_mfma_f32_16x16x32_bf16 v[48:51], a[100:103], a[128:131], v[48:51]
ds_read_b64_tr_b16 a[116:117], v7 offset:18592
v_mfma_f32_16x16x32_bf16 v[52:55], a[100:103], a[132:135], v[52:55]
ds_read_b64_tr_b16 a[118:119], v7 offset:23200
v_mfma_f32_16x16x32_bf16 v[56:59], a[100:103], a[136:139], v[56:59]
buffer_load_dwordx4 a[196:199], v18, s[20:23], s37 offen sc1
v_mfma_f32_16x16x32_bf16 v[60:63], a[100:103], a[140:143], v[60:63]
s_waitcnt lgkmcnt(6)
v_mfma_f32_16x16x32_bf16 v[64:67], a[104:107], a[128:131], v[64:67]
ds_read_b64_tr_b16 a[96:97], v7 offset:18624
v_mfma_f32_16x16x32_bf16 v[68:71], a[104:107], a[132:135], v[68:71]
ds_read_b64_tr_b16 a[98:99], v7 offset:23232
v_mfma_f32_16x16x32_bf16 v[72:75], a[104:107], a[136:139], v[72:75]
buffer_load_dwordx4 a[200:203], v19, s[20:23], s37 offen sc1
v_mfma_f32_16x16x32_bf16 v[76:79], a[104:107], a[140:143], v[76:79]
buffer_load_dwordx4 a[204:207], v20, s[20:23], s37 offen sc1
s_waitcnt lgkmcnt(6)
v_mfma_f32_16x16x32_bf16 v[80:83], a[108:111], a[128:131], v[80:83]
ds_read_b64_tr_b16 a[100:101], v7 offset:18656
v_mfma_f32_16x16x32_bf16 v[84:87], a[108:111], a[132:135], v[84:87]
ds_read_b64_tr_b16 a[102:103], v7 offset:23264
v_mfma_f32_16x16x32_bf16 v[88:91], a[108:111], a[136:139], v[88:91]
s_add_u32 m0, s33, 18432
v_mfma_f32_16x16x32_bf16 v[92:95], a[108:111], a[140:143], v[92:95]
s_waitcnt lgkmcnt(6)
v_mfma_f32_16x16x32_bf16 v[96:99], a[112:115], a[128:131], v[96:99]
ds_read_b64_tr_b16 a[104:105], v7 offset:18688
v_mfma_f32_16x16x32_bf16 v[100:103], a[112:115], a[132:135], v[100:103]
ds_read_b64_tr_b16 a[106:107], v7 offset:23296
v_mfma_f32_16x16x32_bf16 v[104:107], a[112:115], a[136:139], v[104:107]
s_add_u32 s36, s62, 258048
v_mfma_f32_16x16x32_bf16 v[108:111], a[112:115], a[140:143], v[108:111]
buffer_load_dwordx4 v1, s[16:19], s36 offen offset:0 lds
s_waitcnt lgkmcnt(6)
v_mfma_f32_16x16x32_bf16 v[112:115], a[116:119], a[128:131], v[112:115]
ds_read_b64_tr_b16 a[108:109], v7 offset:36864
v_mfma_f32_16x16x32_bf16 v[116:119], a[116:119], a[132:135], v[116:119]
ds_read_b64_tr_b16 a[110:111], v7 offset:41472
v_mfma_f32_16x16x32_bf16 v[120:123], a[116:119], a[136:139], v[120:123]
v_mfma_f32_16x16x32_bf16 v[124:127], a[116:119], a[140:143], v[124:127]
buffer_load_dwordx4 v2, s[16:19], s36 offen offset:1024 lds
s_waitcnt lgkmcnt(6)
v_mfma_f32_16x16x32_bf16 v[128:131], a[96:99], a[128:131], v[128:131]
ds_read_b64_tr_b16 a[112:113], v7 offset:36896
v_mfma_f32_16x16x32_bf16 v[132:135], a[96:99], a[132:135], v[132:135]
ds_read_b64_tr_b16 a[114:115], v7 offset:41504
v_mfma_f32_16x16x32_bf16 v[136:139], a[96:99], a[136:139], v[136:139]
buffer_load_dwordx4 v3, s[16:19], s36 offen offset:2048 lds
v_mfma_f32_16x16x32_bf16 v[140:143], a[96:99], a[140:143], v[140:143]
buffer_load_dwordx4 v4, s[16:19], s36 offen offset:3072 lds
s_waitcnt lgkmcnt(6)
v_mfma_f32_16x16x32_bf16 v[144:147], a[100:103], a[128:131], v[144:147]
ds_read_b64_tr_b16 a[116:117], v7 offset:36928
v_mfma_f32_16x16x32_bf16 v[148:151], a[100:103], a[132:135], v[148:151]
ds_read_b64_tr_b16 a[118:119], v7 offset:41536
v_mfma_f32_16x16x32_bf16 v[152:155], a[100:103], a[136:139], v[152:155]
v_mfma_f32_16x16x32_bf16 v[156:159], a[100:103], a[140:143], v[156:159]
s_add_u32 m0, s35, 18432
s_waitcnt lgkmcnt(6)
v_mfma_f32_16x16x32_bf16 v[160:163], a[104:107], a[128:131], v[160:163]
ds_read_b64_tr_b16 a[96:97], v7 offset:36960
v_mfma_f32_16x16x32_bf16 v[164:167], a[104:107], a[132:135], v[164:167]
ds_read_b64_tr_b16 a[98:99], v7 offset:41568
v_mfma_f32_16x16x32_bf16 v[168:171], a[104:107], a[136:139], v[168:171]
s_mov_b64 exec, s[48:49]
buffer_load_dwordx4 v5, s[16:19], s36 offen lds
s_mov_b64 exec, -1
v_mfma_f32_16x16x32_bf16 v[172:175], a[104:107], a[140:143], v[172:175]
s_waitcnt vmcnt(32) lgkmcnt(6)
v_mfma_f32_16x16x32_bf16 v[32:35], a[108:111], a[144:147], v[32:35]
ds_read_b64_tr_b16 a[100:101], v7 offset:36992
v_mfma_f32_16x16x32_bf16 v[36:39], a[108:111], a[148:151], v[36:39]
ds_read_b64_tr_b16 a[102:103], v7 offset:41600
v_mfma_f32_16x16x32_bf16 v[40:43], a[108:111], a[152:155], v[40:43]
s_add_u32 s37, s38, 7168
v_mfma_f32_16x16x32_bf16 v[44:47], a[108:111], a[156:159], v[44:47]
buffer_load_dwordx4 a[128:131], v17, s[20:23], s37 offen sc1
s_waitcnt lgkmcnt(6)
v_mfma_f32_16x16x32_bf16 v[48:51], a[112:115], a[144:147], v[48:51]
ds_read_b64_tr_b16 a[104:105], v7 offset:37024
v_mfma_f32_16x16x32_bf16 v[52:55], a[112:115], a[148:151], v[52:55]
ds_read_b64_tr_b16 a[106:107], v7 offset:41632
v_mfma_f32_16x16x32_bf16 v[56:59], a[112:115], a[152:155], v[56:59]
buffer_load_dwordx4 a[132:135], v18, s[20:23], s37 offen sc1
v_mfma_f32_16x16x32_bf16 v[60:63], a[112:115], a[156:159], v[60:63]
buffer_load_dwordx4 a[136:139], v19, s[20:23], s37 offen sc1
s_waitcnt lgkmcnt(6)
v_mfma_f32_16x16x32_bf16 v[64:67], a[116:119], a[144:147], v[64:67]
ds_read_b64_tr_b16 a[108:109], v7 offset:37056
v_mfma_f32_16x16x32_bf16 v[68:71], a[116:119], a[148:151], v[68:71]
ds_read_b64_tr_b16 a[110:111], v7 offset:41664
v_mfma_f32_16x16x32_bf16 v[72:75], a[116:119], a[152:155], v[72:75]
buffer_load_dwordx4 a[140:143], v20, s[20:23], s37 offen sc1
v_mfma_f32_16x16x32_bf16 v[76:79], a[116:119], a[156:159], v[76:79]
s_waitcnt lgkmcnt(6)
v_mfma_f32_16x16x32_bf16 v[80:83], a[96:99], a[144:147], v[80:83]
ds_read_b64_tr_b16 a[112:113], v7 offset:37088
v_mfma_f32_16x16x32_bf16 v[84:87], a[96:99], a[148:151], v[84:87]
ds_read_b64_tr_b16 a[114:115], v7 offset:41696
v_mfma_f32_16x16x32_bf16 v[88:91], a[96:99], a[152:155], v[88:91]
s_add_u32 m0, s33, 36864
v_mfma_f32_16x16x32_bf16 v[92:95], a[96:99], a[156:159], v[92:95]
s_add_u32 s36, s62, 294912
s_waitcnt lgkmcnt(6)
v_mfma_f32_16x16x32_bf16 v[96:99], a[100:103], a[144:147], v[96:99]
ds_read_b64_tr_b16 a[116:117], v7 offset:37120
v_mfma_f32_16x16x32_bf16 v[100:103], a[100:103], a[148:151], v[100:103]
ds_read_b64_tr_b16 a[118:119], v7 offset:41728
v_mfma_f32_16x16x32_bf16 v[104:107], a[100:103], a[152:155], v[104:107]
s_waitcnt vmcnt(22)
v_mfma_f32_16x16x32_bf16 v[108:111], a[100:103], a[156:159], v[108:111]
s_barrier
s_waitcnt lgkmcnt(6)
v_mfma_f32_16x16x32_bf16 v[112:115], a[104:107], a[144:147], v[112:115]
ds_read_b64_tr_b16 a[96:97], v8 offset:0
v_mfma_f32_16x16x32_bf16 v[116:119], a[104:107], a[148:151], v[116:119]
ds_read_b64_tr_b16 a[98:99], v8 offset:4608
v_mfma_f32_16x16x32_bf16 v[120:123], a[104:107], a[152:155], v[120:123]
buffer_load_dwordx4 v1, s[16:19], s36 offen offset:0 lds
v_mfma_f32_16x16x32_bf16 v[124:127], a[104:107], a[156:159], v[124:127]
buffer_load_dwordx4 v2, s[16:19], s36 offen offset:1024 lds
s_waitcnt lgkmcnt(6)
v_mfma_f32_16x16x32_bf16 v[128:131], a[108:111], a[144:147], v[128:131]
ds_read_b64_tr_b16 a[100:101], v8 offset:32
v_mfma_f32_16x16x32_bf16 v[132:135], a[108:111], a[148:151], v[132:135]
ds_read_b64_tr_b16 a[102:103], v8 offset:4640
v_mfma_f32_16x16x32_bf16 v[136:139], a[108:111], a[152:155], v[136:139]
v_mfma_f32_16x16x32_bf16 v[140:143], a[108:111], a[156:159], v[140:143]
buffer_load_dwordx4 v3, s[16:19], s36 offen offset:2048 lds
s_waitcnt lgkmcnt(6)
v_mfma_f32_16x16x32_bf16 v[144:147], a[112:115], a[144:147], v[144:147]
ds_read_b64_tr_b16 a[104:105], v8 offset:64
v_mfma_f32_16x16x32_bf16 v[148:151], a[112:115], a[148:151], v[148:151]
ds_read_b64_tr_b16 a[106:107], v8 offset:4672
v_mfma_f32_16x16x32_bf16 v[152:155], a[112:115], a[152:155], v[152:155]
buffer_load_dwordx4 v4, s[16:19], s36 offen offset:3072 lds
v_mfma_f32_16x16x32_bf16 v[156:159], a[112:115], a[156:159], v[156:159]
s_add_u32 m0, s35, 36864
s_waitcnt lgkmcnt(6)
v_mfma_f32_16x16x32_bf16 v[160:163], a[116:119], a[144:147], v[160:163]
ds_read_b64_tr_b16 a[108:109], v8 offset:96
v_mfma_f32_16x16x32_bf16 v[164:167], a[116:119], a[148:151], v[164:167]
ds_read_b64_tr_b16 a[110:111], v8 offset:4704
v_mfma_f32_16x16x32_bf16 v[168:171], a[116:119], a[152:155], v[168:171]
s_mov_b64 exec, s[48:49]
buffer_load_dwordx4 v5, s[16:19], s36 offen lds
s_mov_b64 exec, -1
v_mfma_f32_16x16x32_bf16 v[172:175], a[116:119], a[156:159], v[172:175]
s_waitcnt lgkmcnt(6)
v_mfma_f32_16x16x32_bf16 v[32:35], a[96:99], a[160:163], v[32:35]
ds_read_b64_tr_b16 a[112:113], v8 offset:128
v_mfma_f32_16x16x32_bf16 v[36:39], a[96:99], a[164:167], v[36:39]
ds_read_b64_tr_b16 a[114:115], v8 offset:4736
v_mfma_f32_16x16x32_bf16 v[40:43], a[96:99], a[168:171], v[40:43]
s_add_u32 s37, s38, 8192
v_mfma_f32_16x16x32_bf16 v[44:47], a[96:99], a[172:175], v[44:47]
buffer_load_dwordx4 a[144:147], v17, s[20:23], s37 offen sc1
s_waitcnt lgkmcnt(6)
v_mfma_f32_16x16x32_bf16 v[48:51], a[100:103], a[160:163], v[48:51]
ds_read_b64_tr_b16 a[116:117], v8 offset:160
v_mfma_f32_16x16x32_bf16 v[52:55], a[100:103], a[164:167], v[52:55]
ds_read_b64_tr_b16 a[118:119], v8 offset:4768
v_mfma_f32_16x16x32_bf16 v[56:59], a[100:103], a[168:171], v[56:59]
buffer_load_dwordx4 a[148:151], v18, s[20:23], s37 offen sc1
v_mfma_f32_16x16x32_bf16 v[60:63], a[100:103], a[172:175], v[60:63]
s_waitcnt lgkmcnt(6)
v_mfma_f32_16x16x32_bf16 v[64:67], a[104:107], a[160:163], v[64:67]
ds_read_b64_tr_b16 a[96:97], v8 offset:192
v_mfma_f32_16x16x32_bf16 v[68:71], a[104:107], a[164:167], v[68:71]
ds_read_b64_tr_b16 a[98:99], v8 offset:4800
v_mfma_f32_16x16x32_bf16 v[72:75], a[104:107], a[168:171], v[72:75]
buffer_load_dwordx4 a[152:155], v19, s[20:23], s37 offen sc1
v_mfma_f32_16x16x32_bf16 v[76:79], a[104:107], a[172:175], v[76:79]
buffer_load_dwordx4 a[156:159], v20, s[20:23], s37 offen sc1
s_waitcnt lgkmcnt(6)
v_mfma_f32_16x16x32_bf16 v[80:83], a[108:111], a[160:163], v[80:83]
ds_read_b64_tr_b16 a[100:101], v8 offset:224
v_mfma_f32_16x16x32_bf16 v[84:87], a[108:111], a[164:167], v[84:87]
ds_read_b64_tr_b16 a[102:103], v8 offset:4832
v_mfma_f32_16x16x32_bf16 v[88:91], a[108:111], a[168:171], v[88:91]
s_add_u32 m0, s33, 55296
v_mfma_f32_16x16x32_bf16 v[92:95], a[108:111], a[172:175], v[92:95]
s_waitcnt lgkmcnt(6)
v_mfma_f32_16x16x32_bf16 v[96:99], a[112:115], a[160:163], v[96:99]
ds_read_b64_tr_b16 a[104:105], v8 offset:256
v_mfma_f32_16x16x32_bf16 v[100:103], a[112:115], a[164:167], v[100:103]
ds_read_b64_tr_b16 a[106:107], v8 offset:4864
v_mfma_f32_16x16x32_bf16 v[104:107], a[112:115], a[168:171], v[104:107]
s_add_u32 s36, s62, 331776
v_mfma_f32_16x16x32_bf16 v[108:111], a[112:115], a[172:175], v[108:111]
buffer_load_dwordx4 v1, s[16:19], s36 offen offset:0 lds
s_waitcnt lgkmcnt(6)
v_mfma_f32_16x16x32_bf16 v[112:115], a[116:119], a[160:163], v[112:115]
ds_read_b64_tr_b16 a[108:109], v8 offset:18432
v_mfma_f32_16x16x32_bf16 v[116:119], a[116:119], a[164:167], v[116:119]
ds_read_b64_tr_b16 a[110:111], v8 offset:23040
v_mfma_f32_16x16x32_bf16 v[120:123], a[116:119], a[168:171], v[120:123]
v_mfma_f32_16x16x32_bf16 v[124:127], a[116:119], a[172:175], v[124:127]
buffer_load_dwordx4 v2, s[16:19], s36 offen offset:1024 lds
s_waitcnt lgkmcnt(6)
v_mfma_f32_16x16x32_bf16 v[128:131], a[96:99], a[160:163], v[128:131]
ds_read_b64_tr_b16 a[112:113], v8 offset:18464
v_mfma_f32_16x16x32_bf16 v[132:135], a[96:99], a[164:167], v[132:135]
ds_read_b64_tr_b16 a[114:115], v8 offset:23072
v_mfma_f32_16x16x32_bf16 v[136:139], a[96:99], a[168:171], v[136:139]
buffer_load_dwordx4 v3, s[16:19], s36 offen offset:2048 lds
v_mfma_f32_16x16x32_bf16 v[140:143], a[96:99], a[172:175], v[140:143]
buffer_load_dwordx4 v4, s[16:19], s36 offen offset:3072 lds
s_waitcnt lgkmcnt(6)
v_mfma_f32_16x16x32_bf16 v[144:147], a[100:103], a[160:163], v[144:147]
ds_read_b64_tr_b16 a[116:117], v8 offset:18496
v_mfma_f32_16x16x32_bf16 v[148:151], a[100:103], a[164:167], v[148:151]
ds_read_b64_tr_b16 a[118:119], v8 offset:23104
v_mfma_f32_16x16x32_bf16 v[152:155], a[100:103], a[168:171], v[152:155]
v_mfma_f32_16x16x32_bf16 v[156:159], a[100:103], a[172:175], v[156:159]
s_add_u32 m0, s35, 55296
s_waitcnt lgkmcnt(6)
v_mfma_f32_16x16x32_bf16 v[160:163], a[104:107], a[160:163], v[160:163]
ds_read_b64_tr_b16 a[96:97], v8 offset:18528
v_mfma_f32_16x16x32_bf16 v[164:167], a[104:107], a[164:167], v[164:167]
ds_read_b64_tr_b16 a[98:99], v8 offset:23136
v_mfma_f32_16x16x32_bf16 v[168:171], a[104:107], a[168:171], v[168:171]
s_mov_b64 exec, s[48:49]
buffer_load_dwordx4 v5, s[16:19], s36 offen lds
s_mov_b64 exec, -1
v_mfma_f32_16x16x32_bf16 v[172:175], a[104:107], a[172:175], v[172:175]
s_waitcnt vmcnt(32) lgkmcnt(6)
v_mfma_f32_16x16x32_bf16 v[32:35], a[108:111], a[176:179], v[32:35]
ds_read_b64_tr_b16 a[100:101], v8 offset:18560
v_mfma_f32_16x16x32_bf16 v[36:39], a[108:111], a[180:183], v[36:39]
ds_read_b64_tr_b16 a[102:103], v8 offset:23168
v_mfma_f32_16x16x32_bf16 v[40:43], a[108:111], a[184:187], v[40:43]
s_add_u32 s37, s38, 9216
v_mfma_f32_16x16x32_bf16 v[44:47], a[108:111], a[188:191], v[44:47]
buffer_load_dwordx4 a[160:163], v17, s[20:23], s37 offen sc1
s_waitcnt lgkmcnt(6)
v_mfma_f32_16x16x32_bf16 v[48:51], a[112:115], a[176:179], v[48:51]
ds_read_b64_tr_b16 a[104:105], v8 offset:18592
v_mfma_f32_16x16x32_bf16 v[52:55], a[112:115], a[180:183], v[52:55]
ds_read_b64_tr_b16 a[106:107], v8 offset:23200
v_mfma_f32_16x16x32_bf16 v[56:59], a[112:115], a[184:187], v[56:59]
buffer_load_dwordx4 a[164:167], v18, s[20:23], s37 offen sc1
v_mfma_f32_16x16x32_bf16 v[60:63], a[112:115], a[188:191], v[60:63]
buffer_load_dwordx4 a[168:171], v19, s[20:23], s37 offen sc1
s_waitcnt lgkmcnt(6)
v_mfma_f32_16x16x32_bf16 v[64:67], a[116:119], a[176:179], v[64:67]
ds_read_b64_tr_b16 a[108:109], v8 offset:18624
v_mfma_f32_16x16x32_bf16 v[68:71], a[116:119], a[180:183], v[68:71]
ds_read_b64_tr_b16 a[110:111], v8 offset:23232
v_mfma_f32_16x16x32_bf16 v[72:75], a[116:119], a[184:187], v[72:75]
buffer_load_dwordx4 a[172:175], v20, s[20:23], s37 offen sc1
v_mfma_f32_16x16x32_bf16 v[76:79], a[116:119], a[188:191], v[76:79]
s_waitcnt lgkmcnt(6)
v_mfma_f32_16x16x32_bf16 v[80:83], a[96:99], a[176:179], v[80:83]
ds_read_b64_tr_b16 a[112:113], v8 offset:18656
v_mfma_f32_16x16x32_bf16 v[84:87], a[96:99], a[180:183], v[84:87]
ds_read_b64_tr_b16 a[114:115], v8 offset:23264
v_mfma_f32_16x16x32_bf16 v[88:91], a[96:99], a[184:187], v[88:91]
s_add_u32 m0, s33, 73728
v_mfma_f32_16x16x32_bf16 v[92:95], a[96:99], a[188:191], v[92:95]
s_add_u32 s36, s62, 368640
s_waitcnt lgkmcnt(6)
v_mfma_f32_16x16x32_bf16 v[96:99], a[100:103], a[176:179], v[96:99]
ds_read_b64_tr_b16 a[116:117], v8 offset:18688
v_mfma_f32_16x16x32_bf16 v[100:103], a[100:103], a[180:183], v[100:103]
ds_read_b64_tr_b16 a[118:119], v8 offset:23296
v_mfma_f32_16x16x32_bf16 v[104:107], a[100:103], a[184:187], v[104:107]
s_waitcnt vmcnt(22)
v_mfma_f32_16x16x32_bf16 v[108:111], a[100:103], a[188:191], v[108:111]
s_barrier
s_waitcnt lgkmcnt(6)
v_mfma_f32_16x16x32_bf16 v[112:115], a[104:107], a[176:179], v[112:115]
ds_read_b64_tr_b16 a[96:97], v6 offset:0
v_mfma_f32_16x16x32_bf16 v[116:119], a[104:107], a[180:183], v[116:119]
ds_read_b64_tr_b16 a[98:99], v6 offset:4608
v_mfma_f32_16x16x32_bf16 v[120:123], a[104:107], a[184:187], v[120:123]
buffer_load_dwordx4 v1, s[16:19], s36 offen offset:0 lds
v_mfma_f32_16x16x32_bf16 v[124:127], a[104:107], a[188:191], v[124:127]
buffer_load_dwordx4 v2, s[16:19], s36 offen offset:1024 lds
s_waitcnt lgkmcnt(6)
v_mfma_f32_16x16x32_bf16 v[128:131], a[108:111], a[176:179], v[128:131]
ds_read_b64_tr_b16 a[100:101], v6 offset:32
v_mfma_f32_16x16x32_bf16 v[132:135], a[108:111], a[180:183], v[132:135]
ds_read_b64_tr_b16 a[102:103], v6 offset:4640
v_mfma_f32_16x16x32_bf16 v[136:139], a[108:111], a[184:187], v[136:139]
v_mfma_f32_16x16x32_bf16 v[140:143], a[108:111], a[188:191], v[140:143]
buffer_load_dwordx4 v3, s[16:19], s36 offen offset:2048 lds
s_waitcnt lgkmcnt(6)
v_mfma_f32_16x16x32_bf16 v[144:147], a[112:115], a[176:179], v[144:147]
ds_read_b64_tr_b16 a[104:105], v6 offset:64
v_mfma_f32_16x16x32_bf16 v[148:151], a[112:115], a[180:183], v[148:151]
ds_read_b64_tr_b16 a[106:107], v6 offset:4672
v_mfma_f32_16x16x32_bf16 v[152:155], a[112:115], a[184:187], v[152:155]
buffer_load_dwordx4 v4, s[16:19], s36 offen offset:3072 lds
v_mfma_f32_16x16x32_bf16 v[156:159], a[112:115], a[188:191], v[156:159]
s_add_u32 m0, s35, 73728
s_waitcnt lgkmcnt(6)
v_mfma_f32_16x16x32_bf16 v[160:163], a[116:119], a[176:179], v[160:163]
ds_read_b64_tr_b16 a[108:109], v6 offset:96
v_mfma_f32_16x16x32_bf16 v[164:167], a[116:119], a[180:183], v[164:167]
ds_read_b64_tr_b16 a[110:111], v6 offset:4704
v_mfma_f32_16x16x32_bf16 v[168:171], a[116:119], a[184:187], v[168:171]
s_mov_b64 exec, s[48:49]
buffer_load_dwordx4 v5, s[16:19], s36 offen lds
s_mov_b64 exec, -1
v_mfma_f32_16x16x32_bf16 v[172:175], a[116:119], a[188:191], v[172:175]
s_waitcnt lgkmcnt(6)
v_mfma_f32_16x16x32_bf16 v[32:35], a[96:99], a[192:195], v[32:35]
ds_read_b64_tr_b16 a[112:113], v6 offset:128
v_mfma_f32_16x16x32_bf16 v[36:39], a[96:99], a[196:199], v[36:39]
ds_read_b64_tr_b16 a[114:115], v6 offset:4736
v_mfma_f32_16x16x32_bf16 v[40:43], a[96:99], a[200:203], v[40:43]
s_add_u32 s37, s38, 10240
v_mfma_f32_16x16x32_bf16 v[44:47], a[96:99], a[204:207], v[44:47]
buffer_load_dwordx4 a[176:179], v17, s[20:23], s37 offen sc1
s_waitcnt lgkmcnt(6)
v_mfma_f32_16x16x32_bf16 v[48:51], a[100:103], a[192:195], v[48:51]
ds_read_b64_tr_b16 a[116:117], v6 offset:160
v_mfma_f32_16x16x32_bf16 v[52:55], a[100:103], a[196:199], v[52:55]
ds_read_b64_tr_b16 a[118:119], v6 offset:4768
v_mfma_f32_16x16x32_bf16 v[56:59], a[100:103], a[200:203], v[56:59]
buffer_load_dwordx4 a[180:183], v18, s[20:23], s37 offen sc1
v_mfma_f32_16x16x32_bf16 v[60:63], a[100:103], a[204:207], v[60:63]
s_waitcnt lgkmcnt(6)
v_mfma_f32_16x16x32_bf16 v[64:67], a[104:107], a[192:195], v[64:67]
ds_read_b64_tr_b16 a[96:97], v6 offset:192
v_mfma_f32_16x16x32_bf16 v[68:71], a[104:107], a[196:199], v[68:71]
ds_read_b64_tr_b16 a[98:99], v6 offset:4800
v_mfma_f32_16x16x32_bf16 v[72:75], a[104:107], a[200:203], v[72:75]
buffer_load_dwordx4 a[184:187], v19, s[20:23], s37 offen sc1
v_mfma_f32_16x16x32_bf16 v[76:79], a[104:107], a[204:207], v[76:79]
buffer_load_dwordx4 a[188:191], v20, s[20:23], s37 offen sc1
s_waitcnt lgkmcnt(6)
v_mfma_f32_16x16x32_bf16 v[80:83], a[108:111], a[192:195], v[80:83]
ds_read_b64_tr_b16 a[100:101], v6 offset:224
v_mfma_f32_16x16x32_bf16 v[84:87], a[108:111], a[196:199], v[84:87]
ds_read_b64_tr_b16 a[102:103], v6 offset:4832
v_mfma_f32_16x16x32_bf16 v[88:91], a[108:111], a[200:203], v[88:91]
s_add_u32 m0, s33, 92160
v_mfma_f32_16x16x32_bf16 v[92:95], a[108:111], a[204:207], v[92:95]
s_waitcnt lgkmcnt(6)
v_mfma_f32_16x16x32_bf16 v[96:99], a[112:115], a[192:195], v[96:99]
ds_read_b64_tr_b16 a[104:105], v6 offset:256
v_mfma_f32_16x16x32_bf16 v[100:103], a[112:115], a[196:199], v[100:103]
ds_read_b64_tr_b16 a[106:107], v6 offset:4864
v_mfma_f32_16x16x32_bf16 v[104:107], a[112:115], a[200:203], v[104:107]
s_add_u32 s36, s62, 405504
v_mfma_f32_16x16x32_bf16 v[108:111], a[112:115], a[204:207], v[108:111]
buffer_load_dwordx4 v1, s[16:19], s36 offen offset:0 lds
s_waitcnt lgkmcnt(6)
v_mfma_f32_16x16x32_bf16 v[112:115], a[116:119], a[192:195], v[112:115]
ds_read_b64_tr_b16 a[108:109], v6 offset:18432
v_mfma_f32_16x16x32_bf16 v[116:119], a[116:119], a[196:199], v[116:119]
ds_read_b64_tr_b16 a[110:111], v6 offset:23040
v_mfma_f32_16x16x32_bf16 v[120:123], a[116:119], a[200:203], v[120:123]
v_mfma_f32_16x16x32_bf16 v[124:127], a[116:119], a[204:207], v[124:127]
buffer_load_dwordx4 v2, s[16:19], s36 offen offset:1024 lds
s_waitcnt lgkmcnt(6)
v_mfma_f32_16x16x32_bf16 v[128:131], a[96:99], a[192:195], v[128:131]
ds_read_b64_tr_b16 a[112:113], v6 offset:18464
v_mfma_f32_16x16x32_bf16 v[132:135], a[96:99], a[196:199], v[132:135]
ds_read_b64_tr_b16 a[114:115], v6 offset:23072
v_mfma_f32_16x16x32_bf16 v[136:139], a[96:99], a[200:203], v[136:139]
buffer_load_dwordx4 v3, s[16:19], s36 offen offset:2048 lds
v_mfma_f32_16x16x32_bf16 v[140:143], a[96:99], a[204:207], v[140:143]
buffer_load_dwordx4 v4, s[16:19], s36 offen offset:3072 lds
s_waitcnt lgkmcnt(6)
v_mfma_f32_16x16x32_bf16 v[144:147], a[100:103], a[192:195], v[144:147]
ds_read_b64_tr_b16 a[116:117], v6 offset:18496
v_mfma_f32_16x16x32_bf16 v[148:151], a[100:103], a[196:199], v[148:151]
ds_read_b64_tr_b16 a[118:119], v6 offset:23104
v_mfma_f32_16x16x32_bf16 v[152:155], a[100:103], a[200:203], v[152:155]
v_mfma_f32_16x16x32_bf16 v[156:159], a[100:103], a[204:207], v[156:159]
s_add_u32 m0, s35, 92160
s_waitcnt lgkmcnt(6)
v_mfma_f32_16x16x32_bf16 v[160:163], a[104:107], a[192:195], v[160:163]
ds_read_b64_tr_b16 a[96:97], v6 offset:18528
v_mfma_f32_16x16x32_bf16 v[164:167], a[104:107], a[196:199], v[164:167]
ds_read_b64_tr_b16 a[98:99], v6 offset:23136
v_mfma_f32_16x16x32_bf16 v[168:171], a[104:107], a[200:203], v[168:171]
s_mov_b64 exec, s[48:49]
buffer_load_dwordx4 v5, s[16:19], s36 offen lds
s_mov_b64 exec, -1
v_mfma_f32_16x16x32_bf16 v[172:175], a[104:107], a[204:207], v[172:175]
s_waitcnt vmcnt(32) lgkmcnt(6)
v_mfma_f32_16x16x32_bf16 v[32:35], a[108:111], a[128:131], v[32:35]
ds_read_b64_tr_b16 a[100:101], v6 offset:18560
v_mfma_f32_16x16x32_bf16 v[36:39], a[108:111], a[132:135], v[36:39]
ds_read_b64_tr_b16 a[102:103], v6 offset:23168
v_mfma_f32_16x16x32_bf16 v[40:43], a[108:111], a[136:139], v[40:43]
s_add_u32 s37, s38, 11264
v_mfma_f32_16x16x32_bf16 v[44:47], a[108:111], a[140:143], v[44:47]
buffer_load_dwordx4 a[192:195], v17, s[20:23], s37 offen sc1
s_waitcnt lgkmcnt(6)
v_mfma_f32_16x16x32_bf16 v[48:51], a[112:115], a[128:131], v[48:51]
ds_read_b64_tr_b16 a[104:105], v6 offset:18592
v_mfma_f32_16x16x32_bf16 v[52:55], a[112:115], a[132:135], v[52:55]
ds_read_b64_tr_b16 a[106:107], v6 offset:23200
v_mfma_f32_16x16x32_bf16 v[56:59], a[112:115], a[136:139], v[56:59]
buffer_load_dwordx4 a[196:199], v18, s[20:23], s37 offen sc1
v_mfma_f32_16x16x32_bf16 v[60:63], a[112:115], a[140:143], v[60:63]
buffer_load_dwordx4 a[200:203], v19, s[20:23], s37 offen sc1
s_waitcnt lgkmcnt(6)
v_mfma_f32_16x16x32_bf16 v[64:67], a[116:119], a[128:131], v[64:67]
ds_read_b64_tr_b16 a[108:109], v6 offset:18624
v_mfma_f32_16x16x32_bf16 v[68:71], a[116:119], a[132:135], v[68:71]
ds_read_b64_tr_b16 a[110:111], v6 offset:23232
v_mfma_f32_16x16x32_bf16 v[72:75], a[116:119], a[136:139], v[72:75]
buffer_load_dwordx4 a[204:207], v20, s[20:23], s37 offen sc1
v_mfma_f32_16x16x32_bf16 v[76:79], a[116:119], a[140:143], v[76:79]
s_waitcnt lgkmcnt(6)
v_mfma_f32_16x16x32_bf16 v[80:83], a[96:99], a[128:131], v[80:83]
ds_read_b64_tr_b16 a[112:113], v6 offset:18656
v_mfma_f32_16x16x32_bf16 v[84:87], a[96:99], a[132:135], v[84:87]
ds_read_b64_tr_b16 a[114:115], v6 offset:23264
v_mfma_f32_16x16x32_bf16 v[88:91], a[96:99], a[136:139], v[88:91]
s_add_u32 m0, s33, 110592
v_mfma_f32_16x16x32_bf16 v[92:95], a[96:99], a[140:143], v[92:95]
s_add_u32 s36, s62, 442368
s_waitcnt lgkmcnt(6)
v_mfma_f32_16x16x32_bf16 v[96:99], a[100:103], a[128:131], v[96:99]
ds_read_b64_tr_b16 a[116:117], v6 offset:18688
v_mfma_f32_16x16x32_bf16 v[100:103], a[100:103], a[132:135], v[100:103]
ds_read_b64_tr_b16 a[118:119], v6 offset:23296
v_mfma_f32_16x16x32_bf16 v[104:107], a[100:103], a[136:139], v[104:107]
s_waitcnt vmcnt(22)
v_mfma_f32_16x16x32_bf16 v[108:111], a[100:103], a[140:143], v[108:111]
s_barrier
s_waitcnt lgkmcnt(6)
v_mfma_f32_16x16x32_bf16 v[112:115], a[104:107], a[128:131], v[112:115]
ds_read_b64_tr_b16 a[96:97], v6 offset:36864
v_mfma_f32_16x16x32_bf16 v[116:119], a[104:107], a[132:135], v[116:119]
ds_read_b64_tr_b16 a[98:99], v6 offset:41472
v_mfma_f32_16x16x32_bf16 v[120:123], a[104:107], a[136:139], v[120:123]
buffer_load_dwordx4 v1, s[16:19], s36 offen offset:0 lds
v_mfma_f32_16x16x32_bf16 v[124:127], a[104:107], a[140:143], v[124:127]
buffer_load_dwordx4 v2, s[16:19], s36 offen offset:1024 lds
s_waitcnt lgkmcnt(6)
v_mfma_f32_16x16x32_bf16 v[128:131], a[108:111], a[128:131], v[128:131]
ds_read_b64_tr_b16 a[100:101], v6 offset:36896
v_mfma_f32_16x16x32_bf16 v[132:135], a[108:111], a[132:135], v[132:135]
ds_read_b64_tr_b16 a[102:103], v6 offset:41504
v_mfma_f32_16x16x32_bf16 v[136:139], a[108:111], a[136:139], v[136:139]
v_mfma_f32_16x16x32_bf16 v[140:143], a[108:111], a[140:143], v[140:143]
buffer_load_dwordx4 v3, s[16:19], s36 offen offset:2048 lds
s_waitcnt lgkmcnt(6)
v_mfma_f32_16x16x32_bf16 v[144:147], a[112:115], a[128:131], v[144:147]
ds_read_b64_tr_b16 a[104:105], v6 offset:36928
v_mfma_f32_16x16x32_bf16 v[148:151], a[112:115], a[132:135], v[148:151]
ds_read_b64_tr_b16 a[106:107], v6 offset:41536
v_mfma_f32_16x16x32_bf16 v[152:155], a[112:115], a[136:139], v[152:155]
buffer_load_dwordx4 v4, s[16:19], s36 offen offset:3072 lds
v_mfma_f32_16x16x32_bf16 v[156:159], a[112:115], a[140:143], v[156:159]
s_add_u32 m0, s35, 110592
s_waitcnt lgkmcnt(6)
v_mfma_f32_16x16x32_bf16 v[160:163], a[116:119], a[128:131], v[160:163]
ds_read_b64_tr_b16 a[108:109], v6 offset:36960
v_mfma_f32_16x16x32_bf16 v[164:167], a[116:119], a[132:135], v[164:167]
ds_read_b64_tr_b16 a[110:111], v6 offset:41568
v_mfma_f32_16x16x32_bf16 v[168:171], a[116:119], a[136:139], v[168:171]
s_mov_b64 exec, s[48:49]
buffer_load_dwordx4 v5, s[16:19], s36 offen lds
s_mov_b64 exec, -1
v_mfma_f32_16x16x32_bf16 v[172:175], a[116:119], a[140:143], v[172:175]
s_waitcnt lgkmcnt(6)
v_mfma_f32_16x16x32_bf16 v[32:35], a[96:99], a[144:147], v[32:35]
ds_read_b64_tr_b16 a[112:113], v6 offset:36992
v_mfma_f32_16x16x32_bf16 v[36:39], a[96:99], a[148:151], v[36:39]
ds_read_b64_tr_b16 a[114:115], v6 offset:41600
v_mfma_f32_16x16x32_bf16 v[40:43], a[96:99], a[152:155], v[40:43]
s_add_u32 s37, s38, 12288
v_mfma_f32_16x16x32_bf16 v[44:47], a[96:99], a[156:159], v[44:47]
buffer_load_dwordx4 a[128:131], v17, s[20:23], s37 offen sc1
s_waitcnt lgkmcnt(6)
v_mfma_f32_16x16x32_bf16 v[48:51], a[100:103], a[144:147], v[48:51]
ds_read_b64_tr_b16 a[116:117], v6 offset:37024
v_mfma_f32_16x16x32_bf16 v[52:55], a[100:103], a[148:151], v[52:55]
ds_read_b64_tr_b16 a[118:119], v6 offset:41632
v_mfma_f32_16x16x32_bf16 v[56:59], a[100:103], a[152:155], v[56:59]
buffer_load_dwordx4 a[132:135], v18, s[20:23], s37 offen sc1
v_mfma_f32_16x16x32_bf16 v[60:63], a[100:103], a[156:159], v[60:63]
s_waitcnt lgkmcnt(6)
v_mfma_f32_16x16x32_bf16 v[64:67], a[104:107], a[144:147], v[64:67]
ds_read_b64_tr_b16 a[96:97], v6 offset:37056
v_mfma_f32_16x16x32_bf16 v[68:71], a[104:107], a[148:151], v[68:71]
ds_read_b64_tr_b16 a[98:99], v6 offset:41664
v_mfma_f32_16x16x32_bf16 v[72:75], a[104:107], a[152:155], v[72:75]
buffer_load_dwordx4 a[136:139], v19, s[20:23], s37 offen sc1
v_mfma_f32_16x16x32_bf16 v[76:79], a[104:107], a[156:159], v[76:79]
buffer_load_dwordx4 a[140:143], v20, s[20:23], s37 offen sc1
s_waitcnt lgkmcnt(6)
v_mfma_f32_16x16x32_bf16 v[80:83], a[108:111], a[144:147], v[80:83]
ds_read_b64_tr_b16 a[100:101], v6 offset:37088
v_mfma_f32_16x16x32_bf16 v[84:87], a[108:111], a[148:151], v[84:87]
ds_read_b64_tr_b16 a[102:103], v6 offset:41696
v_mfma_f32_16x16x32_bf16 v[88:91], a[108:111], a[152:155], v[88:91]
s_add_u32 m0, s33, 129024
v_mfma_f32_16x16x32_bf16 v[92:95], a[108:111], a[156:159], v[92:95]
s_waitcnt lgkmcnt(6)
v_mfma_f32_16x16x32_bf16 v[96:99], a[112:115], a[144:147], v[96:99]
ds_read_b64_tr_b16 a[104:105], v6 offset:37120
v_mfma_f32_16x16x32_bf16 v[100:103], a[112:115], a[148:151], v[100:103]
ds_read_b64_tr_b16 a[106:107], v6 offset:41728
v_mfma_f32_16x16x32_bf16 v[104:107], a[112:115], a[152:155], v[104:107]
s_add_u32 s36, s62, 479232
v_mfma_f32_16x16x32_bf16 v[108:111], a[112:115], a[156:159], v[108:111]
buffer_load_dwordx4 v1, s[16:19], s36 offen offset:0 lds
s_waitcnt lgkmcnt(6)
v_mfma_f32_16x16x32_bf16 v[112:115], a[116:119], a[144:147], v[112:115]
ds_read_b64_tr_b16 a[108:109], v7 offset:0
v_mfma_f32_16x16x32_bf16 v[116:119], a[116:119], a[148:151], v[116:119]
ds_read_b64_tr_b16 a[110:111], v7 offset:4608
v_mfma_f32_16x16x32_bf16 v[120:123], a[116:119], a[152:155], v[120:123]
v_mfma_f32_16x16x32_bf16 v[124:127], a[116:119], a[156:159], v[124:127]
buffer_load_dwordx4 v2, s[16:19], s36 offen offset:1024 lds
s_waitcnt lgkmcnt(6)
v_mfma_f32_16x16x32_bf16 v[128:131], a[96:99], a[144:147], v[128:131]
ds_read_b64_tr_b16 a[112:113], v7 offset:32
v_mfma_f32_16x16x32_bf16 v[132:135], a[96:99], a[148:151], v[132:135]
ds_read_b64_tr_b16 a[114:115], v7 offset:4640
v_mfma_f32_16x16x32_bf16 v[136:139], a[96:99], a[152:155], v[136:139]
buffer_load_dwordx4 v3, s[16:19], s36 offen offset:2048 lds
v_mfma_f32_16x16x32_bf16 v[140:143], a[96:99], a[156:159], v[140:143]
buffer_load_dwordx4 v4, s[16:19], s36 offen offset:3072 lds
s_waitcnt lgkmcnt(6)
v_mfma_f32_16x16x32_bf16 v[144:147], a[100:103], a[144:147], v[144:147]
ds_read_b64_tr_b16 a[116:117], v7 offset:64
v_mfma_f32_16x16x32_bf16 v[148:151], a[100:103], a[148:151], v[148:151]
ds_read_b64_tr_b16 a[118:119], v7 offset:4672
v_mfma_f32_16x16x32_bf16 v[152:155], a[100:103], a[152:155], v[152:155]
v_mfma_f32_16x16x32_bf16 v[156:159], a[100:103], a[156:159], v[156:159]
s_add_u32 m0, s35, 129024
s_waitcnt lgkmcnt(6)
v_mfma_f32_16x16x32_bf16 v[160:163], a[104:107], a[144:147], v[160:163]
ds_read_b64_tr_b16 a[96:97], v7 offset:96
v_mfma_f32_16x16x32_bf16 v[164:167], a[104:107], a[148:151], v[164:167]
ds_read_b64_tr_b16 a[98:99], v7 offset:4704
v_mfma_f32_16x16x32_bf16 v[168:171], a[104:107], a[152:155], v[168:171]
s_mov_b64 exec, s[48:49]
buffer_load_dwordx4 v5, s[16:19], s36 offen lds
s_mov_b64 exec, -1
v_mfma_f32_16x16x32_bf16 v[172:175], a[104:107], a[156:159], v[172:175]
s_waitcnt vmcnt(32) lgkmcnt(6)
v_mfma_f32_16x16x32_bf16 v[32:35], a[108:111], a[160:163], v[32:35]
ds_read_b64_tr_b16 a[100:101], v7 offset:128
v_mfma_f32_16x16x32_bf16 v[36:39], a[108:111], a[164:167], v[36:39]
ds_read_b64_tr_b16 a[102:103], v7 offset:4736
v_mfma_f32_16x16x32_bf16 v[40:43], a[108:111], a[168:171], v[40:43]
s_add_u32 s37, s38, 13312
v_mfma_f32_16x16x32_bf16 v[44:47], a[108:111], a[172:175], v[44:47]
buffer_load_dwordx4 a[144:147], v17, s[20:23], s37 offen sc1
s_waitcnt lgkmcnt(6)
v_mfma_f32_16x16x32_bf16 v[48:51], a[112:115], a[160:163], v[48:51]
ds_read_b64_tr_b16 a[104:105], v7 offset:160
v_mfma_f32_16x16x32_bf16 v[52:55], a[112:115], a[164:167], v[52:55]
ds_read_b64_tr_b16 a[106:107], v7 offset:4768
v_mfma_f32_16x16x32_bf16 v[56:59], a[112:115], a[168:171], v[56:59]
buffer_load_dwordx4 a[148:151], v18, s[20:23], s37 offen sc1
v_mfma_f32_16x16x32_bf16 v[60:63], a[112:115], a[172:175], v[60:63]
buffer_load_dwordx4 a[152:155], v19, s[20:23], s37 offen sc1
s_waitcnt lgkmcnt(6)
v_mfma_f32_16x16x32_bf16 v[64:67], a[116:119], a[160:163], v[64:67]
ds_read_b64_tr_b16 a[108:109], v7 offset:192
v_mfma_f32_16x16x32_bf16 v[68:71], a[116:119], a[164:167], v[68:71]
ds_read_b64_tr_b16 a[110:111], v7 offset:4800
v_mfma_f32_16x16x32_bf16 v[72:75], a[116:119], a[168:171], v[72:75]
buffer_load_dwordx4 a[156:159], v20, s[20:23], s37 offen sc1
v_mfma_f32_16x16x32_bf16 v[76:79], a[116:119], a[172:175], v[76:79]
s_waitcnt lgkmcnt(6)
v_mfma_f32_16x16x32_bf16 v[80:83], a[96:99], a[160:163], v[80:83]
ds_read_b64_tr_b16 a[112:113], v7 offset:224
v_mfma_f32_16x16x32_bf16 v[84:87], a[96:99], a[164:167], v[84:87]
ds_read_b64_tr_b16 a[114:115], v7 offset:4832
v_mfma_f32_16x16x32_bf16 v[88:91], a[96:99], a[168:171], v[88:91]
s_add_u32 m0, s33, 0
v_mfma_f32_16x16x32_bf16 v[92:95], a[96:99], a[172:175], v[92:95]
s_add_u32 s36, s62, 516096
s_waitcnt lgkmcnt(6)
v_mfma_f32_16x16x32_bf16 v[96:99], a[100:103], a[160:163], v[96:99]
ds_read_b64_tr_b16 a[116:117], v7 offset:256
v_mfma_f32_16x16x32_bf16 v[100:103], a[100:103], a[164:167], v[100:103]
ds_read_b64_tr_b16 a[118:119], v7 offset:4864
v_mfma_f32_16x16x32_bf16 v[104:107], a[100:103], a[168:171], v[104:107]
s_waitcnt vmcnt(22)
v_mfma_f32_16x16x32_bf16 v[108:111], a[100:103], a[172:175], v[108:111]
s_barrier
s_waitcnt lgkmcnt(6)
v_mfma_f32_16x16x32_bf16 v[112:115], a[104:107], a[160:163], v[112:115]
ds_read_b64_tr_b16 a[96:97], v7 offset:18432
v_mfma_f32_16x16x32_bf16 v[116:119], a[104:107], a[164:167], v[116:119]
ds_read_b64_tr_b16 a[98:99], v7 offset:23040
v_mfma_f32_16x16x32_bf16 v[120:123], a[104:107], a[168:171], v[120:123]
buffer_load_dwordx4 v1, s[16:19], s36 offen offset:0 lds
v_mfma_f32_16x16x32_bf16 v[124:127], a[104:107], a[172:175], v[124:127]
buffer_load_dwordx4 v2, s[16:19], s36 offen offset:1024 lds
s_waitcnt lgkmcnt(6)
v_mfma_f32_16x16x32_bf16 v[128:131], a[108:111], a[160:163], v[128:131]
ds_read_b64_tr_b16 a[100:101], v7 offset:18464
v_mfma_f32_16x16x32_bf16 v[132:135], a[108:111], a[164:167], v[132:135]
ds_read_b64_tr_b16 a[102:103], v7 offset:23072
v_mfma_f32_16x16x32_bf16 v[136:139], a[108:111], a[168:171], v[136:139]
v_mfma_f32_16x16x32_bf16 v[140:143], a[108:111], a[172:175], v[140:143]
buffer_load_dwordx4 v3, s[16:19], s36 offen offset:2048 lds
s_waitcnt lgkmcnt(6)
v_mfma_f32_16x16x32_bf16 v[144:147], a[112:115], a[160:163], v[144:147]
ds_read_b64_tr_b16 a[104:105], v7 offset:18496
v_mfma_f32_16x16x32_bf16 v[148:151], a[112:115], a[164:167], v[148:151]
ds_read_b64_tr_b16 a[106:107], v7 offset:23104
v_mfma_f32_16x16x32_bf16 v[152:155], a[112:115], a[168:171], v[152:155]
buffer_load_dwordx4 v4, s[16:19], s36 offen offset:3072 lds
v_mfma_f32_16x16x32_bf16 v[156:159], a[112:115], a[172:175], v[156:159]
s_add_u32 m0, s35, 0
s_waitcnt lgkmcnt(6)
v_mfma_f32_16x16x32_bf16 v[160:163], a[116:119], a[160:163], v[160:163]
ds_read_b64_tr_b16 a[108:109], v7 offset:18528
v_mfma_f32_16x16x32_bf16 v[164:167], a[116:119], a[164:167], v[164:167]
ds_read_b64_tr_b16 a[110:111], v7 offset:23136
v_mfma_f32_16x16x32_bf16 v[168:171], a[116:119], a[168:171], v[168:171]
s_mov_b64 exec, s[48:49]
buffer_load_dwordx4 v5, s[16:19], s36 offen lds
s_mov_b64 exec, -1
v_mfma_f32_16x16x32_bf16 v[172:175], a[116:119], a[172:175], v[172:175]
s_waitcnt lgkmcnt(6)
v_mfma_f32_16x16x32_bf16 v[32:35], a[96:99], a[176:179], v[32:35]
ds_read_b64_tr_b16 a[112:113], v7 offset:18560
v_mfma_f32_16x16x32_bf16 v[36:39], a[96:99], a[180:183], v[36:39]
ds_read_b64_tr_b16 a[114:115], v7 offset:23168
v_mfma_f32_16x16x32_bf16 v[40:43], a[96:99], a[184:187], v[40:43]
s_add_u32 s37, s38, 14336
v_mfma_f32_16x16x32_bf16 v[44:47], a[96:99], a[188:191], v[44:47]
buffer_load_dwordx4 a[160:163], v17, s[20:23], s37 offen sc1
s_waitcnt lgkmcnt(6)
v_mfma_f32_16x16x32_bf16 v[48:51], a[100:103], a[176:179], v[48:51]
ds_read_b64_tr_b16 a[116:117], v7 offset:18592
v_mfma_f32_16x16x32_bf16 v[52:55], a[100:103], a[180:183], v[52:55]
ds_read_b64_tr_b16 a[118:119], v7 offset:23200
v_mfma_f32_16x16x32_bf16 v[56:59], a[100:103], a[184:187], v[56:59]
buffer_load_dwordx4 a[164:167], v18, s[20:23], s37 offen sc1
v_mfma_f32_16x16x32_bf16 v[60:63], a[100:103], a[188:191], v[60:63]
s_waitcnt lgkmcnt(6)
v_mfma_f32_16x16x32_bf16 v[64:67], a[104:107], a[176:179], v[64:67]
ds_read_b64_tr_b16 a[96:97], v7 offset:18624
v_mfma_f32_16x16x32_bf16 v[68:71], a[104:107], a[180:183], v[68:71]
ds_read_b64_tr_b16 a[98:99], v7 offset:23232
v_mfma_f32_16x16x32_bf16 v[72:75], a[104:107], a[184:187], v[72:75]
buffer_load_dwordx4 a[168:171], v19, s[20:23], s37 offen sc1
v_mfma_f32_16x16x32_bf16 v[76:79], a[104:107], a[188:191], v[76:79]
buffer_load_dwordx4 a[172:175], v20, s[20:23], s37 offen sc1
s_waitcnt lgkmcnt(6)
v_mfma_f32_16x16x32_bf16 v[80:83], a[108:111], a[176:179], v[80:83]
ds_read_b64_tr_b16 a[100:101], v7 offset:18656
v_mfma_f32_16x16x32_bf16 v[84:87], a[108:111], a[180:183], v[84:87]
ds_read_b64_tr_b16 a[102:103], v7 offset:23264
v_mfma_f32_16x16x32_bf16 v[88:91], a[108:111], a[184:187], v[88:91]
s_add_u32 m0, s33, 18432
v_mfma_f32_16x16x32_bf16 v[92:95], a[108:111], a[188:191], v[92:95]
s_waitcnt lgkmcnt(6)
v_mfma_f32_16x16x32_bf16 v[96:99], a[112:115], a[176:179], v[96:99]
ds_read_b64_tr_b16 a[104:105], v7 offset:18688
v_mfma_f32_16x16x32_bf16 v[100:103], a[112:115], a[180:183], v[100:103]
ds_read_b64_tr_b16 a[106:107], v7 offset:23296
v_mfma_f32_16x16x32_bf16 v[104:107], a[112:115], a[184:187], v[104:107]
s_add_u32 s36, s62, 552960
v_mfma_f32_16x16x32_bf16 v[108:111], a[112:115], a[188:191], v[108:111]
buffer_load_dwordx4 v1, s[16:19], s36 offen offset:0 lds
s_waitcnt lgkmcnt(6)
v_mfma_f32_16x16x32_bf16 v[112:115], a[116:119], a[176:179], v[112:115]
ds_read_b64_tr_b16 a[108:109], v7 offset:36864
v_mfma_f32_16x16x32_bf16 v[116:119], a[116:119], a[180:183], v[116:119]
ds_read_b64_tr_b16 a[110:111], v7 offset:41472
v_mfma_f32_16x16x32_bf16 v[120:123], a[116:119], a[184:187], v[120:123]
v_mfma_f32_16x16x32_bf16 v[124:127], a[116:119], a[188:191], v[124:127]
buffer_load_dwordx4 v2, s[16:19], s36 offen offset:1024 lds
s_waitcnt lgkmcnt(6)
v_mfma_f32_16x16x32_bf16 v[128:131], a[96:99], a[176:179], v[128:131]
ds_read_b64_tr_b16 a[112:113], v7 offset:36896
v_mfma_f32_16x16x32_bf16 v[132:135], a[96:99], a[180:183], v[132:135]
ds_read_b64_tr_b16 a[114:115], v7 offset:41504
v_mfma_f32_16x16x32_bf16 v[136:139], a[96:99], a[184:187], v[136:139]
buffer_load_dwordx4 v3, s[16:19], s36 offen offset:2048 lds
v_mfma_f32_16x16x32_bf16 v[140:143], a[96:99], a[188:191], v[140:143]
buffer_load_dwordx4 v4, s[16:19], s36 offen offset:3072 lds
s_waitcnt lgkmcnt(6)
v_mfma_f32_16x16x32_bf16 v[144:147], a[100:103], a[176:179], v[144:147]
ds_read_b64_tr_b16 a[116:117], v7 offset:36928
v_mfma_f32_16x16x32_bf16 v[148:151], a[100:103], a[180:183], v[148:151]
ds_read_b64_tr_b16 a[118:119], v7 offset:41536
v_mfma_f32_16x16x32_bf16 v[152:155], a[100:103], a[184:187], v[152:155]
v_mfma_f32_16x16x32_bf16 v[156:159], a[100:103], a[188:191], v[156:159]
s_add_u32 m0, s35, 18432
s_waitcnt lgkmcnt(6)
v_mfma_f32_16x16x32_bf16 v[160:163], a[104:107], a[176:179], v[160:163]
ds_read_b64_tr_b16 a[96:97], v7 offset:36960
v_mfma_f32_16x16x32_bf16 v[164:167], a[104:107], a[180:183], v[164:167]
ds_read_b64_tr_b16 a[98:99], v7 offset:41568
v_mfma_f32_16x16x32_bf16 v[168:171], a[104:107], a[184:187], v[168:171]
s_mov_b64 exec, s[48:49]
buffer_load_dwordx4 v5, s[16:19], s36 offen lds
s_mov_b64 exec, -1
v_mfma_f32_16x16x32_bf16 v[172:175], a[104:107], a[188:191], v[172:175]
s_waitcnt vmcnt(32) lgkmcnt(6)
v_mfma_f32_16x16x32_bf16 v[32:35], a[108:111], a[192:195], v[32:35]
ds_read_b64_tr_b16 a[100:101], v7 offset:36992
v_mfma_f32_16x16x32_bf16 v[36:39], a[108:111], a[196:199], v[36:39]
ds_read_b64_tr_b16 a[102:103], v7 offset:41600
v_mfma_f32_16x16x32_bf16 v[40:43], a[108:111], a[200:203], v[40:43]
s_add_u32 s37, s38, 15360
v_mfma_f32_16x16x32_bf16 v[44:47], a[108:111], a[204:207], v[44:47]
s_waitcnt lgkmcnt(6)
v_mfma_f32_16x16x32_bf16 v[48:51], a[112:115], a[192:195], v[48:51]
ds_read_b64_tr_b16 a[104:105], v7 offset:37024
v_mfma_f32_16x16x32_bf16 v[52:55], a[112:115], a[196:199], v[52:55]
ds_read_b64_tr_b16 a[106:107], v7 offset:41632
v_mfma_f32_16x16x32_bf16 v[56:59], a[112:115], a[200:203], v[56:59]
v_mfma_f32_16x16x32_bf16 v[60:63], a[112:115], a[204:207], v[60:63]
buffer_load_dwordx4 a[176:179], v17, s[20:23], s37 offen sc1
s_waitcnt lgkmcnt(6)
v_mfma_f32_16x16x32_bf16 v[64:67], a[116:119], a[192:195], v[64:67]
ds_read_b64_tr_b16 a[108:109], v7 offset:37056
v_mfma_f32_16x16x32_bf16 v[68:71], a[116:119], a[196:199], v[68:71]
ds_read_b64_tr_b16 a[110:111], v7 offset:41664
v_mfma_f32_16x16x32_bf16 v[72:75], a[116:119], a[200:203], v[72:75]
v_mfma_f32_16x16x32_bf16 v[76:79], a[116:119], a[204:207], v[76:79]
s_waitcnt lgkmcnt(6)
v_mfma_f32_16x16x32_bf16 v[80:83], a[96:99], a[192:195], v[80:83]
ds_read_b64_tr_b16 a[112:113], v7 offset:37088
v_mfma_f32_16x16x32_bf16 v[84:87], a[96:99], a[196:199], v[84:87]
ds_read_b64_tr_b16 a[114:115], v7 offset:41696
v_mfma_f32_16x16x32_bf16 v[88:91], a[96:99], a[200:203], v[88:91]
buffer_load_dwordx4 a[180:183], v18, s[20:23], s37 offen sc1
v_mfma_f32_16x16x32_bf16 v[92:95], a[96:99], a[204:207], v[92:95]
s_waitcnt lgkmcnt(6)
v_mfma_f32_16x16x32_bf16 v[96:99], a[100:103], a[192:195], v[96:99]
ds_read_b64_tr_b16 a[116:117], v7 offset:37120
v_mfma_f32_16x16x32_bf16 v[100:103], a[100:103], a[196:199], v[100:103]
ds_read_b64_tr_b16 a[118:119], v7 offset:41728
v_mfma_f32_16x16x32_bf16 v[104:107], a[100:103], a[200:203], v[104:107]
s_waitcnt vmcnt(20)
v_mfma_f32_16x16x32_bf16 v[108:111], a[100:103], a[204:207], v[108:111]
s_barrier
s_waitcnt lgkmcnt(6)
v_mfma_f32_16x16x32_bf16 v[112:115], a[104:107], a[192:195], v[112:115]
ds_read_b64_tr_b16 a[96:97], v8 offset:0
v_mfma_f32_16x16x32_bf16 v[116:119], a[104:107], a[196:199], v[116:119]
ds_read_b64_tr_b16 a[98:99], v8 offset:4608
v_mfma_f32_16x16x32_bf16 v[120:123], a[104:107], a[200:203], v[120:123]
v_mfma_f32_16x16x32_bf16 v[124:127], a[104:107], a[204:207], v[124:127]
buffer_load_dwordx4 a[184:187], v19, s[20:23], s37 offen sc1
s_waitcnt lgkmcnt(6)
v_mfma_f32_16x16x32_bf16 v[128:131], a[108:111], a[192:195], v[128:131]
ds_read_b64_tr_b16 a[100:101], v8 offset:32
v_mfma_f32_16x16x32_bf16 v[132:135], a[108:111], a[196:199], v[132:135]
ds_read_b64_tr_b16 a[102:103], v8 offset:4640
v_mfma_f32_16x16x32_bf16 v[136:139], a[108:111], a[200:203], v[136:139]
v_mfma_f32_16x16x32_bf16 v[140:143], a[108:111], a[204:207], v[140:143]
s_waitcnt lgkmcnt(6)
v_mfma_f32_16x16x32_bf16 v[144:147], a[112:115], a[192:195], v[144:147]
ds_read_b64_tr_b16 a[104:105], v8 offset:64
v_mfma_f32_16x16x32_bf16 v[148:151], a[112:115], a[196:199], v[148:151]
ds_read_b64_tr_b16 a[106:107], v8 offset:4672
v_mfma_f32_16x16x32_bf16 v[152:155], a[112:115], a[200:203], v[152:155]
buffer_load_dwordx4 a[188:191], v20, s[20:23], s37 offen sc1
v_mfma_f32_16x16x32_bf16 v[156:159], a[112:115], a[204:207], v[156:159]
s_waitcnt lgkmcnt(6)
v_mfma_f32_16x16x32_bf16 v[160:163], a[116:119], a[192:195], v[160:163]
ds_read_b64_tr_b16 a[108:109], v8 offset:96
v_mfma_f32_16x16x32_bf16 v[164:167], a[116:119], a[196:199], v[164:167]
ds_read_b64_tr_b16 a[110:111], v8 offset:4704
v_mfma_f32_16x16x32_bf16 v[168:171], a[116:119], a[200:203], v[168:171]
v_mfma_f32_16x16x32_bf16 v[172:175], a[116:119], a[204:207], v[172:175]
s_waitcnt lgkmcnt(6)
v_mfma_f32_16x16x32_bf16 v[32:35], a[96:99], a[128:131], v[32:35]
ds_read_b64_tr_b16 a[112:113], v8 offset:128
v_mfma_f32_16x16x32_bf16 v[36:39], a[96:99], a[132:135], v[36:39]
ds_read_b64_tr_b16 a[114:115], v8 offset:4736
v_mfma_f32_16x16x32_bf16 v[40:43], a[96:99], a[136:139], v[40:43]
v_mfma_f32_16x16x32_bf16 v[44:47], a[96:99], a[140:143], v[44:47]
s_waitcnt lgkmcnt(6)
v_mfma_f32_16x16x32_bf16 v[48:51], a[100:103], a[128:131], v[48:51]
ds_read_b64_tr_b16 a[116:117], v8 offset:160
v_mfma_f32_16x16x32_bf16 v[52:55], a[100:103], a[132:135], v[52:55]
ds_read_b64_tr_b16 a[118:119], v8 offset:4768
v_mfma_f32_16x16x32_bf16 v[56:59], a[100:103], a[136:139], v[56:59]
v_mfma_f32_16x16x32_bf16 v[60:63], a[100:103], a[140:143], v[60:63]
s_waitcnt lgkmcnt(6)
v_mfma_f32_16x16x32_bf16 v[64:67], a[104:107], a[128:131], v[64:67]
ds_read_b64_tr_b16 a[96:97], v8 offset:192
v_mfma_f32_16x16x32_bf16 v[68:71], a[104:107], a[132:135], v[68:71]
ds_read_b64_tr_b16 a[98:99], v8 offset:4800
v_mfma_f32_16x16x32_bf16 v[72:75], a[104:107], a[136:139], v[72:75]
v_mfma_f32_16x16x32_bf16 v[76:79], a[104:107], a[140:143], v[76:79]
s_waitcnt lgkmcnt(6)
v_mfma_f32_16x16x32_bf16 v[80:83], a[108:111], a[128:131], v[80:83]
ds_read_b64_tr_b16 a[100:101], v8 offset:224
v_mfma_f32_16x16x32_bf16 v[84:87], a[108:111], a[132:135], v[84:87]
ds_read_b64_tr_b16 a[102:103], v8 offset:4832
v_mfma_f32_16x16x32_bf16 v[88:91], a[108:111], a[136:139], v[88:91]
v_mfma_f32_16x16x32_bf16 v[92:95], a[108:111], a[140:143], v[92:95]
s_waitcnt lgkmcnt(6)
v_mfma_f32_16x16x32_bf16 v[96:99], a[112:115], a[128:131], v[96:99]
ds_read_b64_tr_b16 a[104:105], v8 offset:256
v_mfma_f32_16x16x32_bf16 v[100:103], a[112:115], a[132:135], v[100:103]
ds_read_b64_tr_b16 a[106:107], v8 offset:4864
v_mfma_f32_16x16x32_bf16 v[104:107], a[112:115], a[136:139], v[104:107]
v_mfma_f32_16x16x32_bf16 v[108:111], a[112:115], a[140:143], v[108:111]
s_waitcnt lgkmcnt(6)
v_mfma_f32_16x16x32_bf16 v[112:115], a[116:119], a[128:131], v[112:115]
ds_read_b64_tr_b16 a[108:109], v8 offset:18432
v_mfma_f32_16x16x32_bf16 v[116:119], a[116:119], a[132:135], v[116:119]
ds_read_b64_tr_b16 a[110:111], v8 offset:23040
v_mfma_f32_16x16x32_bf16 v[120:123], a[116:119], a[136:139], v[120:123]
v_mfma_f32_16x16x32_bf16 v[124:127], a[116:119], a[140:143], v[124:127]
s_waitcnt lgkmcnt(6)
v_mfma_f32_16x16x32_bf16 v[128:131], a[96:99], a[128:131], v[128:131]
ds_read_b64_tr_b16 a[112:113], v8 offset:18464
v_mfma_f32_16x16x32_bf16 v[132:135], a[96:99], a[132:135], v[132:135]
ds_read_b64_tr_b16 a[114:115], v8 offset:23072
v_mfma_f32_16x16x32_bf16 v[136:139], a[96:99], a[136:139], v[136:139]
v_mfma_f32_16x16x32_bf16 v[140:143], a[96:99], a[140:143], v[140:143]
s_waitcnt lgkmcnt(6)
v_mfma_f32_16x16x32_bf16 v[144:147], a[100:103], a[128:131], v[144:147]
ds_read_b64_tr_b16 a[116:117], v8 offset:18496
v_mfma_f32_16x16x32_bf16 v[148:151], a[100:103], a[132:135], v[148:151]
ds_read_b64_tr_b16 a[118:119], v8 offset:23104
v_mfma_f32_16x16x32_bf16 v[152:155], a[100:103], a[136:139], v[152:155]
v_mfma_f32_16x16x32_bf16 v[156:159], a[100:103], a[140:143], v[156:159]
s_waitcnt lgkmcnt(6)
v_mfma_f32_16x16x32_bf16 v[160:163], a[104:107], a[128:131], v[160:163]
ds_read_b64_tr_b16 a[96:97], v8 offset:18528
v_mfma_f32_16x16x32_bf16 v[164:167], a[104:107], a[132:135], v[164:167]
ds_read_b64_tr_b16 a[98:99], v8 offset:23136
v_mfma_f32_16x16x32_bf16 v[168:171], a[104:107], a[136:139], v[168:171]
v_mfma_f32_16x16x32_bf16 v[172:175], a[104:107], a[140:143], v[172:175]
s_waitcnt vmcnt(18) lgkmcnt(6)
v_mfma_f32_16x16x32_bf16 v[32:35], a[108:111], a[144:147], v[32:35]
ds_read_b64_tr_b16 a[100:101], v8 offset:18560
v_mfma_f32_16x16x32_bf16 v[36:39], a[108:111], a[148:151], v[36:39]
ds_read_b64_tr_b16 a[102:103], v8 offset:23168
v_mfma_f32_16x16x32_bf16 v[40:43], a[108:111], a[152:155], v[40:43]
v_mfma_f32_16x16x32_bf16 v[44:47], a[108:111], a[156:159], v[44:47]
s_waitcnt lgkmcnt(6)
v_mfma_f32_16x16x32_bf16 v[48:51], a[112:115], a[144:147], v[48:51]
ds_read_b64_tr_b16 a[104:105], v8 offset:18592
v_mfma_f32_16x16x32_bf16 v[52:55], a[112:115], a[148:151], v[52:55]
ds_read_b64_tr_b16 a[106:107], v8 offset:23200
v_mfma_f32_16x16x32_bf16 v[56:59], a[112:115], a[152:155], v[56:59]
v_mfma_f32_16x16x32_bf16 v[60:63], a[112:115], a[156:159], v[60:63]
s_waitcnt lgkmcnt(6)
v_mfma_f32_16x16x32_bf16 v[64:67], a[116:119], a[144:147], v[64:67]
ds_read_b64_tr_b16 a[108:109], v8 offset:18624
v_mfma_f32_16x16x32_bf16 v[68:71], a[116:119], a[148:151], v[68:71]
ds_read_b64_tr_b16 a[110:111], v8 offset:23232
v_mfma_f32_16x16x32_bf16 v[72:75], a[116:119], a[152:155], v[72:75]
v_mfma_f32_16x16x32_bf16 v[76:79], a[116:119], a[156:159], v[76:79]
s_waitcnt lgkmcnt(6)
v_mfma_f32_16x16x32_bf16 v[80:83], a[96:99], a[144:147], v[80:83]
ds_read_b64_tr_b16 a[112:113], v8 offset:18656
v_mfma_f32_16x16x32_bf16 v[84:87], a[96:99], a[148:151], v[84:87]
ds_read_b64_tr_b16 a[114:115], v8 offset:23264
v_mfma_f32_16x16x32_bf16 v[88:91], a[96:99], a[152:155], v[88:91]
v_mfma_f32_16x16x32_bf16 v[92:95], a[96:99], a[156:159], v[92:95]
s_waitcnt lgkmcnt(6)
v_mfma_f32_16x16x32_bf16 v[96:99], a[100:103], a[144:147], v[96:99]
ds_read_b64_tr_b16 a[116:117], v8 offset:18688
v_mfma_f32_16x16x32_bf16 v[100:103], a[100:103], a[148:151], v[100:103]
ds_read_b64_tr_b16 a[118:119], v8 offset:23296
v_mfma_f32_16x16x32_bf16 v[104:107], a[100:103], a[152:155], v[104:107]
s_waitcnt vmcnt(4)
v_mfma_f32_16x16x32_bf16 v[108:111], a[100:103], a[156:159], v[108:111]
s_barrier
s_waitcnt lgkmcnt(6)
v_mfma_f32_16x16x32_bf16 v[112:115], a[104:107], a[144:147], v[112:115]
ds_read_b64_tr_b16 a[96:97], v6 offset:0
v_mfma_f32_16x16x32_bf16 v[116:119], a[104:107], a[148:151], v[116:119]
ds_read_b64_tr_b16 a[98:99], v6 offset:4608
v_mfma_f32_16x16x32_bf16 v[120:123], a[104:107], a[152:155], v[120:123]
v_mfma_f32_16x16x32_bf16 v[124:127], a[104:107], a[156:159], v[124:127]
s_waitcnt lgkmcnt(6)
v_mfma_f32_16x16x32_bf16 v[128:131], a[108:111], a[144:147], v[128:131]
ds_read_b64_tr_b16 a[100:101], v6 offset:32
v_mfma_f32_16x16x32_bf16 v[132:135], a[108:111], a[148:151], v[132:135]
ds_read_b64_tr_b16 a[102:103], v6 offset:4640
v_mfma_f32_16x16x32_bf16 v[136:139], a[108:111], a[152:155], v[136:139]
v_mfma_f32_16x16x32_bf16 v[140:143], a[108:111], a[156:159], v[140:143]
s_waitcnt lgkmcnt(6)
v_mfma_f32_16x16x32_bf16 v[144:147], a[112:115], a[144:147], v[144:147]
ds_read_b64_tr_b16 a[104:105], v6 offset:64
v_mfma_f32_16x16x32_bf16 v[148:151], a[112:115], a[148:151], v[148:151]
ds_read_b64_tr_b16 a[106:107], v6 offset:4672
v_mfma_f32_16x16x32_bf16 v[152:155], a[112:115], a[152:155], v[152:155]
v_mfma_f32_16x16x32_bf16 v[156:159], a[112:115], a[156:159], v[156:159]
s_waitcnt lgkmcnt(6)
v_mfma_f32_16x16x32_bf16 v[160:163], a[116:119], a[144:147], v[160:163]
ds_read_b64_tr_b16 a[108:109], v6 offset:96
v_mfma_f32_16x16x32_bf16 v[164:167], a[116:119], a[148:151], v[164:167]
ds_read_b64_tr_b16 a[110:111], v6 offset:4704
v_mfma_f32_16x16x32_bf16 v[168:171], a[116:119], a[152:155], v[168:171]
v_mfma_f32_16x16x32_bf16 v[172:175], a[116:119], a[156:159], v[172:175]
s_waitcnt lgkmcnt(6)
v_mfma_f32_16x16x32_bf16 v[32:35], a[96:99], a[160:163], v[32:35]
ds_read_b64_tr_b16 a[112:113], v6 offset:128
v_mfma_f32_16x16x32_bf16 v[36:39], a[96:99], a[164:167], v[36:39]
ds_read_b64_tr_b16 a[114:115], v6 offset:4736
v_mfma_f32_16x16x32_bf16 v[40:43], a[96:99], a[168:171], v[40:43]
v_mfma_f32_16x16x32_bf16 v[44:47], a[96:99], a[172:175], v[44:47]
s_waitcnt lgkmcnt(6)
v_mfma_f32_16x16x32_bf16 v[48:51], a[100:103], a[160:163], v[48:51]
ds_read_b64_tr_b16 a[116:117], v6 offset:160
v_mfma_f32_16x16x32_bf16 v[52:55], a[100:103], a[164:167], v[52:55]
ds_read_b64_tr_b16 a[118:119], v6 offset:4768
v_mfma_f32_16x16x32_bf16 v[56:59], a[100:103], a[168:171], v[56:59]
v_mfma_f32_16x16x32_bf16 v[60:63], a[100:103], a[172:175], v[60:63]
s_waitcnt lgkmcnt(6)
v_mfma_f32_16x16x32_bf16 v[64:67], a[104:107], a[160:163], v[64:67]
ds_read_b64_tr_b16 a[96:97], v6 offset:192
v_mfma_f32_16x16x32_bf16 v[68:71], a[104:107], a[164:167], v[68:71]
ds_read_b64_tr_b16 a[98:99], v6 offset:4800
v_mfma_f32_16x16x32_bf16 v[72:75], a[104:107], a[168:171], v[72:75]
v_mfma_f32_16x16x32_bf16 v[76:79], a[104:107], a[172:175], v[76:79]
s_waitcnt lgkmcnt(6)
v_mfma_f32_16x16x32_bf16 v[80:83], a[108:111], a[160:163], v[80:83]
ds_read_b64_tr_b16 a[100:101], v6 offset:224
v_mfma_f32_16x16x32_bf16 v[84:87], a[108:111], a[164:167], v[84:87]
ds_read_b64_tr_b16 a[102:103], v6 offset:4832
v_mfma_f32_16x16x32_bf16 v[88:91], a[108:111], a[168:171], v[88:91]
v_mfma_f32_16x16x32_bf16 v[92:95], a[108:111], a[172:175], v[92:95]
s_waitcnt lgkmcnt(6)
v_mfma_f32_16x16x32_bf16 v[96:99], a[112:115], a[160:163], v[96:99]
ds_read_b64_tr_b16 a[104:105], v6 offset:256
v_mfma_f32_16x16x32_bf16 v[100:103], a[112:115], a[164:167], v[100:103]
ds_read_b64_tr_b16 a[106:107], v6 offset:4864
v_mfma_f32_16x16x32_bf16 v[104:107], a[112:115], a[168:171], v[104:107]
v_mfma_f32_16x16x32_bf16 v[108:111], a[112:115], a[172:175], v[108:111]
s_waitcnt lgkmcnt(6)
v_mfma_f32_16x16x32_bf16 v[112:115], a[116:119], a[160:163], v[112:115]
ds_read_b64_tr_b16 a[108:109], v6 offset:18432
v_mfma_f32_16x16x32_bf16 v[116:119], a[116:119], a[164:167], v[116:119]
ds_read_b64_tr_b16 a[110:111], v6 offset:23040
v_mfma_f32_16x16x32_bf16 v[120:123], a[116:119], a[168:171], v[120:123]
v_mfma_f32_16x16x32_bf16 v[124:127], a[116:119], a[172:175], v[124:127]
s_waitcnt lgkmcnt(6)
v_mfma_f32_16x16x32_bf16 v[128:131], a[96:99], a[160:163], v[128:131]
ds_read_b64_tr_b16 a[112:113], v6 offset:18464
v_mfma_f32_16x16x32_bf16 v[132:135], a[96:99], a[164:167], v[132:135]
ds_read_b64_tr_b16 a[114:115], v6 offset:23072
v_mfma_f32_16x16x32_bf16 v[136:139], a[96:99], a[168:171], v[136:139]
v_mfma_f32_16x16x32_bf16 v[140:143], a[96:99], a[172:175], v[140:143]
s_waitcnt lgkmcnt(6)
v_mfma_f32_16x16x32_bf16 v[144:147], a[100:103], a[160:163], v[144:147]
ds_read_b64_tr_b16 a[116:117], v6 offset:18496
v_mfma_f32_16x16x32_bf16 v[148:151], a[100:103], a[164:167], v[148:151]
ds_read_b64_tr_b16 a[118:119], v6 offset:23104
v_mfma_f32_16x16x32_bf16 v[152:155], a[100:103], a[168:171], v[152:155]
v_mfma_f32_16x16x32_bf16 v[156:159], a[100:103], a[172:175], v[156:159]
s_waitcnt lgkmcnt(6)
v_mfma_f32_16x16x32_bf16 v[160:163], a[104:107], a[160:163], v[160:163]
ds_read_b64_tr_b16 a[96:97], v6 offset:18528
v_mfma_f32_16x16x32_bf16 v[164:167], a[104:107], a[164:167], v[164:167]
ds_read_b64_tr_b16 a[98:99], v6 offset:23136
v_mfma_f32_16x16x32_bf16 v[168:171], a[104:107], a[168:171], v[168:171]
v_mfma_f32_16x16x32_bf16 v[172:175], a[104:107], a[172:175], v[172:175]
s_waitcnt vmcnt(0) lgkmcnt(6)
v_mfma_f32_16x16x32_bf16 v[32:35], a[108:111], a[176:179], v[32:35]
ds_read_b64_tr_b16 a[100:101], v6 offset:18560
v_mfma_f32_16x16x32_bf16 v[36:39], a[108:111], a[180:183], v[36:39]
ds_read_b64_tr_b16 a[102:103], v6 offset:23168
v_mfma_f32_16x16x32_bf16 v[40:43], a[108:111], a[184:187], v[40:43]
v_mfma_f32_16x16x32_bf16 v[44:47], a[108:111], a[188:191], v[44:47]
s_waitcnt lgkmcnt(6)
v_mfma_f32_16x16x32_bf16 v[48:51], a[112:115], a[176:179], v[48:51]
ds_read_b64_tr_b16 a[104:105], v6 offset:18592
v_mfma_f32_16x16x32_bf16 v[52:55], a[112:115], a[180:183], v[52:55]
ds_read_b64_tr_b16 a[106:107], v6 offset:23200
v_mfma_f32_16x16x32_bf16 v[56:59], a[112:115], a[184:187], v[56:59]
v_mfma_f32_16x16x32_bf16 v[60:63], a[112:115], a[188:191], v[60:63]
s_waitcnt lgkmcnt(6)
v_mfma_f32_16x16x32_bf16 v[64:67], a[116:119], a[176:179], v[64:67]
ds_read_b64_tr_b16 a[108:109], v6 offset:18624
v_mfma_f32_16x16x32_bf16 v[68:71], a[116:119], a[180:183], v[68:71]
ds_read_b64_tr_b16 a[110:111], v6 offset:23232
v_mfma_f32_16x16x32_bf16 v[72:75], a[116:119], a[184:187], v[72:75]
v_mfma_f32_16x16x32_bf16 v[76:79], a[116:119], a[188:191], v[76:79]
s_waitcnt lgkmcnt(6)
v_mfma_f32_16x16x32_bf16 v[80:83], a[96:99], a[176:179], v[80:83]
ds_read_b64_tr_b16 a[112:113], v6 offset:18656
v_mfma_f32_16x16x32_bf16 v[84:87], a[96:99], a[180:183], v[84:87]
ds_read_b64_tr_b16 a[114:115], v6 offset:23264
v_mfma_f32_16x16x32_bf16 v[88:91], a[96:99], a[184:187], v[88:91]
v_mfma_f32_16x16x32_bf16 v[92:95], a[96:99], a[188:191], v[92:95]
s_waitcnt lgkmcnt(6)
v_mfma_f32_16x16x32_bf16 v[96:99], a[100:103], a[176:179], v[96:99]
ds_read_b64_tr_b16 a[116:117], v6 offset:18688
v_mfma_f32_16x16x32_bf16 v[100:103], a[100:103], a[180:183], v[100:103]
ds_read_b64_tr_b16 a[118:119], v6 offset:23296
v_mfma_f32_16x16x32_bf16 v[104:107], a[100:103], a[184:187], v[104:107]
v_mfma_f32_16x16x32_bf16 v[108:111], a[100:103], a[188:191], v[108:111]
s_waitcnt lgkmcnt(6)
v_mfma_f32_16x16x32_bf16 v[112:115], a[104:107], a[176:179], v[112:115]
v_mfma_f32_16x16x32_bf16 v[116:119], a[104:107], a[180:183], v[116:119]
v_mfma_f32_16x16x32_bf16 v[120:123], a[104:107], a[184:187], v[120:123]
v_mfma_f32_16x16x32_bf16 v[124:127], a[104:107], a[188:191], v[124:127]
s_waitcnt lgkmcnt(4)
v_mfma_f32_16x16x32_bf16 v[128:131], a[108:111], a[176:179], v[128:131]
v_mfma_f32_16x16x32_bf16 v[132:135], a[108:111], a[180:183], v[132:135]
v_mfma_f32_16x16x32_bf16 v[136:139], a[108:111], a[184:187], v[136:139]
v_mfma_f32_16x16x32_bf16 v[140:143], a[108:111], a[188:191], v[140:143]
s_waitcnt lgkmcnt(2)
v_mfma_f32_16x16x32_bf16 v[144:147], a[112:115], a[176:179], v[144:147]
v_mfma_f32_16x16x32_bf16 v[148:151], a[112:115], a[180:183], v[148:151]
v_mfma_f32_16x16x32_bf16 v[152:155], a[112:115], a[184:187], v[152:155]
v_mfma_f32_16x16x32_bf16 v[156:159], a[112:115], a[188:191], v[156:159]
s_waitcnt lgkmcnt(0)
v_mfma_f32_16x16x32_bf16 v[160:163], a[116:119], a[176:179], v[160:163]
v_mfma_f32_16x16x32_bf16 v[164:167], a[116:119], a[180:183], v[164:167]
v_mfma_f32_16x16x32_bf16 v[168:171], a[116:119], a[184:187], v[168:171]
v_mfma_f32_16x16x32_bf16 v[172:175], a[116:119], a[188:191], v[172:175]
s_and_b32 s3, s28, 1
s_lshl_b32 s3, s3, 1
s_lshr_b32 s4, s28, 1
s_add_u32 s44, s3, s4
s_lshl_b32 s98, s60, 2
s_add_u32 s98, s98, s61
s_lshl_b32 s3, s98, 2
s_add_u32 s3, s3, s59
s_lshl_b32 s3, s3, 2
s_add_u32 s3, s3, s44
s_mul_i32 s3, s3, 9216
s_add_u32 s45, s3, 88080384
s_waitcnt lgkmcnt(0)
s_barrier
s_cmp_ge_u32 s28, 2
s_cbranch_scc1 parallel_sum__compressed_kv_cla__geglu_ffn__prompt_kernel_r1
s_mul_i32 s3, s28, 18432
v_add_u32 v22, s3, v21
s_xor_b32 s4, s28, 2
s_mul_i32 s3, s4, 18432
v_add_u32 v23, s3, v21
ds_write_b128 v22, v[40:43] offset:0
ds_write_b128 v22, v[56:59] offset:1024
ds_write_b128 v22, v[72:75] offset:2048
ds_write_b128 v22, v[88:91] offset:3072
ds_write_b128 v22, v[104:107] offset:4096
ds_write_b128 v22, v[120:123] offset:5120
ds_write_b128 v22, v[136:139] offset:6144
ds_write_b128 v22, v[152:155] offset:7168
ds_write_b128 v22, v[168:171] offset:8192
ds_write_b128 v22, v[44:47] offset:9216
ds_write_b128 v22, v[60:63] offset:10240
ds_write_b128 v22, v[76:79] offset:11264
ds_write_b128 v22, v[92:95] offset:12288
ds_write_b128 v22, v[108:111] offset:13312
ds_write_b128 v22, v[124:127] offset:14336
ds_write_b128 v22, v[140:143] offset:15360
ds_write_b128 v22, v[156:159] offset:16384
ds_write_b128 v22, v[172:175] offset:17408
s_waitcnt lgkmcnt(0)
s_barrier
ds_read_b128 v[40:43], v23 offset:0
ds_read_b128 v[56:59], v23 offset:1024
ds_read_b128 v[72:75], v23 offset:2048
ds_read_b128 v[88:91], v23 offset:3072
ds_read_b128 v[104:107], v23 offset:4096
ds_read_b128 v[120:123], v23 offset:5120
ds_read_b128 v[136:139], v23 offset:6144
ds_read_b128 v[152:155], v23 offset:7168
ds_read_b128 v[168:171], v23 offset:8192
ds_read_b128 v[44:47], v23 offset:9216
ds_read_b128 v[60:63], v23 offset:10240
ds_read_b128 v[76:79], v23 offset:11264
ds_read_b128 v[92:95], v23 offset:12288
ds_read_b128 v[108:111], v23 offset:13312
ds_read_b128 v[124:127], v23 offset:14336
ds_read_b128 v[140:143], v23 offset:15360
ds_read_b128 v[156:159], v23 offset:16384
ds_read_b128 v[172:175], v23 offset:17408
s_cmp_eq_u32 s44, s59
s_cbranch_scc1 parallel_sum__compressed_kv_cla__geglu_ffn__prompt_kernel_own0
s_waitcnt lgkmcnt(15)
v_add_f32 v32, v32, v40
v_add_f32 v33, v33, v41
v_add_f32 v34, v34, v42
v_add_f32 v35, v35, v43
v_add_f32 v48, v48, v56
v_add_f32 v49, v49, v57
v_add_f32 v50, v50, v58
v_add_f32 v51, v51, v59
v_cvt_pk_bf16_f32 v32, v32, v33
v_cvt_pk_bf16_f32 v33, v34, v35
v_cvt_pk_bf16_f32 v34, v48, v49
v_cvt_pk_bf16_f32 v35, v50, v51
s_add_u32 s36, s45, 0
buffer_store_dwordx4 v[32:35], v21, s[20:23], s36 offen offset:0 sc1
v_add_f32 v64, v64, v72
v_add_f32 v65, v65, v73
v_add_f32 v66, v66, v74
v_add_f32 v67, v67, v75
s_waitcnt lgkmcnt(14)
v_add_f32 v80, v80, v88
v_add_f32 v81, v81, v89
v_add_f32 v82, v82, v90
v_add_f32 v83, v83, v91
v_cvt_pk_bf16_f32 v64, v64, v65
v_cvt_pk_bf16_f32 v65, v66, v67
v_cvt_pk_bf16_f32 v66, v80, v81
v_cvt_pk_bf16_f32 v67, v82, v83
buffer_store_dwordx4 v[64:67], v21, s[20:23], s36 offen offset:1024 sc1
s_waitcnt lgkmcnt(13)
v_add_f32 v96, v96, v104
v_add_f32 v97, v97, v105
v_add_f32 v98, v98, v106
v_add_f32 v99, v99, v107
s_waitcnt lgkmcnt(12)
v_add_f32 v112, v112, v120
v_add_f32 v113, v113, v121
v_add_f32 v114, v114, v122
v_add_f32 v115, v115, v123
v_cvt_pk_bf16_f32 v96, v96, v97
v_cvt_pk_bf16_f32 v97, v98, v99
v_cvt_pk_bf16_f32 v98, v112, v113
v_cvt_pk_bf16_f32 v99, v114, v115
buffer_store_dwordx4 v[96:99], v21, s[20:23], s36 offen offset:2048 sc1
s_waitcnt lgkmcnt(11)
v_add_f32 v128, v128, v136
v_add_f32 v129, v129, v137
v_add_f32 v130, v130, v138
v_add_f32 v131, v131, v139
s_waitcnt lgkmcnt(10)
v_add_f32 v144, v144, v152
v_add_f32 v145, v145, v153
v_add_f32 v146, v146, v154
v_add_f32 v147, v147, v155
v_cvt_pk_bf16_f32 v128, v128, v129
v_cvt_pk_bf16_f32 v129, v130, v131
v_cvt_pk_bf16_f32 v130, v144, v145
v_cvt_pk_bf16_f32 v131, v146, v147
buffer_store_dwordx4 v[128:131], v21, s[20:23], s36 offen offset:3072 sc1
s_waitcnt lgkmcnt(9)
v_add_f32 v160, v160, v168
v_add_f32 v161, v161, v169
v_add_f32 v162, v162, v170
v_add_f32 v163, v163, v171
s_waitcnt lgkmcnt(8)
v_add_f32 v36, v36, v44
v_add_f32 v37, v37, v45
v_add_f32 v38, v38, v46
v_add_f32 v39, v39, v47
v_cvt_pk_bf16_f32 v160, v160, v161
v_cvt_pk_bf16_f32 v161, v162, v163
v_cvt_pk_bf16_f32 v162, v36, v37
v_cvt_pk_bf16_f32 v163, v38, v39
s_add_u32 s36, s45, 4096
buffer_store_dwordx4 v[160:163], v21, s[20:23], s36 offen offset:0 sc1
s_waitcnt lgkmcnt(7)
v_add_f32 v52, v52, v60
v_add_f32 v53, v53, v61
v_add_f32 v54, v54, v62
v_add_f32 v55, v55, v63
s_waitcnt lgkmcnt(6)
v_add_f32 v68, v68, v76
v_add_f32 v69, v69, v77
v_add_f32 v70, v70, v78
v_add_f32 v71, v71, v79
v_cvt_pk_bf16_f32 v52, v52, v53
v_cvt_pk_bf16_f32 v53, v54, v55
v_cvt_pk_bf16_f32 v54, v68, v69
v_cvt_pk_bf16_f32 v55, v70, v71
buffer_store_dwordx4 v[52:55], v21, s[20:23], s36 offen offset:1024 sc1
s_waitcnt lgkmcnt(5)
v_add_f32 v84, v84, v92
v_add_f32 v85, v85, v93
v_add_f32 v86, v86, v94
v_add_f32 v87, v87, v95
s_waitcnt lgkmcnt(4)
v_add_f32 v100, v100, v108
v_add_f32 v101, v101, v109
v_add_f32 v102, v102, v110
v_add_f32 v103, v103, v111
v_cvt_pk_bf16_f32 v84, v84, v85
v_cvt_pk_bf16_f32 v85, v86, v87
v_cvt_pk_bf16_f32 v86, v100, v101
v_cvt_pk_bf16_f32 v87, v102, v103
buffer_store_dwordx4 v[84:87], v21, s[20:23], s36 offen offset:2048 sc1
s_waitcnt lgkmcnt(3)
v_add_f32 v116, v116, v124
v_add_f32 v117, v117, v125
v_add_f32 v118, v118, v126
v_add_f32 v119, v119, v127
s_waitcnt lgkmcnt(2)
v_add_f32 v132, v132, v140
v_add_f32 v133, v133, v141
v_add_f32 v134, v134, v142
v_add_f32 v135, v135, v143
v_cvt_pk_bf16_f32 v116, v116, v117
v_cvt_pk_bf16_f32 v117, v118, v119
v_cvt_pk_bf16_f32 v118, v132, v133
v_cvt_pk_bf16_f32 v119, v134, v135
buffer_store_dwordx4 v[116:119], v21, s[20:23], s36 offen offset:3072 sc1
s_waitcnt lgkmcnt(1)
v_add_f32 v148, v148, v156
v_add_f32 v149, v149, v157
v_add_f32 v150, v150, v158
v_add_f32 v151, v151, v159
s_waitcnt lgkmcnt(0)
v_add_f32 v164, v164, v172
v_add_f32 v165, v165, v173
v_add_f32 v166, v166, v174
v_add_f32 v167, v167, v175
v_cvt_pk_bf16_f32 v148, v148, v149
v_cvt_pk_bf16_f32 v149, v150, v151
v_cvt_pk_bf16_f32 v150, v164, v165
v_cvt_pk_bf16_f32 v151, v166, v167
s_add_u32 s36, s45, 8192
buffer_store_dwordx4 v[148:151], v21, s[20:23], s36 offen offset:0 sc1
s_branch parallel_sum__compressed_kv_cla__geglu_ffn__prompt_kernel_sent
parallel_sum__compressed_kv_cla__geglu_ffn__prompt_kernel_own0:
v_add_u32 v22, 73728, v21
s_waitcnt lgkmcnt(15)
v_add_f32 v32, v32, v40
v_add_f32 v33, v33, v41
v_add_f32 v34, v34, v42
v_add_f32 v35, v35, v43
ds_write_b128 v22, v[32:35] offset:0
v_add_f32 v48, v48, v56
v_add_f32 v49, v49, v57
v_add_f32 v50, v50, v58
v_add_f32 v51, v51, v59
ds_write_b128 v22, v[48:51] offset:1024
v_add_f32 v64, v64, v72
v_add_f32 v65, v65, v73
v_add_f32 v66, v66, v74
v_add_f32 v67, v67, v75
ds_write_b128 v22, v[64:67] offset:2048
s_waitcnt lgkmcnt(15)
v_add_f32 v80, v80, v88
v_add_f32 v81, v81, v89
v_add_f32 v82, v82, v90
v_add_f32 v83, v83, v91
ds_write_b128 v22, v[80:83] offset:3072
v_add_f32 v96, v96, v104
v_add_f32 v97, v97, v105
v_add_f32 v98, v98, v106
v_add_f32 v99, v99, v107
ds_write_b128 v22, v[96:99] offset:4096
v_add_f32 v112, v112, v120
v_add_f32 v113, v113, v121
v_add_f32 v114, v114, v122
v_add_f32 v115, v115, v123
ds_write_b128 v22, v[112:115] offset:5120
s_waitcnt lgkmcnt(15)
v_add_f32 v128, v128, v136
v_add_f32 v129, v129, v137
v_add_f32 v130, v130, v138
v_add_f32 v131, v131, v139
ds_write_b128 v22, v[128:131] offset:6144
v_add_f32 v144, v144, v152
v_add_f32 v145, v145, v153
v_add_f32 v146, v146, v154
v_add_f32 v147, v147, v155
ds_write_b128 v22, v[144:147] offset:7168
v_add_f32 v160, v160, v168
v_add_f32 v161, v161, v169
v_add_f32 v162, v162, v170
v_add_f32 v163, v163, v171
ds_write_b128 v22, v[160:163] offset:8192
s_waitcnt lgkmcnt(15)
v_add_f32 v36, v36, v44
v_add_f32 v37, v37, v45
v_add_f32 v38, v38, v46
v_add_f32 v39, v39, v47
ds_write_b128 v22, v[36:39] offset:9216
v_add_f32 v52, v52, v60
v_add_f32 v53, v53, v61
v_add_f32 v54, v54, v62
v_add_f32 v55, v55, v63
ds_write_b128 v22, v[52:55] offset:10240
v_add_f32 v68, v68, v76
v_add_f32 v69, v69, v77
v_add_f32 v70, v70, v78
v_add_f32 v71, v71, v79
ds_write_b128 v22, v[68:71] offset:11264
s_waitcnt lgkmcnt(15)
v_add_f32 v84, v84, v92
v_add_f32 v85, v85, v93
v_add_f32 v86, v86, v94
v_add_f32 v87, v87, v95
ds_write_b128 v22, v[84:87] offset:12288
v_add_f32 v100, v100, v108
v_add_f32 v101, v101, v109
v_add_f32 v102, v102, v110
v_add_f32 v103, v103, v111
ds_write_b128 v22, v[100:103] offset:13312
v_add_f32 v116, v116, v124
v_add_f32 v117, v117, v125
v_add_f32 v118, v118, v126
v_add_f32 v119, v119, v127
ds_write_b128 v22, v[116:119] offset:14336
s_waitcnt lgkmcnt(15)
v_add_f32 v132, v132, v140
v_add_f32 v133, v133, v141
v_add_f32 v134, v134, v142
v_add_f32 v135, v135, v143
ds_write_b128 v22, v[132:135] offset:15360
v_add_f32 v148, v148, v156
v_add_f32 v149, v149, v157
v_add_f32 v150, v150, v158
v_add_f32 v151, v151, v159
ds_write_b128 v22, v[148:151] offset:16384
v_add_f32 v164, v164, v172
v_add_f32 v165, v165, v173
v_add_f32 v166, v166, v174
v_add_f32 v167, v167, v175
ds_write_b128 v22, v[164:167] offset:17408
s_branch parallel_sum__compressed_kv_cla__geglu_ffn__prompt_kernel_sent
parallel_sum__compressed_kv_cla__geglu_ffn__prompt_kernel_r1:
s_mul_i32 s3, s28, 18432
v_add_u32 v22, s3, v21
s_xor_b32 s4, s28, 2
s_mul_i32 s3, s4, 18432
v_add_u32 v23, s3, v21
ds_write_b128 v22, v[32:35] offset:0
ds_write_b128 v22, v[48:51] offset:1024
ds_write_b128 v22, v[64:67] offset:2048
ds_write_b128 v22, v[80:83] offset:3072
ds_write_b128 v22, v[96:99] offset:4096
ds_write_b128 v22, v[112:115] offset:5120
ds_write_b128 v22, v[128:131] offset:6144
ds_write_b128 v22, v[144:147] offset:7168
ds_write_b128 v22, v[160:163] offset:8192
ds_write_b128 v22, v[36:39] offset:9216
ds_write_b128 v22, v[52:55] offset:10240
ds_write_b128 v22, v[68:71] offset:11264
ds_write_b128 v22, v[84:87] offset:12288
ds_write_b128 v22, v[100:103] offset:13312
ds_write_b128 v22, v[116:119] offset:14336
ds_write_b128 v22, v[132:135] offset:15360
ds_write_b128 v22, v[148:151] offset:16384
ds_write_b128 v22, v[164:167] offset:17408
s_waitcnt lgkmcnt(0)
s_barrier
ds_read_b128 v[32:35], v23 offset:0
ds_read_b128 v[48:51], v23 offset:1024
ds_read_b128 v[64:67], v23 offset:2048
ds_read_b128 v[80:83], v23 offset:3072
ds_read_b128 v[96:99], v23 offset:4096
ds_read_b128 v[112:115], v23 offset:5120
ds_read_b128 v[128:131], v23 offset:6144
ds_read_b128 v[144:147], v23 offset:7168
ds_read_b128 v[160:163], v23 offset:8192
ds_read_b128 v[36:39], v23 offset:9216
ds_read_b128 v[52:55], v23 offset:10240
ds_read_b128 v[68:71], v23 offset:11264
ds_read_b128 v[84:87], v23 offset:12288
ds_read_b128 v[100:103], v23 offset:13312
ds_read_b128 v[116:119], v23 offset:14336
ds_read_b128 v[132:135], v23 offset:15360
ds_read_b128 v[148:151], v23 offset:16384
ds_read_b128 v[164:167], v23 offset:17408
s_cmp_eq_u32 s44, s59
s_cbranch_scc1 parallel_sum__compressed_kv_cla__geglu_ffn__prompt_kernel_own1
s_waitcnt lgkmcnt(15)
v_add_f32 v40, v40, v32
v_add_f32 v41, v41, v33
v_add_f32 v42, v42, v34
v_add_f32 v43, v43, v35
v_add_f32 v56, v56, v48
v_add_f32 v57, v57, v49
v_add_f32 v58, v58, v50
v_add_f32 v59, v59, v51
v_cvt_pk_bf16_f32 v40, v40, v41
v_cvt_pk_bf16_f32 v41, v42, v43
v_cvt_pk_bf16_f32 v42, v56, v57
v_cvt_pk_bf16_f32 v43, v58, v59
s_add_u32 s36, s45, 0
buffer_store_dwordx4 v[40:43], v21, s[20:23], s36 offen offset:0 sc1
v_add_f32 v72, v72, v64
v_add_f32 v73, v73, v65
v_add_f32 v74, v74, v66
v_add_f32 v75, v75, v67
s_waitcnt lgkmcnt(14)
v_add_f32 v88, v88, v80
v_add_f32 v89, v89, v81
v_add_f32 v90, v90, v82
v_add_f32 v91, v91, v83
v_cvt_pk_bf16_f32 v72, v72, v73
v_cvt_pk_bf16_f32 v73, v74, v75
v_cvt_pk_bf16_f32 v74, v88, v89
v_cvt_pk_bf16_f32 v75, v90, v91
buffer_store_dwordx4 v[72:75], v21, s[20:23], s36 offen offset:1024 sc1
s_waitcnt lgkmcnt(13)
v_add_f32 v104, v104, v96
v_add_f32 v105, v105, v97
v_add_f32 v106, v106, v98
v_add_f32 v107, v107, v99
s_waitcnt lgkmcnt(12)
v_add_f32 v120, v120, v112
v_add_f32 v121, v121, v113
v_add_f32 v122, v122, v114
v_add_f32 v123, v123, v115
v_cvt_pk_bf16_f32 v104, v104, v105
v_cvt_pk_bf16_f32 v105, v106, v107
v_cvt_pk_bf16_f32 v106, v120, v121
v_cvt_pk_bf16_f32 v107, v122, v123
buffer_store_dwordx4 v[104:107], v21, s[20:23], s36 offen offset:2048 sc1
s_waitcnt lgkmcnt(11)
v_add_f32 v136, v136, v128
v_add_f32 v137, v137, v129
v_add_f32 v138, v138, v130
v_add_f32 v139, v139, v131
s_waitcnt lgkmcnt(10)
v_add_f32 v152, v152, v144
v_add_f32 v153, v153, v145
v_add_f32 v154, v154, v146
v_add_f32 v155, v155, v147
v_cvt_pk_bf16_f32 v136, v136, v137
v_cvt_pk_bf16_f32 v137, v138, v139
v_cvt_pk_bf16_f32 v138, v152, v153
v_cvt_pk_bf16_f32 v139, v154, v155
buffer_store_dwordx4 v[136:139], v21, s[20:23], s36 offen offset:3072 sc1
s_waitcnt lgkmcnt(9)
v_add_f32 v168, v168, v160
v_add_f32 v169, v169, v161
v_add_f32 v170, v170, v162
v_add_f32 v171, v171, v163
s_waitcnt lgkmcnt(8)
v_add_f32 v44, v44, v36
v_add_f32 v45, v45, v37
v_add_f32 v46, v46, v38
v_add_f32 v47, v47, v39
v_cvt_pk_bf16_f32 v168, v168, v169
v_cvt_pk_bf16_f32 v169, v170, v171
v_cvt_pk_bf16_f32 v170, v44, v45
v_cvt_pk_bf16_f32 v171, v46, v47
s_add_u32 s36, s45, 4096
buffer_store_dwordx4 v[168:171], v21, s[20:23], s36 offen offset:0 sc1
s_waitcnt lgkmcnt(7)
v_add_f32 v60, v60, v52
v_add_f32 v61, v61, v53
v_add_f32 v62, v62, v54
v_add_f32 v63, v63, v55
s_waitcnt lgkmcnt(6)
v_add_f32 v76, v76, v68
v_add_f32 v77, v77, v69
v_add_f32 v78, v78, v70
v_add_f32 v79, v79, v71
v_cvt_pk_bf16_f32 v60, v60, v61
v_cvt_pk_bf16_f32 v61, v62, v63
v_cvt_pk_bf16_f32 v62, v76, v77
v_cvt_pk_bf16_f32 v63, v78, v79
buffer_store_dwordx4 v[60:63], v21, s[20:23], s36 offen offset:1024 sc1
s_waitcnt lgkmcnt(5)
v_add_f32 v92, v92, v84
v_add_f32 v93, v93, v85
v_add_f32 v94, v94, v86
v_add_f32 v95, v95, v87
s_waitcnt lgkmcnt(4)
v_add_f32 v108, v108, v100
v_add_f32 v109, v109, v101
v_add_f32 v110, v110, v102
v_add_f32 v111, v111, v103
v_cvt_pk_bf16_f32 v92, v92, v93
v_cvt_pk_bf16_f32 v93, v94, v95
v_cvt_pk_bf16_f32 v94, v108, v109
v_cvt_pk_bf16_f32 v95, v110, v111
buffer_store_dwordx4 v[92:95], v21, s[20:23], s36 offen offset:2048 sc1
s_waitcnt lgkmcnt(3)
v_add_f32 v124, v124, v116
v_add_f32 v125, v125, v117
v_add_f32 v126, v126, v118
v_add_f32 v127, v127, v119
s_waitcnt lgkmcnt(2)
v_add_f32 v140, v140, v132
v_add_f32 v141, v141, v133
v_add_f32 v142, v142, v134
v_add_f32 v143, v143, v135
v_cvt_pk_bf16_f32 v124, v124, v125
v_cvt_pk_bf16_f32 v125, v126, v127
v_cvt_pk_bf16_f32 v126, v140, v141
v_cvt_pk_bf16_f32 v127, v142, v143
buffer_store_dwordx4 v[124:127], v21, s[20:23], s36 offen offset:3072 sc1
s_waitcnt lgkmcnt(1)
v_add_f32 v156, v156, v148
v_add_f32 v157, v157, v149
v_add_f32 v158, v158, v150
v_add_f32 v159, v159, v151
s_waitcnt lgkmcnt(0)
v_add_f32 v172, v172, v164
v_add_f32 v173, v173, v165
v_add_f32 v174, v174, v166
v_add_f32 v175, v175, v167
v_cvt_pk_bf16_f32 v156, v156, v157
v_cvt_pk_bf16_f32 v157, v158, v159
v_cvt_pk_bf16_f32 v158, v172, v173
v_cvt_pk_bf16_f32 v159, v174, v175
s_add_u32 s36, s45, 8192
buffer_store_dwordx4 v[156:159], v21, s[20:23], s36 offen offset:0 sc1
s_branch parallel_sum__compressed_kv_cla__geglu_ffn__prompt_kernel_sent
parallel_sum__compressed_kv_cla__geglu_ffn__prompt_kernel_own1:
v_add_u32 v22, 73728, v21
s_waitcnt lgkmcnt(15)
v_add_f32 v40, v40, v32
v_add_f32 v41, v41, v33
v_add_f32 v42, v42, v34
v_add_f32 v43, v43, v35
ds_write_b128 v22, v[40:43] offset:0
v_add_f32 v56, v56, v48
v_add_f32 v57, v57, v49
v_add_f32 v58, v58, v50
v_add_f32 v59, v59, v51
ds_write_b128 v22, v[56:59] offset:1024
v_add_f32 v72, v72, v64
v_add_f32 v73, v73, v65
v_add_f32 v74, v74, v66
v_add_f32 v75, v75, v67
ds_write_b128 v22, v[72:75] offset:2048
s_waitcnt lgkmcnt(15)
v_add_f32 v88, v88, v80
v_add_f32 v89, v89, v81
v_add_f32 v90, v90, v82
v_add_f32 v91, v91, v83
ds_write_b128 v22, v[88:91] offset:3072
v_add_f32 v104, v104, v96
v_add_f32 v105, v105, v97
v_add_f32 v106, v106, v98
v_add_f32 v107, v107, v99
ds_write_b128 v22, v[104:107] offset:4096
v_add_f32 v120, v120, v112
v_add_f32 v121, v121, v113
v_add_f32 v122, v122, v114
v_add_f32 v123, v123, v115
ds_write_b128 v22, v[120:123] offset:5120
s_waitcnt lgkmcnt(15)
v_add_f32 v136, v136, v128
v_add_f32 v137, v137, v129
v_add_f32 v138, v138, v130
v_add_f32 v139, v139, v131
ds_write_b128 v22, v[136:139] offset:6144
v_add_f32 v152, v152, v144
v_add_f32 v153, v153, v145
v_add_f32 v154, v154, v146
v_add_f32 v155, v155, v147
ds_write_b128 v22, v[152:155] offset:7168
v_add_f32 v168, v168, v160
v_add_f32 v169, v169, v161
v_add_f32 v170, v170, v162
v_add_f32 v171, v171, v163
ds_write_b128 v22, v[168:171] offset:8192
s_waitcnt lgkmcnt(15)
v_add_f32 v44, v44, v36
v_add_f32 v45, v45, v37
v_add_f32 v46, v46, v38
v_add_f32 v47, v47, v39
ds_write_b128 v22, v[44:47] offset:9216
v_add_f32 v60, v60, v52
v_add_f32 v61, v61, v53
v_add_f32 v62, v62, v54
v_add_f32 v63, v63, v55
ds_write_b128 v22, v[60:63] offset:10240
v_add_f32 v76, v76, v68
v_add_f32 v77, v77, v69
v_add_f32 v78, v78, v70
v_add_f32 v79, v79, v71
ds_write_b128 v22, v[76:79] offset:11264
s_waitcnt lgkmcnt(15)
v_add_f32 v92, v92, v84
v_add_f32 v93, v93, v85
v_add_f32 v94, v94, v86
v_add_f32 v95, v95, v87
ds_write_b128 v22, v[92:95] offset:12288
v_add_f32 v108, v108, v100
v_add_f32 v109, v109, v101
v_add_f32 v110, v110, v102
v_add_f32 v111, v111, v103
ds_write_b128 v22, v[108:111] offset:13312
v_add_f32 v124, v124, v116
v_add_f32 v125, v125, v117
v_add_f32 v126, v126, v118
v_add_f32 v127, v127, v119
ds_write_b128 v22, v[124:127] offset:14336
s_waitcnt lgkmcnt(15)
v_add_f32 v140, v140, v132
v_add_f32 v141, v141, v133
v_add_f32 v142, v142, v134
v_add_f32 v143, v143, v135
ds_write_b128 v22, v[140:143] offset:15360
v_add_f32 v156, v156, v148
v_add_f32 v157, v157, v149
v_add_f32 v158, v158, v150
v_add_f32 v159, v159, v151
ds_write_b128 v22, v[156:159] offset:16384
v_add_f32 v172, v172, v164
v_add_f32 v173, v173, v165
v_add_f32 v174, v174, v166
v_add_f32 v175, v175, v167
ds_write_b128 v22, v[172:175] offset:17408
parallel_sum__compressed_kv_cla__geglu_ffn__prompt_kernel_sent:
s_waitcnt vmcnt(0) lgkmcnt(0)
s_barrier
s_lshl_b32 s68, s100, 7
s_mov_b32 s69, s59
s_lshl_b32 s69, s69, 2
s_add_u32 s68, s68, s69
s_add_u32 s68, s68, 113254400
s_cmp_eq_u32 s28, 0
s_cselect_b32 s68, s68, 0x10000000
v_mov_b32 v26, 1
s_mov_b64 exec, 1
buffer_store_dword v26, off, s[20:23], s68 sc1
s_mov_b64 exec, -1
s_nop 1
s_mov_b32 s24, s72
s_mov_b32 s25, s73
s_mov_b32 s26, 2359296
s_mov_b32 s27, 0x20000
s_mov_b32 s16, s90
s_mov_b32 s17, s91
s_mov_b32 s18, 2359296
s_mov_b32 s19, 0x20000
s_lshl_b32 s31, s28, 1
s_add_u32 s31, s31, 1
s_cmp_eq_u32 s28, 0
s_cselect_b32 s31, 0, s31
s_lshl_b32 s33, s60, 7
s_lshl_b32 s35, s59, 5
s_add_u32 s33, s33, s35
s_mul_i32 s34, s61, 144
s_add_u32 s3, s59, 1
s_and_b32 s3, s3, 3
s_lshl_b32 s4, s98, 2
s_add_u32 s3, s3, s4
s_lshl_b32 s3, s3, 2
s_add_u32 s3, s3, s59
s_mul_i32 s3, s3, 9216
s_add_u32 s46, s3, 88080384
s_add_u32 s3, s59, 2
s_and_b32 s3, s3, 3
s_lshl_b32 s4, s98, 2
s_add_u32 s3, s3, s4
s_lshl_b32 s3, s3, 2
s_add_u32 s3, s3, s59
s_mul_i32 s3, s3, 9216
s_add_u32 s47, s3, 88080384
s_add_u32 s3, s59, 3
s_and_b32 s3, s3, 3
s_lshl_b32 s4, s98, 2
s_add_u32 s3, s3, s4
s_lshl_b32 s3, s3, 2
s_add_u32 s3, s3, s59
s_mul_i32 s3, s3, 9216
s_add_u32 s48, s3, 88080384
v_lshlrev_b32 v1, 4, v0
v_and_b32 v2, 15, v0
v_mul_u32_u24 v2, 1152, v2
v_lshrrev_b32 v3, 4, v0
v_lshl_add_u32 v2, v3, 3, v2
s_lshl_b32 s7, s31, 11
v_add_u32 v3, s7, v1
v_add_u32 v3, 73728, v3
s_add_u32 s36, s31, 0
s_lshl_b32 s37, s36, 1
s_add_u32 s37, s37, 0
s_cmp_ge_u32 s37, 9
s_cselect_b32 s38, 1, 0
s_mul_i32 s39, s38, 9
s_sub_u32 s39, s37, s39
s_lshl_b32 s38, s38, 4
s_add_u32 s38, s38, s33
s_mul_i32 s38, s38, 1152
s_lshl_b32 s39, s39, 4
s_add_u32 s39, s39, s34
s_lshl_b32 s39, s39, 1
s_add_u32 s50, s38, s39
buffer_load_dwordx2 v[20:21], v2, s[24:27], s50 offen
ds_read_b128 v[24:27], v3 offset:0
s_lshl_b32 s37, s36, 1
s_add_u32 s37, s37, 1
s_cmp_ge_u32 s37, 9
s_cselect_b32 s38, 1, 0
s_mul_i32 s39, s38, 9
s_sub_u32 s39, s37, s39
s_lshl_b32 s38, s38, 4
s_add_u32 s38, s38, s33
s_mul_i32 s38, s38, 1152
s_lshl_b32 s39, s39, 4
s_add_u32 s39, s39, s34
s_lshl_b32 s39, s39, 1
s_add_u32 s51, s38, s39
buffer_load_dwordx2 v[22:23], v2, s[24:27], s51 offen
ds_read_b128 v[28:31], v3 offset:1024
s_add_u32 s36, s31, 1
s_lshl_b32 s37, s36, 1
s_add_u32 s37, s37, 0
s_cmp_ge_u32 s37, 9
s_cselect_b32 s38, 1, 0
s_mul_i32 s39, s38, 9
s_sub_u32 s39, s37, s39
s_lshl_b32 s38, s38, 4
s_add_u32 s38, s38, s33
s_mul_i32 s38, s38, 1152
s_lshl_b32 s39, s39, 4
s_add_u32 s39, s39, s34
s_lshl_b32 s39, s39, 1
s_add_u32 s52, s38, s39
buffer_load_dwordx2 v[52:53], v2, s[24:27], s52 offen
ds_read_b128 v[56:59], v3 offset:2048
s_lshl_b32 s37, s36, 1
s_add_u32 s37, s37, 1
s_cmp_ge_u32 s37, 9
s_cselect_b32 s38, 1, 0
s_mul_i32 s39, s38, 9
s_sub_u32 s39, s37, s39
s_lshl_b32 s38, s38, 4
s_add_u32 s38, s38, s33
s_mul_i32 s38, s38, 1152
s_lshl_b32 s39, s39, 4
s_add_u32 s39, s39, s34
s_lshl_b32 s39, s39, 1
s_add_u32 s53, s38, s39
buffer_load_dwordx2 v[54:55], v2, s[24:27], s53 offen
ds_read_b128 v[60:63], v3 offset:3072
s_add_u32 s36, s31, 2
s_lshl_b32 s37, s36, 1
s_add_u32 s37, s37, 0
s_cmp_ge_u32 s37, 9
s_cselect_b32 s38, 1, 0
s_mul_i32 s39, s38, 9
s_sub_u32 s39, s37, s39
s_lshl_b32 s38, s38, 4
s_add_u32 s38, s38, s33
s_mul_i32 s38, s38, 1152
s_lshl_b32 s39, s39, 4
s_add_u32 s39, s39, s34
s_lshl_b32 s39, s39, 1
s_add_u32 s54, s38, s39
s_cmp_eq_u32 s28, 0
s_cselect_b32 s54, s54, 0x10000000
buffer_load_dwordx2 v[84:85], v2, s[24:27], s54 offen
ds_read_b128 v[88:91], v3 offset:4096
s_lshl_b32 s37, s36, 1
s_add_u32 s37, s37, 1
s_cmp_ge_u32 s37, 9
s_cselect_b32 s38, 1, 0
s_mul_i32 s39, s38, 9
s_sub_u32 s39, s37, s39
s_lshl_b32 s38, s38, 4
s_add_u32 s38, s38, s33
s_mul_i32 s38, s38, 1152
s_lshl_b32 s39, s39, 4
s_add_u32 s39, s39, s34
s_lshl_b32 s39, s39, 1
s_add_u32 s55, s38, s39
s_cmp_eq_u32 s28, 0
s_cselect_b32 s55, s55, 0x10000000
buffer_load_dwordx2 v[86:87], v2, s[24:27], s55 offen
ds_read_b128 v[92:95], v3 offset:5120
s_lshl_b32 s68, s100, 7
s_add_u32 s68, s68, 113254400
v_and_b32 v110, 3, v0
v_lshlrev_b32 v110, 2, v110
buffer_load_dword v110, v110, s[20:23], s68 offen sc1
s_waitcnt vmcnt(0)
v_cmp_eq_u32 vcc, 0, v110
s_nop 4
s_cbranch_vccnz parallel_sum__compressed_kv_cla__geglu_ffn__prompt_kernel_spin10
parallel_sum__compressed_kv_cla__geglu_ffn__prompt_kernel_spin10_ret:
s_add_u32 s36, s31, 0
s_lshl_b32 s37, s36, 10
s_add_u32 s38, s37, s46
buffer_load_dwordx4 v[8:11], v1, s[20:23], s38 offen sc1
s_add_u32 s38, s37, s47
buffer_load_dwordx4 v[12:15], v1, s[20:23], s38 offen sc1
s_add_u32 s38, s37, s48
buffer_load_dwordx4 v[16:19], v1, s[20:23], s38 offen sc1
s_add_u32 s36, s31, 1
s_lshl_b32 s37, s36, 10
s_add_u32 s38, s37, s46
buffer_load_dwordx4 v[40:43], v1, s[20:23], s38 offen sc1
s_add_u32 s38, s37, s47
buffer_load_dwordx4 v[44:47], v1, s[20:23], s38 offen sc1
s_add_u32 s38, s37, s48
buffer_load_dwordx4 v[48:51], v1, s[20:23], s38 offen sc1
s_add_u32 s36, s31, 2
s_lshl_b32 s37, s36, 10
s_add_u32 s38, s37, s46
s_cmp_eq_u32 s28, 0
s_cselect_b32 s38, s38, 0x10000000
buffer_load_dwordx4 v[72:75], v1, s[20:23], s38 offen sc1
s_add_u32 s38, s37, s47
s_cmp_eq_u32 s28, 0
s_cselect_b32 s38, s38, 0x10000000
buffer_load_dwordx4 v[76:79], v1, s[20:23], s38 offen sc1
s_add_u32 s38, s37, s48
s_cmp_eq_u32 s28, 0
s_cselect_b32 s38, s38, 0x10000000
buffer_load_dwordx4 v[80:83], v1, s[20:23], s38 offen sc1
s_waitcnt vmcnt(6) lgkmcnt(4)
v_lshlrev_b32 v4, 16, v8
v_and_b32 v5, 0xffff0000, v8
v_lshlrev_b32 v6, 16, v9
v_and_b32 v7, 0xffff0000, v9
v_add_f32 v24, v24, v4
v_add_f32 v25, v25, v5
v_add_f32 v26, v26, v6
v_add_f32 v27, v27, v7
v_lshlrev_b32 v4, 16, v12
v_and_b32 v5, 0xffff0000, v12
v_lshlrev_b32 v6, 16, v13
v_and_b32 v7, 0xffff0000, v13
v_add_f32 v24, v24, v4
v_add_f32 v25, v25, v5
v_add_f32 v26, v26, v6
v_add_f32 v27, v27, v7
v_lshlrev_b32 v4, 16, v16
v_and_b32 v5, 0xffff0000, v16
v_lshlrev_b32 v6, 16, v17
v_and_b32 v7, 0xffff0000, v17
v_add_f32 v24, v24, v4
v_add_f32 v25, v25, v5
v_add_f32 v26, v26, v6
v_add_f32 v27, v27, v7
v_lshlrev_b32 v4, 16, v20
v_and_b32 v5, 0xffff0000, v20
v_lshlrev_b32 v6, 16, v21
v_and_b32 v7, 0xffff0000, v21
v_add_f32 v24, v24, v4
v_add_f32 v25, v25, v5
v_add_f32 v26, v26, v6
v_add_f32 v27, v27, v7
v_cvt_pk_bf16_f32 v24, v24, v25
v_cvt_pk_bf16_f32 v25, v26, v27
buffer_store_dwordx2 v[24:25], v2, s[16:19], s50 offen
v_lshlrev_b32 v4, 16, v10
v_and_b32 v5, 0xffff0000, v10
v_lshlrev_b32 v6, 16, v11
v_and_b32 v7, 0xffff0000, v11
v_add_f32 v28, v28, v4
v_add_f32 v29, v29, v5
v_add_f32 v30, v30, v6
v_add_f32 v31, v31, v7
v_lshlrev_b32 v4, 16, v14
v_and_b32 v5, 0xffff0000, v14
v_lshlrev_b32 v6, 16, v15
v_and_b32 v7, 0xffff0000, v15
v_add_f32 v28, v28, v4
v_add_f32 v29, v29, v5
v_add_f32 v30, v30, v6
v_add_f32 v31, v31, v7
v_lshlrev_b32 v4, 16, v18
v_and_b32 v5, 0xffff0000, v18
v_lshlrev_b32 v6, 16, v19
v_and_b32 v7, 0xffff0000, v19
v_add_f32 v28, v28, v4
v_add_f32 v29, v29, v5
v_add_f32 v30, v30, v6
v_add_f32 v31, v31, v7
v_lshlrev_b32 v4, 16, v22
v_and_b32 v5, 0xffff0000, v22
v_lshlrev_b32 v6, 16, v23
v_and_b32 v7, 0xffff0000, v23
v_add_f32 v28, v28, v4
v_add_f32 v29, v29, v5
v_add_f32 v30, v30, v6
v_add_f32 v31, v31, v7
v_cvt_pk_bf16_f32 v28, v28, v29
v_cvt_pk_bf16_f32 v29, v30, v31
buffer_store_dwordx2 v[28:29], v2, s[16:19], s51 offen
s_waitcnt vmcnt(5) lgkmcnt(2)
v_lshlrev_b32 v4, 16, v40
v_and_b32 v5, 0xffff0000, v40
v_lshlrev_b32 v6, 16, v41
v_and_b32 v7, 0xffff0000, v41
v_add_f32 v56, v56, v4
v_add_f32 v57, v57, v5
v_add_f32 v58, v58, v6
v_add_f32 v59, v59, v7
v_lshlrev_b32 v4, 16, v44
v_and_b32 v5, 0xffff0000, v44
v_lshlrev_b32 v6, 16, v45
v_and_b32 v7, 0xffff0000, v45
v_add_f32 v56, v56, v4
v_add_f32 v57, v57, v5
v_add_f32 v58, v58, v6
v_add_f32 v59, v59, v7
v_lshlrev_b32 v4, 16, v48
v_and_b32 v5, 0xffff0000, v48
v_lshlrev_b32 v6, 16, v49
v_and_b32 v7, 0xffff0000, v49
v_add_f32 v56, v56, v4
v_add_f32 v57, v57, v5
v_add_f32 v58, v58, v6
v_add_f32 v59, v59, v7
v_lshlrev_b32 v4, 16, v52
v_and_b32 v5, 0xffff0000, v52
v_lshlrev_b32 v6, 16, v53
v_and_b32 v7, 0xffff0000, v53
v_add_f32 v56, v56, v4
v_add_f32 v57, v57, v5
v_add_f32 v58, v58, v6
v_add_f32 v59, v59, v7
v_cvt_pk_bf16_f32 v56, v56, v57
v_cvt_pk_bf16_f32 v57, v58, v59
buffer_store_dwordx2 v[56:57], v2, s[16:19], s52 offen
v_lshlrev_b32 v4, 16, v42
v_and_b32 v5, 0xffff0000, v42
v_lshlrev_b32 v6, 16, v43
v_and_b32 v7, 0xffff0000, v43
v_add_f32 v60, v60, v4
v_add_f32 v61, v61, v5
v_add_f32 v62, v62, v6
v_add_f32 v63, v63, v7
v_lshlrev_b32 v4, 16, v46
v_and_b32 v5, 0xffff0000, v46
v_lshlrev_b32 v6, 16, v47
v_and_b32 v7, 0xffff0000, v47
v_add_f32 v60, v60, v4
v_add_f32 v61, v61, v5
v_add_f32 v62, v62, v6
v_add_f32 v63, v63, v7
v_lshlrev_b32 v4, 16, v50
v_and_b32 v5, 0xffff0000, v50
v_lshlrev_b32 v6, 16, v51
v_and_b32 v7, 0xffff0000, v51
v_add_f32 v60, v60, v4
v_add_f32 v61, v61, v5
v_add_f32 v62, v62, v6
v_add_f32 v63, v63, v7
v_lshlrev_b32 v4, 16, v54
v_and_b32 v5, 0xffff0000, v54
v_lshlrev_b32 v6, 16, v55
v_and_b32 v7, 0xffff0000, v55
v_add_f32 v60, v60, v4
v_add_f32 v61, v61, v5
v_add_f32 v62, v62, v6
v_add_f32 v63, v63, v7
v_cvt_pk_bf16_f32 v60, v60, v61
v_cvt_pk_bf16_f32 v61, v62, v63
buffer_store_dwordx2 v[60:61], v2, s[16:19], s53 offen
s_cmp_lg_u32 s28, 0
s_cbranch_scc1 parallel_sum__compressed_kv_cla__geglu_ffn__prompt_kernel_fin
s_waitcnt vmcnt(4) lgkmcnt(0)
v_lshlrev_b32 v4, 16, v72
v_and_b32 v5, 0xffff0000, v72
v_lshlrev_b32 v6, 16, v73
v_and_b32 v7, 0xffff0000, v73
v_add_f32 v88, v88, v4
v_add_f32 v89, v89, v5
v_add_f32 v90, v90, v6
v_add_f32 v91, v91, v7
v_lshlrev_b32 v4, 16, v76
v_and_b32 v5, 0xffff0000, v76
v_lshlrev_b32 v6, 16, v77
v_and_b32 v7, 0xffff0000, v77
v_add_f32 v88, v88, v4
v_add_f32 v89, v89, v5
v_add_f32 v90, v90, v6
v_add_f32 v91, v91, v7
v_lshlrev_b32 v4, 16, v80
v_and_b32 v5, 0xffff0000, v80
v_lshlrev_b32 v6, 16, v81
v_and_b32 v7, 0xffff0000, v81
v_add_f32 v88, v88, v4
v_add_f32 v89, v89, v5
v_add_f32 v90, v90, v6
v_add_f32 v91, v91, v7
v_lshlrev_b32 v4, 16, v84
v_and_b32 v5, 0xffff0000, v84
v_lshlrev_b32 v6, 16, v85
v_and_b32 v7, 0xffff0000, v85
v_add_f32 v88, v88, v4
v_add_f32 v89, v89, v5
v_add_f32 v90, v90, v6
v_add_f32 v91, v91, v7
v_cvt_pk_bf16_f32 v88, v88, v89
v_cvt_pk_bf16_f32 v89, v90, v91
buffer_store_dwordx2 v[88:89], v2, s[16:19], s54 offen
v_lshlrev_b32 v4, 16, v74
v_and_b32 v5, 0xffff0000, v74
v_lshlrev_b32 v6, 16, v75
v_and_b32 v7, 0xffff0000, v75
v_add_f32 v92, v92, v4
v_add_f32 v93, v93, v5
v_add_f32 v94, v94, v6
v_add_f32 v95, v95, v7
v_lshlrev_b32 v4, 16, v78
v_and_b32 v5, 0xffff0000, v78
v_lshlrev_b32 v6, 16, v79
v_and_b32 v7, 0xffff0000, v79
v_add_f32 v92, v92, v4
v_add_f32 v93, v93, v5
v_add_f32 v94, v94, v6
v_add_f32 v95, v95, v7
v_lshlrev_b32 v4, 16, v82
v_and_b32 v5, 0xffff0000, v82
v_lshlrev_b32 v6, 16, v83
v_and_b32 v7, 0xffff0000, v83
v_add_f32 v92, v92, v4
v_add_f32 v93, v93, v5
v_add_f32 v94, v94, v6
v_add_f32 v95, v95, v7
v_lshlrev_b32 v4, 16, v86
v_and_b32 v5, 0xffff0000, v86
v_lshlrev_b32 v6, 16, v87
v_and_b32 v7, 0xffff0000, v87
v_add_f32 v92, v92, v4
v_add_f32 v93, v93, v5
v_add_f32 v94, v94, v6
v_add_f32 v95, v95, v7
v_cvt_pk_bf16_f32 v92, v92, v93
v_cvt_pk_bf16_f32 v93, v94, v95
buffer_store_dwordx2 v[92:93], v2, s[16:19], s55 offen
parallel_sum__compressed_kv_cla__geglu_ffn__prompt_kernel_fin:
s_endpgm
parallel_sum__compressed_kv_cla__geglu_ffn__prompt_kernel_mask_pro:
s_nop 7
v_sub_u32 v130, s52, v122
v_cmp_gt_i32 s[40:41], 0, v130
v_cmp_gt_i32 s[42:43], 1, v130
v_cmp_gt_i32 s[44:45], 2, v130
v_cmp_gt_i32 s[46:47], 3, v130
v_cndmask_b32 v32, v32, v126, s[40:41]
v_cndmask_b32 v33, v33, v126, s[42:43]
v_cndmask_b32 v34, v34, v126, s[44:45]
v_cndmask_b32 v35, v35, v126, s[46:47]
v_cmp_gt_i32 s[40:41], 8, v130
v_cmp_gt_i32 s[42:43], 9, v130
v_cmp_gt_i32 s[44:45], 10, v130
v_cmp_gt_i32 s[46:47], 11, v130
v_cndmask_b32 v36, v36, v126, s[40:41]
v_cndmask_b32 v37, v37, v126, s[42:43]
v_cndmask_b32 v38, v38, v126, s[44:45]
v_cndmask_b32 v39, v39, v126, s[46:47]
v_cmp_gt_i32 s[40:41], 16, v130
v_cmp_gt_i32 s[42:43], 17, v130
v_cmp_gt_i32 s[44:45], 18, v130
v_cmp_gt_i32 s[46:47], 19, v130
v_cndmask_b32 v40, v40, v126, s[40:41]
v_cndmask_b32 v41, v41, v126, s[42:43]
v_cndmask_b32 v42, v42, v126, s[44:45]
v_cndmask_b32 v43, v43, v126, s[46:47]
v_cmp_gt_i32 s[40:41], 24, v130
v_cmp_gt_i32 s[42:43], 25, v130
v_cmp_gt_i32 s[44:45], 26, v130
v_cmp_gt_i32 s[46:47], 27, v130
v_cndmask_b32 v44, v44, v126, s[40:41]
v_cndmask_b32 v45, v45, v126, s[42:43]
v_cndmask_b32 v46, v46, v126, s[44:45]
v_cndmask_b32 v47, v47, v126, s[46:47]
s_branch parallel_sum__compressed_kv_cla__geglu_ffn__prompt_kernel_mask_pro_ret
parallel_sum__compressed_kv_cla__geglu_ffn__prompt_kernel_mask_p0b:
s_nop 7
v_sub_u32 v130, s52, v122
v_cmp_gt_i32 s[40:41], 0, v130
v_cmp_gt_i32 s[42:43], 1, v130
v_cmp_gt_i32 s[44:45], 2, v130
v_cmp_gt_i32 s[46:47], 3, v130
v_cndmask_b32 v32, v32, v126, s[40:41]
v_cndmask_b32 v33, v33, v126, s[42:43]
v_cndmask_b32 v34, v34, v126, s[44:45]
v_cndmask_b32 v35, v35, v126, s[46:47]
v_cmp_gt_i32 s[40:41], 8, v130
v_cmp_gt_i32 s[42:43], 9, v130
v_cmp_gt_i32 s[44:45], 10, v130
v_cmp_gt_i32 s[46:47], 11, v130
v_cndmask_b32 v36, v36, v126, s[40:41]
v_cndmask_b32 v37, v37, v126, s[42:43]
v_cndmask_b32 v38, v38, v126, s[44:45]
v_cndmask_b32 v39, v39, v126, s[46:47]
v_cmp_gt_i32 s[40:41], 16, v130
v_cmp_gt_i32 s[42:43], 17, v130
v_cmp_gt_i32 s[44:45], 18, v130
v_cmp_gt_i32 s[46:47], 19, v130
v_cndmask_b32 v40, v40, v126, s[40:41]
v_cndmask_b32 v41, v41, v126, s[42:43]
v_cndmask_b32 v42, v42, v126, s[44:45]
v_cndmask_b32 v43, v43, v126, s[46:47]
v_cmp_gt_i32 s[40:41], 24, v130
v_cmp_gt_i32 s[42:43], 25, v130
v_cmp_gt_i32 s[44:45], 26, v130
v_cmp_gt_i32 s[46:47], 27, v130
v_cndmask_b32 v44, v44, v126, s[40:41]
v_cndmask_b32 v45, v45, v126, s[42:43]
v_cndmask_b32 v46, v46, v126, s[44:45]
v_cndmask_b32 v47, v47, v126, s[46:47]
s_branch parallel_sum__compressed_kv_cla__geglu_ffn__prompt_kernel_mask_p0b_ret
parallel_sum__compressed_kv_cla__geglu_ffn__prompt_kernel_mask_p1b:
s_nop 7
v_sub_u32 v130, s52, v122
v_cmp_gt_i32 s[40:41], 0, v130
v_cmp_gt_i32 s[42:43], 1, v130
v_cmp_gt_i32 s[44:45], 2, v130
v_cmp_gt_i32 s[46:47], 3, v130
v_cndmask_b32 v32, v32, v126, s[40:41]
v_cndmask_b32 v33, v33, v126, s[42:43]
v_cndmask_b32 v34, v34, v126, s[44:45]
v_cndmask_b32 v35, v35, v126, s[46:47]
v_cmp_gt_i32 s[40:41], 8, v130
v_cmp_gt_i32 s[42:43], 9, v130
v_cmp_gt_i32 s[44:45], 10, v130
v_cmp_gt_i32 s[46:47], 11, v130
v_cndmask_b32 v36, v36, v126, s[40:41]
v_cndmask_b32 v37, v37, v126, s[42:43]
v_cndmask_b32 v38, v38, v126, s[44:45]
v_cndmask_b32 v39, v39, v126, s[46:47]
v_cmp_gt_i32 s[40:41], 16, v130
v_cmp_gt_i32 s[42:43], 17, v130
v_cmp_gt_i32 s[44:45], 18, v130
v_cmp_gt_i32 s[46:47], 19, v130
v_cndmask_b32 v40, v40, v126, s[40:41]
v_cndmask_b32 v41, v41, v126, s[42:43]
v_cndmask_b32 v42, v42, v126, s[44:45]
v_cndmask_b32 v43, v43, v126, s[46:47]
v_cmp_gt_i32 s[40:41], 24, v130
v_cmp_gt_i32 s[42:43], 25, v130
v_cmp_gt_i32 s[44:45], 26, v130
v_cmp_gt_i32 s[46:47], 27, v130
v_cndmask_b32 v44, v44, v126, s[40:41]
v_cndmask_b32 v45, v45, v126, s[42:43]
v_cndmask_b32 v46, v46, v126, s[44:45]
v_cndmask_b32 v47, v47, v126, s[46:47]
s_branch parallel_sum__compressed_kv_cla__geglu_ffn__prompt_kernel_mask_p1b_ret
parallel_sum__compressed_kv_cla__geglu_ffn__prompt_kernel_mask_p1lb:
s_nop 7
v_sub_u32 v130, s53, v122
v_cmp_gt_i32 s[40:41], 0, v130
v_cmp_gt_i32 s[42:43], 1, v130
v_cmp_gt_i32 s[44:45], 2, v130
v_cmp_gt_i32 s[46:47], 3, v130
v_cndmask_b32 v32, v32, v126, s[40:41]
v_cndmask_b32 v33, v33, v126, s[42:43]
v_cndmask_b32 v34, v34, v126, s[44:45]
v_cndmask_b32 v35, v35, v126, s[46:47]
v_cmp_gt_i32 s[40:41], 8, v130
v_cmp_gt_i32 s[42:43], 9, v130
v_cmp_gt_i32 s[44:45], 10, v130
v_cmp_gt_i32 s[46:47], 11, v130
v_cndmask_b32 v36, v36, v126, s[40:41]
v_cndmask_b32 v37, v37, v126, s[42:43]
v_cndmask_b32 v38, v38, v126, s[44:45]
v_cndmask_b32 v39, v39, v126, s[46:47]
v_cmp_gt_i32 s[40:41], 16, v130
v_cmp_gt_i32 s[42:43], 17, v130
v_cmp_gt_i32 s[44:45], 18, v130
v_cmp_gt_i32 s[46:47], 19, v130
v_cndmask_b32 v40, v40, v126, s[40:41]
v_cndmask_b32 v41, v41, v126, s[42:43]
v_cndmask_b32 v42, v42, v126, s[44:45]
v_cndmask_b32 v43, v43, v126, s[46:47]
v_cmp_gt_i32 s[40:41], 24, v130
v_cmp_gt_i32 s[42:43], 25, v130
v_cmp_gt_i32 s[44:45], 26, v130
v_cmp_gt_i32 s[46:47], 27, v130
v_cndmask_b32 v44, v44, v126, s[40:41]
v_cndmask_b32 v45, v45, v126, s[42:43]
v_cndmask_b32 v46, v46, v126, s[44:45]
v_cndmask_b32 v47, v47, v126, s[46:47]
s_branch parallel_sum__compressed_kv_cla__geglu_ffn__prompt_kernel_mask_p1lb_ret
parallel_sum__compressed_kv_cla__geglu_ffn__prompt_kernel_mask_p2a:
s_nop 7
v_sub_u32 v130, s53, v122
v_cmp_gt_i32 s[40:41], 0, v130
v_cmp_gt_i32 s[42:43], 1, v130
v_cmp_gt_i32 s[44:45], 2, v130
v_cmp_gt_i32 s[46:47], 3, v130
v_cndmask_b32 v48, v48, v126, s[40:41]
v_cndmask_b32 v49, v49, v126, s[42:43]
v_cndmask_b32 v50, v50, v126, s[44:45]
v_cndmask_b32 v51, v51, v126, s[46:47]
v_cmp_gt_i32 s[40:41], 8, v130
v_cmp_gt_i32 s[42:43], 9, v130
v_cmp_gt_i32 s[44:45], 10, v130
v_cmp_gt_i32 s[46:47], 11, v130
v_cndmask_b32 v52, v52, v126, s[40:41]
v_cndmask_b32 v53, v53, v126, s[42:43]
v_cndmask_b32 v54, v54, v126, s[44:45]
v_cndmask_b32 v55, v55, v126, s[46:47]
v_cmp_gt_i32 s[40:41], 16, v130
v_cmp_gt_i32 s[42:43], 17, v130
v_cmp_gt_i32 s[44:45], 18, v130
v_cmp_gt_i32 s[46:47], 19, v130
v_cndmask_b32 v56, v56, v126, s[40:41]
v_cndmask_b32 v57, v57, v126, s[42:43]
v_cndmask_b32 v58, v58, v126, s[44:45]
v_cndmask_b32 v59, v59, v126, s[46:47]
v_cmp_gt_i32 s[40:41], 24, v130
v_cmp_gt_i32 s[42:43], 25, v130
v_cmp_gt_i32 s[44:45], 26, v130
v_cmp_gt_i32 s[46:47], 27, v130
v_cndmask_b32 v60, v60, v126, s[40:41]
v_cndmask_b32 v61, v61, v126, s[42:43]
v_cndmask_b32 v62, v62, v126, s[44:45]
v_cndmask_b32 v63, v63, v126, s[46:47]
s_branch parallel_sum__compressed_kv_cla__geglu_ffn__prompt_kernel_mask_p2a_ret
parallel_sum__compressed_kv_cla__geglu_ffn__prompt_kernel_mask_p2b:
s_nop 7
v_sub_u32 v130, s53, v122
v_cmp_gt_i32 s[40:41], 0, v130
v_cmp_gt_i32 s[42:43], 1, v130
v_cmp_gt_i32 s[44:45], 2, v130
v_cmp_gt_i32 s[46:47], 3, v130
v_cndmask_b32 v32, v32, v126, s[40:41]
v_cndmask_b32 v33, v33, v126, s[42:43]
v_cndmask_b32 v34, v34, v126, s[44:45]
v_cndmask_b32 v35, v35, v126, s[46:47]
v_cmp_gt_i32 s[40:41], 8, v130
v_cmp_gt_i32 s[42:43], 9, v130
v_cmp_gt_i32 s[44:45], 10, v130
v_cmp_gt_i32 s[46:47], 11, v130
v_cndmask_b32 v36, v36, v126, s[40:41]
v_cndmask_b32 v37, v37, v126, s[42:43]
v_cndmask_b32 v38, v38, v126, s[44:45]
v_cndmask_b32 v39, v39, v126, s[46:47]
v_cmp_gt_i32 s[40:41], 16, v130
v_cmp_gt_i32 s[42:43], 17, v130
v_cmp_gt_i32 s[44:45], 18, v130
v_cmp_gt_i32 s[46:47], 19, v130
v_cndmask_b32 v40, v40, v126, s[40:41]
v_cndmask_b32 v41, v41, v126, s[42:43]
v_cndmask_b32 v42, v42, v126, s[44:45]
v_cndmask_b32 v43, v43, v126, s[46:47]
v_cmp_gt_i32 s[40:41], 24, v130
v_cmp_gt_i32 s[42:43], 25, v130
v_cmp_gt_i32 s[44:45], 26, v130
v_cmp_gt_i32 s[46:47], 27, v130
v_cndmask_b32 v44, v44, v126, s[40:41]
v_cndmask_b32 v45, v45, v126, s[42:43]
v_cndmask_b32 v46, v46, v126, s[44:45]
v_cndmask_b32 v47, v47, v126, s[46:47]
s_branch parallel_sum__compressed_kv_cla__geglu_ffn__prompt_kernel_mask_p2b_ret
parallel_sum__compressed_kv_cla__geglu_ffn__prompt_kernel_mask_p2la:
s_nop 7
v_sub_u32 v130, s53, v122
v_cmp_gt_i32 s[40:41], 0, v130
v_cmp_gt_i32 s[42:43], 1, v130
v_cmp_gt_i32 s[44:45], 2, v130
v_cmp_gt_i32 s[46:47], 3, v130
v_cndmask_b32 v48, v48, v126, s[40:41]
v_cndmask_b32 v49, v49, v126, s[42:43]
v_cndmask_b32 v50, v50, v126, s[44:45]
v_cndmask_b32 v51, v51, v126, s[46:47]
v_cmp_gt_i32 s[40:41], 8, v130
v_cmp_gt_i32 s[42:43], 9, v130
v_cmp_gt_i32 s[44:45], 10, v130
v_cmp_gt_i32 s[46:47], 11, v130
v_cndmask_b32 v52, v52, v126, s[40:41]
v_cndmask_b32 v53, v53, v126, s[42:43]
v_cndmask_b32 v54, v54, v126, s[44:45]
v_cndmask_b32 v55, v55, v126, s[46:47]
v_cmp_gt_i32 s[40:41], 16, v130
v_cmp_gt_i32 s[42:43], 17, v130
v_cmp_gt_i32 s[44:45], 18, v130
v_cmp_gt_i32 s[46:47], 19, v130
v_cndmask_b32 v56, v56, v126, s[40:41]
v_cndmask_b32 v57, v57, v126, s[42:43]
v_cndmask_b32 v58, v58, v126, s[44:45]
v_cndmask_b32 v59, v59, v126, s[46:47]
v_cmp_gt_i32 s[40:41], 24, v130
v_cmp_gt_i32 s[42:43], 25, v130
v_cmp_gt_i32 s[44:45], 26, v130
v_cmp_gt_i32 s[46:47], 27, v130
v_cndmask_b32 v60, v60, v126, s[40:41]
v_cndmask_b32 v61, v61, v126, s[42:43]
v_cndmask_b32 v62, v62, v126, s[44:45]
v_cndmask_b32 v63, v63, v126, s[46:47]
s_branch parallel_sum__compressed_kv_cla__geglu_ffn__prompt_kernel_mask_p2la_ret
parallel_sum__compressed_kv_cla__geglu_ffn__prompt_kernel_site_p0a_call:
s_mov_b32 s55, 0
s_branch parallel_sum__compressed_kv_cla__geglu_ffn__prompt_kernel_rare_0_0_0_0
parallel_sum__compressed_kv_cla__geglu_ffn__prompt_kernel_site_p1a_call:
s_mov_b32 s55, 1
s_branch parallel_sum__compressed_kv_cla__geglu_ffn__prompt_kernel_rare_0_0_0_0
parallel_sum__compressed_kv_cla__geglu_ffn__prompt_kernel_site_p1la_call:
s_mov_b32 s55, 2
parallel_sum__compressed_kv_cla__geglu_ffn__prompt_kernel_rare_0_0_0_0:
s_nop 15
s_nop 7
v_max3_f32 v125, v32, v33, v34
v_max3_f32 v125, v125, v35, v36
v_max3_f32 v125, v125, v37, v38
v_max3_f32 v125, v125, v39, v40
v_max3_f32 v125, v125, v41, v42
v_max3_f32 v125, v125, v43, v44
v_max3_f32 v125, v125, v45, v46
v_max_f32 v125, v125, v47
v_mov_b32 v130, v125
v_mov_b32 v131, v125
s_nop 1
v_permlane32_swap_b32 v130, v131
s_nop 1
v_max_f32 v130, v130, v131
v_max_f32 v130, 0, v130
v_ceil_f32 v130, v130
v_sub_f32 v32, v32, v130
v_sub_f32 v33, v33, v130
v_sub_f32 v34, v34, v130
v_sub_f32 v35, v35, v130
v_sub_f32 v36, v36, v130
v_sub_f32 v37, v37, v130
v_sub_f32 v38, v38, v130
v_sub_f32 v39, v39, v130
v_sub_f32 v40, v40, v130
v_sub_f32 v41, v41, v130
v_sub_f32 v42, v42, v130
v_sub_f32 v43, v43, v130
v_sub_f32 v44, v44, v130
v_sub_f32 v45, v45, v130
v_sub_f32 v46, v46, v130
v_sub_f32 v47, v47, v130
v_sub_f32 v80, v80, v130
v_sub_f32 v81, v81, v130
v_sub_f32 v82, v82, v130
v_sub_f32 v83, v83, v130
v_sub_f32 v84, v84, v130
v_sub_f32 v85, v85, v130
v_sub_f32 v86, v86, v130
v_sub_f32 v87, v87, v130
v_sub_f32 v88, v88, v130
v_sub_f32 v89, v89, v130
v_sub_f32 v90, v90, v130
v_sub_f32 v91, v91, v130
v_sub_f32 v92, v92, v130
v_sub_f32 v93, v93, v130
v_sub_f32 v94, v94, v130
v_sub_f32 v95, v95, v130
v_exp_f32 v131, -v130
s_nop 0
v_mul_f32 v123, v123, v131
v_accvgpr_read_b32 v132, a0
v_mul_f32 v132, v132, v131
v_accvgpr_write_b32 a0, v132
v_accvgpr_read_b32 v133, a1
v_mul_f32 v133, v133, v131
v_accvgpr_write_b32 a1, v133
v_accvgpr_read_b32 v134, a2
v_mul_f32 v134, v134, v131
v_accvgpr_write_b32 a2, v134
v_accvgpr_read_b32 v135, a3
v_mul_f32 v135, v135, v131
v_accvgpr_write_b32 a3, v135
v_accvgpr_read_b32 v132, a4
v_mul_f32 v132, v132, v131
v_accvgpr_write_b32 a4, v132
v_accvgpr_read_b32 v133, a5
v_mul_f32 v133, v133, v131
v_accvgpr_write_b32 a5, v133
v_accvgpr_read_b32 v134, a6
v_mul_f32 v134, v134, v131
v_accvgpr_write_b32 a6, v134
v_accvgpr_read_b32 v135, a7
v_mul_f32 v135, v135, v131
v_accvgpr_write_b32 a7, v135
v_accvgpr_read_b32 v132, a8
v_mul_f32 v132, v132, v131
v_accvgpr_write_b32 a8, v132
v_accvgpr_read_b32 v133, a9
v_mul_f32 v133, v133, v131
v_accvgpr_write_b32 a9, v133
v_accvgpr_read_b32 v134, a10
v_mul_f32 v134, v134, v131
v_accvgpr_write_b32 a10, v134
v_accvgpr_read_b32 v135, a11
v_mul_f32 v135, v135, v131
v_accvgpr_write_b32 a11, v135
v_accvgpr_read_b32 v132, a12
v_mul_f32 v132, v132, v131
v_accvgpr_write_b32 a12, v132
v_accvgpr_read_b32 v133, a13
v_mul_f32 v133, v133, v131
v_accvgpr_write_b32 a13, v133
v_accvgpr_read_b32 v134, a14
v_mul_f32 v134, v134, v131
v_accvgpr_write_b32 a14, v134
v_accvgpr_read_b32 v135, a15
v_mul_f32 v135, v135, v131
v_accvgpr_write_b32 a15, v135
v_accvgpr_read_b32 v132, a16
v_mul_f32 v132, v132, v131
v_accvgpr_write_b32 a16, v132
v_accvgpr_read_b32 v133, a17
v_mul_f32 v133, v133, v131
v_accvgpr_write_b32 a17, v133
v_accvgpr_read_b32 v134, a18
v_mul_f32 v134, v134, v131
v_accvgpr_write_b32 a18, v134
v_accvgpr_read_b32 v135, a19
v_mul_f32 v135, v135, v131
v_accvgpr_write_b32 a19, v135
v_accvgpr_read_b32 v132, a20
v_mul_f32 v132, v132, v131
v_accvgpr_write_b32 a20, v132
v_accvgpr_read_b32 v133, a21
v_mul_f32 v133, v133, v131
v_accvgpr_write_b32 a21, v133
v_accvgpr_read_b32 v134, a22
v_mul_f32 v134, v134, v131
v_accvgpr_write_b32 a22, v134
v_accvgpr_read_b32 v135, a23
v_mul_f32 v135, v135, v131
v_accvgpr_write_b32 a23, v135
v_accvgpr_read_b32 v132, a24
v_mul_f32 v132, v132, v131
v_accvgpr_write_b32 a24, v132
v_accvgpr_read_b32 v133, a25
v_mul_f32 v133, v133, v131
v_accvgpr_write_b32 a25, v133
v_accvgpr_read_b32 v134, a26
v_mul_f32 v134, v134, v131
v_accvgpr_write_b32 a26, v134
v_accvgpr_read_b32 v135, a27
v_mul_f32 v135, v135, v131
v_accvgpr_write_b32 a27, v135
v_accvgpr_read_b32 v132, a28
v_mul_f32 v132, v132, v131
v_accvgpr_write_b32 a28, v132
v_accvgpr_read_b32 v133, a29
v_mul_f32 v133, v133, v131
v_accvgpr_write_b32 a29, v133
v_accvgpr_read_b32 v134, a30
v_mul_f32 v134, v134, v131
v_accvgpr_write_b32 a30, v134
v_accvgpr_read_b32 v135, a31
v_mul_f32 v135, v135, v131
v_accvgpr_write_b32 a31, v135
v_accvgpr_read_b32 v132, a32
v_mul_f32 v132, v132, v131
v_accvgpr_write_b32 a32, v132
v_accvgpr_read_b32 v133, a33
v_mul_f32 v133, v133, v131
v_accvgpr_write_b32 a33, v133
v_accvgpr_read_b32 v134, a34
v_mul_f32 v134, v134, v131
v_accvgpr_write_b32 a34, v134
v_accvgpr_read_b32 v135, a35
v_mul_f32 v135, v135, v131
v_accvgpr_write_b32 a35, v135
v_accvgpr_read_b32 v132, a36
v_mul_f32 v132, v132, v131
v_accvgpr_write_b32 a36, v132
v_accvgpr_read_b32 v133, a37
v_mul_f32 v133, v133, v131
v_accvgpr_write_b32 a37, v133
v_accvgpr_read_b32 v134, a38
v_mul_f32 v134, v134, v131
v_accvgpr_write_b32 a38, v134
v_accvgpr_read_b32 v135, a39
v_mul_f32 v135, v135, v131
v_accvgpr_write_b32 a39, v135
v_accvgpr_read_b32 v132, a40
v_mul_f32 v132, v132, v131
v_accvgpr_write_b32 a40, v132
v_accvgpr_read_b32 v133, a41
v_mul_f32 v133, v133, v131
v_accvgpr_write_b32 a41, v133
v_accvgpr_read_b32 v134, a42
v_mul_f32 v134, v134, v131
v_accvgpr_write_b32 a42, v134
v_accvgpr_read_b32 v135, a43
v_mul_f32 v135, v135, v131
v_accvgpr_write_b32 a43, v135
v_accvgpr_read_b32 v132, a44
v_mul_f32 v132, v132, v131
v_accvgpr_write_b32 a44, v132
v_accvgpr_read_b32 v133, a45
v_mul_f32 v133, v133, v131
v_accvgpr_write_b32 a45, v133
v_accvgpr_read_b32 v134, a46
v_mul_f32 v134, v134, v131
v_accvgpr_write_b32 a46, v134
v_accvgpr_read_b32 v135, a47
v_mul_f32 v135, v135, v131
v_accvgpr_write_b32 a47, v135
v_accvgpr_read_b32 v132, a48
v_mul_f32 v132, v132, v131
v_accvgpr_write_b32 a48, v132
v_accvgpr_read_b32 v133, a49
v_mul_f32 v133, v133, v131
v_accvgpr_write_b32 a49, v133
v_accvgpr_read_b32 v134, a50
v_mul_f32 v134, v134, v131
v_accvgpr_write_b32 a50, v134
v_accvgpr_read_b32 v135, a51
v_mul_f32 v135, v135, v131
v_accvgpr_write_b32 a51, v135
v_accvgpr_read_b32 v132, a52
v_mul_f32 v132, v132, v131
v_accvgpr_write_b32 a52, v132
v_accvgpr_read_b32 v133, a53
v_mul_f32 v133, v133, v131
v_accvgpr_write_b32 a53, v133
v_accvgpr_read_b32 v134, a54
v_mul_f32 v134, v134, v131
v_accvgpr_write_b32 a54, v134
v_accvgpr_read_b32 v135, a55
v_mul_f32 v135, v135, v131
v_accvgpr_write_b32 a55, v135
v_accvgpr_read_b32 v132, a56
v_mul_f32 v132, v132, v131
v_accvgpr_write_b32 a56, v132
v_accvgpr_read_b32 v133, a57
v_mul_f32 v133, v133, v131
v_accvgpr_write_b32 a57, v133
v_accvgpr_read_b32 v134, a58
v_mul_f32 v134, v134, v131
v_accvgpr_write_b32 a58, v134
v_accvgpr_read_b32 v135, a59
v_mul_f32 v135, v135, v131
v_accvgpr_write_b32 a59, v135
v_accvgpr_read_b32 v132, a60
v_mul_f32 v132, v132, v131
v_accvgpr_write_b32 a60, v132
v_accvgpr_read_b32 v133, a61
v_mul_f32 v133, v133, v131
v_accvgpr_write_b32 a61, v133
v_accvgpr_read_b32 v134, a62
v_mul_f32 v134, v134, v131
v_accvgpr_write_b32 a62, v134
v_accvgpr_read_b32 v135, a63
v_mul_f32 v135, v135, v131
v_accvgpr_write_b32 a63, v135
v_exp_f32 v112, v32
v_exp_f32 v113, v33
s_nop 0
v_add_f32 v128, v112, v113
v_cvt_pk_bf16_f32 v64, v112, v113
v_exp_f32 v114, v34
v_exp_f32 v115, v35
s_nop 0
v_add_f32 v128, v128, v114
v_add_f32 v128, v128, v115
v_cvt_pk_bf16_f32 v65, v114, v115
v_exp_f32 v116, v36
v_exp_f32 v117, v37
s_nop 0
v_add_f32 v128, v128, v116
v_add_f32 v128, v128, v117
v_cvt_pk_bf16_f32 v68, v116, v117
v_exp_f32 v118, v38
v_exp_f32 v119, v39
s_nop 0
v_add_f32 v128, v128, v118
v_add_f32 v128, v128, v119
v_cvt_pk_bf16_f32 v69, v118, v119
v_exp_f32 v112, v40
v_exp_f32 v113, v41
s_nop 0
v_add_f32 v128, v128, v112
v_add_f32 v128, v128, v113
v_cvt_pk_bf16_f32 v66, v112, v113
v_exp_f32 v114, v42
v_exp_f32 v115, v43
s_nop 0
v_add_f32 v128, v128, v114
v_add_f32 v128, v128, v115
v_cvt_pk_bf16_f32 v67, v114, v115
v_exp_f32 v116, v44
v_exp_f32 v117, v45
s_nop 0
v_add_f32 v128, v128, v116
v_add_f32 v128, v128, v117
v_cvt_pk_bf16_f32 v70, v116, v117
v_exp_f32 v118, v46
v_exp_f32 v119, v47
s_nop 0
v_add_f32 v128, v128, v118
v_add_f32 v128, v128, v119
v_cvt_pk_bf16_f32 v71, v118, v119
s_nop 1
s_cmp_eq_u32 s55, 0
s_cbranch_scc1 parallel_sum__compressed_kv_cla__geglu_ffn__prompt_kernel_site_p0a_ret
s_cmp_eq_u32 s55, 1
s_cbranch_scc1 parallel_sum__compressed_kv_cla__geglu_ffn__prompt_kernel_site_p1a_ret
s_branch parallel_sum__compressed_kv_cla__geglu_ffn__prompt_kernel_site_p1la_ret
parallel_sum__compressed_kv_cla__geglu_ffn__prompt_kernel_site_p0b_call:
s_mov_b32 s55, 0
s_branch parallel_sum__compressed_kv_cla__geglu_ffn__prompt_kernel_rare_1_1_1_0
parallel_sum__compressed_kv_cla__geglu_ffn__prompt_kernel_site_p1b_call:
s_mov_b32 s55, 1
s_branch parallel_sum__compressed_kv_cla__geglu_ffn__prompt_kernel_rare_1_1_1_0
parallel_sum__compressed_kv_cla__geglu_ffn__prompt_kernel_site_p2lb_call:
s_mov_b32 s55, 2
parallel_sum__compressed_kv_cla__geglu_ffn__prompt_kernel_rare_1_1_1_0:
s_nop 15
s_nop 7
v_max3_f32 v125, v48, v49, v50
v_max3_f32 v125, v125, v51, v52
v_max3_f32 v125, v125, v53, v54
v_max3_f32 v125, v125, v55, v56
v_max3_f32 v125, v125, v57, v58
v_max3_f32 v125, v125, v59, v60
v_max3_f32 v125, v125, v61, v62
v_max_f32 v125, v125, v63
v_mov_b32 v130, v125
v_mov_b32 v131, v125
s_nop 1
v_permlane32_swap_b32 v130, v131
s_nop 1
v_max_f32 v130, v130, v131
v_max_f32 v130, 0, v130
v_ceil_f32 v130, v130
v_sub_f32 v48, v48, v130
v_sub_f32 v49, v49, v130
v_sub_f32 v50, v50, v130
v_sub_f32 v51, v51, v130
v_sub_f32 v52, v52, v130
v_sub_f32 v53, v53, v130
v_sub_f32 v54, v54, v130
v_sub_f32 v55, v55, v130
v_sub_f32 v56, v56, v130
v_sub_f32 v57, v57, v130
v_sub_f32 v58, v58, v130
v_sub_f32 v59, v59, v130
v_sub_f32 v60, v60, v130
v_sub_f32 v61, v61, v130
v_sub_f32 v62, v62, v130
v_sub_f32 v63, v63, v130
v_sub_f32 v96, v96, v130
v_sub_f32 v97, v97, v130
v_sub_f32 v98, v98, v130
v_sub_f32 v99, v99, v130
v_sub_f32 v100, v100, v130
v_sub_f32 v101, v101, v130
v_sub_f32 v102, v102, v130
v_sub_f32 v103, v103, v130
v_sub_f32 v104, v104, v130
v_sub_f32 v105, v105, v130
v_sub_f32 v106, v106, v130
v_sub_f32 v107, v107, v130
v_sub_f32 v108, v108, v130
v_sub_f32 v109, v109, v130
v_sub_f32 v110, v110, v130
v_sub_f32 v111, v111, v130
v_exp_f32 v131, -v130
s_nop 0
v_mul_f32 v124, v124, v131
v_accvgpr_read_b32 v132, a64
v_mul_f32 v132, v132, v131
v_accvgpr_write_b32 a64, v132
v_accvgpr_read_b32 v133, a65
v_mul_f32 v133, v133, v131
v_accvgpr_write_b32 a65, v133
v_accvgpr_read_b32 v134, a66
v_mul_f32 v134, v134, v131
v_accvgpr_write_b32 a66, v134
v_accvgpr_read_b32 v135, a67
v_mul_f32 v135, v135, v131
v_accvgpr_write_b32 a67, v135
v_accvgpr_read_b32 v132, a68
v_mul_f32 v132, v132, v131
v_accvgpr_write_b32 a68, v132
v_accvgpr_read_b32 v133, a69
v_mul_f32 v133, v133, v131
v_accvgpr_write_b32 a69, v133
v_accvgpr_read_b32 v134, a70
v_mul_f32 v134, v134, v131
v_accvgpr_write_b32 a70, v134
v_accvgpr_read_b32 v135, a71
v_mul_f32 v135, v135, v131
v_accvgpr_write_b32 a71, v135
v_accvgpr_read_b32 v132, a72
v_mul_f32 v132, v132, v131
v_accvgpr_write_b32 a72, v132
v_accvgpr_read_b32 v133, a73
v_mul_f32 v133, v133, v131
v_accvgpr_write_b32 a73, v133
v_accvgpr_read_b32 v134, a74
v_mul_f32 v134, v134, v131
v_accvgpr_write_b32 a74, v134
v_accvgpr_read_b32 v135, a75
v_mul_f32 v135, v135, v131
v_accvgpr_write_b32 a75, v135
v_accvgpr_read_b32 v132, a76
v_mul_f32 v132, v132, v131
v_accvgpr_write_b32 a76, v132
v_accvgpr_read_b32 v133, a77
v_mul_f32 v133, v133, v131
v_accvgpr_write_b32 a77, v133
v_accvgpr_read_b32 v134, a78
v_mul_f32 v134, v134, v131
v_accvgpr_write_b32 a78, v134
v_accvgpr_read_b32 v135, a79
v_mul_f32 v135, v135, v131
v_accvgpr_write_b32 a79, v135
v_accvgpr_read_b32 v132, a80
v_mul_f32 v132, v132, v131
v_accvgpr_write_b32 a80, v132
v_accvgpr_read_b32 v133, a81
v_mul_f32 v133, v133, v131
v_accvgpr_write_b32 a81, v133
v_accvgpr_read_b32 v134, a82
v_mul_f32 v134, v134, v131
v_accvgpr_write_b32 a82, v134
v_accvgpr_read_b32 v135, a83
v_mul_f32 v135, v135, v131
v_accvgpr_write_b32 a83, v135
v_accvgpr_read_b32 v132, a84
v_mul_f32 v132, v132, v131
v_accvgpr_write_b32 a84, v132
v_accvgpr_read_b32 v133, a85
v_mul_f32 v133, v133, v131
v_accvgpr_write_b32 a85, v133
v_accvgpr_read_b32 v134, a86
v_mul_f32 v134, v134, v131
v_accvgpr_write_b32 a86, v134
v_accvgpr_read_b32 v135, a87
v_mul_f32 v135, v135, v131
v_accvgpr_write_b32 a87, v135
v_accvgpr_read_b32 v132, a88
v_mul_f32 v132, v132, v131
v_accvgpr_write_b32 a88, v132
v_accvgpr_read_b32 v133, a89
v_mul_f32 v133, v133, v131
v_accvgpr_write_b32 a89, v133
v_accvgpr_read_b32 v134, a90
v_mul_f32 v134, v134, v131
v_accvgpr_write_b32 a90, v134
v_accvgpr_read_b32 v135, a91
v_mul_f32 v135, v135, v131
v_accvgpr_write_b32 a91, v135
v_accvgpr_read_b32 v132, a92
v_mul_f32 v132, v132, v131
v_accvgpr_write_b32 a92, v132
v_accvgpr_read_b32 v133, a93
v_mul_f32 v133, v133, v131
v_accvgpr_write_b32 a93, v133
v_accvgpr_read_b32 v134, a94
v_mul_f32 v134, v134, v131
v_accvgpr_write_b32 a94, v134
v_accvgpr_read_b32 v135, a95
v_mul_f32 v135, v135, v131
v_accvgpr_write_b32 a95, v135
v_accvgpr_read_b32 v132, a96
v_mul_f32 v132, v132, v131
v_accvgpr_write_b32 a96, v132
v_accvgpr_read_b32 v133, a97
v_mul_f32 v133, v133, v131
v_accvgpr_write_b32 a97, v133
v_accvgpr_read_b32 v134, a98
v_mul_f32 v134, v134, v131
v_accvgpr_write_b32 a98, v134
v_accvgpr_read_b32 v135, a99
v_mul_f32 v135, v135, v131
v_accvgpr_write_b32 a99, v135
v_accvgpr_read_b32 v132, a100
v_mul_f32 v132, v132, v131
v_accvgpr_write_b32 a100, v132
v_accvgpr_read_b32 v133, a101
v_mul_f32 v133, v133, v131
v_accvgpr_write_b32 a101, v133
v_accvgpr_read_b32 v134, a102
v_mul_f32 v134, v134, v131
v_accvgpr_write_b32 a102, v134
v_accvgpr_read_b32 v135, a103
v_mul_f32 v135, v135, v131
v_accvgpr_write_b32 a103, v135
v_accvgpr_read_b32 v132, a104
v_mul_f32 v132, v132, v131
v_accvgpr_write_b32 a104, v132
v_accvgpr_read_b32 v133, a105
v_mul_f32 v133, v133, v131
v_accvgpr_write_b32 a105, v133
v_accvgpr_read_b32 v134, a106
v_mul_f32 v134, v134, v131
v_accvgpr_write_b32 a106, v134
v_accvgpr_read_b32 v135, a107
v_mul_f32 v135, v135, v131
v_accvgpr_write_b32 a107, v135
v_accvgpr_read_b32 v132, a108
v_mul_f32 v132, v132, v131
v_accvgpr_write_b32 a108, v132
v_accvgpr_read_b32 v133, a109
v_mul_f32 v133, v133, v131
v_accvgpr_write_b32 a109, v133
v_accvgpr_read_b32 v134, a110
v_mul_f32 v134, v134, v131
v_accvgpr_write_b32 a110, v134
v_accvgpr_read_b32 v135, a111
v_mul_f32 v135, v135, v131
v_accvgpr_write_b32 a111, v135
v_accvgpr_read_b32 v132, a112
v_mul_f32 v132, v132, v131
v_accvgpr_write_b32 a112, v132
v_accvgpr_read_b32 v133, a113
v_mul_f32 v133, v133, v131
v_accvgpr_write_b32 a113, v133
v_accvgpr_read_b32 v134, a114
v_mul_f32 v134, v134, v131
v_accvgpr_write_b32 a114, v134
v_accvgpr_read_b32 v135, a115
v_mul_f32 v135, v135, v131
v_accvgpr_write_b32 a115, v135
v_accvgpr_read_b32 v132, a116
v_mul_f32 v132, v132, v131
v_accvgpr_write_b32 a116, v132
v_accvgpr_read_b32 v133, a117
v_mul_f32 v133, v133, v131
v_accvgpr_write_b32 a117, v133
v_accvgpr_read_b32 v134, a118
v_mul_f32 v134, v134, v131
v_accvgpr_write_b32 a118, v134
v_accvgpr_read_b32 v135, a119
v_mul_f32 v135, v135, v131
v_accvgpr_write_b32 a119, v135
v_accvgpr_read_b32 v132, a120
v_mul_f32 v132, v132, v131
v_accvgpr_write_b32 a120, v132
v_accvgpr_read_b32 v133, a121
v_mul_f32 v133, v133, v131
v_accvgpr_write_b32 a121, v133
v_accvgpr_read_b32 v134, a122
v_mul_f32 v134, v134, v131
v_accvgpr_write_b32 a122, v134
v_accvgpr_read_b32 v135, a123
v_mul_f32 v135, v135, v131
v_accvgpr_write_b32 a123, v135
v_accvgpr_read_b32 v132, a124
v_mul_f32 v132, v132, v131
v_accvgpr_write_b32 a124, v132
v_accvgpr_read_b32 v133, a125
v_mul_f32 v133, v133, v131
v_accvgpr_write_b32 a125, v133
v_accvgpr_read_b32 v134, a126
v_mul_f32 v134, v134, v131
v_accvgpr_write_b32 a126, v134
v_accvgpr_read_b32 v135, a127
v_mul_f32 v135, v135, v131
v_accvgpr_write_b32 a127, v135
v_exp_f32 v112, v48
v_exp_f32 v113, v49
s_nop 0
v_add_f32 v129, v112, v113
v_cvt_pk_bf16_f32 v72, v112, v113
v_exp_f32 v114, v50
v_exp_f32 v115, v51
s_nop 0
v_add_f32 v129, v129, v114
v_add_f32 v129, v129, v115
v_cvt_pk_bf16_f32 v73, v114, v115
v_exp_f32 v116, v52
v_exp_f32 v117, v53
s_nop 0
v_add_f32 v129, v129, v116
v_add_f32 v129, v129, v117
v_cvt_pk_bf16_f32 v76, v116, v117
v_exp_f32 v118, v54
v_exp_f32 v119, v55
s_nop 0
v_add_f32 v129, v129, v118
v_add_f32 v129, v129, v119
v_cvt_pk_bf16_f32 v77, v118, v119
v_exp_f32 v112, v56
v_exp_f32 v113, v57
s_nop 0
v_add_f32 v129, v129, v112
v_add_f32 v129, v129, v113
v_cvt_pk_bf16_f32 v74, v112, v113
v_exp_f32 v114, v58
v_exp_f32 v115, v59
s_nop 0
v_add_f32 v129, v129, v114
v_add_f32 v129, v129, v115
v_cvt_pk_bf16_f32 v75, v114, v115
v_exp_f32 v116, v60
v_exp_f32 v117, v61
s_nop 0
v_add_f32 v129, v129, v116
v_add_f32 v129, v129, v117
v_cvt_pk_bf16_f32 v78, v116, v117
v_exp_f32 v118, v62
v_exp_f32 v119, v63
s_nop 0
v_add_f32 v129, v129, v118
v_add_f32 v129, v129, v119
v_cvt_pk_bf16_f32 v79, v118, v119
s_nop 1
s_cmp_eq_u32 s55, 0
s_cbranch_scc1 parallel_sum__compressed_kv_cla__geglu_ffn__prompt_kernel_site_p0b_ret
s_cmp_eq_u32 s55, 1
s_cbranch_scc1 parallel_sum__compressed_kv_cla__geglu_ffn__prompt_kernel_site_p1b_ret
s_branch parallel_sum__compressed_kv_cla__geglu_ffn__prompt_kernel_site_p2lb_ret
parallel_sum__compressed_kv_cla__geglu_ffn__prompt_kernel_site_p1lb_call:
s_mov_b32 s55, 0
s_branch parallel_sum__compressed_kv_cla__geglu_ffn__prompt_kernel_rare_1_1_1_1
parallel_sum__compressed_kv_cla__geglu_ffn__prompt_kernel_site_p2b_call:
s_mov_b32 s55, 1
parallel_sum__compressed_kv_cla__geglu_ffn__prompt_kernel_rare_1_1_1_1:
s_nop 15
s_nop 7
v_max3_f32 v125, v48, v49, v50
v_max3_f32 v125, v125, v51, v52
v_max3_f32 v125, v125, v53, v54
v_max3_f32 v125, v125, v55, v56
v_max3_f32 v125, v125, v57, v58
v_max3_f32 v125, v125, v59, v60
v_max3_f32 v125, v125, v61, v62
v_max_f32 v125, v125, v63
v_mov_b32 v130, v125
v_mov_b32 v131, v125
s_nop 1
v_permlane32_swap_b32 v130, v131
s_nop 1
v_max_f32 v130, v130, v131
v_max_f32 v130, 0, v130
v_ceil_f32 v130, v130
v_sub_f32 v48, v48, v130
v_sub_f32 v49, v49, v130
v_sub_f32 v50, v50, v130
v_sub_f32 v51, v51, v130
v_sub_f32 v52, v52, v130
v_sub_f32 v53, v53, v130
v_sub_f32 v54, v54, v130
v_sub_f32 v55, v55, v130
v_sub_f32 v56, v56, v130
v_sub_f32 v57, v57, v130
v_sub_f32 v58, v58, v130
v_sub_f32 v59, v59, v130
v_sub_f32 v60, v60, v130
v_sub_f32 v61, v61, v130
v_sub_f32 v62, v62, v130
v_sub_f32 v63, v63, v130
v_sub_f32 v96, v96, v130
v_sub_f32 v97, v97, v130
v_sub_f32 v98, v98, v130
v_sub_f32 v99, v99, v130
v_sub_f32 v100, v100, v130
v_sub_f32 v101, v101, v130
v_sub_f32 v102, v102, v130
v_sub_f32 v103, v103, v130
v_sub_f32 v104, v104, v130
v_sub_f32 v105, v105, v130
v_sub_f32 v106, v106, v130
v_sub_f32 v107, v107, v130
v_sub_f32 v108, v108, v130
v_sub_f32 v109, v109, v130
v_sub_f32 v110, v110, v130
v_sub_f32 v111, v111, v130
v_sub_f32 v32, v32, v130
v_sub_f32 v33, v33, v130
v_sub_f32 v34, v34, v130
v_sub_f32 v35, v35, v130
v_sub_f32 v36, v36, v130
v_sub_f32 v37, v37, v130
v_sub_f32 v38, v38, v130
v_sub_f32 v39, v39, v130
v_sub_f32 v40, v40, v130
v_sub_f32 v41, v41, v130
v_sub_f32 v42, v42, v130
v_sub_f32 v43, v43, v130
v_sub_f32 v44, v44, v130
v_sub_f32 v45, v45, v130
v_sub_f32 v46, v46, v130
v_sub_f32 v47, v47, v130
v_exp_f32 v131, -v130
s_nop 0
v_mul_f32 v124, v124, v131
v_accvgpr_read_b32 v132, a64
v_mul_f32 v132, v132, v131
v_accvgpr_write_b32 a64, v132
v_accvgpr_read_b32 v133, a65
v_mul_f32 v133, v133, v131
v_accvgpr_write_b32 a65, v133
v_accvgpr_read_b32 v134, a66
v_mul_f32 v134, v134, v131
v_accvgpr_write_b32 a66, v134
v_accvgpr_read_b32 v135, a67
v_mul_f32 v135, v135, v131
v_accvgpr_write_b32 a67, v135
v_accvgpr_read_b32 v132, a68
v_mul_f32 v132, v132, v131
v_accvgpr_write_b32 a68, v132
v_accvgpr_read_b32 v133, a69
v_mul_f32 v133, v133, v131
v_accvgpr_write_b32 a69, v133
v_accvgpr_read_b32 v134, a70
v_mul_f32 v134, v134, v131
v_accvgpr_write_b32 a70, v134
v_accvgpr_read_b32 v135, a71
v_mul_f32 v135, v135, v131
v_accvgpr_write_b32 a71, v135
v_accvgpr_read_b32 v132, a72
v_mul_f32 v132, v132, v131
v_accvgpr_write_b32 a72, v132
v_accvgpr_read_b32 v133, a73
v_mul_f32 v133, v133, v131
v_accvgpr_write_b32 a73, v133
v_accvgpr_read_b32 v134, a74
v_mul_f32 v134, v134, v131
v_accvgpr_write_b32 a74, v134
v_accvgpr_read_b32 v135, a75
v_mul_f32 v135, v135, v131
v_accvgpr_write_b32 a75, v135
v_accvgpr_read_b32 v132, a76
v_mul_f32 v132, v132, v131
v_accvgpr_write_b32 a76, v132
v_accvgpr_read_b32 v133, a77
v_mul_f32 v133, v133, v131
v_accvgpr_write_b32 a77, v133
v_accvgpr_read_b32 v134, a78
v_mul_f32 v134, v134, v131
v_accvgpr_write_b32 a78, v134
v_accvgpr_read_b32 v135, a79
v_mul_f32 v135, v135, v131
v_accvgpr_write_b32 a79, v135
v_accvgpr_read_b32 v132, a80
v_mul_f32 v132, v132, v131
v_accvgpr_write_b32 a80, v132
v_accvgpr_read_b32 v133, a81
v_mul_f32 v133, v133, v131
v_accvgpr_write_b32 a81, v133
v_accvgpr_read_b32 v134, a82
v_mul_f32 v134, v134, v131
v_accvgpr_write_b32 a82, v134
v_accvgpr_read_b32 v135, a83
v_mul_f32 v135, v135, v131
v_accvgpr_write_b32 a83, v135
v_accvgpr_read_b32 v132, a84
v_mul_f32 v132, v132, v131
v_accvgpr_write_b32 a84, v132
v_accvgpr_read_b32 v133, a85
v_mul_f32 v133, v133, v131
v_accvgpr_write_b32 a85, v133
v_accvgpr_read_b32 v134, a86
v_mul_f32 v134, v134, v131
v_accvgpr_write_b32 a86, v134
v_accvgpr_read_b32 v135, a87
v_mul_f32 v135, v135, v131
v_accvgpr_write_b32 a87, v135
v_accvgpr_read_b32 v132, a88
v_mul_f32 v132, v132, v131
v_accvgpr_write_b32 a88, v132
v_accvgpr_read_b32 v133, a89
v_mul_f32 v133, v133, v131
v_accvgpr_write_b32 a89, v133
v_accvgpr_read_b32 v134, a90
v_mul_f32 v134, v134, v131
v_accvgpr_write_b32 a90, v134
v_accvgpr_read_b32 v135, a91
v_mul_f32 v135, v135, v131
v_accvgpr_write_b32 a91, v135
v_accvgpr_read_b32 v132, a92
v_mul_f32 v132, v132, v131
v_accvgpr_write_b32 a92, v132
v_accvgpr_read_b32 v133, a93
v_mul_f32 v133, v133, v131
v_accvgpr_write_b32 a93, v133
v_accvgpr_read_b32 v134, a94
v_mul_f32 v134, v134, v131
v_accvgpr_write_b32 a94, v134
v_accvgpr_read_b32 v135, a95
v_mul_f32 v135, v135, v131
v_accvgpr_write_b32 a95, v135
v_accvgpr_read_b32 v132, a96
v_mul_f32 v132, v132, v131
v_accvgpr_write_b32 a96, v132
v_accvgpr_read_b32 v133, a97
v_mul_f32 v133, v133, v131
v_accvgpr_write_b32 a97, v133
v_accvgpr_read_b32 v134, a98
v_mul_f32 v134, v134, v131
v_accvgpr_write_b32 a98, v134
v_accvgpr_read_b32 v135, a99
v_mul_f32 v135, v135, v131
v_accvgpr_write_b32 a99, v135
v_accvgpr_read_b32 v132, a100
v_mul_f32 v132, v132, v131
v_accvgpr_write_b32 a100, v132
v_accvgpr_read_b32 v133, a101
v_mul_f32 v133, v133, v131
v_accvgpr_write_b32 a101, v133
v_accvgpr_read_b32 v134, a102
v_mul_f32 v134, v134, v131
v_accvgpr_write_b32 a102, v134
v_accvgpr_read_b32 v135, a103
v_mul_f32 v135, v135, v131
v_accvgpr_write_b32 a103, v135
v_accvgpr_read_b32 v132, a104
v_mul_f32 v132, v132, v131
v_accvgpr_write_b32 a104, v132
v_accvgpr_read_b32 v133, a105
v_mul_f32 v133, v133, v131
v_accvgpr_write_b32 a105, v133
v_accvgpr_read_b32 v134, a106
v_mul_f32 v134, v134, v131
v_accvgpr_write_b32 a106, v134
v_accvgpr_read_b32 v135, a107
v_mul_f32 v135, v135, v131
v_accvgpr_write_b32 a107, v135
v_accvgpr_read_b32 v132, a108
v_mul_f32 v132, v132, v131
v_accvgpr_write_b32 a108, v132
v_accvgpr_read_b32 v133, a109
v_mul_f32 v133, v133, v131
v_accvgpr_write_b32 a109, v133
v_accvgpr_read_b32 v134, a110
v_mul_f32 v134, v134, v131
v_accvgpr_write_b32 a110, v134
v_accvgpr_read_b32 v135, a111
v_mul_f32 v135, v135, v131
v_accvgpr_write_b32 a111, v135
v_accvgpr_read_b32 v132, a112
v_mul_f32 v132, v132, v131
v_accvgpr_write_b32 a112, v132
v_accvgpr_read_b32 v133, a113
v_mul_f32 v133, v133, v131
v_accvgpr_write_b32 a113, v133
v_accvgpr_read_b32 v134, a114
v_mul_f32 v134, v134, v131
v_accvgpr_write_b32 a114, v134
v_accvgpr_read_b32 v135, a115
v_mul_f32 v135, v135, v131
v_accvgpr_write_b32 a115, v135
v_accvgpr_read_b32 v132, a116
v_mul_f32 v132, v132, v131
v_accvgpr_write_b32 a116, v132
v_accvgpr_read_b32 v133, a117
v_mul_f32 v133, v133, v131
v_accvgpr_write_b32 a117, v133
v_accvgpr_read_b32 v134, a118
v_mul_f32 v134, v134, v131
v_accvgpr_write_b32 a118, v134
v_accvgpr_read_b32 v135, a119
v_mul_f32 v135, v135, v131
v_accvgpr_write_b32 a119, v135
v_accvgpr_read_b32 v132, a120
v_mul_f32 v132, v132, v131
v_accvgpr_write_b32 a120, v132
v_accvgpr_read_b32 v133, a121
v_mul_f32 v133, v133, v131
v_accvgpr_write_b32 a121, v133
v_accvgpr_read_b32 v134, a122
v_mul_f32 v134, v134, v131
v_accvgpr_write_b32 a122, v134
v_accvgpr_read_b32 v135, a123
v_mul_f32 v135, v135, v131
v_accvgpr_write_b32 a123, v135
v_accvgpr_read_b32 v132, a124
v_mul_f32 v132, v132, v131
v_accvgpr_write_b32 a124, v132
v_accvgpr_read_b32 v133, a125
v_mul_f32 v133, v133, v131
v_accvgpr_write_b32 a125, v133
v_accvgpr_read_b32 v134, a126
v_mul_f32 v134, v134, v131
v_accvgpr_write_b32 a126, v134
v_accvgpr_read_b32 v135, a127
v_mul_f32 v135, v135, v131
v_accvgpr_write_b32 a127, v135
v_exp_f32 v112, v48
v_exp_f32 v113, v49
s_nop 0
v_add_f32 v129, v112, v113
v_cvt_pk_bf16_f32 v72, v112, v113
v_exp_f32 v114, v50
v_exp_f32 v115, v51
s_nop 0
v_add_f32 v129, v129, v114
v_add_f32 v129, v129, v115
v_cvt_pk_bf16_f32 v73, v114, v115
v_exp_f32 v116, v52
v_exp_f32 v117, v53
s_nop 0
v_add_f32 v129, v129, v116
v_add_f32 v129, v129, v117
v_cvt_pk_bf16_f32 v76, v116, v117
v_exp_f32 v118, v54
v_exp_f32 v119, v55
s_nop 0
v_add_f32 v129, v129, v118
v_add_f32 v129, v129, v119
v_cvt_pk_bf16_f32 v77, v118, v119
v_exp_f32 v112, v56
v_exp_f32 v113, v57
s_nop 0
v_add_f32 v129, v129, v112
v_add_f32 v129, v129, v113
v_cvt_pk_bf16_f32 v74, v112, v113
v_exp_f32 v114, v58
v_exp_f32 v115, v59
s_nop 0
v_add_f32 v129, v129, v114
v_add_f32 v129, v129, v115
v_cvt_pk_bf16_f32 v75, v114, v115
v_exp_f32 v116, v60
v_exp_f32 v117, v61
s_nop 0
v_add_f32 v129, v129, v116
v_add_f32 v129, v129, v117
v_cvt_pk_bf16_f32 v78, v116, v117
v_exp_f32 v118, v62
v_exp_f32 v119, v63
s_nop 0
v_add_f32 v129, v129, v118
v_add_f32 v129, v129, v119
v_cvt_pk_bf16_f32 v79, v118, v119
s_nop 1
s_cmp_eq_u32 s55, 0
s_cbranch_scc1 parallel_sum__compressed_kv_cla__geglu_ffn__prompt_kernel_site_p1lb_ret
s_branch parallel_sum__compressed_kv_cla__geglu_ffn__prompt_kernel_site_p2b_ret
parallel_sum__compressed_kv_cla__geglu_ffn__prompt_kernel_site_p2a_call:
s_mov_b32 s55, 0
s_branch parallel_sum__compressed_kv_cla__geglu_ffn__prompt_kernel_rare_1_0_0_1
parallel_sum__compressed_kv_cla__geglu_ffn__prompt_kernel_site_p2la_call:
s_mov_b32 s55, 1
parallel_sum__compressed_kv_cla__geglu_ffn__prompt_kernel_rare_1_0_0_1:
s_nop 15
s_nop 7
v_max3_f32 v125, v32, v33, v34
v_max3_f32 v125, v125, v35, v36
v_max3_f32 v125, v125, v37, v38
v_max3_f32 v125, v125, v39, v40
v_max3_f32 v125, v125, v41, v42
v_max3_f32 v125, v125, v43, v44
v_max3_f32 v125, v125, v45, v46
v_max_f32 v125, v125, v47
v_mov_b32 v130, v125
v_mov_b32 v131, v125
s_nop 1
v_permlane32_swap_b32 v130, v131
s_nop 1
v_max_f32 v130, v130, v131
v_max_f32 v130, 0, v130
v_ceil_f32 v130, v130
v_sub_f32 v32, v32, v130
v_sub_f32 v33, v33, v130
v_sub_f32 v34, v34, v130
v_sub_f32 v35, v35, v130
v_sub_f32 v36, v36, v130
v_sub_f32 v37, v37, v130
v_sub_f32 v38, v38, v130
v_sub_f32 v39, v39, v130
v_sub_f32 v40, v40, v130
v_sub_f32 v41, v41, v130
v_sub_f32 v42, v42, v130
v_sub_f32 v43, v43, v130
v_sub_f32 v44, v44, v130
v_sub_f32 v45, v45, v130
v_sub_f32 v46, v46, v130
v_sub_f32 v47, v47, v130
v_sub_f32 v96, v96, v130
v_sub_f32 v97, v97, v130
v_sub_f32 v98, v98, v130
v_sub_f32 v99, v99, v130
v_sub_f32 v100, v100, v130
v_sub_f32 v101, v101, v130
v_sub_f32 v102, v102, v130
v_sub_f32 v103, v103, v130
v_sub_f32 v104, v104, v130
v_sub_f32 v105, v105, v130
v_sub_f32 v106, v106, v130
v_sub_f32 v107, v107, v130
v_sub_f32 v108, v108, v130
v_sub_f32 v109, v109, v130
v_sub_f32 v110, v110, v130
v_sub_f32 v111, v111, v130
v_sub_f32 v48, v48, v130
v_sub_f32 v49, v49, v130
v_sub_f32 v50, v50, v130
v_sub_f32 v51, v51, v130
v_sub_f32 v52, v52, v130
v_sub_f32 v53, v53, v130
v_sub_f32 v54, v54, v130
v_sub_f32 v55, v55, v130
v_sub_f32 v56, v56, v130
v_sub_f32 v57, v57, v130
v_sub_f32 v58, v58, v130
v_sub_f32 v59, v59, v130
v_sub_f32 v60, v60, v130
v_sub_f32 v61, v61, v130
v_sub_f32 v62, v62, v130
v_sub_f32 v63, v63, v130
v_exp_f32 v131, -v130
s_nop 0
v_mul_f32 v124, v124, v131
v_accvgpr_read_b32 v132, a64
v_mul_f32 v132, v132, v131
v_accvgpr_write_b32 a64, v132
v_accvgpr_read_b32 v133, a65
v_mul_f32 v133, v133, v131
v_accvgpr_write_b32 a65, v133
v_accvgpr_read_b32 v134, a66
v_mul_f32 v134, v134, v131
v_accvgpr_write_b32 a66, v134
v_accvgpr_read_b32 v135, a67
v_mul_f32 v135, v135, v131
v_accvgpr_write_b32 a67, v135
v_accvgpr_read_b32 v132, a68
v_mul_f32 v132, v132, v131
v_accvgpr_write_b32 a68, v132
v_accvgpr_read_b32 v133, a69
v_mul_f32 v133, v133, v131
v_accvgpr_write_b32 a69, v133
v_accvgpr_read_b32 v134, a70
v_mul_f32 v134, v134, v131
v_accvgpr_write_b32 a70, v134
v_accvgpr_read_b32 v135, a71
v_mul_f32 v135, v135, v131
v_accvgpr_write_b32 a71, v135
v_accvgpr_read_b32 v132, a72
v_mul_f32 v132, v132, v131
v_accvgpr_write_b32 a72, v132
v_accvgpr_read_b32 v133, a73
v_mul_f32 v133, v133, v131
v_accvgpr_write_b32 a73, v133
v_accvgpr_read_b32 v134, a74
v_mul_f32 v134, v134, v131
v_accvgpr_write_b32 a74, v134
v_accvgpr_read_b32 v135, a75
v_mul_f32 v135, v135, v131
v_accvgpr_write_b32 a75, v135
v_accvgpr_read_b32 v132, a76
v_mul_f32 v132, v132, v131
v_accvgpr_write_b32 a76, v132
v_accvgpr_read_b32 v133, a77
v_mul_f32 v133, v133, v131
v_accvgpr_write_b32 a77, v133
v_accvgpr_read_b32 v134, a78
v_mul_f32 v134, v134, v131
v_accvgpr_write_b32 a78, v134
v_accvgpr_read_b32 v135, a79
v_mul_f32 v135, v135, v131
v_accvgpr_write_b32 a79, v135
v_accvgpr_read_b32 v132, a80
v_mul_f32 v132, v132, v131
v_accvgpr_write_b32 a80, v132
v_accvgpr_read_b32 v133, a81
v_mul_f32 v133, v133, v131
v_accvgpr_write_b32 a81, v133
v_accvgpr_read_b32 v134, a82
v_mul_f32 v134, v134, v131
v_accvgpr_write_b32 a82, v134
v_accvgpr_read_b32 v135, a83
v_mul_f32 v135, v135, v131
v_accvgpr_write_b32 a83, v135
v_accvgpr_read_b32 v132, a84
v_mul_f32 v132, v132, v131
v_accvgpr_write_b32 a84, v132
v_accvgpr_read_b32 v133, a85
v_mul_f32 v133, v133, v131
v_accvgpr_write_b32 a85, v133
v_accvgpr_read_b32 v134, a86
v_mul_f32 v134, v134, v131
v_accvgpr_write_b32 a86, v134
v_accvgpr_read_b32 v135, a87
v_mul_f32 v135, v135, v131
v_accvgpr_write_b32 a87, v135
v_accvgpr_read_b32 v132, a88
v_mul_f32 v132, v132, v131
v_accvgpr_write_b32 a88, v132
v_accvgpr_read_b32 v133, a89
v_mul_f32 v133, v133, v131
v_accvgpr_write_b32 a89, v133
v_accvgpr_read_b32 v134, a90
v_mul_f32 v134, v134, v131
v_accvgpr_write_b32 a90, v134
v_accvgpr_read_b32 v135, a91
v_mul_f32 v135, v135, v131
v_accvgpr_write_b32 a91, v135
v_accvgpr_read_b32 v132, a92
v_mul_f32 v132, v132, v131
v_accvgpr_write_b32 a92, v132
v_accvgpr_read_b32 v133, a93
v_mul_f32 v133, v133, v131
v_accvgpr_write_b32 a93, v133
v_accvgpr_read_b32 v134, a94
v_mul_f32 v134, v134, v131
v_accvgpr_write_b32 a94, v134
v_accvgpr_read_b32 v135, a95
v_mul_f32 v135, v135, v131
v_accvgpr_write_b32 a95, v135
v_accvgpr_read_b32 v132, a96
v_mul_f32 v132, v132, v131
v_accvgpr_write_b32 a96, v132
v_accvgpr_read_b32 v133, a97
v_mul_f32 v133, v133, v131
v_accvgpr_write_b32 a97, v133
v_accvgpr_read_b32 v134, a98
v_mul_f32 v134, v134, v131
v_accvgpr_write_b32 a98, v134
v_accvgpr_read_b32 v135, a99
v_mul_f32 v135, v135, v131
v_accvgpr_write_b32 a99, v135
v_accvgpr_read_b32 v132, a100
v_mul_f32 v132, v132, v131
v_accvgpr_write_b32 a100, v132
v_accvgpr_read_b32 v133, a101
v_mul_f32 v133, v133, v131
v_accvgpr_write_b32 a101, v133
v_accvgpr_read_b32 v134, a102
v_mul_f32 v134, v134, v131
v_accvgpr_write_b32 a102, v134
v_accvgpr_read_b32 v135, a103
v_mul_f32 v135, v135, v131
v_accvgpr_write_b32 a103, v135
v_accvgpr_read_b32 v132, a104
v_mul_f32 v132, v132, v131
v_accvgpr_write_b32 a104, v132
v_accvgpr_read_b32 v133, a105
v_mul_f32 v133, v133, v131
v_accvgpr_write_b32 a105, v133
v_accvgpr_read_b32 v134, a106
v_mul_f32 v134, v134, v131
v_accvgpr_write_b32 a106, v134
v_accvgpr_read_b32 v135, a107
v_mul_f32 v135, v135, v131
v_accvgpr_write_b32 a107, v135
v_accvgpr_read_b32 v132, a108
v_mul_f32 v132, v132, v131
v_accvgpr_write_b32 a108, v132
v_accvgpr_read_b32 v133, a109
v_mul_f32 v133, v133, v131
v_accvgpr_write_b32 a109, v133
v_accvgpr_read_b32 v134, a110
v_mul_f32 v134, v134, v131
v_accvgpr_write_b32 a110, v134
v_accvgpr_read_b32 v135, a111
v_mul_f32 v135, v135, v131
v_accvgpr_write_b32 a111, v135
v_accvgpr_read_b32 v132, a112
v_mul_f32 v132, v132, v131
v_accvgpr_write_b32 a112, v132
v_accvgpr_read_b32 v133, a113
v_mul_f32 v133, v133, v131
v_accvgpr_write_b32 a113, v133
v_accvgpr_read_b32 v134, a114
v_mul_f32 v134, v134, v131
v_accvgpr_write_b32 a114, v134
v_accvgpr_read_b32 v135, a115
v_mul_f32 v135, v135, v131
v_accvgpr_write_b32 a115, v135
v_accvgpr_read_b32 v132, a116
v_mul_f32 v132, v132, v131
v_accvgpr_write_b32 a116, v132
v_accvgpr_read_b32 v133, a117
v_mul_f32 v133, v133, v131
v_accvgpr_write_b32 a117, v133
v_accvgpr_read_b32 v134, a118
v_mul_f32 v134, v134, v131
v_accvgpr_write_b32 a118, v134
v_accvgpr_read_b32 v135, a119
v_mul_f32 v135, v135, v131
v_accvgpr_write_b32 a119, v135
v_accvgpr_read_b32 v132, a120
v_mul_f32 v132, v132, v131
v_accvgpr_write_b32 a120, v132
v_accvgpr_read_b32 v133, a121
v_mul_f32 v133, v133, v131
v_accvgpr_write_b32 a121, v133
v_accvgpr_read_b32 v134, a122
v_mul_f32 v134, v134, v131
v_accvgpr_write_b32 a122, v134
v_accvgpr_read_b32 v135, a123
v_mul_f32 v135, v135, v131
v_accvgpr_write_b32 a123, v135
v_accvgpr_read_b32 v132, a124
v_mul_f32 v132, v132, v131
v_accvgpr_write_b32 a124, v132
v_accvgpr_read_b32 v133, a125
v_mul_f32 v133, v133, v131
v_accvgpr_write_b32 a125, v133
v_accvgpr_read_b32 v134, a126
v_mul_f32 v134, v134, v131
v_accvgpr_write_b32 a126, v134
v_accvgpr_read_b32 v135, a127
v_mul_f32 v135, v135, v131
v_accvgpr_write_b32 a127, v135
v_exp_f32 v112, v32
v_exp_f32 v113, v33
s_nop 0
v_add_f32 v128, v112, v113
v_cvt_pk_bf16_f32 v64, v112, v113
v_exp_f32 v114, v34
v_exp_f32 v115, v35
s_nop 0
v_add_f32 v128, v128, v114
v_add_f32 v128, v128, v115
v_cvt_pk_bf16_f32 v65, v114, v115
v_exp_f32 v116, v36
v_exp_f32 v117, v37
s_nop 0
v_add_f32 v128, v128, v116
v_add_f32 v128, v128, v117
v_cvt_pk_bf16_f32 v68, v116, v117
v_exp_f32 v118, v38
v_exp_f32 v119, v39
s_nop 0
v_add_f32 v128, v128, v118
v_add_f32 v128, v128, v119
v_cvt_pk_bf16_f32 v69, v118, v119
v_exp_f32 v112, v40
v_exp_f32 v113, v41
s_nop 0
v_add_f32 v128, v128, v112
v_add_f32 v128, v128, v113
v_cvt_pk_bf16_f32 v66, v112, v113
v_exp_f32 v114, v42
v_exp_f32 v115, v43
s_nop 0
v_add_f32 v128, v128, v114
v_add_f32 v128, v128, v115
v_cvt_pk_bf16_f32 v67, v114, v115
v_exp_f32 v116, v44
v_exp_f32 v117, v45
s_nop 0
v_add_f32 v128, v128, v116
v_add_f32 v128, v128, v117
v_cvt_pk_bf16_f32 v70, v116, v117
v_exp_f32 v118, v46
v_exp_f32 v119, v47
s_nop 0
v_add_f32 v128, v128, v118
v_add_f32 v128, v128, v119
v_cvt_pk_bf16_f32 v71, v118, v119
s_nop 1
s_cmp_eq_u32 s55, 0
s_cbranch_scc1 parallel_sum__compressed_kv_cla__geglu_ffn__prompt_kernel_site_p2a_ret
s_branch parallel_sum__compressed_kv_cla__geglu_ffn__prompt_kernel_site_p2la_ret
parallel_sum__compressed_kv_cla__geglu_ffn__prompt_kernel_spin1:
s_mov_b32 s71, 0
parallel_sum__compressed_kv_cla__geglu_ffn__prompt_kernel_spin1_l:
s_sleep 2
v_lshlrev_b32 v23, 2, v0
buffer_load_dword v23, v23, s[64:67], 0 offen sc1
s_waitcnt vmcnt(0)
v_subrev_u32 v24, 0x01010101, v23
v_not_b32 v25, v23
v_and_b32 v24, v24, v25
v_and_b32 v24, 0x80808080, v24
v_cmp_ne_u32 vcc, 0, v24
s_add_u32 s71, s71, 1
s_cmp_ge_u32 s71, 0x40000
s_cbranch_scc1 parallel_sum__compressed_kv_cla__geglu_ffn__prompt_kernel_spin1_ret
s_nop 2
s_cbranch_vccnz parallel_sum__compressed_kv_cla__geglu_ffn__prompt_kernel_spin1_l
s_branch parallel_sum__compressed_kv_cla__geglu_ffn__prompt_kernel_spin1_ret
parallel_sum__compressed_kv_cla__geglu_ffn__prompt_kernel_spin2:
s_mov_b32 s71, 0
parallel_sum__compressed_kv_cla__geglu_ffn__prompt_kernel_spin2_l:
s_sleep 2
s_mov_b32 s68, 113246208
v_lshlrev_b32 v20, 4, v0
buffer_load_dwordx4 v[20:23], v20, s[20:23], s68 offen sc1
s_waitcnt vmcnt(0)
v_min_u32 v20, v20, v21
v_min3_u32 v20, v20, v22, v23
v_cmp_eq_u32 vcc, 0, v20
s_add_u32 s71, s71, 1
s_cmp_ge_u32 s71, 0x40000
s_cbranch_scc1 parallel_sum__compressed_kv_cla__geglu_ffn__prompt_kernel_spin2_ret
s_nop 2
s_cbranch_vccnz parallel_sum__compressed_kv_cla__geglu_ffn__prompt_kernel_spin2_l
s_branch parallel_sum__compressed_kv_cla__geglu_ffn__prompt_kernel_spin2_ret
parallel_sum__compressed_kv_cla__geglu_ffn__prompt_kernel_spin3:
s_mov_b32 s71, 0
parallel_sum__compressed_kv_cla__geglu_ffn__prompt_kernel_spin3_l:
s_sleep 2
v_lshlrev_b32 v23, 2, v0
buffer_load_dword v23, v23, s[64:67], 0 offen sc1
s_waitcnt vmcnt(0)
v_subrev_u32 v24, 0x01010101, v23
v_not_b32 v25, v23
v_and_b32 v24, v24, v25
v_and_b32 v24, 0x80808080, v24
v_cmp_ne_u32 vcc, 0, v24
s_add_u32 s71, s71, 1
s_cmp_ge_u32 s71, 0x40000
s_cbranch_scc1 parallel_sum__compressed_kv_cla__geglu_ffn__prompt_kernel_spin3_ret
s_nop 2
s_cbranch_vccnz parallel_sum__compressed_kv_cla__geglu_ffn__prompt_kernel_spin3_l
s_branch parallel_sum__compressed_kv_cla__geglu_ffn__prompt_kernel_spin3_ret
parallel_sum__compressed_kv_cla__geglu_ffn__prompt_kernel_spin4:
s_mov_b32 s71, 0
parallel_sum__compressed_kv_cla__geglu_ffn__prompt_kernel_spin4_l:
s_sleep 2
s_mov_b32 s68, 113246208
v_lshlrev_b32 v20, 4, v0
buffer_load_dwordx4 v[20:23], v20, s[20:23], s68 offen sc1
s_waitcnt vmcnt(0)
v_min_u32 v20, v20, v21
v_min3_u32 v20, v20, v22, v23
v_cmp_eq_u32 vcc, 0, v20
s_add_u32 s71, s71, 1
s_cmp_ge_u32 s71, 0x40000
s_cbranch_scc1 parallel_sum__compressed_kv_cla__geglu_ffn__prompt_kernel_spin4_ret
s_nop 2
s_cbranch_vccnz parallel_sum__compressed_kv_cla__geglu_ffn__prompt_kernel_spin4_l
s_branch parallel_sum__compressed_kv_cla__geglu_ffn__prompt_kernel_spin4_ret
parallel_sum__compressed_kv_cla__geglu_ffn__prompt_kernel_spin5:
s_mov_b32 s71, 0
parallel_sum__compressed_kv_cla__geglu_ffn__prompt_kernel_spin5_l:
s_sleep 2
s_lshl_b32 s68, s29, 7
s_add_u32 s68, s68, 113249280
v_and_b32 v17, 7, v0
v_lshlrev_b32 v17, 2, v17
buffer_load_dword v17, v17, s[20:23], s68 offen sc1
s_waitcnt vmcnt(0)
v_cmp_eq_u32 vcc, 0, v17
s_add_u32 s71, s71, 1
s_cmp_ge_u32 s71, 0x40000
s_cbranch_scc1 parallel_sum__compressed_kv_cla__geglu_ffn__prompt_kernel_spin5_ret
s_nop 2
s_cbranch_vccnz parallel_sum__compressed_kv_cla__geglu_ffn__prompt_kernel_spin5_l
s_branch parallel_sum__compressed_kv_cla__geglu_ffn__prompt_kernel_spin5_ret
parallel_sum__compressed_kv_cla__geglu_ffn__prompt_kernel_spin8:
s_mov_b32 s71, 0
parallel_sum__compressed_kv_cla__geglu_ffn__prompt_kernel_spin8_l:
s_sleep 2
s_mov_b32 s68, 113264768
v_and_b32 v140, 7, v0
v_lshlrev_b32 v140, 2, v140
buffer_load_dword v140, v140, s[20:23], s68 offen sc1
s_waitcnt vmcnt(0)
s_nop 1
v_add_u32_dpp v140, v140, v140 quad_perm:[1,0,3,2] row_mask:0xf bank_mask:0xf
s_nop 1
v_add_u32_dpp v140, v140, v140 quad_perm:[2,3,0,1] row_mask:0xf bank_mask:0xf
s_nop 1
v_add_u32_dpp v140, v140, v140 row_half_mirror row_mask:0xf bank_mask:0xf
v_cmp_ne_u32 vcc, 0x100, v140
s_add_u32 s71, s71, 1
s_cmp_ge_u32 s71, 0x40000
s_cbranch_scc1 parallel_sum__compressed_kv_cla__geglu_ffn__prompt_kernel_spin8_ret
s_nop 2
s_cbranch_vccnz parallel_sum__compressed_kv_cla__geglu_ffn__prompt_kernel_spin8_l
s_branch parallel_sum__compressed_kv_cla__geglu_ffn__prompt_kernel_spin8_ret
parallel_sum__compressed_kv_cla__geglu_ffn__prompt_kernel_spin9:
s_mov_b32 s71, 0
parallel_sum__compressed_kv_cla__geglu_ffn__prompt_kernel_spin9_l:
s_sleep 2
s_lshl_b32 s68, s98, 7
s_add_u32 s68, s68, 113248256
v_and_b32 v27, 31, v0
v_lshlrev_b32 v27, 2, v27
buffer_load_dword v27, v27, s[20:23], s68 offen sc1
s_waitcnt vmcnt(0)
v_cmp_eq_u32 vcc, 0, v27
s_add_u32 s71, s71, 1
s_cmp_ge_u32 s71, 0x40000
s_cbranch_scc1 parallel_sum__compressed_kv_cla__geglu_ffn__prompt_kernel_spin9_ret
s_nop 2
s_cbranch_vccnz parallel_sum__compressed_kv_cla__geglu_ffn__prompt_kernel_spin9_l
s_branch parallel_sum__compressed_kv_cla__geglu_ffn__prompt_kernel_spin9_ret
parallel_sum__compressed_kv_cla__geglu_ffn__prompt_kernel_spin10:
s_mov_b32 s71, 0
parallel_sum__compressed_kv_cla__geglu_ffn__prompt_kernel_spin10_l:
s_sleep 2
s_lshl_b32 s68, s100, 7
s_add_u32 s68, s68, 113254400
v_and_b32 v110, 3, v0
v_lshlrev_b32 v110, 2, v110
buffer_load_dword v110, v110, s[20:23], s68 offen sc1
s_waitcnt vmcnt(0)
v_cmp_eq_u32 vcc, 0, v110
s_add_u32 s71, s71, 1
s_cmp_ge_u32 s71, 0x40000
s_cbranch_scc1 parallel_sum__compressed_kv_cla__geglu_ffn__prompt_kernel_spin10_ret
s_nop 2
s_cbranch_vccnz parallel_sum__compressed_kv_cla__geglu_ffn__prompt_kernel_spin10_l
s_branch parallel_sum__compressed_kv_cla__geglu_ffn__prompt_kernel_spin10_ret
parallel_sum__compressed_kv_cla__geglu_ffn__prompt_kernel_end:
s_endpgm
.section .rodata,"a"
.p2align 6
.amdhsa_kernel parallel_sum__compressed_kv_cla__geglu_ffn__prompt_kernel
  .amdhsa_next_free_vgpr 512
  .amdhsa_next_free_sgpr 102
  .amdhsa_accum_offset 256
  .amdhsa_group_segment_fixed_size 0
  .amdhsa_kernarg_size 104
  .amdhsa_user_sgpr_count 2
  .amdhsa_user_sgpr_kernarg_segment_ptr 1
  .amdhsa_system_sgpr_workgroup_id_x 1
.end_amdhsa_kernel
```
